```python
import torch

def _softmax(x, axis=-1):
    return torch.softmax(x, dim=axis)

def _gelu(x):
    return torch.nn.functional.gelu(x, approximate='tanh')

def _silu(x):
    return torch.nn.functional.silu(x)

def _sigmoid(x):
    return torch.sigmoid(x)

def _layernorm(x, axis=-1, eps=1e-05):
    m = x.mean(dim=axis, keepdim=True)
    v = x.var(dim=axis, keepdim=True, unbiased=False)
    return (x - m) / torch.sqrt(v + eps)

def _scatter_add(tgt, idx, src, axis=0):
    return tgt.clone().index_add_(axis, idx, src)

def _segment_sum(src, seg, n):
    out = torch.zeros((n,) + src.shape[1:], dtype=src.dtype)
    return out.index_add_(0, seg, src)

def _pad(x, pw):
    flat = tuple((v for pair in reversed(pw) for v in pair))
    return torch.nn.functional.pad(x, flat)
kernel_name = 'adaLN_cond__sliding_block_cached__dense_activation_gelu__decode'

def setup_inputs():

    _w = lambda a: (lambda t: t.to(torch.bfloat16) if t.is_floating_point() else t)(torch.as_tensor(a))

    def _A_setup():
        B, Sq, D = (4, 1, 640)
        Hq, Hkv, Sk, Dh = (32, 32, 8192, 128)
        assert Hq % Hkv == 0, (Hq, Hkv)
        return {'x': _w((lambda *s: torch.randn(*s, dtype=torch.bfloat16) * 0.1)(B, Sq, D)), 'k_cache': _w((lambda *s: torch.randn(*s, dtype=torch.bfloat16) * 0.8)(B, Hkv, Sk, Dh)), 'v_cache': _w((lambda *s: torch.randn(*s, dtype=torch.bfloat16) * 3.2)(B, Hkv, Sk, Dh)), 'wq': _w((lambda *s: torch.randn(*s, dtype=torch.bfloat16) * 0.8)(D, Hq * Dh) * D ** (-0.5)), 'wo': _w((lambda *s: torch.randn(*s, dtype=torch.bfloat16) * 3.2)(Hq * Dh, D) * (Hq * Dh) ** (-0.5))}
    _A_in = _A_setup()

    def _B_setup():
        B, S, D, F = (4, 1, 640, 1728)
        return {'x': _w((lambda *s: torch.randn(*s, dtype=torch.bfloat16) * 0.1)(B, S, D)), 'w1': _w((lambda *s: torch.randn(*s, dtype=torch.bfloat16) * 3.2)(D, F) * D ** (-0.5)), 'b1': _w((lambda *s: torch.randn(*s, dtype=torch.bfloat16) * 3.2)(F) * 0.01), 'w2': _w((lambda *s: torch.randn(*s, dtype=torch.bfloat16) * 3.2)(F, D) * F ** (-0.5)), 'b2': _w((lambda *s: torch.randn(*s, dtype=torch.bfloat16) * 3.2)(D) * 0.01)}
    _B_in = _B_setup()
    return {'A_x': _A_in['x'], 'A_k_cache': _A_in['k_cache'], 'A_v_cache': _A_in['v_cache'], 'A_wq': _A_in['wq'], 'A_wo': _A_in['wo'], 'B_x': _B_in['x'], 'B_w1': _B_in['w1'], 'B_b1': _B_in['b1'], 'B_w2': _B_in['w2'], 'B_b2': _B_in['b2'], 'c': _w((lambda *s: torch.randn(*s, dtype=torch.bfloat16) * 0.1)(4, 640) * 8.0), 'w_mod': _w((lambda *s: torch.randn(*s, dtype=torch.bfloat16) * 0.1)(640, 6 * 640) * 640 ** (-0.5) * 8.0)}

def reference(A_x, A_k_cache, A_v_cache, A_wq, A_wo, B_x, B_w1, B_b1, B_w2, B_b2, c, w_mod):

    def _A_ref(x, k_cache, v_cache, wq, wo):
        B, Sq, D = x.shape
        Hq, Dh = (32, 128)
        Hkv, Sk = (k_cache.shape[1], k_cache.shape[2])
        W = min(4096, max(256, Sk // 4))
        rep = Hq // Hkv
        q = (lambda x, *d: x.permute(*d))((x @ wq).reshape(B, Sq, Hq, Dh), 0, 2, 1, 3)
        k = (lambda x, n, axis: torch.repeat_interleave(x, n, dim=axis))(k_cache[:, :, Sk - W:, :], rep, axis=1)
        v = (lambda x, n, axis: torch.repeat_interleave(x, n, dim=axis))(v_cache[:, :, Sk - W:, :], rep, axis=1)
        scores = torch.einsum('bhqd,bhkd->bhqk', q, k) * Dh ** (-0.5)
        p = _softmax(scores, axis=-1)
        o = torch.einsum('bhqk,bhkd->bhqd', p, v)
        return (lambda x, *d: x.permute(*d))(o, 0, 2, 1, 3).reshape(B, Sq, Hq * Dh) @ wo

    def _B_ref(x, w1, b1, w2, b2):
        h = torch.einsum('bsd,df->bsf', x, w1) + b1
        h = _gelu(h)
        return torch.einsum('bsf,fd->bsd', h, w2) + b2
    x = A_x
    mod = (_silu(c) @ w_mod).reshape(c.shape[0], 6, 1, -1)
    sa, ca, ga, sb, cb, gb = (mod[:, 0].clone(), mod[:, 1].clone(), mod[:, 2].clone(), mod[:, 3].clone(), mod[:, 4].clone(), mod[:, 5].clone())
    h = _layernorm(x, axis=-1) * (1 + ca) + sa
    x = x + ga * _A_ref(h, A_k_cache, A_v_cache, A_wq, A_wo)
    h = _layernorm(x, axis=-1) * (1 + cb) + sb
    x = x + gb * _B_ref(h, B_w1, B_b1, B_w2, B_b2)
    return x
```

```asm
; @launch grid=(256,1,1) block=(512,1,1) lds=130304
.amdgcn_target "amdgcn-amd-amdhsa--gfx950"
.text
.globl adaLN_cond__sliding_block_cached__dense_activation_gelu__decode_kernel
.p2align 8
.type adaLN_cond__sliding_block_cached__dense_activation_gelu__decode_kernel,@function
adaLN_cond__sliding_block_cached__dense_activation_gelu__decode_kernel:
    s_cmp_ge_u32 s2, 256
    s_cbranch_scc1 L_exit
    s_load_dwordx16 s[4:19], s[0:1], 0
    s_load_dwordx8 s[20:27], s[0:1], 64
    s_load_dwordx4 s[28:31], s[0:1], 96
    s_load_dwordx2 s[32:33], s[0:1], 112
    v_lshrrev_b32 v1, 6, v0
    v_and_b32 v0, 63, v0
    v_readfirstlane_b32 s3, v1
    s_and_b32 s60, s2, 7
    s_lshr_b32 s61, s2, 3
    s_cmp_eq_u32 s3, 0
    s_cbranch_scc1 L_helper
    s_and_b32 s34, s2, 127
    s_lshl_b32 s34, s34, 21
    s_lshr_b32 s35, s2, 7
    s_lshl_b32 s35, s35, 18
    s_add_u32 s34, s34, s35
    s_add_u32 s34, s34, 1572864
    s_sub_u32 s35, s3, 1
    s_lshl_b32 s35, s35, 12
    v_lshl_add_u32 v1, v0, 4, s35
    s_mov_b32 s38, 0x40000
    s_mov_b32 s39, 0x20000
    s_mov_b32 s42, 0x40000
    s_mov_b32 s43, 0x20000
    s_waitcnt lgkmcnt(0)
    s_add_u32 s36, s6, s34
    s_addc_u32 s37, s7, 0
    s_add_u32 s40, s8, s34
    s_addc_u32 s41, s9, 0
    s_mov_b32 s34, 0
    buffer_load_dwordx4 v[16:19], v1, s[36:39], s34 offen offset:0 nt
    buffer_load_dwordx4 v[20:23], v1, s[36:39], s34 offen offset:1024 nt
    buffer_load_dwordx4 v[24:27], v1, s[36:39], s34 offen offset:2048 nt
    buffer_load_dwordx4 v[28:31], v1, s[36:39], s34 offen offset:3072 nt
    s_barrier
    s_mov_b32 s34, 28672
    buffer_load_dwordx4 v[32:35], v1, s[36:39], s34 offen offset:0 nt
    buffer_load_dwordx4 v[36:39], v1, s[36:39], s34 offen offset:1024 nt
    buffer_load_dwordx4 v[40:43], v1, s[36:39], s34 offen offset:2048 nt
    buffer_load_dwordx4 v[44:47], v1, s[36:39], s34 offen offset:3072 nt
    s_mov_b32 s34, 57344
    buffer_load_dwordx4 v[48:51], v1, s[36:39], s34 offen offset:0 nt
    buffer_load_dwordx4 v[52:55], v1, s[36:39], s34 offen offset:1024 nt
    buffer_load_dwordx4 v[56:59], v1, s[36:39], s34 offen offset:2048 nt
    buffer_load_dwordx4 v[60:63], v1, s[36:39], s34 offen offset:3072 nt
    s_mov_b32 s34, 86016
    buffer_load_dwordx4 v[64:67], v1, s[36:39], s34 offen offset:0 nt
    buffer_load_dwordx4 v[68:71], v1, s[36:39], s34 offen offset:1024 nt
    buffer_load_dwordx4 v[72:75], v1, s[36:39], s34 offen offset:2048 nt
    buffer_load_dwordx4 v[76:79], v1, s[36:39], s34 offen offset:3072 nt
    s_mov_b32 s34, 114688
    buffer_load_dwordx4 v[80:83], v1, s[36:39], s34 offen offset:0 nt
    buffer_load_dwordx4 v[84:87], v1, s[36:39], s34 offen offset:1024 nt
    buffer_load_dwordx4 v[88:91], v1, s[36:39], s34 offen offset:2048 nt
    buffer_load_dwordx4 v[92:95], v1, s[36:39], s34 offen offset:3072 nt
    s_mov_b32 s34, 143360
    buffer_load_dwordx4 v[96:99], v1, s[36:39], s34 offen offset:0 nt
    buffer_load_dwordx4 v[100:103], v1, s[36:39], s34 offen offset:1024 nt
    buffer_load_dwordx4 v[104:107], v1, s[36:39], s34 offen offset:2048 nt
    buffer_load_dwordx4 v[108:111], v1, s[36:39], s34 offen offset:3072 nt
    s_mov_b32 s34, 172032
    buffer_load_dwordx4 v[112:115], v1, s[36:39], s34 offen offset:0 nt
    buffer_load_dwordx4 v[116:119], v1, s[36:39], s34 offen offset:1024 nt
    buffer_load_dwordx4 v[120:123], v1, s[36:39], s34 offen offset:2048 nt
    buffer_load_dwordx4 v[124:127], v1, s[36:39], s34 offen offset:3072 nt
    s_mov_b32 s34, 200704
    buffer_load_dwordx4 v[128:131], v1, s[36:39], s34 offen offset:0 nt
    buffer_load_dwordx4 v[132:135], v1, s[36:39], s34 offen offset:1024 nt
    buffer_load_dwordx4 v[136:139], v1, s[36:39], s34 offen offset:2048 nt
    buffer_load_dwordx4 v[140:143], v1, s[36:39], s34 offen offset:3072 nt
    s_mov_b32 s34, 229376
    buffer_load_dwordx4 v[144:147], v1, s[36:39], s34 offen offset:0 nt
    buffer_load_dwordx4 v[148:151], v1, s[36:39], s34 offen offset:1024 nt
    buffer_load_dwordx4 v[152:155], v1, s[36:39], s34 offen offset:2048 nt
    buffer_load_dwordx4 v[156:159], v1, s[36:39], s34 offen offset:3072 nt
    s_mov_b32 s34, 258048
    buffer_load_dwordx4 v[160:163], v1, s[36:39], s34 offen offset:0 nt
    buffer_load_dwordx4 v[164:167], v1, s[36:39], s34 offen offset:1024 nt
    buffer_load_dwordx4 v[168:171], v1, s[36:39], s34 offen offset:2048 nt
    buffer_load_dwordx4 v[172:175], v1, s[36:39], s34 offen offset:3072 nt
    s_mov_b32 s34, 0
    buffer_load_dwordx4 v[176:179], v1, s[40:43], s34 offen offset:0 nt
    buffer_load_dwordx4 v[180:183], v1, s[40:43], s34 offen offset:1024 nt
    buffer_load_dwordx4 v[184:187], v1, s[40:43], s34 offen offset:2048 nt
    buffer_load_dwordx4 v[188:191], v1, s[40:43], s34 offen offset:3072 nt
    s_mov_b32 s34, 28672
    buffer_load_dwordx4 v[192:195], v1, s[40:43], s34 offen offset:0 nt
    buffer_load_dwordx4 v[196:199], v1, s[40:43], s34 offen offset:1024 nt
    buffer_load_dwordx4 v[200:203], v1, s[40:43], s34 offen offset:2048 nt
    buffer_load_dwordx4 v[204:207], v1, s[40:43], s34 offen offset:3072 nt
    s_mov_b32 s34, 57344
    buffer_load_dwordx4 v[208:211], v1, s[40:43], s34 offen offset:0 nt
    buffer_load_dwordx4 v[212:215], v1, s[40:43], s34 offen offset:1024 nt
    buffer_load_dwordx4 v[216:219], v1, s[40:43], s34 offen offset:2048 nt
    buffer_load_dwordx4 v[220:223], v1, s[40:43], s34 offen offset:3072 nt
    s_mov_b32 s34, 86016
    buffer_load_dwordx4 v[224:227], v1, s[40:43], s34 offen offset:0 nt
    buffer_load_dwordx4 v[228:231], v1, s[40:43], s34 offen offset:1024 nt
    buffer_load_dwordx4 v[232:235], v1, s[40:43], s34 offen offset:2048 nt
    buffer_load_dwordx4 v[236:239], v1, s[40:43], s34 offen offset:3072 nt
    s_mov_b32 s34, 114688
    buffer_load_dwordx4 v[240:243], v1, s[40:43], s34 offen offset:0 nt
    buffer_load_dwordx4 v[244:247], v1, s[40:43], s34 offen offset:1024 nt
    buffer_load_dwordx4 v[248:251], v1, s[40:43], s34 offen offset:2048 nt
    buffer_load_dwordx4 v[252:255], v1, s[40:43], s34 offen offset:3072 nt
    s_mov_b32 s44, s32
    s_and_b32 s45, s33, 0xffff
    s_mov_b32 s46, 196608
    s_mov_b32 s47, 0x20000
    v_and_b32 v2, 15, v0
    v_lshlrev_b32 v2, 4, v2
    v_add_u32 v2, 98304, v2
    s_mov_b32 s35, 0
L_poll1:
    ds_read_b128 v[4:7], v2
    s_add_u32 s35, s35, 1
    s_waitcnt lgkmcnt(0)
    v_max3_u32 v3, v4, v5, v6
    v_max_u32 v3, v3, v7
    v_cmp_eq_u32 vcc, -1, v3
    s_cbranch_vccz L_done2
    s_sleep 2
    s_cmp_lt_u32 s35, 60000
    s_cbranch_scc1 L_poll1
L_done2:
    s_waitcnt vmcnt(56)
    v_dot2_f32_bf16 v8, v16, v4, 0
    v_dot2_f32_bf16 v9, v20, v4, 0
    v_dot2_f32_bf16 v10, v24, v4, 0
    v_dot2_f32_bf16 v11, v28, v4, 0
    v_dot2c_f32_bf16 v8, v17, v5
    v_dot2c_f32_bf16 v9, v21, v5
    v_dot2c_f32_bf16 v10, v25, v5
    v_dot2c_f32_bf16 v11, v29, v5
    v_dot2c_f32_bf16 v8, v18, v6
    v_dot2c_f32_bf16 v9, v22, v6
    v_dot2c_f32_bf16 v10, v26, v6
    v_dot2c_f32_bf16 v11, v30, v6
    v_dot2c_f32_bf16 v8, v19, v7
    v_dot2c_f32_bf16 v9, v23, v7
    v_dot2c_f32_bf16 v10, v27, v7
    v_dot2c_f32_bf16 v11, v31, v7
    v_add_f32_dpp v12, v8, v8 row_ror:8 row_mask:0xf bank_mask:0x3
    v_add_f32_dpp v12, v9, v9 row_ror:8 row_mask:0xf bank_mask:0xc
    v_add_f32_dpp v13, v10, v10 row_ror:8 row_mask:0xf bank_mask:0x3
    v_add_f32_dpp v13, v11, v11 row_ror:8 row_mask:0xf bank_mask:0xc
    s_waitcnt vmcnt(52)
    v_dot2_f32_bf16 v8, v32, v4, 0
    v_dot2_f32_bf16 v9, v36, v4, 0
    v_dot2_f32_bf16 v10, v40, v4, 0
    v_dot2_f32_bf16 v11, v44, v4, 0
    v_add_f32_dpp v12, v12, v12 row_half_mirror row_mask:0xf bank_mask:0xf
    v_add_f32_dpp v13, v13, v13 row_half_mirror row_mask:0xf bank_mask:0xf
    v_dot2c_f32_bf16 v8, v33, v5
    v_dot2c_f32_bf16 v9, v37, v5
    v_dot2c_f32_bf16 v10, v41, v5
    v_dot2c_f32_bf16 v11, v45, v5
    v_add_f32_dpp v12, v12, v12 quad_perm:[1,0,3,2] row_mask:0xf bank_mask:0xf
    v_add_f32_dpp v13, v13, v13 quad_perm:[1,0,3,2] row_mask:0xf bank_mask:0xf
    v_dot2c_f32_bf16 v8, v34, v6
    v_dot2c_f32_bf16 v9, v38, v6
    v_dot2c_f32_bf16 v10, v42, v6
    v_dot2c_f32_bf16 v11, v46, v6
    v_add_f32_dpp v12, v12, v12 quad_perm:[2,3,0,1] row_mask:0xf bank_mask:0xf
    v_add_f32_dpp v13, v13, v13 quad_perm:[2,3,0,1] row_mask:0xf bank_mask:0xf
    v_dot2c_f32_bf16 v8, v35, v7
    v_dot2c_f32_bf16 v9, v39, v7
    v_dot2c_f32_bf16 v10, v43, v7
    v_dot2c_f32_bf16 v11, v47, v7
    s_mov_b32 s34, 143360
    buffer_load_dwordx4 v[32:35], v1, s[40:43], s34 offen offset:0 nt
    buffer_load_dwordx4 v[36:39], v1, s[40:43], s34 offen offset:1024 nt
    buffer_load_dwordx4 v[40:43], v1, s[40:43], s34 offen offset:2048 nt
    buffer_load_dwordx4 v[44:47], v1, s[40:43], s34 offen offset:3072 nt
    v_add_f32_dpp v16, v8, v8 row_ror:8 row_mask:0xf bank_mask:0x3
    v_add_f32_dpp v16, v9, v9 row_ror:8 row_mask:0xf bank_mask:0xc
    v_add_f32_dpp v17, v10, v10 row_ror:8 row_mask:0xf bank_mask:0x3
    v_add_f32_dpp v17, v11, v11 row_ror:8 row_mask:0xf bank_mask:0xc
    s_waitcnt vmcnt(52)
    v_dot2_f32_bf16 v8, v48, v4, 0
    v_dot2_f32_bf16 v9, v52, v4, 0
    v_dot2_f32_bf16 v10, v56, v4, 0
    v_dot2_f32_bf16 v11, v60, v4, 0
    v_add_f32_dpp v16, v16, v16 row_half_mirror row_mask:0xf bank_mask:0xf
    v_add_f32_dpp v17, v17, v17 row_half_mirror row_mask:0xf bank_mask:0xf
    v_dot2c_f32_bf16 v8, v49, v5
    v_dot2c_f32_bf16 v9, v53, v5
    v_dot2c_f32_bf16 v10, v57, v5
    v_dot2c_f32_bf16 v11, v61, v5
    v_add_f32_dpp v16, v16, v16 quad_perm:[1,0,3,2] row_mask:0xf bank_mask:0xf
    v_add_f32_dpp v17, v17, v17 quad_perm:[1,0,3,2] row_mask:0xf bank_mask:0xf
    v_dot2c_f32_bf16 v8, v50, v6
    v_dot2c_f32_bf16 v9, v54, v6
    v_dot2c_f32_bf16 v10, v58, v6
    v_dot2c_f32_bf16 v11, v62, v6
    v_add_f32_dpp v16, v16, v16 quad_perm:[2,3,0,1] row_mask:0xf bank_mask:0xf
    v_add_f32_dpp v17, v17, v17 quad_perm:[2,3,0,1] row_mask:0xf bank_mask:0xf
    v_dot2c_f32_bf16 v8, v51, v7
    v_dot2c_f32_bf16 v9, v55, v7
    v_dot2c_f32_bf16 v10, v59, v7
    v_dot2c_f32_bf16 v11, v63, v7
    s_mov_b32 s34, 172032
    buffer_load_dwordx4 v[48:51], v1, s[40:43], s34 offen offset:0 nt
    buffer_load_dwordx4 v[52:55], v1, s[40:43], s34 offen offset:1024 nt
    buffer_load_dwordx4 v[56:59], v1, s[40:43], s34 offen offset:2048 nt
    buffer_load_dwordx4 v[60:63], v1, s[40:43], s34 offen offset:3072 nt
    v_add_f32_dpp v18, v8, v8 row_ror:8 row_mask:0xf bank_mask:0x3
    v_add_f32_dpp v18, v9, v9 row_ror:8 row_mask:0xf bank_mask:0xc
    v_add_f32_dpp v19, v10, v10 row_ror:8 row_mask:0xf bank_mask:0x3
    v_add_f32_dpp v19, v11, v11 row_ror:8 row_mask:0xf bank_mask:0xc
    s_waitcnt vmcnt(52)
    v_dot2_f32_bf16 v8, v64, v4, 0
    v_dot2_f32_bf16 v9, v68, v4, 0
    v_dot2_f32_bf16 v10, v72, v4, 0
    v_dot2_f32_bf16 v11, v76, v4, 0
    v_add_f32_dpp v18, v18, v18 row_half_mirror row_mask:0xf bank_mask:0xf
    v_add_f32_dpp v19, v19, v19 row_half_mirror row_mask:0xf bank_mask:0xf
    v_dot2c_f32_bf16 v8, v65, v5
    v_dot2c_f32_bf16 v9, v69, v5
    v_dot2c_f32_bf16 v10, v73, v5
    v_dot2c_f32_bf16 v11, v77, v5
    v_add_f32_dpp v18, v18, v18 quad_perm:[1,0,3,2] row_mask:0xf bank_mask:0xf
    v_add_f32_dpp v19, v19, v19 quad_perm:[1,0,3,2] row_mask:0xf bank_mask:0xf
    v_dot2c_f32_bf16 v8, v66, v6
    v_dot2c_f32_bf16 v9, v70, v6
    v_dot2c_f32_bf16 v10, v74, v6
    v_dot2c_f32_bf16 v11, v78, v6
    v_add_f32_dpp v18, v18, v18 quad_perm:[2,3,0,1] row_mask:0xf bank_mask:0xf
    v_add_f32_dpp v19, v19, v19 quad_perm:[2,3,0,1] row_mask:0xf bank_mask:0xf
    v_dot2c_f32_bf16 v8, v67, v7
    v_dot2c_f32_bf16 v9, v71, v7
    v_dot2c_f32_bf16 v10, v75, v7
    v_dot2c_f32_bf16 v11, v79, v7
    s_mov_b32 s34, 200704
    buffer_load_dwordx4 v[64:67], v1, s[40:43], s34 offen offset:0 nt
    buffer_load_dwordx4 v[68:71], v1, s[40:43], s34 offen offset:1024 nt
    buffer_load_dwordx4 v[72:75], v1, s[40:43], s34 offen offset:2048 nt
    buffer_load_dwordx4 v[76:79], v1, s[40:43], s34 offen offset:3072 nt
    v_add_f32_dpp v20, v8, v8 row_ror:8 row_mask:0xf bank_mask:0x3
    v_add_f32_dpp v20, v9, v9 row_ror:8 row_mask:0xf bank_mask:0xc
    v_add_f32_dpp v21, v10, v10 row_ror:8 row_mask:0xf bank_mask:0x3
    v_add_f32_dpp v21, v11, v11 row_ror:8 row_mask:0xf bank_mask:0xc
    s_waitcnt vmcnt(52)
    v_dot2_f32_bf16 v8, v80, v4, 0
    v_dot2_f32_bf16 v9, v84, v4, 0
    v_dot2_f32_bf16 v10, v88, v4, 0
    v_dot2_f32_bf16 v11, v92, v4, 0
    v_add_f32_dpp v20, v20, v20 row_half_mirror row_mask:0xf bank_mask:0xf
    v_add_f32_dpp v21, v21, v21 row_half_mirror row_mask:0xf bank_mask:0xf
    v_dot2c_f32_bf16 v8, v81, v5
    v_dot2c_f32_bf16 v9, v85, v5
    v_dot2c_f32_bf16 v10, v89, v5
    v_dot2c_f32_bf16 v11, v93, v5
    v_add_f32_dpp v20, v20, v20 quad_perm:[1,0,3,2] row_mask:0xf bank_mask:0xf
    v_add_f32_dpp v21, v21, v21 quad_perm:[1,0,3,2] row_mask:0xf bank_mask:0xf
    v_dot2c_f32_bf16 v8, v82, v6
    v_dot2c_f32_bf16 v9, v86, v6
    v_dot2c_f32_bf16 v10, v90, v6
    v_dot2c_f32_bf16 v11, v94, v6
    v_add_f32_dpp v20, v20, v20 quad_perm:[2,3,0,1] row_mask:0xf bank_mask:0xf
    v_add_f32_dpp v21, v21, v21 quad_perm:[2,3,0,1] row_mask:0xf bank_mask:0xf
    v_dot2c_f32_bf16 v8, v83, v7
    v_dot2c_f32_bf16 v9, v87, v7
    v_dot2c_f32_bf16 v10, v91, v7
    v_dot2c_f32_bf16 v11, v95, v7
    s_mov_b32 s34, 229376
    buffer_load_dwordx4 v[80:83], v1, s[40:43], s34 offen offset:0 nt
    buffer_load_dwordx4 v[84:87], v1, s[40:43], s34 offen offset:1024 nt
    buffer_load_dwordx4 v[88:91], v1, s[40:43], s34 offen offset:2048 nt
    buffer_load_dwordx4 v[92:95], v1, s[40:43], s34 offen offset:3072 nt
    v_add_f32_dpp v22, v8, v8 row_ror:8 row_mask:0xf bank_mask:0x3
    v_add_f32_dpp v22, v9, v9 row_ror:8 row_mask:0xf bank_mask:0xc
    v_add_f32_dpp v23, v10, v10 row_ror:8 row_mask:0xf bank_mask:0x3
    v_add_f32_dpp v23, v11, v11 row_ror:8 row_mask:0xf bank_mask:0xc
    s_waitcnt vmcnt(52)
    v_dot2_f32_bf16 v8, v96, v4, 0
    v_dot2_f32_bf16 v9, v100, v4, 0
    v_dot2_f32_bf16 v10, v104, v4, 0
    v_dot2_f32_bf16 v11, v108, v4, 0
    v_add_f32_dpp v22, v22, v22 row_half_mirror row_mask:0xf bank_mask:0xf
    v_add_f32_dpp v23, v23, v23 row_half_mirror row_mask:0xf bank_mask:0xf
    v_dot2c_f32_bf16 v8, v97, v5
    v_dot2c_f32_bf16 v9, v101, v5
    v_dot2c_f32_bf16 v10, v105, v5
    v_dot2c_f32_bf16 v11, v109, v5
    v_add_f32_dpp v22, v22, v22 quad_perm:[1,0,3,2] row_mask:0xf bank_mask:0xf
    v_add_f32_dpp v23, v23, v23 quad_perm:[1,0,3,2] row_mask:0xf bank_mask:0xf
    v_dot2c_f32_bf16 v8, v98, v6
    v_dot2c_f32_bf16 v9, v102, v6
    v_dot2c_f32_bf16 v10, v106, v6
    v_dot2c_f32_bf16 v11, v110, v6
    v_add_f32_dpp v22, v22, v22 quad_perm:[2,3,0,1] row_mask:0xf bank_mask:0xf
    v_add_f32_dpp v23, v23, v23 quad_perm:[2,3,0,1] row_mask:0xf bank_mask:0xf
    v_dot2c_f32_bf16 v8, v99, v7
    v_dot2c_f32_bf16 v9, v103, v7
    v_dot2c_f32_bf16 v10, v107, v7
    v_dot2c_f32_bf16 v11, v111, v7
    s_mov_b32 s34, 258048
    buffer_load_dwordx4 v[96:99], v1, s[40:43], s34 offen offset:0 nt
    buffer_load_dwordx4 v[100:103], v1, s[40:43], s34 offen offset:1024 nt
    buffer_load_dwordx4 v[104:107], v1, s[40:43], s34 offen offset:2048 nt
    buffer_load_dwordx4 v[108:111], v1, s[40:43], s34 offen offset:3072 nt
    v_add_f32_dpp v24, v8, v8 row_ror:8 row_mask:0xf bank_mask:0x3
    v_add_f32_dpp v24, v9, v9 row_ror:8 row_mask:0xf bank_mask:0xc
    v_add_f32_dpp v25, v10, v10 row_ror:8 row_mask:0xf bank_mask:0x3
    v_add_f32_dpp v25, v11, v11 row_ror:8 row_mask:0xf bank_mask:0xc
    s_waitcnt vmcnt(52)
    v_dot2_f32_bf16 v8, v112, v4, 0
    v_dot2_f32_bf16 v9, v116, v4, 0
    v_dot2_f32_bf16 v10, v120, v4, 0
    v_dot2_f32_bf16 v11, v124, v4, 0
    v_add_f32_dpp v24, v24, v24 row_half_mirror row_mask:0xf bank_mask:0xf
    v_add_f32_dpp v25, v25, v25 row_half_mirror row_mask:0xf bank_mask:0xf
    v_dot2c_f32_bf16 v8, v113, v5
    v_dot2c_f32_bf16 v9, v117, v5
    v_dot2c_f32_bf16 v10, v121, v5
    v_dot2c_f32_bf16 v11, v125, v5
    v_add_f32_dpp v24, v24, v24 quad_perm:[1,0,3,2] row_mask:0xf bank_mask:0xf
    v_add_f32_dpp v25, v25, v25 quad_perm:[1,0,3,2] row_mask:0xf bank_mask:0xf
    v_dot2c_f32_bf16 v8, v114, v6
    v_dot2c_f32_bf16 v9, v118, v6
    v_dot2c_f32_bf16 v10, v122, v6
    v_dot2c_f32_bf16 v11, v126, v6
    v_add_f32_dpp v24, v24, v24 quad_perm:[2,3,0,1] row_mask:0xf bank_mask:0xf
    v_add_f32_dpp v25, v25, v25 quad_perm:[2,3,0,1] row_mask:0xf bank_mask:0xf
    v_dot2c_f32_bf16 v8, v115, v7
    v_dot2c_f32_bf16 v9, v119, v7
    v_dot2c_f32_bf16 v10, v123, v7
    v_dot2c_f32_bf16 v11, v127, v7
    v_add_f32_dpp v26, v8, v8 row_ror:8 row_mask:0xf bank_mask:0x3
    v_add_f32_dpp v26, v9, v9 row_ror:8 row_mask:0xf bank_mask:0xc
    v_add_f32_dpp v27, v10, v10 row_ror:8 row_mask:0xf bank_mask:0x3
    v_add_f32_dpp v27, v11, v11 row_ror:8 row_mask:0xf bank_mask:0xc
    s_waitcnt vmcnt(48)
    v_dot2_f32_bf16 v8, v128, v4, 0
    v_dot2_f32_bf16 v9, v132, v4, 0
    v_dot2_f32_bf16 v10, v136, v4, 0
    v_dot2_f32_bf16 v11, v140, v4, 0
    v_add_f32_dpp v26, v26, v26 row_half_mirror row_mask:0xf bank_mask:0xf
    v_add_f32_dpp v27, v27, v27 row_half_mirror row_mask:0xf bank_mask:0xf
    v_dot2c_f32_bf16 v8, v129, v5
    v_dot2c_f32_bf16 v9, v133, v5
    v_dot2c_f32_bf16 v10, v137, v5
    v_dot2c_f32_bf16 v11, v141, v5
    v_add_f32_dpp v26, v26, v26 quad_perm:[1,0,3,2] row_mask:0xf bank_mask:0xf
    v_add_f32_dpp v27, v27, v27 quad_perm:[1,0,3,2] row_mask:0xf bank_mask:0xf
    v_dot2c_f32_bf16 v8, v130, v6
    v_dot2c_f32_bf16 v9, v134, v6
    v_dot2c_f32_bf16 v10, v138, v6
    v_dot2c_f32_bf16 v11, v142, v6
    v_add_f32_dpp v26, v26, v26 quad_perm:[2,3,0,1] row_mask:0xf bank_mask:0xf
    v_add_f32_dpp v27, v27, v27 quad_perm:[2,3,0,1] row_mask:0xf bank_mask:0xf
    v_dot2c_f32_bf16 v8, v131, v7
    v_dot2c_f32_bf16 v9, v135, v7
    v_dot2c_f32_bf16 v10, v139, v7
    v_dot2c_f32_bf16 v11, v143, v7
    v_add_f32_dpp v28, v8, v8 row_ror:8 row_mask:0xf bank_mask:0x3
    v_add_f32_dpp v28, v9, v9 row_ror:8 row_mask:0xf bank_mask:0xc
    v_add_f32_dpp v29, v10, v10 row_ror:8 row_mask:0xf bank_mask:0x3
    v_add_f32_dpp v29, v11, v11 row_ror:8 row_mask:0xf bank_mask:0xc
    s_waitcnt vmcnt(44)
    v_dot2_f32_bf16 v8, v144, v4, 0
    v_dot2_f32_bf16 v9, v148, v4, 0
    v_dot2_f32_bf16 v10, v152, v4, 0
    v_dot2_f32_bf16 v11, v156, v4, 0
    v_add_f32_dpp v28, v28, v28 row_half_mirror row_mask:0xf bank_mask:0xf
    v_add_f32_dpp v29, v29, v29 row_half_mirror row_mask:0xf bank_mask:0xf
    v_dot2c_f32_bf16 v8, v145, v5
    v_dot2c_f32_bf16 v9, v149, v5
    v_dot2c_f32_bf16 v10, v153, v5
    v_dot2c_f32_bf16 v11, v157, v5
    v_add_f32_dpp v28, v28, v28 quad_perm:[1,0,3,2] row_mask:0xf bank_mask:0xf
    v_add_f32_dpp v29, v29, v29 quad_perm:[1,0,3,2] row_mask:0xf bank_mask:0xf
    v_dot2c_f32_bf16 v8, v146, v6
    v_dot2c_f32_bf16 v9, v150, v6
    v_dot2c_f32_bf16 v10, v154, v6
    v_dot2c_f32_bf16 v11, v158, v6
    v_add_f32_dpp v28, v28, v28 quad_perm:[2,3,0,1] row_mask:0xf bank_mask:0xf
    v_add_f32_dpp v29, v29, v29 quad_perm:[2,3,0,1] row_mask:0xf bank_mask:0xf
    v_dot2c_f32_bf16 v8, v147, v7
    v_dot2c_f32_bf16 v9, v151, v7
    v_dot2c_f32_bf16 v10, v155, v7
    v_dot2c_f32_bf16 v11, v159, v7
    v_add_f32_dpp v30, v8, v8 row_ror:8 row_mask:0xf bank_mask:0x3
    v_add_f32_dpp v30, v9, v9 row_ror:8 row_mask:0xf bank_mask:0xc
    v_add_f32_dpp v31, v10, v10 row_ror:8 row_mask:0xf bank_mask:0x3
    v_add_f32_dpp v31, v11, v11 row_ror:8 row_mask:0xf bank_mask:0xc
    s_waitcnt vmcnt(40)
    v_dot2_f32_bf16 v8, v160, v4, 0
    v_dot2_f32_bf16 v9, v164, v4, 0
    v_dot2_f32_bf16 v10, v168, v4, 0
    v_dot2_f32_bf16 v11, v172, v4, 0
    v_add_f32_dpp v30, v30, v30 row_half_mirror row_mask:0xf bank_mask:0xf
    v_add_f32_dpp v31, v31, v31 row_half_mirror row_mask:0xf bank_mask:0xf
    v_dot2c_f32_bf16 v8, v161, v5
    v_dot2c_f32_bf16 v9, v165, v5
    v_dot2c_f32_bf16 v10, v169, v5
    v_dot2c_f32_bf16 v11, v173, v5
    v_add_f32_dpp v30, v30, v30 quad_perm:[1,0,3,2] row_mask:0xf bank_mask:0xf
    v_add_f32_dpp v31, v31, v31 quad_perm:[1,0,3,2] row_mask:0xf bank_mask:0xf
    v_dot2c_f32_bf16 v8, v162, v6
    v_dot2c_f32_bf16 v9, v166, v6
    v_dot2c_f32_bf16 v10, v170, v6
    v_dot2c_f32_bf16 v11, v174, v6
    v_add_f32_dpp v30, v30, v30 quad_perm:[2,3,0,1] row_mask:0xf bank_mask:0xf
    v_add_f32_dpp v31, v31, v31 quad_perm:[2,3,0,1] row_mask:0xf bank_mask:0xf
    v_dot2c_f32_bf16 v8, v163, v7
    v_dot2c_f32_bf16 v9, v167, v7
    v_dot2c_f32_bf16 v10, v171, v7
    v_dot2c_f32_bf16 v11, v175, v7
    v_add_f32_dpp v14, v8, v8 row_ror:8 row_mask:0xf bank_mask:0x3
    v_add_f32_dpp v14, v9, v9 row_ror:8 row_mask:0xf bank_mask:0xc
    v_add_f32_dpp v15, v10, v10 row_ror:8 row_mask:0xf bank_mask:0x3
    v_add_f32_dpp v15, v11, v11 row_ror:8 row_mask:0xf bank_mask:0xc
    v_add_f32_dpp v14, v14, v14 row_half_mirror row_mask:0xf bank_mask:0xf
    s_nop 0
    v_add_f32_dpp v15, v15, v15 row_half_mirror row_mask:0xf bank_mask:0xf
    v_add_f32_dpp v14, v14, v14 quad_perm:[1,0,3,2] row_mask:0xf bank_mask:0xf
    s_nop 0
    v_add_f32_dpp v15, v15, v15 quad_perm:[1,0,3,2] row_mask:0xf bank_mask:0xf
    v_add_f32_dpp v14, v14, v14 quad_perm:[2,3,0,1] row_mask:0xf bank_mask:0xf
    s_nop 0
    v_add_f32_dpp v15, v15, v15 quad_perm:[2,3,0,1] row_mask:0xf bank_mask:0xf
    s_cmp_eq_u32 s3, 1
    s_cbranch_scc1 L_nomask
    v_mov_b32 v14, 0xfe967699
    v_mov_b32 v15, 0xfe967699
L_nomask:
    v_max3_f32 v8, v12, v13, v16
    v_max3_f32 v8, v8, v17, v18
    v_max3_f32 v8, v8, v19, v20
    v_max3_f32 v8, v8, v21, v22
    v_max3_f32 v8, v8, v23, v24
    v_max3_f32 v8, v8, v25, v26
    v_max3_f32 v8, v8, v27, v28
    v_max3_f32 v8, v8, v29, v30
    v_max3_f32 v8, v8, v31, v14
    v_max_f32 v8, v8, v15
    s_nop 1
    v_max_f32_dpp v8, v8, v8 row_ror:8 row_mask:0xf bank_mask:0xf
    v_mov_b32 v9, v8
    s_nop 1
    v_permlane16_swap_b32 v8, v9
    v_max_f32 v8, v8, v9
    v_mov_b32 v9, v8
    s_nop 1
    v_permlane32_swap_b32 v8, v9
    v_max_f32 v8, v8, v9
    s_mov_b32 s34, 0x3e0293ee
    v_mul_f32 v8, s34, v8
    v_fma_f32 v12, v12, s34, -v8
    v_fma_f32 v13, v13, s34, -v8
    v_fma_f32 v16, v16, s34, -v8
    v_fma_f32 v17, v17, s34, -v8
    v_fma_f32 v18, v18, s34, -v8
    v_fma_f32 v19, v19, s34, -v8
    v_fma_f32 v20, v20, s34, -v8
    v_fma_f32 v21, v21, s34, -v8
    v_fma_f32 v22, v22, s34, -v8
    v_fma_f32 v23, v23, s34, -v8
    v_fma_f32 v24, v24, s34, -v8
    v_fma_f32 v25, v25, s34, -v8
    v_fma_f32 v26, v26, s34, -v8
    v_fma_f32 v27, v27, s34, -v8
    v_fma_f32 v28, v28, s34, -v8
    v_fma_f32 v29, v29, s34, -v8
    v_fma_f32 v30, v30, s34, -v8
    v_fma_f32 v31, v31, s34, -v8
    v_fma_f32 v14, v14, s34, -v8
    v_fma_f32 v15, v15, s34, -v8
    v_exp_f32 v12, v12
    v_exp_f32 v13, v13
    v_exp_f32 v16, v16
    v_exp_f32 v17, v17
    v_exp_f32 v18, v18
    v_exp_f32 v19, v19
    v_exp_f32 v20, v20
    v_exp_f32 v21, v21
    v_exp_f32 v22, v22
    v_exp_f32 v23, v23
    v_exp_f32 v24, v24
    v_exp_f32 v25, v25
    v_exp_f32 v26, v26
    v_exp_f32 v27, v27
    v_exp_f32 v28, v28
    v_exp_f32 v29, v29
    v_exp_f32 v30, v30
    v_exp_f32 v31, v31
    v_exp_f32 v14, v14
    v_exp_f32 v15, v15
    v_add_f32 v9, v12, v13
    v_add_f32 v9, v9, v16
    v_add_f32 v9, v9, v17
    v_add_f32 v9, v9, v18
    v_add_f32 v9, v9, v19
    v_add_f32 v9, v9, v20
    v_add_f32 v9, v9, v21
    v_add_f32 v9, v9, v22
    v_add_f32 v9, v9, v23
    v_add_f32 v9, v9, v24
    v_add_f32 v9, v9, v25
    v_add_f32 v9, v9, v26
    v_add_f32 v9, v9, v27
    v_add_f32 v9, v9, v28
    v_add_f32 v9, v9, v29
    v_add_f32 v9, v9, v30
    v_add_f32 v9, v9, v31
    v_add_f32 v9, v9, v14
    v_add_f32 v9, v9, v15
    v_and_b32 v10, 1, v0
    v_lshlrev_b32 v10, 4, v10
    v_mov_b32 v11, 0xffff
    v_lshlrev_b32 v10, v10, v11
    v_bfe_u32 v11, v0, 1, 2
    v_cmp_eq_u32 vcc, 0, v11
    s_nop 1
    v_cndmask_b32 v160, 0, v10, vcc
    v_cmp_eq_u32 vcc, 1, v11
    s_nop 1
    v_cndmask_b32 v161, 0, v10, vcc
    v_cmp_eq_u32 vcc, 2, v11
    s_nop 1
    v_cndmask_b32 v162, 0, v10, vcc
    v_cmp_eq_u32 vcc, 3, v11
    s_nop 1
    v_cndmask_b32 v163, 0, v10, vcc
    v_add_f32_dpp v9, v9, v9 row_ror:8 row_mask:0xf bank_mask:0xf
    v_mov_b32 v10, v9
    s_nop 1
    v_permlane16_swap_b32 v9, v10
    v_add_f32 v9, v9, v10
    v_mov_b32 v10, v9
    s_nop 1
    v_permlane32_swap_b32 v9, v10
    v_add_f32 v9, v9, v10
    s_lshl_b32 s34, s3, 3
    s_add_u32 s34, s34, 98552
    v_mov_b32 v10, s34
    s_mov_b64 exec, 1
    ds_write_b64 v10, v[8:9]
    s_mov_b64 exec, -1
    s_lshl_b32 s34, s3, 10
    s_add_u32 s34, s34, 98304
    v_lshl_add_u32 v2, v0, 4, s34
    v_cvt_pk_bf16_f32 v10, v12, v12
    v_and_b32 v144, v10, v160
    v_and_b32 v145, v10, v161
    v_and_b32 v146, v10, v162
    v_and_b32 v147, v10, v163
    s_waitcnt vmcnt(38)
    s_nop 0
    v_mfma_f32_16x16x32_bf16 v[164:167], v[176:179], v[144:147], 0
    v_mfma_f32_16x16x32_bf16 v[168:171], v[180:183], v[144:147], 0
    v_cvt_pk_bf16_f32 v10, v13, v13
    v_and_b32 v148, v10, v160
    v_and_b32 v149, v10, v161
    v_and_b32 v150, v10, v162
    v_and_b32 v151, v10, v163
    s_waitcnt vmcnt(36)
    s_nop 0
    v_mfma_f32_16x16x32_bf16 v[164:167], v[184:187], v[148:151], v[164:167]
    v_mfma_f32_16x16x32_bf16 v[168:171], v[188:191], v[148:151], v[168:171]
    v_cvt_pk_bf16_f32 v10, v16, v16
    v_and_b32 v144, v10, v160
    v_and_b32 v145, v10, v161
    v_and_b32 v146, v10, v162
    v_and_b32 v147, v10, v163
    s_waitcnt vmcnt(34)
    s_nop 0
    v_mfma_f32_16x16x32_bf16 v[164:167], v[192:195], v[144:147], v[164:167]
    v_mfma_f32_16x16x32_bf16 v[168:171], v[196:199], v[144:147], v[168:171]
    v_cvt_pk_bf16_f32 v10, v17, v17
    v_and_b32 v148, v10, v160
    v_and_b32 v149, v10, v161
    v_and_b32 v150, v10, v162
    v_and_b32 v151, v10, v163
    s_waitcnt vmcnt(32)
    s_nop 0
    v_mfma_f32_16x16x32_bf16 v[164:167], v[200:203], v[148:151], v[164:167]
    v_mfma_f32_16x16x32_bf16 v[168:171], v[204:207], v[148:151], v[168:171]
    v_cvt_pk_bf16_f32 v10, v18, v18
    v_and_b32 v144, v10, v160
    v_and_b32 v145, v10, v161
    v_and_b32 v146, v10, v162
    v_and_b32 v147, v10, v163
    s_waitcnt vmcnt(30)
    s_nop 0
    v_mfma_f32_16x16x32_bf16 v[164:167], v[208:211], v[144:147], v[164:167]
    v_mfma_f32_16x16x32_bf16 v[168:171], v[212:215], v[144:147], v[168:171]
    v_cvt_pk_bf16_f32 v10, v19, v19
    v_and_b32 v148, v10, v160
    v_and_b32 v149, v10, v161
    v_and_b32 v150, v10, v162
    v_and_b32 v151, v10, v163
    s_waitcnt vmcnt(28)
    s_nop 0
    v_mfma_f32_16x16x32_bf16 v[164:167], v[216:219], v[148:151], v[164:167]
    v_mfma_f32_16x16x32_bf16 v[168:171], v[220:223], v[148:151], v[168:171]
    v_cvt_pk_bf16_f32 v10, v20, v20
    v_and_b32 v144, v10, v160
    v_and_b32 v145, v10, v161
    v_and_b32 v146, v10, v162
    v_and_b32 v147, v10, v163
    s_waitcnt vmcnt(26)
    s_nop 0
    v_mfma_f32_16x16x32_bf16 v[164:167], v[224:227], v[144:147], v[164:167]
    v_mfma_f32_16x16x32_bf16 v[168:171], v[228:231], v[144:147], v[168:171]
    v_cvt_pk_bf16_f32 v10, v21, v21
    v_and_b32 v148, v10, v160
    v_and_b32 v149, v10, v161
    v_and_b32 v150, v10, v162
    v_and_b32 v151, v10, v163
    s_waitcnt vmcnt(24)
    s_nop 0
    v_mfma_f32_16x16x32_bf16 v[164:167], v[232:235], v[148:151], v[164:167]
    v_mfma_f32_16x16x32_bf16 v[168:171], v[236:239], v[148:151], v[168:171]
    v_cvt_pk_bf16_f32 v10, v22, v22
    v_and_b32 v144, v10, v160
    v_and_b32 v145, v10, v161
    v_and_b32 v146, v10, v162
    v_and_b32 v147, v10, v163
    s_waitcnt vmcnt(22)
    s_nop 0
    v_mfma_f32_16x16x32_bf16 v[164:167], v[240:243], v[144:147], v[164:167]
    v_mfma_f32_16x16x32_bf16 v[168:171], v[244:247], v[144:147], v[168:171]
    v_cvt_pk_bf16_f32 v10, v23, v23
    v_and_b32 v148, v10, v160
    v_and_b32 v149, v10, v161
    v_and_b32 v150, v10, v162
    v_and_b32 v151, v10, v163
    s_waitcnt vmcnt(20)
    s_nop 0
    v_mfma_f32_16x16x32_bf16 v[164:167], v[248:251], v[148:151], v[164:167]
    v_mfma_f32_16x16x32_bf16 v[168:171], v[252:255], v[148:151], v[168:171]
    v_cvt_pk_bf16_f32 v10, v24, v24
    v_and_b32 v144, v10, v160
    v_and_b32 v145, v10, v161
    v_and_b32 v146, v10, v162
    v_and_b32 v147, v10, v163
    s_waitcnt vmcnt(18)
    s_nop 0
    v_mfma_f32_16x16x32_bf16 v[164:167], v[32:35], v[144:147], v[164:167]
    v_mfma_f32_16x16x32_bf16 v[168:171], v[36:39], v[144:147], v[168:171]
    v_cvt_pk_bf16_f32 v10, v25, v25
    v_and_b32 v148, v10, v160
    v_and_b32 v149, v10, v161
    v_and_b32 v150, v10, v162
    v_and_b32 v151, v10, v163
    s_waitcnt vmcnt(16)
    s_nop 0
    v_mfma_f32_16x16x32_bf16 v[164:167], v[40:43], v[148:151], v[164:167]
    v_mfma_f32_16x16x32_bf16 v[168:171], v[44:47], v[148:151], v[168:171]
    v_cvt_pk_bf16_f32 v10, v26, v26
    v_and_b32 v144, v10, v160
    v_and_b32 v145, v10, v161
    v_and_b32 v146, v10, v162
    v_and_b32 v147, v10, v163
    s_waitcnt vmcnt(14)
    s_nop 0
    v_mfma_f32_16x16x32_bf16 v[164:167], v[48:51], v[144:147], v[164:167]
    v_mfma_f32_16x16x32_bf16 v[168:171], v[52:55], v[144:147], v[168:171]
    v_cvt_pk_bf16_f32 v10, v27, v27
    v_and_b32 v148, v10, v160
    v_and_b32 v149, v10, v161
    v_and_b32 v150, v10, v162
    v_and_b32 v151, v10, v163
    s_waitcnt vmcnt(12)
    s_nop 0
    v_mfma_f32_16x16x32_bf16 v[164:167], v[56:59], v[148:151], v[164:167]
    v_mfma_f32_16x16x32_bf16 v[168:171], v[60:63], v[148:151], v[168:171]
    v_cvt_pk_bf16_f32 v10, v28, v28
    v_and_b32 v144, v10, v160
    v_and_b32 v145, v10, v161
    v_and_b32 v146, v10, v162
    v_and_b32 v147, v10, v163
    s_waitcnt vmcnt(10)
    s_nop 0
    v_mfma_f32_16x16x32_bf16 v[164:167], v[64:67], v[144:147], v[164:167]
    v_mfma_f32_16x16x32_bf16 v[168:171], v[68:71], v[144:147], v[168:171]
    v_cvt_pk_bf16_f32 v10, v29, v29
    v_and_b32 v148, v10, v160
    v_and_b32 v149, v10, v161
    v_and_b32 v150, v10, v162
    v_and_b32 v151, v10, v163
    s_waitcnt vmcnt(8)
    s_nop 0
    v_mfma_f32_16x16x32_bf16 v[164:167], v[72:75], v[148:151], v[164:167]
    v_mfma_f32_16x16x32_bf16 v[168:171], v[76:79], v[148:151], v[168:171]
    v_cvt_pk_bf16_f32 v10, v30, v30
    v_and_b32 v144, v10, v160
    v_and_b32 v145, v10, v161
    v_and_b32 v146, v10, v162
    v_and_b32 v147, v10, v163
    s_waitcnt vmcnt(6)
    s_nop 0
    v_mfma_f32_16x16x32_bf16 v[164:167], v[80:83], v[144:147], v[164:167]
    v_mfma_f32_16x16x32_bf16 v[168:171], v[84:87], v[144:147], v[168:171]
    v_cvt_pk_bf16_f32 v10, v31, v31
    v_and_b32 v148, v10, v160
    v_and_b32 v149, v10, v161
    v_and_b32 v150, v10, v162
    v_and_b32 v151, v10, v163
    s_waitcnt vmcnt(4)
    s_nop 0
    v_mfma_f32_16x16x32_bf16 v[164:167], v[88:91], v[148:151], v[164:167]
    v_mfma_f32_16x16x32_bf16 v[168:171], v[92:95], v[148:151], v[168:171]
    v_cvt_pk_bf16_f32 v10, v14, v14
    v_and_b32 v144, v10, v160
    v_and_b32 v145, v10, v161
    v_and_b32 v146, v10, v162
    v_and_b32 v147, v10, v163
    s_waitcnt vmcnt(2)
    s_nop 0
    v_mfma_f32_16x16x32_bf16 v[164:167], v[96:99], v[144:147], v[164:167]
    v_mfma_f32_16x16x32_bf16 v[168:171], v[100:103], v[144:147], v[168:171]
    v_cvt_pk_bf16_f32 v10, v15, v15
    v_and_b32 v148, v10, v160
    v_and_b32 v149, v10, v161
    v_and_b32 v150, v10, v162
    v_and_b32 v151, v10, v163
    s_waitcnt vmcnt(0)
    s_nop 0
    v_mfma_f32_16x16x32_bf16 v[164:167], v[104:107], v[148:151], v[164:167]
    v_mfma_f32_16x16x32_bf16 v[168:171], v[108:111], v[148:151], v[168:171]
    s_nop 7
    v_mov_b32_dpp v164, v168 quad_perm:[0,1,2,3] row_mask:0xf bank_mask:0xc
    v_mov_b32_dpp v165, v169 quad_perm:[0,1,2,3] row_mask:0xf bank_mask:0xc
    v_mov_b32_dpp v166, v170 quad_perm:[0,1,2,3] row_mask:0xf bank_mask:0xc
    v_mov_b32_dpp v167, v171 quad_perm:[0,1,2,3] row_mask:0xf bank_mask:0xc
    ds_write_b128 v2, v[164:167]
    s_waitcnt lgkmcnt(0)
    s_barrier
    s_branch L_tail
L_helper:
    s_setprio 3
    v_lshlrev_b32 v1, 2, v0
    v_add_u32 v1, 98304, v1
    v_mov_b32 v2, -1
    v_mov_b32 v3, 0
    v_cmp_eq_u32 vcc, 14, v0
    v_mov_b32 v5, 0xfe967699
    s_nop 0
    v_cndmask_b32 v4, v2, v5, vcc
    v_cmp_eq_u32 vcc, 15, v0
    s_nop 1
    v_cndmask_b32 v4, v4, v3, vcc
    ds_write_b32 v1, v2
    ds_write_b32 v1, v4 offset:256
    ds_write_b32 v1, v3 offset:512
    v_bfe_u32 v5, v0, 3, 2
    v_lshlrev_b32 v10, 3, v5
    v_lshrrev_b32 v5, 5, v0
    v_lshl_add_u32 v10, v5, 2, v10
    v_bfe_u32 v5, v0, 1, 2
    v_add_u32 v10, v10, v5
    v_and_b32 v11, 1, v0
    v_and_b32 v12, 3, v0
    v_bfe_u32 v13, v0, 2, 2
    v_lshrrev_b32 v14, 4, v0
    v_lshlrev_b32 v15, 3, v0
    s_waitcnt lgkmcnt(0)
    s_barrier
    s_mov_b32 s44, s32
    s_and_b32 s45, s33, 0xffff
    s_mov_b32 s46, 196608
    s_mov_b32 s47, 0x20000
    s_movk_i32 s48, 0x1000
    s_lshr_b32 s34, s61, 3
    s_lshl_b32 s34, s34, 3
    s_add_u32 s34, s34, s60
    s_lshl_b32 s34, s34, 8
    s_and_b32 s35, s61, 7
    s_lshl_b32 s35, s35, 5
    s_add_u32 s49, s34, s35
    v_lshlrev_b32 v16, 13, v10
    v_lshl_add_u32 v16, v11, 4, v16
    v_add_u32 v16, s49, v16
    s_cmp_ge_u32 s61, 16
    s_cbranch_scc1 L_r_rest1
    s_cmp_lt_u32 s61, 8
    s_cbranch_scc1 L_r_h
    s_cmp_lt_u32 s60, 2
    s_cbranch_scc1 L_r_h
    s_cmp_ge_u32 s60, 6
    s_cbranch_scc1 L_clear
    s_lshl_b32 s34, s60, 1
    s_lshr_b32 s35, s61, 2
    s_add_u32 s34, s34, s35
    s_add_u32 s34, s34, 26
    s_branch L_r_rest2
L_r_rest1:
    s_lshr_b32 s34, s61, 2
    s_sub_u32 s34, s34, 4
    s_lshl_b32 s34, s34, 3
    s_add_u32 s34, s34, s60
L_r_rest2:
    s_lshl_b32 s34, s34, 7
    s_and_b32 s35, s61, 3
    s_lshl_b32 s35, s35, 5
    s_add_u32 s51, s34, s35
    s_add_u32 s53, s51, 2560
    s_mov_b32 s52, 16
    s_mov_b32 s50, 1
    s_mov_b32 s54, 0
    s_branch L_p1
L_r_h:
    s_and_b32 s34, s61, 8
    s_add_u32 s34, s34, s60
    s_lshl_b32 s34, s34, 7
    s_and_b32 s35, s61, 7
    s_lshl_b32 s35, s35, 4
    s_add_u32 s51, s34, s35
    s_mov_b32 s53, s51
    s_movk_i32 s52, 1280
    s_mov_b32 s50, 0
    s_mov_b32 s54, s51
L_p1:
    v_mul_u32_u24 v17, 1280, v12
    v_lshl_add_u32 v18, v13, 6, v17
    v_lshl_add_u32 v18, v14, 4, v18
    global_load_dwordx4 v[32:35], v18, s[24:25] offset:0
    global_load_dwordx4 v[36:39], v18, s[24:25] offset:256
    global_load_dwordx4 v[40:43], v18, s[24:25] offset:512
    global_load_dwordx4 v[44:47], v18, s[24:25] offset:768
    global_load_dwordx4 v[48:51], v18, s[24:25] offset:1024
    global_load_dwordx4 v[52:55], v18, s[4:5] offset:0
    global_load_dwordx4 v[56:59], v18, s[4:5] offset:256
    global_load_dwordx4 v[60:63], v18, s[4:5] offset:512
    global_load_dwordx4 v[64:67], v18, s[4:5] offset:768
    global_load_dwordx4 v[68:71], v18, s[4:5] offset:1024
    v_and_b32 v19, 1, v14
    v_lshl_add_u32 v19, v19, 3, v17
    v_add_u32 v19, s54, v19
    global_load_dwordx2 v[72:73], v19, s[4:5]
    s_mov_b32 s36, s26
    s_and_b32 s37, s27, 0xffff
    s_mov_b32 s38, 4915200
    s_mov_b32 s39, 0x20000
    v_mul_u32_u24 v17, 7680, v10
    v_mul_u32_u24 v19, s52, v11
    v_add3_u32 v17, v17, v19, s53
    s_mov_b32 m0, 0
    s_mov_b32 s34, 0
L_dma3:
    buffer_load_dwordx4 v17, s[36:39], s34 offen nt lds
    s_add_u32 m0, m0, 1024
    s_add_u32 s34, s34, 245760
    s_cmp_lt_u32 s34, 4915200
    s_cbranch_scc1 L_dma3
    s_getpc_b64 s[56:57]
L_pc4:
    s_sub_u32 s56, s56, L_pc4-adaLN_cond__sliding_block_cached__dense_activation_gelu__decode_kernel
    s_subb_u32 s57, s57, 0
    s_and_b32 s34, s61, 15
    s_lshl_b32 s34, s34, 10
    v_lshl_add_u32 v19, v0, 4, s34
    v_min_u32 v19, L_codeend-adaLN_cond__sliding_block_cached__dense_activation_gelu__decode_kernel-16, v19
    global_load_dwordx4 v[76:79], v19, s[56:57]
    s_mov_b32 s36, s10
    s_and_b32 s37, s11, 0xffff
    s_mov_b32 s38, 5242880
    s_mov_b32 s39, 0x20000
    s_mov_b32 m0, 20480
    s_mov_b32 s34, 0
L_dma5:
    buffer_load_dwordx4 v16, s[36:39], s34 offen nt lds
    s_add_u32 m0, m0, 1024
    s_add_u32 s34, s34, 262144
    s_cmp_lt_u32 s34, 5242880
    s_cbranch_scc1 L_dma5
    s_waitcnt vmcnt(47)
    s_mov_b32 s34, 0xbfb8aa3b
    v_lshlrev_b32 v20, 16, v32
    v_and_b32 v21, 0xffff0000, v32
    v_lshlrev_b32 v22, 16, v33
    v_and_b32 v23, 0xffff0000, v33
    v_mul_f32 v24, s34, v20
    v_mul_f32 v25, s34, v21
    v_mul_f32 v26, s34, v22
    v_mul_f32 v27, s34, v23
    v_exp_f32 v24, v24
    v_exp_f32 v25, v25
    v_exp_f32 v26, v26
    v_exp_f32 v27, v27
    v_add_f32 v24, 1.0, v24
    v_add_f32 v25, 1.0, v25
    v_add_f32 v26, 1.0, v26
    v_add_f32 v27, 1.0, v27
    v_rcp_f32 v24, v24
    v_rcp_f32 v25, v25
    v_rcp_f32 v26, v26
    v_rcp_f32 v27, v27
    v_mul_f32 v24, v20, v24
    v_mul_f32 v25, v21, v25
    v_mul_f32 v26, v22, v26
    v_mul_f32 v27, v23, v27
    v_cvt_pk_bf16_f32 v32, v24, v25
    v_cvt_pk_bf16_f32 v33, v26, v27
    v_lshlrev_b32 v20, 16, v34
    v_and_b32 v21, 0xffff0000, v34
    v_lshlrev_b32 v22, 16, v35
    v_and_b32 v23, 0xffff0000, v35
    v_mul_f32 v24, s34, v20
    v_mul_f32 v25, s34, v21
    v_mul_f32 v26, s34, v22
    v_mul_f32 v27, s34, v23
    v_exp_f32 v24, v24
    v_exp_f32 v25, v25
    v_exp_f32 v26, v26
    v_exp_f32 v27, v27
    v_add_f32 v24, 1.0, v24
    v_add_f32 v25, 1.0, v25
    v_add_f32 v26, 1.0, v26
    v_add_f32 v27, 1.0, v27
    v_rcp_f32 v24, v24
    v_rcp_f32 v25, v25
    v_rcp_f32 v26, v26
    v_rcp_f32 v27, v27
    v_mul_f32 v24, v20, v24
    v_mul_f32 v25, v21, v25
    v_mul_f32 v26, v22, v26
    v_mul_f32 v27, v23, v27
    v_cvt_pk_bf16_f32 v34, v24, v25
    v_cvt_pk_bf16_f32 v35, v26, v27
    v_lshlrev_b32 v20, 16, v36
    v_and_b32 v21, 0xffff0000, v36
    v_lshlrev_b32 v22, 16, v37
    v_and_b32 v23, 0xffff0000, v37
    v_mul_f32 v24, s34, v20
    v_mul_f32 v25, s34, v21
    v_mul_f32 v26, s34, v22
    v_mul_f32 v27, s34, v23
    v_exp_f32 v24, v24
    v_exp_f32 v25, v25
    v_exp_f32 v26, v26
    v_exp_f32 v27, v27
    v_add_f32 v24, 1.0, v24
    v_add_f32 v25, 1.0, v25
    v_add_f32 v26, 1.0, v26
    v_add_f32 v27, 1.0, v27
    v_rcp_f32 v24, v24
    v_rcp_f32 v25, v25
    v_rcp_f32 v26, v26
    v_rcp_f32 v27, v27
    v_mul_f32 v24, v20, v24
    v_mul_f32 v25, v21, v25
    v_mul_f32 v26, v22, v26
    v_mul_f32 v27, v23, v27
    v_cvt_pk_bf16_f32 v36, v24, v25
    v_cvt_pk_bf16_f32 v37, v26, v27
    v_lshlrev_b32 v20, 16, v38
    v_and_b32 v21, 0xffff0000, v38
    v_lshlrev_b32 v22, 16, v39
    v_and_b32 v23, 0xffff0000, v39
    v_mul_f32 v24, s34, v20
    v_mul_f32 v25, s34, v21
    v_mul_f32 v26, s34, v22
    v_mul_f32 v27, s34, v23
    v_exp_f32 v24, v24
    v_exp_f32 v25, v25
    v_exp_f32 v26, v26
    v_exp_f32 v27, v27
    v_add_f32 v24, 1.0, v24
    v_add_f32 v25, 1.0, v25
    v_add_f32 v26, 1.0, v26
    v_add_f32 v27, 1.0, v27
    v_rcp_f32 v24, v24
    v_rcp_f32 v25, v25
    v_rcp_f32 v26, v26
    v_rcp_f32 v27, v27
    v_mul_f32 v24, v20, v24
    v_mul_f32 v25, v21, v25
    v_mul_f32 v26, v22, v26
    v_mul_f32 v27, v23, v27
    v_cvt_pk_bf16_f32 v38, v24, v25
    v_cvt_pk_bf16_f32 v39, v26, v27
    v_lshlrev_b32 v20, 16, v40
    v_and_b32 v21, 0xffff0000, v40
    v_lshlrev_b32 v22, 16, v41
    v_and_b32 v23, 0xffff0000, v41
    v_mul_f32 v24, s34, v20
    v_mul_f32 v25, s34, v21
    v_mul_f32 v26, s34, v22
    v_mul_f32 v27, s34, v23
    v_exp_f32 v24, v24
    v_exp_f32 v25, v25
    v_exp_f32 v26, v26
    v_exp_f32 v27, v27
    v_add_f32 v24, 1.0, v24
    v_add_f32 v25, 1.0, v25
    v_add_f32 v26, 1.0, v26
    v_add_f32 v27, 1.0, v27
    v_rcp_f32 v24, v24
    v_rcp_f32 v25, v25
    v_rcp_f32 v26, v26
    v_rcp_f32 v27, v27
    v_mul_f32 v24, v20, v24
    v_mul_f32 v25, v21, v25
    v_mul_f32 v26, v22, v26
    v_mul_f32 v27, v23, v27
    v_cvt_pk_bf16_f32 v40, v24, v25
    v_cvt_pk_bf16_f32 v41, v26, v27
    v_lshlrev_b32 v20, 16, v42
    v_and_b32 v21, 0xffff0000, v42
    v_lshlrev_b32 v22, 16, v43
    v_and_b32 v23, 0xffff0000, v43
    v_mul_f32 v24, s34, v20
    v_mul_f32 v25, s34, v21
    v_mul_f32 v26, s34, v22
    v_mul_f32 v27, s34, v23
    v_exp_f32 v24, v24
    v_exp_f32 v25, v25
    v_exp_f32 v26, v26
    v_exp_f32 v27, v27
    v_add_f32 v24, 1.0, v24
    v_add_f32 v25, 1.0, v25
    v_add_f32 v26, 1.0, v26
    v_add_f32 v27, 1.0, v27
    v_rcp_f32 v24, v24
    v_rcp_f32 v25, v25
    v_rcp_f32 v26, v26
    v_rcp_f32 v27, v27
    v_mul_f32 v24, v20, v24
    v_mul_f32 v25, v21, v25
    v_mul_f32 v26, v22, v26
    v_mul_f32 v27, v23, v27
    v_cvt_pk_bf16_f32 v42, v24, v25
    v_cvt_pk_bf16_f32 v43, v26, v27
    v_lshlrev_b32 v20, 16, v44
    v_and_b32 v21, 0xffff0000, v44
    v_lshlrev_b32 v22, 16, v45
    v_and_b32 v23, 0xffff0000, v45
    v_mul_f32 v24, s34, v20
    v_mul_f32 v25, s34, v21
    v_mul_f32 v26, s34, v22
    v_mul_f32 v27, s34, v23
    v_exp_f32 v24, v24
    v_exp_f32 v25, v25
    v_exp_f32 v26, v26
    v_exp_f32 v27, v27
    v_add_f32 v24, 1.0, v24
    v_add_f32 v25, 1.0, v25
    v_add_f32 v26, 1.0, v26
    v_add_f32 v27, 1.0, v27
    v_rcp_f32 v24, v24
    v_rcp_f32 v25, v25
    v_rcp_f32 v26, v26
    v_rcp_f32 v27, v27
    v_mul_f32 v24, v20, v24
    v_mul_f32 v25, v21, v25
    v_mul_f32 v26, v22, v26
    v_mul_f32 v27, v23, v27
    v_cvt_pk_bf16_f32 v44, v24, v25
    v_cvt_pk_bf16_f32 v45, v26, v27
    v_lshlrev_b32 v20, 16, v46
    v_and_b32 v21, 0xffff0000, v46
    v_lshlrev_b32 v22, 16, v47
    v_and_b32 v23, 0xffff0000, v47
    v_mul_f32 v24, s34, v20
    v_mul_f32 v25, s34, v21
    v_mul_f32 v26, s34, v22
    v_mul_f32 v27, s34, v23
    v_exp_f32 v24, v24
    v_exp_f32 v25, v25
    v_exp_f32 v26, v26
    v_exp_f32 v27, v27
    v_add_f32 v24, 1.0, v24
    v_add_f32 v25, 1.0, v25
    v_add_f32 v26, 1.0, v26
    v_add_f32 v27, 1.0, v27
    v_rcp_f32 v24, v24
    v_rcp_f32 v25, v25
    v_rcp_f32 v26, v26
    v_rcp_f32 v27, v27
    v_mul_f32 v24, v20, v24
    v_mul_f32 v25, v21, v25
    v_mul_f32 v26, v22, v26
    v_mul_f32 v27, v23, v27
    v_cvt_pk_bf16_f32 v46, v24, v25
    v_cvt_pk_bf16_f32 v47, v26, v27
    v_lshlrev_b32 v20, 16, v48
    v_and_b32 v21, 0xffff0000, v48
    v_lshlrev_b32 v22, 16, v49
    v_and_b32 v23, 0xffff0000, v49
    v_mul_f32 v24, s34, v20
    v_mul_f32 v25, s34, v21
    v_mul_f32 v26, s34, v22
    v_mul_f32 v27, s34, v23
    v_exp_f32 v24, v24
    v_exp_f32 v25, v25
    v_exp_f32 v26, v26
    v_exp_f32 v27, v27
    v_add_f32 v24, 1.0, v24
    v_add_f32 v25, 1.0, v25
    v_add_f32 v26, 1.0, v26
    v_add_f32 v27, 1.0, v27
    v_rcp_f32 v24, v24
    v_rcp_f32 v25, v25
    v_rcp_f32 v26, v26
    v_rcp_f32 v27, v27
    v_mul_f32 v24, v20, v24
    v_mul_f32 v25, v21, v25
    v_mul_f32 v26, v22, v26
    v_mul_f32 v27, v23, v27
    v_cvt_pk_bf16_f32 v48, v24, v25
    v_cvt_pk_bf16_f32 v49, v26, v27
    v_lshlrev_b32 v20, 16, v50
    v_and_b32 v21, 0xffff0000, v50
    v_lshlrev_b32 v22, 16, v51
    v_and_b32 v23, 0xffff0000, v51
    v_mul_f32 v24, s34, v20
    v_mul_f32 v25, s34, v21
    v_mul_f32 v26, s34, v22
    v_mul_f32 v27, s34, v23
    v_exp_f32 v24, v24
    v_exp_f32 v25, v25
    v_exp_f32 v26, v26
    v_exp_f32 v27, v27
    v_add_f32 v24, 1.0, v24
    v_add_f32 v25, 1.0, v25
    v_add_f32 v26, 1.0, v26
    v_add_f32 v27, 1.0, v27
    v_rcp_f32 v24, v24
    v_rcp_f32 v25, v25
    v_rcp_f32 v26, v26
    v_rcp_f32 v27, v27
    v_mul_f32 v24, v20, v24
    v_mul_f32 v25, v21, v25
    v_mul_f32 v26, v22, v26
    v_mul_f32 v27, v23, v27
    v_cvt_pk_bf16_f32 v50, v24, v25
    v_cvt_pk_bf16_f32 v51, v26, v27
    s_cmp_lg_u32 s50, 0
    s_cbranch_scc1 L_nostats
    s_waitcnt vmcnt(41)
    v_mov_b32 v20, 0
    v_mov_b32 v21, 0
    v_mov_b32 v22, 0x3f803f80
    v_dot2c_f32_bf16 v20, v52, v22
    v_dot2c_f32_bf16 v21, v52, v52
    v_dot2c_f32_bf16 v20, v53, v22
    v_dot2c_f32_bf16 v21, v53, v53
    v_dot2c_f32_bf16 v20, v54, v22
    v_dot2c_f32_bf16 v21, v54, v54
    v_dot2c_f32_bf16 v20, v55, v22
    v_dot2c_f32_bf16 v21, v55, v55
    v_dot2c_f32_bf16 v20, v56, v22
    v_dot2c_f32_bf16 v21, v56, v56
    v_dot2c_f32_bf16 v20, v57, v22
    v_dot2c_f32_bf16 v21, v57, v57
    v_dot2c_f32_bf16 v20, v58, v22
    v_dot2c_f32_bf16 v21, v58, v58
    v_dot2c_f32_bf16 v20, v59, v22
    v_dot2c_f32_bf16 v21, v59, v59
    v_dot2c_f32_bf16 v20, v60, v22
    v_dot2c_f32_bf16 v21, v60, v60
    v_dot2c_f32_bf16 v20, v61, v22
    v_dot2c_f32_bf16 v21, v61, v61
    v_dot2c_f32_bf16 v20, v62, v22
    v_dot2c_f32_bf16 v21, v62, v62
    v_dot2c_f32_bf16 v20, v63, v22
    v_dot2c_f32_bf16 v21, v63, v63
    v_dot2c_f32_bf16 v20, v64, v22
    v_dot2c_f32_bf16 v21, v64, v64
    v_dot2c_f32_bf16 v20, v65, v22
    v_dot2c_f32_bf16 v21, v65, v65
    v_dot2c_f32_bf16 v20, v66, v22
    v_dot2c_f32_bf16 v21, v66, v66
    v_dot2c_f32_bf16 v20, v67, v22
    v_dot2c_f32_bf16 v21, v67, v67
    v_dot2c_f32_bf16 v20, v68, v22
    v_dot2c_f32_bf16 v21, v68, v68
    v_dot2c_f32_bf16 v20, v69, v22
    v_dot2c_f32_bf16 v21, v69, v69
    v_dot2c_f32_bf16 v20, v70, v22
    v_dot2c_f32_bf16 v21, v70, v70
    v_dot2c_f32_bf16 v20, v71, v22
    v_dot2c_f32_bf16 v21, v71, v71
    s_nop 1
    v_add_f32_dpp v20, v20, v20 row_ror:4 row_mask:0xf bank_mask:0xf
    v_add_f32_dpp v21, v21, v21 row_ror:4 row_mask:0xf bank_mask:0xf
    s_nop 0
    v_add_f32_dpp v20, v20, v20 row_ror:8 row_mask:0xf bank_mask:0xf
    v_add_f32_dpp v21, v21, v21 row_ror:8 row_mask:0xf bank_mask:0xf
    v_mov_b32 v22, v20
    v_mov_b32 v23, v21
    s_nop 0
    v_permlane16_swap_b32 v20, v22
    v_permlane16_swap_b32 v21, v23
    v_add_f32 v20, v20, v22
    v_add_f32 v21, v21, v23
    v_mov_b32 v22, v20
    v_mov_b32 v23, v21
    s_nop 0
    v_permlane32_swap_b32 v20, v22
    v_permlane32_swap_b32 v21, v23
    v_add_f32 v20, v20, v22
    v_add_f32 v21, v21, v23
    v_mul_f32 v22, 0x3acccccd, v20
    v_mul_f32 v21, 0x3acccccd, v21
    v_fma_f32 v21, -v22, v22, v21
    v_max_f32 v21, 0, v21
    v_add_f32 v21, 0x3727c5ac, v21
    v_rsq_f32 v20, v21
    s_nop 0
    v_mul_f32_e64 v21, -v22, v20
    v_lshlrev_b32 v24, 16, v72
    v_and_b32 v25, 0xffff0000, v72
    v_lshlrev_b32 v26, 16, v73
    v_and_b32 v27, 0xffff0000, v73
    v_fma_f32 v24, v24, v20, v21
    v_fma_f32 v25, v25, v20, v21
    v_fma_f32 v26, v26, v20, v21
    v_fma_f32 v27, v27, v20, v21
L_nostats:
    s_waitcnt vmcnt(21)
    v_add_u32 v19, 0, v15
    ds_read_b64_tr_b16 v[96:97], v19 offset:0
    ds_read_b64_tr_b16 v[98:99], v19 offset:512
    ds_read_b64_tr_b16 v[100:101], v19 offset:1024
    ds_read_b64_tr_b16 v[102:103], v19 offset:1536
    ds_read_b64_tr_b16 v[104:105], v19 offset:2048
    ds_read_b64_tr_b16 v[106:107], v19 offset:2560
    ds_read_b64_tr_b16 v[108:109], v19 offset:3072
    ds_read_b64_tr_b16 v[110:111], v19 offset:3584
    s_waitcnt lgkmcnt(0)
    ds_read_b64_tr_b16 v[112:113], v19 offset:4096
    ds_read_b64_tr_b16 v[114:115], v19 offset:4608
    ds_read_b64_tr_b16 v[116:117], v19 offset:5120
    ds_read_b64_tr_b16 v[118:119], v19 offset:5632
    ds_read_b64_tr_b16 v[120:121], v19 offset:6144
    ds_read_b64_tr_b16 v[122:123], v19 offset:6656
    ds_read_b64_tr_b16 v[124:125], v19 offset:7168
    ds_read_b64_tr_b16 v[126:127], v19 offset:7680
    v_mfma_f32_16x16x32_bf16 v[80:83], v[96:99], v[32:35], 0
    v_mfma_f32_16x16x32_bf16 v[84:87], v[100:103], v[32:35], 0
    v_mfma_f32_16x16x32_bf16 v[88:91], v[104:107], v[32:35], 0
    v_mfma_f32_16x16x32_bf16 v[92:95], v[108:111], v[32:35], 0
    s_waitcnt lgkmcnt(0)
    ds_read_b64_tr_b16 v[96:97], v19 offset:8192
    ds_read_b64_tr_b16 v[98:99], v19 offset:8704
    ds_read_b64_tr_b16 v[100:101], v19 offset:9216
    ds_read_b64_tr_b16 v[102:103], v19 offset:9728
    ds_read_b64_tr_b16 v[104:105], v19 offset:10240
    ds_read_b64_tr_b16 v[106:107], v19 offset:10752
    ds_read_b64_tr_b16 v[108:109], v19 offset:11264
    ds_read_b64_tr_b16 v[110:111], v19 offset:11776
    v_mfma_f32_16x16x32_bf16 v[80:83], v[112:115], v[36:39], v[80:83]
    v_mfma_f32_16x16x32_bf16 v[84:87], v[116:119], v[36:39], v[84:87]
    v_mfma_f32_16x16x32_bf16 v[88:91], v[120:123], v[36:39], v[88:91]
    v_mfma_f32_16x16x32_bf16 v[92:95], v[124:127], v[36:39], v[92:95]
    s_waitcnt lgkmcnt(0)
    ds_read_b64_tr_b16 v[112:113], v19 offset:12288
    ds_read_b64_tr_b16 v[114:115], v19 offset:12800
    ds_read_b64_tr_b16 v[116:117], v19 offset:13312
    ds_read_b64_tr_b16 v[118:119], v19 offset:13824
    ds_read_b64_tr_b16 v[120:121], v19 offset:14336
    ds_read_b64_tr_b16 v[122:123], v19 offset:14848
    ds_read_b64_tr_b16 v[124:125], v19 offset:15360
    ds_read_b64_tr_b16 v[126:127], v19 offset:15872
    v_mfma_f32_16x16x32_bf16 v[80:83], v[96:99], v[40:43], v[80:83]
    v_mfma_f32_16x16x32_bf16 v[84:87], v[100:103], v[40:43], v[84:87]
    v_mfma_f32_16x16x32_bf16 v[88:91], v[104:107], v[40:43], v[88:91]
    v_mfma_f32_16x16x32_bf16 v[92:95], v[108:111], v[40:43], v[92:95]
    s_waitcnt lgkmcnt(0)
    ds_read_b64_tr_b16 v[96:97], v19 offset:16384
    ds_read_b64_tr_b16 v[98:99], v19 offset:16896
    ds_read_b64_tr_b16 v[100:101], v19 offset:17408
    ds_read_b64_tr_b16 v[102:103], v19 offset:17920
    ds_read_b64_tr_b16 v[104:105], v19 offset:18432
    ds_read_b64_tr_b16 v[106:107], v19 offset:18944
    ds_read_b64_tr_b16 v[108:109], v19 offset:19456
    ds_read_b64_tr_b16 v[110:111], v19 offset:19968
    v_mfma_f32_16x16x32_bf16 v[80:83], v[112:115], v[44:47], v[80:83]
    v_mfma_f32_16x16x32_bf16 v[84:87], v[116:119], v[44:47], v[84:87]
    v_mfma_f32_16x16x32_bf16 v[88:91], v[120:123], v[44:47], v[88:91]
    v_mfma_f32_16x16x32_bf16 v[92:95], v[124:127], v[44:47], v[92:95]
    s_waitcnt lgkmcnt(0)
    v_mfma_f32_16x16x32_bf16 v[80:83], v[96:99], v[48:51], v[80:83]
    v_mfma_f32_16x16x32_bf16 v[84:87], v[100:103], v[48:51], v[84:87]
    v_mfma_f32_16x16x32_bf16 v[88:91], v[104:107], v[48:51], v[88:91]
    v_mfma_f32_16x16x32_bf16 v[92:95], v[108:111], v[48:51], v[92:95]
    s_nop 5
    v_mov_b32_dpp v80, v84 quad_perm:[0,1,2,3] row_mask:0xf bank_mask:0x2
    v_mov_b32_dpp v81, v85 quad_perm:[0,1,2,3] row_mask:0xf bank_mask:0x2
    v_mov_b32_dpp v82, v86 quad_perm:[0,1,2,3] row_mask:0xf bank_mask:0x2
    v_mov_b32_dpp v83, v87 quad_perm:[0,1,2,3] row_mask:0xf bank_mask:0x2
    v_mov_b32_dpp v80, v88 quad_perm:[0,1,2,3] row_mask:0xf bank_mask:0x4
    v_mov_b32_dpp v81, v89 quad_perm:[0,1,2,3] row_mask:0xf bank_mask:0x4
    v_mov_b32_dpp v82, v90 quad_perm:[0,1,2,3] row_mask:0xf bank_mask:0x4
    v_mov_b32_dpp v83, v91 quad_perm:[0,1,2,3] row_mask:0xf bank_mask:0x4
    v_mov_b32_dpp v80, v92 quad_perm:[0,1,2,3] row_mask:0xf bank_mask:0x8
    v_mov_b32_dpp v81, v93 quad_perm:[0,1,2,3] row_mask:0xf bank_mask:0x8
    v_mov_b32_dpp v82, v94 quad_perm:[0,1,2,3] row_mask:0xf bank_mask:0x8
    v_mov_b32_dpp v83, v95 quad_perm:[0,1,2,3] row_mask:0xf bank_mask:0x8
    v_add_f32_dpp v80, v80, v80 row_ror:4 row_mask:0xf bank_mask:0xf
    v_add_f32_dpp v81, v81, v81 row_ror:4 row_mask:0xf bank_mask:0xf
    v_add_f32_dpp v82, v82, v82 row_ror:4 row_mask:0xf bank_mask:0xf
    v_add_f32_dpp v83, v83, v83 row_ror:4 row_mask:0xf bank_mask:0xf
    v_add_f32_dpp v80, v80, v80 row_ror:8 row_mask:0xf bank_mask:0xf
    v_add_f32_dpp v81, v81, v81 row_ror:8 row_mask:0xf bank_mask:0xf
    v_add_f32_dpp v82, v82, v82 row_ror:8 row_mask:0xf bank_mask:0xf
    v_add_f32_dpp v83, v83, v83 row_ror:8 row_mask:0xf bank_mask:0xf
    s_cmp_lg_u32 s50, 0
    s_cbranch_scc1 L_p1rest
    v_permlane32_swap_b32 v80, v84
    v_permlane32_swap_b32 v81, v85
    v_permlane32_swap_b32 v82, v86
    v_permlane32_swap_b32 v83, v87
    v_fma_f32 v80, v24, v84, v80
    v_fma_f32 v81, v25, v85, v81
    v_fma_f32 v82, v26, v86, v82
    v_fma_f32 v83, v27, v87, v83
    v_add_f32 v80, v80, v24
    v_add_f32 v81, v81, v25
    v_add_f32 v82, v82, v26
    v_add_f32 v83, v83, v27
    s_lshl_b32 s34, s51, 2
    v_lshl_add_u32 v19, v12, 4, s34
    v_lshl_add_u32 v19, v14, 3, v19
    s_mov_b32 s58, 0x000f000f
    s_mov_b32 s59, 0
    s_branch L_p1store
L_p1rest:
    s_add_u32 s34, s51, 40960
    v_mul_u32_u24 v19, 5120, v12
    v_lshl_add_u32 v19, v14, 3, v19
    v_add_u32 v19, s34, v19
    s_mov_b32 s58, 0x000f000f
    s_mov_b32 s59, 0x000f000f
L_p1store:
    v_cvt_pk_bf16_f32 v20, v80, v81
    v_cvt_pk_bf16_f32 v21, v82, v83
    v_min_u32 v20, -2, v20
    v_min_u32 v21, -2, v21
    v_and_b32 v22, 15, v0
    v_lshlrev_b32 v22, 2, v22
    s_mov_b32 s35, 0
L_poll6:
    global_load_dword v23, v22, s[30:31] sc1
    s_add_u32 s35, s35, 1
    s_waitcnt vmcnt(0)
    v_cmp_ne_u32 vcc, 1, v23
    s_cbranch_vccz L_done7
    s_sleep 1
    s_cmp_lt_u32 s35, 60000
    s_cbranch_scc1 L_poll6
L_done7:
    s_mov_b64 exec, s[58:59]
    buffer_store_dwordx2 v[20:21], v19, s[44:47], 0 offen sc1
    s_mov_b64 exec, -1
    s_branch L_p2
L_clear:
    s_sub_u32 s34, s60, 6
    s_lshl_b32 s34, s34, 3
    s_add_u32 s34, s34, s61
    s_sub_u32 s55, s34, 8
    s_mul_i32 s34, s55, 12288
    v_lshl_add_u32 v19, v0, 4, s34
    v_mov_b32 v20, -1
    v_mov_b32 v21, -1
    v_mov_b32 v22, -1
    v_mov_b32 v23, -1
    s_mov_b32 s34, 0
    buffer_store_dwordx4 v[20:23], v19, s[44:47], s34 offen sc1
    s_mov_b32 s34, 1024
    buffer_store_dwordx4 v[20:23], v19, s[44:47], s34 offen sc1
    s_mov_b32 s34, 2048
    buffer_store_dwordx4 v[20:23], v19, s[44:47], s34 offen sc1
    s_mov_b32 s34, 3072
    buffer_store_dwordx4 v[20:23], v19, s[44:47], s34 offen sc1
    s_mov_b32 s34, 4096
    buffer_store_dwordx4 v[20:23], v19, s[44:47], s34 offen sc1
    s_mov_b32 s34, 5120
    buffer_store_dwordx4 v[20:23], v19, s[44:47], s34 offen sc1
    s_mov_b32 s34, 6144
    buffer_store_dwordx4 v[20:23], v19, s[44:47], s34 offen sc1
    s_mov_b32 s34, 7168
    buffer_store_dwordx4 v[20:23], v19, s[44:47], s34 offen sc1
    s_mov_b32 s34, 8192
    buffer_store_dwordx4 v[20:23], v19, s[44:47], s34 offen sc1
    s_mov_b32 s34, 9216
    buffer_store_dwordx4 v[20:23], v19, s[44:47], s34 offen sc1
    s_mov_b32 s34, 10240
    buffer_store_dwordx4 v[20:23], v19, s[44:47], s34 offen sc1
    s_mov_b32 s34, 11264
    buffer_store_dwordx4 v[20:23], v19, s[44:47], s34 offen sc1
    s_lshl_b32 s34, s55, 2
    v_mov_b32 v24, s34
    v_mov_b32 v25, 1
    s_waitcnt vmcnt(0)
    s_mov_b64 exec, 1
    global_store_dword v24, v25, s[30:31] sc1
    s_mov_b64 exec, -1
    s_getpc_b64 s[56:57]
L_pc8:
    s_sub_u32 s56, s56, L_pc8-adaLN_cond__sliding_block_cached__dense_activation_gelu__decode_kernel
    s_subb_u32 s57, s57, 0
    s_and_b32 s34, s61, 15
    s_lshl_b32 s34, s34, 10
    v_lshl_add_u32 v19, v0, 4, s34
    v_min_u32 v19, L_codeend-adaLN_cond__sliding_block_cached__dense_activation_gelu__decode_kernel-16, v19
    global_load_dwordx4 v[76:79], v19, s[56:57]
    s_mov_b32 s36, s10
    s_and_b32 s37, s11, 0xffff
    s_mov_b32 s38, 5242880
    s_mov_b32 s39, 0x20000
    s_mov_b32 m0, 20480
    s_mov_b32 s34, 0
L_dma9:
    buffer_load_dwordx4 v16, s[36:39], s34 offen nt lds
    s_add_u32 m0, m0, 1024
    s_add_u32 s34, s34, 262144
    s_cmp_lt_u32 s34, 5242880
    s_cbranch_scc1 L_dma9
    v_and_b32 v22, 15, v0
    v_lshlrev_b32 v22, 2, v22
    s_mov_b32 s35, 0
L_poll10:
    global_load_dword v23, v22, s[30:31] sc1
    s_add_u32 s35, s35, 1
    s_waitcnt vmcnt(0)
    v_cmp_ne_u32 vcc, 1, v23
    s_cbranch_vccz L_done11
    s_sleep 1
    s_cmp_lt_u32 s35, 60000
    s_cbranch_scc1 L_poll10
L_done11:
L_p2:
    v_lshlrev_b32 v19, 8, v13
    v_lshl_add_u32 v19, v14, 6, v19
    v_lshl_add_u32 v19, v12, 4, v19
    s_mov_b32 s35, 0
L_poll12:
    buffer_load_dwordx4 v[32:35], v19, s[44:47], 0 offen offset:0 sc1
    buffer_load_dwordx4 v[36:39], v19, s[44:47], 0 offen offset:1024 sc1
    buffer_load_dwordx4 v[40:43], v19, s[44:47], 0 offen offset:2048 sc1
    buffer_load_dwordx4 v[44:47], v19, s[44:47], 0 offen offset:3072 sc1
    buffer_load_dwordx4 v[48:51], v19, s[44:47], s48 offen offset:0 sc1
    s_add_u32 s35, s35, 1
    s_waitcnt vmcnt(0)
    v_max3_u32 v20, v32, v33, v34
    v_max3_u32 v20, v20, v35, v36
    v_max3_u32 v20, v20, v37, v38
    v_max3_u32 v20, v20, v39, v40
    v_max3_u32 v20, v20, v41, v42
    v_max3_u32 v20, v20, v43, v44
    v_max3_u32 v20, v20, v45, v46
    v_max3_u32 v20, v20, v47, v48
    v_max3_u32 v20, v20, v49, v50
    v_max_u32 v20, v20, v51
    v_cmp_eq_u32 vcc, -1, v20
    s_cbranch_vccz L_done13
    s_sleep 1
    s_cmp_lt_u32 s35, 60000
    s_cbranch_scc1 L_poll12
L_done13:
    v_add_u32 v19, 20480, v15
    ds_read_b64_tr_b16 v[96:97], v19 offset:0
    ds_read_b64_tr_b16 v[98:99], v19 offset:512
    ds_read_b64_tr_b16 v[100:101], v19 offset:1024
    ds_read_b64_tr_b16 v[102:103], v19 offset:1536
    ds_read_b64_tr_b16 v[104:105], v19 offset:2048
    ds_read_b64_tr_b16 v[106:107], v19 offset:2560
    ds_read_b64_tr_b16 v[108:109], v19 offset:3072
    ds_read_b64_tr_b16 v[110:111], v19 offset:3584
    s_waitcnt lgkmcnt(0)
    ds_read_b64_tr_b16 v[112:113], v19 offset:4096
    ds_read_b64_tr_b16 v[114:115], v19 offset:4608
    ds_read_b64_tr_b16 v[116:117], v19 offset:5120
    ds_read_b64_tr_b16 v[118:119], v19 offset:5632
    ds_read_b64_tr_b16 v[120:121], v19 offset:6144
    ds_read_b64_tr_b16 v[122:123], v19 offset:6656
    ds_read_b64_tr_b16 v[124:125], v19 offset:7168
    ds_read_b64_tr_b16 v[126:127], v19 offset:7680
    v_mfma_f32_16x16x32_bf16 v[80:83], v[96:99], v[32:35], 0
    v_mfma_f32_16x16x32_bf16 v[84:87], v[100:103], v[32:35], 0
    v_mfma_f32_16x16x32_bf16 v[88:91], v[104:107], v[32:35], 0
    v_mfma_f32_16x16x32_bf16 v[92:95], v[108:111], v[32:35], 0
    s_waitcnt lgkmcnt(0)
    ds_read_b64_tr_b16 v[96:97], v19 offset:8192
    ds_read_b64_tr_b16 v[98:99], v19 offset:8704
    ds_read_b64_tr_b16 v[100:101], v19 offset:9216
    ds_read_b64_tr_b16 v[102:103], v19 offset:9728
    ds_read_b64_tr_b16 v[104:105], v19 offset:10240
    ds_read_b64_tr_b16 v[106:107], v19 offset:10752
    ds_read_b64_tr_b16 v[108:109], v19 offset:11264
    ds_read_b64_tr_b16 v[110:111], v19 offset:11776
    v_mfma_f32_16x16x32_bf16 v[80:83], v[112:115], v[36:39], v[80:83]
    v_mfma_f32_16x16x32_bf16 v[84:87], v[116:119], v[36:39], v[84:87]
    v_mfma_f32_16x16x32_bf16 v[88:91], v[120:123], v[36:39], v[88:91]
    v_mfma_f32_16x16x32_bf16 v[92:95], v[124:127], v[36:39], v[92:95]
    s_waitcnt lgkmcnt(0)
    ds_read_b64_tr_b16 v[112:113], v19 offset:12288
    ds_read_b64_tr_b16 v[114:115], v19 offset:12800
    ds_read_b64_tr_b16 v[116:117], v19 offset:13312
    ds_read_b64_tr_b16 v[118:119], v19 offset:13824
    ds_read_b64_tr_b16 v[120:121], v19 offset:14336
    ds_read_b64_tr_b16 v[122:123], v19 offset:14848
    ds_read_b64_tr_b16 v[124:125], v19 offset:15360
    ds_read_b64_tr_b16 v[126:127], v19 offset:15872
    v_mfma_f32_16x16x32_bf16 v[80:83], v[96:99], v[40:43], v[80:83]
    v_mfma_f32_16x16x32_bf16 v[84:87], v[100:103], v[40:43], v[84:87]
    v_mfma_f32_16x16x32_bf16 v[88:91], v[104:107], v[40:43], v[88:91]
    v_mfma_f32_16x16x32_bf16 v[92:95], v[108:111], v[40:43], v[92:95]
    s_waitcnt lgkmcnt(0)
    ds_read_b64_tr_b16 v[96:97], v19 offset:16384
    ds_read_b64_tr_b16 v[98:99], v19 offset:16896
    ds_read_b64_tr_b16 v[100:101], v19 offset:17408
    ds_read_b64_tr_b16 v[102:103], v19 offset:17920
    ds_read_b64_tr_b16 v[104:105], v19 offset:18432
    ds_read_b64_tr_b16 v[106:107], v19 offset:18944
    ds_read_b64_tr_b16 v[108:109], v19 offset:19456
    ds_read_b64_tr_b16 v[110:111], v19 offset:19968
    v_mfma_f32_16x16x32_bf16 v[80:83], v[112:115], v[44:47], v[80:83]
    v_mfma_f32_16x16x32_bf16 v[84:87], v[116:119], v[44:47], v[84:87]
    v_mfma_f32_16x16x32_bf16 v[88:91], v[120:123], v[44:47], v[88:91]
    v_mfma_f32_16x16x32_bf16 v[92:95], v[124:127], v[44:47], v[92:95]
    s_waitcnt lgkmcnt(0)
    v_mfma_f32_16x16x32_bf16 v[80:83], v[96:99], v[48:51], v[80:83]
    v_mfma_f32_16x16x32_bf16 v[84:87], v[100:103], v[48:51], v[84:87]
    v_mfma_f32_16x16x32_bf16 v[88:91], v[104:107], v[48:51], v[88:91]
    v_mfma_f32_16x16x32_bf16 v[92:95], v[108:111], v[48:51], v[92:95]
    s_nop 5
    v_mov_b32_dpp v80, v84 quad_perm:[0,1,2,3] row_mask:0xf bank_mask:0x2
    v_mov_b32_dpp v81, v85 quad_perm:[0,1,2,3] row_mask:0xf bank_mask:0x2
    v_mov_b32_dpp v82, v86 quad_perm:[0,1,2,3] row_mask:0xf bank_mask:0x2
    v_mov_b32_dpp v83, v87 quad_perm:[0,1,2,3] row_mask:0xf bank_mask:0x2
    v_mov_b32_dpp v80, v88 quad_perm:[0,1,2,3] row_mask:0xf bank_mask:0x4
    v_mov_b32_dpp v81, v89 quad_perm:[0,1,2,3] row_mask:0xf bank_mask:0x4
    v_mov_b32_dpp v82, v90 quad_perm:[0,1,2,3] row_mask:0xf bank_mask:0x4
    v_mov_b32_dpp v83, v91 quad_perm:[0,1,2,3] row_mask:0xf bank_mask:0x4
    v_mov_b32_dpp v80, v92 quad_perm:[0,1,2,3] row_mask:0xf bank_mask:0x8
    v_mov_b32_dpp v81, v93 quad_perm:[0,1,2,3] row_mask:0xf bank_mask:0x8
    v_mov_b32_dpp v82, v94 quad_perm:[0,1,2,3] row_mask:0xf bank_mask:0x8
    v_mov_b32_dpp v83, v95 quad_perm:[0,1,2,3] row_mask:0xf bank_mask:0x8
    v_add_f32_dpp v80, v80, v80 row_ror:4 row_mask:0xf bank_mask:0xf
    v_add_f32_dpp v81, v81, v81 row_ror:4 row_mask:0xf bank_mask:0xf
    v_add_f32_dpp v82, v82, v82 row_ror:4 row_mask:0xf bank_mask:0xf
    v_add_f32_dpp v83, v83, v83 row_ror:4 row_mask:0xf bank_mask:0xf
    v_add_f32_dpp v80, v80, v80 row_ror:8 row_mask:0xf bank_mask:0xf
    v_add_f32_dpp v81, v81, v81 row_ror:8 row_mask:0xf bank_mask:0xf
    v_add_f32_dpp v82, v82, v82 row_ror:8 row_mask:0xf bank_mask:0xf
    v_add_f32_dpp v83, v83, v83 row_ror:8 row_mask:0xf bank_mask:0xf
    v_cvt_pk_bf16_f32 v20, v80, v81
    v_cvt_pk_bf16_f32 v21, v82, v83
    v_min_u32 v20, -2, v20
    v_min_u32 v21, -2, v21
    s_add_u32 s34, s49, 8192
    v_lshlrev_b32 v19, 13, v12
    v_lshl_add_u32 v19, v14, 3, v19
    v_add_u32 v19, s34, v19
    s_mov_b32 exec_lo, 0x000f000f
    s_mov_b32 exec_hi, 0x000f000f
    buffer_store_dwordx2 v[20:21], v19, s[44:47], 0 offen sc1
    s_mov_b64 exec, 0xffff
    s_and_b32 s34, s2, 127
    s_lshl_b32 s34, s34, 8
    s_add_u32 s34, s34, 8192
    v_lshl_add_u32 v19, v0, 4, s34
    s_mov_b32 s35, 0
L_poll14:
    buffer_load_dwordx4 v[24:27], v19, s[44:47], 0 offen sc1
    s_add_u32 s35, s35, 1
    s_waitcnt vmcnt(0)
    v_max3_u32 v22, v24, v25, v26
    v_max_u32 v22, v22, v27
    v_cmp_eq_u32 vcc, -1, v22
    s_cbranch_vccz L_done15
    s_sleep 1
    s_cmp_lt_u32 s35, 60000
    s_cbranch_scc1 L_poll14
L_done15:
    v_lshlrev_b32 v19, 4, v0
    v_add_u32 v19, 98304, v19
    ds_write_b128 v19, v[24:27]
    s_mov_b64 exec, -1
    s_mov_b32 s62, s61
    s_cmp_lt_u32 s61, 20
    s_cbranch_scc1 L_d_wo
    s_lshl_b32 s62, s60, 2
    s_and_b32 s34, s61, 3
    s_add_u32 s62, s62, s34
    s_cmp_lt_u32 s61, 24
    s_cbranch_scc1 L_d_w2
    s_cmp_ge_u32 s60, 2
    s_cbranch_scc1 L_d_w1b
    s_cmp_ge_u32 s61, 28
    s_cbranch_scc1 L_d_w1
    s_add_u32 s62, s62, 32
    s_branch L_d_w2
L_d_w1b:
    s_lshl_b32 s62, s60, 3
    s_add_u32 s62, s62, s61
    s_sub_u32 s62, s62, 32
    s_cmp_ge_u32 s62, 54
    s_cbranch_scc1 L_d_none
L_d_w1:
    s_mov_b32 s36, s16
    s_and_b32 s37, s17, 0xffff
    s_mov_b32 s38, 2211840
    s_mov_b32 s39, 0x20000
    v_lshl_add_u32 v17, v13, 3, v14
    v_mul_u32_u24 v17, 3456, v17
    v_lshl_add_u32 v17, v12, 4, v17
    s_lshl_b32 s34, s62, 6
    v_add_u32 v17, s34, v17
    s_mov_b32 m0, 40960
    s_mov_b32 s34, 0
    buffer_load_dwordx4 v17, s[36:39], s34 offen nt lds
    s_mov_b32 m0, 41984
    s_mov_b32 s34, 884736
    buffer_load_dwordx4 v17, s[36:39], s34 offen nt lds
    s_mov_b32 m0, 43008
    s_mov_b32 s34, 13824
    buffer_load_dwordx4 v17, s[36:39], s34 offen nt lds
    s_mov_b32 m0, 44032
    s_mov_b32 s34, 898560
    buffer_load_dwordx4 v17, s[36:39], s34 offen nt lds
    s_mov_b32 m0, 45056
    s_mov_b32 s34, 442368
    buffer_load_dwordx4 v17, s[36:39], s34 offen nt lds
    s_mov_b32 m0, 46080
    s_mov_b32 s34, 1327104
    buffer_load_dwordx4 v17, s[36:39], s34 offen nt lds
    s_mov_b32 m0, 47104
    s_mov_b32 s34, 456192
    buffer_load_dwordx4 v17, s[36:39], s34 offen nt lds
    s_mov_b32 m0, 48128
    s_mov_b32 s34, 1340928
    buffer_load_dwordx4 v17, s[36:39], s34 offen nt lds
    s_mov_b32 m0, 49152
    s_mov_b32 s34, 110592
    buffer_load_dwordx4 v17, s[36:39], s34 offen nt lds
    s_mov_b32 m0, 50176
    s_mov_b32 s34, 995328
    buffer_load_dwordx4 v17, s[36:39], s34 offen nt lds
    s_mov_b32 m0, 51200
    s_mov_b32 s34, 124416
    buffer_load_dwordx4 v17, s[36:39], s34 offen nt lds
    s_mov_b32 m0, 52224
    s_mov_b32 s34, 1009152
    buffer_load_dwordx4 v17, s[36:39], s34 offen nt lds
    s_mov_b32 m0, 53248
    s_mov_b32 s34, 552960
    buffer_load_dwordx4 v17, s[36:39], s34 offen nt lds
    s_mov_b32 m0, 54272
    s_mov_b32 s34, 1437696
    buffer_load_dwordx4 v17, s[36:39], s34 offen nt lds
    s_mov_b32 m0, 55296
    s_mov_b32 s34, 566784
    buffer_load_dwordx4 v17, s[36:39], s34 offen nt lds
    s_mov_b32 m0, 56320
    s_mov_b32 s34, 1451520
    buffer_load_dwordx4 v17, s[36:39], s34 offen nt lds
    s_mov_b32 m0, 57344
    s_mov_b32 s34, 221184
    buffer_load_dwordx4 v17, s[36:39], s34 offen nt lds
    s_mov_b32 m0, 58368
    s_mov_b32 s34, 1105920
    buffer_load_dwordx4 v17, s[36:39], s34 offen nt lds
    s_mov_b32 m0, 59392
    s_mov_b32 s34, 235008
    buffer_load_dwordx4 v17, s[36:39], s34 offen nt lds
    s_mov_b32 m0, 60416
    s_mov_b32 s34, 1119744
    buffer_load_dwordx4 v17, s[36:39], s34 offen nt lds
    s_mov_b32 m0, 61440
    s_mov_b32 s34, 663552
    buffer_load_dwordx4 v17, s[36:39], s34 offen nt lds
    s_mov_b32 m0, 62464
    s_mov_b32 s34, 1548288
    buffer_load_dwordx4 v17, s[36:39], s34 offen nt lds
    s_mov_b32 m0, 63488
    s_mov_b32 s34, 677376
    buffer_load_dwordx4 v17, s[36:39], s34 offen nt lds
    s_mov_b32 m0, 64512
    s_mov_b32 s34, 1562112
    buffer_load_dwordx4 v17, s[36:39], s34 offen nt lds
    s_mov_b32 m0, 65536
    s_mov_b32 s34, 331776
    buffer_load_dwordx4 v17, s[36:39], s34 offen nt lds
    s_mov_b32 m0, 66560
    s_mov_b32 s34, 1216512
    buffer_load_dwordx4 v17, s[36:39], s34 offen nt lds
    s_mov_b32 m0, 67584
    s_mov_b32 s34, 345600
    buffer_load_dwordx4 v17, s[36:39], s34 offen nt lds
    s_mov_b32 m0, 68608
    s_mov_b32 s34, 1230336
    buffer_load_dwordx4 v17, s[36:39], s34 offen nt lds
    s_mov_b32 m0, 69632
    s_mov_b32 s34, 774144
    buffer_load_dwordx4 v17, s[36:39], s34 offen nt lds
    s_mov_b32 m0, 70656
    s_mov_b32 s34, 1658880
    buffer_load_dwordx4 v17, s[36:39], s34 offen nt lds
    s_mov_b32 m0, 71680
    s_mov_b32 s34, 787968
    buffer_load_dwordx4 v17, s[36:39], s34 offen nt lds
    s_mov_b32 m0, 72704
    s_mov_b32 s34, 1672704
    buffer_load_dwordx4 v17, s[36:39], s34 offen nt lds
    s_mov_b32 m0, 73728
    s_mov_b32 s34, 1769472
    buffer_load_dwordx4 v17, s[36:39], s34 offen nt lds
    s_mov_b32 m0, 74752
    s_mov_b32 s34, 1783296
    buffer_load_dwordx4 v17, s[36:39], s34 offen nt lds
    s_mov_b32 m0, 75776
    s_mov_b32 s34, 1880064
    buffer_load_dwordx4 v17, s[36:39], s34 offen nt lds
    s_mov_b32 m0, 76800
    s_mov_b32 s34, 1893888
    buffer_load_dwordx4 v17, s[36:39], s34 offen nt lds
    s_mov_b32 m0, 77824
    s_mov_b32 s34, 1990656
    buffer_load_dwordx4 v17, s[36:39], s34 offen nt lds
    s_mov_b32 m0, 78848
    s_mov_b32 s34, 2004480
    buffer_load_dwordx4 v17, s[36:39], s34 offen nt lds
    s_mov_b32 m0, 79872
    s_mov_b32 s34, 2101248
    buffer_load_dwordx4 v17, s[36:39], s34 offen nt lds
    s_mov_b32 m0, 80896
    s_mov_b32 s34, 2115072
    buffer_load_dwordx4 v17, s[36:39], s34 offen nt lds
    s_branch L_d_none
L_d_w2:
    s_mov_b32 s36, s20
    s_and_b32 s37, s21, 0xffff
    s_mov_b32 s38, 2211840
    s_mov_b32 s39, 0x20000
    v_mul_u32_u24 v17, 1280, v10
    v_lshl_add_u32 v17, v11, 4, v17
    s_lshl_b32 s34, s62, 5
    v_add_u32 v17, s34, v17
    s_mov_b32 m0, 40960
    s_mov_b32 s34, 0
L_dma16:
    buffer_load_dwordx4 v17, s[36:39], s34 offen nt lds
    s_add_u32 m0, m0, 1024
    s_add_u32 s34, s34, 40960
    s_cmp_lt_u32 s34, 2293760
    s_cbranch_scc1 L_dma16
    s_branch L_d_none
L_d_wo:
    s_mov_b32 s36, s12
    s_and_b32 s37, s13, 0xffff
    s_mov_b32 s38, 5242880
    s_mov_b32 s39, 0x20000
    v_lshlrev_b32 v17, 2, v13
    v_add_u32 v17, v17, v14
    v_mul_u32_u24 v17, 2560, v17
    v_lshl_add_u32 v17, v12, 4, v17
    s_mul_i32 s34, s60, 163840
    s_lshl_b32 s35, s62, 6
    s_add_u32 s34, s34, s35
    v_add_u32 v17, s34, v17
    v_add_u32 v18, 256, v17
    s_mov_b32 m0, 40960
    s_mov_b32 s34, 0
    buffer_load_dwordx4 v17, s[36:39], s34 offen nt lds
    buffer_load_dwordx4 v18, s[36:39], s34 offen offset:1024 nt lds
    s_mov_b32 m0, 43008
    s_mov_b32 s34, 40960
    buffer_load_dwordx4 v17, s[36:39], s34 offen nt lds
    buffer_load_dwordx4 v18, s[36:39], s34 offen offset:1024 nt lds
    s_mov_b32 m0, 45056
    s_mov_b32 s34, 81920
    buffer_load_dwordx4 v17, s[36:39], s34 offen nt lds
    buffer_load_dwordx4 v18, s[36:39], s34 offen offset:1024 nt lds
    s_mov_b32 m0, 47104
    s_mov_b32 s34, 122880
    buffer_load_dwordx4 v17, s[36:39], s34 offen nt lds
    buffer_load_dwordx4 v18, s[36:39], s34 offen offset:1024 nt lds
    s_mov_b32 m0, 49152
    s_mov_b32 s34, 1310720
    buffer_load_dwordx4 v17, s[36:39], s34 offen nt lds
    buffer_load_dwordx4 v18, s[36:39], s34 offen offset:1024 nt lds
    s_mov_b32 m0, 51200
    s_mov_b32 s34, 1351680
    buffer_load_dwordx4 v17, s[36:39], s34 offen nt lds
    buffer_load_dwordx4 v18, s[36:39], s34 offen offset:1024 nt lds
    s_mov_b32 m0, 53248
    s_mov_b32 s34, 1392640
    buffer_load_dwordx4 v17, s[36:39], s34 offen nt lds
    buffer_load_dwordx4 v18, s[36:39], s34 offen offset:1024 nt lds
    s_mov_b32 m0, 55296
    s_mov_b32 s34, 1433600
    buffer_load_dwordx4 v17, s[36:39], s34 offen nt lds
    buffer_load_dwordx4 v18, s[36:39], s34 offen offset:1024 nt lds
    s_mov_b32 m0, 57344
    s_mov_b32 s34, 2621440
    buffer_load_dwordx4 v17, s[36:39], s34 offen nt lds
    buffer_load_dwordx4 v18, s[36:39], s34 offen offset:1024 nt lds
    s_mov_b32 m0, 59392
    s_mov_b32 s34, 2662400
    buffer_load_dwordx4 v17, s[36:39], s34 offen nt lds
    buffer_load_dwordx4 v18, s[36:39], s34 offen offset:1024 nt lds
    s_mov_b32 m0, 61440
    s_mov_b32 s34, 2703360
    buffer_load_dwordx4 v17, s[36:39], s34 offen nt lds
    buffer_load_dwordx4 v18, s[36:39], s34 offen offset:1024 nt lds
    s_mov_b32 m0, 63488
    s_mov_b32 s34, 2744320
    buffer_load_dwordx4 v17, s[36:39], s34 offen nt lds
    buffer_load_dwordx4 v18, s[36:39], s34 offen offset:1024 nt lds
    s_mov_b32 m0, 65536
    s_mov_b32 s34, 3932160
    buffer_load_dwordx4 v17, s[36:39], s34 offen nt lds
    buffer_load_dwordx4 v18, s[36:39], s34 offen offset:1024 nt lds
    s_mov_b32 m0, 67584
    s_mov_b32 s34, 3973120
    buffer_load_dwordx4 v17, s[36:39], s34 offen nt lds
    buffer_load_dwordx4 v18, s[36:39], s34 offen offset:1024 nt lds
    s_mov_b32 m0, 69632
    s_mov_b32 s34, 4014080
    buffer_load_dwordx4 v17, s[36:39], s34 offen nt lds
    buffer_load_dwordx4 v18, s[36:39], s34 offen offset:1024 nt lds
    s_mov_b32 m0, 71680
    s_mov_b32 s34, 4055040
    buffer_load_dwordx4 v17, s[36:39], s34 offen nt lds
    buffer_load_dwordx4 v18, s[36:39], s34 offen offset:1024 nt lds
L_d_none:
    v_and_b32 v19, 7, v0
    v_lshlrev_b32 v19, 3, v19
    v_add_u32 v19, 98560, v19
    s_mov_b32 s35, 0
L_poll17:
    ds_read_b64 v[20:21], v19
    s_add_u32 s35, s35, 1
    s_waitcnt lgkmcnt(0)
    v_max_u32 v22, v20, v21
    v_cmp_eq_u32 vcc, -1, v22
    s_cbranch_vccz L_done18
    s_sleep 4
    s_cmp_lt_u32 s35, 60000
    s_cbranch_scc1 L_poll17
L_done18:
    v_max_f32_dpp v22, v20, v20 row_half_mirror row_mask:0xf bank_mask:0xf
    s_nop 1
    v_max_f32_dpp v22, v22, v22 quad_perm:[1,0,3,2] row_mask:0xf bank_mask:0xf
    s_nop 1
    v_max_f32_dpp v22, v22, v22 quad_perm:[2,3,0,1] row_mask:0xf bank_mask:0xf
    v_sub_f32 v20, v20, v22
    v_exp_f32 v20, v20
    s_nop 0
    v_mul_f32 v21, v21, v20
    s_nop 1
    v_add_f32_dpp v21, v21, v21 row_half_mirror row_mask:0xf bank_mask:0xf
    s_nop 1
    v_add_f32_dpp v21, v21, v21 quad_perm:[1,0,3,2] row_mask:0xf bank_mask:0xf
    s_nop 1
    v_add_f32_dpp v21, v21, v21 quad_perm:[2,3,0,1] row_mask:0xf bank_mask:0xf
    v_rcp_f32 v23, v21
    v_log_f32 v21, v21
    v_mul_f32 v20, v20, v23
    v_add_f32 v21, v21, v22
    v_min_u32 v21, -2, v21
    v_readlane_b32 s50, v20, 0
    v_readlane_b32 s52, v20, 1
    v_readlane_b32 s54, v20, 2
    v_readlane_b32 s56, v20, 3
    v_readlane_b32 s58, v20, 4
    v_readlane_b32 s96, v20, 5
    v_readlane_b32 s98, v20, 6
    s_and_b32 s34, s2, 31
    s_bfe_u32 s35, s2, 0x20005
    s_lshl_b32 s35, s35, 1
    s_lshr_b32 s63, s2, 7
    s_add_u32 s35, s35, s63
    s_lshl_b32 s63, s34, 7
    s_lshl_b32 s49, s35, 2
    s_add_u32 s63, s63, s49
    s_add_u32 s63, s63, 131072
    v_mov_b32 v19, s63
    s_mov_b64 exec, 1
    buffer_store_dword v21, v19, s[44:47], 0 offen sc1
    s_mov_b64 exec, -1
    s_lshl_b32 s34, s34, 11
    s_lshl_b32 s35, s35, 8
    s_add_u32 s34, s34, s35
    s_add_u32 s34, s34, 65536
    v_and_b32 v18, 7, v0
    v_lshl_add_u32 v18, v14, 3, v18
    v_lshl_add_u32 v18, v18, 3, s34
    v_lshlrev_b32 v19, 4, v0
    v_add_u32 v19, 99328, v19
    s_waitcnt vmcnt(0)
    s_barrier
    ds_read_b128 v[32:35], v19 offset:0
    ds_read_b128 v[36:39], v19 offset:1024
    ds_read_b128 v[40:43], v19 offset:2048
    ds_read_b128 v[44:47], v19 offset:3072
    ds_read_b128 v[48:51], v19 offset:4096
    ds_read_b128 v[52:55], v19 offset:5120
    ds_read_b128 v[56:59], v19 offset:6144
    s_waitcnt lgkmcnt(6)
    v_pk_mul_f32 v[20:21], v[32:33], s[50:51] op_sel_hi:[1,0]
    v_pk_mul_f32 v[22:23], v[34:35], s[50:51] op_sel_hi:[1,0]
    s_waitcnt lgkmcnt(5)
    v_pk_fma_f32 v[20:21], v[36:37], s[52:53], v[20:21] op_sel_hi:[1,0,1]
    v_pk_fma_f32 v[22:23], v[38:39], s[52:53], v[22:23] op_sel_hi:[1,0,1]
    s_waitcnt lgkmcnt(4)
    v_pk_fma_f32 v[20:21], v[40:41], s[54:55], v[20:21] op_sel_hi:[1,0,1]
    v_pk_fma_f32 v[22:23], v[42:43], s[54:55], v[22:23] op_sel_hi:[1,0,1]
    s_waitcnt lgkmcnt(3)
    v_pk_fma_f32 v[20:21], v[44:45], s[56:57], v[20:21] op_sel_hi:[1,0,1]
    v_pk_fma_f32 v[22:23], v[46:47], s[56:57], v[22:23] op_sel_hi:[1,0,1]
    s_waitcnt lgkmcnt(2)
    v_pk_fma_f32 v[20:21], v[48:49], s[58:59], v[20:21] op_sel_hi:[1,0,1]
    v_pk_fma_f32 v[22:23], v[50:51], s[58:59], v[22:23] op_sel_hi:[1,0,1]
    s_waitcnt lgkmcnt(1)
    v_pk_fma_f32 v[20:21], v[52:53], s[96:97], v[20:21] op_sel_hi:[1,0,1]
    v_pk_fma_f32 v[22:23], v[54:55], s[96:97], v[22:23] op_sel_hi:[1,0,1]
    s_waitcnt lgkmcnt(0)
    v_pk_fma_f32 v[20:21], v[56:57], s[98:99], v[20:21] op_sel_hi:[1,0,1]
    v_pk_fma_f32 v[22:23], v[58:59], s[98:99], v[22:23] op_sel_hi:[1,0,1]
    s_nop 0
    v_add_f32_dpp v20, v20, v20 row_ror:8 row_mask:0xf bank_mask:0xf
    v_add_f32_dpp v21, v21, v21 row_ror:8 row_mask:0xf bank_mask:0xf
    v_add_f32_dpp v22, v22, v22 row_ror:8 row_mask:0xf bank_mask:0xf
    v_add_f32_dpp v23, v23, v23 row_ror:8 row_mask:0xf bank_mask:0xf
    v_cvt_pk_bf16_f32 v24, v20, v21
    v_cvt_pk_bf16_f32 v25, v22, v23
    v_min_u32 v24, -2, v24
    v_min_u32 v25, -2, v25
    s_mov_b32 exec_lo, 0x00ff00ff
    s_mov_b32 exec_hi, 0x00ff00ff
    buffer_store_dwordx2 v[24:25], v18, s[44:47], 0 offen sc1
    s_mov_b64 exec, -1
L_tail:
    s_nop 1
    v_and_b32 v12, 3, v0
    v_bfe_u32 v13, v0, 2, 2
    v_lshrrev_b32 v14, 4, v0
    s_lshl_b32 s34, s3, 10
    s_add_u32 s34, s34, 122112
    v_lshl_add_u32 v2, v0, 4, s34
    s_mov_b32 s62, s61
    s_cmp_lt_u32 s61, 20
    s_cbranch_scc1 L_t_wo
    s_lshl_b32 s62, s60, 2
    s_and_b32 s34, s61, 3
    s_add_u32 s62, s62, s34
    s_cmp_lt_u32 s61, 24
    s_cbranch_scc1 L_t_w2
    s_cmp_ge_u32 s60, 2
    s_cbranch_scc1 L_t_w1b
    s_cmp_ge_u32 s61, 28
    s_cbranch_scc1 L_t_w1
    s_add_u32 s62, s62, 32
    s_branch L_t_w2
L_t_w1b:
    s_lshl_b32 s62, s60, 3
    s_add_u32 s62, s62, s61
    s_sub_u32 s62, s62, 32
    s_cmp_ge_u32 s62, 54
    s_cbranch_scc1 L_t_none
L_t_w1:
    s_lshr_b32 s34, s3, 1
    s_mul_i32 s35, s34, 320
    s_mul_i32 s34, s34, 10240
    s_and_b32 s49, s3, 1
    s_lshl_b32 s49, s49, 5
    s_add_u32 s34, s34, s49
    s_add_u32 s34, s34, 40960
    v_lshrrev_b32 v3, 2, v0
    v_lshlrev_b32 v3, 6, v3
    v_lshl_add_u32 v3, v12, 3, v3
    v_add_u32 v3, s34, v3
    ds_read_b64_tr_b16 v[32:33], v3 offset:0
    ds_read_b64_tr_b16 v[34:35], v3 offset:1024
    ds_read_b64_tr_b16 v[36:37], v3 offset:2048
    ds_read_b64_tr_b16 v[38:39], v3 offset:3072
    ds_read_b64_tr_b16 v[40:41], v3 offset:4096
    ds_read_b64_tr_b16 v[42:43], v3 offset:5120
    ds_read_b64_tr_b16 v[44:45], v3 offset:6144
    ds_read_b64_tr_b16 v[46:47], v3 offset:7168
    ds_read_b64_tr_b16 v[48:49], v3 offset:8192
    ds_read_b64_tr_b16 v[50:51], v3 offset:9216
    s_add_u32 s35, s35, 116736
    v_mul_u32_u24 v4, 1344, v12
    v_lshl_add_u32 v4, v14, 4, v4
    v_add_u32 v4, s35, v4
    s_cmp_ge_u32 s3, 4
    s_cbranch_scc1 L_w1_mm
    s_lshl_b32 s34, s62, 6
    v_lshlrev_b32 v5, 4, v14
    v_lshl_add_u32 v5, v12, 2, v5
    v_add_u32 v5, s34, v5
    global_load_dword v6, v5, s[18:19]
    v_and_b32 v10, 1, v0
    v_lshlrev_b32 v10, 4, v10
    v_mov_b32 v11, 0xffff
    v_lshlrev_b32 v10, v10, v11
    v_bfe_u32 v11, v0, 1, 2
    v_cmp_eq_u32 vcc, 0, v11
    s_nop 1
    v_cndmask_b32 v16, 0, v10, vcc
    v_cmp_eq_u32 vcc, 1, v11
    s_nop 1
    v_cndmask_b32 v17, 0, v10, vcc
    v_cmp_eq_u32 vcc, 2, v11
    s_nop 1
    v_cndmask_b32 v18, 0, v10, vcc
    v_cmp_eq_u32 vcc, 3, v11
    s_nop 1
    v_cndmask_b32 v19, 0, v10, vcc
    v_bfe_u32 v10, v0, 3, 1
    v_cmp_eq_u32 vcc, 0, v10
    s_nop 1
    v_cndmask_b32 v20, 0, v16, vcc
    v_xor_b32 v24, v20, v16
    v_cndmask_b32 v21, 0, v17, vcc
    v_xor_b32 v25, v21, v17
    v_cndmask_b32 v22, 0, v18, vcc
    v_xor_b32 v26, v22, v18
    v_cndmask_b32 v23, 0, v19, vcc
    v_xor_b32 v27, v23, v19
    v_and_b32 v52, 0x3f803f80, v20
    v_and_b32 v60, 0x3e803e80, v20
    v_and_b32 v53, 0x3f803f80, v21
    v_and_b32 v61, 0x3e803e80, v21
    v_and_b32 v54, 0x3f803f80, v22
    v_and_b32 v62, 0x3e803e80, v22
    v_and_b32 v55, 0x3f803f80, v23
    v_and_b32 v63, 0x3e803e80, v23
    v_and_b32 v56, 0x3f803f80, v24
    v_and_b32 v64, 0x3e803e80, v24
    v_and_b32 v57, 0x3f803f80, v25
    v_and_b32 v65, 0x3e803e80, v25
    v_and_b32 v58, 0x3f803f80, v26
    v_and_b32 v66, 0x3e803e80, v26
    v_and_b32 v59, 0x3f803f80, v27
    v_and_b32 v67, 0x3e803e80, v27
    v_and_b32 v10, 15, v0
    v_lshlrev_b32 v10, 4, v10
    s_mul_i32 s34, s3, 1280
    v_add_u32 v11, s34, v10
    global_load_dwordx4 v[116:119], v11, s[4:5] offset:0
    global_load_dwordx4 v[120:123], v11, s[4:5] offset:256
    global_load_dwordx4 v[124:127], v11, s[4:5] offset:512
    global_load_dwordx4 v[128:131], v11, s[4:5] offset:768
    global_load_dwordx4 v[132:135], v11, s[4:5] offset:1024
    s_mul_i32 s34, s3, 5120
    s_add_u32 s34, s34, 42240
    v_add_u32 v15, s34, v10
    s_mov_b32 s35, 0
L_poll19:
    buffer_load_dwordx4 v[136:139], v15, s[44:47], 0 offen offset:0 sc1
    buffer_load_dwordx4 v[140:143], v15, s[44:47], 0 offen offset:256 sc1
    buffer_load_dwordx4 v[144:147], v15, s[44:47], 0 offen offset:512 sc1
    buffer_load_dwordx4 v[148:151], v15, s[44:47], 0 offen offset:768 sc1
    buffer_load_dwordx4 v[152:155], v15, s[44:47], 0 offen offset:1024 sc1
    buffer_load_dwordx4 v[156:159], v15, s[44:47], 0 offen offset:1280 sc1
    buffer_load_dwordx4 v[160:163], v15, s[44:47], 0 offen offset:1536 sc1
    buffer_load_dwordx4 v[164:167], v15, s[44:47], 0 offen offset:1792 sc1
    buffer_load_dwordx4 v[168:171], v15, s[44:47], 0 offen offset:2048 sc1
    buffer_load_dwordx4 v[172:175], v15, s[44:47], 0 offen offset:2304 sc1
    s_add_u32 s35, s35, 1
    s_waitcnt vmcnt(0)
    v_max3_u32 v28, v136, v137, v138
    v_max3_u32 v28, v28, v139, v140
    v_max3_u32 v28, v28, v141, v142
    v_max3_u32 v28, v28, v143, v144
    v_max3_u32 v28, v28, v145, v146
    v_max3_u32 v28, v28, v147, v148
    v_max3_u32 v28, v28, v149, v150
    v_max3_u32 v28, v28, v151, v152
    v_max3_u32 v28, v28, v153, v154
    v_max3_u32 v28, v28, v155, v156
    v_max3_u32 v28, v28, v157, v158
    v_max3_u32 v28, v28, v159, v160
    v_max3_u32 v28, v28, v161, v162
    v_max3_u32 v28, v28, v163, v164
    v_max3_u32 v28, v28, v165, v166
    v_max3_u32 v28, v28, v167, v168
    v_max3_u32 v28, v28, v169, v170
    v_max3_u32 v28, v28, v171, v172
    v_max3_u32 v28, v28, v173, v174
    v_max_u32 v28, v28, v175
    v_cmp_eq_u32 vcc, -1, v28
    s_cbranch_vccz L_done20
    s_sleep 1
    s_cmp_lt_u32 s35, 60000
    s_cbranch_scc1 L_poll19
L_done20:
    v_mfma_f32_16x16x32_bf16 v[68:71], v[116:119], v[60:63], 0
    v_mfma_f32_16x16x32_bf16 v[68:71], v[120:123], v[64:67], v[68:71]
    v_mfma_f32_16x16x32_bf16 v[72:75], v[124:127], v[60:63], 0
    v_mfma_f32_16x16x32_bf16 v[72:75], v[128:131], v[64:67], v[72:75]
    v_mfma_f32_16x16x32_bf16 v[76:79], v[132:135], v[60:63], 0
    v_mfma_f32_16x16x32_bf16 v[92:95], v[136:139], v[60:63], 0
    v_mfma_f32_16x16x32_bf16 v[92:95], v[140:143], v[64:67], v[92:95]
    v_mfma_f32_16x16x32_bf16 v[96:99], v[144:147], v[60:63], 0
    v_mfma_f32_16x16x32_bf16 v[96:99], v[148:151], v[64:67], v[96:99]
    v_mfma_f32_16x16x32_bf16 v[100:103], v[152:155], v[60:63], 0
    v_mfma_f32_16x16x32_bf16 v[80:83], v[156:159], v[60:63], 1.0
    v_mfma_f32_16x16x32_bf16 v[80:83], v[160:163], v[64:67], v[80:83]
    v_mfma_f32_16x16x32_bf16 v[84:87], v[164:167], v[60:63], 1.0
    v_mfma_f32_16x16x32_bf16 v[84:87], v[168:171], v[64:67], v[84:87]
    v_mfma_f32_16x16x32_bf16 v[88:91], v[172:175], v[60:63], 1.0
    v_mul_u32_u24 v15, 5120, v14
    v_add_u32 v15, v15, v11
    v_add_u32 v15, 139264, v15
    s_movk_i32 s48, 20480
    s_mul_i32 s34, s3, 1344
    s_add_u32 s34, s34, 116736
    v_lshl_add_u32 v7, v0, 4, s34
    v_lshlrev_b32 v8, 6, v14
    v_lshl_add_u32 v8, v12, 4, v8
    v_and_b32 v9, 1, v13
    v_lshl_add_u32 v8, v9, 3, v8
    v_add_u32 v8, s34, v8
    v_lshrrev_b32 v9, 5, v0
    v_lshlrev_b32 v9, 10, v9
    v_and_b32 v10, 1, v14
    v_lshl_add_u32 v9, v10, 9, v9
    v_bfe_u32 v10, v0, 1, 1
    v_lshl_add_u32 v9, v10, 8, v9
    v_lshl_add_u32 v9, v13, 4, v9
    v_and_b32 v10, 1, v0
    v_lshl_add_u32 v9, v10, 3, v9
    v_add_u32 v9, 122112, v9
    v_lshlrev_b32 v30, 16, v6
    v_and_b32 v31, 0xffff0000, v6
    s_lshl_b32 s34, s62, 8
    s_add_u32 s34, s34, 180224
    v_lshl_add_u32 v5, v0, 2, s34
    s_mov_b32 s35, 0
L_poll21:
    buffer_load_dwordx4 v[116:119], v15, s[44:47], 0 offen offset:0 sc1
    buffer_load_dwordx4 v[120:123], v15, s[44:47], s48 offen offset:0 sc1
    buffer_load_dwordx4 v[124:127], v15, s[44:47], 0 offen offset:256 sc1
    buffer_load_dwordx4 v[128:131], v15, s[44:47], s48 offen offset:256 sc1
    buffer_load_dwordx4 v[132:135], v15, s[44:47], 0 offen offset:512 sc1
    buffer_load_dwordx4 v[136:139], v15, s[44:47], s48 offen offset:512 sc1
    buffer_load_dwordx4 v[140:143], v15, s[44:47], 0 offen offset:768 sc1
    buffer_load_dwordx4 v[144:147], v15, s[44:47], s48 offen offset:768 sc1
    buffer_load_dwordx4 v[148:151], v15, s[44:47], 0 offen offset:1024 sc1
    buffer_load_dwordx4 v[152:155], v15, s[44:47], s48 offen offset:1024 sc1
    s_add_u32 s35, s35, 1
    s_waitcnt vmcnt(0)
    v_mfma_f32_16x16x32_bf16 v[104:107], v[116:119], v[52:55], v[68:71]
    v_max3_u32 v28, v116, v117, v118
    v_max3_u32 v28, v28, v119, v120
    v_mfma_f32_16x16x32_bf16 v[104:107], v[120:123], v[52:55], v[104:107]
    v_max3_u32 v28, v28, v121, v122
    v_max3_u32 v28, v28, v123, v124
    v_mfma_f32_16x16x32_bf16 v[104:107], v[124:127], v[56:59], v[104:107]
    v_max3_u32 v28, v28, v125, v126
    v_max3_u32 v28, v28, v127, v128
    v_mfma_f32_16x16x32_bf16 v[104:107], v[128:131], v[56:59], v[104:107]
    v_max3_u32 v28, v28, v129, v130
    v_max3_u32 v28, v28, v131, v132
    v_mfma_f32_16x16x32_bf16 v[108:111], v[132:135], v[52:55], v[72:75]
    v_max3_u32 v28, v28, v133, v134
    v_max3_u32 v28, v28, v135, v136
    v_mfma_f32_16x16x32_bf16 v[108:111], v[136:139], v[52:55], v[108:111]
    v_max3_u32 v28, v28, v137, v138
    v_max3_u32 v28, v28, v139, v140
    v_mfma_f32_16x16x32_bf16 v[108:111], v[140:143], v[56:59], v[108:111]
    v_max3_u32 v28, v28, v141, v142
    v_max3_u32 v28, v28, v143, v144
    v_mfma_f32_16x16x32_bf16 v[108:111], v[144:147], v[56:59], v[108:111]
    v_max3_u32 v28, v28, v145, v146
    v_max3_u32 v28, v28, v147, v148
    v_mfma_f32_16x16x32_bf16 v[112:115], v[148:151], v[52:55], v[76:79]
    v_max3_u32 v28, v28, v149, v150
    v_max3_u32 v28, v28, v151, v152
    v_mfma_f32_16x16x32_bf16 v[112:115], v[152:155], v[52:55], v[112:115]
    v_max3_u32 v28, v28, v153, v154
    v_max_u32 v28, v28, v155
    v_cmp_eq_u32 vcc, -1, v28
    s_cbranch_vccz L_done22
    s_cmp_lt_u32 s35, 60000
    s_nop 7
    s_cbranch_scc1 L_poll21
L_done22:
    v_pk_add_f32 v[20:21], v[104:105], v[106:107]
    v_pk_mul_f32 v[22:23], v[104:105], v[104:105]
    v_pk_fma_f32 v[22:23], v[106:107], v[106:107], v[22:23]
    v_pk_add_f32 v[20:21], v[20:21], v[108:109]
    v_pk_fma_f32 v[22:23], v[108:109], v[108:109], v[22:23]
    v_pk_add_f32 v[20:21], v[20:21], v[110:111]
    v_pk_fma_f32 v[22:23], v[110:111], v[110:111], v[22:23]
    v_pk_add_f32 v[20:21], v[20:21], v[112:113]
    v_pk_fma_f32 v[22:23], v[112:113], v[112:113], v[22:23]
    v_pk_add_f32 v[20:21], v[20:21], v[114:115]
    v_pk_fma_f32 v[22:23], v[114:115], v[114:115], v[22:23]
    v_add_f32 v20, v20, v21
    v_add_f32 v21, v22, v23
    s_nop 0
    v_add_f32_dpp v20, v20, v20 row_ror:8 row_mask:0xf bank_mask:0xf
    v_add_f32_dpp v21, v21, v21 row_ror:8 row_mask:0xf bank_mask:0xf
    s_nop 0
    v_add_f32_dpp v20, v20, v20 row_ror:4 row_mask:0xf bank_mask:0xf
    v_add_f32_dpp v21, v21, v21 row_ror:4 row_mask:0xf bank_mask:0xf
    s_nop 0
    v_add_f32_dpp v20, v20, v20 row_ror:2 row_mask:0xf bank_mask:0xf
    v_add_f32_dpp v21, v21, v21 row_ror:2 row_mask:0xf bank_mask:0xf
    s_nop 0
    v_add_f32_dpp v20, v20, v20 row_ror:1 row_mask:0xf bank_mask:0xf
    v_add_f32_dpp v21, v21, v21 row_ror:1 row_mask:0xf bank_mask:0xf
    v_mov_b32 v22, v20
    v_mov_b32 v23, v21
    s_nop 0
    v_permlane16_swap_b32 v20, v22
    v_permlane16_swap_b32 v21, v23
    v_add_f32 v20, v20, v22
    v_add_f32 v21, v21, v23
    v_mov_b32 v22, v20
    v_mov_b32 v23, v21
    s_nop 0
    v_permlane32_swap_b32 v20, v22
    v_permlane32_swap_b32 v21, v23
    v_add_f32 v20, v20, v22
    v_add_f32 v21, v21, v23
    v_mul_f32 v22, 0x3acccccd, v20
    v_mul_f32 v21, 0x3acccccd, v21
    v_fma_f32 v21, -v22, v22, v21
    v_max_f32 v21, 0, v21
    v_add_f32 v21, 0x3727c5ac, v21
    v_rsq_f32 v20, v21
    s_nop 0
    v_mul_f32_e64 v21, -v22, v20
    v_pk_fma_f32 v[104:105], v[104:105], v[20:21], v[20:21] op_sel:[0,0,1] op_sel_hi:[1,0,1]
    v_pk_fma_f32 v[106:107], v[106:107], v[20:21], v[20:21] op_sel:[0,0,1] op_sel_hi:[1,0,1]
    v_pk_fma_f32 v[108:109], v[108:109], v[20:21], v[20:21] op_sel:[0,0,1] op_sel_hi:[1,0,1]
    v_pk_fma_f32 v[110:111], v[110:111], v[20:21], v[20:21] op_sel:[0,0,1] op_sel_hi:[1,0,1]
    v_pk_fma_f32 v[112:113], v[112:113], v[20:21], v[20:21] op_sel:[0,0,1] op_sel_hi:[1,0,1]
    v_pk_fma_f32 v[114:115], v[114:115], v[20:21], v[20:21] op_sel:[0,0,1] op_sel_hi:[1,0,1]
    v_pk_fma_f32 v[104:105], v[104:105], v[80:81], v[92:93]
    v_pk_fma_f32 v[106:107], v[106:107], v[82:83], v[94:95]
    v_pk_fma_f32 v[108:109], v[108:109], v[84:85], v[96:97]
    v_pk_fma_f32 v[110:111], v[110:111], v[86:87], v[98:99]
    v_pk_fma_f32 v[112:113], v[112:113], v[88:89], v[100:101]
    v_pk_fma_f32 v[114:115], v[114:115], v[90:91], v[102:103]
    v_cvt_pk_bf16_f32 v20, v104, v105
    v_cvt_pk_bf16_f32 v21, v106, v107
    v_cvt_pk_bf16_f32 v22, v108, v109
    v_cvt_pk_bf16_f32 v23, v110, v111
    v_cvt_pk_bf16_f32 v24, v112, v113
    v_cvt_pk_bf16_f32 v25, v114, v115
    ds_write_b128 v7, v[20:23]
    s_mov_b32 exec_lo, 0x00ff00ff
    s_mov_b32 exec_hi, 0x00ff00ff
    ds_write_b64 v8, v[24:25] offset:1024
    s_mov_b64 exec, -1
L_w1_mm:
    s_waitcnt lgkmcnt(0)
    s_barrier
    ds_read_b128 v[116:119], v4 offset:0
    ds_read_b128 v[120:123], v4 offset:64
    ds_read_b128 v[124:127], v4 offset:128
    ds_read_b128 v[128:131], v4 offset:192
    ds_read_b128 v[132:135], v4 offset:256
    s_waitcnt lgkmcnt(4)
    v_mfma_f32_16x16x32_bf16 v[20:23], v[32:35], v[116:119], 0
    s_waitcnt lgkmcnt(3)
    v_mfma_f32_16x16x32_bf16 v[20:23], v[36:39], v[120:123], v[20:23]
    s_waitcnt lgkmcnt(2)
    v_mfma_f32_16x16x32_bf16 v[20:23], v[40:43], v[124:127], v[20:23]
    s_waitcnt lgkmcnt(1)
    v_mfma_f32_16x16x32_bf16 v[20:23], v[44:47], v[128:131], v[20:23]
    s_waitcnt lgkmcnt(0)
    v_mfma_f32_16x16x32_bf16 v[20:23], v[48:51], v[132:135], v[20:23]
    s_nop 7
    ds_write_b128 v2, v[20:23]
    s_waitcnt lgkmcnt(0)
    s_barrier
    s_cmp_lg_u32 s3, 0
    s_cbranch_scc1 L_fin
    ds_read_b64 v[20:21], v9 offset:0
    ds_read_b64 v[22:23], v9 offset:2048
    ds_read_b64 v[24:25], v9 offset:4096
    ds_read_b64 v[26:27], v9 offset:6144
    s_mov_b32 s34, 0xbdd2d3e8
    v_mov_b32 v10, 0xc0135761
    s_waitcnt lgkmcnt(3)
    v_pk_add_f32 v[30:31], v[30:31], v[20:21]
    s_waitcnt lgkmcnt(2)
    v_pk_add_f32 v[30:31], v[30:31], v[22:23]
    s_waitcnt lgkmcnt(1)
    v_pk_add_f32 v[30:31], v[30:31], v[24:25]
    s_waitcnt lgkmcnt(0)
    v_pk_add_f32 v[30:31], v[30:31], v[26:27]
    v_pk_mul_f32 v[20:21], v[30:31], v[30:31]
    v_fma_f32 v20, v20, s34, v10
    v_fma_f32 v21, v21, s34, v10
    v_pk_mul_f32 v[20:21], v[20:21], v[30:31]
    v_exp_f32 v20, v20
    v_exp_f32 v21, v21
    v_add_f32 v20, 1.0, v20
    v_add_f32 v21, 1.0, v21
    v_rcp_f32 v20, v20
    v_rcp_f32 v21, v21
    s_nop 0
    v_pk_mul_f32 v[20:21], v[20:21], v[30:31]
    v_cvt_pk_bf16_f32 v20, v20, v21
    v_min_u32 v20, -2, v20
    buffer_store_dword v20, v5, s[44:47], 0 offen sc1
    s_branch L_fin
L_t_w2:
    s_cmp_eq_u32 s3, 7
    s_cbranch_scc1 L_w2_red
    s_lshl_b32 s34, s3, 13
    s_add_u32 s34, s34, 40960
    v_lshl_add_u32 v3, v0, 3, s34
    ds_read_b64_tr_b16 v[32:33], v3 offset:0
    ds_read_b64_tr_b16 v[34:35], v3 offset:512
    ds_read_b64_tr_b16 v[36:37], v3 offset:1024
    ds_read_b64_tr_b16 v[38:39], v3 offset:1536
    ds_read_b64_tr_b16 v[40:41], v3 offset:2048
    ds_read_b64_tr_b16 v[42:43], v3 offset:2560
    ds_read_b64_tr_b16 v[44:45], v3 offset:3072
    ds_read_b64_tr_b16 v[46:47], v3 offset:3584
    s_waitcnt lgkmcnt(0)
    ds_read_b64_tr_b16 v[48:49], v3 offset:4096
    ds_read_b64_tr_b16 v[50:51], v3 offset:4608
    ds_read_b64_tr_b16 v[52:53], v3 offset:5120
    ds_read_b64_tr_b16 v[54:55], v3 offset:5632
    ds_read_b64_tr_b16 v[56:57], v3 offset:6144
    ds_read_b64_tr_b16 v[58:59], v3 offset:6656
    ds_read_b64_tr_b16 v[60:61], v3 offset:7168
    ds_read_b64_tr_b16 v[62:63], v3 offset:7680
    s_lshl_b32 s34, s3, 3
    v_add_u32 v4, s34, v13
    v_add_u32 v5, 4, v4
    v_min_u32 v5, 53, v5
    v_lshlrev_b32 v6, 6, v14
    v_lshl_add_u32 v6, v12, 4, v6
    v_add_u32 v6, 180224, v6
    v_lshl_add_u32 v4, v4, 8, v6
    v_lshl_add_u32 v5, v5, 8, v6
    s_waitcnt lgkmcnt(0)
    s_mov_b32 s35, 0
L_poll23:
    buffer_load_dwordx4 v[64:67], v4, s[44:47], 0 offen sc1
    buffer_load_dwordx4 v[68:71], v5, s[44:47], 0 offen sc1
    s_add_u32 s35, s35, 1
    s_waitcnt vmcnt(0)
    v_mfma_f32_16x16x32_bf16 v[80:83], v[32:35], v[64:67], 0
    v_max3_u32 v28, v64, v65, v66
    v_mfma_f32_16x16x32_bf16 v[84:87], v[36:39], v[64:67], 0
    v_max3_u32 v28, v28, v67, v68
    v_mfma_f32_16x16x32_bf16 v[88:91], v[40:43], v[64:67], 0
    v_max3_u32 v28, v28, v69, v70
    v_mfma_f32_16x16x32_bf16 v[92:95], v[44:47], v[64:67], 0
    v_max_u32 v28, v28, v71
    v_mfma_f32_16x16x32_bf16 v[80:83], v[48:51], v[68:71], v[80:83]
    v_mfma_f32_16x16x32_bf16 v[84:87], v[52:55], v[68:71], v[84:87]
    v_mfma_f32_16x16x32_bf16 v[88:91], v[56:59], v[68:71], v[88:91]
    v_mfma_f32_16x16x32_bf16 v[92:95], v[60:63], v[68:71], v[92:95]
    v_cmp_eq_u32 vcc, -1, v28
    s_cbranch_vccz L_done24
    s_cmp_lt_u32 s35, 60000
    s_nop 7
    s_cbranch_scc1 L_poll23
L_done24:
    s_nop 3
    v_mov_b32_dpp v80, v84 quad_perm:[0,1,2,3] row_mask:0xf bank_mask:0x2
    v_mov_b32_dpp v81, v85 quad_perm:[0,1,2,3] row_mask:0xf bank_mask:0x2
    v_mov_b32_dpp v82, v86 quad_perm:[0,1,2,3] row_mask:0xf bank_mask:0x2
    v_mov_b32_dpp v83, v87 quad_perm:[0,1,2,3] row_mask:0xf bank_mask:0x2
    v_mov_b32_dpp v80, v88 quad_perm:[0,1,2,3] row_mask:0xf bank_mask:0x4
    v_mov_b32_dpp v81, v89 quad_perm:[0,1,2,3] row_mask:0xf bank_mask:0x4
    v_mov_b32_dpp v82, v90 quad_perm:[0,1,2,3] row_mask:0xf bank_mask:0x4
    v_mov_b32_dpp v83, v91 quad_perm:[0,1,2,3] row_mask:0xf bank_mask:0x4
    v_mov_b32_dpp v80, v92 quad_perm:[0,1,2,3] row_mask:0xf bank_mask:0x8
    v_mov_b32_dpp v81, v93 quad_perm:[0,1,2,3] row_mask:0xf bank_mask:0x8
    v_mov_b32_dpp v82, v94 quad_perm:[0,1,2,3] row_mask:0xf bank_mask:0x8
    v_mov_b32_dpp v83, v95 quad_perm:[0,1,2,3] row_mask:0xf bank_mask:0x8
    ds_write_b128 v2, v[80:83]
    s_waitcnt lgkmcnt(0)
    s_barrier
    s_branch L_fin
L_w2_red:
    s_setprio 3
    s_lshl_b32 s34, s62, 5
    v_lshl_add_u32 v3, v14, 3, s34
    global_load_dwordx2 v[20:21], v3, s[22:23]
    v_mul_u32_u24 v4, 1280, v12
    v_add_u32 v4, v4, v3
    global_load_dwordx2 v[22:23], v4, s[4:5]
    v_mul_u32_u24 v5, 5120, v12
    v_add_u32 v5, v5, v3
    v_add_u32 v5, 44800, v5
    s_mov_b32 s35, 0
L_poll25:
    buffer_load_dwordx2 v[24:25], v5, s[44:47], 0 offen sc1
    s_add_u32 s35, s35, 1
    s_waitcnt vmcnt(0)
    v_max_u32 v28, v24, v25
    v_cmp_eq_u32 vcc, -1, v28
    s_cbranch_vccz L_done26
    s_sleep 1
    s_cmp_lt_u32 s35, 60000
    s_cbranch_scc1 L_poll25
L_done26:
    v_lshlrev_b32 v32, 16, v20
    v_and_b32 v33, 0xffff0000, v20
    v_lshlrev_b32 v34, 16, v21
    v_and_b32 v35, 0xffff0000, v21
    v_lshlrev_b32 v36, 16, v22
    v_and_b32 v37, 0xffff0000, v22
    v_lshlrev_b32 v38, 16, v23
    v_and_b32 v39, 0xffff0000, v23
    v_lshlrev_b32 v40, 16, v24
    v_and_b32 v41, 0xffff0000, v24
    v_lshlrev_b32 v42, 16, v25
    v_and_b32 v43, 0xffff0000, v25
    v_fma_f32 v36, v40, v32, v36
    v_fma_f32 v37, v41, v33, v37
    v_fma_f32 v38, v42, v34, v38
    v_fma_f32 v39, v43, v35, v39
    v_mul_f32 v36, 0x3e800000, v36
    v_mul_f32 v37, 0x3e800000, v37
    v_mul_f32 v38, 0x3e800000, v38
    v_mul_f32 v39, 0x3e800000, v39
    v_mul_u32_u24 v5, 5120, v13
    v_add_u32 v5, v5, v4
    v_add_u32 v5, 139264, v5
    s_movk_i32 s48, 20480
    s_mov_b32 s35, 0
L_poll27:
    buffer_load_dwordx2 v[20:21], v5, s[44:47], 0 offen sc1
    buffer_load_dwordx2 v[22:23], v5, s[44:47], s48 offen sc1
    s_add_u32 s35, s35, 1
    s_waitcnt vmcnt(0)
    v_max3_u32 v28, v20, v21, v22
    v_max_u32 v28, v28, v23
    v_cmp_eq_u32 vcc, -1, v28
    s_cbranch_vccz L_done28
    s_sleep 2
    s_cmp_lt_u32 s35, 60000
    s_cbranch_scc1 L_poll27
L_done28:
    v_lshlrev_b32 v44, 16, v20
    v_and_b32 v45, 0xffff0000, v20
    v_lshlrev_b32 v46, 16, v21
    v_and_b32 v47, 0xffff0000, v21
    v_lshlrev_b32 v48, 16, v22
    v_and_b32 v49, 0xffff0000, v22
    v_lshlrev_b32 v50, 16, v23
    v_and_b32 v51, 0xffff0000, v23
    v_add_f32 v36, v36, v44
    v_add_f32 v37, v37, v45
    v_add_f32 v38, v38, v46
    v_add_f32 v39, v39, v47
    v_add_f32 v36, v36, v48
    v_add_f32 v37, v37, v49
    v_add_f32 v38, v38, v50
    v_add_f32 v39, v39, v51
    v_lshlrev_b32 v6, 4, v0
    v_add_u32 v6, 122112, v6
    s_barrier
    ds_read_b128 v[64:67], v6 offset:0
    ds_read_b128 v[68:71], v6 offset:1024
    ds_read_b128 v[72:75], v6 offset:2048
    ds_read_b128 v[76:79], v6 offset:3072
    ds_read_b128 v[80:83], v6 offset:4096
    ds_read_b128 v[84:87], v6 offset:5120
    ds_read_b128 v[88:91], v6 offset:6144
    s_waitcnt lgkmcnt(5)
    v_pk_add_f32 v[64:65], v[64:65], v[68:69]
    v_pk_add_f32 v[66:67], v[66:67], v[70:71]
    s_waitcnt lgkmcnt(4)
    v_pk_add_f32 v[64:65], v[64:65], v[72:73]
    v_pk_add_f32 v[66:67], v[66:67], v[74:75]
    s_waitcnt lgkmcnt(3)
    v_pk_add_f32 v[64:65], v[64:65], v[76:77]
    v_pk_add_f32 v[66:67], v[66:67], v[78:79]
    s_waitcnt lgkmcnt(2)
    v_pk_add_f32 v[64:65], v[64:65], v[80:81]
    v_pk_add_f32 v[66:67], v[66:67], v[82:83]
    s_waitcnt lgkmcnt(1)
    v_pk_add_f32 v[64:65], v[64:65], v[84:85]
    v_pk_add_f32 v[66:67], v[66:67], v[86:87]
    s_waitcnt lgkmcnt(0)
    v_pk_add_f32 v[64:65], v[64:65], v[88:89]
    v_pk_add_f32 v[66:67], v[66:67], v[90:91]
    v_pk_fma_f32 v[64:65], v[64:65], v[40:41], v[36:37]
    v_pk_fma_f32 v[66:67], v[66:67], v[42:43], v[38:39]
    s_nop 0
    v_add_f32_dpp v64, v64, v64 row_ror:4 row_mask:0xf bank_mask:0xf
    v_add_f32_dpp v65, v65, v65 row_ror:4 row_mask:0xf bank_mask:0xf
    v_add_f32_dpp v66, v66, v66 row_ror:4 row_mask:0xf bank_mask:0xf
    v_add_f32_dpp v67, v67, v67 row_ror:4 row_mask:0xf bank_mask:0xf
    v_add_f32_dpp v64, v64, v64 row_ror:8 row_mask:0xf bank_mask:0xf
    v_add_f32_dpp v65, v65, v65 row_ror:8 row_mask:0xf bank_mask:0xf
    v_add_f32_dpp v66, v66, v66 row_ror:8 row_mask:0xf bank_mask:0xf
    v_add_f32_dpp v67, v67, v67 row_ror:8 row_mask:0xf bank_mask:0xf
    v_cvt_pk_bf16_f32 v20, v64, v65
    v_cvt_pk_bf16_f32 v21, v66, v67
    s_mov_b32 exec_lo, 0x000f000f
    s_mov_b32 exec_hi, 0x000f000f
    global_store_dwordx2 v4, v[20:21], s[28:29]
    s_mov_b64 exec, -1
    s_branch L_fin
L_t_wo:
    s_lshl_b32 s34, s3, 12
    s_add_u32 s34, s34, 40960
    v_lshrrev_b32 v3, 2, v0
    v_lshlrev_b32 v3, 6, v3
    v_lshl_add_u32 v3, v12, 3, v3
    v_add_u32 v3, s34, v3
    ds_read_b64_tr_b16 v[32:33], v3 offset:0
    ds_read_b64_tr_b16 v[34:35], v3 offset:1024
    ds_read_b64_tr_b16 v[36:37], v3 offset:32
    ds_read_b64_tr_b16 v[38:39], v3 offset:1056
    ds_read_b64_tr_b16 v[40:41], v3 offset:2048
    ds_read_b64_tr_b16 v[42:43], v3 offset:3072
    ds_read_b64_tr_b16 v[44:45], v3 offset:2080
    ds_read_b64_tr_b16 v[46:47], v3 offset:3104
    s_lshr_b32 s34, s3, 1
    s_lshl_b32 s34, s34, 3
    s_add_u32 s34, s34, s60
    v_and_b32 v4, 7, v0
    s_lshl_b32 s35, s34, 7
    s_add_u32 s35, s35, 131072
    v_lshl_add_u32 v5, v4, 2, s35
    v_bfe_u32 v6, v0, 1, 2
    v_bfe_u32 v7, v0, 3, 1
    v_lshlrev_b32 v8, 5, v7
    v_lshl_add_u32 v8, v14, 3, v8
    s_lshl_b32 s35, s62, 6
    v_add_u32 v8, s35, v8
    v_mul_u32_u24 v9, 5120, v6
    v_add_u32 v9, v9, v8
    v_add_u32 v9, 40960, v9
    s_lshl_b32 s34, s34, 11
    s_and_b32 s49, s3, 1
    s_lshl_b32 s49, s49, 7
    s_add_u32 s34, s34, s49
    s_add_u32 s34, s34, 65536
    v_lshrrev_b32 v10, 3, v0
    v_lshlrev_b32 v11, 8, v10
    v_lshl_add_u32 v11, v4, 4, v11
    v_add_u32 v11, s34, v11
    s_mul_i32 s34, s3, 1152
    s_add_u32 s34, s34, 107520
    v_mul_u32_u24 v15, 144, v10
    v_lshl_add_u32 v15, v4, 4, v15
    v_add_u32 v15, s34, v15
    v_mul_u32_u24 v16, 144, v4
    v_lshl_add_u32 v16, v14, 4, v16
    v_add_u32 v16, s34, v16
    v_mov_b32 v18, 98816
    v_cmp_eq_u32 vcc, 0, v7
    s_nop 1
    v_cndmask_b32 v17, v16, v18, vcc
    v_cndmask_b32 v16, v18, v16, vcc
    s_mul_i32 s34, s60, 5120
    s_add_u32 s34, s34, 139264
    v_mul_u32_u24 v18, 1280, v6
    v_add3_u32 v18, v18, v8, s34
    v_lshlrev_b32 v19, 4, v0
    v_add_u32 v19, 122112, v19
    s_mov_b32 s35, 0
L_poll29:
    buffer_load_dword v20, v5, s[44:47], 0 offen sc1
    buffer_load_dwordx2 v[22:23], v9, s[44:47], 0 offen sc1
    s_add_u32 s35, s35, 1
    s_waitcnt vmcnt(0)
    v_max3_u32 v28, v20, v22, v23
    v_cmp_eq_u32 vcc, -1, v28
    s_cbranch_vccz L_done30
    s_sleep 1
    s_cmp_lt_u32 s35, 60000
    s_cbranch_scc1 L_poll29
L_done30:
    v_sub_f32_dpp v21, v20, v20 quad_perm:[1,0,3,2] row_mask:0xf bank_mask:0xf
    v_exp_f32 v21, v21
    v_lshlrev_b32 v24, 16, v22
    v_and_b32 v25, 0xffff0000, v22
    v_lshlrev_b32 v26, 16, v23
    v_and_b32 v27, 0xffff0000, v23
    v_add_f32 v21, 1.0, v21
    v_rcp_f32 v21, v21
    s_nop 0
    v_mul_f32 v24, v24, v21
    v_mul_f32 v25, v25, v21
    v_mul_f32 v26, v26, v21
    v_mul_f32 v27, v27, v21
    s_waitcnt lgkmcnt(0)
    s_mov_b32 s35, 0
L_poll31:
    buffer_load_dwordx4 v[64:67], v11, s[44:47], 0 offen sc1
    s_add_u32 s35, s35, 1
    s_waitcnt vmcnt(0)
    ds_write_b128 v15, v[64:67]
    v_max3_u32 v28, v64, v65, v66
    v_max_u32 v28, v28, v67
    v_cmp_eq_u32 vcc, -1, v28
    s_cbranch_vccz L_done32
    s_cmp_lt_u32 s35, 60000
    s_nop 7
    s_cbranch_scc1 L_poll31
L_done32:
    s_waitcnt lgkmcnt(0)
    ds_read_b128 v[68:71], v16 offset:0
    ds_read_b128 v[72:75], v17 offset:0
    ds_read_b128 v[76:79], v16 offset:64
    ds_read_b128 v[80:83], v17 offset:64
    s_waitcnt lgkmcnt(3)
    v_mfma_f32_16x16x32_bf16 v[20:23], v[32:35], v[68:71], 0
    s_waitcnt lgkmcnt(2)
    v_mfma_f32_16x16x32_bf16 v[20:23], v[36:39], v[72:75], v[20:23]
    s_waitcnt lgkmcnt(1)
    v_mfma_f32_16x16x32_bf16 v[20:23], v[40:43], v[76:79], v[20:23]
    s_waitcnt lgkmcnt(0)
    v_mfma_f32_16x16x32_bf16 v[20:23], v[44:47], v[80:83], v[20:23]
    s_nop 7
    v_pk_mul_f32 v[20:21], v[20:21], v[24:25]
    v_pk_mul_f32 v[22:23], v[22:23], v[26:27]
    ds_write_b128 v2, v[20:23]
    s_waitcnt lgkmcnt(0)
    s_barrier
    s_cmp_lg_u32 s3, 0
    s_cbranch_scc1 L_fin
    ds_read_b128 v[64:67], v19 offset:0
    ds_read_b128 v[68:71], v19 offset:1024
    ds_read_b128 v[72:75], v19 offset:2048
    ds_read_b128 v[76:79], v19 offset:3072
    ds_read_b128 v[80:83], v19 offset:4096
    ds_read_b128 v[84:87], v19 offset:5120
    ds_read_b128 v[88:91], v19 offset:6144
    ds_read_b128 v[92:95], v19 offset:7168
    s_waitcnt lgkmcnt(6)
    v_pk_add_f32 v[64:65], v[64:65], v[68:69]
    v_pk_add_f32 v[66:67], v[66:67], v[70:71]
    s_waitcnt lgkmcnt(5)
    v_pk_add_f32 v[64:65], v[64:65], v[72:73]
    v_pk_add_f32 v[66:67], v[66:67], v[74:75]
    s_waitcnt lgkmcnt(4)
    v_pk_add_f32 v[64:65], v[64:65], v[76:77]
    v_pk_add_f32 v[66:67], v[66:67], v[78:79]
    s_waitcnt lgkmcnt(3)
    v_pk_add_f32 v[64:65], v[64:65], v[80:81]
    v_pk_add_f32 v[66:67], v[66:67], v[82:83]
    s_waitcnt lgkmcnt(2)
    v_pk_add_f32 v[64:65], v[64:65], v[84:85]
    v_pk_add_f32 v[66:67], v[66:67], v[86:87]
    s_waitcnt lgkmcnt(1)
    v_pk_add_f32 v[64:65], v[64:65], v[88:89]
    v_pk_add_f32 v[66:67], v[66:67], v[90:91]
    s_waitcnt lgkmcnt(0)
    v_pk_add_f32 v[64:65], v[64:65], v[92:93]
    v_pk_add_f32 v[66:67], v[66:67], v[94:95]
    s_nop 0
    v_add_f32_dpp v64, v64, v64 quad_perm:[1,0,3,2] row_mask:0xf bank_mask:0xf
    v_add_f32_dpp v65, v65, v65 quad_perm:[1,0,3,2] row_mask:0xf bank_mask:0xf
    v_add_f32_dpp v66, v66, v66 quad_perm:[1,0,3,2] row_mask:0xf bank_mask:0xf
    v_add_f32_dpp v67, v67, v67 quad_perm:[1,0,3,2] row_mask:0xf bank_mask:0xf
    v_cvt_pk_bf16_f32 v20, v64, v65
    v_cvt_pk_bf16_f32 v21, v66, v67
    v_min_u32 v20, -2, v20
    v_min_u32 v21, -2, v21
    s_mov_b32 exec_lo, 0x55555555
    s_mov_b32 exec_hi, 0x55555555
    buffer_store_dwordx2 v[20:21], v18, s[44:47], 0 offen sc1
    s_mov_b64 exec, -1
L_t_none:
L_fin:
L_exit:
    s_endpgm
L_codeend:
.section .rodata,"a"
.p2align 6
.amdhsa_kernel adaLN_cond__sliding_block_cached__dense_activation_gelu__decode_kernel
  .amdhsa_next_free_vgpr 256
  .amdhsa_next_free_sgpr 102
  .amdhsa_accum_offset 256
  .amdhsa_group_segment_fixed_size 0
  .amdhsa_kernarg_size 120
  .amdhsa_user_sgpr_count 2
  .amdhsa_user_sgpr_kernarg_segment_ptr 1
  .amdhsa_system_sgpr_workgroup_id_x 1
  .amdhsa_float_denorm_mode_32 3
.end_amdhsa_kernel
```

```asm
; @launch grid=(256,1,1) block=(512,1,1) lds=130304
.amdgcn_target "amdgcn-amd-amdhsa--gfx950"
.text
.globl adaLN_cond__sliding_block_cached__dense_activation_gelu__decode_kernel
.p2align 8
.type adaLN_cond__sliding_block_cached__dense_activation_gelu__decode_kernel,@function
adaLN_cond__sliding_block_cached__dense_activation_gelu__decode_kernel:
    s_cmp_ge_u32 s2, 256
    s_cbranch_scc1 L_exit
    s_load_dwordx16 s[4:19], s[0:1], 0
    s_load_dwordx8 s[20:27], s[0:1], 64
    s_load_dwordx4 s[28:31], s[0:1], 96
    s_load_dwordx2 s[32:33], s[0:1], 112
    v_lshrrev_b32 v1, 6, v0
    v_and_b32 v0, 63, v0
    v_readfirstlane_b32 s3, v1
    s_and_b32 s60, s2, 7
    s_lshr_b32 s61, s2, 3
    s_mov_b32 s39, 0x20000
    s_mov_b32 s43, 0x20000
    s_mov_b32 s46, 524288
    s_mov_b32 s47, 0x20000
    s_cmp_lg_u32 s3, 0
    s_cbranch_scc1 L_stream
    s_setprio 3
    v_and_b32 v12, 3, v0
    v_bfe_u32 v13, v0, 2, 2
    v_lshrrev_b32 v14, 4, v0
    v_lshrrev_b32 v10, 3, v0
    v_and_b32 v11, 7, v0
    v_lshlrev_b32 v11, 4, v11
    s_lshr_b32 s50, s2, 2
    s_and_b32 s51, s2, 3
    s_mul_i32 s34, s51, 1228800
    s_lshl_b32 s35, s50, 7
    s_add_u32 s34, s34, s35
    v_mul_u32_u24 v17, 7680, v10
    v_add3_u32 v17, v17, v11, s34
    v_mul_u32_u24 v16, 1280, v12
    v_lshl_add_u32 v18, v14, 4, v16
    s_mul_i32 s34, s51, 320
    v_add_u32 v19, s34, v18
    s_mov_b32 s38, 4915200
    s_sub_u32 s52, s50, 10
    s_cmp_ge_u32 s2, 240
    s_waitcnt lgkmcnt(0)
    s_mov_b32 s44, s32
    s_mov_b32 s45, s33
    s_cbranch_scc1 L_clear
    s_cmp_ge_u32 s52, 10
    s_cbranch_scc1 L_nox
    v_lshl_add_u32 v18, v13, 6, v18
    global_load_dwordx4 v[52:55], v18, s[4:5] offset:0
    global_load_dwordx4 v[56:59], v18, s[4:5] offset:256
    global_load_dwordx4 v[60:63], v18, s[4:5] offset:512
    global_load_dwordx4 v[64:67], v18, s[4:5] offset:768
    global_load_dwordx4 v[68:71], v18, s[4:5] offset:1024
    s_lshl_b32 s34, s52, 7
    v_lshl_add_u32 v16, v13, 5, v16
    v_lshl_add_u32 v16, v14, 3, v16
    v_add_u32 v16, s34, v16
    global_load_dwordx2 v[72:73], v16, s[4:5]
L_nox:
    global_load_dwordx4 v[32:35], v19, s[24:25] offset:0
    global_load_dwordx4 v[36:39], v19, s[24:25] offset:64
    global_load_dwordx4 v[40:43], v19, s[24:25] offset:128
    global_load_dwordx4 v[44:47], v19, s[24:25] offset:192
    global_load_dwordx4 v[48:51], v19, s[24:25] offset:256
    s_mov_b32 s36, s26
    s_mov_b32 s37, s27
    s_mov_b32 m0, 0
    s_mov_b32 s34, 0
L_dma1:
    buffer_load_dwordx4 v17, s[36:39], s34 offen  lds
    s_add_u32 m0, m0, 1024
    s_add_u32 s34, s34, 61440
    buffer_load_dwordx4 v17, s[36:39], s34 offen  lds
    s_add_u32 m0, m0, 1024
    s_add_u32 s34, s34, 61440
    buffer_load_dwordx4 v17, s[36:39], s34 offen  lds
    s_add_u32 m0, m0, 1024
    s_add_u32 s34, s34, 61440
    buffer_load_dwordx4 v17, s[36:39], s34 offen  lds
    s_add_u32 m0, m0, 1024
    s_add_u32 s34, s34, 61440
    s_cmp_lt_u32 s34, 1228800
    s_cbranch_scc1 L_dma1
    v_lshlrev_b32 v1, 2, v0
    v_add_u32 v1, 98304, v1
    v_mov_b32 v2, -1
    v_mov_b32 v3, 0
    v_cmp_eq_u32 vcc, 14, v0
    v_mov_b32 v5, 0xfe967699
    s_nop 0
    v_cndmask_b32 v4, v2, v5, vcc
    v_cmp_eq_u32 vcc, 15, v0
    s_nop 1
    v_cndmask_b32 v4, v4, v3, vcc
    ds_write_b32 v1, v2
    ds_write_b32 v1, v4 offset:256
    ds_write_b32 v1, v3 offset:512
    s_waitcnt lgkmcnt(0)
    s_barrier
    s_getpc_b64 s[56:57]
L_pc2:
    s_sub_u32 s56, s56, L_pc2-adaLN_cond__sliding_block_cached__dense_activation_gelu__decode_kernel
    s_subb_u32 s57, s57, 0
    s_lshl_b32 s34, s61, 10
    v_lshl_add_u32 v9, v0, 4, s34
    v_min_u32 v9, L_codeend-adaLN_cond__sliding_block_cached__dense_activation_gelu__decode_kernel-16, v9
    global_load_dwordx4 v[76:79], v9, s[56:57]
    s_and_b32 s34, s2, 31
    s_lshl_b32 s34, s34, 8
    s_lshr_b32 s35, s2, 7
    s_lshl_b32 s35, s35, 7
    s_add_u32 s49, s34, s35
    s_bfe_u32 s53, s2, 0x20005
    s_mul_i32 s34, s53, 1310720
    s_add_u32 s34, s34, s49
    v_lshl_add_u32 v16, v10, 13, v11
    v_add_u32 v16, s34, v16
    s_mov_b32 s36, s10
    s_mov_b32 s37, s11
    s_mov_b32 s38, 5242880
    s_mov_b32 m0, 20480
    s_mov_b32 s34, 0
L_dma3:
    buffer_load_dwordx4 v16, s[36:39], s34 offen  lds
    s_add_u32 m0, m0, 1024
    s_add_u32 s34, s34, 65536
    buffer_load_dwordx4 v16, s[36:39], s34 offen  lds
    s_add_u32 m0, m0, 1024
    s_add_u32 s34, s34, 65536
    buffer_load_dwordx4 v16, s[36:39], s34 offen  lds
    s_add_u32 m0, m0, 1024
    s_add_u32 s34, s34, 65536
    buffer_load_dwordx4 v16, s[36:39], s34 offen  lds
    s_add_u32 m0, m0, 1024
    s_add_u32 s34, s34, 65536
    s_cmp_lt_u32 s34, 1310720
    s_cbranch_scc1 L_dma3
    v_lshl_add_u32 v15, v14, 3, v13
    v_lshlrev_b32 v15, 7, v15
    v_lshl_add_u32 v15, v12, 3, v15
    s_waitcnt vmcnt(41)
    s_mov_b32 s34, 0xbfb8aa3b
    v_lshlrev_b32 v20, 16, v32
    v_and_b32 v21, 0xffff0000, v32
    v_lshlrev_b32 v22, 16, v33
    v_and_b32 v23, 0xffff0000, v33
    v_mul_f32 v24, s34, v20
    v_mul_f32 v25, s34, v21
    v_mul_f32 v26, s34, v22
    v_mul_f32 v27, s34, v23
    v_exp_f32 v24, v24
    v_exp_f32 v25, v25
    v_exp_f32 v26, v26
    v_exp_f32 v27, v27
    v_add_f32 v24, 1.0, v24
    v_add_f32 v25, 1.0, v25
    v_add_f32 v26, 1.0, v26
    v_add_f32 v27, 1.0, v27
    v_rcp_f32 v24, v24
    v_rcp_f32 v25, v25
    v_rcp_f32 v26, v26
    v_rcp_f32 v27, v27
    v_mul_f32 v24, v20, v24
    v_mul_f32 v25, v21, v25
    v_mul_f32 v26, v22, v26
    v_mul_f32 v27, v23, v27
    v_cvt_pk_bf16_f32 v32, v24, v25
    v_cvt_pk_bf16_f32 v33, v26, v27
    v_lshlrev_b32 v20, 16, v34
    v_and_b32 v21, 0xffff0000, v34
    v_lshlrev_b32 v22, 16, v35
    v_and_b32 v23, 0xffff0000, v35
    v_mul_f32 v24, s34, v20
    v_mul_f32 v25, s34, v21
    v_mul_f32 v26, s34, v22
    v_mul_f32 v27, s34, v23
    v_exp_f32 v24, v24
    v_exp_f32 v25, v25
    v_exp_f32 v26, v26
    v_exp_f32 v27, v27
    v_add_f32 v24, 1.0, v24
    v_add_f32 v25, 1.0, v25
    v_add_f32 v26, 1.0, v26
    v_add_f32 v27, 1.0, v27
    v_rcp_f32 v24, v24
    v_rcp_f32 v25, v25
    v_rcp_f32 v26, v26
    v_rcp_f32 v27, v27
    v_mul_f32 v24, v20, v24
    v_mul_f32 v25, v21, v25
    v_mul_f32 v26, v22, v26
    v_mul_f32 v27, v23, v27
    v_cvt_pk_bf16_f32 v34, v24, v25
    v_cvt_pk_bf16_f32 v35, v26, v27
    v_lshlrev_b32 v20, 16, v36
    v_and_b32 v21, 0xffff0000, v36
    v_lshlrev_b32 v22, 16, v37
    v_and_b32 v23, 0xffff0000, v37
    v_mul_f32 v24, s34, v20
    v_mul_f32 v25, s34, v21
    v_mul_f32 v26, s34, v22
    v_mul_f32 v27, s34, v23
    v_exp_f32 v24, v24
    v_exp_f32 v25, v25
    v_exp_f32 v26, v26
    v_exp_f32 v27, v27
    v_add_f32 v24, 1.0, v24
    v_add_f32 v25, 1.0, v25
    v_add_f32 v26, 1.0, v26
    v_add_f32 v27, 1.0, v27
    v_rcp_f32 v24, v24
    v_rcp_f32 v25, v25
    v_rcp_f32 v26, v26
    v_rcp_f32 v27, v27
    v_mul_f32 v24, v20, v24
    v_mul_f32 v25, v21, v25
    v_mul_f32 v26, v22, v26
    v_mul_f32 v27, v23, v27
    v_cvt_pk_bf16_f32 v36, v24, v25
    v_cvt_pk_bf16_f32 v37, v26, v27
    v_lshlrev_b32 v20, 16, v38
    v_and_b32 v21, 0xffff0000, v38
    v_lshlrev_b32 v22, 16, v39
    v_and_b32 v23, 0xffff0000, v39
    v_mul_f32 v24, s34, v20
    v_mul_f32 v25, s34, v21
    v_mul_f32 v26, s34, v22
    v_mul_f32 v27, s34, v23
    v_exp_f32 v24, v24
    v_exp_f32 v25, v25
    v_exp_f32 v26, v26
    v_exp_f32 v27, v27
    v_add_f32 v24, 1.0, v24
    v_add_f32 v25, 1.0, v25
    v_add_f32 v26, 1.0, v26
    v_add_f32 v27, 1.0, v27
    v_rcp_f32 v24, v24
    v_rcp_f32 v25, v25
    v_rcp_f32 v26, v26
    v_rcp_f32 v27, v27
    v_mul_f32 v24, v20, v24
    v_mul_f32 v25, v21, v25
    v_mul_f32 v26, v22, v26
    v_mul_f32 v27, v23, v27
    v_cvt_pk_bf16_f32 v38, v24, v25
    v_cvt_pk_bf16_f32 v39, v26, v27
    v_lshlrev_b32 v20, 16, v40
    v_and_b32 v21, 0xffff0000, v40
    v_lshlrev_b32 v22, 16, v41
    v_and_b32 v23, 0xffff0000, v41
    v_mul_f32 v24, s34, v20
    v_mul_f32 v25, s34, v21
    v_mul_f32 v26, s34, v22
    v_mul_f32 v27, s34, v23
    v_exp_f32 v24, v24
    v_exp_f32 v25, v25
    v_exp_f32 v26, v26
    v_exp_f32 v27, v27
    v_add_f32 v24, 1.0, v24
    v_add_f32 v25, 1.0, v25
    v_add_f32 v26, 1.0, v26
    v_add_f32 v27, 1.0, v27
    v_rcp_f32 v24, v24
    v_rcp_f32 v25, v25
    v_rcp_f32 v26, v26
    v_rcp_f32 v27, v27
    v_mul_f32 v24, v20, v24
    v_mul_f32 v25, v21, v25
    v_mul_f32 v26, v22, v26
    v_mul_f32 v27, v23, v27
    v_cvt_pk_bf16_f32 v40, v24, v25
    v_cvt_pk_bf16_f32 v41, v26, v27
    v_lshlrev_b32 v20, 16, v42
    v_and_b32 v21, 0xffff0000, v42
    v_lshlrev_b32 v22, 16, v43
    v_and_b32 v23, 0xffff0000, v43
    v_mul_f32 v24, s34, v20
    v_mul_f32 v25, s34, v21
    v_mul_f32 v26, s34, v22
    v_mul_f32 v27, s34, v23
    v_exp_f32 v24, v24
    v_exp_f32 v25, v25
    v_exp_f32 v26, v26
    v_exp_f32 v27, v27
    v_add_f32 v24, 1.0, v24
    v_add_f32 v25, 1.0, v25
    v_add_f32 v26, 1.0, v26
    v_add_f32 v27, 1.0, v27
    v_rcp_f32 v24, v24
    v_rcp_f32 v25, v25
    v_rcp_f32 v26, v26
    v_rcp_f32 v27, v27
    v_mul_f32 v24, v20, v24
    v_mul_f32 v25, v21, v25
    v_mul_f32 v26, v22, v26
    v_mul_f32 v27, v23, v27
    v_cvt_pk_bf16_f32 v42, v24, v25
    v_cvt_pk_bf16_f32 v43, v26, v27
    v_lshlrev_b32 v20, 16, v44
    v_and_b32 v21, 0xffff0000, v44
    v_lshlrev_b32 v22, 16, v45
    v_and_b32 v23, 0xffff0000, v45
    v_mul_f32 v24, s34, v20
    v_mul_f32 v25, s34, v21
    v_mul_f32 v26, s34, v22
    v_mul_f32 v27, s34, v23
    v_exp_f32 v24, v24
    v_exp_f32 v25, v25
    v_exp_f32 v26, v26
    v_exp_f32 v27, v27
    v_add_f32 v24, 1.0, v24
    v_add_f32 v25, 1.0, v25
    v_add_f32 v26, 1.0, v26
    v_add_f32 v27, 1.0, v27
    v_rcp_f32 v24, v24
    v_rcp_f32 v25, v25
    v_rcp_f32 v26, v26
    v_rcp_f32 v27, v27
    v_mul_f32 v24, v20, v24
    v_mul_f32 v25, v21, v25
    v_mul_f32 v26, v22, v26
    v_mul_f32 v27, v23, v27
    v_cvt_pk_bf16_f32 v44, v24, v25
    v_cvt_pk_bf16_f32 v45, v26, v27
    v_lshlrev_b32 v20, 16, v46
    v_and_b32 v21, 0xffff0000, v46
    v_lshlrev_b32 v22, 16, v47
    v_and_b32 v23, 0xffff0000, v47
    v_mul_f32 v24, s34, v20
    v_mul_f32 v25, s34, v21
    v_mul_f32 v26, s34, v22
    v_mul_f32 v27, s34, v23
    v_exp_f32 v24, v24
    v_exp_f32 v25, v25
    v_exp_f32 v26, v26
    v_exp_f32 v27, v27
    v_add_f32 v24, 1.0, v24
    v_add_f32 v25, 1.0, v25
    v_add_f32 v26, 1.0, v26
    v_add_f32 v27, 1.0, v27
    v_rcp_f32 v24, v24
    v_rcp_f32 v25, v25
    v_rcp_f32 v26, v26
    v_rcp_f32 v27, v27
    v_mul_f32 v24, v20, v24
    v_mul_f32 v25, v21, v25
    v_mul_f32 v26, v22, v26
    v_mul_f32 v27, v23, v27
    v_cvt_pk_bf16_f32 v46, v24, v25
    v_cvt_pk_bf16_f32 v47, v26, v27
    v_lshlrev_b32 v20, 16, v48
    v_and_b32 v21, 0xffff0000, v48
    v_lshlrev_b32 v22, 16, v49
    v_and_b32 v23, 0xffff0000, v49
    v_mul_f32 v24, s34, v20
    v_mul_f32 v25, s34, v21
    v_mul_f32 v26, s34, v22
    v_mul_f32 v27, s34, v23
    v_exp_f32 v24, v24
    v_exp_f32 v25, v25
    v_exp_f32 v26, v26
    v_exp_f32 v27, v27
    v_add_f32 v24, 1.0, v24
    v_add_f32 v25, 1.0, v25
    v_add_f32 v26, 1.0, v26
    v_add_f32 v27, 1.0, v27
    v_rcp_f32 v24, v24
    v_rcp_f32 v25, v25
    v_rcp_f32 v26, v26
    v_rcp_f32 v27, v27
    v_mul_f32 v24, v20, v24
    v_mul_f32 v25, v21, v25
    v_mul_f32 v26, v22, v26
    v_mul_f32 v27, v23, v27
    v_cvt_pk_bf16_f32 v48, v24, v25
    v_cvt_pk_bf16_f32 v49, v26, v27
    v_lshlrev_b32 v20, 16, v50
    v_and_b32 v21, 0xffff0000, v50
    v_lshlrev_b32 v22, 16, v51
    v_and_b32 v23, 0xffff0000, v51
    v_mul_f32 v24, s34, v20
    v_mul_f32 v25, s34, v21
    v_mul_f32 v26, s34, v22
    v_mul_f32 v27, s34, v23
    v_exp_f32 v24, v24
    v_exp_f32 v25, v25
    v_exp_f32 v26, v26
    v_exp_f32 v27, v27
    v_add_f32 v24, 1.0, v24
    v_add_f32 v25, 1.0, v25
    v_add_f32 v26, 1.0, v26
    v_add_f32 v27, 1.0, v27
    v_rcp_f32 v24, v24
    v_rcp_f32 v25, v25
    v_rcp_f32 v26, v26
    v_rcp_f32 v27, v27
    v_mul_f32 v24, v20, v24
    v_mul_f32 v25, v21, v25
    v_mul_f32 v26, v22, v26
    v_mul_f32 v27, v23, v27
    v_cvt_pk_bf16_f32 v50, v24, v25
    v_cvt_pk_bf16_f32 v51, v26, v27
    s_cmp_ge_u32 s52, 10
    s_cbranch_scc1 L_nostats
    v_mov_b32 v20, 0
    v_mov_b32 v21, 0
    v_mov_b32 v22, 0x3f803f80
    v_dot2c_f32_bf16 v20, v52, v22
    v_dot2c_f32_bf16 v21, v52, v52
    v_dot2c_f32_bf16 v20, v53, v22
    v_dot2c_f32_bf16 v21, v53, v53
    v_dot2c_f32_bf16 v20, v54, v22
    v_dot2c_f32_bf16 v21, v54, v54
    v_dot2c_f32_bf16 v20, v55, v22
    v_dot2c_f32_bf16 v21, v55, v55
    v_dot2c_f32_bf16 v20, v56, v22
    v_dot2c_f32_bf16 v21, v56, v56
    v_dot2c_f32_bf16 v20, v57, v22
    v_dot2c_f32_bf16 v21, v57, v57
    v_dot2c_f32_bf16 v20, v58, v22
    v_dot2c_f32_bf16 v21, v58, v58
    v_dot2c_f32_bf16 v20, v59, v22
    v_dot2c_f32_bf16 v21, v59, v59
    v_dot2c_f32_bf16 v20, v60, v22
    v_dot2c_f32_bf16 v21, v60, v60
    v_dot2c_f32_bf16 v20, v61, v22
    v_dot2c_f32_bf16 v21, v61, v61
    v_dot2c_f32_bf16 v20, v62, v22
    v_dot2c_f32_bf16 v21, v62, v62
    v_dot2c_f32_bf16 v20, v63, v22
    v_dot2c_f32_bf16 v21, v63, v63
    v_dot2c_f32_bf16 v20, v64, v22
    v_dot2c_f32_bf16 v21, v64, v64
    v_dot2c_f32_bf16 v20, v65, v22
    v_dot2c_f32_bf16 v21, v65, v65
    v_dot2c_f32_bf16 v20, v66, v22
    v_dot2c_f32_bf16 v21, v66, v66
    v_dot2c_f32_bf16 v20, v67, v22
    v_dot2c_f32_bf16 v21, v67, v67
    v_dot2c_f32_bf16 v20, v68, v22
    v_dot2c_f32_bf16 v21, v68, v68
    v_dot2c_f32_bf16 v20, v69, v22
    v_dot2c_f32_bf16 v21, v69, v69
    v_dot2c_f32_bf16 v20, v70, v22
    v_dot2c_f32_bf16 v21, v70, v70
    v_dot2c_f32_bf16 v20, v71, v22
    v_dot2c_f32_bf16 v21, v71, v71
    s_nop 1
    v_add_f32_dpp v20, v20, v20 row_ror:4 row_mask:0xf bank_mask:0xf
    v_add_f32_dpp v21, v21, v21 row_ror:4 row_mask:0xf bank_mask:0xf
    s_nop 0
    v_add_f32_dpp v20, v20, v20 row_ror:8 row_mask:0xf bank_mask:0xf
    v_add_f32_dpp v21, v21, v21 row_ror:8 row_mask:0xf bank_mask:0xf
    v_mov_b32 v22, v20
    v_mov_b32 v23, v21
    s_nop 0
    v_permlane16_swap_b32 v20, v22
    v_permlane16_swap_b32 v21, v23
    v_add_f32 v20, v20, v22
    v_add_f32 v21, v21, v23
    v_mov_b32 v22, v20
    v_mov_b32 v23, v21
    s_nop 0
    v_permlane32_swap_b32 v20, v22
    v_permlane32_swap_b32 v21, v23
    v_add_f32 v20, v20, v22
    v_add_f32 v21, v21, v23
    v_mul_f32 v22, 0x3acccccd, v20
    v_mul_f32 v21, 0x3acccccd, v21
    v_fma_f32 v21, -v22, v22, v21
    v_max_f32 v21, 0, v21
    v_add_f32 v21, 0x3727c5ac, v21
    v_rsq_f32 v20, v21
    s_nop 0
    v_mul_f32_e64 v21, -v22, v20
    v_lshlrev_b32 v24, 16, v72
    v_and_b32 v25, 0xffff0000, v72
    v_lshlrev_b32 v26, 16, v73
    v_and_b32 v27, 0xffff0000, v73
    v_fma_f32 v24, v24, v20, v21
    v_fma_f32 v25, v25, v20, v21
    v_fma_f32 v26, v26, v20, v21
    v_fma_f32 v27, v27, v20, v21
L_nostats:
    s_waitcnt vmcnt(21)
    ds_read_b64_tr_b16 v[96:97], v15 offset:0
    ds_read_b64_tr_b16 v[98:99], v15 offset:512
    ds_read_b64_tr_b16 v[100:101], v15 offset:32
    ds_read_b64_tr_b16 v[102:103], v15 offset:544
    ds_read_b64_tr_b16 v[104:105], v15 offset:64
    ds_read_b64_tr_b16 v[106:107], v15 offset:576
    ds_read_b64_tr_b16 v[108:109], v15 offset:96
    ds_read_b64_tr_b16 v[110:111], v15 offset:608
    s_waitcnt lgkmcnt(7)
    ds_read_b64_tr_b16 v[112:113], v15 offset:4096
    ds_read_b64_tr_b16 v[114:115], v15 offset:4608
    ds_read_b64_tr_b16 v[116:117], v15 offset:4128
    ds_read_b64_tr_b16 v[118:119], v15 offset:4640
    ds_read_b64_tr_b16 v[120:121], v15 offset:4160
    ds_read_b64_tr_b16 v[122:123], v15 offset:4672
    ds_read_b64_tr_b16 v[124:125], v15 offset:4192
    ds_read_b64_tr_b16 v[126:127], v15 offset:4704
    s_waitcnt lgkmcnt(7)
    ds_read_b64_tr_b16 v[128:129], v15 offset:8192
    ds_read_b64_tr_b16 v[130:131], v15 offset:8704
    ds_read_b64_tr_b16 v[132:133], v15 offset:8224
    ds_read_b64_tr_b16 v[134:135], v15 offset:8736
    ds_read_b64_tr_b16 v[136:137], v15 offset:8256
    ds_read_b64_tr_b16 v[138:139], v15 offset:8768
    ds_read_b64_tr_b16 v[140:141], v15 offset:8288
    ds_read_b64_tr_b16 v[142:143], v15 offset:8800
    s_waitcnt lgkmcnt(7)
    ds_read_b64_tr_b16 v[144:145], v15 offset:12288
    ds_read_b64_tr_b16 v[146:147], v15 offset:12800
    ds_read_b64_tr_b16 v[148:149], v15 offset:12320
    ds_read_b64_tr_b16 v[150:151], v15 offset:12832
    ds_read_b64_tr_b16 v[152:153], v15 offset:12352
    ds_read_b64_tr_b16 v[154:155], v15 offset:12864
    ds_read_b64_tr_b16 v[156:157], v15 offset:12384
    ds_read_b64_tr_b16 v[158:159], v15 offset:12896
    s_waitcnt lgkmcnt(7)
    ds_read_b64_tr_b16 v[160:161], v15 offset:16384
    ds_read_b64_tr_b16 v[162:163], v15 offset:16896
    ds_read_b64_tr_b16 v[164:165], v15 offset:16416
    ds_read_b64_tr_b16 v[166:167], v15 offset:16928
    ds_read_b64_tr_b16 v[168:169], v15 offset:16448
    ds_read_b64_tr_b16 v[170:171], v15 offset:16960
    ds_read_b64_tr_b16 v[172:173], v15 offset:16480
    ds_read_b64_tr_b16 v[174:175], v15 offset:16992
    s_waitcnt lgkmcnt(0)
    v_mfma_f32_16x16x32_bf16 v[80:83], v[96:99], v[32:35], 0
    v_mfma_f32_16x16x32_bf16 v[84:87], v[100:103], v[32:35], 0
    v_mfma_f32_16x16x32_bf16 v[88:91], v[104:107], v[32:35], 0
    v_mfma_f32_16x16x32_bf16 v[92:95], v[108:111], v[32:35], 0
    v_mfma_f32_16x16x32_bf16 v[80:83], v[112:115], v[36:39], v[80:83]
    v_mfma_f32_16x16x32_bf16 v[84:87], v[116:119], v[36:39], v[84:87]
    v_mfma_f32_16x16x32_bf16 v[88:91], v[120:123], v[36:39], v[88:91]
    v_mfma_f32_16x16x32_bf16 v[92:95], v[124:127], v[36:39], v[92:95]
    v_mfma_f32_16x16x32_bf16 v[80:83], v[128:131], v[40:43], v[80:83]
    v_mfma_f32_16x16x32_bf16 v[84:87], v[132:135], v[40:43], v[84:87]
    v_mfma_f32_16x16x32_bf16 v[88:91], v[136:139], v[40:43], v[88:91]
    v_mfma_f32_16x16x32_bf16 v[92:95], v[140:143], v[40:43], v[92:95]
    v_mfma_f32_16x16x32_bf16 v[80:83], v[144:147], v[44:47], v[80:83]
    v_mfma_f32_16x16x32_bf16 v[84:87], v[148:151], v[44:47], v[84:87]
    v_mfma_f32_16x16x32_bf16 v[88:91], v[152:155], v[44:47], v[88:91]
    v_mfma_f32_16x16x32_bf16 v[92:95], v[156:159], v[44:47], v[92:95]
    v_mfma_f32_16x16x32_bf16 v[80:83], v[160:163], v[48:51], v[80:83]
    v_mfma_f32_16x16x32_bf16 v[84:87], v[164:167], v[48:51], v[84:87]
    v_mfma_f32_16x16x32_bf16 v[88:91], v[168:171], v[48:51], v[88:91]
    v_mfma_f32_16x16x32_bf16 v[92:95], v[172:175], v[48:51], v[92:95]
    s_cmp_ge_u32 s50, 20
    s_cbranch_scc1 L_adr_rest
    s_cmp_lt_u32 s50, 10
    s_cselect_b32 s34, 20480, 0
    s_cselect_b32 s35, s50, s52
    s_lshl_b32 s35, s35, 9
    s_add_u32 s34, s34, s35
    s_mul_i32 s35, s51, 5120
    s_add_u32 s34, s34, s35
    v_lshrrev_b32 v19, 1, v14
    v_lshl_add_u32 v19, v13, 1, v19
    v_lshlrev_b32 v19, 6, v19
    v_lshl_add_u32 v19, v12, 4, v19
    v_and_b32 v20, 1, v14
    v_lshl_add_u32 v19, v20, 3, v19
    s_branch L_adr_done
L_adr_rest:
    s_mul_i32 s34, s51, 20480
    s_lshl_b32 s35, s50, 7
    s_add_u32 s34, s34, s35
    s_add_u32 s34, s34, 38400
    v_mul_u32_u24 v19, 5120, v12
    v_lshl_add_u32 v19, v13, 5, v19
    v_lshl_add_u32 v19, v14, 3, v19
    s_nop 3
L_adr_done:
    v_add_u32 v19, s34, v19
    v_mov_b32_dpp v80, v84 quad_perm:[0,1,2,3] row_mask:0xf bank_mask:0x2
    v_mov_b32_dpp v81, v85 quad_perm:[0,1,2,3] row_mask:0xf bank_mask:0x2
    v_mov_b32_dpp v82, v86 quad_perm:[0,1,2,3] row_mask:0xf bank_mask:0x2
    v_mov_b32_dpp v83, v87 quad_perm:[0,1,2,3] row_mask:0xf bank_mask:0x2
    v_mov_b32_dpp v80, v88 quad_perm:[0,1,2,3] row_mask:0xf bank_mask:0x4
    v_mov_b32_dpp v81, v89 quad_perm:[0,1,2,3] row_mask:0xf bank_mask:0x4
    v_mov_b32_dpp v82, v90 quad_perm:[0,1,2,3] row_mask:0xf bank_mask:0x4
    v_mov_b32_dpp v83, v91 quad_perm:[0,1,2,3] row_mask:0xf bank_mask:0x4
    v_mov_b32_dpp v80, v92 quad_perm:[0,1,2,3] row_mask:0xf bank_mask:0x8
    v_mov_b32_dpp v81, v93 quad_perm:[0,1,2,3] row_mask:0xf bank_mask:0x8
    v_mov_b32_dpp v82, v94 quad_perm:[0,1,2,3] row_mask:0xf bank_mask:0x8
    v_mov_b32_dpp v83, v95 quad_perm:[0,1,2,3] row_mask:0xf bank_mask:0x8
    s_cmp_ge_u32 s52, 10
    s_cbranch_scc1 L_noz
    v_add_f32 v80, 0x3e800000, v80
    v_add_f32 v81, 0x3e800000, v81
    v_add_f32 v82, 0x3e800000, v82
    v_add_f32 v83, 0x3e800000, v83
    v_mul_f32 v80, v80, v24
    v_mul_f32 v81, v81, v25
    v_mul_f32 v82, v82, v26
    v_mul_f32 v83, v83, v27
L_noz:
    v_cvt_pk_bf16_f32 v20, v80, v81
    v_cvt_pk_bf16_f32 v21, v82, v83
    v_min_u32 v20, -2, v20
    v_min_u32 v21, -2, v21
    v_and_b32 v22, 15, v0
    v_lshlrev_b32 v22, 2, v22
    s_mov_b32 s35, 0
L_poll4:
    global_load_dword v23, v22, s[30:31] offset:128 sc1
    s_add_u32 s35, s35, 1
    s_waitcnt vmcnt(0)
    v_cmp_ne_u32 vcc, 1, v23
    s_cbranch_vccz L_done5
    s_sleep 1
    s_cmp_lt_u32 s35, 60000
    s_cbranch_scc1 L_poll4
L_done5:
    buffer_store_dwordx2 v[20:21], v19, s[44:47], 0 offen sc1
    s_branch L_p2
L_clear:
    s_sub_u32 s55, s2, 240
    s_lshl_b32 s34, s55, 15
    v_lshl_add_u32 v19, v0, 4, s34
    v_mov_b32 v20, -1
    v_mov_b32 v21, -1
    v_mov_b32 v22, -1
    v_mov_b32 v23, -1
    s_mov_b32 s34, 0
L_clrloop:
    buffer_store_dwordx4 v[20:23], v19, s[44:47], s34 offen offset:0 sc1
    buffer_store_dwordx4 v[20:23], v19, s[44:47], s34 offen offset:1024 sc1
    buffer_store_dwordx4 v[20:23], v19, s[44:47], s34 offen offset:2048 sc1
    buffer_store_dwordx4 v[20:23], v19, s[44:47], s34 offen offset:3072 sc1
    s_add_u32 s34, s34, 4096
    s_cmp_lt_u32 s34, 32768
    s_cbranch_scc1 L_clrloop
    v_lshlrev_b32 v1, 2, v0
    v_add_u32 v1, 98304, v1
    v_mov_b32 v2, -1
    v_mov_b32 v3, 0
    v_cmp_eq_u32 vcc, 14, v0
    v_mov_b32 v5, 0xfe967699
    s_nop 0
    v_cndmask_b32 v4, v2, v5, vcc
    v_cmp_eq_u32 vcc, 15, v0
    s_nop 1
    v_cndmask_b32 v4, v4, v3, vcc
    ds_write_b32 v1, v2
    ds_write_b32 v1, v4 offset:256
    ds_write_b32 v1, v3 offset:512
    s_waitcnt lgkmcnt(0)
    s_barrier
    s_lshl_b32 s34, s55, 2
    v_mov_b32 v24, s34
    v_mov_b32 v25, 1
    s_waitcnt vmcnt(0)
    s_mov_b64 exec, 1
    global_store_dword v24, v25, s[30:31] offset:128 sc1
    s_mov_b64 exec, -1
    s_getpc_b64 s[56:57]
L_pc7:
    s_sub_u32 s56, s56, L_pc7-adaLN_cond__sliding_block_cached__dense_activation_gelu__decode_kernel
    s_subb_u32 s57, s57, 0
    s_lshl_b32 s34, s61, 10
    v_lshl_add_u32 v9, v0, 4, s34
    v_min_u32 v9, L_codeend-adaLN_cond__sliding_block_cached__dense_activation_gelu__decode_kernel-16, v9
    global_load_dwordx4 v[76:79], v9, s[56:57]
    s_and_b32 s34, s2, 31
    s_lshl_b32 s34, s34, 8
    s_lshr_b32 s35, s2, 7
    s_lshl_b32 s35, s35, 7
    s_add_u32 s49, s34, s35
    s_bfe_u32 s53, s2, 0x20005
    s_mul_i32 s34, s53, 1310720
    s_add_u32 s34, s34, s49
    v_lshl_add_u32 v16, v10, 13, v11
    v_add_u32 v16, s34, v16
    s_mov_b32 s36, s10
    s_mov_b32 s37, s11
    s_mov_b32 s38, 5242880
    s_mov_b32 m0, 20480
    s_mov_b32 s34, 0
L_dma8:
    buffer_load_dwordx4 v16, s[36:39], s34 offen  lds
    s_add_u32 m0, m0, 1024
    s_add_u32 s34, s34, 65536
    buffer_load_dwordx4 v16, s[36:39], s34 offen  lds
    s_add_u32 m0, m0, 1024
    s_add_u32 s34, s34, 65536
    buffer_load_dwordx4 v16, s[36:39], s34 offen  lds
    s_add_u32 m0, m0, 1024
    s_add_u32 s34, s34, 65536
    buffer_load_dwordx4 v16, s[36:39], s34 offen  lds
    s_add_u32 m0, m0, 1024
    s_add_u32 s34, s34, 65536
    s_cmp_lt_u32 s34, 1310720
    s_cbranch_scc1 L_dma8
    v_lshl_add_u32 v15, v14, 3, v13
    v_lshlrev_b32 v15, 7, v15
    v_lshl_add_u32 v15, v12, 3, v15
    v_and_b32 v22, 15, v0
    v_lshlrev_b32 v22, 2, v22
    s_mov_b32 s35, 0
L_poll9:
    global_load_dword v23, v22, s[30:31] offset:128 sc1
    s_add_u32 s35, s35, 1
    s_waitcnt vmcnt(0)
    v_cmp_ne_u32 vcc, 1, v23
    s_cbranch_vccz L_done10
    s_sleep 1
    s_cmp_lt_u32 s35, 60000
    s_cbranch_scc1 L_poll9
L_done10:
L_p2:
    ds_read_b64_tr_b16 v[96:97], v15 offset:20480
    ds_read_b64_tr_b16 v[98:99], v15 offset:20992
    ds_read_b64_tr_b16 v[100:101], v15 offset:20512
    ds_read_b64_tr_b16 v[102:103], v15 offset:21024
    ds_read_b64_tr_b16 v[104:105], v15 offset:20544
    ds_read_b64_tr_b16 v[106:107], v15 offset:21056
    ds_read_b64_tr_b16 v[108:109], v15 offset:20576
    ds_read_b64_tr_b16 v[110:111], v15 offset:21088
    s_waitcnt lgkmcnt(7)
    ds_read_b64_tr_b16 v[112:113], v15 offset:24576
    ds_read_b64_tr_b16 v[114:115], v15 offset:25088
    ds_read_b64_tr_b16 v[116:117], v15 offset:24608
    ds_read_b64_tr_b16 v[118:119], v15 offset:25120
    ds_read_b64_tr_b16 v[120:121], v15 offset:24640
    ds_read_b64_tr_b16 v[122:123], v15 offset:25152
    ds_read_b64_tr_b16 v[124:125], v15 offset:24672
    ds_read_b64_tr_b16 v[126:127], v15 offset:25184
    s_waitcnt lgkmcnt(7)
    ds_read_b64_tr_b16 v[128:129], v15 offset:28672
    ds_read_b64_tr_b16 v[130:131], v15 offset:29184
    ds_read_b64_tr_b16 v[132:133], v15 offset:28704
    ds_read_b64_tr_b16 v[134:135], v15 offset:29216
    ds_read_b64_tr_b16 v[136:137], v15 offset:28736
    ds_read_b64_tr_b16 v[138:139], v15 offset:29248
    ds_read_b64_tr_b16 v[140:141], v15 offset:28768
    ds_read_b64_tr_b16 v[142:143], v15 offset:29280
    s_waitcnt lgkmcnt(7)
    ds_read_b64_tr_b16 v[144:145], v15 offset:32768
    ds_read_b64_tr_b16 v[146:147], v15 offset:33280
    ds_read_b64_tr_b16 v[148:149], v15 offset:32800
    ds_read_b64_tr_b16 v[150:151], v15 offset:33312
    ds_read_b64_tr_b16 v[152:153], v15 offset:32832
    ds_read_b64_tr_b16 v[154:155], v15 offset:33344
    ds_read_b64_tr_b16 v[156:157], v15 offset:32864
    ds_read_b64_tr_b16 v[158:159], v15 offset:33376
    s_waitcnt lgkmcnt(7)
    ds_read_b64_tr_b16 v[160:161], v15 offset:36864
    ds_read_b64_tr_b16 v[162:163], v15 offset:37376
    ds_read_b64_tr_b16 v[164:165], v15 offset:36896
    ds_read_b64_tr_b16 v[166:167], v15 offset:37408
    ds_read_b64_tr_b16 v[168:169], v15 offset:36928
    ds_read_b64_tr_b16 v[170:171], v15 offset:37440
    ds_read_b64_tr_b16 v[172:173], v15 offset:36960
    ds_read_b64_tr_b16 v[174:175], v15 offset:37472
    s_waitcnt lgkmcnt(0)
    s_mul_i32 s34, s53, 1280
    v_mul_u32_u24 v19, 5120, v13
    v_lshl_add_u32 v19, v14, 6, v19
    v_lshl_add_u32 v19, v12, 4, v19
    v_add_u32 v19, s34, v19
    s_movk_i32 s48, 20480
    s_mov_b32 s35, 0
L_poll12:
    buffer_load_dwordx4 v[32:35], v19, s[44:47], 0 offen offset:0 sc1
    buffer_load_dwordx4 v[36:39], v19, s[44:47], s48 offen offset:0 sc1
    buffer_load_dwordx4 v[40:43], v19, s[44:47], 0 offen offset:256 sc1
    buffer_load_dwordx4 v[44:47], v19, s[44:47], s48 offen offset:256 sc1
    buffer_load_dwordx4 v[48:51], v19, s[44:47], 0 offen offset:512 sc1
    buffer_load_dwordx4 v[52:55], v19, s[44:47], s48 offen offset:512 sc1
    buffer_load_dwordx4 v[56:59], v19, s[44:47], 0 offen offset:768 sc1
    buffer_load_dwordx4 v[60:63], v19, s[44:47], s48 offen offset:768 sc1
    buffer_load_dwordx4 v[64:67], v19, s[44:47], 0 offen offset:1024 sc1
    buffer_load_dwordx4 v[68:71], v19, s[44:47], s48 offen offset:1024 sc1
    s_add_u32 s35, s35, 1
    s_waitcnt vmcnt(0)
    v_max3_u32 v20, v32, v33, v34
    v_max3_u32 v20, v20, v35, v36
    v_max3_u32 v20, v20, v37, v38
    v_max3_u32 v20, v20, v39, v40
    v_max3_u32 v20, v20, v41, v42
    v_max3_u32 v20, v20, v43, v44
    v_max3_u32 v20, v20, v45, v46
    v_max3_u32 v20, v20, v47, v48
    v_max3_u32 v20, v20, v49, v50
    v_max3_u32 v20, v20, v51, v52
    v_max3_u32 v20, v20, v53, v54
    v_max3_u32 v20, v20, v55, v56
    v_max3_u32 v20, v20, v57, v58
    v_max3_u32 v20, v20, v59, v60
    v_max3_u32 v20, v20, v61, v62
    v_max3_u32 v20, v20, v63, v64
    v_max3_u32 v20, v20, v65, v66
    v_max3_u32 v20, v20, v67, v68
    v_max3_u32 v20, v20, v69, v70
    v_max_u32 v20, v20, v71
    v_cmp_eq_u32 vcc, -1, v20
    s_cbranch_vccz L_done13
    s_sleep 4
    s_cmp_lt_u32 s35, 60000
    s_cbranch_scc1 L_poll12
L_done13:
    v_mfma_f32_16x16x32_bf16 v[80:83], v[96:99], v[32:35], 0
    v_mfma_f32_16x16x32_bf16 v[84:87], v[100:103], v[32:35], 0
    v_mfma_f32_16x16x32_bf16 v[88:91], v[104:107], v[32:35], 0
    v_mfma_f32_16x16x32_bf16 v[92:95], v[108:111], v[32:35], 0
    v_mfma_f32_16x16x32_bf16 v[80:83], v[96:99], v[36:39], v[80:83]
    v_mfma_f32_16x16x32_bf16 v[84:87], v[100:103], v[36:39], v[84:87]
    v_mfma_f32_16x16x32_bf16 v[88:91], v[104:107], v[36:39], v[88:91]
    v_mfma_f32_16x16x32_bf16 v[92:95], v[108:111], v[36:39], v[92:95]
    v_mfma_f32_16x16x32_bf16 v[80:83], v[112:115], v[40:43], v[80:83]
    v_mfma_f32_16x16x32_bf16 v[84:87], v[116:119], v[40:43], v[84:87]
    v_mfma_f32_16x16x32_bf16 v[88:91], v[120:123], v[40:43], v[88:91]
    v_mfma_f32_16x16x32_bf16 v[92:95], v[124:127], v[40:43], v[92:95]
    v_mfma_f32_16x16x32_bf16 v[80:83], v[112:115], v[44:47], v[80:83]
    v_mfma_f32_16x16x32_bf16 v[84:87], v[116:119], v[44:47], v[84:87]
    v_mfma_f32_16x16x32_bf16 v[88:91], v[120:123], v[44:47], v[88:91]
    v_mfma_f32_16x16x32_bf16 v[92:95], v[124:127], v[44:47], v[92:95]
    v_mfma_f32_16x16x32_bf16 v[80:83], v[128:131], v[48:51], v[80:83]
    v_mfma_f32_16x16x32_bf16 v[84:87], v[132:135], v[48:51], v[84:87]
    v_mfma_f32_16x16x32_bf16 v[88:91], v[136:139], v[48:51], v[88:91]
    v_mfma_f32_16x16x32_bf16 v[92:95], v[140:143], v[48:51], v[92:95]
    v_mfma_f32_16x16x32_bf16 v[80:83], v[128:131], v[52:55], v[80:83]
    v_mfma_f32_16x16x32_bf16 v[84:87], v[132:135], v[52:55], v[84:87]
    v_mfma_f32_16x16x32_bf16 v[88:91], v[136:139], v[52:55], v[88:91]
    v_mfma_f32_16x16x32_bf16 v[92:95], v[140:143], v[52:55], v[92:95]
    v_mfma_f32_16x16x32_bf16 v[80:83], v[144:147], v[56:59], v[80:83]
    v_mfma_f32_16x16x32_bf16 v[84:87], v[148:151], v[56:59], v[84:87]
    v_mfma_f32_16x16x32_bf16 v[88:91], v[152:155], v[56:59], v[88:91]
    v_mfma_f32_16x16x32_bf16 v[92:95], v[156:159], v[56:59], v[92:95]
    v_mfma_f32_16x16x32_bf16 v[80:83], v[144:147], v[60:63], v[80:83]
    v_mfma_f32_16x16x32_bf16 v[84:87], v[148:151], v[60:63], v[84:87]
    v_mfma_f32_16x16x32_bf16 v[88:91], v[152:155], v[60:63], v[88:91]
    v_mfma_f32_16x16x32_bf16 v[92:95], v[156:159], v[60:63], v[92:95]
    v_mfma_f32_16x16x32_bf16 v[80:83], v[160:163], v[64:67], v[80:83]
    v_mfma_f32_16x16x32_bf16 v[84:87], v[164:167], v[64:67], v[84:87]
    v_mfma_f32_16x16x32_bf16 v[88:91], v[168:171], v[64:67], v[88:91]
    v_mfma_f32_16x16x32_bf16 v[92:95], v[172:175], v[64:67], v[92:95]
    v_mfma_f32_16x16x32_bf16 v[80:83], v[160:163], v[68:71], v[80:83]
    v_mfma_f32_16x16x32_bf16 v[84:87], v[164:167], v[68:71], v[84:87]
    v_mfma_f32_16x16x32_bf16 v[88:91], v[168:171], v[68:71], v[88:91]
    v_mfma_f32_16x16x32_bf16 v[92:95], v[172:175], v[68:71], v[92:95]
    s_lshl_b32 s34, s53, 16
    s_lshl_b32 s35, s49, 1
    s_add_u32 s34, s34, s35
    s_add_u32 s34, s34, 262144
    v_lshlrev_b32 v19, 14, v12
    v_lshl_add_u32 v19, v13, 6, v19
    v_lshl_add_u32 v19, v14, 4, v19
    v_add_u32 v19, s34, v19
    v_add_f32_dpp v20, v80, v80 row_ror:8 row_mask:0xf bank_mask:0x3
    v_add_f32_dpp v24, v84, v84 row_ror:8 row_mask:0xf bank_mask:0x3
    v_add_f32_dpp v21, v81, v81 row_ror:8 row_mask:0xf bank_mask:0x3
    v_add_f32_dpp v25, v85, v85 row_ror:8 row_mask:0xf bank_mask:0x3
    v_add_f32_dpp v22, v82, v82 row_ror:8 row_mask:0xf bank_mask:0x3
    v_add_f32_dpp v26, v86, v86 row_ror:8 row_mask:0xf bank_mask:0x3
    v_add_f32_dpp v23, v83, v83 row_ror:8 row_mask:0xf bank_mask:0x3
    v_add_f32_dpp v27, v87, v87 row_ror:8 row_mask:0xf bank_mask:0x3
    v_add_f32_dpp v20, v88, v88 row_ror:8 row_mask:0xf bank_mask:0xc
    v_add_f32_dpp v24, v92, v92 row_ror:8 row_mask:0xf bank_mask:0xc
    v_add_f32_dpp v21, v89, v89 row_ror:8 row_mask:0xf bank_mask:0xc
    v_add_f32_dpp v25, v93, v93 row_ror:8 row_mask:0xf bank_mask:0xc
    v_add_f32_dpp v22, v90, v90 row_ror:8 row_mask:0xf bank_mask:0xc
    v_add_f32_dpp v26, v94, v94 row_ror:8 row_mask:0xf bank_mask:0xc
    v_add_f32_dpp v23, v91, v91 row_ror:8 row_mask:0xf bank_mask:0xc
    v_add_f32_dpp v27, v95, v95 row_ror:8 row_mask:0xf bank_mask:0xc
    v_add_f32_dpp v28, v20, v20 row_shl:4 row_mask:0xf bank_mask:0x5
    v_add_f32_dpp v29, v21, v21 row_shl:4 row_mask:0xf bank_mask:0x5
    v_add_f32_dpp v30, v22, v22 row_shl:4 row_mask:0xf bank_mask:0x5
    v_add_f32_dpp v31, v23, v23 row_shl:4 row_mask:0xf bank_mask:0x5
    v_add_f32_dpp v28, v24, v24 row_shr:4 row_mask:0xf bank_mask:0xa
    v_add_f32_dpp v29, v25, v25 row_shr:4 row_mask:0xf bank_mask:0xa
    v_add_f32_dpp v30, v26, v26 row_shr:4 row_mask:0xf bank_mask:0xa
    v_add_f32_dpp v31, v27, v27 row_shr:4 row_mask:0xf bank_mask:0xa
    v_min_u32 v28, -2, v28
    v_min_u32 v29, -2, v29
    v_min_u32 v30, -2, v30
    v_min_u32 v31, -2, v31
    buffer_store_dwordx4 v[28:31], v19, s[44:47], 0 offen sc1
    s_and_b32 s34, s2, 127
    s_lshl_b32 s34, s34, 9
    s_add_u32 s34, s34, 262144
    v_lshl_add_u32 v19, v0, 3, s34
    s_mov_b32 s50, 0x10000
    s_mov_b32 s51, 0x20000
    s_mov_b32 s52, 0x30000
    s_mov_b32 s35, 0
L_poll15:
    buffer_load_dwordx2 v[32:33], v19, s[44:47], 0 offen sc1
    buffer_load_dwordx2 v[34:35], v19, s[44:47], s50 offen sc1
    buffer_load_dwordx2 v[36:37], v19, s[44:47], s51 offen sc1
    buffer_load_dwordx2 v[38:39], v19, s[44:47], s52 offen sc1
    s_add_u32 s35, s35, 1
    s_waitcnt vmcnt(0)
    v_max3_u32 v22, v32, v33, v34
    v_max3_u32 v22, v22, v35, v36
    v_max3_u32 v22, v22, v37, v38
    v_max_u32 v22, v22, v39
    v_cmp_eq_u32 vcc, -1, v22
    s_cbranch_vccz L_done16
    s_sleep 2
    s_cmp_lt_u32 s35, 60000
    s_cbranch_scc1 L_poll15
L_done16:
    v_pk_add_f32 v[32:33], v[32:33], v[34:35]
    v_pk_add_f32 v[36:37], v[36:37], v[38:39]
    v_pk_add_f32 v[32:33], v[32:33], v[36:37]
    v_cvt_pk_bf16_f32 v32, v32, v33
    v_min_u32 v32, -2, v32
    ds_write_b32 v1, v32
    s_getpc_b64 s[56:57]
L_pc18:
    s_sub_u32 s56, s56, L_pc18-adaLN_cond__sliding_block_cached__dense_activation_gelu__decode_kernel
    s_subb_u32 s57, s57, 0
    s_lshl_b32 s34, s61, 10
    v_lshl_add_u32 v9, v0, 4, s34
    v_min_u32 v9, L_codeend-adaLN_cond__sliding_block_cached__dense_activation_gelu__decode_kernel-16, v9
    global_load_dwordx4 v[76:79], v9, s[56:57]
    s_mov_b32 s50, 20480
    s_mov_b32 s51, 40960
    s_mov_b32 s52, 61440
    s_mov_b32 s62, s61
    s_cmp_lt_u32 s61, 20
    s_cbranch_scc1 L_d_wo
    s_lshl_b32 s62, s60, 2
    s_and_b32 s34, s61, 3
    s_add_u32 s62, s62, s34
    s_cmp_lt_u32 s61, 24
    s_cbranch_scc1 L_d_w2
    s_cmp_ge_u32 s60, 2
    s_cbranch_scc1 L_d_w1b
    s_cmp_ge_u32 s61, 28
    s_cbranch_scc1 L_d_w1
    s_add_u32 s62, s62, 32
    s_branch L_d_w2
L_d_w1b:
    s_lshl_b32 s62, s60, 3
    s_add_u32 s62, s62, s61
    s_sub_u32 s62, s62, 32
    s_cmp_ge_u32 s62, 54
    s_cbranch_scc1 L_d_none
L_d_w1:
    s_lshl_b32 s34, s62, 6
    v_lshlrev_b32 v5, 4, v14
    v_lshl_add_u32 v5, v12, 2, v5
    v_add_u32 v5, s34, v5
    global_load_dword v6, v5, s[18:19]
    s_waitcnt vmcnt(0)
    v_lshlrev_b32 v100, 16, v6
    v_and_b32 v101, 0xffff0000, v6
    s_branch L_d_none
L_d_w2:
    s_lshl_b32 s34, s62, 5
    v_lshl_add_u32 v3, v14, 3, s34
    global_load_dwordx2 v[20:21], v3, s[22:23]
    v_mul_u32_u24 v112, 1280, v12
    v_add_u32 v112, v112, v3
    global_load_dwordx2 v[22:23], v112, s[4:5]
    v_mul_u32_u24 v5, 5120, v12
    v_mul_u32_u24 v6, 20480, v13
    v_add3_u32 v5, v5, v3, v6
    v_add_u32 v5, 44800, v5
    s_mov_b32 s35, 0
L_poll19:
    buffer_load_dwordx2 v[24:25], v5, s[44:47], 0 offen sc1
    s_add_u32 s35, s35, 1
    s_waitcnt vmcnt(0)
    v_max_u32 v28, v24, v25
    v_cmp_eq_u32 vcc, -1, v28
    s_cbranch_vccz L_done20
    s_sleep 4
    s_cmp_lt_u32 s35, 60000
    s_cbranch_scc1 L_poll19
L_done20:
    v_lshlrev_b32 v104, 16, v24
    v_and_b32 v105, 0xffff0000, v24
    v_lshlrev_b32 v106, 16, v25
    v_and_b32 v107, 0xffff0000, v25
    v_lshlrev_b32 v32, 16, v20
    v_and_b32 v33, 0xffff0000, v20
    v_lshlrev_b32 v34, 16, v21
    v_and_b32 v35, 0xffff0000, v21
    v_lshlrev_b32 v108, 16, v22
    v_and_b32 v109, 0xffff0000, v22
    v_lshlrev_b32 v110, 16, v23
    v_and_b32 v111, 0xffff0000, v23
    v_add_f32_dpp v104, v104, v104 row_ror:4 row_mask:0xf bank_mask:0xf
    v_add_f32_dpp v105, v105, v105 row_ror:4 row_mask:0xf bank_mask:0xf
    v_add_f32_dpp v106, v106, v106 row_ror:4 row_mask:0xf bank_mask:0xf
    v_add_f32_dpp v107, v107, v107 row_ror:4 row_mask:0xf bank_mask:0xf
    v_add_f32_dpp v104, v104, v104 row_ror:8 row_mask:0xf bank_mask:0xf
    v_add_f32_dpp v105, v105, v105 row_ror:8 row_mask:0xf bank_mask:0xf
    v_add_f32_dpp v106, v106, v106 row_ror:8 row_mask:0xf bank_mask:0xf
    v_add_f32_dpp v107, v107, v107 row_ror:8 row_mask:0xf bank_mask:0xf
    v_fma_f32 v108, v104, v32, v108
    v_fma_f32 v109, v105, v33, v109
    v_fma_f32 v110, v106, v34, v110
    v_fma_f32 v111, v107, v35, v111
    v_mul_f32 v108, 0x3e800000, v108
    v_mul_f32 v109, 0x3e800000, v109
    v_mul_f32 v110, 0x3e800000, v110
    v_mul_f32 v111, 0x3e800000, v111
    s_branch L_d_none
L_d_wo:
    v_bfe_u32 v6, v0, 1, 2
    v_bfe_u32 v7, v0, 3, 1
    v_lshlrev_b32 v8, 5, v7
    v_lshl_add_u32 v8, v14, 3, v8
    s_lshl_b32 s35, s62, 6
    v_add_u32 v8, s35, v8
    v_mul_u32_u24 v9, 5120, v6
    v_add_u32 v9, v9, v8
    v_add_u32 v9, 40960, v9
    s_mul_i32 s34, s60, 5120
    s_add_u32 s34, s34, 192512
    v_mul_u32_u24 v112, 1280, v6
    v_add3_u32 v112, v112, v8, s34
    s_mov_b32 s35, 0
L_poll22:
    buffer_load_dwordx2 v[32:33], v9, s[44:47], 0 offen sc1
    buffer_load_dwordx2 v[34:35], v9, s[44:47], s50 offen sc1
    buffer_load_dwordx2 v[36:37], v9, s[44:47], s51 offen sc1
    buffer_load_dwordx2 v[38:39], v9, s[44:47], s52 offen sc1
    s_add_u32 s35, s35, 1
    s_waitcnt vmcnt(0)
    v_max3_u32 v22, v32, v33, v34
    v_max3_u32 v22, v22, v35, v36
    v_max3_u32 v22, v22, v37, v38
    v_max_u32 v22, v22, v39
    v_cmp_eq_u32 vcc, -1, v22
    s_cbranch_vccz L_done23
    s_sleep 4
    s_cmp_lt_u32 s35, 60000
    s_cbranch_scc1 L_poll22
L_done23:
    v_lshlrev_b32 v100, 16, v32
    v_and_b32 v101, 0xffff0000, v32
    v_lshlrev_b32 v102, 16, v33
    v_and_b32 v103, 0xffff0000, v33
    v_lshlrev_b32 v20, 16, v34
    v_and_b32 v21, 0xffff0000, v34
    v_lshlrev_b32 v22, 16, v35
    v_and_b32 v23, 0xffff0000, v35
    v_add_f32 v100, v100, v20
    v_add_f32 v101, v101, v21
    v_add_f32 v102, v102, v22
    v_add_f32 v103, v103, v23
    v_lshlrev_b32 v20, 16, v36
    v_and_b32 v21, 0xffff0000, v36
    v_lshlrev_b32 v22, 16, v37
    v_and_b32 v23, 0xffff0000, v37
    v_add_f32 v100, v100, v20
    v_add_f32 v101, v101, v21
    v_add_f32 v102, v102, v22
    v_add_f32 v103, v103, v23
    v_lshlrev_b32 v20, 16, v38
    v_and_b32 v21, 0xffff0000, v38
    v_lshlrev_b32 v22, 16, v39
    v_and_b32 v23, 0xffff0000, v39
    v_add_f32 v100, v100, v20
    v_add_f32 v101, v101, v21
    v_add_f32 v102, v102, v22
    v_add_f32 v103, v103, v23
L_d_none:
    v_and_b32 v19, 7, v0
    v_lshlrev_b32 v19, 3, v19
    v_add_u32 v19, 98560, v19
    s_mov_b32 s35, 0
L_poll25:
    ds_read_b64 v[20:21], v19
    s_add_u32 s35, s35, 1
    s_waitcnt lgkmcnt(0)
    v_max_u32 v22, v20, v21
    v_cmp_eq_u32 vcc, -1, v22
    s_cbranch_vccz L_done26
    s_sleep 2
    s_cmp_lt_u32 s35, 60000
    s_cbranch_scc1 L_poll25
L_done26:
    v_max_f32_dpp v22, v20, v20 row_half_mirror row_mask:0xf bank_mask:0xf
    s_nop 1
    v_max_f32_dpp v22, v22, v22 quad_perm:[1,0,3,2] row_mask:0xf bank_mask:0xf
    s_nop 1
    v_max_f32_dpp v22, v22, v22 quad_perm:[2,3,0,1] row_mask:0xf bank_mask:0xf
    v_sub_f32 v20, v20, v22
    v_exp_f32 v20, v20
    s_nop 0
    v_mul_f32 v21, v21, v20
    s_nop 1
    v_add_f32_dpp v21, v21, v21 row_half_mirror row_mask:0xf bank_mask:0xf
    s_nop 1
    v_add_f32_dpp v21, v21, v21 quad_perm:[1,0,3,2] row_mask:0xf bank_mask:0xf
    s_nop 1
    v_add_f32_dpp v21, v21, v21 quad_perm:[2,3,0,1] row_mask:0xf bank_mask:0xf
    v_rcp_f32 v23, v21
    v_log_f32 v21, v21
    v_mul_f32 v20, v20, v23
    v_add_f32 v21, v21, v22
    v_min_u32 v21, -2, v21
    v_readlane_b32 s50, v20, 0
    v_readlane_b32 s52, v20, 1
    v_readlane_b32 s54, v20, 2
    v_readlane_b32 s56, v20, 3
    v_readlane_b32 s58, v20, 4
    v_readlane_b32 s96, v20, 5
    v_readlane_b32 s98, v20, 6
    s_and_b32 s34, s2, 31
    s_bfe_u32 s35, s2, 0x20005
    s_lshl_b32 s35, s35, 1
    s_lshr_b32 s63, s2, 7
    s_add_u32 s35, s35, s63
    s_lshl_b32 s63, s34, 7
    s_lshl_b32 s49, s35, 2
    s_add_u32 s63, s63, s49
    s_add_u32 s63, s63, 188416
    v_mov_b32 v19, s63
    s_mov_b64 exec, 1
    buffer_store_dword v21, v19, s[44:47], 0 offen sc1
    s_mov_b64 exec, -1
    s_lshl_b32 s34, s34, 11
    s_lshl_b32 s35, s35, 8
    s_add_u32 s34, s34, s35
    s_add_u32 s34, s34, 122880
    v_and_b32 v18, 7, v0
    v_lshl_add_u32 v18, v14, 3, v18
    v_lshl_add_u32 v18, v18, 3, s34
    v_lshlrev_b32 v19, 4, v0
    v_add_u32 v19, 99328, v19
    s_barrier
    ds_read_b128 v[32:35], v19 offset:0
    ds_read_b128 v[36:39], v19 offset:1024
    ds_read_b128 v[40:43], v19 offset:2048
    ds_read_b128 v[44:47], v19 offset:3072
    ds_read_b128 v[48:51], v19 offset:4096
    ds_read_b128 v[52:55], v19 offset:5120
    ds_read_b128 v[56:59], v19 offset:6144
    s_waitcnt lgkmcnt(6)
    v_pk_mul_f32 v[20:21], v[32:33], s[50:51] op_sel_hi:[1,0]
    v_pk_mul_f32 v[22:23], v[34:35], s[50:51] op_sel_hi:[1,0]
    s_waitcnt lgkmcnt(5)
    v_pk_fma_f32 v[20:21], v[36:37], s[52:53], v[20:21] op_sel_hi:[1,0,1]
    v_pk_fma_f32 v[22:23], v[38:39], s[52:53], v[22:23] op_sel_hi:[1,0,1]
    s_waitcnt lgkmcnt(4)
    v_pk_fma_f32 v[20:21], v[40:41], s[54:55], v[20:21] op_sel_hi:[1,0,1]
    v_pk_fma_f32 v[22:23], v[42:43], s[54:55], v[22:23] op_sel_hi:[1,0,1]
    s_waitcnt lgkmcnt(3)
    v_pk_fma_f32 v[20:21], v[44:45], s[56:57], v[20:21] op_sel_hi:[1,0,1]
    v_pk_fma_f32 v[22:23], v[46:47], s[56:57], v[22:23] op_sel_hi:[1,0,1]
    s_waitcnt lgkmcnt(2)
    v_pk_fma_f32 v[20:21], v[48:49], s[58:59], v[20:21] op_sel_hi:[1,0,1]
    v_pk_fma_f32 v[22:23], v[50:51], s[58:59], v[22:23] op_sel_hi:[1,0,1]
    s_waitcnt lgkmcnt(1)
    v_pk_fma_f32 v[20:21], v[52:53], s[96:97], v[20:21] op_sel_hi:[1,0,1]
    v_pk_fma_f32 v[22:23], v[54:55], s[96:97], v[22:23] op_sel_hi:[1,0,1]
    s_waitcnt lgkmcnt(0)
    v_pk_fma_f32 v[20:21], v[56:57], s[98:99], v[20:21] op_sel_hi:[1,0,1]
    v_pk_fma_f32 v[22:23], v[58:59], s[98:99], v[22:23] op_sel_hi:[1,0,1]
    s_nop 0
    v_add_f32_dpp v20, v20, v20 row_ror:8 row_mask:0xf bank_mask:0xf
    v_add_f32_dpp v21, v21, v21 row_ror:8 row_mask:0xf bank_mask:0xf
    v_add_f32_dpp v22, v22, v22 row_ror:8 row_mask:0xf bank_mask:0xf
    v_add_f32_dpp v23, v23, v23 row_ror:8 row_mask:0xf bank_mask:0xf
    v_cvt_pk_bf16_f32 v24, v20, v21
    v_cvt_pk_bf16_f32 v25, v22, v23
    v_min_u32 v24, -2, v24
    v_min_u32 v25, -2, v25
    s_mov_b32 exec_lo, 0x00ff00ff
    s_mov_b32 exec_hi, 0x00ff00ff
    buffer_store_dwordx2 v[24:25], v18, s[44:47], 0 offen sc1
    s_mov_b64 exec, -1
    s_branch L_tail
L_stream:
    s_and_b32 s34, s2, 127
    s_lshl_b32 s34, s34, 21
    s_lshr_b32 s35, s2, 7
    s_lshl_b32 s35, s35, 18
    s_add_u32 s34, s34, s35
    s_add_u32 s34, s34, 1572864
    s_sub_u32 s35, s3, 1
    s_lshl_b32 s35, s35, 12
    v_lshl_add_u32 v1, v0, 4, s35
    s_mov_b32 s38, 0x40000
    s_mov_b32 s42, 0x40000
    s_waitcnt lgkmcnt(0)
    s_add_u32 s36, s6, s34
    s_addc_u32 s37, s7, 0
    s_add_u32 s40, s8, s34
    s_addc_u32 s41, s9, 0
    s_mov_b32 s34, 0
    buffer_load_dwordx4 v[16:19], v1, s[36:39], s34 offen offset:0 nt
    s_barrier
    buffer_load_dwordx4 v[20:23], v1, s[36:39], s34 offen offset:1024 nt
    buffer_load_dwordx4 v[24:27], v1, s[36:39], s34 offen offset:2048 nt
    buffer_load_dwordx4 v[28:31], v1, s[36:39], s34 offen offset:3072 nt
    s_mov_b32 s34, 28672
    s_waitcnt vmcnt(3)
    buffer_load_dwordx4 v[32:35], v1, s[36:39], s34 offen offset:0 nt
    s_waitcnt vmcnt(3)
    buffer_load_dwordx4 v[36:39], v1, s[36:39], s34 offen offset:1024 nt
    s_waitcnt vmcnt(3)
    buffer_load_dwordx4 v[40:43], v1, s[36:39], s34 offen offset:2048 nt
    s_waitcnt vmcnt(3)
    buffer_load_dwordx4 v[44:47], v1, s[36:39], s34 offen offset:3072 nt
    s_mov_b32 s34, 57344
    s_waitcnt vmcnt(3)
    buffer_load_dwordx4 v[48:51], v1, s[36:39], s34 offen offset:0 nt
    s_waitcnt vmcnt(3)
    buffer_load_dwordx4 v[52:55], v1, s[36:39], s34 offen offset:1024 nt
    s_waitcnt vmcnt(3)
    buffer_load_dwordx4 v[56:59], v1, s[36:39], s34 offen offset:2048 nt
    s_waitcnt vmcnt(3)
    buffer_load_dwordx4 v[60:63], v1, s[36:39], s34 offen offset:3072 nt
    s_mov_b32 s34, 86016
    s_waitcnt vmcnt(3)
    buffer_load_dwordx4 v[64:67], v1, s[36:39], s34 offen offset:0 nt
    s_waitcnt vmcnt(3)
    buffer_load_dwordx4 v[68:71], v1, s[36:39], s34 offen offset:1024 nt
    s_waitcnt vmcnt(3)
    buffer_load_dwordx4 v[72:75], v1, s[36:39], s34 offen offset:2048 nt
    s_waitcnt vmcnt(3)
    buffer_load_dwordx4 v[76:79], v1, s[36:39], s34 offen offset:3072 nt
    s_mov_b32 s34, 114688
    s_waitcnt vmcnt(3)
    buffer_load_dwordx4 v[80:83], v1, s[36:39], s34 offen offset:0 nt
    s_waitcnt vmcnt(3)
    buffer_load_dwordx4 v[84:87], v1, s[36:39], s34 offen offset:1024 nt
    s_waitcnt vmcnt(3)
    buffer_load_dwordx4 v[88:91], v1, s[36:39], s34 offen offset:2048 nt
    s_waitcnt vmcnt(3)
    buffer_load_dwordx4 v[92:95], v1, s[36:39], s34 offen offset:3072 nt
    s_mov_b32 s34, 143360
    s_waitcnt vmcnt(3)
    buffer_load_dwordx4 v[96:99], v1, s[36:39], s34 offen offset:0 nt
    s_waitcnt vmcnt(3)
    buffer_load_dwordx4 v[100:103], v1, s[36:39], s34 offen offset:1024 nt
    s_waitcnt vmcnt(3)
    buffer_load_dwordx4 v[104:107], v1, s[36:39], s34 offen offset:2048 nt
    s_waitcnt vmcnt(3)
    buffer_load_dwordx4 v[108:111], v1, s[36:39], s34 offen offset:3072 nt
    s_mov_b32 s34, 172032
    s_waitcnt vmcnt(3)
    buffer_load_dwordx4 v[112:115], v1, s[36:39], s34 offen offset:0 nt
    s_waitcnt vmcnt(3)
    buffer_load_dwordx4 v[116:119], v1, s[36:39], s34 offen offset:1024 nt
    s_waitcnt vmcnt(3)
    buffer_load_dwordx4 v[120:123], v1, s[36:39], s34 offen offset:2048 nt
    s_waitcnt vmcnt(3)
    buffer_load_dwordx4 v[124:127], v1, s[36:39], s34 offen offset:3072 nt
    s_mov_b32 s34, 200704
    s_waitcnt vmcnt(3)
    buffer_load_dwordx4 v[128:131], v1, s[36:39], s34 offen offset:0 nt
    s_waitcnt vmcnt(3)
    buffer_load_dwordx4 v[132:135], v1, s[36:39], s34 offen offset:1024 nt
    s_waitcnt vmcnt(3)
    buffer_load_dwordx4 v[136:139], v1, s[36:39], s34 offen offset:2048 nt
    s_waitcnt vmcnt(3)
    buffer_load_dwordx4 v[140:143], v1, s[36:39], s34 offen offset:3072 nt
    s_mov_b32 s34, 229376
    s_waitcnt vmcnt(3)
    buffer_load_dwordx4 v[144:147], v1, s[36:39], s34 offen offset:0 nt
    s_waitcnt vmcnt(3)
    buffer_load_dwordx4 v[148:151], v1, s[36:39], s34 offen offset:1024 nt
    s_waitcnt vmcnt(3)
    buffer_load_dwordx4 v[152:155], v1, s[36:39], s34 offen offset:2048 nt
    s_waitcnt vmcnt(3)
    buffer_load_dwordx4 v[156:159], v1, s[36:39], s34 offen offset:3072 nt
    s_mov_b32 s34, 258048
    s_waitcnt vmcnt(3)
    buffer_load_dwordx4 v[160:163], v1, s[36:39], s34 offen offset:0 nt
    s_waitcnt vmcnt(3)
    buffer_load_dwordx4 v[164:167], v1, s[36:39], s34 offen offset:1024 nt
    s_waitcnt vmcnt(3)
    buffer_load_dwordx4 v[168:171], v1, s[36:39], s34 offen offset:2048 nt
    s_waitcnt vmcnt(3)
    buffer_load_dwordx4 v[172:175], v1, s[36:39], s34 offen offset:3072 nt
    s_mov_b32 s34, 0
    s_waitcnt vmcnt(3)
    buffer_load_dwordx4 v[176:179], v1, s[40:43], s34 offen offset:0 nt
    s_waitcnt vmcnt(3)
    buffer_load_dwordx4 v[180:183], v1, s[40:43], s34 offen offset:1024 nt
    s_waitcnt vmcnt(3)
    buffer_load_dwordx4 v[184:187], v1, s[40:43], s34 offen offset:2048 nt
    s_waitcnt vmcnt(3)
    buffer_load_dwordx4 v[188:191], v1, s[40:43], s34 offen offset:3072 nt
    s_mov_b32 s34, 28672
    s_waitcnt vmcnt(3)
    buffer_load_dwordx4 v[192:195], v1, s[40:43], s34 offen offset:0 nt
    s_waitcnt vmcnt(3)
    buffer_load_dwordx4 v[196:199], v1, s[40:43], s34 offen offset:1024 nt
    s_waitcnt vmcnt(3)
    buffer_load_dwordx4 v[200:203], v1, s[40:43], s34 offen offset:2048 nt
    s_waitcnt vmcnt(3)
    buffer_load_dwordx4 v[204:207], v1, s[40:43], s34 offen offset:3072 nt
    s_mov_b32 s34, 57344
    s_waitcnt vmcnt(3)
    buffer_load_dwordx4 v[208:211], v1, s[40:43], s34 offen offset:0 nt
    s_waitcnt vmcnt(3)
    buffer_load_dwordx4 v[212:215], v1, s[40:43], s34 offen offset:1024 nt
    s_waitcnt vmcnt(3)
    buffer_load_dwordx4 v[216:219], v1, s[40:43], s34 offen offset:2048 nt
    s_waitcnt vmcnt(3)
    buffer_load_dwordx4 v[220:223], v1, s[40:43], s34 offen offset:3072 nt
    s_mov_b32 s34, 86016
    s_waitcnt vmcnt(3)
    buffer_load_dwordx4 v[224:227], v1, s[40:43], s34 offen offset:0 nt
    s_waitcnt vmcnt(3)
    buffer_load_dwordx4 v[228:231], v1, s[40:43], s34 offen offset:1024 nt
    s_waitcnt vmcnt(3)
    buffer_load_dwordx4 v[232:235], v1, s[40:43], s34 offen offset:2048 nt
    s_waitcnt vmcnt(3)
    buffer_load_dwordx4 v[236:239], v1, s[40:43], s34 offen offset:3072 nt
    s_mov_b32 s34, 114688
    s_waitcnt vmcnt(3)
    buffer_load_dwordx4 v[240:243], v1, s[40:43], s34 offen offset:0 nt
    s_waitcnt vmcnt(3)
    buffer_load_dwordx4 v[244:247], v1, s[40:43], s34 offen offset:1024 nt
    s_waitcnt vmcnt(3)
    buffer_load_dwordx4 v[248:251], v1, s[40:43], s34 offen offset:2048 nt
    s_waitcnt vmcnt(3)
    buffer_load_dwordx4 v[252:255], v1, s[40:43], s34 offen offset:3072 nt
    s_mov_b32 s44, s32
    s_mov_b32 s45, s33
    v_and_b32 v2, 15, v0
    v_lshlrev_b32 v2, 4, v2
    v_add_u32 v2, 98304, v2
    s_mov_b32 s35, 0
L_poll28:
    ds_read_b128 v[4:7], v2
    s_add_u32 s35, s35, 1
    s_waitcnt lgkmcnt(0)
    v_max3_u32 v3, v4, v5, v6
    v_max_u32 v3, v3, v7
    v_cmp_eq_u32 vcc, -1, v3
    s_cbranch_vccz L_done29
    s_sleep 2
    s_cmp_lt_u32 s35, 60000
    s_cbranch_scc1 L_poll28
L_done29:
    s_waitcnt vmcnt(56)
    v_dot2_f32_bf16 v8, v16, v4, 0
    v_dot2_f32_bf16 v9, v20, v4, 0
    v_dot2_f32_bf16 v10, v24, v4, 0
    v_dot2_f32_bf16 v11, v28, v4, 0
    v_dot2c_f32_bf16 v8, v17, v5
    v_dot2c_f32_bf16 v9, v21, v5
    v_dot2c_f32_bf16 v10, v25, v5
    v_dot2c_f32_bf16 v11, v29, v5
    v_dot2c_f32_bf16 v8, v18, v6
    v_dot2c_f32_bf16 v9, v22, v6
    v_dot2c_f32_bf16 v10, v26, v6
    v_dot2c_f32_bf16 v11, v30, v6
    v_dot2c_f32_bf16 v8, v19, v7
    v_dot2c_f32_bf16 v9, v23, v7
    v_dot2c_f32_bf16 v10, v27, v7
    v_dot2c_f32_bf16 v11, v31, v7
    v_add_f32_dpp v12, v8, v8 row_ror:8 row_mask:0xf bank_mask:0x3
    v_add_f32_dpp v12, v9, v9 row_ror:8 row_mask:0xf bank_mask:0xc
    v_add_f32_dpp v13, v10, v10 row_ror:8 row_mask:0xf bank_mask:0x3
    v_add_f32_dpp v13, v11, v11 row_ror:8 row_mask:0xf bank_mask:0xc
    s_waitcnt vmcnt(52)
    v_dot2_f32_bf16 v8, v32, v4, 0
    v_dot2_f32_bf16 v9, v36, v4, 0
    v_dot2_f32_bf16 v10, v40, v4, 0
    v_dot2_f32_bf16 v11, v44, v4, 0
    v_add_f32_dpp v12, v12, v12 row_half_mirror row_mask:0xf bank_mask:0xf
    v_add_f32_dpp v13, v13, v13 row_half_mirror row_mask:0xf bank_mask:0xf
    v_dot2c_f32_bf16 v8, v33, v5
    v_dot2c_f32_bf16 v9, v37, v5
    v_dot2c_f32_bf16 v10, v41, v5
    v_dot2c_f32_bf16 v11, v45, v5
    v_add_f32_dpp v12, v12, v12 quad_perm:[1,0,3,2] row_mask:0xf bank_mask:0xf
    v_add_f32_dpp v13, v13, v13 quad_perm:[1,0,3,2] row_mask:0xf bank_mask:0xf
    v_dot2c_f32_bf16 v8, v34, v6
    v_dot2c_f32_bf16 v9, v38, v6
    v_dot2c_f32_bf16 v10, v42, v6
    v_dot2c_f32_bf16 v11, v46, v6
    v_add_f32_dpp v12, v12, v12 quad_perm:[2,3,0,1] row_mask:0xf bank_mask:0xf
    v_add_f32_dpp v13, v13, v13 quad_perm:[2,3,0,1] row_mask:0xf bank_mask:0xf
    v_dot2c_f32_bf16 v8, v35, v7
    v_dot2c_f32_bf16 v9, v39, v7
    v_dot2c_f32_bf16 v10, v43, v7
    v_dot2c_f32_bf16 v11, v47, v7
    s_mov_b32 s34, 143360
    buffer_load_dwordx4 v[32:35], v1, s[40:43], s34 offen offset:0 nt
    buffer_load_dwordx4 v[36:39], v1, s[40:43], s34 offen offset:1024 nt
    buffer_load_dwordx4 v[40:43], v1, s[40:43], s34 offen offset:2048 nt
    buffer_load_dwordx4 v[44:47], v1, s[40:43], s34 offen offset:3072 nt
    v_add_f32_dpp v16, v8, v8 row_ror:8 row_mask:0xf bank_mask:0x3
    v_add_f32_dpp v16, v9, v9 row_ror:8 row_mask:0xf bank_mask:0xc
    v_add_f32_dpp v17, v10, v10 row_ror:8 row_mask:0xf bank_mask:0x3
    v_add_f32_dpp v17, v11, v11 row_ror:8 row_mask:0xf bank_mask:0xc
    s_waitcnt vmcnt(52)
    v_dot2_f32_bf16 v8, v48, v4, 0
    v_dot2_f32_bf16 v9, v52, v4, 0
    v_dot2_f32_bf16 v10, v56, v4, 0
    v_dot2_f32_bf16 v11, v60, v4, 0
    v_add_f32_dpp v16, v16, v16 row_half_mirror row_mask:0xf bank_mask:0xf
    v_add_f32_dpp v17, v17, v17 row_half_mirror row_mask:0xf bank_mask:0xf
    v_dot2c_f32_bf16 v8, v49, v5
    v_dot2c_f32_bf16 v9, v53, v5
    v_dot2c_f32_bf16 v10, v57, v5
    v_dot2c_f32_bf16 v11, v61, v5
    v_add_f32_dpp v16, v16, v16 quad_perm:[1,0,3,2] row_mask:0xf bank_mask:0xf
    v_add_f32_dpp v17, v17, v17 quad_perm:[1,0,3,2] row_mask:0xf bank_mask:0xf
    v_dot2c_f32_bf16 v8, v50, v6
    v_dot2c_f32_bf16 v9, v54, v6
    v_dot2c_f32_bf16 v10, v58, v6
    v_dot2c_f32_bf16 v11, v62, v6
    v_add_f32_dpp v16, v16, v16 quad_perm:[2,3,0,1] row_mask:0xf bank_mask:0xf
    v_add_f32_dpp v17, v17, v17 quad_perm:[2,3,0,1] row_mask:0xf bank_mask:0xf
    v_dot2c_f32_bf16 v8, v51, v7
    v_dot2c_f32_bf16 v9, v55, v7
    v_dot2c_f32_bf16 v10, v59, v7
    v_dot2c_f32_bf16 v11, v63, v7
    s_mov_b32 s34, 172032
    buffer_load_dwordx4 v[48:51], v1, s[40:43], s34 offen offset:0 nt
    buffer_load_dwordx4 v[52:55], v1, s[40:43], s34 offen offset:1024 nt
    buffer_load_dwordx4 v[56:59], v1, s[40:43], s34 offen offset:2048 nt
    buffer_load_dwordx4 v[60:63], v1, s[40:43], s34 offen offset:3072 nt
    v_add_f32_dpp v18, v8, v8 row_ror:8 row_mask:0xf bank_mask:0x3
    v_add_f32_dpp v18, v9, v9 row_ror:8 row_mask:0xf bank_mask:0xc
    v_add_f32_dpp v19, v10, v10 row_ror:8 row_mask:0xf bank_mask:0x3
    v_add_f32_dpp v19, v11, v11 row_ror:8 row_mask:0xf bank_mask:0xc
    s_waitcnt vmcnt(52)
    v_dot2_f32_bf16 v8, v64, v4, 0
    v_dot2_f32_bf16 v9, v68, v4, 0
    v_dot2_f32_bf16 v10, v72, v4, 0
    v_dot2_f32_bf16 v11, v76, v4, 0
    v_add_f32_dpp v18, v18, v18 row_half_mirror row_mask:0xf bank_mask:0xf
    v_add_f32_dpp v19, v19, v19 row_half_mirror row_mask:0xf bank_mask:0xf
    v_dot2c_f32_bf16 v8, v65, v5
    v_dot2c_f32_bf16 v9, v69, v5
    v_dot2c_f32_bf16 v10, v73, v5
    v_dot2c_f32_bf16 v11, v77, v5
    v_add_f32_dpp v18, v18, v18 quad_perm:[1,0,3,2] row_mask:0xf bank_mask:0xf
    v_add_f32_dpp v19, v19, v19 quad_perm:[1,0,3,2] row_mask:0xf bank_mask:0xf
    v_dot2c_f32_bf16 v8, v66, v6
    v_dot2c_f32_bf16 v9, v70, v6
    v_dot2c_f32_bf16 v10, v74, v6
    v_dot2c_f32_bf16 v11, v78, v6
    v_add_f32_dpp v18, v18, v18 quad_perm:[2,3,0,1] row_mask:0xf bank_mask:0xf
    v_add_f32_dpp v19, v19, v19 quad_perm:[2,3,0,1] row_mask:0xf bank_mask:0xf
    v_dot2c_f32_bf16 v8, v67, v7
    v_dot2c_f32_bf16 v9, v71, v7
    v_dot2c_f32_bf16 v10, v75, v7
    v_dot2c_f32_bf16 v11, v79, v7
    s_mov_b32 s34, 200704
    buffer_load_dwordx4 v[64:67], v1, s[40:43], s34 offen offset:0 nt
    buffer_load_dwordx4 v[68:71], v1, s[40:43], s34 offen offset:1024 nt
    buffer_load_dwordx4 v[72:75], v1, s[40:43], s34 offen offset:2048 nt
    buffer_load_dwordx4 v[76:79], v1, s[40:43], s34 offen offset:3072 nt
    v_add_f32_dpp v20, v8, v8 row_ror:8 row_mask:0xf bank_mask:0x3
    v_add_f32_dpp v20, v9, v9 row_ror:8 row_mask:0xf bank_mask:0xc
    v_add_f32_dpp v21, v10, v10 row_ror:8 row_mask:0xf bank_mask:0x3
    v_add_f32_dpp v21, v11, v11 row_ror:8 row_mask:0xf bank_mask:0xc
    s_waitcnt vmcnt(52)
    v_dot2_f32_bf16 v8, v80, v4, 0
    v_dot2_f32_bf16 v9, v84, v4, 0
    v_dot2_f32_bf16 v10, v88, v4, 0
    v_dot2_f32_bf16 v11, v92, v4, 0
    v_add_f32_dpp v20, v20, v20 row_half_mirror row_mask:0xf bank_mask:0xf
    v_add_f32_dpp v21, v21, v21 row_half_mirror row_mask:0xf bank_mask:0xf
    v_dot2c_f32_bf16 v8, v81, v5
    v_dot2c_f32_bf16 v9, v85, v5
    v_dot2c_f32_bf16 v10, v89, v5
    v_dot2c_f32_bf16 v11, v93, v5
    v_add_f32_dpp v20, v20, v20 quad_perm:[1,0,3,2] row_mask:0xf bank_mask:0xf
    v_add_f32_dpp v21, v21, v21 quad_perm:[1,0,3,2] row_mask:0xf bank_mask:0xf
    v_dot2c_f32_bf16 v8, v82, v6
    v_dot2c_f32_bf16 v9, v86, v6
    v_dot2c_f32_bf16 v10, v90, v6
    v_dot2c_f32_bf16 v11, v94, v6
    v_add_f32_dpp v20, v20, v20 quad_perm:[2,3,0,1] row_mask:0xf bank_mask:0xf
    v_add_f32_dpp v21, v21, v21 quad_perm:[2,3,0,1] row_mask:0xf bank_mask:0xf
    v_dot2c_f32_bf16 v8, v83, v7
    v_dot2c_f32_bf16 v9, v87, v7
    v_dot2c_f32_bf16 v10, v91, v7
    v_dot2c_f32_bf16 v11, v95, v7
    s_mov_b32 s34, 229376
    buffer_load_dwordx4 v[80:83], v1, s[40:43], s34 offen offset:0 nt
    buffer_load_dwordx4 v[84:87], v1, s[40:43], s34 offen offset:1024 nt
    buffer_load_dwordx4 v[88:91], v1, s[40:43], s34 offen offset:2048 nt
    buffer_load_dwordx4 v[92:95], v1, s[40:43], s34 offen offset:3072 nt
    v_add_f32_dpp v22, v8, v8 row_ror:8 row_mask:0xf bank_mask:0x3
    v_add_f32_dpp v22, v9, v9 row_ror:8 row_mask:0xf bank_mask:0xc
    v_add_f32_dpp v23, v10, v10 row_ror:8 row_mask:0xf bank_mask:0x3
    v_add_f32_dpp v23, v11, v11 row_ror:8 row_mask:0xf bank_mask:0xc
    s_waitcnt vmcnt(52)
    v_dot2_f32_bf16 v8, v96, v4, 0
    v_dot2_f32_bf16 v9, v100, v4, 0
    v_dot2_f32_bf16 v10, v104, v4, 0
    v_dot2_f32_bf16 v11, v108, v4, 0
    v_add_f32_dpp v22, v22, v22 row_half_mirror row_mask:0xf bank_mask:0xf
    v_add_f32_dpp v23, v23, v23 row_half_mirror row_mask:0xf bank_mask:0xf
    v_dot2c_f32_bf16 v8, v97, v5
    v_dot2c_f32_bf16 v9, v101, v5
    v_dot2c_f32_bf16 v10, v105, v5
    v_dot2c_f32_bf16 v11, v109, v5
    v_add_f32_dpp v22, v22, v22 quad_perm:[1,0,3,2] row_mask:0xf bank_mask:0xf
    v_add_f32_dpp v23, v23, v23 quad_perm:[1,0,3,2] row_mask:0xf bank_mask:0xf
    v_dot2c_f32_bf16 v8, v98, v6
    v_dot2c_f32_bf16 v9, v102, v6
    v_dot2c_f32_bf16 v10, v106, v6
    v_dot2c_f32_bf16 v11, v110, v6
    v_add_f32_dpp v22, v22, v22 quad_perm:[2,3,0,1] row_mask:0xf bank_mask:0xf
    v_add_f32_dpp v23, v23, v23 quad_perm:[2,3,0,1] row_mask:0xf bank_mask:0xf
    v_dot2c_f32_bf16 v8, v99, v7
    v_dot2c_f32_bf16 v9, v103, v7
    v_dot2c_f32_bf16 v10, v107, v7
    v_dot2c_f32_bf16 v11, v111, v7
    s_mov_b32 s34, 258048
    buffer_load_dwordx4 v[96:99], v1, s[40:43], s34 offen offset:0 nt
    buffer_load_dwordx4 v[100:103], v1, s[40:43], s34 offen offset:1024 nt
    buffer_load_dwordx4 v[104:107], v1, s[40:43], s34 offen offset:2048 nt
    buffer_load_dwordx4 v[108:111], v1, s[40:43], s34 offen offset:3072 nt
    v_add_f32_dpp v24, v8, v8 row_ror:8 row_mask:0xf bank_mask:0x3
    v_add_f32_dpp v24, v9, v9 row_ror:8 row_mask:0xf bank_mask:0xc
    v_add_f32_dpp v25, v10, v10 row_ror:8 row_mask:0xf bank_mask:0x3
    v_add_f32_dpp v25, v11, v11 row_ror:8 row_mask:0xf bank_mask:0xc
    s_waitcnt vmcnt(52)
    v_dot2_f32_bf16 v8, v112, v4, 0
    v_dot2_f32_bf16 v9, v116, v4, 0
    v_dot2_f32_bf16 v10, v120, v4, 0
    v_dot2_f32_bf16 v11, v124, v4, 0
    v_add_f32_dpp v24, v24, v24 row_half_mirror row_mask:0xf bank_mask:0xf
    v_add_f32_dpp v25, v25, v25 row_half_mirror row_mask:0xf bank_mask:0xf
    v_dot2c_f32_bf16 v8, v113, v5
    v_dot2c_f32_bf16 v9, v117, v5
    v_dot2c_f32_bf16 v10, v121, v5
    v_dot2c_f32_bf16 v11, v125, v5
    v_add_f32_dpp v24, v24, v24 quad_perm:[1,0,3,2] row_mask:0xf bank_mask:0xf
    v_add_f32_dpp v25, v25, v25 quad_perm:[1,0,3,2] row_mask:0xf bank_mask:0xf
    v_dot2c_f32_bf16 v8, v114, v6
    v_dot2c_f32_bf16 v9, v118, v6
    v_dot2c_f32_bf16 v10, v122, v6
    v_dot2c_f32_bf16 v11, v126, v6
    v_add_f32_dpp v24, v24, v24 quad_perm:[2,3,0,1] row_mask:0xf bank_mask:0xf
    v_add_f32_dpp v25, v25, v25 quad_perm:[2,3,0,1] row_mask:0xf bank_mask:0xf
    v_dot2c_f32_bf16 v8, v115, v7
    v_dot2c_f32_bf16 v9, v119, v7
    v_dot2c_f32_bf16 v10, v123, v7
    v_dot2c_f32_bf16 v11, v127, v7
    v_add_f32_dpp v26, v8, v8 row_ror:8 row_mask:0xf bank_mask:0x3
    v_add_f32_dpp v26, v9, v9 row_ror:8 row_mask:0xf bank_mask:0xc
    v_add_f32_dpp v27, v10, v10 row_ror:8 row_mask:0xf bank_mask:0x3
    v_add_f32_dpp v27, v11, v11 row_ror:8 row_mask:0xf bank_mask:0xc
    s_waitcnt vmcnt(48)
    v_dot2_f32_bf16 v8, v128, v4, 0
    v_dot2_f32_bf16 v9, v132, v4, 0
    v_dot2_f32_bf16 v10, v136, v4, 0
    v_dot2_f32_bf16 v11, v140, v4, 0
    v_add_f32_dpp v26, v26, v26 row_half_mirror row_mask:0xf bank_mask:0xf
    v_add_f32_dpp v27, v27, v27 row_half_mirror row_mask:0xf bank_mask:0xf
    v_dot2c_f32_bf16 v8, v129, v5
    v_dot2c_f32_bf16 v9, v133, v5
    v_dot2c_f32_bf16 v10, v137, v5
    v_dot2c_f32_bf16 v11, v141, v5
    v_add_f32_dpp v26, v26, v26 quad_perm:[1,0,3,2] row_mask:0xf bank_mask:0xf
    v_add_f32_dpp v27, v27, v27 quad_perm:[1,0,3,2] row_mask:0xf bank_mask:0xf
    v_dot2c_f32_bf16 v8, v130, v6
    v_dot2c_f32_bf16 v9, v134, v6
    v_dot2c_f32_bf16 v10, v138, v6
    v_dot2c_f32_bf16 v11, v142, v6
    v_add_f32_dpp v26, v26, v26 quad_perm:[2,3,0,1] row_mask:0xf bank_mask:0xf
    v_add_f32_dpp v27, v27, v27 quad_perm:[2,3,0,1] row_mask:0xf bank_mask:0xf
    v_dot2c_f32_bf16 v8, v131, v7
    v_dot2c_f32_bf16 v9, v135, v7
    v_dot2c_f32_bf16 v10, v139, v7
    v_dot2c_f32_bf16 v11, v143, v7
    v_add_f32_dpp v28, v8, v8 row_ror:8 row_mask:0xf bank_mask:0x3
    v_add_f32_dpp v28, v9, v9 row_ror:8 row_mask:0xf bank_mask:0xc
    v_add_f32_dpp v29, v10, v10 row_ror:8 row_mask:0xf bank_mask:0x3
    v_add_f32_dpp v29, v11, v11 row_ror:8 row_mask:0xf bank_mask:0xc
    s_waitcnt vmcnt(44)
    v_dot2_f32_bf16 v8, v144, v4, 0
    v_dot2_f32_bf16 v9, v148, v4, 0
    v_dot2_f32_bf16 v10, v152, v4, 0
    v_dot2_f32_bf16 v11, v156, v4, 0
    v_add_f32_dpp v28, v28, v28 row_half_mirror row_mask:0xf bank_mask:0xf
    v_add_f32_dpp v29, v29, v29 row_half_mirror row_mask:0xf bank_mask:0xf
    v_dot2c_f32_bf16 v8, v145, v5
    v_dot2c_f32_bf16 v9, v149, v5
    v_dot2c_f32_bf16 v10, v153, v5
    v_dot2c_f32_bf16 v11, v157, v5
    v_add_f32_dpp v28, v28, v28 quad_perm:[1,0,3,2] row_mask:0xf bank_mask:0xf
    v_add_f32_dpp v29, v29, v29 quad_perm:[1,0,3,2] row_mask:0xf bank_mask:0xf
    v_dot2c_f32_bf16 v8, v146, v6
    v_dot2c_f32_bf16 v9, v150, v6
    v_dot2c_f32_bf16 v10, v154, v6
    v_dot2c_f32_bf16 v11, v158, v6
    v_add_f32_dpp v28, v28, v28 quad_perm:[2,3,0,1] row_mask:0xf bank_mask:0xf
    v_add_f32_dpp v29, v29, v29 quad_perm:[2,3,0,1] row_mask:0xf bank_mask:0xf
    v_dot2c_f32_bf16 v8, v147, v7
    v_dot2c_f32_bf16 v9, v151, v7
    v_dot2c_f32_bf16 v10, v155, v7
    v_dot2c_f32_bf16 v11, v159, v7
    v_add_f32_dpp v30, v8, v8 row_ror:8 row_mask:0xf bank_mask:0x3
    v_add_f32_dpp v30, v9, v9 row_ror:8 row_mask:0xf bank_mask:0xc
    v_add_f32_dpp v31, v10, v10 row_ror:8 row_mask:0xf bank_mask:0x3
    v_add_f32_dpp v31, v11, v11 row_ror:8 row_mask:0xf bank_mask:0xc
    s_waitcnt vmcnt(40)
    v_dot2_f32_bf16 v8, v160, v4, 0
    v_dot2_f32_bf16 v9, v164, v4, 0
    v_dot2_f32_bf16 v10, v168, v4, 0
    v_dot2_f32_bf16 v11, v172, v4, 0
    v_add_f32_dpp v30, v30, v30 row_half_mirror row_mask:0xf bank_mask:0xf
    v_add_f32_dpp v31, v31, v31 row_half_mirror row_mask:0xf bank_mask:0xf
    v_dot2c_f32_bf16 v8, v161, v5
    v_dot2c_f32_bf16 v9, v165, v5
    v_dot2c_f32_bf16 v10, v169, v5
    v_dot2c_f32_bf16 v11, v173, v5
    v_add_f32_dpp v30, v30, v30 quad_perm:[1,0,3,2] row_mask:0xf bank_mask:0xf
    v_add_f32_dpp v31, v31, v31 quad_perm:[1,0,3,2] row_mask:0xf bank_mask:0xf
    v_dot2c_f32_bf16 v8, v162, v6
    v_dot2c_f32_bf16 v9, v166, v6
    v_dot2c_f32_bf16 v10, v170, v6
    v_dot2c_f32_bf16 v11, v174, v6
    v_add_f32_dpp v30, v30, v30 quad_perm:[2,3,0,1] row_mask:0xf bank_mask:0xf
    v_add_f32_dpp v31, v31, v31 quad_perm:[2,3,0,1] row_mask:0xf bank_mask:0xf
    v_dot2c_f32_bf16 v8, v163, v7
    v_dot2c_f32_bf16 v9, v167, v7
    v_dot2c_f32_bf16 v10, v171, v7
    v_dot2c_f32_bf16 v11, v175, v7
    v_add_f32_dpp v14, v8, v8 row_ror:8 row_mask:0xf bank_mask:0x3
    v_add_f32_dpp v14, v9, v9 row_ror:8 row_mask:0xf bank_mask:0xc
    v_add_f32_dpp v15, v10, v10 row_ror:8 row_mask:0xf bank_mask:0x3
    v_add_f32_dpp v15, v11, v11 row_ror:8 row_mask:0xf bank_mask:0xc
    v_add_f32_dpp v14, v14, v14 row_half_mirror row_mask:0xf bank_mask:0xf
    s_nop 0
    v_add_f32_dpp v15, v15, v15 row_half_mirror row_mask:0xf bank_mask:0xf
    v_add_f32_dpp v14, v14, v14 quad_perm:[1,0,3,2] row_mask:0xf bank_mask:0xf
    s_nop 0
    v_add_f32_dpp v15, v15, v15 quad_perm:[1,0,3,2] row_mask:0xf bank_mask:0xf
    v_add_f32_dpp v14, v14, v14 quad_perm:[2,3,0,1] row_mask:0xf bank_mask:0xf
    s_nop 0
    v_add_f32_dpp v15, v15, v15 quad_perm:[2,3,0,1] row_mask:0xf bank_mask:0xf
    s_cmp_eq_u32 s3, 1
    s_cbranch_scc1 L_nomask
    v_mov_b32 v14, 0xfe967699
    v_mov_b32 v15, 0xfe967699
L_nomask:
    v_max3_f32 v8, v12, v13, v16
    v_max3_f32 v8, v8, v17, v18
    v_max3_f32 v8, v8, v19, v20
    v_max3_f32 v8, v8, v21, v22
    v_max3_f32 v8, v8, v23, v24
    v_max3_f32 v8, v8, v25, v26
    v_max3_f32 v8, v8, v27, v28
    v_max3_f32 v8, v8, v29, v30
    v_max3_f32 v8, v8, v31, v14
    v_max_f32 v8, v8, v15
    s_nop 1
    v_max_f32_dpp v8, v8, v8 row_ror:8 row_mask:0xf bank_mask:0xf
    v_mov_b32 v9, v8
    s_nop 1
    v_permlane16_swap_b32 v8, v9
    v_max_f32 v8, v8, v9
    v_mov_b32 v9, v8
    s_nop 1
    v_permlane32_swap_b32 v8, v9
    v_max_f32 v8, v8, v9
    s_mov_b32 s34, 0x3e0293ee
    v_mul_f32 v8, s34, v8
    v_fma_f32 v12, v12, s34, -v8
    v_fma_f32 v13, v13, s34, -v8
    v_fma_f32 v16, v16, s34, -v8
    v_fma_f32 v17, v17, s34, -v8
    v_fma_f32 v18, v18, s34, -v8
    v_fma_f32 v19, v19, s34, -v8
    v_fma_f32 v20, v20, s34, -v8
    v_fma_f32 v21, v21, s34, -v8
    v_fma_f32 v22, v22, s34, -v8
    v_fma_f32 v23, v23, s34, -v8
    v_fma_f32 v24, v24, s34, -v8
    v_fma_f32 v25, v25, s34, -v8
    v_fma_f32 v26, v26, s34, -v8
    v_fma_f32 v27, v27, s34, -v8
    v_fma_f32 v28, v28, s34, -v8
    v_fma_f32 v29, v29, s34, -v8
    v_fma_f32 v30, v30, s34, -v8
    v_fma_f32 v31, v31, s34, -v8
    v_fma_f32 v14, v14, s34, -v8
    v_fma_f32 v15, v15, s34, -v8
    v_exp_f32 v12, v12
    v_exp_f32 v13, v13
    v_exp_f32 v16, v16
    v_exp_f32 v17, v17
    v_exp_f32 v18, v18
    v_exp_f32 v19, v19
    v_exp_f32 v20, v20
    v_exp_f32 v21, v21
    v_exp_f32 v22, v22
    v_exp_f32 v23, v23
    v_exp_f32 v24, v24
    v_exp_f32 v25, v25
    v_exp_f32 v26, v26
    v_exp_f32 v27, v27
    v_exp_f32 v28, v28
    v_exp_f32 v29, v29
    v_exp_f32 v30, v30
    v_exp_f32 v31, v31
    v_exp_f32 v14, v14
    v_exp_f32 v15, v15
    v_add_f32 v9, v12, v13
    v_add_f32 v9, v9, v16
    v_add_f32 v9, v9, v17
    v_add_f32 v9, v9, v18
    v_add_f32 v9, v9, v19
    v_add_f32 v9, v9, v20
    v_add_f32 v9, v9, v21
    v_add_f32 v9, v9, v22
    v_add_f32 v9, v9, v23
    v_add_f32 v9, v9, v24
    v_add_f32 v9, v9, v25
    v_add_f32 v9, v9, v26
    v_add_f32 v9, v9, v27
    v_add_f32 v9, v9, v28
    v_add_f32 v9, v9, v29
    v_add_f32 v9, v9, v30
    v_add_f32 v9, v9, v31
    v_add_f32 v9, v9, v14
    v_add_f32 v9, v9, v15
    v_and_b32 v10, 1, v0
    v_lshlrev_b32 v10, 4, v10
    v_mov_b32 v11, 0xffff
    v_lshlrev_b32 v10, v10, v11
    v_bfe_u32 v11, v0, 1, 2
    v_cmp_eq_u32 vcc, 0, v11
    s_nop 1
    v_cndmask_b32 v160, 0, v10, vcc
    v_cmp_eq_u32 vcc, 1, v11
    s_nop 1
    v_cndmask_b32 v161, 0, v10, vcc
    v_cmp_eq_u32 vcc, 2, v11
    s_nop 1
    v_cndmask_b32 v162, 0, v10, vcc
    v_cmp_eq_u32 vcc, 3, v11
    s_nop 1
    v_cndmask_b32 v163, 0, v10, vcc
    v_add_f32_dpp v9, v9, v9 row_ror:8 row_mask:0xf bank_mask:0xf
    v_mov_b32 v10, v9
    s_nop 1
    v_permlane16_swap_b32 v9, v10
    v_add_f32 v9, v9, v10
    v_mov_b32 v10, v9
    s_nop 1
    v_permlane32_swap_b32 v9, v10
    v_add_f32 v9, v9, v10
    s_lshl_b32 s34, s3, 3
    s_add_u32 s34, s34, 98552
    v_mov_b32 v10, s34
    s_mov_b64 exec, 1
    ds_write_b64 v10, v[8:9]
    s_mov_b64 exec, -1
    s_lshl_b32 s34, s3, 10
    s_add_u32 s34, s34, 98304
    v_lshl_add_u32 v2, v0, 4, s34
    v_cvt_pk_bf16_f32 v10, v12, v12
    v_and_b32 v144, v10, v160
    v_and_b32 v145, v10, v161
    v_and_b32 v146, v10, v162
    v_and_b32 v147, v10, v163
    s_waitcnt vmcnt(38)
    s_nop 0
    v_mfma_f32_16x16x32_bf16 v[164:167], v[176:179], v[144:147], 0
    v_mfma_f32_16x16x32_bf16 v[168:171], v[180:183], v[144:147], 0
    v_cvt_pk_bf16_f32 v10, v13, v13
    v_and_b32 v148, v10, v160
    v_and_b32 v149, v10, v161
    v_and_b32 v150, v10, v162
    v_and_b32 v151, v10, v163
    s_waitcnt vmcnt(36)
    s_nop 0
    v_mfma_f32_16x16x32_bf16 v[164:167], v[184:187], v[148:151], v[164:167]
    v_mfma_f32_16x16x32_bf16 v[168:171], v[188:191], v[148:151], v[168:171]
    v_cvt_pk_bf16_f32 v10, v16, v16
    v_and_b32 v144, v10, v160
    v_and_b32 v145, v10, v161
    v_and_b32 v146, v10, v162
    v_and_b32 v147, v10, v163
    s_waitcnt vmcnt(34)
    s_nop 0
    v_mfma_f32_16x16x32_bf16 v[164:167], v[192:195], v[144:147], v[164:167]
    v_mfma_f32_16x16x32_bf16 v[168:171], v[196:199], v[144:147], v[168:171]
    v_cvt_pk_bf16_f32 v10, v17, v17
    v_and_b32 v148, v10, v160
    v_and_b32 v149, v10, v161
    v_and_b32 v150, v10, v162
    v_and_b32 v151, v10, v163
    s_waitcnt vmcnt(32)
    s_nop 0
    v_mfma_f32_16x16x32_bf16 v[164:167], v[200:203], v[148:151], v[164:167]
    v_mfma_f32_16x16x32_bf16 v[168:171], v[204:207], v[148:151], v[168:171]
    v_cvt_pk_bf16_f32 v10, v18, v18
    v_and_b32 v144, v10, v160
    v_and_b32 v145, v10, v161
    v_and_b32 v146, v10, v162
    v_and_b32 v147, v10, v163
    s_waitcnt vmcnt(30)
    s_nop 0
    v_mfma_f32_16x16x32_bf16 v[164:167], v[208:211], v[144:147], v[164:167]
    v_mfma_f32_16x16x32_bf16 v[168:171], v[212:215], v[144:147], v[168:171]
    v_cvt_pk_bf16_f32 v10, v19, v19
    v_and_b32 v148, v10, v160
    v_and_b32 v149, v10, v161
    v_and_b32 v150, v10, v162
    v_and_b32 v151, v10, v163
    s_waitcnt vmcnt(28)
    s_nop 0
    v_mfma_f32_16x16x32_bf16 v[164:167], v[216:219], v[148:151], v[164:167]
    v_mfma_f32_16x16x32_bf16 v[168:171], v[220:223], v[148:151], v[168:171]
    v_cvt_pk_bf16_f32 v10, v20, v20
    v_and_b32 v144, v10, v160
    v_and_b32 v145, v10, v161
    v_and_b32 v146, v10, v162
    v_and_b32 v147, v10, v163
    s_waitcnt vmcnt(26)
    s_nop 0
    v_mfma_f32_16x16x32_bf16 v[164:167], v[224:227], v[144:147], v[164:167]
    v_mfma_f32_16x16x32_bf16 v[168:171], v[228:231], v[144:147], v[168:171]
    v_cvt_pk_bf16_f32 v10, v21, v21
    v_and_b32 v148, v10, v160
    v_and_b32 v149, v10, v161
    v_and_b32 v150, v10, v162
    v_and_b32 v151, v10, v163
    s_waitcnt vmcnt(24)
    s_nop 0
    v_mfma_f32_16x16x32_bf16 v[164:167], v[232:235], v[148:151], v[164:167]
    v_mfma_f32_16x16x32_bf16 v[168:171], v[236:239], v[148:151], v[168:171]
    v_cvt_pk_bf16_f32 v10, v22, v22
    v_and_b32 v144, v10, v160
    v_and_b32 v145, v10, v161
    v_and_b32 v146, v10, v162
    v_and_b32 v147, v10, v163
    s_waitcnt vmcnt(22)
    s_nop 0
    v_mfma_f32_16x16x32_bf16 v[164:167], v[240:243], v[144:147], v[164:167]
    v_mfma_f32_16x16x32_bf16 v[168:171], v[244:247], v[144:147], v[168:171]
    v_cvt_pk_bf16_f32 v10, v23, v23
    v_and_b32 v148, v10, v160
    v_and_b32 v149, v10, v161
    v_and_b32 v150, v10, v162
    v_and_b32 v151, v10, v163
    s_waitcnt vmcnt(20)
    s_nop 0
    v_mfma_f32_16x16x32_bf16 v[164:167], v[248:251], v[148:151], v[164:167]
    v_mfma_f32_16x16x32_bf16 v[168:171], v[252:255], v[148:151], v[168:171]
    v_cvt_pk_bf16_f32 v10, v24, v24
    v_and_b32 v144, v10, v160
    v_and_b32 v145, v10, v161
    v_and_b32 v146, v10, v162
    v_and_b32 v147, v10, v163
    s_waitcnt vmcnt(18)
    s_nop 0
    v_mfma_f32_16x16x32_bf16 v[164:167], v[32:35], v[144:147], v[164:167]
    v_mfma_f32_16x16x32_bf16 v[168:171], v[36:39], v[144:147], v[168:171]
    v_cvt_pk_bf16_f32 v10, v25, v25
    v_and_b32 v148, v10, v160
    v_and_b32 v149, v10, v161
    v_and_b32 v150, v10, v162
    v_and_b32 v151, v10, v163
    s_waitcnt vmcnt(16)
    s_nop 0
    v_mfma_f32_16x16x32_bf16 v[164:167], v[40:43], v[148:151], v[164:167]
    v_mfma_f32_16x16x32_bf16 v[168:171], v[44:47], v[148:151], v[168:171]
    v_cvt_pk_bf16_f32 v10, v26, v26
    v_and_b32 v144, v10, v160
    v_and_b32 v145, v10, v161
    v_and_b32 v146, v10, v162
    v_and_b32 v147, v10, v163
    s_waitcnt vmcnt(14)
    s_nop 0
    v_mfma_f32_16x16x32_bf16 v[164:167], v[48:51], v[144:147], v[164:167]
    v_mfma_f32_16x16x32_bf16 v[168:171], v[52:55], v[144:147], v[168:171]
    v_cvt_pk_bf16_f32 v10, v27, v27
    v_and_b32 v148, v10, v160
    v_and_b32 v149, v10, v161
    v_and_b32 v150, v10, v162
    v_and_b32 v151, v10, v163
    s_waitcnt vmcnt(12)
    s_nop 0
    v_mfma_f32_16x16x32_bf16 v[164:167], v[56:59], v[148:151], v[164:167]
    v_mfma_f32_16x16x32_bf16 v[168:171], v[60:63], v[148:151], v[168:171]
    v_cvt_pk_bf16_f32 v10, v28, v28
    v_and_b32 v144, v10, v160
    v_and_b32 v145, v10, v161
    v_and_b32 v146, v10, v162
    v_and_b32 v147, v10, v163
    s_waitcnt vmcnt(10)
    s_nop 0
    v_mfma_f32_16x16x32_bf16 v[164:167], v[64:67], v[144:147], v[164:167]
    v_mfma_f32_16x16x32_bf16 v[168:171], v[68:71], v[144:147], v[168:171]
    v_cvt_pk_bf16_f32 v10, v29, v29
    v_and_b32 v148, v10, v160
    v_and_b32 v149, v10, v161
    v_and_b32 v150, v10, v162
    v_and_b32 v151, v10, v163
    s_waitcnt vmcnt(8)
    s_nop 0
    v_mfma_f32_16x16x32_bf16 v[164:167], v[72:75], v[148:151], v[164:167]
    v_mfma_f32_16x16x32_bf16 v[168:171], v[76:79], v[148:151], v[168:171]
    v_cvt_pk_bf16_f32 v10, v30, v30
    v_and_b32 v144, v10, v160
    v_and_b32 v145, v10, v161
    v_and_b32 v146, v10, v162
    v_and_b32 v147, v10, v163
    s_waitcnt vmcnt(6)
    s_nop 0
    v_mfma_f32_16x16x32_bf16 v[164:167], v[80:83], v[144:147], v[164:167]
    v_mfma_f32_16x16x32_bf16 v[168:171], v[84:87], v[144:147], v[168:171]
    v_cvt_pk_bf16_f32 v10, v31, v31
    v_and_b32 v148, v10, v160
    v_and_b32 v149, v10, v161
    v_and_b32 v150, v10, v162
    v_and_b32 v151, v10, v163
    s_waitcnt vmcnt(4)
    s_nop 0
    v_mfma_f32_16x16x32_bf16 v[164:167], v[88:91], v[148:151], v[164:167]
    v_mfma_f32_16x16x32_bf16 v[168:171], v[92:95], v[148:151], v[168:171]
    v_cvt_pk_bf16_f32 v10, v14, v14
    v_and_b32 v144, v10, v160
    v_and_b32 v145, v10, v161
    v_and_b32 v146, v10, v162
    v_and_b32 v147, v10, v163
    s_waitcnt vmcnt(2)
    s_nop 0
    v_mfma_f32_16x16x32_bf16 v[164:167], v[96:99], v[144:147], v[164:167]
    v_mfma_f32_16x16x32_bf16 v[168:171], v[100:103], v[144:147], v[168:171]
    v_cvt_pk_bf16_f32 v10, v15, v15
    v_and_b32 v148, v10, v160
    v_and_b32 v149, v10, v161
    v_and_b32 v150, v10, v162
    v_and_b32 v151, v10, v163
    s_waitcnt vmcnt(0)
    s_nop 0
    v_mfma_f32_16x16x32_bf16 v[164:167], v[104:107], v[148:151], v[164:167]
    v_mfma_f32_16x16x32_bf16 v[168:171], v[108:111], v[148:151], v[168:171]
    s_nop 7
    v_mov_b32_dpp v164, v168 quad_perm:[0,1,2,3] row_mask:0xf bank_mask:0xc
    v_mov_b32_dpp v165, v169 quad_perm:[0,1,2,3] row_mask:0xf bank_mask:0xc
    v_mov_b32_dpp v166, v170 quad_perm:[0,1,2,3] row_mask:0xf bank_mask:0xc
    v_mov_b32_dpp v167, v171 quad_perm:[0,1,2,3] row_mask:0xf bank_mask:0xc
    ds_write_b128 v2, v[164:167]
    s_waitcnt lgkmcnt(0)
    s_barrier
L_tail:
    v_and_b32 v12, 3, v0
    v_bfe_u32 v13, v0, 2, 2
    v_lshrrev_b32 v14, 4, v0
    s_lshl_b32 s34, s3, 10
    s_add_u32 s34, s34, 122112
    v_lshl_add_u32 v2, v0, 4, s34
    s_movk_i32 s48, 20480
    s_mov_b32 s62, s61
    s_cmp_lt_u32 s61, 20
    s_cbranch_scc1 L_t_wo
    s_lshl_b32 s62, s60, 2
    s_and_b32 s34, s61, 3
    s_add_u32 s62, s62, s34
    s_cmp_lt_u32 s61, 24
    s_cbranch_scc1 L_t_w2
    s_cmp_ge_u32 s60, 2
    s_cbranch_scc1 L_t_w1b
    s_cmp_ge_u32 s61, 28
    s_cbranch_scc1 L_t_w1
    s_add_u32 s62, s62, 32
    s_branch L_t_w2
L_t_w1b:
    s_lshl_b32 s62, s60, 3
    s_add_u32 s62, s62, s61
    s_sub_u32 s62, s62, 32
    s_cmp_ge_u32 s62, 54
    s_cbranch_scc1 L_t_none
L_t_w1:
    s_mov_b32 s36, s16
    s_mov_b32 s37, s17
    s_mov_b32 s38, 2211840
    v_lshl_add_u32 v17, v13, 3, v14
    v_mul_u32_u24 v17, 3456, v17
    v_lshl_add_u32 v17, v12, 4, v17
    s_lshl_b32 s34, s62, 6
    v_add_u32 v17, s34, v17
    s_and_b32 s34, s3, 1
    s_lshl_b32 s40, s34, 8
    s_lshl_b32 s41, s34, 2
    s_lshr_b32 s34, s3, 2
    s_lshl_b32 s34, s34, 7
    s_add_u32 s40, s40, s34
    s_lshr_b32 s34, s3, 1
    s_lshl_b32 s35, s34, 5
    s_add_u32 s41, s41, s35
    s_add_u32 s41, s41, 512
    s_and_b32 s34, s34, 1
    s_lshl_b32 s34, s34, 2
    s_add_u32 s40, s40, s34
    s_mul_i32 s40, s40, 3456
    s_mul_i32 s41, s41, 3456
    s_lshl_b32 s42, s3, 10
    s_add_u32 s42, s42, 40960
    v_and_b32 v10, 15, v0
    v_lshlrev_b32 v10, 4, v10
    s_and_b32 s49, s3, 3
    s_mul_i32 s34, s49, 1280
    v_add_u32 v11, s34, v10
    s_mul_i32 s34, s49, 5120
    s_add_u32 s34, s34, 42240
    v_mul_u32_u24 v15, 20480, v14
    v_add3_u32 v15, v15, v10, s34
    s_barrier
    s_cmp_lt_u32 s3, 4
    s_cbranch_scc1 L_w1_ln
    s_bitcmp1_b32 s62, 0
    s_cbranch_scc1 L_rot31
    s_add_u32 m0, s42, 0
    s_add_u32 s34, s40, 0
    buffer_load_dwordx4 v17, s[36:39], s34 offen  lds
    s_add_u32 m0, s42, 8192
    s_add_u32 s34, s40, 110592
    buffer_load_dwordx4 v17, s[36:39], s34 offen  lds
    s_add_u32 m0, s42, 16384
    s_add_u32 s34, s40, 221184
    buffer_load_dwordx4 v17, s[36:39], s34 offen  lds
    s_add_u32 m0, s42, 24576
    s_add_u32 s34, s40, 331776
    buffer_load_dwordx4 v17, s[36:39], s34 offen  lds
    s_add_u32 m0, s42, 32768
    s_mov_b32 s34, s41
    buffer_load_dwordx4 v17, s[36:39], s34 offen  lds
    s_branch L_rot32
L_rot31:
    s_add_u32 m0, s42, 24576
    s_add_u32 s34, s40, 331776
    buffer_load_dwordx4 v17, s[36:39], s34 offen  lds
    s_add_u32 m0, s42, 32768
    s_mov_b32 s34, s41
    buffer_load_dwordx4 v17, s[36:39], s34 offen  lds
    s_add_u32 m0, s42, 0
    s_add_u32 s34, s40, 0
    buffer_load_dwordx4 v17, s[36:39], s34 offen  lds
    s_add_u32 m0, s42, 8192
    s_add_u32 s34, s40, 110592
    buffer_load_dwordx4 v17, s[36:39], s34 offen  lds
    s_add_u32 m0, s42, 16384
    s_add_u32 s34, s40, 221184
    buffer_load_dwordx4 v17, s[36:39], s34 offen  lds
L_rot32:
    s_waitcnt vmcnt(0)
    s_branch L_w1_rd
L_w1_ln:
    global_load_dwordx4 v[140:143], v11, s[4:5] offset:0
    global_load_dwordx4 v[144:147], v11, s[4:5] offset:256
    global_load_dwordx4 v[148:151], v11, s[4:5] offset:512
    global_load_dwordx4 v[152:155], v11, s[4:5] offset:768
    global_load_dwordx4 v[156:159], v11, s[4:5] offset:1024
    s_mov_b32 s35, 0
    buffer_load_dwordx4 v[160:163], v15, s[44:47], 0 offen offset:0 sc1
    buffer_load_dwordx4 v[164:167], v15, s[44:47], 0 offen offset:256 sc1
    buffer_load_dwordx4 v[168:171], v15, s[44:47], 0 offen offset:512 sc1
    buffer_load_dwordx4 v[172:175], v15, s[44:47], 0 offen offset:768 sc1
    buffer_load_dwordx4 v[176:179], v15, s[44:47], 0 offen offset:1024 sc1
    buffer_load_dwordx4 v[180:183], v15, s[44:47], 0 offen offset:1280 sc1
    buffer_load_dwordx4 v[184:187], v15, s[44:47], 0 offen offset:1536 sc1
    buffer_load_dwordx4 v[188:191], v15, s[44:47], 0 offen offset:1792 sc1
    buffer_load_dwordx4 v[192:195], v15, s[44:47], 0 offen offset:2048 sc1
    buffer_load_dwordx4 v[196:199], v15, s[44:47], 0 offen offset:2304 sc1
    s_bitcmp1_b32 s62, 0
    s_cbranch_scc1 L_rot36
    s_add_u32 m0, s42, 0
    s_add_u32 s34, s40, 0
    buffer_load_dwordx4 v17, s[36:39], s34 offen  lds
    s_add_u32 m0, s42, 8192
    s_add_u32 s34, s40, 110592
    buffer_load_dwordx4 v17, s[36:39], s34 offen  lds
    s_add_u32 m0, s42, 16384
    s_add_u32 s34, s40, 221184
    buffer_load_dwordx4 v17, s[36:39], s34 offen  lds
    s_add_u32 m0, s42, 24576
    s_add_u32 s34, s40, 331776
    buffer_load_dwordx4 v17, s[36:39], s34 offen  lds
    s_add_u32 m0, s42, 32768
    s_mov_b32 s34, s41
    buffer_load_dwordx4 v17, s[36:39], s34 offen  lds
    s_branch L_rot37
L_rot36:
    s_add_u32 m0, s42, 24576
    s_add_u32 s34, s40, 331776
    buffer_load_dwordx4 v17, s[36:39], s34 offen  lds
    s_add_u32 m0, s42, 32768
    s_mov_b32 s34, s41
    buffer_load_dwordx4 v17, s[36:39], s34 offen  lds
    s_add_u32 m0, s42, 0
    s_add_u32 s34, s40, 0
    buffer_load_dwordx4 v17, s[36:39], s34 offen  lds
    s_add_u32 m0, s42, 8192
    s_add_u32 s34, s40, 110592
    buffer_load_dwordx4 v17, s[36:39], s34 offen  lds
    s_add_u32 m0, s42, 16384
    s_add_u32 s34, s40, 221184
    buffer_load_dwordx4 v17, s[36:39], s34 offen  lds
L_rot37:
    v_and_b32 v8, 1, v0
    v_lshlrev_b32 v8, 4, v8
    v_mov_b32 v9, 0xffff
    v_lshlrev_b32 v8, v8, v9
    v_bfe_u32 v9, v0, 1, 2
    v_cmp_eq_u32 vcc, 0, v9
    s_nop 1
    v_cndmask_b32 v16, 0, v8, vcc
    v_cmp_eq_u32 vcc, 1, v9
    s_nop 1
    v_cndmask_b32 v17, 0, v8, vcc
    v_cmp_eq_u32 vcc, 2, v9
    s_nop 1
    v_cndmask_b32 v18, 0, v8, vcc
    v_cmp_eq_u32 vcc, 3, v9
    s_nop 1
    v_cndmask_b32 v19, 0, v8, vcc
    v_bfe_u32 v8, v0, 3, 1
    v_cmp_eq_u32 vcc, 0, v8
    s_nop 1
    v_cndmask_b32 v20, 0, v16, vcc
    v_xor_b32 v24, v20, v16
    v_cndmask_b32 v21, 0, v17, vcc
    v_xor_b32 v25, v21, v17
    v_cndmask_b32 v22, 0, v18, vcc
    v_xor_b32 v26, v22, v18
    v_cndmask_b32 v23, 0, v19, vcc
    v_xor_b32 v27, v23, v19
    v_and_b32 v52, 0x3f803f80, v20
    v_and_b32 v60, 0x3e803e80, v20
    v_and_b32 v53, 0x3f803f80, v21
    v_and_b32 v61, 0x3e803e80, v21
    v_and_b32 v54, 0x3f803f80, v22
    v_and_b32 v62, 0x3e803e80, v22
    v_and_b32 v55, 0x3f803f80, v23
    v_and_b32 v63, 0x3e803e80, v23
    v_and_b32 v56, 0x3f803f80, v24
    v_and_b32 v64, 0x3e803e80, v24
    v_and_b32 v57, 0x3f803f80, v25
    v_and_b32 v65, 0x3e803e80, v25
    v_and_b32 v58, 0x3f803f80, v26
    v_and_b32 v66, 0x3e803e80, v26
    v_and_b32 v59, 0x3f803f80, v27
    v_and_b32 v67, 0x3e803e80, v27
    s_mul_i32 s34, s3, 1344
    s_add_u32 s34, s34, 116736
    v_lshl_add_u32 v7, v0, 4, s34
    v_lshlrev_b32 v8, 6, v14
    v_lshl_add_u32 v8, v12, 4, v8
    v_and_b32 v9, 1, v13
    v_lshl_add_u32 v8, v9, 3, v8
    v_add_u32 v8, s34, v8
    v_lshrrev_b32 v9, 5, v0
    v_lshlrev_b32 v9, 10, v9
    v_and_b32 v6, 1, v14
    v_lshl_add_u32 v9, v6, 9, v9
    v_bfe_u32 v6, v0, 1, 1
    v_lshl_add_u32 v9, v6, 8, v9
    v_lshl_add_u32 v9, v13, 4, v9
    v_and_b32 v6, 1, v0
    v_lshl_add_u32 v9, v6, 3, v9
    v_add_u32 v9, 122112, v9
    s_lshl_b32 s34, s62, 8
    s_add_u32 s34, s34, 233472
    v_lshl_add_u32 v5, v0, 2, s34
    s_branch L_mid35
L_poll33:
    buffer_load_dwordx4 v[160:163], v15, s[44:47], 0 offen offset:0 sc1
    buffer_load_dwordx4 v[164:167], v15, s[44:47], 0 offen offset:256 sc1
    buffer_load_dwordx4 v[168:171], v15, s[44:47], 0 offen offset:512 sc1
    buffer_load_dwordx4 v[172:175], v15, s[44:47], 0 offen offset:768 sc1
    buffer_load_dwordx4 v[176:179], v15, s[44:47], 0 offen offset:1024 sc1
    buffer_load_dwordx4 v[180:183], v15, s[44:47], 0 offen offset:1280 sc1
    buffer_load_dwordx4 v[184:187], v15, s[44:47], 0 offen offset:1536 sc1
    buffer_load_dwordx4 v[188:191], v15, s[44:47], 0 offen offset:1792 sc1
    buffer_load_dwordx4 v[192:195], v15, s[44:47], 0 offen offset:2048 sc1
    buffer_load_dwordx4 v[196:199], v15, s[44:47], 0 offen offset:2304 sc1
L_mid35:
    s_add_u32 s35, s35, 1
    s_waitcnt vmcnt(0)
    v_max3_u32 v28, v160, v161, v162
    v_max3_u32 v28, v28, v163, v164
    v_max3_u32 v28, v28, v165, v166
    v_max3_u32 v28, v28, v167, v168
    v_max3_u32 v28, v28, v169, v170
    v_max3_u32 v28, v28, v171, v172
    v_max3_u32 v28, v28, v173, v174
    v_max3_u32 v28, v28, v175, v176
    v_max3_u32 v28, v28, v177, v178
    v_max3_u32 v28, v28, v179, v180
    v_max3_u32 v28, v28, v181, v182
    v_max3_u32 v28, v28, v183, v184
    v_max3_u32 v28, v28, v185, v186
    v_max3_u32 v28, v28, v187, v188
    v_max3_u32 v28, v28, v189, v190
    v_max3_u32 v28, v28, v191, v192
    v_max3_u32 v28, v28, v193, v194
    v_max3_u32 v28, v28, v195, v196
    v_max3_u32 v28, v28, v197, v198
    v_max_u32 v28, v28, v199
    v_cmp_eq_u32 vcc, -1, v28
    s_cbranch_vccz L_done34
    s_sleep 1
    s_cmp_lt_u32 s35, 60000
    s_cbranch_scc1 L_poll33
L_done34:
    v_mfma_f32_16x16x32_bf16 v[68:71], v[140:143], v[60:63], 0
    v_mfma_f32_16x16x32_bf16 v[68:71], v[144:147], v[64:67], v[68:71]
    v_mfma_f32_16x16x32_bf16 v[72:75], v[148:151], v[60:63], 0
    v_mfma_f32_16x16x32_bf16 v[72:75], v[152:155], v[64:67], v[72:75]
    v_mfma_f32_16x16x32_bf16 v[76:79], v[156:159], v[60:63], 0
    v_mfma_f32_16x16x32_bf16 v[116:119], v[160:163], v[52:55], 0
    v_mfma_f32_16x16x32_bf16 v[116:119], v[164:167], v[56:59], v[116:119]
    v_mfma_f32_16x16x32_bf16 v[120:123], v[168:171], v[52:55], 0
    v_mfma_f32_16x16x32_bf16 v[120:123], v[172:175], v[56:59], v[120:123]
    v_mfma_f32_16x16x32_bf16 v[124:127], v[176:179], v[52:55], 0
    v_mfma_f32_16x16x32_bf16 v[80:83], v[180:183], v[52:55], 1.0
    v_mfma_f32_16x16x32_bf16 v[80:83], v[184:187], v[56:59], v[80:83]
    v_mfma_f32_16x16x32_bf16 v[84:87], v[188:191], v[52:55], 1.0
    v_mfma_f32_16x16x32_bf16 v[84:87], v[192:195], v[56:59], v[84:87]
    v_mfma_f32_16x16x32_bf16 v[88:91], v[196:199], v[52:55], 1.0
    v_mul_u32_u24 v15, 5120, v14
    v_add_u32 v15, v15, v11
    v_add_u32 v15, 192512, v15
L_w1_rd:
    s_barrier
    s_lshr_b32 s34, s3, 1
    s_mul_i32 s35, s34, 320
    s_mul_i32 s34, s34, 10240
    s_and_b32 s49, s3, 1
    s_lshl_b32 s49, s49, 5
    s_add_u32 s34, s34, s49
    s_add_u32 s34, s34, 40960
    v_lshrrev_b32 v3, 2, v0
    v_lshlrev_b32 v3, 6, v3
    v_lshl_add_u32 v3, v12, 3, v3
    v_add_u32 v3, s34, v3
    ds_read_b64_tr_b16 v[32:33], v3 offset:0
    ds_read_b64_tr_b16 v[34:35], v3 offset:1024
    ds_read_b64_tr_b16 v[36:37], v3 offset:2048
    ds_read_b64_tr_b16 v[38:39], v3 offset:3072
    ds_read_b64_tr_b16 v[40:41], v3 offset:4096
    ds_read_b64_tr_b16 v[42:43], v3 offset:5120
    ds_read_b64_tr_b16 v[44:45], v3 offset:6144
    ds_read_b64_tr_b16 v[46:47], v3 offset:7168
    ds_read_b64_tr_b16 v[48:49], v3 offset:8192
    ds_read_b64_tr_b16 v[50:51], v3 offset:9216
    s_add_u32 s35, s35, 116736
    v_mul_u32_u24 v4, 1344, v12
    v_lshl_add_u32 v4, v14, 4, v4
    v_add_u32 v4, s35, v4
    s_cmp_ge_u32 s3, 4
    s_cbranch_scc1 L_w1_mm
    s_mov_b32 s35, 0
L_poll38:
    buffer_load_dwordx4 v[140:143], v15, s[44:47], 0 offen offset:0 sc1
    buffer_load_dwordx4 v[144:147], v15, s[44:47], s48 offen offset:0 sc1
    buffer_load_dwordx4 v[148:151], v15, s[44:47], 0 offen offset:256 sc1
    buffer_load_dwordx4 v[152:155], v15, s[44:47], s48 offen offset:256 sc1
    buffer_load_dwordx4 v[156:159], v15, s[44:47], 0 offen offset:512 sc1
    buffer_load_dwordx4 v[160:163], v15, s[44:47], s48 offen offset:512 sc1
    buffer_load_dwordx4 v[164:167], v15, s[44:47], 0 offen offset:768 sc1
    buffer_load_dwordx4 v[168:171], v15, s[44:47], s48 offen offset:768 sc1
    buffer_load_dwordx4 v[172:175], v15, s[44:47], 0 offen offset:1024 sc1
    buffer_load_dwordx4 v[176:179], v15, s[44:47], s48 offen offset:1024 sc1
    s_add_u32 s35, s35, 1
    s_waitcnt vmcnt(0)
    v_mfma_f32_16x16x32_bf16 v[128:131], v[140:143], v[52:55], v[68:71]
    v_max3_u32 v28, v140, v141, v142
    v_max3_u32 v28, v28, v143, v144
    v_mfma_f32_16x16x32_bf16 v[128:131], v[144:147], v[52:55], v[128:131]
    v_max3_u32 v28, v28, v145, v146
    v_max3_u32 v28, v28, v147, v148
    v_mfma_f32_16x16x32_bf16 v[128:131], v[148:151], v[56:59], v[128:131]
    v_max3_u32 v28, v28, v149, v150
    v_max3_u32 v28, v28, v151, v152
    v_mfma_f32_16x16x32_bf16 v[128:131], v[152:155], v[56:59], v[128:131]
    v_max3_u32 v28, v28, v153, v154
    v_max3_u32 v28, v28, v155, v156
    v_mfma_f32_16x16x32_bf16 v[132:135], v[156:159], v[52:55], v[72:75]
    v_max3_u32 v28, v28, v157, v158
    v_max3_u32 v28, v28, v159, v160
    v_mfma_f32_16x16x32_bf16 v[132:135], v[160:163], v[52:55], v[132:135]
    v_max3_u32 v28, v28, v161, v162
    v_max3_u32 v28, v28, v163, v164
    v_mfma_f32_16x16x32_bf16 v[132:135], v[164:167], v[56:59], v[132:135]
    v_max3_u32 v28, v28, v165, v166
    v_max3_u32 v28, v28, v167, v168
    v_mfma_f32_16x16x32_bf16 v[132:135], v[168:171], v[56:59], v[132:135]
    v_max3_u32 v28, v28, v169, v170
    v_max3_u32 v28, v28, v171, v172
    v_mfma_f32_16x16x32_bf16 v[136:139], v[172:175], v[52:55], v[76:79]
    v_max3_u32 v28, v28, v173, v174
    v_max3_u32 v28, v28, v175, v176
    v_mfma_f32_16x16x32_bf16 v[136:139], v[176:179], v[52:55], v[136:139]
    v_max3_u32 v28, v28, v177, v178
    v_max_u32 v28, v28, v179
    v_cmp_eq_u32 vcc, -1, v28
    s_cbranch_vccz L_done39
    s_cmp_lt_u32 s35, 60000
    s_nop 7
    s_cbranch_scc1 L_poll38
L_done39:
    v_pk_add_f32 v[20:21], v[128:129], v[130:131]
    v_pk_mul_f32 v[22:23], v[128:129], v[128:129]
    v_pk_fma_f32 v[22:23], v[130:131], v[130:131], v[22:23]
    v_pk_add_f32 v[20:21], v[20:21], v[132:133]
    v_pk_fma_f32 v[22:23], v[132:133], v[132:133], v[22:23]
    v_pk_add_f32 v[20:21], v[20:21], v[134:135]
    v_pk_fma_f32 v[22:23], v[134:135], v[134:135], v[22:23]
    v_pk_add_f32 v[20:21], v[20:21], v[136:137]
    v_pk_fma_f32 v[22:23], v[136:137], v[136:137], v[22:23]
    v_pk_add_f32 v[20:21], v[20:21], v[138:139]
    v_pk_fma_f32 v[22:23], v[138:139], v[138:139], v[22:23]
    v_add_f32 v20, v20, v21
    v_add_f32 v21, v22, v23
    s_nop 0
    v_add_f32_dpp v20, v20, v20 row_ror:8 row_mask:0xf bank_mask:0xf
    v_add_f32_dpp v21, v21, v21 row_ror:8 row_mask:0xf bank_mask:0xf
    s_nop 0
    v_add_f32_dpp v20, v20, v20 row_ror:4 row_mask:0xf bank_mask:0xf
    v_add_f32_dpp v21, v21, v21 row_ror:4 row_mask:0xf bank_mask:0xf
    s_nop 0
    v_add_f32_dpp v20, v20, v20 row_ror:2 row_mask:0xf bank_mask:0xf
    v_add_f32_dpp v21, v21, v21 row_ror:2 row_mask:0xf bank_mask:0xf
    s_nop 0
    v_add_f32_dpp v20, v20, v20 row_ror:1 row_mask:0xf bank_mask:0xf
    v_add_f32_dpp v21, v21, v21 row_ror:1 row_mask:0xf bank_mask:0xf
    v_mov_b32 v22, v20
    v_mov_b32 v23, v21
    s_nop 0
    v_permlane16_swap_b32 v20, v22
    v_permlane16_swap_b32 v21, v23
    v_add_f32 v20, v20, v22
    v_add_f32 v21, v21, v23
    v_mov_b32 v22, v20
    v_mov_b32 v23, v21
    s_nop 0
    v_permlane32_swap_b32 v20, v22
    v_permlane32_swap_b32 v21, v23
    v_add_f32 v20, v20, v22
    v_add_f32 v21, v21, v23
    v_mul_f32 v22, 0x3acccccd, v20
    v_mul_f32 v21, 0x3acccccd, v21
    v_fma_f32 v21, -v22, v22, v21
    v_max_f32 v21, 0, v21
    v_add_f32 v21, 0x3727c5ac, v21
    v_rsq_f32 v20, v21
    s_nop 0
    v_mul_f32_e64 v21, -v22, v20
    v_pk_fma_f32 v[128:129], v[128:129], v[20:21], v[20:21] op_sel:[0,0,1] op_sel_hi:[1,0,1]
    v_pk_fma_f32 v[130:131], v[130:131], v[20:21], v[20:21] op_sel:[0,0,1] op_sel_hi:[1,0,1]
    v_pk_fma_f32 v[132:133], v[132:133], v[20:21], v[20:21] op_sel:[0,0,1] op_sel_hi:[1,0,1]
    v_pk_fma_f32 v[134:135], v[134:135], v[20:21], v[20:21] op_sel:[0,0,1] op_sel_hi:[1,0,1]
    v_pk_fma_f32 v[136:137], v[136:137], v[20:21], v[20:21] op_sel:[0,0,1] op_sel_hi:[1,0,1]
    v_pk_fma_f32 v[138:139], v[138:139], v[20:21], v[20:21] op_sel:[0,0,1] op_sel_hi:[1,0,1]
    v_pk_fma_f32 v[128:129], v[128:129], v[80:81], v[116:117]
    v_pk_fma_f32 v[130:131], v[130:131], v[82:83], v[118:119]
    v_pk_fma_f32 v[132:133], v[132:133], v[84:85], v[120:121]
    v_pk_fma_f32 v[134:135], v[134:135], v[86:87], v[122:123]
    v_pk_fma_f32 v[136:137], v[136:137], v[88:89], v[124:125]
    v_pk_fma_f32 v[138:139], v[138:139], v[90:91], v[126:127]
    v_cvt_pk_bf16_f32 v20, v128, v129
    v_cvt_pk_bf16_f32 v21, v130, v131
    v_cvt_pk_bf16_f32 v22, v132, v133
    v_cvt_pk_bf16_f32 v23, v134, v135
    v_cvt_pk_bf16_f32 v24, v136, v137
    v_cvt_pk_bf16_f32 v25, v138, v139
    ds_write_b128 v7, v[20:23]
    s_mov_b32 exec_lo, 0x00ff00ff
    s_mov_b32 exec_hi, 0x00ff00ff
    ds_write_b64 v8, v[24:25] offset:1024
    s_mov_b64 exec, -1
L_w1_mm:
    s_waitcnt lgkmcnt(0)
    s_barrier
    ds_read_b128 v[140:143], v4 offset:0
    ds_read_b128 v[144:147], v4 offset:64
    ds_read_b128 v[148:151], v4 offset:128
    ds_read_b128 v[152:155], v4 offset:192
    ds_read_b128 v[156:159], v4 offset:256
    s_waitcnt lgkmcnt(4)
    v_mfma_f32_16x16x32_bf16 v[20:23], v[32:35], v[140:143], 0
    s_waitcnt lgkmcnt(3)
    v_mfma_f32_16x16x32_bf16 v[20:23], v[36:39], v[144:147], v[20:23]
    s_waitcnt lgkmcnt(2)
    v_mfma_f32_16x16x32_bf16 v[20:23], v[40:43], v[148:151], v[20:23]
    s_waitcnt lgkmcnt(1)
    v_mfma_f32_16x16x32_bf16 v[20:23], v[44:47], v[152:155], v[20:23]
    s_waitcnt lgkmcnt(0)
    v_mfma_f32_16x16x32_bf16 v[20:23], v[48:51], v[156:159], v[20:23]
    s_nop 7
    ds_write_b128 v2, v[20:23]
    s_waitcnt lgkmcnt(0)
    s_barrier
    s_cmp_lg_u32 s3, 0
    s_cbranch_scc1 L_fin
    ds_read_b64 v[20:21], v9 offset:0
    ds_read_b64 v[22:23], v9 offset:2048
    ds_read_b64 v[24:25], v9 offset:4096
    ds_read_b64 v[26:27], v9 offset:6144
    s_mov_b32 s34, 0xbdd2d3e8
    v_mov_b32 v10, 0xc0135761
    s_waitcnt lgkmcnt(3)
    v_pk_add_f32 v[100:101], v[100:101], v[20:21]
    s_waitcnt lgkmcnt(2)
    v_pk_add_f32 v[100:101], v[100:101], v[22:23]
    s_waitcnt lgkmcnt(1)
    v_pk_add_f32 v[100:101], v[100:101], v[24:25]
    s_waitcnt lgkmcnt(0)
    v_pk_add_f32 v[100:101], v[100:101], v[26:27]
    v_pk_mul_f32 v[20:21], v[100:101], v[100:101]
    v_fma_f32 v20, v20, s34, v10
    v_fma_f32 v21, v21, s34, v10
    v_pk_mul_f32 v[20:21], v[20:21], v[100:101]
    v_exp_f32 v20, v20
    v_exp_f32 v21, v21
    v_add_f32 v20, 1.0, v20
    v_add_f32 v21, 1.0, v21
    v_rcp_f32 v20, v20
    v_rcp_f32 v21, v21
    s_nop 0
    v_pk_mul_f32 v[20:21], v[20:21], v[100:101]
    v_cvt_pk_bf16_f32 v20, v20, v21
    v_min_u32 v20, -2, v20
    buffer_store_dword v20, v5, s[44:47], 0 offen sc1
    s_branch L_fin
L_t_w2:
    s_cmp_eq_u32 s3, 0
    s_cbranch_scc1 L_w2_red
    s_mov_b32 s36, s20
    s_mov_b32 s37, s21
    s_mov_b32 s38, 2211840
    v_bfe_u32 v5, v0, 3, 2
    v_lshlrev_b32 v10, 3, v5
    v_lshrrev_b32 v5, 5, v0
    v_lshl_add_u32 v10, v5, 2, v10
    v_bfe_u32 v5, v0, 1, 2
    v_add_u32 v10, v10, v5
    v_and_b32 v11, 1, v0
    s_sub_u32 s49, s3, 1
    v_mul_u32_u24 v17, 1280, v10
    v_lshl_add_u32 v17, v11, 4, v17
    s_lshl_b32 s34, s62, 5
    s_mul_i32 s35, s49, 327680
    s_add_u32 s34, s34, s35
    v_add_u32 v17, s34, v17
    s_lshl_b32 s42, s49, 13
    s_add_u32 s42, s42, 40960
    v_lshl_add_u32 v3, v0, 3, s42
    s_lshl_b32 s40, s62, 1
    s_add_u32 s41, s40, 8
    s_barrier
L_w2_dma:
    s_and_b32 s34, s40, 7
    s_lshl_b32 s35, s34, 10
    s_add_u32 m0, s42, s35
    s_mul_i32 s34, s34, 40960
    buffer_load_dwordx4 v17, s[36:39], s34 offen  lds
    s_add_u32 s40, s40, 1
    s_cmp_lt_u32 s40, s41
    s_cbranch_scc1 L_w2_dma
    s_lshl_b32 s34, s49, 3
    v_add_u32 v4, s34, v13
    v_add_u32 v5, 4, v4
    v_min_u32 v5, 53, v5
    v_lshlrev_b32 v6, 6, v14
    v_lshl_add_u32 v6, v12, 4, v6
    v_add_u32 v6, 233472, v6
    v_lshl_add_u32 v4, v4, 8, v6
    v_lshl_add_u32 v5, v5, 8, v6
    s_waitcnt vmcnt(0)
    ds_read_b64_tr_b16 v[32:33], v3 offset:0
    ds_read_b64_tr_b16 v[34:35], v3 offset:512
    ds_read_b64_tr_b16 v[36:37], v3 offset:1024
    ds_read_b64_tr_b16 v[38:39], v3 offset:1536
    ds_read_b64_tr_b16 v[40:41], v3 offset:2048
    ds_read_b64_tr_b16 v[42:43], v3 offset:2560
    ds_read_b64_tr_b16 v[44:45], v3 offset:3072
    ds_read_b64_tr_b16 v[46:47], v3 offset:3584
    s_waitcnt lgkmcnt(0)
    ds_read_b64_tr_b16 v[48:49], v3 offset:4096
    ds_read_b64_tr_b16 v[50:51], v3 offset:4608
    ds_read_b64_tr_b16 v[52:53], v3 offset:5120
    ds_read_b64_tr_b16 v[54:55], v3 offset:5632
    ds_read_b64_tr_b16 v[56:57], v3 offset:6144
    ds_read_b64_tr_b16 v[58:59], v3 offset:6656
    ds_read_b64_tr_b16 v[60:61], v3 offset:7168
    ds_read_b64_tr_b16 v[62:63], v3 offset:7680
    s_waitcnt lgkmcnt(0)
    s_mov_b32 s35, 0
L_poll41:
    buffer_load_dwordx4 v[64:67], v4, s[44:47], 0 offen sc1
    buffer_load_dwordx4 v[68:71], v5, s[44:47], 0 offen sc1
    s_add_u32 s35, s35, 1
    s_waitcnt vmcnt(0)
    v_mfma_f32_16x16x32_bf16 v[80:83], v[32:35], v[64:67], 0
    v_max3_u32 v28, v64, v65, v66
    v_mfma_f32_16x16x32_bf16 v[84:87], v[36:39], v[64:67], 0
    v_max3_u32 v28, v28, v67, v68
    v_mfma_f32_16x16x32_bf16 v[88:91], v[40:43], v[64:67], 0
    v_max3_u32 v28, v28, v69, v70
    v_mfma_f32_16x16x32_bf16 v[92:95], v[44:47], v[64:67], 0
    v_max_u32 v28, v28, v71
    v_mfma_f32_16x16x32_bf16 v[80:83], v[48:51], v[68:71], v[80:83]
    v_mfma_f32_16x16x32_bf16 v[84:87], v[52:55], v[68:71], v[84:87]
    v_mfma_f32_16x16x32_bf16 v[88:91], v[56:59], v[68:71], v[88:91]
    v_mfma_f32_16x16x32_bf16 v[92:95], v[60:63], v[68:71], v[92:95]
    v_cmp_eq_u32 vcc, -1, v28
    s_cbranch_vccz L_done42
    s_cmp_lt_u32 s35, 60000
    s_nop 7
    s_cbranch_scc1 L_poll41
L_done42:
    s_nop 3
    v_mov_b32_dpp v80, v84 quad_perm:[0,1,2,3] row_mask:0xf bank_mask:0x2
    v_mov_b32_dpp v81, v85 quad_perm:[0,1,2,3] row_mask:0xf bank_mask:0x2
    v_mov_b32_dpp v82, v86 quad_perm:[0,1,2,3] row_mask:0xf bank_mask:0x2
    v_mov_b32_dpp v83, v87 quad_perm:[0,1,2,3] row_mask:0xf bank_mask:0x2
    v_mov_b32_dpp v80, v88 quad_perm:[0,1,2,3] row_mask:0xf bank_mask:0x4
    v_mov_b32_dpp v81, v89 quad_perm:[0,1,2,3] row_mask:0xf bank_mask:0x4
    v_mov_b32_dpp v82, v90 quad_perm:[0,1,2,3] row_mask:0xf bank_mask:0x4
    v_mov_b32_dpp v83, v91 quad_perm:[0,1,2,3] row_mask:0xf bank_mask:0x4
    v_mov_b32_dpp v80, v92 quad_perm:[0,1,2,3] row_mask:0xf bank_mask:0x8
    v_mov_b32_dpp v81, v93 quad_perm:[0,1,2,3] row_mask:0xf bank_mask:0x8
    v_mov_b32_dpp v82, v94 quad_perm:[0,1,2,3] row_mask:0xf bank_mask:0x8
    v_mov_b32_dpp v83, v95 quad_perm:[0,1,2,3] row_mask:0xf bank_mask:0x8
    ds_write_b128 v2, v[80:83]
    s_waitcnt lgkmcnt(0)
    s_barrier
    s_branch L_fin
L_w2_red:
    s_barrier
    v_mul_u32_u24 v5, 5120, v13
    v_add_u32 v5, v5, v112
    v_add_u32 v5, 192512, v5
    s_mov_b32 s35, 0
L_poll44:
    buffer_load_dwordx2 v[20:21], v5, s[44:47], 0 offen sc1
    buffer_load_dwordx2 v[22:23], v5, s[44:47], s48 offen sc1
    s_add_u32 s35, s35, 1
    s_waitcnt vmcnt(0)
    v_max3_u32 v28, v20, v21, v22
    v_max_u32 v28, v28, v23
    v_cmp_eq_u32 vcc, -1, v28
    s_cbranch_vccz L_done45
    s_sleep 4
    s_cmp_lt_u32 s35, 60000
    s_cbranch_scc1 L_poll44
L_done45:
    v_lshlrev_b32 v44, 16, v20
    v_and_b32 v45, 0xffff0000, v20
    v_lshlrev_b32 v46, 16, v21
    v_and_b32 v47, 0xffff0000, v21
    v_lshlrev_b32 v48, 16, v22
    v_and_b32 v49, 0xffff0000, v22
    v_lshlrev_b32 v50, 16, v23
    v_and_b32 v51, 0xffff0000, v23
    v_add_f32 v108, v108, v44
    v_add_f32 v109, v109, v45
    v_add_f32 v110, v110, v46
    v_add_f32 v111, v111, v47
    v_add_f32 v108, v108, v48
    v_add_f32 v109, v109, v49
    v_add_f32 v110, v110, v50
    v_add_f32 v111, v111, v51
    s_barrier
    ds_read_b128 v[64:67], v2 offset:1024
    ds_read_b128 v[68:71], v2 offset:2048
    ds_read_b128 v[72:75], v2 offset:3072
    ds_read_b128 v[76:79], v2 offset:4096
    ds_read_b128 v[80:83], v2 offset:5120
    ds_read_b128 v[84:87], v2 offset:6144
    ds_read_b128 v[88:91], v2 offset:7168
    s_waitcnt lgkmcnt(5)
    v_pk_add_f32 v[64:65], v[64:65], v[68:69]
    v_pk_add_f32 v[66:67], v[66:67], v[70:71]
    s_waitcnt lgkmcnt(4)
    v_pk_add_f32 v[64:65], v[64:65], v[72:73]
    v_pk_add_f32 v[66:67], v[66:67], v[74:75]
    s_waitcnt lgkmcnt(3)
    v_pk_add_f32 v[64:65], v[64:65], v[76:77]
    v_pk_add_f32 v[66:67], v[66:67], v[78:79]
    s_waitcnt lgkmcnt(2)
    v_pk_add_f32 v[64:65], v[64:65], v[80:81]
    v_pk_add_f32 v[66:67], v[66:67], v[82:83]
    s_waitcnt lgkmcnt(1)
    v_pk_add_f32 v[64:65], v[64:65], v[84:85]
    v_pk_add_f32 v[66:67], v[66:67], v[86:87]
    s_waitcnt lgkmcnt(0)
    v_pk_add_f32 v[64:65], v[64:65], v[88:89]
    v_pk_add_f32 v[66:67], v[66:67], v[90:91]
    v_pk_fma_f32 v[64:65], v[64:65], v[104:105], v[108:109]
    v_pk_fma_f32 v[66:67], v[66:67], v[106:107], v[110:111]
    s_nop 0
    v_add_f32_dpp v64, v64, v64 row_ror:4 row_mask:0xf bank_mask:0xf
    v_add_f32_dpp v65, v65, v65 row_ror:4 row_mask:0xf bank_mask:0xf
    v_add_f32_dpp v66, v66, v66 row_ror:4 row_mask:0xf bank_mask:0xf
    v_add_f32_dpp v67, v67, v67 row_ror:4 row_mask:0xf bank_mask:0xf
    v_add_f32_dpp v64, v64, v64 row_ror:8 row_mask:0xf bank_mask:0xf
    v_add_f32_dpp v65, v65, v65 row_ror:8 row_mask:0xf bank_mask:0xf
    v_add_f32_dpp v66, v66, v66 row_ror:8 row_mask:0xf bank_mask:0xf
    v_add_f32_dpp v67, v67, v67 row_ror:8 row_mask:0xf bank_mask:0xf
    v_cvt_pk_bf16_f32 v20, v64, v65
    v_cvt_pk_bf16_f32 v21, v66, v67
    s_mov_b32 exec_lo, 0x000f000f
    s_mov_b32 exec_hi, 0x000f000f
    global_store_dwordx2 v112, v[20:21], s[28:29]
    s_mov_b64 exec, -1
    s_branch L_fin
L_t_wo:
    s_mov_b32 s36, s12
    s_mov_b32 s37, s13
    s_mov_b32 s38, 5242880
    s_lshr_b32 s40, s3, 1
    s_lshl_b32 s40, s40, 3
    s_add_u32 s40, s40, s60
    s_and_b32 s41, s3, 1
    s_lshl_b32 s34, s40, 1
    s_add_u32 s34, s34, s41
    s_mul_i32 s34, s34, 81920
    s_lshl_b32 s35, s62, 6
    s_add_u32 s34, s34, s35
    v_lshl_add_u32 v3, v13, 2, v14
    v_mul_u32_u24 v3, 2560, v3
    v_lshl_add_u32 v3, v12, 4, v3
    v_add_u32 v3, s34, v3
    v_add_u32 v6, 256, v3
    s_lshl_b32 s42, s3, 12
    s_add_u32 s42, s42, 40960
    s_and_b32 s34, s62, 1
    s_lshl_b32 s35, s34, 11
    s_add_u32 m0, s42, s35
    s_mul_i32 s34, s34, 40960
    v_and_b32 v4, 7, v0
    s_lshl_b32 s49, s40, 7
    s_add_u32 s49, s49, 188416
    v_lshl_add_u32 v5, v4, 2, s49
    s_lshl_b32 s49, s40, 11
    s_lshl_b32 s41, s41, 7
    s_add_u32 s49, s49, s41
    s_add_u32 s49, s49, 122880
    v_lshrrev_b32 v10, 3, v0
    v_lshlrev_b32 v11, 8, v10
    v_lshl_add_u32 v11, v4, 4, v11
    v_add_u32 v11, s49, v11
    s_barrier
    buffer_load_dwordx4 v3, s[36:39], s34 offen  lds
    buffer_load_dwordx4 v6, s[36:39], s34 offen offset:1024  lds
    s_xor_b32 m0, m0, 2048
    s_sub_u32 s34, 40960, s34
    buffer_load_dwordx4 v3, s[36:39], s34 offen  lds
    buffer_load_dwordx4 v6, s[36:39], s34 offen offset:1024  lds
    s_mov_b32 s35, 0
    buffer_load_dwordx4 v[64:67], v11, s[44:47], 0 offen sc1
    buffer_load_dword v24, v5, s[44:47], 0 offen sc1
    v_lshrrev_b32 v3, 2, v0
    v_lshlrev_b32 v3, 6, v3
    v_lshl_add_u32 v3, v12, 3, v3
    v_add_u32 v3, s42, v3
    s_mul_i32 s34, s3, 1152
    s_add_u32 s34, s34, 107520
    v_mul_u32_u24 v15, 144, v10
    v_lshl_add_u32 v15, v4, 4, v15
    v_add_u32 v15, s34, v15
    v_mul_u32_u24 v16, 144, v4
    v_lshl_add_u32 v16, v14, 4, v16
    v_add_u32 v16, s34, v16
    v_bfe_u32 v7, v0, 3, 1
    v_mov_b32 v18, 98816
    v_cmp_eq_u32 vcc, 0, v7
    s_nop 1
    v_cndmask_b32 v17, v16, v18, vcc
    v_cndmask_b32 v16, v18, v16, vcc
    s_waitcnt vmcnt(2)
    ds_read_b64_tr_b16 v[32:33], v3 offset:0
    ds_read_b64_tr_b16 v[34:35], v3 offset:1024
    ds_read_b64_tr_b16 v[36:37], v3 offset:32
    ds_read_b64_tr_b16 v[38:39], v3 offset:1056
    ds_read_b64_tr_b16 v[40:41], v3 offset:2048
    ds_read_b64_tr_b16 v[42:43], v3 offset:3072
    ds_read_b64_tr_b16 v[44:45], v3 offset:2080
    ds_read_b64_tr_b16 v[46:47], v3 offset:3104
    s_branch L_mid49
L_poll47:
    buffer_load_dwordx4 v[64:67], v11, s[44:47], 0 offen sc1
    buffer_load_dword v24, v5, s[44:47], 0 offen sc1
L_mid49:
    s_add_u32 s35, s35, 1
    s_waitcnt vmcnt(0)
    ds_write_b128 v15, v[64:67]
    v_max3_u32 v28, v64, v65, v66
    v_max3_u32 v28, v28, v67, v24
    v_cmp_eq_u32 vcc, -1, v28
    s_cbranch_vccz L_done48
    s_cmp_lt_u32 s35, 60000
    s_nop 7
    s_cbranch_scc1 L_poll47
L_done48:
    ds_read_b128 v[68:71], v16 offset:0
    ds_read_b128 v[72:75], v17 offset:0
    ds_read_b128 v[76:79], v16 offset:64
    ds_read_b128 v[80:83], v17 offset:64
    v_sub_f32_dpp v24, v24, v24 quad_perm:[1,0,3,2] row_mask:0xf bank_mask:0xf
    v_exp_f32 v24, v24
    s_nop 0
    v_add_f32 v24, 1.0, v24
    v_rcp_f32 v24, v24
    s_waitcnt lgkmcnt(3)
    v_mfma_f32_16x16x32_bf16 v[20:23], v[32:35], v[68:71], 0
    s_waitcnt lgkmcnt(2)
    v_mfma_f32_16x16x32_bf16 v[20:23], v[36:39], v[72:75], v[20:23]
    s_waitcnt lgkmcnt(1)
    v_mfma_f32_16x16x32_bf16 v[20:23], v[40:43], v[76:79], v[20:23]
    s_waitcnt lgkmcnt(0)
    v_mfma_f32_16x16x32_bf16 v[20:23], v[44:47], v[80:83], v[20:23]
    s_nop 7
    v_pk_mul_f32 v[20:21], v[20:21], v[24:25] op_sel_hi:[1,0]
    v_pk_mul_f32 v[22:23], v[22:23], v[24:25] op_sel_hi:[1,0]
    ds_write_b128 v2, v[20:23]
    s_waitcnt lgkmcnt(0)
    s_barrier
    s_cmp_lg_u32 s3, 0
    s_cbranch_scc1 L_fin
    ds_read_b128 v[68:71], v2 offset:1024
    ds_read_b128 v[72:75], v2 offset:2048
    ds_read_b128 v[76:79], v2 offset:3072
    ds_read_b128 v[80:83], v2 offset:4096
    ds_read_b128 v[84:87], v2 offset:5120
    ds_read_b128 v[88:91], v2 offset:6144
    ds_read_b128 v[92:95], v2 offset:7168
    s_waitcnt lgkmcnt(6)
    v_pk_add_f32 v[20:21], v[20:21], v[68:69]
    v_pk_add_f32 v[22:23], v[22:23], v[70:71]
    s_waitcnt lgkmcnt(5)
    v_pk_add_f32 v[20:21], v[20:21], v[72:73]
    v_pk_add_f32 v[22:23], v[22:23], v[74:75]
    s_waitcnt lgkmcnt(4)
    v_pk_add_f32 v[20:21], v[20:21], v[76:77]
    v_pk_add_f32 v[22:23], v[22:23], v[78:79]
    s_waitcnt lgkmcnt(3)
    v_pk_add_f32 v[20:21], v[20:21], v[80:81]
    v_pk_add_f32 v[22:23], v[22:23], v[82:83]
    s_waitcnt lgkmcnt(2)
    v_pk_add_f32 v[20:21], v[20:21], v[84:85]
    v_pk_add_f32 v[22:23], v[22:23], v[86:87]
    s_waitcnt lgkmcnt(1)
    v_pk_add_f32 v[20:21], v[20:21], v[88:89]
    v_pk_add_f32 v[22:23], v[22:23], v[90:91]
    s_waitcnt lgkmcnt(0)
    v_pk_add_f32 v[20:21], v[20:21], v[92:93]
    v_pk_add_f32 v[22:23], v[22:23], v[94:95]
    v_pk_mul_f32 v[20:21], v[20:21], v[100:101]
    v_pk_mul_f32 v[22:23], v[22:23], v[102:103]
    s_nop 0
    v_add_f32_dpp v20, v20, v20 quad_perm:[1,0,3,2] row_mask:0xf bank_mask:0xf
    v_add_f32_dpp v21, v21, v21 quad_perm:[1,0,3,2] row_mask:0xf bank_mask:0xf
    v_add_f32_dpp v22, v22, v22 quad_perm:[1,0,3,2] row_mask:0xf bank_mask:0xf
    v_add_f32_dpp v23, v23, v23 quad_perm:[1,0,3,2] row_mask:0xf bank_mask:0xf
    v_cvt_pk_bf16_f32 v24, v20, v21
    v_cvt_pk_bf16_f32 v25, v22, v23
    v_min_u32 v24, -2, v24
    v_min_u32 v25, -2, v25
    s_mov_b32 exec_lo, 0x55555555
    s_mov_b32 exec_hi, 0x55555555
    buffer_store_dwordx2 v[24:25], v112, s[44:47], 0 offen sc1
    s_mov_b64 exec, -1
L_t_none:
L_fin:
L_exit:
    s_endpgm
L_codeend:
.section .rodata,"a"
.p2align 6
.amdhsa_kernel adaLN_cond__sliding_block_cached__dense_activation_gelu__decode_kernel
  .amdhsa_next_free_vgpr 256
  .amdhsa_next_free_sgpr 102
  .amdhsa_accum_offset 256
  .amdhsa_group_segment_fixed_size 0
  .amdhsa_kernarg_size 120
  .amdhsa_user_sgpr_count 2
  .amdhsa_user_sgpr_kernarg_segment_ptr 1
  .amdhsa_system_sgpr_workgroup_id_x 1
  .amdhsa_float_denorm_mode_32 3
.end_amdhsa_kernel
```

```asm
; @launch grid=(256,1,1) block=(512,1,1) lds=131328
.amdgcn_target "amdgcn-amd-amdhsa--gfx950"
.text
.globl adaLN_cond__sliding_block_cached__dense_activation_gelu__decode_kernel
.p2align 8
.type adaLN_cond__sliding_block_cached__dense_activation_gelu__decode_kernel,@function
adaLN_cond__sliding_block_cached__dense_activation_gelu__decode_kernel:
    s_cmp_ge_u32 s2, 256
    s_cbranch_scc1 L_exit
    s_load_dwordx16 s[4:19], s[0:1], 0
    s_load_dwordx8 s[20:27], s[0:1], 64
    s_load_dwordx4 s[28:31], s[0:1], 96
    s_load_dwordx2 s[32:33], s[0:1], 112
    v_lshrrev_b32 v1, 6, v0
    v_and_b32 v0, 63, v0
    v_readfirstlane_b32 s3, v1
    s_and_b32 s60, s2, 7
    s_lshr_b32 s61, s2, 3
    s_mov_b32 s39, 0x20000
    s_mov_b32 s43, 0x20000
    s_mov_b32 s46, 495616
    s_mov_b32 s47, 0x20000
    s_cmp_lg_u32 s3, 0
    s_cbranch_scc1 L_stream
    s_setprio 3
    v_and_b32 v12, 3, v0
    v_bfe_u32 v13, v0, 2, 2
    v_lshrrev_b32 v14, 4, v0
    v_lshrrev_b32 v10, 3, v0
    v_and_b32 v11, 7, v0
    v_lshlrev_b32 v11, 4, v11
    s_lshr_b32 s50, s2, 2
    s_and_b32 s51, s2, 3
    s_mul_i32 s34, s51, 1228800
    s_lshl_b32 s35, s50, 7
    s_add_u32 s34, s34, s35
    v_mul_u32_u24 v17, 7680, v10
    v_add3_u32 v17, v17, v11, s34
    v_mul_u32_u24 v16, 1280, v12
    v_lshl_add_u32 v18, v14, 4, v16
    s_mul_i32 s34, s51, 320
    v_add_u32 v19, s34, v18
    s_mov_b32 s38, 4915200
    s_sub_u32 s52, s50, 10
    s_waitcnt lgkmcnt(0)
    s_add_u32 s44, s32, 0
    s_addc_u32 s45, s33, 0
    s_cmp_ge_u32 s2, 240
    s_cbranch_scc1 L_clear
    s_cmp_ge_u32 s52, 10
    s_cbranch_scc1 L_nox
    v_lshl_add_u32 v18, v13, 6, v18
    global_load_dwordx4 v[52:55], v18, s[4:5] offset:0
    global_load_dwordx4 v[56:59], v18, s[4:5] offset:256
    global_load_dwordx4 v[60:63], v18, s[4:5] offset:512
    global_load_dwordx4 v[64:67], v18, s[4:5] offset:768
    global_load_dwordx4 v[68:71], v18, s[4:5] offset:1024
    s_lshl_b32 s34, s52, 7
    v_lshl_add_u32 v16, v13, 5, v16
    v_lshl_add_u32 v16, v14, 3, v16
    v_add_u32 v16, s34, v16
    global_load_dwordx2 v[72:73], v16, s[4:5]
L_nox:
    global_load_dwordx4 v[32:35], v19, s[24:25] offset:0
    global_load_dwordx4 v[36:39], v19, s[24:25] offset:64
    global_load_dwordx4 v[40:43], v19, s[24:25] offset:128
    global_load_dwordx4 v[44:47], v19, s[24:25] offset:192
    global_load_dwordx4 v[48:51], v19, s[24:25] offset:256
    s_mov_b32 s36, s26
    s_mov_b32 s37, s27
    s_mov_b32 m0, 0
    s_mov_b32 s34, 0
L_dma1:
    buffer_load_dwordx4 v17, s[36:39], s34 offen  lds
    s_add_u32 m0, m0, 1024
    s_add_u32 s34, s34, 61440
    buffer_load_dwordx4 v17, s[36:39], s34 offen  lds
    s_add_u32 m0, m0, 1024
    s_add_u32 s34, s34, 61440
    buffer_load_dwordx4 v17, s[36:39], s34 offen  lds
    s_add_u32 m0, m0, 1024
    s_add_u32 s34, s34, 61440
    buffer_load_dwordx4 v17, s[36:39], s34 offen  lds
    s_add_u32 m0, m0, 1024
    s_add_u32 s34, s34, 61440
    s_cmp_lt_u32 s34, 1228800
    s_cbranch_scc1 L_dma1
    v_lshlrev_b32 v1, 2, v0
    v_add_u32 v1, 98304, v1
    v_mov_b32 v2, -1
    v_mov_b32 v3, 0
    ds_write_b32 v1, v2
    ds_write_b32 v1, v2 offset:256
    ds_write_b32 v1, v3 offset:512
    ds_write_b32 v1, v3 offset:768
    s_waitcnt lgkmcnt(0)
    s_barrier
    s_getpc_b64 s[56:57]
L_pc2:
    s_sub_u32 s56, s56, L_pc2-adaLN_cond__sliding_block_cached__dense_activation_gelu__decode_kernel
    s_subb_u32 s57, s57, 0
    s_lshl_b32 s34, s61, 10
    v_lshl_add_u32 v9, v0, 4, s34
    v_min_u32 v9, L_codeend-adaLN_cond__sliding_block_cached__dense_activation_gelu__decode_kernel-16, v9
    global_load_dwordx4 v[76:79], v9, s[56:57]
    v_lshlrev_b32 v9, 21, v0
    s_mov_b64 exec, 7
    global_load_dword v76, v9, s[12:13]
    s_mov_b64 exec, 3
    global_load_dword v76, v9, s[16:17]
    global_load_dword v76, v9, s[20:21]
    s_mov_b64 exec, 1
    global_load_dword v76, v9, s[28:29]
    global_load_dword v76, v9, s[18:19]
    global_load_dword v76, v9, s[22:23]
    global_load_dword v76, v9, s[4:5]
    s_mov_b64 exec, -1
    s_and_b32 s34, s2, 31
    s_lshl_b32 s34, s34, 8
    s_lshr_b32 s35, s2, 7
    s_lshl_b32 s35, s35, 7
    s_add_u32 s49, s34, s35
    s_bfe_u32 s53, s2, 0x20005
    s_mul_i32 s34, s53, 1310720
    s_add_u32 s34, s34, s49
    v_lshl_add_u32 v16, v10, 13, v11
    v_add_u32 v16, s34, v16
    s_mov_b32 s36, s10
    s_mov_b32 s37, s11
    s_mov_b32 s38, 5242880
    s_mov_b32 m0, 20480
    s_mov_b32 s34, 0
L_dma3:
    buffer_load_dwordx4 v16, s[36:39], s34 offen  lds
    s_add_u32 m0, m0, 1024
    s_add_u32 s34, s34, 65536
    buffer_load_dwordx4 v16, s[36:39], s34 offen  lds
    s_add_u32 m0, m0, 1024
    s_add_u32 s34, s34, 65536
    buffer_load_dwordx4 v16, s[36:39], s34 offen  lds
    s_add_u32 m0, m0, 1024
    s_add_u32 s34, s34, 65536
    buffer_load_dwordx4 v16, s[36:39], s34 offen  lds
    s_add_u32 m0, m0, 1024
    s_add_u32 s34, s34, 65536
    s_cmp_lt_u32 s34, 1310720
    s_cbranch_scc1 L_dma3
    v_lshl_add_u32 v15, v14, 3, v13
    v_lshlrev_b32 v15, 7, v15
    v_lshl_add_u32 v15, v12, 3, v15
    s_waitcnt vmcnt(48)
    s_mov_b32 s34, 0xbfb8aa3b
    v_lshlrev_b32 v20, 16, v32
    v_and_b32 v21, 0xffff0000, v32
    v_lshlrev_b32 v22, 16, v33
    v_and_b32 v23, 0xffff0000, v33
    v_mul_f32 v24, s34, v20
    v_mul_f32 v25, s34, v21
    v_mul_f32 v26, s34, v22
    v_mul_f32 v27, s34, v23
    v_exp_f32 v24, v24
    v_exp_f32 v25, v25
    v_exp_f32 v26, v26
    v_exp_f32 v27, v27
    v_add_f32 v24, 1.0, v24
    v_add_f32 v25, 1.0, v25
    v_add_f32 v26, 1.0, v26
    v_add_f32 v27, 1.0, v27
    v_rcp_f32 v24, v24
    v_rcp_f32 v25, v25
    v_rcp_f32 v26, v26
    v_rcp_f32 v27, v27
    v_mul_f32 v24, v20, v24
    v_mul_f32 v25, v21, v25
    v_mul_f32 v26, v22, v26
    v_mul_f32 v27, v23, v27
    v_cvt_pk_bf16_f32 v32, v24, v25
    v_cvt_pk_bf16_f32 v33, v26, v27
    v_lshlrev_b32 v20, 16, v34
    v_and_b32 v21, 0xffff0000, v34
    v_lshlrev_b32 v22, 16, v35
    v_and_b32 v23, 0xffff0000, v35
    v_mul_f32 v24, s34, v20
    v_mul_f32 v25, s34, v21
    v_mul_f32 v26, s34, v22
    v_mul_f32 v27, s34, v23
    v_exp_f32 v24, v24
    v_exp_f32 v25, v25
    v_exp_f32 v26, v26
    v_exp_f32 v27, v27
    v_add_f32 v24, 1.0, v24
    v_add_f32 v25, 1.0, v25
    v_add_f32 v26, 1.0, v26
    v_add_f32 v27, 1.0, v27
    v_rcp_f32 v24, v24
    v_rcp_f32 v25, v25
    v_rcp_f32 v26, v26
    v_rcp_f32 v27, v27
    v_mul_f32 v24, v20, v24
    v_mul_f32 v25, v21, v25
    v_mul_f32 v26, v22, v26
    v_mul_f32 v27, v23, v27
    v_cvt_pk_bf16_f32 v34, v24, v25
    v_cvt_pk_bf16_f32 v35, v26, v27
    v_lshlrev_b32 v20, 16, v36
    v_and_b32 v21, 0xffff0000, v36
    v_lshlrev_b32 v22, 16, v37
    v_and_b32 v23, 0xffff0000, v37
    v_mul_f32 v24, s34, v20
    v_mul_f32 v25, s34, v21
    v_mul_f32 v26, s34, v22
    v_mul_f32 v27, s34, v23
    v_exp_f32 v24, v24
    v_exp_f32 v25, v25
    v_exp_f32 v26, v26
    v_exp_f32 v27, v27
    v_add_f32 v24, 1.0, v24
    v_add_f32 v25, 1.0, v25
    v_add_f32 v26, 1.0, v26
    v_add_f32 v27, 1.0, v27
    v_rcp_f32 v24, v24
    v_rcp_f32 v25, v25
    v_rcp_f32 v26, v26
    v_rcp_f32 v27, v27
    v_mul_f32 v24, v20, v24
    v_mul_f32 v25, v21, v25
    v_mul_f32 v26, v22, v26
    v_mul_f32 v27, v23, v27
    v_cvt_pk_bf16_f32 v36, v24, v25
    v_cvt_pk_bf16_f32 v37, v26, v27
    v_lshlrev_b32 v20, 16, v38
    v_and_b32 v21, 0xffff0000, v38
    v_lshlrev_b32 v22, 16, v39
    v_and_b32 v23, 0xffff0000, v39
    v_mul_f32 v24, s34, v20
    v_mul_f32 v25, s34, v21
    v_mul_f32 v26, s34, v22
    v_mul_f32 v27, s34, v23
    v_exp_f32 v24, v24
    v_exp_f32 v25, v25
    v_exp_f32 v26, v26
    v_exp_f32 v27, v27
    v_add_f32 v24, 1.0, v24
    v_add_f32 v25, 1.0, v25
    v_add_f32 v26, 1.0, v26
    v_add_f32 v27, 1.0, v27
    v_rcp_f32 v24, v24
    v_rcp_f32 v25, v25
    v_rcp_f32 v26, v26
    v_rcp_f32 v27, v27
    v_mul_f32 v24, v20, v24
    v_mul_f32 v25, v21, v25
    v_mul_f32 v26, v22, v26
    v_mul_f32 v27, v23, v27
    v_cvt_pk_bf16_f32 v38, v24, v25
    v_cvt_pk_bf16_f32 v39, v26, v27
    v_lshlrev_b32 v20, 16, v40
    v_and_b32 v21, 0xffff0000, v40
    v_lshlrev_b32 v22, 16, v41
    v_and_b32 v23, 0xffff0000, v41
    v_mul_f32 v24, s34, v20
    v_mul_f32 v25, s34, v21
    v_mul_f32 v26, s34, v22
    v_mul_f32 v27, s34, v23
    v_exp_f32 v24, v24
    v_exp_f32 v25, v25
    v_exp_f32 v26, v26
    v_exp_f32 v27, v27
    v_add_f32 v24, 1.0, v24
    v_add_f32 v25, 1.0, v25
    v_add_f32 v26, 1.0, v26
    v_add_f32 v27, 1.0, v27
    v_rcp_f32 v24, v24
    v_rcp_f32 v25, v25
    v_rcp_f32 v26, v26
    v_rcp_f32 v27, v27
    v_mul_f32 v24, v20, v24
    v_mul_f32 v25, v21, v25
    v_mul_f32 v26, v22, v26
    v_mul_f32 v27, v23, v27
    v_cvt_pk_bf16_f32 v40, v24, v25
    v_cvt_pk_bf16_f32 v41, v26, v27
    v_lshlrev_b32 v20, 16, v42
    v_and_b32 v21, 0xffff0000, v42
    v_lshlrev_b32 v22, 16, v43
    v_and_b32 v23, 0xffff0000, v43
    v_mul_f32 v24, s34, v20
    v_mul_f32 v25, s34, v21
    v_mul_f32 v26, s34, v22
    v_mul_f32 v27, s34, v23
    v_exp_f32 v24, v24
    v_exp_f32 v25, v25
    v_exp_f32 v26, v26
    v_exp_f32 v27, v27
    v_add_f32 v24, 1.0, v24
    v_add_f32 v25, 1.0, v25
    v_add_f32 v26, 1.0, v26
    v_add_f32 v27, 1.0, v27
    v_rcp_f32 v24, v24
    v_rcp_f32 v25, v25
    v_rcp_f32 v26, v26
    v_rcp_f32 v27, v27
    v_mul_f32 v24, v20, v24
    v_mul_f32 v25, v21, v25
    v_mul_f32 v26, v22, v26
    v_mul_f32 v27, v23, v27
    v_cvt_pk_bf16_f32 v42, v24, v25
    v_cvt_pk_bf16_f32 v43, v26, v27
    v_lshlrev_b32 v20, 16, v44
    v_and_b32 v21, 0xffff0000, v44
    v_lshlrev_b32 v22, 16, v45
    v_and_b32 v23, 0xffff0000, v45
    v_mul_f32 v24, s34, v20
    v_mul_f32 v25, s34, v21
    v_mul_f32 v26, s34, v22
    v_mul_f32 v27, s34, v23
    v_exp_f32 v24, v24
    v_exp_f32 v25, v25
    v_exp_f32 v26, v26
    v_exp_f32 v27, v27
    v_add_f32 v24, 1.0, v24
    v_add_f32 v25, 1.0, v25
    v_add_f32 v26, 1.0, v26
    v_add_f32 v27, 1.0, v27
    v_rcp_f32 v24, v24
    v_rcp_f32 v25, v25
    v_rcp_f32 v26, v26
    v_rcp_f32 v27, v27
    v_mul_f32 v24, v20, v24
    v_mul_f32 v25, v21, v25
    v_mul_f32 v26, v22, v26
    v_mul_f32 v27, v23, v27
    v_cvt_pk_bf16_f32 v44, v24, v25
    v_cvt_pk_bf16_f32 v45, v26, v27
    v_lshlrev_b32 v20, 16, v46
    v_and_b32 v21, 0xffff0000, v46
    v_lshlrev_b32 v22, 16, v47
    v_and_b32 v23, 0xffff0000, v47
    v_mul_f32 v24, s34, v20
    v_mul_f32 v25, s34, v21
    v_mul_f32 v26, s34, v22
    v_mul_f32 v27, s34, v23
    v_exp_f32 v24, v24
    v_exp_f32 v25, v25
    v_exp_f32 v26, v26
    v_exp_f32 v27, v27
    v_add_f32 v24, 1.0, v24
    v_add_f32 v25, 1.0, v25
    v_add_f32 v26, 1.0, v26
    v_add_f32 v27, 1.0, v27
    v_rcp_f32 v24, v24
    v_rcp_f32 v25, v25
    v_rcp_f32 v26, v26
    v_rcp_f32 v27, v27
    v_mul_f32 v24, v20, v24
    v_mul_f32 v25, v21, v25
    v_mul_f32 v26, v22, v26
    v_mul_f32 v27, v23, v27
    v_cvt_pk_bf16_f32 v46, v24, v25
    v_cvt_pk_bf16_f32 v47, v26, v27
    v_lshlrev_b32 v20, 16, v48
    v_and_b32 v21, 0xffff0000, v48
    v_lshlrev_b32 v22, 16, v49
    v_and_b32 v23, 0xffff0000, v49
    v_mul_f32 v24, s34, v20
    v_mul_f32 v25, s34, v21
    v_mul_f32 v26, s34, v22
    v_mul_f32 v27, s34, v23
    v_exp_f32 v24, v24
    v_exp_f32 v25, v25
    v_exp_f32 v26, v26
    v_exp_f32 v27, v27
    v_add_f32 v24, 1.0, v24
    v_add_f32 v25, 1.0, v25
    v_add_f32 v26, 1.0, v26
    v_add_f32 v27, 1.0, v27
    v_rcp_f32 v24, v24
    v_rcp_f32 v25, v25
    v_rcp_f32 v26, v26
    v_rcp_f32 v27, v27
    v_mul_f32 v24, v20, v24
    v_mul_f32 v25, v21, v25
    v_mul_f32 v26, v22, v26
    v_mul_f32 v27, v23, v27
    v_cvt_pk_bf16_f32 v48, v24, v25
    v_cvt_pk_bf16_f32 v49, v26, v27
    v_lshlrev_b32 v20, 16, v50
    v_and_b32 v21, 0xffff0000, v50
    v_lshlrev_b32 v22, 16, v51
    v_and_b32 v23, 0xffff0000, v51
    v_mul_f32 v24, s34, v20
    v_mul_f32 v25, s34, v21
    v_mul_f32 v26, s34, v22
    v_mul_f32 v27, s34, v23
    v_exp_f32 v24, v24
    v_exp_f32 v25, v25
    v_exp_f32 v26, v26
    v_exp_f32 v27, v27
    v_add_f32 v24, 1.0, v24
    v_add_f32 v25, 1.0, v25
    v_add_f32 v26, 1.0, v26
    v_add_f32 v27, 1.0, v27
    v_rcp_f32 v24, v24
    v_rcp_f32 v25, v25
    v_rcp_f32 v26, v26
    v_rcp_f32 v27, v27
    v_mul_f32 v24, v20, v24
    v_mul_f32 v25, v21, v25
    v_mul_f32 v26, v22, v26
    v_mul_f32 v27, v23, v27
    v_cvt_pk_bf16_f32 v50, v24, v25
    v_cvt_pk_bf16_f32 v51, v26, v27
    s_cmp_ge_u32 s52, 10
    s_cbranch_scc1 L_nostats
    v_mov_b32 v20, 0
    v_mov_b32 v21, 0
    v_mov_b32 v22, 0x3f803f80
    v_dot2c_f32_bf16 v20, v52, v22
    v_dot2c_f32_bf16 v21, v52, v52
    v_dot2c_f32_bf16 v20, v53, v22
    v_dot2c_f32_bf16 v21, v53, v53
    v_dot2c_f32_bf16 v20, v54, v22
    v_dot2c_f32_bf16 v21, v54, v54
    v_dot2c_f32_bf16 v20, v55, v22
    v_dot2c_f32_bf16 v21, v55, v55
    v_dot2c_f32_bf16 v20, v56, v22
    v_dot2c_f32_bf16 v21, v56, v56
    v_dot2c_f32_bf16 v20, v57, v22
    v_dot2c_f32_bf16 v21, v57, v57
    v_dot2c_f32_bf16 v20, v58, v22
    v_dot2c_f32_bf16 v21, v58, v58
    v_dot2c_f32_bf16 v20, v59, v22
    v_dot2c_f32_bf16 v21, v59, v59
    v_dot2c_f32_bf16 v20, v60, v22
    v_dot2c_f32_bf16 v21, v60, v60
    v_dot2c_f32_bf16 v20, v61, v22
    v_dot2c_f32_bf16 v21, v61, v61
    v_dot2c_f32_bf16 v20, v62, v22
    v_dot2c_f32_bf16 v21, v62, v62
    v_dot2c_f32_bf16 v20, v63, v22
    v_dot2c_f32_bf16 v21, v63, v63
    v_dot2c_f32_bf16 v20, v64, v22
    v_dot2c_f32_bf16 v21, v64, v64
    v_dot2c_f32_bf16 v20, v65, v22
    v_dot2c_f32_bf16 v21, v65, v65
    v_dot2c_f32_bf16 v20, v66, v22
    v_dot2c_f32_bf16 v21, v66, v66
    v_dot2c_f32_bf16 v20, v67, v22
    v_dot2c_f32_bf16 v21, v67, v67
    v_dot2c_f32_bf16 v20, v68, v22
    v_dot2c_f32_bf16 v21, v68, v68
    v_dot2c_f32_bf16 v20, v69, v22
    v_dot2c_f32_bf16 v21, v69, v69
    v_dot2c_f32_bf16 v20, v70, v22
    v_dot2c_f32_bf16 v21, v70, v70
    v_dot2c_f32_bf16 v20, v71, v22
    v_dot2c_f32_bf16 v21, v71, v71
    s_nop 1
    v_add_f32_dpp v20, v20, v20 row_ror:4 row_mask:0xf bank_mask:0xf
    v_add_f32_dpp v21, v21, v21 row_ror:4 row_mask:0xf bank_mask:0xf
    s_nop 0
    v_add_f32_dpp v20, v20, v20 row_ror:8 row_mask:0xf bank_mask:0xf
    v_add_f32_dpp v21, v21, v21 row_ror:8 row_mask:0xf bank_mask:0xf
    v_mov_b32 v22, v20
    v_mov_b32 v23, v21
    s_nop 0
    v_permlane16_swap_b32 v20, v22
    v_permlane16_swap_b32 v21, v23
    v_add_f32 v20, v20, v22
    v_add_f32 v21, v21, v23
    v_mov_b32 v22, v20
    v_mov_b32 v23, v21
    s_nop 0
    v_permlane32_swap_b32 v20, v22
    v_permlane32_swap_b32 v21, v23
    v_add_f32 v20, v20, v22
    v_add_f32 v21, v21, v23
    v_mul_f32 v22, 0x3acccccd, v20
    v_mul_f32 v21, 0x3acccccd, v21
    v_fma_f32 v21, -v22, v22, v21
    v_max_f32 v21, 0, v21
    v_add_f32 v21, 0x3727c5ac, v21
    v_rsq_f32 v20, v21
    s_nop 0
    v_mul_f32_e64 v21, -v22, v20
    v_lshlrev_b32 v24, 16, v72
    v_and_b32 v25, 0xffff0000, v72
    v_lshlrev_b32 v26, 16, v73
    v_and_b32 v27, 0xffff0000, v73
    v_fma_f32 v24, v24, v20, v21
    v_fma_f32 v25, v25, v20, v21
    v_fma_f32 v26, v26, v20, v21
    v_fma_f32 v27, v27, v20, v21
L_nostats:
    s_waitcnt vmcnt(28)
    ds_read_b64_tr_b16 v[96:97], v15 offset:0
    ds_read_b64_tr_b16 v[98:99], v15 offset:512
    ds_read_b64_tr_b16 v[100:101], v15 offset:32
    ds_read_b64_tr_b16 v[102:103], v15 offset:544
    ds_read_b64_tr_b16 v[104:105], v15 offset:64
    ds_read_b64_tr_b16 v[106:107], v15 offset:576
    ds_read_b64_tr_b16 v[108:109], v15 offset:96
    ds_read_b64_tr_b16 v[110:111], v15 offset:608
    s_waitcnt lgkmcnt(7)
    ds_read_b64_tr_b16 v[112:113], v15 offset:4096
    ds_read_b64_tr_b16 v[114:115], v15 offset:4608
    ds_read_b64_tr_b16 v[116:117], v15 offset:4128
    ds_read_b64_tr_b16 v[118:119], v15 offset:4640
    ds_read_b64_tr_b16 v[120:121], v15 offset:4160
    ds_read_b64_tr_b16 v[122:123], v15 offset:4672
    ds_read_b64_tr_b16 v[124:125], v15 offset:4192
    ds_read_b64_tr_b16 v[126:127], v15 offset:4704
    s_waitcnt lgkmcnt(7)
    ds_read_b64_tr_b16 v[128:129], v15 offset:8192
    ds_read_b64_tr_b16 v[130:131], v15 offset:8704
    ds_read_b64_tr_b16 v[132:133], v15 offset:8224
    ds_read_b64_tr_b16 v[134:135], v15 offset:8736
    ds_read_b64_tr_b16 v[136:137], v15 offset:8256
    ds_read_b64_tr_b16 v[138:139], v15 offset:8768
    ds_read_b64_tr_b16 v[140:141], v15 offset:8288
    ds_read_b64_tr_b16 v[142:143], v15 offset:8800
    s_waitcnt lgkmcnt(7)
    ds_read_b64_tr_b16 v[144:145], v15 offset:12288
    ds_read_b64_tr_b16 v[146:147], v15 offset:12800
    ds_read_b64_tr_b16 v[148:149], v15 offset:12320
    ds_read_b64_tr_b16 v[150:151], v15 offset:12832
    ds_read_b64_tr_b16 v[152:153], v15 offset:12352
    ds_read_b64_tr_b16 v[154:155], v15 offset:12864
    ds_read_b64_tr_b16 v[156:157], v15 offset:12384
    ds_read_b64_tr_b16 v[158:159], v15 offset:12896
    s_waitcnt lgkmcnt(7)
    ds_read_b64_tr_b16 v[160:161], v15 offset:16384
    ds_read_b64_tr_b16 v[162:163], v15 offset:16896
    ds_read_b64_tr_b16 v[164:165], v15 offset:16416
    ds_read_b64_tr_b16 v[166:167], v15 offset:16928
    ds_read_b64_tr_b16 v[168:169], v15 offset:16448
    ds_read_b64_tr_b16 v[170:171], v15 offset:16960
    ds_read_b64_tr_b16 v[172:173], v15 offset:16480
    ds_read_b64_tr_b16 v[174:175], v15 offset:16992
    s_waitcnt lgkmcnt(0)
    v_mfma_f32_16x16x32_bf16 v[80:83], v[96:99], v[32:35], 0
    v_mfma_f32_16x16x32_bf16 v[84:87], v[100:103], v[32:35], 0
    v_mfma_f32_16x16x32_bf16 v[88:91], v[104:107], v[32:35], 0
    v_mfma_f32_16x16x32_bf16 v[92:95], v[108:111], v[32:35], 0
    v_mfma_f32_16x16x32_bf16 v[80:83], v[112:115], v[36:39], v[80:83]
    v_mfma_f32_16x16x32_bf16 v[84:87], v[116:119], v[36:39], v[84:87]
    v_mfma_f32_16x16x32_bf16 v[88:91], v[120:123], v[36:39], v[88:91]
    v_mfma_f32_16x16x32_bf16 v[92:95], v[124:127], v[36:39], v[92:95]
    v_mfma_f32_16x16x32_bf16 v[80:83], v[128:131], v[40:43], v[80:83]
    v_mfma_f32_16x16x32_bf16 v[84:87], v[132:135], v[40:43], v[84:87]
    v_mfma_f32_16x16x32_bf16 v[88:91], v[136:139], v[40:43], v[88:91]
    v_mfma_f32_16x16x32_bf16 v[92:95], v[140:143], v[40:43], v[92:95]
    v_mfma_f32_16x16x32_bf16 v[80:83], v[144:147], v[44:47], v[80:83]
    v_mfma_f32_16x16x32_bf16 v[84:87], v[148:151], v[44:47], v[84:87]
    v_mfma_f32_16x16x32_bf16 v[88:91], v[152:155], v[44:47], v[88:91]
    v_mfma_f32_16x16x32_bf16 v[92:95], v[156:159], v[44:47], v[92:95]
    v_mfma_f32_16x16x32_bf16 v[80:83], v[160:163], v[48:51], v[80:83]
    v_mfma_f32_16x16x32_bf16 v[84:87], v[164:167], v[48:51], v[84:87]
    v_mfma_f32_16x16x32_bf16 v[88:91], v[168:171], v[48:51], v[88:91]
    v_mfma_f32_16x16x32_bf16 v[92:95], v[172:175], v[48:51], v[92:95]
    s_cmp_ge_u32 s50, 20
    s_cbranch_scc1 L_adr_rest
    s_cmp_lt_u32 s50, 10
    s_cselect_b32 s34, 5120, 0
    s_cselect_b32 s35, s50, s52
    s_lshl_b32 s35, s35, 9
    s_add_u32 s34, s34, s35
    s_lshl_b32 s35, s51, 17
    s_add_u32 s34, s34, s35
    v_lshrrev_b32 v19, 1, v14
    v_lshl_add_u32 v19, v13, 1, v19
    v_lshlrev_b32 v19, 6, v19
    v_lshl_add_u32 v19, v12, 4, v19
    v_and_b32 v20, 1, v14
    v_lshl_add_u32 v19, v20, 3, v19
    s_branch L_adr_done
L_adr_rest:
    s_lshl_b32 s34, s51, 17
    s_lshl_b32 s35, s50, 7
    s_add_u32 s34, s34, s35
    s_add_u32 s34, s34, 7680
    v_mul_u32_u24 v19, 5120, v12
    v_lshl_add_u32 v19, v13, 5, v19
    v_lshl_add_u32 v19, v14, 3, v19
    s_nop 3
L_adr_done:
    v_add_u32 v19, s34, v19
    v_mov_b32_dpp v80, v84 quad_perm:[0,1,2,3] row_mask:0xf bank_mask:0x2
    v_mov_b32_dpp v81, v85 quad_perm:[0,1,2,3] row_mask:0xf bank_mask:0x2
    v_mov_b32_dpp v82, v86 quad_perm:[0,1,2,3] row_mask:0xf bank_mask:0x2
    v_mov_b32_dpp v83, v87 quad_perm:[0,1,2,3] row_mask:0xf bank_mask:0x2
    v_mov_b32_dpp v80, v88 quad_perm:[0,1,2,3] row_mask:0xf bank_mask:0x4
    v_mov_b32_dpp v81, v89 quad_perm:[0,1,2,3] row_mask:0xf bank_mask:0x4
    v_mov_b32_dpp v82, v90 quad_perm:[0,1,2,3] row_mask:0xf bank_mask:0x4
    v_mov_b32_dpp v83, v91 quad_perm:[0,1,2,3] row_mask:0xf bank_mask:0x4
    v_mov_b32_dpp v80, v92 quad_perm:[0,1,2,3] row_mask:0xf bank_mask:0x8
    v_mov_b32_dpp v81, v93 quad_perm:[0,1,2,3] row_mask:0xf bank_mask:0x8
    v_mov_b32_dpp v82, v94 quad_perm:[0,1,2,3] row_mask:0xf bank_mask:0x8
    v_mov_b32_dpp v83, v95 quad_perm:[0,1,2,3] row_mask:0xf bank_mask:0x8
    s_cmp_ge_u32 s52, 10
    s_cbranch_scc1 L_noz
    v_add_f32 v80, 0x3e800000, v80
    v_add_f32 v81, 0x3e800000, v81
    v_add_f32 v82, 0x3e800000, v82
    v_add_f32 v83, 0x3e800000, v83
    v_mul_f32 v80, v80, v24
    v_mul_f32 v81, v81, v25
    v_mul_f32 v82, v82, v26
    v_mul_f32 v83, v83, v27
L_noz:
    v_cvt_pk_bf16_f32 v20, v80, v81
    v_cvt_pk_bf16_f32 v21, v82, v83
    v_min_u32 v20, -2, v20
    v_min_u32 v21, -2, v21
    v_and_b32 v22, 15, v0
    v_lshlrev_b32 v22, 2, v22
    s_mov_b32 s35, 0
L_poll4:
    global_load_dword v23, v22, s[30:31] offset:128 sc1
    s_add_u32 s35, s35, 1
    s_waitcnt vmcnt(0)
    v_cmp_ne_u32 vcc, 1, v23
    s_cbranch_vccz L_done5
    s_sleep 8
    s_cmp_lt_u32 s35, 60000
    s_cbranch_scc1 L_poll4
L_done5:
    buffer_store_dwordx2 v[20:21], v19, s[44:47], 0 offen sc1
    s_branch L_p2
L_clear:
    s_sub_u32 s55, s2, 240
    s_lshr_b32 s34, s55, 2
    s_mul_i32 s34, s34, 25600
    s_lshl_b32 s35, s51, 17
    s_add_u32 s34, s34, s35
    v_lshl_add_u32 v19, v0, 4, s34
    v_mov_b32 v20, -1
    v_mov_b32 v21, -1
    v_mov_b32 v22, -1
    v_mov_b32 v23, -1
    s_mov_b32 s34, 0
L_clrloop:
    buffer_store_dwordx4 v[20:23], v19, s[44:47], s34 offen sc1
    s_add_u32 s34, s34, 1024
    s_cmp_lt_u32 s34, 25600
    s_cbranch_scc1 L_clrloop
    v_lshlrev_b32 v1, 2, v0
    v_add_u32 v1, 98304, v1
    v_mov_b32 v2, -1
    v_mov_b32 v3, 0
    ds_write_b32 v1, v2
    ds_write_b32 v1, v2 offset:256
    ds_write_b32 v1, v3 offset:512
    ds_write_b32 v1, v3 offset:768
    s_waitcnt lgkmcnt(0)
    s_barrier
    s_lshl_b32 s34, s55, 2
    v_mov_b32 v24, s34
    v_mov_b32 v25, 1
    s_waitcnt vmcnt(0)
    s_mov_b64 exec, 1
    global_store_dword v24, v25, s[30:31] offset:128 sc1
    s_mov_b64 exec, -1
    s_getpc_b64 s[56:57]
L_pc7:
    s_sub_u32 s56, s56, L_pc7-adaLN_cond__sliding_block_cached__dense_activation_gelu__decode_kernel
    s_subb_u32 s57, s57, 0
    s_lshl_b32 s34, s61, 10
    v_lshl_add_u32 v9, v0, 4, s34
    v_min_u32 v9, L_codeend-adaLN_cond__sliding_block_cached__dense_activation_gelu__decode_kernel-16, v9
    global_load_dwordx4 v[76:79], v9, s[56:57]
    v_lshlrev_b32 v9, 21, v0
    s_mov_b64 exec, 7
    global_load_dword v76, v9, s[12:13]
    s_mov_b64 exec, 3
    global_load_dword v76, v9, s[16:17]
    global_load_dword v76, v9, s[20:21]
    s_mov_b64 exec, 1
    global_load_dword v76, v9, s[28:29]
    global_load_dword v76, v9, s[18:19]
    global_load_dword v76, v9, s[22:23]
    global_load_dword v76, v9, s[4:5]
    s_mov_b64 exec, -1
    s_and_b32 s34, s2, 31
    s_lshl_b32 s34, s34, 8
    s_lshr_b32 s35, s2, 7
    s_lshl_b32 s35, s35, 7
    s_add_u32 s49, s34, s35
    s_bfe_u32 s53, s2, 0x20005
    s_mul_i32 s34, s53, 1310720
    s_add_u32 s34, s34, s49
    v_lshl_add_u32 v16, v10, 13, v11
    v_add_u32 v16, s34, v16
    s_mov_b32 s36, s10
    s_mov_b32 s37, s11
    s_mov_b32 s38, 5242880
    s_mov_b32 m0, 20480
    s_mov_b32 s34, 0
L_dma8:
    buffer_load_dwordx4 v16, s[36:39], s34 offen  lds
    s_add_u32 m0, m0, 1024
    s_add_u32 s34, s34, 65536
    buffer_load_dwordx4 v16, s[36:39], s34 offen  lds
    s_add_u32 m0, m0, 1024
    s_add_u32 s34, s34, 65536
    buffer_load_dwordx4 v16, s[36:39], s34 offen  lds
    s_add_u32 m0, m0, 1024
    s_add_u32 s34, s34, 65536
    buffer_load_dwordx4 v16, s[36:39], s34 offen  lds
    s_add_u32 m0, m0, 1024
    s_add_u32 s34, s34, 65536
    s_cmp_lt_u32 s34, 1310720
    s_cbranch_scc1 L_dma8
    v_lshl_add_u32 v15, v14, 3, v13
    v_lshlrev_b32 v15, 7, v15
    v_lshl_add_u32 v15, v12, 3, v15
    v_and_b32 v22, 15, v0
    v_lshlrev_b32 v22, 2, v22
    s_mov_b32 s35, 0
L_poll9:
    global_load_dword v23, v22, s[30:31] offset:128 sc1
    s_add_u32 s35, s35, 1
    s_waitcnt vmcnt(0)
    v_cmp_ne_u32 vcc, 1, v23
    s_cbranch_vccz L_done10
    s_sleep 8
    s_cmp_lt_u32 s35, 60000
    s_cbranch_scc1 L_poll9
L_done10:
L_p2:
    v_mov_b32 v199, v19
    ds_read_b64_tr_b16 v[96:97], v15 offset:20480
    ds_read_b64_tr_b16 v[98:99], v15 offset:20992
    ds_read_b64_tr_b16 v[100:101], v15 offset:20512
    ds_read_b64_tr_b16 v[102:103], v15 offset:21024
    ds_read_b64_tr_b16 v[104:105], v15 offset:20544
    ds_read_b64_tr_b16 v[106:107], v15 offset:21056
    ds_read_b64_tr_b16 v[108:109], v15 offset:20576
    ds_read_b64_tr_b16 v[110:111], v15 offset:21088
    s_waitcnt lgkmcnt(7)
    ds_read_b64_tr_b16 v[112:113], v15 offset:24576
    ds_read_b64_tr_b16 v[114:115], v15 offset:25088
    ds_read_b64_tr_b16 v[116:117], v15 offset:24608
    ds_read_b64_tr_b16 v[118:119], v15 offset:25120
    ds_read_b64_tr_b16 v[120:121], v15 offset:24640
    ds_read_b64_tr_b16 v[122:123], v15 offset:25152
    ds_read_b64_tr_b16 v[124:125], v15 offset:24672
    ds_read_b64_tr_b16 v[126:127], v15 offset:25184
    s_waitcnt lgkmcnt(7)
    ds_read_b64_tr_b16 v[128:129], v15 offset:28672
    ds_read_b64_tr_b16 v[130:131], v15 offset:29184
    ds_read_b64_tr_b16 v[132:133], v15 offset:28704
    ds_read_b64_tr_b16 v[134:135], v15 offset:29216
    ds_read_b64_tr_b16 v[136:137], v15 offset:28736
    ds_read_b64_tr_b16 v[138:139], v15 offset:29248
    ds_read_b64_tr_b16 v[140:141], v15 offset:28768
    ds_read_b64_tr_b16 v[142:143], v15 offset:29280
    s_waitcnt lgkmcnt(7)
    ds_read_b64_tr_b16 v[144:145], v15 offset:32768
    ds_read_b64_tr_b16 v[146:147], v15 offset:33280
    ds_read_b64_tr_b16 v[148:149], v15 offset:32800
    ds_read_b64_tr_b16 v[150:151], v15 offset:33312
    ds_read_b64_tr_b16 v[152:153], v15 offset:32832
    ds_read_b64_tr_b16 v[154:155], v15 offset:33344
    ds_read_b64_tr_b16 v[156:157], v15 offset:32864
    ds_read_b64_tr_b16 v[158:159], v15 offset:33376
    s_waitcnt lgkmcnt(7)
    ds_read_b64_tr_b16 v[160:161], v15 offset:36864
    ds_read_b64_tr_b16 v[162:163], v15 offset:37376
    ds_read_b64_tr_b16 v[164:165], v15 offset:36896
    ds_read_b64_tr_b16 v[166:167], v15 offset:37408
    ds_read_b64_tr_b16 v[168:169], v15 offset:36928
    ds_read_b64_tr_b16 v[170:171], v15 offset:37440
    ds_read_b64_tr_b16 v[172:173], v15 offset:36960
    ds_read_b64_tr_b16 v[174:175], v15 offset:37472
    s_waitcnt lgkmcnt(0)
    s_mul_i32 s34, s53, 1280
    v_lshlrev_b32 v19, 17, v13
    v_lshl_add_u32 v19, v14, 6, v19
    v_lshl_add_u32 v19, v12, 4, v19
    v_add_u32 v19, s34, v19
    s_movk_i32 s48, 5120
    v_mov_b32 v22, 99072
    s_mov_b32 s35, 0
L_poll12:
    ds_read_b32 v23, v22
    s_add_u32 s35, s35, 1
    s_waitcnt lgkmcnt(0)
    v_cmp_gt_u32 vcc, 20, v23
    s_cbranch_vccz L_done13
    s_sleep 2
    s_cmp_lt_u32 s35, 60000
    s_cbranch_scc1 L_poll12
L_done13:
    s_mov_b32 s35, 0
L_poll15:
    buffer_load_dwordx4 v[32:35], v19, s[44:47], 0 offen offset:0 sc1
    buffer_load_dwordx4 v[36:39], v19, s[44:47], s48 offen offset:0 sc1
    buffer_load_dwordx4 v[40:43], v19, s[44:47], 0 offen offset:256 sc1
    buffer_load_dwordx4 v[44:47], v19, s[44:47], s48 offen offset:256 sc1
    buffer_load_dwordx4 v[48:51], v19, s[44:47], 0 offen offset:512 sc1
    buffer_load_dwordx4 v[52:55], v19, s[44:47], s48 offen offset:512 sc1
    buffer_load_dwordx4 v[56:59], v19, s[44:47], 0 offen offset:768 sc1
    buffer_load_dwordx4 v[60:63], v19, s[44:47], s48 offen offset:768 sc1
    buffer_load_dwordx4 v[64:67], v19, s[44:47], 0 offen offset:1024 sc1
    buffer_load_dwordx4 v[68:71], v19, s[44:47], s48 offen offset:1024 sc1
    s_add_u32 s35, s35, 1
    s_waitcnt vmcnt(0)
    v_max3_u32 v20, v32, v33, v34
    v_max3_u32 v20, v20, v35, v36
    v_max3_u32 v20, v20, v37, v38
    v_max3_u32 v20, v20, v39, v40
    v_max3_u32 v20, v20, v41, v42
    v_max3_u32 v20, v20, v43, v44
    v_max3_u32 v20, v20, v45, v46
    v_max3_u32 v20, v20, v47, v48
    v_max3_u32 v20, v20, v49, v50
    v_max3_u32 v20, v20, v51, v52
    v_max3_u32 v20, v20, v53, v54
    v_max3_u32 v20, v20, v55, v56
    v_max3_u32 v20, v20, v57, v58
    v_max3_u32 v20, v20, v59, v60
    v_max3_u32 v20, v20, v61, v62
    v_max3_u32 v20, v20, v63, v64
    v_max3_u32 v20, v20, v65, v66
    v_max3_u32 v20, v20, v67, v68
    v_max3_u32 v20, v20, v69, v70
    v_max_u32 v20, v20, v71
    v_cmp_eq_u32 vcc, -1, v20
    s_cbranch_vccz L_done16
    s_sleep 16
    s_cmp_lt_u32 s35, 60000
    s_cbranch_scc1 L_poll15
L_done16:
    v_mfma_f32_16x16x32_bf16 v[80:83], v[96:99], v[32:35], 0
    v_mfma_f32_16x16x32_bf16 v[84:87], v[100:103], v[32:35], 0
    v_mfma_f32_16x16x32_bf16 v[88:91], v[104:107], v[32:35], 0
    v_mfma_f32_16x16x32_bf16 v[92:95], v[108:111], v[32:35], 0
    v_mfma_f32_16x16x32_bf16 v[80:83], v[96:99], v[36:39], v[80:83]
    v_mfma_f32_16x16x32_bf16 v[84:87], v[100:103], v[36:39], v[84:87]
    v_mfma_f32_16x16x32_bf16 v[88:91], v[104:107], v[36:39], v[88:91]
    v_mfma_f32_16x16x32_bf16 v[92:95], v[108:111], v[36:39], v[92:95]
    v_mfma_f32_16x16x32_bf16 v[80:83], v[112:115], v[40:43], v[80:83]
    v_mfma_f32_16x16x32_bf16 v[84:87], v[116:119], v[40:43], v[84:87]
    v_mfma_f32_16x16x32_bf16 v[88:91], v[120:123], v[40:43], v[88:91]
    v_mfma_f32_16x16x32_bf16 v[92:95], v[124:127], v[40:43], v[92:95]
    v_mfma_f32_16x16x32_bf16 v[80:83], v[112:115], v[44:47], v[80:83]
    v_mfma_f32_16x16x32_bf16 v[84:87], v[116:119], v[44:47], v[84:87]
    v_mfma_f32_16x16x32_bf16 v[88:91], v[120:123], v[44:47], v[88:91]
    v_mfma_f32_16x16x32_bf16 v[92:95], v[124:127], v[44:47], v[92:95]
    v_mfma_f32_16x16x32_bf16 v[80:83], v[128:131], v[48:51], v[80:83]
    v_mfma_f32_16x16x32_bf16 v[84:87], v[132:135], v[48:51], v[84:87]
    v_mfma_f32_16x16x32_bf16 v[88:91], v[136:139], v[48:51], v[88:91]
    v_mfma_f32_16x16x32_bf16 v[92:95], v[140:143], v[48:51], v[92:95]
    v_mfma_f32_16x16x32_bf16 v[80:83], v[128:131], v[52:55], v[80:83]
    v_mfma_f32_16x16x32_bf16 v[84:87], v[132:135], v[52:55], v[84:87]
    v_mfma_f32_16x16x32_bf16 v[88:91], v[136:139], v[52:55], v[88:91]
    v_mfma_f32_16x16x32_bf16 v[92:95], v[140:143], v[52:55], v[92:95]
    v_mfma_f32_16x16x32_bf16 v[80:83], v[144:147], v[56:59], v[80:83]
    v_mfma_f32_16x16x32_bf16 v[84:87], v[148:151], v[56:59], v[84:87]
    v_mfma_f32_16x16x32_bf16 v[88:91], v[152:155], v[56:59], v[88:91]
    v_mfma_f32_16x16x32_bf16 v[92:95], v[156:159], v[56:59], v[92:95]
    v_mfma_f32_16x16x32_bf16 v[80:83], v[144:147], v[60:63], v[80:83]
    v_mfma_f32_16x16x32_bf16 v[84:87], v[148:151], v[60:63], v[84:87]
    v_mfma_f32_16x16x32_bf16 v[88:91], v[152:155], v[60:63], v[88:91]
    v_mfma_f32_16x16x32_bf16 v[92:95], v[156:159], v[60:63], v[92:95]
    v_mfma_f32_16x16x32_bf16 v[80:83], v[160:163], v[64:67], v[80:83]
    v_mfma_f32_16x16x32_bf16 v[84:87], v[164:167], v[64:67], v[84:87]
    v_mfma_f32_16x16x32_bf16 v[88:91], v[168:171], v[64:67], v[88:91]
    v_mfma_f32_16x16x32_bf16 v[92:95], v[172:175], v[64:67], v[92:95]
    v_mfma_f32_16x16x32_bf16 v[80:83], v[160:163], v[68:71], v[80:83]
    v_mfma_f32_16x16x32_bf16 v[84:87], v[164:167], v[68:71], v[84:87]
    v_mfma_f32_16x16x32_bf16 v[88:91], v[168:171], v[68:71], v[88:91]
    v_mfma_f32_16x16x32_bf16 v[92:95], v[172:175], v[68:71], v[92:95]
    s_lshl_b32 s34, s53, 17
    s_add_u32 s34, s34, s49
    s_add_u32 s34, s34, 67584
    v_lshlrev_b32 v19, 13, v12
    v_lshl_add_u32 v19, v13, 5, v19
    v_lshl_add_u32 v19, v14, 3, v19
    v_add_u32 v19, s34, v19
    v_add_f32_dpp v20, v80, v80 row_ror:8 row_mask:0xf bank_mask:0x3
    v_add_f32_dpp v24, v84, v84 row_ror:8 row_mask:0xf bank_mask:0x3
    v_add_f32_dpp v21, v81, v81 row_ror:8 row_mask:0xf bank_mask:0x3
    v_add_f32_dpp v25, v85, v85 row_ror:8 row_mask:0xf bank_mask:0x3
    v_add_f32_dpp v22, v82, v82 row_ror:8 row_mask:0xf bank_mask:0x3
    v_add_f32_dpp v26, v86, v86 row_ror:8 row_mask:0xf bank_mask:0x3
    v_add_f32_dpp v23, v83, v83 row_ror:8 row_mask:0xf bank_mask:0x3
    v_add_f32_dpp v27, v87, v87 row_ror:8 row_mask:0xf bank_mask:0x3
    v_add_f32_dpp v20, v88, v88 row_ror:8 row_mask:0xf bank_mask:0xc
    v_add_f32_dpp v24, v92, v92 row_ror:8 row_mask:0xf bank_mask:0xc
    v_add_f32_dpp v21, v89, v89 row_ror:8 row_mask:0xf bank_mask:0xc
    v_add_f32_dpp v25, v93, v93 row_ror:8 row_mask:0xf bank_mask:0xc
    v_add_f32_dpp v22, v90, v90 row_ror:8 row_mask:0xf bank_mask:0xc
    v_add_f32_dpp v26, v94, v94 row_ror:8 row_mask:0xf bank_mask:0xc
    v_add_f32_dpp v23, v91, v91 row_ror:8 row_mask:0xf bank_mask:0xc
    v_add_f32_dpp v27, v95, v95 row_ror:8 row_mask:0xf bank_mask:0xc
    v_add_f32_dpp v28, v20, v20 row_shl:4 row_mask:0xf bank_mask:0x5
    v_add_f32_dpp v29, v21, v21 row_shl:4 row_mask:0xf bank_mask:0x5
    v_add_f32_dpp v30, v22, v22 row_shl:4 row_mask:0xf bank_mask:0x5
    v_add_f32_dpp v31, v23, v23 row_shl:4 row_mask:0xf bank_mask:0x5
    v_add_f32_dpp v28, v24, v24 row_shr:4 row_mask:0xf bank_mask:0xa
    v_add_f32_dpp v29, v25, v25 row_shr:4 row_mask:0xf bank_mask:0xa
    v_add_f32_dpp v30, v26, v26 row_shr:4 row_mask:0xf bank_mask:0xa
    v_add_f32_dpp v31, v27, v27 row_shr:4 row_mask:0xf bank_mask:0xa
    v_cvt_pk_bf16_f32 v20, v28, v29
    v_cvt_pk_bf16_f32 v21, v30, v31
    v_min_u32 v20, -2, v20
    v_min_u32 v21, -2, v21
    buffer_store_dwordx2 v[20:21], v19, s[44:47], 0 offen sc1
    s_and_b32 s34, s2, 127
    s_lshl_b32 s34, s34, 21
    s_lshr_b32 s35, s2, 7
    s_lshl_b32 s35, s35, 18
    s_add_u32 s34, s34, s35
    s_add_u32 s34, s34, 1572864
    s_mov_b32 s38, 0x40000
    s_mov_b32 s42, 0x40000
    s_waitcnt lgkmcnt(0)
    s_add_u32 s36, s6, s34
    s_addc_u32 s37, s7, 0
    s_add_u32 s40, s8, s34
    s_addc_u32 s41, s9, 0
    v_lshlrev_b32 v18, 4, v0
    s_mov_b32 s34, 258048
    buffer_load_dwordx4 v[128:131], v18, s[36:39], s34 offen offset:0 nt
    buffer_load_dwordx4 v[132:135], v18, s[36:39], s34 offen offset:1024 nt
    buffer_load_dwordx4 v[136:139], v18, s[36:39], s34 offen offset:2048 nt
    buffer_load_dwordx4 v[140:143], v18, s[36:39], s34 offen offset:3072 nt
    buffer_load_dwordx4 v[144:147], v18, s[40:43], s34 offen offset:0 nt
    buffer_load_dwordx4 v[148:151], v18, s[40:43], s34 offen offset:1024 nt
    buffer_load_dwordx4 v[152:155], v18, s[40:43], s34 offen offset:2048 nt
    buffer_load_dwordx4 v[156:159], v18, s[40:43], s34 offen offset:3072 nt
    s_and_b32 s34, s2, 127
    s_lshl_b32 s34, s34, 8
    s_add_u32 s34, s34, 67584
    v_lshl_add_u32 v19, v0, 2, s34
    s_mov_b32 s56, 131072
    s_mov_b32 s57, 262144
    s_mov_b32 s58, 393216
    v_mov_b32 v22, 99072
    s_mov_b32 s35, 0
L_poll18:
    ds_read_b32 v23, v22
    s_add_u32 s35, s35, 1
    s_waitcnt lgkmcnt(0)
    v_cmp_gt_u32 vcc, 33, v23
    s_cbranch_vccz L_done19
    s_sleep 2
    s_cmp_lt_u32 s35, 60000
    s_cbranch_scc1 L_poll18
L_done19:
    s_mov_b32 s35, 0
L_poll21:
    buffer_load_dword v32, v19, s[44:47], 0 offen sc1
    buffer_load_dword v33, v19, s[44:47], s56 offen sc1
    buffer_load_dword v34, v19, s[44:47], s57 offen sc1
    buffer_load_dword v35, v19, s[44:47], s58 offen sc1
    s_add_u32 s35, s35, 1
    s_waitcnt vmcnt(0)
    v_max3_u32 v22, v32, v33, v34
    v_max_u32 v22, v22, v35
    v_cmp_eq_u32 vcc, -1, v22
    s_cbranch_vccz L_done22
    s_sleep 16
    s_cmp_lt_u32 s35, 60000
    s_cbranch_scc1 L_poll21
L_done22:
    v_lshlrev_b32 v36, 16, v32
    v_and_b32 v37, 0xffff0000, v32
    v_lshlrev_b32 v38, 16, v33
    v_and_b32 v39, 0xffff0000, v33
    v_lshlrev_b32 v40, 16, v34
    v_and_b32 v41, 0xffff0000, v34
    v_lshlrev_b32 v42, 16, v35
    v_and_b32 v43, 0xffff0000, v35
    v_pk_add_f32 v[36:37], v[36:37], v[38:39]
    v_pk_add_f32 v[40:41], v[40:41], v[42:43]
    v_pk_add_f32 v[36:37], v[36:37], v[40:41]
    v_cvt_pk_bf16_f32 v32, v36, v37
    v_min_u32 v32, -2, v32
    ds_write_b32 v1, v32
    s_getpc_b64 s[56:57]
L_pc24:
    s_sub_u32 s56, s56, L_pc24-adaLN_cond__sliding_block_cached__dense_activation_gelu__decode_kernel
    s_subb_u32 s57, s57, 0
    s_lshl_b32 s34, s61, 10
    v_lshl_add_u32 v9, v0, 4, s34
    v_min_u32 v9, L_codeend-adaLN_cond__sliding_block_cached__dense_activation_gelu__decode_kernel-16, v9
    global_load_dwordx4 v[76:79], v9, s[56:57]
    v_and_b32 v2, 15, v0
    v_lshlrev_b32 v2, 4, v2
    v_add_u32 v2, 98304, v2
    ds_read_b128 v[4:7], v2
    s_waitcnt lgkmcnt(0)
    v_dot2_f32_bf16 v8, v128, v4, 0
    v_dot2_f32_bf16 v9, v132, v4, 0
    v_dot2_f32_bf16 v10, v136, v4, 0
    v_dot2_f32_bf16 v11, v140, v4, 0
    v_dot2c_f32_bf16 v8, v129, v5
    v_dot2c_f32_bf16 v9, v133, v5
    v_dot2c_f32_bf16 v10, v137, v5
    v_dot2c_f32_bf16 v11, v141, v5
    v_dot2c_f32_bf16 v8, v130, v6
    v_dot2c_f32_bf16 v9, v134, v6
    v_dot2c_f32_bf16 v10, v138, v6
    v_dot2c_f32_bf16 v11, v142, v6
    v_dot2c_f32_bf16 v8, v131, v7
    v_dot2c_f32_bf16 v9, v135, v7
    v_dot2c_f32_bf16 v10, v139, v7
    v_dot2c_f32_bf16 v11, v143, v7
    v_add_f32_dpp v16, v8, v8 row_ror:8 row_mask:0xf bank_mask:0x3
    v_add_f32_dpp v16, v9, v9 row_ror:8 row_mask:0xf bank_mask:0xc
    v_add_f32_dpp v17, v10, v10 row_ror:8 row_mask:0xf bank_mask:0x3
    v_add_f32_dpp v17, v11, v11 row_ror:8 row_mask:0xf bank_mask:0xc
    v_add_f32_dpp v16, v16, v16 row_half_mirror row_mask:0xf bank_mask:0xf
    s_nop 0
    v_add_f32_dpp v17, v17, v17 row_half_mirror row_mask:0xf bank_mask:0xf
    v_add_f32_dpp v16, v16, v16 quad_perm:[1,0,3,2] row_mask:0xf bank_mask:0xf
    s_nop 0
    v_add_f32_dpp v17, v17, v17 quad_perm:[1,0,3,2] row_mask:0xf bank_mask:0xf
    v_add_f32_dpp v16, v16, v16 quad_perm:[2,3,0,1] row_mask:0xf bank_mask:0xf
    s_nop 0
    v_add_f32_dpp v17, v17, v17 quad_perm:[2,3,0,1] row_mask:0xf bank_mask:0xf
    v_max_f32 v8, v16, v17
    s_mov_b32 s34, 0x3e0293ee
    s_nop 0
    v_max_f32_dpp v8, v8, v8 row_ror:8 row_mask:0xf bank_mask:0xf
    v_mov_b32 v9, v8
    s_nop 1
    v_permlane16_swap_b32 v8, v9
    v_max_f32 v8, v8, v9
    v_mov_b32 v9, v8
    s_nop 1
    v_permlane32_swap_b32 v8, v9
    v_max_f32 v8, v8, v9
    v_mul_f32 v8, s34, v8
    v_fma_f32 v16, v16, s34, -v8
    v_fma_f32 v17, v17, s34, -v8
    v_exp_f32 v16, v16
    v_exp_f32 v17, v17
    s_nop 0
    v_add_f32 v9, v16, v17
    v_and_b32 v10, 1, v0
    v_lshlrev_b32 v10, 4, v10
    v_mov_b32 v11, 0xffff
    v_lshlrev_b32 v10, v10, v11
    v_bfe_u32 v11, v0, 1, 2
    v_cmp_eq_u32 vcc, 0, v11
    s_nop 1
    v_cndmask_b32 v20, 0, v10, vcc
    v_cmp_eq_u32 vcc, 1, v11
    s_nop 1
    v_cndmask_b32 v21, 0, v10, vcc
    v_cmp_eq_u32 vcc, 2, v11
    s_nop 1
    v_cndmask_b32 v22, 0, v10, vcc
    v_cmp_eq_u32 vcc, 3, v11
    s_nop 1
    v_cndmask_b32 v23, 0, v10, vcc
    v_add_f32_dpp v9, v9, v9 row_ror:8 row_mask:0xf bank_mask:0xf
    v_mov_b32 v10, v9
    s_nop 1
    v_permlane16_swap_b32 v9, v10
    v_add_f32 v9, v9, v10
    v_mov_b32 v10, v9
    s_nop 1
    v_permlane32_swap_b32 v9, v10
    v_add_f32 v9, v9, v10
    v_mov_b32 v10, 98616
    s_mov_b64 exec, 1
    ds_write_b64 v10, v[8:9]
    s_mov_b64 exec, -1
    v_cvt_pk_bf16_f32 v10, v16, v16
    v_and_b32 v24, v10, v20
    v_and_b32 v25, v10, v21
    v_and_b32 v26, v10, v22
    v_and_b32 v27, v10, v23
    s_nop 1
    v_mfma_f32_16x16x32_bf16 v[116:119], v[144:147], v[24:27], 0
    v_mfma_f32_16x16x32_bf16 v[120:123], v[148:151], v[24:27], 0
    v_cvt_pk_bf16_f32 v10, v17, v17
    v_and_b32 v28, v10, v20
    v_and_b32 v29, v10, v21
    v_and_b32 v30, v10, v22
    v_and_b32 v31, v10, v23
    s_nop 1
    v_mfma_f32_16x16x32_bf16 v[116:119], v[152:155], v[28:31], v[116:119]
    v_mfma_f32_16x16x32_bf16 v[120:123], v[156:159], v[28:31], v[120:123]
    s_nop 7
    v_mov_b32_dpp v116, v120 quad_perm:[0,1,2,3] row_mask:0xf bank_mask:0xc
    v_mov_b32_dpp v117, v121 quad_perm:[0,1,2,3] row_mask:0xf bank_mask:0xc
    v_mov_b32_dpp v118, v122 quad_perm:[0,1,2,3] row_mask:0xf bank_mask:0xc
    v_mov_b32_dpp v119, v123 quad_perm:[0,1,2,3] row_mask:0xf bank_mask:0xc
    s_mov_b32 s56, 131072
    s_mov_b32 s57, 262144
    s_sub_u32 s34, s2, 80
    s_cmp_ge_u32 s34, 160
    s_cbranch_scc1 L_nomf
    s_and_b32 s34, s2, 3
    s_cbranch_scc1 L_nomf
    s_mov_b32 s35, 0
L_poll25:
    buffer_load_dwordx2 v[32:33], v199, s[44:47], 0 offen sc1
    buffer_load_dwordx2 v[34:35], v199, s[44:47], s56 offen sc1
    buffer_load_dwordx2 v[36:37], v199, s[44:47], s57 offen sc1
    buffer_load_dwordx2 v[38:39], v199, s[44:47], s58 offen sc1
    s_add_u32 s35, s35, 1
    s_waitcnt vmcnt(0)
    v_max3_u32 v22, v32, v33, v34
    v_max3_u32 v22, v22, v35, v36
    v_max3_u32 v22, v22, v37, v38
    v_max_u32 v22, v22, v39
    v_cmp_eq_u32 vcc, -1, v22
    s_cbranch_vccz L_done26
    s_sleep 4
    s_cmp_lt_u32 s35, 60000
    s_cbranch_scc1 L_poll25
L_done26:
    v_lshlrev_b32 v24, 16, v32
    v_and_b32 v25, 0xffff0000, v32
    v_lshlrev_b32 v26, 16, v33
    v_and_b32 v27, 0xffff0000, v33
    v_lshlrev_b32 v20, 16, v34
    v_and_b32 v21, 0xffff0000, v34
    v_lshlrev_b32 v22, 16, v35
    v_and_b32 v23, 0xffff0000, v35
    v_add_f32 v24, v24, v20
    v_add_f32 v25, v25, v21
    v_add_f32 v26, v26, v22
    v_add_f32 v27, v27, v23
    v_lshlrev_b32 v20, 16, v36
    v_and_b32 v21, 0xffff0000, v36
    v_lshlrev_b32 v22, 16, v37
    v_and_b32 v23, 0xffff0000, v37
    v_add_f32 v24, v24, v20
    v_add_f32 v25, v25, v21
    v_add_f32 v26, v26, v22
    v_add_f32 v27, v27, v23
    v_lshlrev_b32 v20, 16, v38
    v_and_b32 v21, 0xffff0000, v38
    v_lshlrev_b32 v22, 16, v39
    v_and_b32 v23, 0xffff0000, v39
    v_add_f32 v24, v24, v20
    v_add_f32 v25, v25, v21
    v_add_f32 v26, v26, v22
    v_add_f32 v27, v27, v23
    v_cvt_pk_bf16_f32 v20, v24, v25
    v_cvt_pk_bf16_f32 v21, v26, v27
    v_min_u32 v20, -2, v20
    v_min_u32 v21, -2, v21
    v_mul_u32_u24 v22, 125952, v12
    v_add_u32 v199, 20480, v199
    v_add_u32 v199, v199, v22
    buffer_store_dwordx2 v[20:21], v199, s[44:47], 0 offen sc1
L_nomf:
    s_mov_b32 s63, 0
    s_mov_b32 s62, s61
    s_cmp_lt_u32 s61, 20
    s_cbranch_scc1 L_rd28
    s_mov_b32 s63, 2
    s_lshl_b32 s62, s60, 2
    s_and_b32 s34, s61, 3
    s_add_u32 s62, s62, s34
    s_cmp_lt_u32 s61, 24
    s_cbranch_scc1 L_rd28
    s_mov_b32 s63, 1
    s_cmp_ge_u32 s60, 2
    s_cbranch_scc1 L_rd29
    s_cmp_ge_u32 s61, 28
    s_cbranch_scc1 L_rd28
    s_mov_b32 s63, 2
    s_add_u32 s62, s62, 32
    s_branch L_rd28
L_rd29:
    s_lshl_b32 s62, s60, 3
    s_add_u32 s62, s62, s61
    s_sub_u32 s62, s62, 32
    s_cmp_ge_u32 s62, 54
    s_cselect_b32 s63, 3, 1
L_rd28:
    v_and_b32 v8, 3, v0
    v_bfe_u32 v9, v0, 2, 2
    v_lshrrev_b32 v10, 4, v0
    s_mov_b32 s55, 0x20000
    s_lshl_b32 s35, s62, 6
    s_and_b32 s49, s62, 1
    s_cmp_eq_u32 s63, 0
    s_cbranch_scc1 L_dp30
    s_cmp_eq_u32 s63, 1
    s_cbranch_scc1 L_dp31
    s_mov_b32 s52, s20
    s_mov_b32 s53, s21
    s_mov_b32 s54, 2211840
    v_mov_b32 v15, 0
    s_branch L_dp32
L_dp31:
    s_mov_b32 s52, s16
    s_mov_b32 s53, s17
    s_mov_b32 s54, 2211840
    v_lshl_add_u32 v15, v9, 3, v10
    v_mul_u32_u24 v15, 3456, v15
    v_lshl_add_u32 v15, v8, 4, v15
    v_add_u32 v15, s35, v15
    s_bfe_u32 s50, s3, 0x10001
    s_lshl_b32 s50, s50, 7
    s_and_b32 s34, s3, 1
    s_lshl_b32 s34, s34, 2
    s_add_u32 s50, s50, s34
    s_and_b32 s51, s3, 3
    s_lshl_b32 s51, s51, 5
    s_add_u32 s51, s51, 512
    s_mul_i32 s50, s50, 3456
    s_mul_i32 s51, s51, 3456
    s_branch L_dp32
L_dp30:
    s_mov_b32 s52, s12
    s_mov_b32 s53, s13
    s_mov_b32 s54, 5242880
    s_lshr_b32 s50, s3, 1
    s_lshl_b32 s50, s50, 3
    s_add_u32 s50, s50, s60
    s_and_b32 s51, s3, 1
    s_lshl_b32 s34, s50, 1
    s_add_u32 s34, s34, s51
    s_mul_i32 s34, s34, 81920
    s_add_u32 s34, s34, s35
    v_lshl_add_u32 v15, v9, 2, v10
    v_mul_u32_u24 v15, 2560, v15
    v_lshl_add_u32 v15, v8, 4, v15
    v_add_u32 v15, s34, v15
    s_lshl_b32 s56, s3, 12
    s_lshl_b32 s34, s49, 11
    s_add_u32 s56, s56, s34
    s_add_u32 s56, s56, 40960
    s_add_u32 s58, s56, 1024
    s_mul_i32 s57, s49, 40960
    s_add_u32 s59, s57, 1280
L_dp32:
    v_and_b32 v200, 3, v0
    v_bfe_u32 v201, v0, 2, 2
    v_lshrrev_b32 v202, 4, v0
    s_lshl_b32 s34, s3, 10
    s_add_u32 s34, s34, 122112
    v_lshl_add_u32 v203, v0, 4, s34
    s_movk_i32 s48, 5120
    v_mov_b32 v197, 0
    s_mov_b32 s40, 0
    s_mov_b32 s41, 0
    s_mov_b32 s42, 0
    s_cmp_eq_u32 s63, 0
    s_cbranch_scc1 L_d_wo
    s_cmp_eq_u32 s63, 2
    s_cbranch_scc1 L_d_w2
    s_cmp_eq_u32 s63, 3
    s_cbranch_scc1 L_d_none
    v_and_b32 v205, 15, v0
    v_lshlrev_b32 v205, 4, v205
    s_and_b32 s49, s3, 3
    s_mul_i32 s34, s49, 1280
    s_add_u32 s34, s34, 35840
    v_lshl_add_u32 v206, v202, 17, v205
    v_add_u32 v206, s34, v206
    s_mul_i32 s34, s49, 3840
    v_add_u32 v205, s34, v205
    s_lshl_b32 s34, s62, 6
    v_lshlrev_b32 v5, 4, v14
    v_lshl_add_u32 v5, v12, 2, v5
    v_add_u32 v5, s34, v5
    global_load_dword v6, v5, s[18:19]
    v_and_b32 v7, 15, v0
    v_lshlrev_b32 v7, 4, v7
    v_mul_u32_u24 v8, 1280, v14
    v_add_u32 v8, v8, v7
    v_lshl_add_u32 v9, v14, 17, v7
    v_add_u32 v9, 32000, v9
    v_mul_u32_u24 v5, 3840, v14
    v_add_u32 v5, v5, v7
    v_mov_b32 v22, 99072
    s_mov_b32 s35, 0
L_poll33:
    ds_read_b32 v23, v22
    s_add_u32 s35, s35, 1
    s_waitcnt lgkmcnt(0)
    v_cmp_gt_u32 vcc, 48, v23
    s_cbranch_vccz L_done34
    s_sleep 2
    s_cmp_lt_u32 s35, 60000
    s_cbranch_scc1 L_poll33
L_done34:
    global_load_dwordx4 v[32:35], v8, s[4:5] offset:0
    global_load_dwordx4 v[36:39], v8, s[4:5] offset:256
    global_load_dwordx4 v[40:43], v8, s[4:5] offset:512
    global_load_dwordx4 v[44:47], v8, s[4:5] offset:768
    global_load_dwordx4 v[48:51], v8, s[4:5] offset:1024
    s_mov_b32 s35, 0
L_poll36:
    buffer_load_dwordx4 v[52:55], v9, s[44:47], 0 offen offset:0 sc1
    buffer_load_dwordx4 v[56:59], v9, s[44:47], 0 offen offset:256 sc1
    buffer_load_dwordx4 v[60:63], v9, s[44:47], 0 offen offset:512 sc1
    buffer_load_dwordx4 v[64:67], v9, s[44:47], 0 offen offset:768 sc1
    buffer_load_dwordx4 v[68:71], v9, s[44:47], 0 offen offset:1024 sc1
    buffer_load_dwordx4 v[72:75], v9, s[44:47], 0 offen offset:1280 sc1
    buffer_load_dwordx4 v[76:79], v9, s[44:47], 0 offen offset:1536 sc1
    buffer_load_dwordx4 v[80:83], v9, s[44:47], 0 offen offset:1792 sc1
    buffer_load_dwordx4 v[84:87], v9, s[44:47], 0 offen offset:2048 sc1
    buffer_load_dwordx4 v[88:91], v9, s[44:47], 0 offen offset:2304 sc1
    s_add_u32 s35, s35, 1
    s_waitcnt vmcnt(0)
    v_max3_u32 v28, v52, v53, v54
    v_max3_u32 v28, v28, v55, v56
    v_max3_u32 v28, v28, v57, v58
    v_max3_u32 v28, v28, v59, v60
    v_max3_u32 v28, v28, v61, v62
    v_max3_u32 v28, v28, v63, v64
    v_max3_u32 v28, v28, v65, v66
    v_max3_u32 v28, v28, v67, v68
    v_max3_u32 v28, v28, v69, v70
    v_max3_u32 v28, v28, v71, v72
    v_max3_u32 v28, v28, v73, v74
    v_max3_u32 v28, v28, v75, v76
    v_max3_u32 v28, v28, v77, v78
    v_max3_u32 v28, v28, v79, v80
    v_max3_u32 v28, v28, v81, v82
    v_max3_u32 v28, v28, v83, v84
    v_max3_u32 v28, v28, v85, v86
    v_max3_u32 v28, v28, v87, v88
    v_max3_u32 v28, v28, v89, v90
    v_max_u32 v28, v28, v91
    v_cmp_eq_u32 vcc, -1, v28
    s_cbranch_vccz L_done37
    s_sleep 16
    s_cmp_lt_u32 s35, 60000
    s_cbranch_scc1 L_poll36
L_done37:
    ds_write_b128 v5, v[32:35] offset:0
    ds_write_b128 v5, v[36:39] offset:256
    ds_write_b128 v5, v[40:43] offset:512
    ds_write_b128 v5, v[44:47] offset:768
    ds_write_b128 v5, v[48:51] offset:1024
    ds_write_b128 v5, v[52:55] offset:1280
    ds_write_b128 v5, v[56:59] offset:1536
    ds_write_b128 v5, v[60:63] offset:1792
    ds_write_b128 v5, v[64:67] offset:2048
    ds_write_b128 v5, v[68:71] offset:2304
    ds_write_b128 v5, v[72:75] offset:2560
    ds_write_b128 v5, v[76:79] offset:2816
    ds_write_b128 v5, v[80:83] offset:3072
    ds_write_b128 v5, v[84:87] offset:3328
    ds_write_b128 v5, v[88:91] offset:3584
    s_waitcnt lgkmcnt(0)
    v_lshlrev_b32 v100, 16, v6
    v_and_b32 v101, 0xffff0000, v6
    s_lshr_b32 s34, s62, 1
    s_lshl_b32 s34, s34, 7
    s_and_b32 s35, s62, 1
    s_mul_i32 s35, s35, 221184
    s_add_u32 s34, s34, s35
    v_lshrrev_b32 v197, 1, v0
    v_mul_u32_u24 v197, 3456, v197
    v_and_b32 v196, 1, v0
    v_lshl_add_u32 v197, v196, 6, v197
    v_add_u32 v197, s34, v197
    s_mov_b32 s40, 110592
    s_mov_b32 s41, 331776
    s_branch L_d_none
L_d_w2:
    s_lshl_b32 s34, s62, 5
    v_lshl_add_u32 v3, v14, 3, s34
    global_load_dwordx2 v[20:21], v3, s[22:23]
    v_mul_u32_u24 v112, 1280, v12
    v_add_u32 v112, v112, v3
    global_load_dwordx2 v[22:23], v112, s[4:5]
    v_lshl_add_u32 v5, v12, 17, v3
    v_add_u32 v5, 34560, v5
    s_waitcnt vmcnt(0)
    v_lshlrev_b32 v32, 16, v20
    v_and_b32 v33, 0xffff0000, v20
    v_lshlrev_b32 v34, 16, v21
    v_and_b32 v35, 0xffff0000, v21
    v_lshlrev_b32 v108, 16, v22
    v_and_b32 v109, 0xffff0000, v22
    v_lshlrev_b32 v110, 16, v23
    v_and_b32 v111, 0xffff0000, v23
    v_mov_b32 v22, 99072
    s_mov_b32 s35, 0
L_poll39:
    ds_read_b32 v23, v22
    s_add_u32 s35, s35, 1
    s_waitcnt lgkmcnt(0)
    v_cmp_gt_u32 vcc, 48, v23
    s_cbranch_vccz L_done40
    s_sleep 2
    s_cmp_lt_u32 s35, 60000
    s_cbranch_scc1 L_poll39
L_done40:
    s_mov_b32 s35, 0
L_poll42:
    buffer_load_dwordx2 v[24:25], v5, s[44:47], 0 offen sc1
    s_add_u32 s35, s35, 1
    s_waitcnt vmcnt(0)
    v_max_u32 v28, v24, v25
    v_cmp_eq_u32 vcc, -1, v28
    s_cbranch_vccz L_done43
    s_sleep 16
    s_cmp_lt_u32 s35, 60000
    s_cbranch_scc1 L_poll42
L_done43:
    v_lshlrev_b32 v104, 16, v24
    v_and_b32 v105, 0xffff0000, v24
    v_lshlrev_b32 v106, 16, v25
    v_and_b32 v107, 0xffff0000, v25
    v_fma_f32 v108, v104, v32, v108
    v_fma_f32 v109, v105, v33, v109
    v_fma_f32 v110, v106, v34, v110
    v_fma_f32 v111, v107, v35, v111
    v_mul_f32 v108, 0x3e800000, v108
    v_mul_f32 v109, 0x3e800000, v109
    v_mul_f32 v110, 0x3e800000, v110
    v_mul_f32 v111, 0x3e800000, v111
    v_lshl_add_u32 v204, v13, 17, v112
    v_add_u32 v204, 35840, v204
    s_lshr_b32 s34, s62, 2
    s_lshl_b32 s34, s34, 7
    s_and_b32 s35, s62, 3
    s_mul_i32 s35, s35, 81920
    s_add_u32 s34, s34, s35
    v_lshrrev_b32 v197, 1, v0
    v_mul_u32_u24 v197, 1280, v197
    v_and_b32 v196, 1, v0
    v_lshl_add_u32 v197, v196, 6, v197
    v_add_u32 v197, s34, v197
    s_mov_b32 s40, 40960
    s_mov_b32 s41, 286720
    s_branch L_d_none
L_d_wo:
    s_lshr_b32 s49, s3, 1
    s_lshl_b32 s49, s49, 17
    v_and_b32 v210, 7, v0
    s_lshl_b32 s34, s60, 7
    s_add_u32 s34, s34, s49
    s_add_u32 s34, s34, 50176
    v_lshl_add_u32 v204, v210, 2, s34
    s_lshl_b32 s34, s60, 11
    s_lshl_b32 s35, s51, 7
    s_add_u32 s34, s34, s35
    s_add_u32 s34, s34, s49
    s_add_u32 s34, s34, 51200
    v_lshrrev_b32 v211, 3, v0
    v_lshlrev_b32 v205, 8, v211
    v_lshl_add_u32 v205, v210, 4, v205
    v_add_u32 v205, s34, v205
    s_lshl_b32 s34, s3, 12
    s_add_u32 s34, s34, 40960
    v_lshrrev_b32 v206, 2, v0
    v_lshlrev_b32 v206, 6, v206
    v_lshl_add_u32 v206, v200, 3, v206
    v_add_u32 v206, s34, v206
    s_mul_i32 s34, s3, 1152
    s_add_u32 s34, s34, 107520
    v_mul_u32_u24 v207, 144, v211
    v_lshl_add_u32 v207, v210, 4, v207
    v_add_u32 v207, s34, v207
    v_mul_u32_u24 v208, 144, v210
    v_lshl_add_u32 v208, v202, 4, v208
    v_add_u32 v208, s34, v208
    v_and_b32 v211, 1, v211
    v_lshl_add_u32 v203, v211, 6, v208
    v_add_u32 v203, 14592, v203
    v_mov_b32 v210, 98816
    v_cmp_eq_u32 vcc, 0, v211
    s_nop 1
    v_cndmask_b32 v209, v208, v210, vcc
    v_cndmask_b32 v208, v210, v208, vcc
    v_mov_b32 v6, v14
    v_and_b32 v8, 7, v0
    s_lshl_b32 s35, s62, 6
    v_lshl_add_u32 v8, v8, 3, s35
    v_lshl_add_u32 v9, v6, 17, v8
    v_add_u32 v9, 30720, v9
    s_lshr_b32 s34, s60, 2
    s_mul_i32 s34, s34, 5120
    s_and_b32 s35, s60, 3
    s_lshl_b32 s35, s35, 17
    s_add_u32 s34, s34, s35
    s_add_u32 s34, s34, 35840
    v_mul_u32_u24 v112, 1280, v6
    v_add3_u32 v112, v112, v8, s34
    s_lshr_b32 s34, s62, 1
    s_lshl_b32 s34, s34, 7
    s_and_b32 s35, s62, 1
    s_mul_i32 s35, s35, 40960
    s_add_u32 s34, s34, s35
    s_mul_i32 s35, s60, 163840
    s_add_u32 s34, s34, s35
    v_lshrrev_b32 v197, 1, v0
    v_mul_u32_u24 v197, 1280, v197
    v_and_b32 v196, 1, v0
    v_lshl_add_u32 v197, v196, 6, v197
    v_add_u32 v197, s34, v197
    s_mov_b32 s40, 81920
    s_mov_b32 s41, 1228800
    v_mov_b32 v22, 99072
    s_mov_b32 s35, 0
L_poll45:
    ds_read_b32 v23, v22
    s_add_u32 s35, s35, 1
    s_waitcnt lgkmcnt(0)
    v_cmp_gt_u32 vcc, 48, v23
    s_cbranch_vccz L_done46
    s_sleep 2
    s_cmp_lt_u32 s35, 60000
    s_cbranch_scc1 L_poll45
L_done46:
    s_mov_b32 s35, 0
L_poll48:
    buffer_load_dwordx2 v[32:33], v9, s[44:47], 0 offen sc1
    s_add_u32 s35, s35, 1
    s_waitcnt vmcnt(0)
    v_max_u32 v22, v32, v33
    v_cmp_eq_u32 vcc, -1, v22
    s_cbranch_vccz L_done49
    s_sleep 16
    s_cmp_lt_u32 s35, 60000
    s_cbranch_scc1 L_poll48
L_done49:
    v_lshlrev_b32 v100, 16, v32
    v_and_b32 v101, 0xffff0000, v32
    v_lshlrev_b32 v102, 16, v33
    v_and_b32 v103, 0xffff0000, v33
L_d_none:
    v_and_b32 v19, 7, v0
    v_lshlrev_b32 v19, 3, v19
    v_add_u32 v19, 98560, v19
    s_mov_b32 s35, 0
L_poll51:
    ds_read_b64 v[20:21], v19
    s_add_u32 s35, s35, 1
    s_waitcnt lgkmcnt(0)
    v_max_u32 v22, v20, v21
    v_cmp_eq_u32 vcc, -1, v22
    s_cbranch_vccz L_done52
    s_sleep 2
    s_cmp_lt_u32 s35, 60000
    s_cbranch_scc1 L_poll51
L_done52:
    v_max_f32_dpp v22, v20, v20 row_half_mirror row_mask:0xf bank_mask:0xf
    s_nop 1
    v_max_f32_dpp v22, v22, v22 quad_perm:[1,0,3,2] row_mask:0xf bank_mask:0xf
    s_nop 1
    v_max_f32_dpp v22, v22, v22 quad_perm:[2,3,0,1] row_mask:0xf bank_mask:0xf
    v_sub_f32 v20, v20, v22
    v_exp_f32 v20, v20
    s_nop 0
    v_mul_f32 v21, v21, v20
    s_nop 1
    v_add_f32_dpp v21, v21, v21 row_half_mirror row_mask:0xf bank_mask:0xf
    s_nop 1
    v_add_f32_dpp v21, v21, v21 quad_perm:[1,0,3,2] row_mask:0xf bank_mask:0xf
    s_nop 1
    v_add_f32_dpp v21, v21, v21 quad_perm:[2,3,0,1] row_mask:0xf bank_mask:0xf
    v_rcp_f32 v23, v21
    v_log_f32 v21, v21
    v_mul_f32 v20, v20, v23
    v_add_f32 v21, v21, v22
    v_min_u32 v21, -2, v21
    v_readlane_b32 s88, v20, 0
    v_readlane_b32 s90, v20, 1
    v_readlane_b32 s92, v20, 2
    v_readlane_b32 s94, v20, 3
    v_readlane_b32 s96, v20, 4
    v_readlane_b32 s98, v20, 5
    v_readlane_b32 s100, v20, 6
    v_readlane_b32 s89, v20, 7
    s_and_b32 s95, s61, 3
    s_lshl_b32 s95, s95, 17
    s_bfe_u32 s35, s2, 0x20005
    s_lshl_b32 s35, s35, 1
    s_lshr_b32 s91, s2, 7
    s_add_u32 s35, s35, s91
    s_lshl_b32 s91, s60, 7
    s_lshl_b32 s93, s35, 2
    s_add_u32 s91, s91, s93
    s_add_u32 s91, s91, s95
    s_add_u32 s91, s91, 50176
    v_mov_b32 v19, s91
    s_mov_b64 exec, 1
    buffer_store_dword v21, v19, s[44:47], 0 offen sc1
    s_mov_b64 exec, -1
    v_mul_f32 v20, s89, v116
    v_mul_f32 v21, s89, v117
    v_mul_f32 v22, s89, v118
    v_mul_f32 v23, s89, v119
    s_lshl_b32 s34, s60, 11
    s_lshl_b32 s35, s35, 8
    s_add_u32 s34, s34, s35
    s_add_u32 s34, s34, s95
    s_add_u32 s34, s34, 51200
    v_and_b32 v18, 7, v0
    v_lshl_add_u32 v18, v14, 3, v18
    v_lshl_add_u32 v18, v18, 3, s34
    v_lshlrev_b32 v19, 4, v0
    v_add_u32 v19, 99328, v19
    s_barrier
    buffer_load_dword v250, v197, s[52:55], s42 offen
    s_add_u32 s42, s42, s40
    buffer_load_dword v250, v197, s[52:55], s42 offen
    s_add_u32 s42, s42, s41
    buffer_load_dword v250, v197, s[52:55], s42 offen
    s_add_u32 s42, s42, s40
    buffer_load_dword v250, v197, s[52:55], s42 offen
    s_add_u32 s42, s42, s41
    buffer_load_dword v250, v197, s[52:55], s42 offen
    s_add_u32 s42, s42, s40
    buffer_load_dword v250, v197, s[52:55], s42 offen
    s_add_u32 s42, s42, s41
    buffer_load_dword v250, v197, s[52:55], s42 offen
    s_add_u32 s42, s42, s40
    buffer_load_dword v250, v197, s[52:55], s42 offen
    s_add_u32 s42, s42, s41
    s_barrier
    ds_read_b128 v[32:35], v19 offset:0
    ds_read_b128 v[36:39], v19 offset:1024
    ds_read_b128 v[40:43], v19 offset:2048
    ds_read_b128 v[44:47], v19 offset:3072
    ds_read_b128 v[48:51], v19 offset:4096
    ds_read_b128 v[52:55], v19 offset:5120
    ds_read_b128 v[56:59], v19 offset:6144
    s_waitcnt lgkmcnt(6)
    v_pk_fma_f32 v[20:21], v[32:33], s[88:89], v[20:21] op_sel_hi:[1,0,1]
    v_pk_fma_f32 v[22:23], v[34:35], s[88:89], v[22:23] op_sel_hi:[1,0,1]
    s_waitcnt lgkmcnt(5)
    v_pk_fma_f32 v[20:21], v[36:37], s[90:91], v[20:21] op_sel_hi:[1,0,1]
    v_pk_fma_f32 v[22:23], v[38:39], s[90:91], v[22:23] op_sel_hi:[1,0,1]
    s_waitcnt lgkmcnt(4)
    v_pk_fma_f32 v[20:21], v[40:41], s[92:93], v[20:21] op_sel_hi:[1,0,1]
    v_pk_fma_f32 v[22:23], v[42:43], s[92:93], v[22:23] op_sel_hi:[1,0,1]
    s_waitcnt lgkmcnt(3)
    v_pk_fma_f32 v[20:21], v[44:45], s[94:95], v[20:21] op_sel_hi:[1,0,1]
    v_pk_fma_f32 v[22:23], v[46:47], s[94:95], v[22:23] op_sel_hi:[1,0,1]
    s_waitcnt lgkmcnt(2)
    v_pk_fma_f32 v[20:21], v[48:49], s[96:97], v[20:21] op_sel_hi:[1,0,1]
    v_pk_fma_f32 v[22:23], v[50:51], s[96:97], v[22:23] op_sel_hi:[1,0,1]
    s_waitcnt lgkmcnt(1)
    v_pk_fma_f32 v[20:21], v[52:53], s[98:99], v[20:21] op_sel_hi:[1,0,1]
    v_pk_fma_f32 v[22:23], v[54:55], s[98:99], v[22:23] op_sel_hi:[1,0,1]
    s_waitcnt lgkmcnt(0)
    v_pk_fma_f32 v[20:21], v[56:57], s[100:101], v[20:21] op_sel_hi:[1,0,1]
    v_pk_fma_f32 v[22:23], v[58:59], s[100:101], v[22:23] op_sel_hi:[1,0,1]
    s_nop 0
    v_add_f32_dpp v20, v20, v20 row_ror:8 row_mask:0xf bank_mask:0xf
    v_add_f32_dpp v21, v21, v21 row_ror:8 row_mask:0xf bank_mask:0xf
    v_add_f32_dpp v22, v22, v22 row_ror:8 row_mask:0xf bank_mask:0xf
    v_add_f32_dpp v23, v23, v23 row_ror:8 row_mask:0xf bank_mask:0xf
    v_cvt_pk_bf16_f32 v24, v20, v21
    v_cvt_pk_bf16_f32 v25, v22, v23
    v_min_u32 v24, -2, v24
    v_min_u32 v25, -2, v25
    s_mov_b32 exec_lo, 0x00ff00ff
    s_mov_b32 exec_hi, 0x00ff00ff
    buffer_store_dwordx2 v[24:25], v18, s[44:47], 0 offen sc1
    s_mov_b64 exec, -1
    s_barrier
    s_cmp_eq_u32 s63, 0
    s_cbranch_scc1 L_r_wo
    buffer_load_dword v250, v197, s[52:55], s42 offen
    s_add_u32 s42, s42, s40
    buffer_load_dword v250, v197, s[52:55], s42 offen
    s_add_u32 s42, s42, s41
    s_cmp_eq_u32 s63, 1
    s_cbranch_scc1 L_r_w1
    buffer_load_dword v250, v197, s[52:55], s42 offen
    s_add_u32 s42, s42, s40
    buffer_load_dword v250, v197, s[52:55], s42 offen
    s_add_u32 s42, s42, s41
    buffer_load_dword v250, v197, s[52:55], s42 offen
    s_add_u32 s42, s42, s40
    buffer_load_dword v250, v197, s[52:55], s42 offen
    s_add_u32 s42, s42, s41
    s_cmp_eq_u32 s63, 2
    s_cbranch_scc1 L_w2_red
    s_branch L_fin
L_stream:
    s_sub_u32 s49, s3, 1
    s_lshl_b32 s49, s49, 12
    v_lshl_add_u32 v1, v0, 4, s49
    s_and_b32 s34, s2, 127
    s_lshl_b32 s34, s34, 21
    s_lshr_b32 s35, s2, 7
    s_lshl_b32 s35, s35, 18
    s_add_u32 s34, s34, s35
    s_add_u32 s34, s34, 1572864
    s_mov_b32 s38, 0x40000
    s_mov_b32 s42, 0x40000
    s_waitcnt lgkmcnt(0)
    s_add_u32 s36, s6, s34
    s_addc_u32 s37, s7, 0
    s_add_u32 s40, s8, s34
    s_addc_u32 s41, s9, 0
    s_mov_b32 s49, 0
    buffer_load_dwordx4 v[16:19], v1, s[36:39], s49 offen offset:0 nt
    buffer_load_dwordx4 v[160:163], v1, s[40:43], s49 offen offset:0 nt
    buffer_load_dwordx4 v[20:23], v1, s[36:39], s49 offen offset:1024 nt
    s_barrier
    s_waitcnt vmcnt(2)
    buffer_load_dwordx4 v[24:27], v1, s[36:39], s49 offen offset:2048 nt
    s_waitcnt vmcnt(2)
    buffer_load_dwordx4 v[28:31], v1, s[36:39], s49 offen offset:3072 nt
    s_waitcnt vmcnt(2)
    s_mov_b32 s49, 28672
    buffer_load_dwordx4 v[32:35], v1, s[36:39], s49 offen offset:0 nt
    s_waitcnt vmcnt(2)
    buffer_load_dwordx4 v[36:39], v1, s[36:39], s49 offen offset:1024 nt
    s_waitcnt vmcnt(2)
    buffer_load_dwordx4 v[40:43], v1, s[36:39], s49 offen offset:2048 nt
    s_add_u32 s44, s32, 0
    s_addc_u32 s45, s33, 0
    s_mov_b32 s63, 0
    s_mov_b32 s62, s61
    s_cmp_lt_u32 s61, 20
    s_cbranch_scc1 L_rd54
    s_mov_b32 s63, 2
    s_lshl_b32 s62, s60, 2
    s_and_b32 s34, s61, 3
    s_add_u32 s62, s62, s34
    s_cmp_lt_u32 s61, 24
    s_cbranch_scc1 L_rd54
    s_mov_b32 s63, 1
    s_cmp_ge_u32 s60, 2
    s_cbranch_scc1 L_rd55
    s_cmp_ge_u32 s61, 28
    s_cbranch_scc1 L_rd54
    s_mov_b32 s63, 2
    s_add_u32 s62, s62, 32
    s_branch L_rd54
L_rd55:
    s_lshl_b32 s62, s60, 3
    s_add_u32 s62, s62, s61
    s_sub_u32 s62, s62, 32
    s_cmp_ge_u32 s62, 54
    s_cselect_b32 s63, 3, 1
L_rd54:
    v_and_b32 v8, 3, v0
    v_bfe_u32 v9, v0, 2, 2
    v_lshrrev_b32 v10, 4, v0
    s_mov_b32 s55, 0x20000
    s_lshl_b32 s35, s62, 6
    s_and_b32 s49, s62, 1
    s_cmp_eq_u32 s63, 0
    s_cbranch_scc1 L_dp56
    s_cmp_eq_u32 s63, 1
    s_cbranch_scc1 L_dp57
    s_mov_b32 s52, s20
    s_mov_b32 s53, s21
    s_mov_b32 s54, 2211840
    v_mov_b32 v15, 0
    s_branch L_dp58
L_dp57:
    s_mov_b32 s52, s16
    s_mov_b32 s53, s17
    s_mov_b32 s54, 2211840
    v_lshl_add_u32 v15, v9, 3, v10
    v_mul_u32_u24 v15, 3456, v15
    v_lshl_add_u32 v15, v8, 4, v15
    v_add_u32 v15, s35, v15
    s_bfe_u32 s50, s3, 0x10001
    s_lshl_b32 s50, s50, 7
    s_and_b32 s34, s3, 1
    s_lshl_b32 s34, s34, 2
    s_add_u32 s50, s50, s34
    s_and_b32 s51, s3, 3
    s_lshl_b32 s51, s51, 5
    s_add_u32 s51, s51, 512
    s_mul_i32 s50, s50, 3456
    s_mul_i32 s51, s51, 3456
    s_branch L_dp58
L_dp56:
    s_mov_b32 s52, s12
    s_mov_b32 s53, s13
    s_mov_b32 s54, 5242880
    s_lshr_b32 s50, s3, 1
    s_lshl_b32 s50, s50, 3
    s_add_u32 s50, s50, s60
    s_and_b32 s51, s3, 1
    s_lshl_b32 s34, s50, 1
    s_add_u32 s34, s34, s51
    s_mul_i32 s34, s34, 81920
    s_add_u32 s34, s34, s35
    v_lshl_add_u32 v15, v9, 2, v10
    v_mul_u32_u24 v15, 2560, v15
    v_lshl_add_u32 v15, v8, 4, v15
    v_add_u32 v15, s34, v15
    s_lshl_b32 s56, s3, 12
    s_lshl_b32 s34, s49, 11
    s_add_u32 s56, s56, s34
    s_add_u32 s56, s56, 40960
    s_add_u32 s58, s56, 1024
    s_mul_i32 s57, s49, 40960
    s_add_u32 s59, s57, 1280
L_dp58:
    v_and_b32 v2, 15, v0
    v_lshlrev_b32 v2, 4, v2
    v_add_u32 v2, 98304, v2
    s_waitcnt vmcnt(2)
    s_mov_b32 s49, 28672
    buffer_load_dwordx4 v[44:47], v1, s[36:39], s49 offen offset:3072 nt
    s_waitcnt vmcnt(2)
    s_mov_b32 s49, 57344
    buffer_load_dwordx4 v[48:51], v1, s[36:39], s49 offen offset:0 nt
    s_waitcnt vmcnt(2)
    buffer_load_dwordx4 v[52:55], v1, s[36:39], s49 offen offset:1024 nt
    s_waitcnt vmcnt(2)
    buffer_load_dwordx4 v[56:59], v1, s[36:39], s49 offen offset:2048 nt
    s_waitcnt vmcnt(2)
    buffer_load_dwordx4 v[60:63], v1, s[36:39], s49 offen offset:3072 nt
    s_waitcnt vmcnt(2)
    s_mov_b32 s49, 86016
    buffer_load_dwordx4 v[64:67], v1, s[36:39], s49 offen offset:0 nt
    s_waitcnt vmcnt(2)
    buffer_load_dwordx4 v[68:71], v1, s[36:39], s49 offen offset:1024 nt
    s_waitcnt vmcnt(2)
    buffer_load_dwordx4 v[72:75], v1, s[36:39], s49 offen offset:2048 nt
    s_waitcnt vmcnt(2)
    buffer_load_dwordx4 v[76:79], v1, s[36:39], s49 offen offset:3072 nt
    s_waitcnt vmcnt(2)
    s_mov_b32 s49, 114688
    buffer_load_dwordx4 v[80:83], v1, s[36:39], s49 offen offset:0 nt
    s_waitcnt vmcnt(2)
    buffer_load_dwordx4 v[84:87], v1, s[36:39], s49 offen offset:1024 nt
    s_waitcnt vmcnt(2)
    buffer_load_dwordx4 v[88:91], v1, s[36:39], s49 offen offset:2048 nt
    v_mov_b32 v3, 20
    ds_write_b32 v2, v3 offset:768
    s_waitcnt vmcnt(2)
    buffer_load_dwordx4 v[92:95], v1, s[36:39], s49 offen offset:3072 nt
    s_waitcnt vmcnt(2)
    s_mov_b32 s49, 143360
    buffer_load_dwordx4 v[96:99], v1, s[36:39], s49 offen offset:0 nt
    s_waitcnt vmcnt(2)
    buffer_load_dwordx4 v[100:103], v1, s[36:39], s49 offen offset:1024 nt
    s_waitcnt vmcnt(2)
    buffer_load_dwordx4 v[104:107], v1, s[36:39], s49 offen offset:2048 nt
    s_waitcnt vmcnt(2)
    buffer_load_dwordx4 v[108:111], v1, s[36:39], s49 offen offset:3072 nt
    s_waitcnt vmcnt(2)
    s_mov_b32 s49, 172032
    buffer_load_dwordx4 v[112:115], v1, s[36:39], s49 offen offset:0 nt
    s_waitcnt vmcnt(2)
    buffer_load_dwordx4 v[116:119], v1, s[36:39], s49 offen offset:1024 nt
    s_waitcnt vmcnt(2)
    buffer_load_dwordx4 v[120:123], v1, s[36:39], s49 offen offset:2048 nt
    s_waitcnt vmcnt(2)
    buffer_load_dwordx4 v[124:127], v1, s[36:39], s49 offen offset:3072 nt
    s_waitcnt vmcnt(2)
    s_mov_b32 s49, 200704
    buffer_load_dwordx4 v[128:131], v1, s[36:39], s49 offen offset:0 nt
    s_waitcnt vmcnt(2)
    buffer_load_dwordx4 v[132:135], v1, s[36:39], s49 offen offset:1024 nt
    s_waitcnt vmcnt(2)
    buffer_load_dwordx4 v[136:139], v1, s[36:39], s49 offen offset:2048 nt
    s_waitcnt vmcnt(2)
    buffer_load_dwordx4 v[140:143], v1, s[36:39], s49 offen offset:3072 nt
    v_mov_b32 v3, 33
    ds_write_b32 v2, v3 offset:768
    s_waitcnt vmcnt(2)
    s_mov_b32 s49, 229376
    buffer_load_dwordx4 v[144:147], v1, s[36:39], s49 offen offset:0 nt
    s_waitcnt vmcnt(2)
    buffer_load_dwordx4 v[148:151], v1, s[36:39], s49 offen offset:1024 nt
    s_waitcnt vmcnt(2)
    buffer_load_dwordx4 v[152:155], v1, s[36:39], s49 offen offset:2048 nt
    s_waitcnt vmcnt(2)
    buffer_load_dwordx4 v[156:159], v1, s[36:39], s49 offen offset:3072 nt
    s_waitcnt vmcnt(2)
    s_mov_b32 s49, 0
    buffer_load_dwordx4 v[164:167], v1, s[40:43], s49 offen offset:1024 nt
    s_waitcnt vmcnt(2)
    buffer_load_dwordx4 v[168:171], v1, s[40:43], s49 offen offset:2048 nt
    s_waitcnt vmcnt(2)
    buffer_load_dwordx4 v[172:175], v1, s[40:43], s49 offen offset:3072 nt
    s_waitcnt vmcnt(2)
    s_mov_b32 s49, 28672
    buffer_load_dwordx4 v[176:179], v1, s[40:43], s49 offen offset:0 nt
    s_waitcnt vmcnt(2)
    buffer_load_dwordx4 v[180:183], v1, s[40:43], s49 offen offset:1024 nt
    s_waitcnt vmcnt(2)
    buffer_load_dwordx4 v[184:187], v1, s[40:43], s49 offen offset:2048 nt
    s_waitcnt vmcnt(2)
    buffer_load_dwordx4 v[188:191], v1, s[40:43], s49 offen offset:3072 nt
    s_waitcnt vmcnt(2)
    s_mov_b32 s49, 57344
    buffer_load_dwordx4 v[192:195], v1, s[40:43], s49 offen offset:0 nt
    s_waitcnt vmcnt(2)
    buffer_load_dwordx4 v[196:199], v1, s[40:43], s49 offen offset:1024 nt
    s_waitcnt vmcnt(2)
    buffer_load_dwordx4 v[200:203], v1, s[40:43], s49 offen offset:2048 nt
    s_waitcnt vmcnt(2)
    buffer_load_dwordx4 v[204:207], v1, s[40:43], s49 offen offset:3072 nt
    v_mov_b32 v3, 48
    ds_write_b32 v2, v3 offset:768
    s_waitcnt vmcnt(2)
    s_mov_b32 s49, 86016
    buffer_load_dwordx4 v[208:211], v1, s[40:43], s49 offen offset:0 nt
    s_waitcnt vmcnt(2)
    buffer_load_dwordx4 v[212:215], v1, s[40:43], s49 offen offset:1024 nt
    s_waitcnt vmcnt(2)
    buffer_load_dwordx4 v[216:219], v1, s[40:43], s49 offen offset:2048 nt
    s_waitcnt vmcnt(2)
    buffer_load_dwordx4 v[220:223], v1, s[40:43], s49 offen offset:3072 nt
    s_mov_b32 s49, 114688
    buffer_load_dwordx4 v[224:227], v1, s[40:43], s49 offen offset:0 nt
    s_waitcnt vmcnt(3)
    buffer_load_dwordx4 v[228:231], v1, s[40:43], s49 offen offset:1024 nt
    s_waitcnt vmcnt(3)
    buffer_load_dwordx4 v[232:235], v1, s[40:43], s49 offen offset:2048 nt
    s_waitcnt vmcnt(3)
    buffer_load_dwordx4 v[236:239], v1, s[40:43], s49 offen offset:3072 nt
    s_waitcnt vmcnt(3)
    s_mov_b32 s49, 143360
    buffer_load_dwordx4 v[240:243], v1, s[40:43], s49 offen offset:0 nt
    s_waitcnt vmcnt(3)
    buffer_load_dwordx4 v[244:247], v1, s[40:43], s49 offen offset:1024 nt
    s_waitcnt vmcnt(3)
    buffer_load_dwordx4 v[248:251], v1, s[40:43], s49 offen offset:2048 nt
    s_waitcnt vmcnt(3)
    buffer_load_dwordx4 v[252:255], v1, s[40:43], s49 offen offset:3072 nt
    s_mov_b32 s35, 0
L_poll59:
    ds_read_b128 v[4:7], v2
    s_add_u32 s35, s35, 1
    s_waitcnt lgkmcnt(0)
    v_max3_u32 v3, v4, v5, v6
    v_max_u32 v3, v3, v7
    v_cmp_eq_u32 vcc, -1, v3
    s_cbranch_vccz L_done60
    s_sleep 2
    s_cmp_lt_u32 s35, 60000
    s_cbranch_scc1 L_poll59
L_done60:
    v_dot2_f32_bf16 v8, v16, v4, 0
    v_dot2_f32_bf16 v9, v20, v4, 0
    v_dot2_f32_bf16 v10, v24, v4, 0
    v_dot2_f32_bf16 v11, v28, v4, 0
    v_dot2c_f32_bf16 v8, v17, v5
    v_dot2c_f32_bf16 v9, v21, v5
    v_dot2c_f32_bf16 v10, v25, v5
    v_dot2c_f32_bf16 v11, v29, v5
    v_dot2c_f32_bf16 v8, v18, v6
    v_dot2c_f32_bf16 v9, v22, v6
    v_dot2c_f32_bf16 v10, v26, v6
    v_dot2c_f32_bf16 v11, v30, v6
    v_dot2c_f32_bf16 v8, v19, v7
    v_dot2c_f32_bf16 v9, v23, v7
    v_dot2c_f32_bf16 v10, v27, v7
    v_dot2c_f32_bf16 v11, v31, v7
    v_add_f32_dpp v12, v8, v8 row_ror:8 row_mask:0xf bank_mask:0x3
    v_add_f32_dpp v12, v9, v9 row_ror:8 row_mask:0xf bank_mask:0xc
    v_add_f32_dpp v13, v10, v10 row_ror:8 row_mask:0xf bank_mask:0x3
    v_add_f32_dpp v13, v11, v11 row_ror:8 row_mask:0xf bank_mask:0xc
    v_dot2_f32_bf16 v8, v32, v4, 0
    v_dot2_f32_bf16 v9, v36, v4, 0
    v_dot2_f32_bf16 v10, v40, v4, 0
    v_dot2_f32_bf16 v11, v44, v4, 0
    v_add_f32_dpp v12, v12, v12 row_half_mirror row_mask:0xf bank_mask:0xf
    v_add_f32_dpp v13, v13, v13 row_half_mirror row_mask:0xf bank_mask:0xf
    v_dot2c_f32_bf16 v8, v33, v5
    v_dot2c_f32_bf16 v9, v37, v5
    v_dot2c_f32_bf16 v10, v41, v5
    v_dot2c_f32_bf16 v11, v45, v5
    v_add_f32_dpp v12, v12, v12 quad_perm:[1,0,3,2] row_mask:0xf bank_mask:0xf
    v_add_f32_dpp v13, v13, v13 quad_perm:[1,0,3,2] row_mask:0xf bank_mask:0xf
    v_dot2c_f32_bf16 v8, v34, v6
    v_dot2c_f32_bf16 v9, v38, v6
    v_dot2c_f32_bf16 v10, v42, v6
    v_dot2c_f32_bf16 v11, v46, v6
    v_add_f32_dpp v12, v12, v12 quad_perm:[2,3,0,1] row_mask:0xf bank_mask:0xf
    v_add_f32_dpp v13, v13, v13 quad_perm:[2,3,0,1] row_mask:0xf bank_mask:0xf
    v_dot2c_f32_bf16 v8, v35, v7
    v_dot2c_f32_bf16 v9, v39, v7
    v_dot2c_f32_bf16 v10, v43, v7
    v_dot2c_f32_bf16 v11, v47, v7
    s_waitcnt vmcnt(3)
    s_mov_b32 s49, 172032
    buffer_load_dwordx4 v[32:35], v1, s[40:43], s49 offen offset:0 nt
    v_add_f32_dpp v16, v8, v8 row_ror:8 row_mask:0xf bank_mask:0x3
    v_add_f32_dpp v16, v9, v9 row_ror:8 row_mask:0xf bank_mask:0xc
    v_add_f32_dpp v17, v10, v10 row_ror:8 row_mask:0xf bank_mask:0x3
    v_add_f32_dpp v17, v11, v11 row_ror:8 row_mask:0xf bank_mask:0xc
    v_dot2_f32_bf16 v8, v48, v4, 0
    v_dot2_f32_bf16 v9, v52, v4, 0
    v_dot2_f32_bf16 v10, v56, v4, 0
    v_dot2_f32_bf16 v11, v60, v4, 0
    v_add_f32_dpp v16, v16, v16 row_half_mirror row_mask:0xf bank_mask:0xf
    v_add_f32_dpp v17, v17, v17 row_half_mirror row_mask:0xf bank_mask:0xf
    v_dot2c_f32_bf16 v8, v49, v5
    v_dot2c_f32_bf16 v9, v53, v5
    v_dot2c_f32_bf16 v10, v57, v5
    v_dot2c_f32_bf16 v11, v61, v5
    v_add_f32_dpp v16, v16, v16 quad_perm:[1,0,3,2] row_mask:0xf bank_mask:0xf
    v_add_f32_dpp v17, v17, v17 quad_perm:[1,0,3,2] row_mask:0xf bank_mask:0xf
    v_dot2c_f32_bf16 v8, v50, v6
    v_dot2c_f32_bf16 v9, v54, v6
    v_dot2c_f32_bf16 v10, v58, v6
    v_dot2c_f32_bf16 v11, v62, v6
    v_add_f32_dpp v16, v16, v16 quad_perm:[2,3,0,1] row_mask:0xf bank_mask:0xf
    v_add_f32_dpp v17, v17, v17 quad_perm:[2,3,0,1] row_mask:0xf bank_mask:0xf
    v_dot2c_f32_bf16 v8, v51, v7
    v_dot2c_f32_bf16 v9, v55, v7
    v_dot2c_f32_bf16 v10, v59, v7
    v_dot2c_f32_bf16 v11, v63, v7
    v_add_f32_dpp v18, v8, v8 row_ror:8 row_mask:0xf bank_mask:0x3
    v_add_f32_dpp v18, v9, v9 row_ror:8 row_mask:0xf bank_mask:0xc
    v_add_f32_dpp v19, v10, v10 row_ror:8 row_mask:0xf bank_mask:0x3
    v_add_f32_dpp v19, v11, v11 row_ror:8 row_mask:0xf bank_mask:0xc
    v_dot2_f32_bf16 v8, v64, v4, 0
    v_dot2_f32_bf16 v9, v68, v4, 0
    v_dot2_f32_bf16 v10, v72, v4, 0
    v_dot2_f32_bf16 v11, v76, v4, 0
    v_add_f32_dpp v18, v18, v18 row_half_mirror row_mask:0xf bank_mask:0xf
    v_add_f32_dpp v19, v19, v19 row_half_mirror row_mask:0xf bank_mask:0xf
    v_dot2c_f32_bf16 v8, v65, v5
    v_dot2c_f32_bf16 v9, v69, v5
    v_dot2c_f32_bf16 v10, v73, v5
    v_dot2c_f32_bf16 v11, v77, v5
    v_add_f32_dpp v18, v18, v18 quad_perm:[1,0,3,2] row_mask:0xf bank_mask:0xf
    v_add_f32_dpp v19, v19, v19 quad_perm:[1,0,3,2] row_mask:0xf bank_mask:0xf
    v_dot2c_f32_bf16 v8, v66, v6
    v_dot2c_f32_bf16 v9, v70, v6
    v_dot2c_f32_bf16 v10, v74, v6
    v_dot2c_f32_bf16 v11, v78, v6
    v_add_f32_dpp v18, v18, v18 quad_perm:[2,3,0,1] row_mask:0xf bank_mask:0xf
    v_add_f32_dpp v19, v19, v19 quad_perm:[2,3,0,1] row_mask:0xf bank_mask:0xf
    v_dot2c_f32_bf16 v8, v67, v7
    v_dot2c_f32_bf16 v9, v71, v7
    v_dot2c_f32_bf16 v10, v75, v7
    v_dot2c_f32_bf16 v11, v79, v7
    v_add_f32_dpp v20, v8, v8 row_ror:8 row_mask:0xf bank_mask:0x3
    v_add_f32_dpp v20, v9, v9 row_ror:8 row_mask:0xf bank_mask:0xc
    v_add_f32_dpp v21, v10, v10 row_ror:8 row_mask:0xf bank_mask:0x3
    v_add_f32_dpp v21, v11, v11 row_ror:8 row_mask:0xf bank_mask:0xc
    v_dot2_f32_bf16 v8, v80, v4, 0
    v_dot2_f32_bf16 v9, v84, v4, 0
    v_dot2_f32_bf16 v10, v88, v4, 0
    v_dot2_f32_bf16 v11, v92, v4, 0
    s_waitcnt vmcnt(3)
    buffer_load_dwordx4 v[36:39], v1, s[40:43], s49 offen offset:1024 nt
    v_add_f32_dpp v20, v20, v20 row_half_mirror row_mask:0xf bank_mask:0xf
    v_add_f32_dpp v21, v21, v21 row_half_mirror row_mask:0xf bank_mask:0xf
    v_dot2c_f32_bf16 v8, v81, v5
    v_dot2c_f32_bf16 v9, v85, v5
    v_dot2c_f32_bf16 v10, v89, v5
    v_dot2c_f32_bf16 v11, v93, v5
    v_add_f32_dpp v20, v20, v20 quad_perm:[1,0,3,2] row_mask:0xf bank_mask:0xf
    v_add_f32_dpp v21, v21, v21 quad_perm:[1,0,3,2] row_mask:0xf bank_mask:0xf
    v_dot2c_f32_bf16 v8, v82, v6
    v_dot2c_f32_bf16 v9, v86, v6
    v_dot2c_f32_bf16 v10, v90, v6
    v_dot2c_f32_bf16 v11, v94, v6
    v_add_f32_dpp v20, v20, v20 quad_perm:[2,3,0,1] row_mask:0xf bank_mask:0xf
    v_add_f32_dpp v21, v21, v21 quad_perm:[2,3,0,1] row_mask:0xf bank_mask:0xf
    v_dot2c_f32_bf16 v8, v83, v7
    v_dot2c_f32_bf16 v9, v87, v7
    v_dot2c_f32_bf16 v10, v91, v7
    v_dot2c_f32_bf16 v11, v95, v7
    v_add_f32_dpp v22, v8, v8 row_ror:8 row_mask:0xf bank_mask:0x3
    v_add_f32_dpp v22, v9, v9 row_ror:8 row_mask:0xf bank_mask:0xc
    v_add_f32_dpp v23, v10, v10 row_ror:8 row_mask:0xf bank_mask:0x3
    v_add_f32_dpp v23, v11, v11 row_ror:8 row_mask:0xf bank_mask:0xc
    v_dot2_f32_bf16 v8, v96, v4, 0
    v_dot2_f32_bf16 v9, v100, v4, 0
    v_dot2_f32_bf16 v10, v104, v4, 0
    v_dot2_f32_bf16 v11, v108, v4, 0
    v_add_f32_dpp v22, v22, v22 row_half_mirror row_mask:0xf bank_mask:0xf
    v_add_f32_dpp v23, v23, v23 row_half_mirror row_mask:0xf bank_mask:0xf
    v_dot2c_f32_bf16 v8, v97, v5
    v_dot2c_f32_bf16 v9, v101, v5
    v_dot2c_f32_bf16 v10, v105, v5
    v_dot2c_f32_bf16 v11, v109, v5
    v_add_f32_dpp v22, v22, v22 quad_perm:[1,0,3,2] row_mask:0xf bank_mask:0xf
    v_add_f32_dpp v23, v23, v23 quad_perm:[1,0,3,2] row_mask:0xf bank_mask:0xf
    v_dot2c_f32_bf16 v8, v98, v6
    v_dot2c_f32_bf16 v9, v102, v6
    v_dot2c_f32_bf16 v10, v106, v6
    v_dot2c_f32_bf16 v11, v110, v6
    v_add_f32_dpp v22, v22, v22 quad_perm:[2,3,0,1] row_mask:0xf bank_mask:0xf
    v_add_f32_dpp v23, v23, v23 quad_perm:[2,3,0,1] row_mask:0xf bank_mask:0xf
    v_dot2c_f32_bf16 v8, v99, v7
    v_dot2c_f32_bf16 v9, v103, v7
    v_dot2c_f32_bf16 v10, v107, v7
    v_dot2c_f32_bf16 v11, v111, v7
    v_add_f32_dpp v24, v8, v8 row_ror:8 row_mask:0xf bank_mask:0x3
    v_add_f32_dpp v24, v9, v9 row_ror:8 row_mask:0xf bank_mask:0xc
    v_add_f32_dpp v25, v10, v10 row_ror:8 row_mask:0xf bank_mask:0x3
    v_add_f32_dpp v25, v11, v11 row_ror:8 row_mask:0xf bank_mask:0xc
    v_dot2_f32_bf16 v8, v112, v4, 0
    v_dot2_f32_bf16 v9, v116, v4, 0
    v_dot2_f32_bf16 v10, v120, v4, 0
    v_dot2_f32_bf16 v11, v124, v4, 0
    v_add_f32_dpp v24, v24, v24 row_half_mirror row_mask:0xf bank_mask:0xf
    v_add_f32_dpp v25, v25, v25 row_half_mirror row_mask:0xf bank_mask:0xf
    v_dot2c_f32_bf16 v8, v113, v5
    v_dot2c_f32_bf16 v9, v117, v5
    v_dot2c_f32_bf16 v10, v121, v5
    v_dot2c_f32_bf16 v11, v125, v5
    v_add_f32_dpp v24, v24, v24 quad_perm:[1,0,3,2] row_mask:0xf bank_mask:0xf
    v_add_f32_dpp v25, v25, v25 quad_perm:[1,0,3,2] row_mask:0xf bank_mask:0xf
    s_waitcnt vmcnt(3)
    buffer_load_dwordx4 v[40:43], v1, s[40:43], s49 offen offset:2048 nt
    v_dot2c_f32_bf16 v8, v114, v6
    v_dot2c_f32_bf16 v9, v118, v6
    v_dot2c_f32_bf16 v10, v122, v6
    v_dot2c_f32_bf16 v11, v126, v6
    v_add_f32_dpp v24, v24, v24 quad_perm:[2,3,0,1] row_mask:0xf bank_mask:0xf
    v_add_f32_dpp v25, v25, v25 quad_perm:[2,3,0,1] row_mask:0xf bank_mask:0xf
    v_dot2c_f32_bf16 v8, v115, v7
    v_dot2c_f32_bf16 v9, v119, v7
    v_dot2c_f32_bf16 v10, v123, v7
    v_dot2c_f32_bf16 v11, v127, v7
    v_add_f32_dpp v26, v8, v8 row_ror:8 row_mask:0xf bank_mask:0x3
    v_add_f32_dpp v26, v9, v9 row_ror:8 row_mask:0xf bank_mask:0xc
    v_add_f32_dpp v27, v10, v10 row_ror:8 row_mask:0xf bank_mask:0x3
    v_add_f32_dpp v27, v11, v11 row_ror:8 row_mask:0xf bank_mask:0xc
    v_dot2_f32_bf16 v8, v128, v4, 0
    v_dot2_f32_bf16 v9, v132, v4, 0
    v_dot2_f32_bf16 v10, v136, v4, 0
    v_dot2_f32_bf16 v11, v140, v4, 0
    v_add_f32_dpp v26, v26, v26 row_half_mirror row_mask:0xf bank_mask:0xf
    v_add_f32_dpp v27, v27, v27 row_half_mirror row_mask:0xf bank_mask:0xf
    v_dot2c_f32_bf16 v8, v129, v5
    v_dot2c_f32_bf16 v9, v133, v5
    v_dot2c_f32_bf16 v10, v137, v5
    v_dot2c_f32_bf16 v11, v141, v5
    v_add_f32_dpp v26, v26, v26 quad_perm:[1,0,3,2] row_mask:0xf bank_mask:0xf
    v_add_f32_dpp v27, v27, v27 quad_perm:[1,0,3,2] row_mask:0xf bank_mask:0xf
    v_dot2c_f32_bf16 v8, v130, v6
    v_dot2c_f32_bf16 v9, v134, v6
    v_dot2c_f32_bf16 v10, v138, v6
    v_dot2c_f32_bf16 v11, v142, v6
    v_add_f32_dpp v26, v26, v26 quad_perm:[2,3,0,1] row_mask:0xf bank_mask:0xf
    v_add_f32_dpp v27, v27, v27 quad_perm:[2,3,0,1] row_mask:0xf bank_mask:0xf
    v_dot2c_f32_bf16 v8, v131, v7
    v_dot2c_f32_bf16 v9, v135, v7
    v_dot2c_f32_bf16 v10, v139, v7
    v_dot2c_f32_bf16 v11, v143, v7
    v_add_f32_dpp v28, v8, v8 row_ror:8 row_mask:0xf bank_mask:0x3
    v_add_f32_dpp v28, v9, v9 row_ror:8 row_mask:0xf bank_mask:0xc
    v_add_f32_dpp v29, v10, v10 row_ror:8 row_mask:0xf bank_mask:0x3
    v_add_f32_dpp v29, v11, v11 row_ror:8 row_mask:0xf bank_mask:0xc
    v_dot2_f32_bf16 v8, v144, v4, 0
    v_dot2_f32_bf16 v9, v148, v4, 0
    v_dot2_f32_bf16 v10, v152, v4, 0
    v_dot2_f32_bf16 v11, v156, v4, 0
    v_add_f32_dpp v28, v28, v28 row_half_mirror row_mask:0xf bank_mask:0xf
    v_add_f32_dpp v29, v29, v29 row_half_mirror row_mask:0xf bank_mask:0xf
    v_dot2c_f32_bf16 v8, v145, v5
    v_dot2c_f32_bf16 v9, v149, v5
    v_dot2c_f32_bf16 v10, v153, v5
    v_dot2c_f32_bf16 v11, v157, v5
    v_add_f32_dpp v28, v28, v28 quad_perm:[1,0,3,2] row_mask:0xf bank_mask:0xf
    v_add_f32_dpp v29, v29, v29 quad_perm:[1,0,3,2] row_mask:0xf bank_mask:0xf
    v_dot2c_f32_bf16 v8, v146, v6
    v_dot2c_f32_bf16 v9, v150, v6
    v_dot2c_f32_bf16 v10, v154, v6
    v_dot2c_f32_bf16 v11, v158, v6
    v_add_f32_dpp v28, v28, v28 quad_perm:[2,3,0,1] row_mask:0xf bank_mask:0xf
    v_add_f32_dpp v29, v29, v29 quad_perm:[2,3,0,1] row_mask:0xf bank_mask:0xf
    v_dot2c_f32_bf16 v8, v147, v7
    v_dot2c_f32_bf16 v9, v151, v7
    s_waitcnt vmcnt(3)
    buffer_load_dwordx4 v[44:47], v1, s[40:43], s49 offen offset:3072 nt
    v_dot2c_f32_bf16 v10, v155, v7
    v_dot2c_f32_bf16 v11, v159, v7
    v_add_f32_dpp v30, v8, v8 row_ror:8 row_mask:0xf bank_mask:0x3
    v_add_f32_dpp v30, v9, v9 row_ror:8 row_mask:0xf bank_mask:0xc
    v_add_f32_dpp v31, v10, v10 row_ror:8 row_mask:0xf bank_mask:0x3
    v_add_f32_dpp v31, v11, v11 row_ror:8 row_mask:0xf bank_mask:0xc
    v_add_f32_dpp v30, v30, v30 row_half_mirror row_mask:0xf bank_mask:0xf
    s_nop 0
    v_add_f32_dpp v31, v31, v31 row_half_mirror row_mask:0xf bank_mask:0xf
    v_add_f32_dpp v30, v30, v30 quad_perm:[1,0,3,2] row_mask:0xf bank_mask:0xf
    s_nop 0
    v_add_f32_dpp v31, v31, v31 quad_perm:[1,0,3,2] row_mask:0xf bank_mask:0xf
    v_add_f32_dpp v30, v30, v30 quad_perm:[2,3,0,1] row_mask:0xf bank_mask:0xf
    s_nop 0
    v_add_f32_dpp v31, v31, v31 quad_perm:[2,3,0,1] row_mask:0xf bank_mask:0xf
    v_max3_f32 v8, v12, v13, v16
    v_max3_f32 v8, v8, v17, v18
    v_max3_f32 v8, v8, v19, v20
    v_max3_f32 v8, v8, v21, v22
    v_max3_f32 v8, v8, v23, v24
    v_max3_f32 v8, v8, v25, v26
    v_max3_f32 v8, v8, v27, v28
    v_max3_f32 v8, v8, v29, v30
    v_max_f32 v8, v8, v31
    s_mov_b32 s34, 0x3e0293ee
    s_nop 0
    v_max_f32_dpp v8, v8, v8 row_ror:8 row_mask:0xf bank_mask:0xf
    v_mov_b32 v9, v8
    s_nop 1
    v_permlane16_swap_b32 v8, v9
    v_max_f32 v8, v8, v9
    v_mov_b32 v9, v8
    s_nop 1
    v_permlane32_swap_b32 v8, v9
    v_max_f32 v8, v8, v9
    v_mul_f32 v8, s34, v8
    v_fma_f32 v12, v12, s34, -v8
    v_fma_f32 v13, v13, s34, -v8
    v_fma_f32 v16, v16, s34, -v8
    v_fma_f32 v17, v17, s34, -v8
    v_fma_f32 v18, v18, s34, -v8
    v_fma_f32 v19, v19, s34, -v8
    v_fma_f32 v20, v20, s34, -v8
    v_fma_f32 v21, v21, s34, -v8
    v_fma_f32 v22, v22, s34, -v8
    v_fma_f32 v23, v23, s34, -v8
    v_fma_f32 v24, v24, s34, -v8
    v_fma_f32 v25, v25, s34, -v8
    v_fma_f32 v26, v26, s34, -v8
    v_fma_f32 v27, v27, s34, -v8
    v_fma_f32 v28, v28, s34, -v8
    v_fma_f32 v29, v29, s34, -v8
    v_fma_f32 v30, v30, s34, -v8
    v_fma_f32 v31, v31, s34, -v8
    v_exp_f32 v12, v12
    v_exp_f32 v13, v13
    v_exp_f32 v16, v16
    v_exp_f32 v17, v17
    v_exp_f32 v18, v18
    v_exp_f32 v19, v19
    v_exp_f32 v20, v20
    v_exp_f32 v21, v21
    v_exp_f32 v22, v22
    v_exp_f32 v23, v23
    v_exp_f32 v24, v24
    v_exp_f32 v25, v25
    s_waitcnt vmcnt(3)
    s_mov_b32 s49, 200704
    buffer_load_dwordx4 v[48:51], v1, s[40:43], s49 offen offset:0 nt
    v_exp_f32 v26, v26
    v_exp_f32 v27, v27
    v_exp_f32 v28, v28
    v_exp_f32 v29, v29
    v_exp_f32 v30, v30
    v_exp_f32 v31, v31
    v_add_f32 v9, v12, v13
    v_add_f32 v9, v9, v16
    v_add_f32 v9, v9, v17
    v_add_f32 v9, v9, v18
    v_add_f32 v9, v9, v19
    v_add_f32 v9, v9, v20
    v_add_f32 v9, v9, v21
    v_add_f32 v9, v9, v22
    v_add_f32 v9, v9, v23
    v_add_f32 v9, v9, v24
    v_add_f32 v9, v9, v25
    v_add_f32 v9, v9, v26
    v_add_f32 v9, v9, v27
    v_add_f32 v9, v9, v28
    v_add_f32 v9, v9, v29
    v_add_f32 v9, v9, v30
    v_add_f32 v9, v9, v31
    v_and_b32 v10, 1, v0
    v_lshlrev_b32 v10, 4, v10
    v_mov_b32 v11, 0xffff
    v_lshlrev_b32 v10, v10, v11
    v_bfe_u32 v11, v0, 1, 2
    v_cmp_eq_u32 vcc, 0, v11
    s_nop 1
    v_cndmask_b32 v144, 0, v10, vcc
    v_cmp_eq_u32 vcc, 1, v11
    s_nop 1
    v_cndmask_b32 v145, 0, v10, vcc
    v_cmp_eq_u32 vcc, 2, v11
    s_nop 1
    v_cndmask_b32 v146, 0, v10, vcc
    v_cmp_eq_u32 vcc, 3, v11
    s_nop 1
    v_cndmask_b32 v147, 0, v10, vcc
    v_add_f32_dpp v9, v9, v9 row_ror:8 row_mask:0xf bank_mask:0xf
    v_mov_b32 v10, v9
    s_nop 1
    v_permlane16_swap_b32 v9, v10
    v_add_f32 v9, v9, v10
    v_mov_b32 v10, v9
    s_nop 1
    v_permlane32_swap_b32 v9, v10
    v_add_f32 v9, v9, v10
    s_lshl_b32 s34, s3, 3
    s_add_u32 s34, s34, 98552
    v_mov_b32 v10, s34
    s_mov_b64 exec, 1
    ds_write_b64 v10, v[8:9]
    s_mov_b64 exec, -1
    s_lshl_b32 s34, s3, 10
    s_add_u32 s34, s34, 98304
    v_lshl_add_u32 v2, v0, 4, s34
    v_cvt_pk_bf16_f32 v10, v12, v12
    v_and_b32 v128, v10, v144
    v_and_b32 v129, v10, v145
    v_and_b32 v130, v10, v146
    v_and_b32 v131, v10, v147
    s_nop 1
    v_mfma_f32_16x16x32_bf16 v[148:151], v[160:163], v[128:131], 0
    v_mfma_f32_16x16x32_bf16 v[152:155], v[164:167], v[128:131], 0
    v_cvt_pk_bf16_f32 v10, v13, v13
    v_and_b32 v132, v10, v144
    v_and_b32 v133, v10, v145
    s_waitcnt vmcnt(3)
    buffer_load_dwordx4 v[52:55], v1, s[40:43], s49 offen offset:1024 nt
    v_and_b32 v134, v10, v146
    v_and_b32 v135, v10, v147
    s_nop 1
    v_mfma_f32_16x16x32_bf16 v[148:151], v[168:171], v[132:135], v[148:151]
    v_mfma_f32_16x16x32_bf16 v[152:155], v[172:175], v[132:135], v[152:155]
    v_cvt_pk_bf16_f32 v10, v16, v16
    v_and_b32 v128, v10, v144
    v_and_b32 v129, v10, v145
    v_and_b32 v130, v10, v146
    v_and_b32 v131, v10, v147
    s_nop 1
    v_mfma_f32_16x16x32_bf16 v[148:151], v[176:179], v[128:131], v[148:151]
    v_mfma_f32_16x16x32_bf16 v[152:155], v[180:183], v[128:131], v[152:155]
    v_cvt_pk_bf16_f32 v10, v17, v17
    v_and_b32 v132, v10, v144
    v_and_b32 v133, v10, v145
    v_and_b32 v134, v10, v146
    v_and_b32 v135, v10, v147
    s_nop 1
    v_mfma_f32_16x16x32_bf16 v[148:151], v[184:187], v[132:135], v[148:151]
    v_mfma_f32_16x16x32_bf16 v[152:155], v[188:191], v[132:135], v[152:155]
    v_cvt_pk_bf16_f32 v10, v18, v18
    v_and_b32 v128, v10, v144
    v_and_b32 v129, v10, v145
    v_and_b32 v130, v10, v146
    v_and_b32 v131, v10, v147
    s_nop 1
    v_mfma_f32_16x16x32_bf16 v[148:151], v[192:195], v[128:131], v[148:151]
    v_mfma_f32_16x16x32_bf16 v[152:155], v[196:199], v[128:131], v[152:155]
    v_cvt_pk_bf16_f32 v10, v19, v19
    v_and_b32 v132, v10, v144
    v_and_b32 v133, v10, v145
    v_and_b32 v134, v10, v146
    v_and_b32 v135, v10, v147
    s_nop 1
    v_mfma_f32_16x16x32_bf16 v[148:151], v[200:203], v[132:135], v[148:151]
    v_mfma_f32_16x16x32_bf16 v[152:155], v[204:207], v[132:135], v[152:155]
    v_cvt_pk_bf16_f32 v10, v20, v20
    v_and_b32 v128, v10, v144
    v_and_b32 v129, v10, v145
    v_and_b32 v130, v10, v146
    v_and_b32 v131, v10, v147
    s_nop 1
    v_mfma_f32_16x16x32_bf16 v[148:151], v[208:211], v[128:131], v[148:151]
    v_mfma_f32_16x16x32_bf16 v[152:155], v[212:215], v[128:131], v[152:155]
    v_cvt_pk_bf16_f32 v10, v21, v21
    v_and_b32 v132, v10, v144
    v_and_b32 v133, v10, v145
    v_and_b32 v134, v10, v146
    v_and_b32 v135, v10, v147
    s_nop 1
    v_mfma_f32_16x16x32_bf16 v[148:151], v[216:219], v[132:135], v[148:151]
    v_mfma_f32_16x16x32_bf16 v[152:155], v[220:223], v[132:135], v[152:155]
    v_cvt_pk_bf16_f32 v10, v22, v22
    v_and_b32 v128, v10, v144
    v_and_b32 v129, v10, v145
    v_and_b32 v130, v10, v146
    v_and_b32 v131, v10, v147
    s_nop 1
    v_mfma_f32_16x16x32_bf16 v[148:151], v[224:227], v[128:131], v[148:151]
    v_mfma_f32_16x16x32_bf16 v[152:155], v[228:231], v[128:131], v[152:155]
    v_cvt_pk_bf16_f32 v10, v23, v23
    v_and_b32 v132, v10, v144
    v_and_b32 v133, v10, v145
    v_and_b32 v134, v10, v146
    v_and_b32 v135, v10, v147
    s_nop 1
    v_mfma_f32_16x16x32_bf16 v[148:151], v[232:235], v[132:135], v[148:151]
    v_mfma_f32_16x16x32_bf16 v[152:155], v[236:239], v[132:135], v[152:155]
    s_waitcnt vmcnt(3)
    buffer_load_dwordx4 v[56:59], v1, s[40:43], s49 offen offset:2048 nt
    v_cvt_pk_bf16_f32 v10, v24, v24
    v_and_b32 v128, v10, v144
    v_and_b32 v129, v10, v145
    v_and_b32 v130, v10, v146
    v_and_b32 v131, v10, v147
    s_nop 1
    v_mfma_f32_16x16x32_bf16 v[148:151], v[240:243], v[128:131], v[148:151]
    v_mfma_f32_16x16x32_bf16 v[152:155], v[244:247], v[128:131], v[152:155]
    v_cvt_pk_bf16_f32 v10, v25, v25
    v_and_b32 v132, v10, v144
    v_and_b32 v133, v10, v145
    v_and_b32 v134, v10, v146
    v_and_b32 v135, v10, v147
    s_nop 1
    v_mfma_f32_16x16x32_bf16 v[148:151], v[248:251], v[132:135], v[148:151]
    v_mfma_f32_16x16x32_bf16 v[152:155], v[252:255], v[132:135], v[152:155]
    v_cvt_pk_bf16_f32 v10, v26, v26
    v_and_b32 v128, v10, v144
    v_and_b32 v129, v10, v145
    v_and_b32 v130, v10, v146
    v_and_b32 v131, v10, v147
    s_nop 1
    v_mfma_f32_16x16x32_bf16 v[148:151], v[32:35], v[128:131], v[148:151]
    v_mfma_f32_16x16x32_bf16 v[152:155], v[36:39], v[128:131], v[152:155]
    v_cvt_pk_bf16_f32 v10, v27, v27
    v_and_b32 v132, v10, v144
    v_and_b32 v133, v10, v145
    v_and_b32 v134, v10, v146
    v_and_b32 v135, v10, v147
    s_waitcnt vmcnt(3)
    buffer_load_dwordx4 v[60:63], v1, s[40:43], s49 offen offset:3072 nt
    v_mfma_f32_16x16x32_bf16 v[148:151], v[40:43], v[132:135], v[148:151]
    v_mfma_f32_16x16x32_bf16 v[152:155], v[44:47], v[132:135], v[152:155]
    v_cvt_pk_bf16_f32 v10, v28, v28
    v_and_b32 v128, v10, v144
    v_and_b32 v129, v10, v145
    v_and_b32 v130, v10, v146
    v_and_b32 v131, v10, v147
    s_waitcnt vmcnt(3)
    s_mov_b32 s49, 229376
    buffer_load_dwordx4 v[64:67], v1, s[40:43], s49 offen offset:0 nt
    s_waitcnt vmcnt(3)
    buffer_load_dwordx4 v[68:71], v1, s[40:43], s49 offen offset:1024 nt
    v_mfma_f32_16x16x32_bf16 v[148:151], v[48:51], v[128:131], v[148:151]
    v_mfma_f32_16x16x32_bf16 v[152:155], v[52:55], v[128:131], v[152:155]
    v_cvt_pk_bf16_f32 v10, v29, v29
    v_and_b32 v132, v10, v144
    v_and_b32 v133, v10, v145
    v_and_b32 v134, v10, v146
    v_and_b32 v135, v10, v147
    s_waitcnt vmcnt(3)
    buffer_load_dwordx4 v[72:75], v1, s[40:43], s49 offen offset:2048 nt
    s_waitcnt vmcnt(3)
    buffer_load_dwordx4 v[76:79], v1, s[40:43], s49 offen offset:3072 nt
    s_barrier
    v_mfma_f32_16x16x32_bf16 v[148:151], v[56:59], v[132:135], v[148:151]
    v_mfma_f32_16x16x32_bf16 v[152:155], v[60:63], v[132:135], v[152:155]
    v_cvt_pk_bf16_f32 v10, v30, v30
    v_and_b32 v128, v10, v144
    v_and_b32 v129, v10, v145
    v_and_b32 v130, v10, v146
    v_and_b32 v131, v10, v147
    s_waitcnt vmcnt(2)
    s_nop 0
    v_mfma_f32_16x16x32_bf16 v[148:151], v[64:67], v[128:131], v[148:151]
    v_mfma_f32_16x16x32_bf16 v[152:155], v[68:71], v[128:131], v[152:155]
    v_cvt_pk_bf16_f32 v10, v31, v31
    v_and_b32 v132, v10, v144
    v_and_b32 v133, v10, v145
    v_and_b32 v134, v10, v146
    v_and_b32 v135, v10, v147
    s_waitcnt vmcnt(0)
    s_nop 0
    v_mfma_f32_16x16x32_bf16 v[148:151], v[72:75], v[132:135], v[148:151]
    v_mfma_f32_16x16x32_bf16 v[152:155], v[76:79], v[132:135], v[152:155]
    s_nop 7
    v_mov_b32_dpp v148, v152 quad_perm:[0,1,2,3] row_mask:0xf bank_mask:0xc
    v_mov_b32_dpp v149, v153 quad_perm:[0,1,2,3] row_mask:0xf bank_mask:0xc
    v_mov_b32_dpp v150, v154 quad_perm:[0,1,2,3] row_mask:0xf bank_mask:0xc
    v_mov_b32_dpp v151, v155 quad_perm:[0,1,2,3] row_mask:0xf bank_mask:0xc
    ds_write_b128 v2, v[148:151]
    s_waitcnt lgkmcnt(0)
    s_barrier
    v_and_b32 v200, 3, v0
    v_bfe_u32 v201, v0, 2, 2
    v_lshrrev_b32 v202, 4, v0
    s_lshl_b32 s34, s3, 10
    s_add_u32 s34, s34, 122112
    v_lshl_add_u32 v203, v0, 4, s34
    s_movk_i32 s48, 5120
    s_cmp_eq_u32 s63, 0
    s_cbranch_scc1 L_t_wo
    s_cmp_eq_u32 s63, 2
    s_cbranch_scc1 L_t_w2
    s_cmp_eq_u32 s63, 3
    s_cbranch_scc1 L_fin
    v_and_b32 v205, 15, v0
    v_lshlrev_b32 v205, 4, v205
    s_and_b32 s49, s3, 3
    s_mul_i32 s34, s49, 1280
    s_add_u32 s34, s34, 35840
    v_lshl_add_u32 v206, v202, 17, v205
    v_add_u32 v206, s34, v206
    s_mul_i32 s34, s49, 3840
    v_add_u32 v205, s34, v205
    s_barrier
L_r_w1:
    s_cmp_lt_u32 s3, 4
    s_cbranch_scc1 L_w1_ln
    s_and_b32 s49, s3, 3
    s_lshl_b32 s42, s49, 11
    s_add_u32 s42, s42, 40960
    s_bitcmp1_b32 s62, 0
    s_cbranch_scc1 L_rot1
    s_add_u32 m0, s42, 0
    s_add_u32 s34, s50, 0
    buffer_load_dwordx4 v15, s[52:55], s34 offen  lds
    s_add_u32 m0, s42, 1024
    s_add_u32 s34, s50, 884736
    buffer_load_dwordx4 v15, s[52:55], s34 offen  lds
    s_add_u32 m0, s42, 8192
    s_add_u32 s34, s50, 110592
    buffer_load_dwordx4 v15, s[52:55], s34 offen  lds
    s_add_u32 m0, s42, 9216
    s_add_u32 s34, s50, 995328
    buffer_load_dwordx4 v15, s[52:55], s34 offen  lds
    s_add_u32 m0, s42, 32768
    s_add_u32 s34, s51, 0
    buffer_load_dwordx4 v15, s[52:55], s34 offen  lds
    s_add_u32 m0, s42, 33792
    s_add_u32 s34, s51, 13824
    buffer_load_dwordx4 v15, s[52:55], s34 offen  lds
    s_add_u32 m0, s42, 16384
    s_add_u32 s34, s50, 221184
    buffer_load_dwordx4 v15, s[52:55], s34 offen  lds
    s_add_u32 m0, s42, 17408
    s_add_u32 s34, s50, 1105920
    buffer_load_dwordx4 v15, s[52:55], s34 offen  lds
    s_add_u32 m0, s42, 24576
    s_add_u32 s34, s50, 331776
    buffer_load_dwordx4 v15, s[52:55], s34 offen  lds
    s_add_u32 m0, s42, 25600
    s_add_u32 s34, s50, 1216512
    buffer_load_dwordx4 v15, s[52:55], s34 offen  lds
    s_branch L_rot2
L_rot1:
    s_add_u32 m0, s42, 16384
    s_add_u32 s34, s50, 221184
    buffer_load_dwordx4 v15, s[52:55], s34 offen  lds
    s_add_u32 m0, s42, 17408
    s_add_u32 s34, s50, 1105920
    buffer_load_dwordx4 v15, s[52:55], s34 offen  lds
    s_add_u32 m0, s42, 24576
    s_add_u32 s34, s50, 331776
    buffer_load_dwordx4 v15, s[52:55], s34 offen  lds
    s_add_u32 m0, s42, 25600
    s_add_u32 s34, s50, 1216512
    buffer_load_dwordx4 v15, s[52:55], s34 offen  lds
    s_add_u32 m0, s42, 32768
    s_add_u32 s34, s51, 0
    buffer_load_dwordx4 v15, s[52:55], s34 offen  lds
    s_add_u32 m0, s42, 33792
    s_add_u32 s34, s51, 13824
    buffer_load_dwordx4 v15, s[52:55], s34 offen  lds
    s_add_u32 m0, s42, 0
    s_add_u32 s34, s50, 0
    buffer_load_dwordx4 v15, s[52:55], s34 offen  lds
    s_add_u32 m0, s42, 1024
    s_add_u32 s34, s50, 884736
    buffer_load_dwordx4 v15, s[52:55], s34 offen  lds
    s_add_u32 m0, s42, 8192
    s_add_u32 s34, s50, 110592
    buffer_load_dwordx4 v15, s[52:55], s34 offen  lds
    s_add_u32 m0, s42, 9216
    s_add_u32 s34, s50, 995328
    buffer_load_dwordx4 v15, s[52:55], s34 offen  lds
L_rot2:
    v_lshrrev_b32 v3, 2, v0
    v_lshlrev_b32 v3, 6, v3
    v_lshl_add_u32 v3, v200, 3, v3
    v_add_u32 v3, s42, v3
    s_lshl_b32 s35, s49, 6
    s_add_u32 s35, s35, 116736
    v_mul_u32_u24 v4, 1344, v200
    v_lshl_add_u32 v4, v202, 4, v4
    v_add_u32 v4, s35, v4
    s_lshl_b32 s35, s49, 11
    s_add_u32 s35, s35, 122112
    v_lshl_add_u32 v5, v0, 4, s35
    s_waitcnt vmcnt(0)
    s_barrier
    ds_read_b64_tr_b16 v[32:33], v3 offset:0
    ds_read_b64_tr_b16 v[34:35], v3 offset:1024
    ds_read_b64_tr_b16 v[36:37], v3 offset:32
    ds_read_b64_tr_b16 v[38:39], v3 offset:1056
    ds_read_b64_tr_b16 v[40:41], v3 offset:8192
    ds_read_b64_tr_b16 v[42:43], v3 offset:9216
    ds_read_b64_tr_b16 v[44:45], v3 offset:8224
    ds_read_b64_tr_b16 v[46:47], v3 offset:9248
    ds_read_b64_tr_b16 v[48:49], v3 offset:16384
    ds_read_b64_tr_b16 v[50:51], v3 offset:17408
    ds_read_b64_tr_b16 v[52:53], v3 offset:16416
    ds_read_b64_tr_b16 v[54:55], v3 offset:17440
    s_waitcnt lgkmcnt(4)
    ds_read_b64_tr_b16 v[56:57], v3 offset:24576
    ds_read_b64_tr_b16 v[58:59], v3 offset:25600
    ds_read_b64_tr_b16 v[60:61], v3 offset:24608
    ds_read_b64_tr_b16 v[62:63], v3 offset:25632
    ds_read_b64_tr_b16 v[64:65], v3 offset:32768
    ds_read_b64_tr_b16 v[66:67], v3 offset:33792
    ds_read_b64_tr_b16 v[68:69], v3 offset:32800
    ds_read_b64_tr_b16 v[70:71], v3 offset:33824
    s_waitcnt lgkmcnt(0)
    s_barrier
    ds_read_b128 v[140:143], v4 offset:0
    ds_read_b128 v[144:147], v4 offset:256
    ds_read_b128 v[148:151], v4 offset:512
    ds_read_b128 v[152:155], v4 offset:768
    ds_read_b128 v[156:159], v4 offset:1024
    s_waitcnt lgkmcnt(4)
    v_mfma_f32_16x16x32_bf16 v[20:23], v[32:35], v[140:143], 0
    v_mfma_f32_16x16x32_bf16 v[24:27], v[36:39], v[140:143], 0
    s_waitcnt lgkmcnt(3)
    v_mfma_f32_16x16x32_bf16 v[20:23], v[40:43], v[144:147], v[20:23]
    v_mfma_f32_16x16x32_bf16 v[24:27], v[44:47], v[144:147], v[24:27]
    s_waitcnt lgkmcnt(2)
    v_mfma_f32_16x16x32_bf16 v[20:23], v[48:51], v[148:151], v[20:23]
    v_mfma_f32_16x16x32_bf16 v[24:27], v[52:55], v[148:151], v[24:27]
    s_waitcnt lgkmcnt(1)
    v_mfma_f32_16x16x32_bf16 v[20:23], v[56:59], v[152:155], v[20:23]
    v_mfma_f32_16x16x32_bf16 v[24:27], v[60:63], v[152:155], v[24:27]
    s_waitcnt lgkmcnt(0)
    v_mfma_f32_16x16x32_bf16 v[20:23], v[64:67], v[156:159], v[20:23]
    v_mfma_f32_16x16x32_bf16 v[24:27], v[68:71], v[156:159], v[24:27]
    s_nop 6
    ds_write_b128 v5, v[20:23]
    ds_write_b128 v5, v[24:27] offset:1024
    s_waitcnt lgkmcnt(0)
    s_barrier
    s_branch L_fin
L_w1_ln:
    ds_read_b128 v[140:143], v205 offset:0
    ds_read_b128 v[144:147], v205 offset:256
    ds_read_b128 v[148:151], v205 offset:512
    ds_read_b128 v[152:155], v205 offset:768
    ds_read_b128 v[156:159], v205 offset:1024
    ds_read_b128 v[160:163], v205 offset:1280
    ds_read_b128 v[164:167], v205 offset:1536
    ds_read_b128 v[168:171], v205 offset:1792
    ds_read_b128 v[172:175], v205 offset:2048
    ds_read_b128 v[176:179], v205 offset:2304
    ds_read_b128 v[180:183], v205 offset:2560
    ds_read_b128 v[184:187], v205 offset:2816
    ds_read_b128 v[188:191], v205 offset:3072
    ds_read_b128 v[192:195], v205 offset:3328
    ds_read_b128 v[196:199], v205 offset:3584
    v_and_b32 v8, 1, v0
    v_lshlrev_b32 v8, 4, v8
    v_mov_b32 v9, 0xffff
    v_lshlrev_b32 v8, v8, v9
    v_bfe_u32 v9, v0, 1, 2
    v_cmp_eq_u32 vcc, 0, v9
    s_nop 1
    v_cndmask_b32 v16, 0, v8, vcc
    v_cmp_eq_u32 vcc, 1, v9
    s_nop 1
    v_cndmask_b32 v17, 0, v8, vcc
    v_cmp_eq_u32 vcc, 2, v9
    s_nop 1
    v_cndmask_b32 v18, 0, v8, vcc
    v_cmp_eq_u32 vcc, 3, v9
    s_nop 1
    v_cndmask_b32 v19, 0, v8, vcc
    v_bfe_u32 v8, v0, 3, 1
    v_cmp_eq_u32 vcc, 0, v8
    s_nop 1
    v_cndmask_b32 v20, 0, v16, vcc
    v_xor_b32 v24, v20, v16
    v_cndmask_b32 v21, 0, v17, vcc
    v_xor_b32 v25, v21, v17
    v_cndmask_b32 v22, 0, v18, vcc
    v_xor_b32 v26, v22, v18
    v_cndmask_b32 v23, 0, v19, vcc
    v_xor_b32 v27, v23, v19
    v_and_b32 v52, 0x3f803f80, v20
    v_and_b32 v60, 0x3e803e80, v20
    v_and_b32 v53, 0x3f803f80, v21
    v_and_b32 v61, 0x3e803e80, v21
    v_and_b32 v54, 0x3f803f80, v22
    v_and_b32 v62, 0x3e803e80, v22
    v_and_b32 v55, 0x3f803f80, v23
    v_and_b32 v63, 0x3e803e80, v23
    v_and_b32 v56, 0x3f803f80, v24
    v_and_b32 v64, 0x3e803e80, v24
    v_and_b32 v57, 0x3f803f80, v25
    v_and_b32 v65, 0x3e803e80, v25
    v_and_b32 v58, 0x3f803f80, v26
    v_and_b32 v66, 0x3e803e80, v26
    v_and_b32 v59, 0x3f803f80, v27
    v_and_b32 v67, 0x3e803e80, v27
    s_waitcnt lgkmcnt(0)
    v_mfma_f32_16x16x32_bf16 v[68:71], v[140:143], v[60:63], 0
    v_mfma_f32_16x16x32_bf16 v[68:71], v[144:147], v[64:67], v[68:71]
    v_mfma_f32_16x16x32_bf16 v[72:75], v[148:151], v[60:63], 0
    v_mfma_f32_16x16x32_bf16 v[72:75], v[152:155], v[64:67], v[72:75]
    v_mfma_f32_16x16x32_bf16 v[76:79], v[156:159], v[60:63], 0
    v_mfma_f32_16x16x32_bf16 v[116:119], v[160:163], v[60:63], 0
    v_mfma_f32_16x16x32_bf16 v[116:119], v[164:167], v[64:67], v[116:119]
    v_mfma_f32_16x16x32_bf16 v[120:123], v[168:171], v[60:63], 0
    v_mfma_f32_16x16x32_bf16 v[120:123], v[172:175], v[64:67], v[120:123]
    v_mfma_f32_16x16x32_bf16 v[124:127], v[176:179], v[60:63], 0
    v_mfma_f32_16x16x32_bf16 v[80:83], v[180:183], v[60:63], 1.0
    v_mfma_f32_16x16x32_bf16 v[80:83], v[184:187], v[64:67], v[80:83]
    v_mfma_f32_16x16x32_bf16 v[84:87], v[188:191], v[60:63], 1.0
    v_mfma_f32_16x16x32_bf16 v[84:87], v[192:195], v[64:67], v[84:87]
    v_mfma_f32_16x16x32_bf16 v[88:91], v[196:199], v[60:63], 1.0
    s_mul_i32 s34, s3, 1344
    s_add_u32 s34, s34, 116736
    v_lshl_add_u32 v7, v0, 4, s34
    v_lshlrev_b32 v8, 6, v202
    v_lshl_add_u32 v8, v200, 4, v8
    v_and_b32 v9, 1, v201
    v_lshl_add_u32 v8, v9, 3, v8
    v_add_u32 v8, s34, v8
    v_lshrrev_b32 v9, 5, v0
    v_lshlrev_b32 v9, 10, v9
    v_and_b32 v6, 1, v202
    v_lshl_add_u32 v9, v6, 9, v9
    v_bfe_u32 v6, v0, 1, 1
    v_lshl_add_u32 v9, v6, 8, v9
    v_lshl_add_u32 v9, v201, 4, v9
    v_and_b32 v6, 1, v0
    v_lshl_add_u32 v9, v6, 3, v9
    v_add_u32 v9, 122112, v9
    s_lshr_b32 s34, s62, 2
    s_lshl_b32 s34, s34, 8
    s_and_b32 s49, s62, 3
    s_lshl_b32 s49, s49, 17
    s_add_u32 s34, s34, s49
    s_add_u32 s34, s34, 46080
    v_lshl_add_u32 v5, v0, 2, s34
    s_barrier
    s_mov_b32 s35, 0
    s_mov_b64 s[40:41], -1
    s_mov_b64 s[42:43], -1
L_pb:
    s_mov_b64 exec, s[40:41]
    s_cbranch_execz L_pbs0
    buffer_load_dwordx4 v[140:143], v206, s[44:47], 0 offen offset:0 sc1
    buffer_load_dwordx4 v[148:151], v206, s[44:47], 0 offen offset:256 sc1
    buffer_load_dwordx4 v[156:159], v206, s[44:47], 0 offen offset:512 sc1
    buffer_load_dwordx4 v[164:167], v206, s[44:47], 0 offen offset:768 sc1
    buffer_load_dwordx4 v[172:175], v206, s[44:47], 0 offen offset:1024 sc1
L_pbs0:
    s_mov_b64 exec, s[42:43]
    s_cbranch_execz L_pbs1
    buffer_load_dwordx4 v[144:147], v206, s[44:47], s48 offen offset:0 sc1
    buffer_load_dwordx4 v[152:155], v206, s[44:47], s48 offen offset:256 sc1
    buffer_load_dwordx4 v[160:163], v206, s[44:47], s48 offen offset:512 sc1
    buffer_load_dwordx4 v[168:171], v206, s[44:47], s48 offen offset:768 sc1
    buffer_load_dwordx4 v[176:179], v206, s[44:47], s48 offen offset:1024 sc1
L_pbs1:
    s_mov_b64 exec, -1
    s_add_u32 s35, s35, 1
    s_waitcnt vmcnt(0)
    v_max3_u32 v28, v140, v141, v142
    v_max3_u32 v29, v144, v145, v146
    v_max3_u32 v28, v28, v143, v148
    v_max3_u32 v29, v29, v147, v152
    v_max3_u32 v28, v28, v149, v150
    v_max3_u32 v29, v29, v153, v154
    v_max3_u32 v28, v28, v151, v156
    v_max3_u32 v29, v29, v155, v160
    v_max3_u32 v28, v28, v157, v158
    v_max3_u32 v29, v29, v161, v162
    v_max3_u32 v28, v28, v159, v164
    v_max3_u32 v29, v29, v163, v168
    v_max3_u32 v28, v28, v165, v166
    v_max3_u32 v29, v29, v169, v170
    v_max3_u32 v28, v28, v167, v172
    v_max3_u32 v29, v29, v171, v176
    v_max3_u32 v28, v28, v173, v174
    v_max3_u32 v29, v29, v177, v178
    v_max_u32 v28, v28, v175
    v_max_u32 v29, v29, v179
    v_cmp_eq_u32 s[40:41], -1, v28
    v_cmp_eq_u32 s[42:43], -1, v29
    v_mfma_f32_16x16x32_bf16 v[128:131], v[140:143], v[52:55], v[68:71]
    s_or_b64 vcc, s[40:41], s[42:43]
    s_cbranch_scc0 L_pbd
    s_cmp_lt_u32 s35, 60000
    s_cbranch_scc1 L_pb
L_pbd:
    v_mfma_f32_16x16x32_bf16 v[128:131], v[144:147], v[52:55], v[128:131]
    v_mfma_f32_16x16x32_bf16 v[128:131], v[148:151], v[56:59], v[128:131]
    v_mfma_f32_16x16x32_bf16 v[128:131], v[152:155], v[56:59], v[128:131]
    v_mfma_f32_16x16x32_bf16 v[132:135], v[156:159], v[52:55], v[72:75]
    v_mfma_f32_16x16x32_bf16 v[132:135], v[160:163], v[52:55], v[132:135]
    v_mfma_f32_16x16x32_bf16 v[132:135], v[164:167], v[56:59], v[132:135]
    v_mfma_f32_16x16x32_bf16 v[132:135], v[168:171], v[56:59], v[132:135]
    v_mfma_f32_16x16x32_bf16 v[136:139], v[172:175], v[52:55], v[76:79]
    v_mfma_f32_16x16x32_bf16 v[136:139], v[176:179], v[52:55], v[136:139]
    s_nop 1
    v_pk_add_f32 v[20:21], v[128:129], v[130:131]
    v_pk_mul_f32 v[22:23], v[128:129], v[128:129]
    v_pk_fma_f32 v[22:23], v[130:131], v[130:131], v[22:23]
    s_nop 0
    v_pk_add_f32 v[20:21], v[20:21], v[132:133]
    v_pk_fma_f32 v[22:23], v[132:133], v[132:133], v[22:23]
    v_pk_add_f32 v[20:21], v[20:21], v[134:135]
    v_pk_fma_f32 v[22:23], v[134:135], v[134:135], v[22:23]
    v_pk_add_f32 v[20:21], v[20:21], v[136:137]
    v_pk_fma_f32 v[22:23], v[136:137], v[136:137], v[22:23]
    v_pk_add_f32 v[20:21], v[20:21], v[138:139]
    v_pk_fma_f32 v[22:23], v[138:139], v[138:139], v[22:23]
    v_add_f32 v20, v20, v21
    v_add_f32 v21, v22, v23
    s_nop 0
    v_add_f32_dpp v20, v20, v20 row_ror:8 row_mask:0xf bank_mask:0xf
    v_add_f32_dpp v21, v21, v21 row_ror:8 row_mask:0xf bank_mask:0xf
    s_nop 0
    v_add_f32_dpp v20, v20, v20 row_ror:4 row_mask:0xf bank_mask:0xf
    v_add_f32_dpp v21, v21, v21 row_ror:4 row_mask:0xf bank_mask:0xf
    s_nop 0
    v_add_f32_dpp v20, v20, v20 row_ror:2 row_mask:0xf bank_mask:0xf
    v_add_f32_dpp v21, v21, v21 row_ror:2 row_mask:0xf bank_mask:0xf
    s_nop 0
    v_add_f32_dpp v20, v20, v20 row_ror:1 row_mask:0xf bank_mask:0xf
    v_add_f32_dpp v21, v21, v21 row_ror:1 row_mask:0xf bank_mask:0xf
    v_mov_b32 v22, v20
    v_mov_b32 v23, v21
    s_nop 0
    v_permlane16_swap_b32 v20, v22
    v_permlane16_swap_b32 v21, v23
    v_add_f32 v20, v20, v22
    v_add_f32 v21, v21, v23
    v_mov_b32 v22, v20
    v_mov_b32 v23, v21
    s_nop 0
    v_permlane32_swap_b32 v20, v22
    v_permlane32_swap_b32 v21, v23
    v_add_f32 v20, v20, v22
    v_add_f32 v21, v21, v23
    v_mul_f32 v22, 0x3acccccd, v20
    v_mul_f32 v21, 0x3acccccd, v21
    v_fma_f32 v21, -v22, v22, v21
    v_max_f32 v21, 0, v21
    v_add_f32 v21, 0x3727c5ac, v21
    v_rsq_f32 v20, v21
    s_nop 0
    v_mul_f32_e64 v21, -v22, v20
    v_pk_fma_f32 v[128:129], v[128:129], v[20:21], v[20:21] op_sel:[0,0,1] op_sel_hi:[1,0,1]
    v_pk_fma_f32 v[130:131], v[130:131], v[20:21], v[20:21] op_sel:[0,0,1] op_sel_hi:[1,0,1]
    v_pk_fma_f32 v[132:133], v[132:133], v[20:21], v[20:21] op_sel:[0,0,1] op_sel_hi:[1,0,1]
    v_pk_fma_f32 v[134:135], v[134:135], v[20:21], v[20:21] op_sel:[0,0,1] op_sel_hi:[1,0,1]
    v_pk_fma_f32 v[136:137], v[136:137], v[20:21], v[20:21] op_sel:[0,0,1] op_sel_hi:[1,0,1]
    v_pk_fma_f32 v[138:139], v[138:139], v[20:21], v[20:21] op_sel:[0,0,1] op_sel_hi:[1,0,1]
    v_pk_fma_f32 v[128:129], v[128:129], v[80:81], v[116:117]
    v_pk_fma_f32 v[130:131], v[130:131], v[82:83], v[118:119]
    v_pk_fma_f32 v[132:133], v[132:133], v[84:85], v[120:121]
    v_pk_fma_f32 v[134:135], v[134:135], v[86:87], v[122:123]
    v_pk_fma_f32 v[136:137], v[136:137], v[88:89], v[124:125]
    v_pk_fma_f32 v[138:139], v[138:139], v[90:91], v[126:127]
    v_cvt_pk_bf16_f32 v20, v128, v129
    v_cvt_pk_bf16_f32 v21, v130, v131
    v_cvt_pk_bf16_f32 v22, v132, v133
    v_cvt_pk_bf16_f32 v23, v134, v135
    v_cvt_pk_bf16_f32 v24, v136, v137
    v_cvt_pk_bf16_f32 v25, v138, v139
    ds_write_b128 v7, v[20:23]
    s_mov_b32 exec_lo, 0x00ff00ff
    s_mov_b32 exec_hi, 0x00ff00ff
    ds_write_b64 v8, v[24:25] offset:1024
    s_mov_b64 exec, -1
    s_waitcnt lgkmcnt(0)
    s_barrier
    s_barrier
    s_cmp_lg_u32 s3, 0
    s_cbranch_scc1 L_fin
    ds_read_b64 v[20:21], v9 offset:0
    ds_read_b64 v[22:23], v9 offset:2048
    ds_read_b64 v[24:25], v9 offset:4096
    ds_read_b64 v[26:27], v9 offset:6144
    s_mov_b32 s34, 0xbdd2d3e8
    v_mov_b32 v10, 0xc0135761
    s_waitcnt lgkmcnt(3)
    v_pk_add_f32 v[100:101], v[100:101], v[20:21]
    s_waitcnt lgkmcnt(2)
    v_pk_add_f32 v[100:101], v[100:101], v[22:23]
    s_waitcnt lgkmcnt(1)
    v_pk_add_f32 v[100:101], v[100:101], v[24:25]
    s_waitcnt lgkmcnt(0)
    v_pk_add_f32 v[100:101], v[100:101], v[26:27]
    v_pk_mul_f32 v[20:21], v[100:101], v[100:101]
    v_fma_f32 v20, v20, s34, v10
    v_fma_f32 v21, v21, s34, v10
    v_pk_mul_f32 v[20:21], v[20:21], v[100:101]
    v_exp_f32 v20, v20
    v_exp_f32 v21, v21
    v_add_f32 v20, 1.0, v20
    v_add_f32 v21, 1.0, v21
    v_rcp_f32 v20, v20
    v_rcp_f32 v21, v21
    s_nop 0
    v_pk_mul_f32 v[20:21], v[20:21], v[100:101]
    v_cvt_pk_bf16_f32 v20, v20, v21
    v_min_u32 v20, -2, v20
    buffer_store_dword v20, v5, s[44:47], 0 offen sc1
    s_branch L_fin
L_t_w2:
    v_bfe_u32 v205, v0, 3, 2
    v_lshlrev_b32 v204, 3, v205
    v_lshrrev_b32 v205, 5, v0
    v_lshl_add_u32 v204, v205, 2, v204
    v_bfe_u32 v205, v0, 1, 2
    v_add_u32 v204, v204, v205
    v_and_b32 v205, 1, v0
    s_sub_u32 s49, s3, 1
    v_mul_u32_u24 v204, 1280, v204
    v_lshl_add_u32 v204, v205, 4, v204
    s_lshl_b32 s34, s62, 5
    s_mul_i32 s35, s49, 327680
    s_add_u32 s34, s34, s35
    v_add_u32 v204, s34, v204
    s_lshl_b32 s50, s49, 13
    s_add_u32 s50, s50, 40960
    v_lshl_add_u32 v205, v0, 3, s50
    s_lshl_b32 s40, s62, 1
    s_add_u32 s41, s40, 8
    s_add_u32 s42, s40, 2
    s_barrier
L_w2_dma:
    s_and_b32 s34, s40, 7
    s_lshl_b32 s35, s34, 10
    s_add_u32 m0, s50, s35
    s_mul_i32 s34, s34, 40960
    buffer_load_dwordx4 v204, s[52:55], s34 offen  lds
    s_add_u32 s40, s40, 1
    s_cmp_lg_u32 s40, s42
    s_cbranch_scc1 L_w2_nw
    s_waitcnt vmcnt(0)
L_w2_nw:
    s_cmp_lt_u32 s40, s41
    s_cbranch_scc1 L_w2_dma
    s_lshl_b32 s34, s49, 9
    s_add_u32 s34, s34, 46080
    s_cmp_eq_u32 s49, 6
    s_cselect_b32 s35, 1, 3
    v_lshlrev_b32 v6, 6, v202
    v_lshl_add_u32 v6, v200, 4, v6
    v_add_u32 v6, s34, v6
    v_lshl_add_u32 v4, v201, 17, v6
    v_min_u32 v5, s35, v201
    v_lshl_add_u32 v5, v5, 17, v6
    s_waitcnt vmcnt(0)
    ds_read_b64_tr_b16 v[32:33], v205 offset:0
    ds_read_b64_tr_b16 v[34:35], v205 offset:512
    ds_read_b64_tr_b16 v[36:37], v205 offset:1024
    ds_read_b64_tr_b16 v[38:39], v205 offset:1536
    ds_read_b64_tr_b16 v[40:41], v205 offset:2048
    ds_read_b64_tr_b16 v[42:43], v205 offset:2560
    ds_read_b64_tr_b16 v[44:45], v205 offset:3072
    ds_read_b64_tr_b16 v[46:47], v205 offset:3584
    s_waitcnt lgkmcnt(0)
    ds_read_b64_tr_b16 v[48:49], v205 offset:4096
    ds_read_b64_tr_b16 v[50:51], v205 offset:4608
    ds_read_b64_tr_b16 v[52:53], v205 offset:5120
    ds_read_b64_tr_b16 v[54:55], v205 offset:5632
    ds_read_b64_tr_b16 v[56:57], v205 offset:6144
    ds_read_b64_tr_b16 v[58:59], v205 offset:6656
    ds_read_b64_tr_b16 v[60:61], v205 offset:7168
    ds_read_b64_tr_b16 v[62:63], v205 offset:7680
    s_waitcnt lgkmcnt(0)
    s_mov_b32 s35, 0
L_poll62:
    buffer_load_dwordx4 v[64:67], v4, s[44:47], 0 offen sc1
    buffer_load_dwordx4 v[68:71], v5, s[44:47], 0 offen offset:256 sc1
    s_add_u32 s35, s35, 1
    s_waitcnt vmcnt(0)
    v_max3_u32 v28, v64, v65, v66
    v_max3_u32 v28, v28, v67, v68
    v_max3_u32 v28, v28, v69, v70
    v_max_u32 v28, v28, v71
    v_cmp_eq_u32 vcc, -1, v28
    s_cbranch_vccz L_done63
    s_cmp_lt_u32 s35, 60000
    s_cbranch_scc1 L_poll62
L_done63:
    v_mfma_f32_16x16x32_bf16 v[80:83], v[32:35], v[64:67], 0
    v_mfma_f32_16x16x32_bf16 v[84:87], v[36:39], v[64:67], 0
    v_mfma_f32_16x16x32_bf16 v[88:91], v[40:43], v[64:67], 0
    v_mfma_f32_16x16x32_bf16 v[92:95], v[44:47], v[64:67], 0
    v_mfma_f32_16x16x32_bf16 v[80:83], v[48:51], v[68:71], v[80:83]
    v_mfma_f32_16x16x32_bf16 v[84:87], v[52:55], v[68:71], v[84:87]
    v_mfma_f32_16x16x32_bf16 v[88:91], v[56:59], v[68:71], v[88:91]
    v_mfma_f32_16x16x32_bf16 v[92:95], v[60:63], v[68:71], v[92:95]
    s_nop 5
    v_mov_b32_dpp v80, v84 quad_perm:[0,1,2,3] row_mask:0xf bank_mask:0x2
    v_mov_b32_dpp v81, v85 quad_perm:[0,1,2,3] row_mask:0xf bank_mask:0x2
    v_mov_b32_dpp v82, v86 quad_perm:[0,1,2,3] row_mask:0xf bank_mask:0x2
    v_mov_b32_dpp v83, v87 quad_perm:[0,1,2,3] row_mask:0xf bank_mask:0x2
    v_mov_b32_dpp v80, v88 quad_perm:[0,1,2,3] row_mask:0xf bank_mask:0x4
    v_mov_b32_dpp v81, v89 quad_perm:[0,1,2,3] row_mask:0xf bank_mask:0x4
    v_mov_b32_dpp v82, v90 quad_perm:[0,1,2,3] row_mask:0xf bank_mask:0x4
    v_mov_b32_dpp v83, v91 quad_perm:[0,1,2,3] row_mask:0xf bank_mask:0x4
    v_mov_b32_dpp v80, v92 quad_perm:[0,1,2,3] row_mask:0xf bank_mask:0x8
    v_mov_b32_dpp v81, v93 quad_perm:[0,1,2,3] row_mask:0xf bank_mask:0x8
    v_mov_b32_dpp v82, v94 quad_perm:[0,1,2,3] row_mask:0xf bank_mask:0x8
    v_mov_b32_dpp v83, v95 quad_perm:[0,1,2,3] row_mask:0xf bank_mask:0x8
    ds_write_b128 v203, v[80:83]
    s_waitcnt lgkmcnt(0)
    s_barrier
    s_branch L_fin
L_w2_red:
    s_mov_b32 s35, 0
L_poll65:
    buffer_load_dwordx2 v[20:21], v204, s[44:47], 0 offen sc1
    buffer_load_dwordx2 v[22:23], v204, s[44:47], s48 offen sc1
    s_add_u32 s35, s35, 1
    s_waitcnt vmcnt(0)
    v_max3_u32 v28, v20, v21, v22
    v_max_u32 v28, v28, v23
    v_cmp_eq_u32 vcc, -1, v28
    s_cbranch_vccz L_done66
    s_sleep 4
    s_cmp_lt_u32 s35, 60000
    s_cbranch_scc1 L_poll65
L_done66:
    v_lshlrev_b32 v44, 16, v20
    v_and_b32 v45, 0xffff0000, v20
    v_lshlrev_b32 v46, 16, v21
    v_and_b32 v47, 0xffff0000, v21
    v_lshlrev_b32 v48, 16, v22
    v_and_b32 v49, 0xffff0000, v22
    v_lshlrev_b32 v50, 16, v23
    v_and_b32 v51, 0xffff0000, v23
    v_add_f32 v108, v108, v44
    v_add_f32 v109, v109, v45
    v_add_f32 v110, v110, v46
    v_add_f32 v111, v111, v47
    v_add_f32 v108, v108, v48
    v_add_f32 v109, v109, v49
    v_add_f32 v110, v110, v50
    v_add_f32 v111, v111, v51
    s_barrier
    ds_read_b128 v[64:67], v203 offset:1024
    ds_read_b128 v[68:71], v203 offset:2048
    ds_read_b128 v[72:75], v203 offset:3072
    ds_read_b128 v[76:79], v203 offset:4096
    ds_read_b128 v[80:83], v203 offset:5120
    ds_read_b128 v[84:87], v203 offset:6144
    ds_read_b128 v[88:91], v203 offset:7168
    s_waitcnt lgkmcnt(5)
    v_pk_add_f32 v[64:65], v[64:65], v[68:69]
    v_pk_add_f32 v[66:67], v[66:67], v[70:71]
    s_waitcnt lgkmcnt(4)
    v_pk_add_f32 v[64:65], v[64:65], v[72:73]
    v_pk_add_f32 v[66:67], v[66:67], v[74:75]
    s_waitcnt lgkmcnt(3)
    v_pk_add_f32 v[64:65], v[64:65], v[76:77]
    v_pk_add_f32 v[66:67], v[66:67], v[78:79]
    s_waitcnt lgkmcnt(2)
    v_pk_add_f32 v[64:65], v[64:65], v[80:81]
    v_pk_add_f32 v[66:67], v[66:67], v[82:83]
    s_waitcnt lgkmcnt(1)
    v_pk_add_f32 v[64:65], v[64:65], v[84:85]
    v_pk_add_f32 v[66:67], v[66:67], v[86:87]
    s_waitcnt lgkmcnt(0)
    v_pk_add_f32 v[64:65], v[64:65], v[88:89]
    v_pk_add_f32 v[66:67], v[66:67], v[90:91]
    v_pk_fma_f32 v[64:65], v[64:65], v[104:105], v[108:109]
    v_pk_fma_f32 v[66:67], v[66:67], v[106:107], v[110:111]
    s_nop 0
    v_add_f32_dpp v64, v64, v64 row_ror:4 row_mask:0xf bank_mask:0xf
    v_add_f32_dpp v65, v65, v65 row_ror:4 row_mask:0xf bank_mask:0xf
    v_add_f32_dpp v66, v66, v66 row_ror:4 row_mask:0xf bank_mask:0xf
    v_add_f32_dpp v67, v67, v67 row_ror:4 row_mask:0xf bank_mask:0xf
    v_add_f32_dpp v64, v64, v64 row_ror:8 row_mask:0xf bank_mask:0xf
    v_add_f32_dpp v65, v65, v65 row_ror:8 row_mask:0xf bank_mask:0xf
    v_add_f32_dpp v66, v66, v66 row_ror:8 row_mask:0xf bank_mask:0xf
    v_add_f32_dpp v67, v67, v67 row_ror:8 row_mask:0xf bank_mask:0xf
    v_cvt_pk_bf16_f32 v20, v64, v65
    v_cvt_pk_bf16_f32 v21, v66, v67
    s_mov_b32 exec_lo, 0x000f000f
    s_mov_b32 exec_hi, 0x000f000f
    global_store_dwordx2 v112, v[20:21], s[28:29]
    s_mov_b64 exec, -1
    s_branch L_fin
L_t_wo:
    s_lshr_b32 s49, s3, 1
    s_lshl_b32 s49, s49, 17
    v_and_b32 v210, 7, v0
    s_lshl_b32 s34, s60, 7
    s_add_u32 s34, s34, s49
    s_add_u32 s34, s34, 50176
    v_lshl_add_u32 v204, v210, 2, s34
    s_lshl_b32 s34, s60, 11
    s_lshl_b32 s35, s51, 7
    s_add_u32 s34, s34, s35
    s_add_u32 s34, s34, s49
    s_add_u32 s34, s34, 51200
    v_lshrrev_b32 v211, 3, v0
    v_lshlrev_b32 v205, 8, v211
    v_lshl_add_u32 v205, v210, 4, v205
    v_add_u32 v205, s34, v205
    s_lshl_b32 s34, s3, 12
    s_add_u32 s34, s34, 40960
    v_lshrrev_b32 v206, 2, v0
    v_lshlrev_b32 v206, 6, v206
    v_lshl_add_u32 v206, v200, 3, v206
    v_add_u32 v206, s34, v206
    s_mul_i32 s34, s3, 1152
    s_add_u32 s34, s34, 107520
    v_mul_u32_u24 v207, 144, v211
    v_lshl_add_u32 v207, v210, 4, v207
    v_add_u32 v207, s34, v207
    v_mul_u32_u24 v208, 144, v210
    v_lshl_add_u32 v208, v202, 4, v208
    v_add_u32 v208, s34, v208
    v_and_b32 v211, 1, v211
    v_lshl_add_u32 v203, v211, 6, v208
    v_add_u32 v203, 14592, v203
    v_mov_b32 v210, 98816
    v_cmp_eq_u32 vcc, 0, v211
    s_nop 1
    v_cndmask_b32 v209, v208, v210, vcc
    v_cndmask_b32 v208, v210, v208, vcc
    s_barrier
L_r_wo:
    s_mov_b32 m0, s56
    s_nop 0
    buffer_load_dwordx4 v15, s[52:55], s57 offen  lds
    s_mov_b32 m0, s58
    s_nop 0
    buffer_load_dwordx4 v15, s[52:55], s59 offen  lds
    s_xor_b32 m0, s56, 2048
    s_sub_u32 s34, 40960, s57
    buffer_load_dwordx4 v15, s[52:55], s34 offen  lds
    s_xor_b32 m0, s58, 2048
    s_add_u32 s34, s34, 1280
    buffer_load_dwordx4 v15, s[52:55], s34 offen  lds
    s_mov_b32 s35, 0
    buffer_load_dwordx4 v[64:67], v205, s[44:47], 0 offen sc1
    buffer_load_dword v26, v204, s[44:47], 0 offen sc1
    s_waitcnt vmcnt(2)
    ds_read_b64_tr_b16 v[32:33], v206 offset:0
    ds_read_b64_tr_b16 v[34:35], v206 offset:1024
    ds_read_b64_tr_b16 v[36:37], v206 offset:32
    ds_read_b64_tr_b16 v[38:39], v206 offset:1056
    ds_read_b64_tr_b16 v[40:41], v206 offset:2048
    ds_read_b64_tr_b16 v[42:43], v206 offset:3072
    ds_read_b64_tr_b16 v[44:45], v206 offset:2080
    ds_read_b64_tr_b16 v[46:47], v206 offset:3104
    s_branch L_mid70
L_poll68:
    buffer_load_dwordx4 v[64:67], v205, s[44:47], 0 offen sc1
    buffer_load_dword v26, v204, s[44:47], 0 offen sc1
L_mid70:
    s_add_u32 s35, s35, 1
    s_waitcnt vmcnt(0)
    ds_write_b128 v207, v[64:67]
    v_max3_u32 v28, v64, v65, v66
    v_max3_u32 v28, v28, v67, v26
    v_cmp_eq_u32 vcc, -1, v28
    s_cbranch_vccz L_done69
    s_cmp_lt_u32 s35, 60000
    s_nop 7
    s_cbranch_scc1 L_poll68
L_done69:
    ds_read_b128 v[68:71], v208 offset:0
    ds_read_b128 v[72:75], v209 offset:0
    ds_read_b128 v[76:79], v208 offset:64
    ds_read_b128 v[80:83], v209 offset:64
    v_sub_f32_dpp v26, v26, v26 quad_perm:[1,0,3,2] row_mask:0xf bank_mask:0xf
    v_exp_f32 v26, v26
    s_nop 0
    v_add_f32 v26, 1.0, v26
    v_rcp_f32 v26, v26
    s_waitcnt lgkmcnt(3)
    v_mfma_f32_16x16x32_bf16 v[20:23], v[32:35], v[68:71], 0
    s_waitcnt lgkmcnt(2)
    v_mfma_f32_16x16x32_bf16 v[20:23], v[36:39], v[72:75], v[20:23]
    s_waitcnt lgkmcnt(1)
    v_mfma_f32_16x16x32_bf16 v[20:23], v[40:43], v[76:79], v[20:23]
    s_waitcnt lgkmcnt(0)
    v_mfma_f32_16x16x32_bf16 v[20:23], v[44:47], v[80:83], v[20:23]
    s_nop 7
    v_pk_mul_f32 v[20:21], v[20:21], v[26:27] op_sel_hi:[1,0]
    v_pk_mul_f32 v[22:23], v[22:23], v[26:27] op_sel_hi:[1,0]
    ds_write_b128 v203, v[20:23]
    s_waitcnt lgkmcnt(0)
    s_barrier
    s_cmp_lg_u32 s3, 0
    s_cbranch_scc1 L_fin
    ds_read_b128 v[64:67], v207 offset:14592
    ds_read_b128 v[68:71], v207 offset:15744
    ds_read_b128 v[72:75], v207 offset:16896
    ds_read_b128 v[76:79], v207 offset:18048
    ds_read_b128 v[80:83], v207 offset:19200
    ds_read_b128 v[84:87], v207 offset:20352
    ds_read_b128 v[88:91], v207 offset:21504
    ds_read_b128 v[92:95], v207 offset:22656
    s_waitcnt lgkmcnt(6)
    v_pk_add_f32 v[64:65], v[64:65], v[68:69]
    v_pk_add_f32 v[66:67], v[66:67], v[70:71]
    s_waitcnt lgkmcnt(5)
    v_pk_add_f32 v[64:65], v[64:65], v[72:73]
    v_pk_add_f32 v[66:67], v[66:67], v[74:75]
    s_waitcnt lgkmcnt(4)
    v_pk_add_f32 v[64:65], v[64:65], v[76:77]
    v_pk_add_f32 v[66:67], v[66:67], v[78:79]
    s_waitcnt lgkmcnt(3)
    v_pk_add_f32 v[64:65], v[64:65], v[80:81]
    v_pk_add_f32 v[66:67], v[66:67], v[82:83]
    s_waitcnt lgkmcnt(2)
    v_pk_add_f32 v[64:65], v[64:65], v[84:85]
    v_pk_add_f32 v[66:67], v[66:67], v[86:87]
    s_waitcnt lgkmcnt(1)
    v_pk_add_f32 v[64:65], v[64:65], v[88:89]
    v_pk_add_f32 v[66:67], v[66:67], v[90:91]
    s_waitcnt lgkmcnt(0)
    v_pk_add_f32 v[64:65], v[64:65], v[92:93]
    v_pk_add_f32 v[66:67], v[66:67], v[94:95]
    v_pk_mul_f32 v[20:21], v[64:65], v[100:101]
    v_pk_mul_f32 v[22:23], v[66:67], v[102:103]
    s_nop 0
    v_add_f32_dpp v20, v20, v20 row_ror:8 row_mask:0xf bank_mask:0xf
    v_add_f32_dpp v21, v21, v21 row_ror:8 row_mask:0xf bank_mask:0xf
    v_add_f32_dpp v22, v22, v22 row_ror:8 row_mask:0xf bank_mask:0xf
    v_add_f32_dpp v23, v23, v23 row_ror:8 row_mask:0xf bank_mask:0xf
    v_cvt_pk_bf16_f32 v24, v20, v21
    v_cvt_pk_bf16_f32 v25, v22, v23
    v_min_u32 v24, -2, v24
    v_min_u32 v25, -2, v25
    s_mov_b32 exec_lo, 0x00ff00ff
    s_mov_b32 exec_hi, 0x00ff00ff
    buffer_store_dwordx2 v[24:25], v112, s[44:47], 0 offen sc1
    s_mov_b64 exec, -1
L_fin:
L_exit:
    s_endpgm
L_codeend:
.section .rodata,"a"
.p2align 6
.amdhsa_kernel adaLN_cond__sliding_block_cached__dense_activation_gelu__decode_kernel
  .amdhsa_next_free_vgpr 256
  .amdhsa_next_free_sgpr 102
  .amdhsa_accum_offset 256
  .amdhsa_group_segment_fixed_size 0
  .amdhsa_kernarg_size 120
  .amdhsa_user_sgpr_count 2
  .amdhsa_user_sgpr_kernarg_segment_ptr 1
  .amdhsa_system_sgpr_workgroup_id_x 1
  .amdhsa_float_denorm_mode_32 3
.end_amdhsa_kernel
```

```asm
; @launch grid=(256,1,1) block=(512,1,1) lds=131328
.amdgcn_target "amdgcn-amd-amdhsa--gfx950"
.text
.globl adaLN_cond__sliding_block_cached__dense_activation_gelu__decode_kernel
.p2align 8
.type adaLN_cond__sliding_block_cached__dense_activation_gelu__decode_kernel,@function
adaLN_cond__sliding_block_cached__dense_activation_gelu__decode_kernel:
    s_cmp_ge_u32 s2, 256
    s_cbranch_scc1 L_exit
    s_load_dwordx16 s[4:19], s[0:1], 0
    s_load_dwordx8 s[20:27], s[0:1], 64
    s_load_dwordx4 s[28:31], s[0:1], 96
    s_load_dwordx2 s[32:33], s[0:1], 112
    v_lshrrev_b32 v1, 6, v0
    v_and_b32 v0, 63, v0
    v_readfirstlane_b32 s3, v1
    s_and_b32 s60, s2, 7
    s_lshr_b32 s61, s2, 3
    s_mov_b32 s39, 0x20000
    s_mov_b32 s43, 0x20000
    s_mov_b32 s46, 1998848
    s_mov_b32 s47, 0x20000
    s_cmp_lg_u32 s3, 0
    s_cbranch_scc1 L_stream
    s_setprio 3
    v_and_b32 v12, 3, v0
    v_bfe_u32 v13, v0, 2, 2
    v_lshrrev_b32 v14, 4, v0
    v_lshrrev_b32 v10, 3, v0
    v_and_b32 v11, 7, v0
    v_lshlrev_b32 v11, 4, v11
    s_lshr_b32 s50, s2, 2
    s_and_b32 s51, s2, 3
    s_mul_i32 s34, s51, 1228800
    s_lshl_b32 s35, s50, 7
    s_add_u32 s34, s34, s35
    v_mul_u32_u24 v17, 7680, v10
    v_add3_u32 v17, v17, v11, s34
    v_mul_u32_u24 v16, 1280, v12
    v_lshl_add_u32 v18, v14, 4, v16
    s_mul_i32 s34, s51, 320
    v_add_u32 v19, s34, v18
    s_mov_b32 s38, 4915200
    s_sub_u32 s52, s50, 10
    s_waitcnt lgkmcnt(0)
    s_add_u32 s44, s32, 0
    s_addc_u32 s45, s33, 0
    s_cmp_ge_u32 s2, 240
    s_cbranch_scc1 L_clear
    s_cmp_ge_u32 s52, 10
    s_cbranch_scc1 L_nox
    v_lshl_add_u32 v18, v13, 6, v18
    global_load_dwordx4 v[52:55], v18, s[4:5] offset:0
    global_load_dwordx4 v[56:59], v18, s[4:5] offset:256
    global_load_dwordx4 v[60:63], v18, s[4:5] offset:512
    global_load_dwordx4 v[64:67], v18, s[4:5] offset:768
    global_load_dwordx4 v[68:71], v18, s[4:5] offset:1024
    s_lshl_b32 s34, s52, 7
    v_lshl_add_u32 v16, v13, 5, v16
    v_lshl_add_u32 v16, v14, 3, v16
    v_add_u32 v16, s34, v16
    global_load_dwordx2 v[72:73], v16, s[4:5]
L_nox:
    global_load_dwordx4 v[32:35], v19, s[24:25] offset:0
    global_load_dwordx4 v[36:39], v19, s[24:25] offset:64
    global_load_dwordx4 v[40:43], v19, s[24:25] offset:128
    global_load_dwordx4 v[44:47], v19, s[24:25] offset:192
    global_load_dwordx4 v[48:51], v19, s[24:25] offset:256
    s_mov_b32 s36, s26
    s_mov_b32 s37, s27
    s_mov_b32 m0, 0
    s_mov_b32 s34, 0
L_dma1:
    buffer_load_dwordx4 v17, s[36:39], s34 offen  lds
    s_add_u32 m0, m0, 1024
    s_add_u32 s34, s34, 61440
    buffer_load_dwordx4 v17, s[36:39], s34 offen  lds
    s_add_u32 m0, m0, 1024
    s_add_u32 s34, s34, 61440
    buffer_load_dwordx4 v17, s[36:39], s34 offen  lds
    s_add_u32 m0, m0, 1024
    s_add_u32 s34, s34, 61440
    buffer_load_dwordx4 v17, s[36:39], s34 offen  lds
    s_add_u32 m0, m0, 1024
    s_add_u32 s34, s34, 61440
    s_cmp_lt_u32 s34, 1228800
    s_cbranch_scc1 L_dma1
    v_lshlrev_b32 v1, 2, v0
    v_add_u32 v1, 98304, v1
    v_mov_b32 v2, -1
    v_mov_b32 v3, 0
    ds_write_b32 v1, v2
    ds_write_b32 v1, v2 offset:256
    ds_write_b32 v1, v3 offset:512
    ds_write_b32 v1, v3 offset:768
    s_waitcnt lgkmcnt(0)
    s_barrier
    s_getpc_b64 s[56:57]
L_pc2:
    s_sub_u32 s56, s56, L_pc2-adaLN_cond__sliding_block_cached__dense_activation_gelu__decode_kernel
    s_subb_u32 s57, s57, 0
    s_lshl_b32 s34, s61, 10
    v_lshl_add_u32 v9, v0, 4, s34
    v_min_u32 v9, L_codeend-adaLN_cond__sliding_block_cached__dense_activation_gelu__decode_kernel-16, v9
    global_load_dwordx4 v[76:79], v9, s[56:57]
    v_lshlrev_b32 v9, 21, v0
    s_mov_b64 exec, 7
    global_load_dword v76, v9, s[12:13]
    s_mov_b64 exec, 3
    global_load_dword v76, v9, s[16:17]
    global_load_dword v76, v9, s[20:21]
    s_mov_b64 exec, 1
    global_load_dword v76, v9, s[28:29]
    global_load_dword v76, v9, s[18:19]
    global_load_dword v76, v9, s[22:23]
    global_load_dword v76, v9, s[4:5]
    s_mov_b64 exec, -1
    s_and_b32 s34, s2, 31
    s_lshl_b32 s34, s34, 8
    s_lshr_b32 s35, s2, 7
    s_lshl_b32 s35, s35, 7
    s_add_u32 s49, s34, s35
    s_bfe_u32 s53, s2, 0x20005
    s_mul_i32 s34, s53, 1310720
    s_add_u32 s34, s34, s49
    v_lshl_add_u32 v16, v10, 13, v11
    v_add_u32 v16, s34, v16
    s_mov_b32 s36, s10
    s_mov_b32 s37, s11
    s_mov_b32 s38, 5242880
    s_mov_b32 m0, 20480
    s_mov_b32 s34, 0
L_dma3:
    buffer_load_dwordx4 v16, s[36:39], s34 offen  lds
    s_add_u32 m0, m0, 1024
    s_add_u32 s34, s34, 65536
    buffer_load_dwordx4 v16, s[36:39], s34 offen  lds
    s_add_u32 m0, m0, 1024
    s_add_u32 s34, s34, 65536
    buffer_load_dwordx4 v16, s[36:39], s34 offen  lds
    s_add_u32 m0, m0, 1024
    s_add_u32 s34, s34, 65536
    buffer_load_dwordx4 v16, s[36:39], s34 offen  lds
    s_add_u32 m0, m0, 1024
    s_add_u32 s34, s34, 65536
    s_cmp_lt_u32 s34, 1310720
    s_cbranch_scc1 L_dma3
    v_lshl_add_u32 v15, v14, 3, v13
    v_lshlrev_b32 v15, 7, v15
    v_lshl_add_u32 v15, v12, 3, v15
    s_waitcnt vmcnt(48)
    s_mov_b32 s34, 0xbfb8aa3b
    v_lshlrev_b32 v20, 16, v32
    v_and_b32 v21, 0xffff0000, v32
    v_lshlrev_b32 v22, 16, v33
    v_and_b32 v23, 0xffff0000, v33
    v_mul_f32 v24, s34, v20
    v_mul_f32 v25, s34, v21
    v_mul_f32 v26, s34, v22
    v_mul_f32 v27, s34, v23
    v_exp_f32 v24, v24
    v_exp_f32 v25, v25
    v_exp_f32 v26, v26
    v_exp_f32 v27, v27
    v_add_f32 v24, 1.0, v24
    v_add_f32 v25, 1.0, v25
    v_add_f32 v26, 1.0, v26
    v_add_f32 v27, 1.0, v27
    v_rcp_f32 v24, v24
    v_rcp_f32 v25, v25
    v_rcp_f32 v26, v26
    v_rcp_f32 v27, v27
    v_mul_f32 v24, v20, v24
    v_mul_f32 v25, v21, v25
    v_mul_f32 v26, v22, v26
    v_mul_f32 v27, v23, v27
    v_cvt_pk_bf16_f32 v32, v24, v25
    v_cvt_pk_bf16_f32 v33, v26, v27
    v_lshlrev_b32 v20, 16, v34
    v_and_b32 v21, 0xffff0000, v34
    v_lshlrev_b32 v22, 16, v35
    v_and_b32 v23, 0xffff0000, v35
    v_mul_f32 v24, s34, v20
    v_mul_f32 v25, s34, v21
    v_mul_f32 v26, s34, v22
    v_mul_f32 v27, s34, v23
    v_exp_f32 v24, v24
    v_exp_f32 v25, v25
    v_exp_f32 v26, v26
    v_exp_f32 v27, v27
    v_add_f32 v24, 1.0, v24
    v_add_f32 v25, 1.0, v25
    v_add_f32 v26, 1.0, v26
    v_add_f32 v27, 1.0, v27
    v_rcp_f32 v24, v24
    v_rcp_f32 v25, v25
    v_rcp_f32 v26, v26
    v_rcp_f32 v27, v27
    v_mul_f32 v24, v20, v24
    v_mul_f32 v25, v21, v25
    v_mul_f32 v26, v22, v26
    v_mul_f32 v27, v23, v27
    v_cvt_pk_bf16_f32 v34, v24, v25
    v_cvt_pk_bf16_f32 v35, v26, v27
    v_lshlrev_b32 v20, 16, v36
    v_and_b32 v21, 0xffff0000, v36
    v_lshlrev_b32 v22, 16, v37
    v_and_b32 v23, 0xffff0000, v37
    v_mul_f32 v24, s34, v20
    v_mul_f32 v25, s34, v21
    v_mul_f32 v26, s34, v22
    v_mul_f32 v27, s34, v23
    v_exp_f32 v24, v24
    v_exp_f32 v25, v25
    v_exp_f32 v26, v26
    v_exp_f32 v27, v27
    v_add_f32 v24, 1.0, v24
    v_add_f32 v25, 1.0, v25
    v_add_f32 v26, 1.0, v26
    v_add_f32 v27, 1.0, v27
    v_rcp_f32 v24, v24
    v_rcp_f32 v25, v25
    v_rcp_f32 v26, v26
    v_rcp_f32 v27, v27
    v_mul_f32 v24, v20, v24
    v_mul_f32 v25, v21, v25
    v_mul_f32 v26, v22, v26
    v_mul_f32 v27, v23, v27
    v_cvt_pk_bf16_f32 v36, v24, v25
    v_cvt_pk_bf16_f32 v37, v26, v27
    v_lshlrev_b32 v20, 16, v38
    v_and_b32 v21, 0xffff0000, v38
    v_lshlrev_b32 v22, 16, v39
    v_and_b32 v23, 0xffff0000, v39
    v_mul_f32 v24, s34, v20
    v_mul_f32 v25, s34, v21
    v_mul_f32 v26, s34, v22
    v_mul_f32 v27, s34, v23
    v_exp_f32 v24, v24
    v_exp_f32 v25, v25
    v_exp_f32 v26, v26
    v_exp_f32 v27, v27
    v_add_f32 v24, 1.0, v24
    v_add_f32 v25, 1.0, v25
    v_add_f32 v26, 1.0, v26
    v_add_f32 v27, 1.0, v27
    v_rcp_f32 v24, v24
    v_rcp_f32 v25, v25
    v_rcp_f32 v26, v26
    v_rcp_f32 v27, v27
    v_mul_f32 v24, v20, v24
    v_mul_f32 v25, v21, v25
    v_mul_f32 v26, v22, v26
    v_mul_f32 v27, v23, v27
    v_cvt_pk_bf16_f32 v38, v24, v25
    v_cvt_pk_bf16_f32 v39, v26, v27
    v_lshlrev_b32 v20, 16, v40
    v_and_b32 v21, 0xffff0000, v40
    v_lshlrev_b32 v22, 16, v41
    v_and_b32 v23, 0xffff0000, v41
    v_mul_f32 v24, s34, v20
    v_mul_f32 v25, s34, v21
    v_mul_f32 v26, s34, v22
    v_mul_f32 v27, s34, v23
    v_exp_f32 v24, v24
    v_exp_f32 v25, v25
    v_exp_f32 v26, v26
    v_exp_f32 v27, v27
    v_add_f32 v24, 1.0, v24
    v_add_f32 v25, 1.0, v25
    v_add_f32 v26, 1.0, v26
    v_add_f32 v27, 1.0, v27
    v_rcp_f32 v24, v24
    v_rcp_f32 v25, v25
    v_rcp_f32 v26, v26
    v_rcp_f32 v27, v27
    v_mul_f32 v24, v20, v24
    v_mul_f32 v25, v21, v25
    v_mul_f32 v26, v22, v26
    v_mul_f32 v27, v23, v27
    v_cvt_pk_bf16_f32 v40, v24, v25
    v_cvt_pk_bf16_f32 v41, v26, v27
    v_lshlrev_b32 v20, 16, v42
    v_and_b32 v21, 0xffff0000, v42
    v_lshlrev_b32 v22, 16, v43
    v_and_b32 v23, 0xffff0000, v43
    v_mul_f32 v24, s34, v20
    v_mul_f32 v25, s34, v21
    v_mul_f32 v26, s34, v22
    v_mul_f32 v27, s34, v23
    v_exp_f32 v24, v24
    v_exp_f32 v25, v25
    v_exp_f32 v26, v26
    v_exp_f32 v27, v27
    v_add_f32 v24, 1.0, v24
    v_add_f32 v25, 1.0, v25
    v_add_f32 v26, 1.0, v26
    v_add_f32 v27, 1.0, v27
    v_rcp_f32 v24, v24
    v_rcp_f32 v25, v25
    v_rcp_f32 v26, v26
    v_rcp_f32 v27, v27
    v_mul_f32 v24, v20, v24
    v_mul_f32 v25, v21, v25
    v_mul_f32 v26, v22, v26
    v_mul_f32 v27, v23, v27
    v_cvt_pk_bf16_f32 v42, v24, v25
    v_cvt_pk_bf16_f32 v43, v26, v27
    v_lshlrev_b32 v20, 16, v44
    v_and_b32 v21, 0xffff0000, v44
    v_lshlrev_b32 v22, 16, v45
    v_and_b32 v23, 0xffff0000, v45
    v_mul_f32 v24, s34, v20
    v_mul_f32 v25, s34, v21
    v_mul_f32 v26, s34, v22
    v_mul_f32 v27, s34, v23
    v_exp_f32 v24, v24
    v_exp_f32 v25, v25
    v_exp_f32 v26, v26
    v_exp_f32 v27, v27
    v_add_f32 v24, 1.0, v24
    v_add_f32 v25, 1.0, v25
    v_add_f32 v26, 1.0, v26
    v_add_f32 v27, 1.0, v27
    v_rcp_f32 v24, v24
    v_rcp_f32 v25, v25
    v_rcp_f32 v26, v26
    v_rcp_f32 v27, v27
    v_mul_f32 v24, v20, v24
    v_mul_f32 v25, v21, v25
    v_mul_f32 v26, v22, v26
    v_mul_f32 v27, v23, v27
    v_cvt_pk_bf16_f32 v44, v24, v25
    v_cvt_pk_bf16_f32 v45, v26, v27
    v_lshlrev_b32 v20, 16, v46
    v_and_b32 v21, 0xffff0000, v46
    v_lshlrev_b32 v22, 16, v47
    v_and_b32 v23, 0xffff0000, v47
    v_mul_f32 v24, s34, v20
    v_mul_f32 v25, s34, v21
    v_mul_f32 v26, s34, v22
    v_mul_f32 v27, s34, v23
    v_exp_f32 v24, v24
    v_exp_f32 v25, v25
    v_exp_f32 v26, v26
    v_exp_f32 v27, v27
    v_add_f32 v24, 1.0, v24
    v_add_f32 v25, 1.0, v25
    v_add_f32 v26, 1.0, v26
    v_add_f32 v27, 1.0, v27
    v_rcp_f32 v24, v24
    v_rcp_f32 v25, v25
    v_rcp_f32 v26, v26
    v_rcp_f32 v27, v27
    v_mul_f32 v24, v20, v24
    v_mul_f32 v25, v21, v25
    v_mul_f32 v26, v22, v26
    v_mul_f32 v27, v23, v27
    v_cvt_pk_bf16_f32 v46, v24, v25
    v_cvt_pk_bf16_f32 v47, v26, v27
    v_lshlrev_b32 v20, 16, v48
    v_and_b32 v21, 0xffff0000, v48
    v_lshlrev_b32 v22, 16, v49
    v_and_b32 v23, 0xffff0000, v49
    v_mul_f32 v24, s34, v20
    v_mul_f32 v25, s34, v21
    v_mul_f32 v26, s34, v22
    v_mul_f32 v27, s34, v23
    v_exp_f32 v24, v24
    v_exp_f32 v25, v25
    v_exp_f32 v26, v26
    v_exp_f32 v27, v27
    v_add_f32 v24, 1.0, v24
    v_add_f32 v25, 1.0, v25
    v_add_f32 v26, 1.0, v26
    v_add_f32 v27, 1.0, v27
    v_rcp_f32 v24, v24
    v_rcp_f32 v25, v25
    v_rcp_f32 v26, v26
    v_rcp_f32 v27, v27
    v_mul_f32 v24, v20, v24
    v_mul_f32 v25, v21, v25
    v_mul_f32 v26, v22, v26
    v_mul_f32 v27, v23, v27
    v_cvt_pk_bf16_f32 v48, v24, v25
    v_cvt_pk_bf16_f32 v49, v26, v27
    v_lshlrev_b32 v20, 16, v50
    v_and_b32 v21, 0xffff0000, v50
    v_lshlrev_b32 v22, 16, v51
    v_and_b32 v23, 0xffff0000, v51
    v_mul_f32 v24, s34, v20
    v_mul_f32 v25, s34, v21
    v_mul_f32 v26, s34, v22
    v_mul_f32 v27, s34, v23
    v_exp_f32 v24, v24
    v_exp_f32 v25, v25
    v_exp_f32 v26, v26
    v_exp_f32 v27, v27
    v_add_f32 v24, 1.0, v24
    v_add_f32 v25, 1.0, v25
    v_add_f32 v26, 1.0, v26
    v_add_f32 v27, 1.0, v27
    v_rcp_f32 v24, v24
    v_rcp_f32 v25, v25
    v_rcp_f32 v26, v26
    v_rcp_f32 v27, v27
    v_mul_f32 v24, v20, v24
    v_mul_f32 v25, v21, v25
    v_mul_f32 v26, v22, v26
    v_mul_f32 v27, v23, v27
    v_cvt_pk_bf16_f32 v50, v24, v25
    v_cvt_pk_bf16_f32 v51, v26, v27
    s_cmp_ge_u32 s52, 10
    s_cbranch_scc1 L_nostats
    v_mov_b32 v20, 0
    v_mov_b32 v21, 0
    v_mov_b32 v22, 0x3f803f80
    v_dot2c_f32_bf16 v20, v52, v22
    v_dot2c_f32_bf16 v21, v52, v52
    v_dot2c_f32_bf16 v20, v53, v22
    v_dot2c_f32_bf16 v21, v53, v53
    v_dot2c_f32_bf16 v20, v54, v22
    v_dot2c_f32_bf16 v21, v54, v54
    v_dot2c_f32_bf16 v20, v55, v22
    v_dot2c_f32_bf16 v21, v55, v55
    v_dot2c_f32_bf16 v20, v56, v22
    v_dot2c_f32_bf16 v21, v56, v56
    v_dot2c_f32_bf16 v20, v57, v22
    v_dot2c_f32_bf16 v21, v57, v57
    v_dot2c_f32_bf16 v20, v58, v22
    v_dot2c_f32_bf16 v21, v58, v58
    v_dot2c_f32_bf16 v20, v59, v22
    v_dot2c_f32_bf16 v21, v59, v59
    v_dot2c_f32_bf16 v20, v60, v22
    v_dot2c_f32_bf16 v21, v60, v60
    v_dot2c_f32_bf16 v20, v61, v22
    v_dot2c_f32_bf16 v21, v61, v61
    v_dot2c_f32_bf16 v20, v62, v22
    v_dot2c_f32_bf16 v21, v62, v62
    v_dot2c_f32_bf16 v20, v63, v22
    v_dot2c_f32_bf16 v21, v63, v63
    v_dot2c_f32_bf16 v20, v64, v22
    v_dot2c_f32_bf16 v21, v64, v64
    v_dot2c_f32_bf16 v20, v65, v22
    v_dot2c_f32_bf16 v21, v65, v65
    v_dot2c_f32_bf16 v20, v66, v22
    v_dot2c_f32_bf16 v21, v66, v66
    v_dot2c_f32_bf16 v20, v67, v22
    v_dot2c_f32_bf16 v21, v67, v67
    v_dot2c_f32_bf16 v20, v68, v22
    v_dot2c_f32_bf16 v21, v68, v68
    v_dot2c_f32_bf16 v20, v69, v22
    v_dot2c_f32_bf16 v21, v69, v69
    v_dot2c_f32_bf16 v20, v70, v22
    v_dot2c_f32_bf16 v21, v70, v70
    v_dot2c_f32_bf16 v20, v71, v22
    v_dot2c_f32_bf16 v21, v71, v71
    s_nop 1
    v_add_f32_dpp v20, v20, v20 row_ror:4 row_mask:0xf bank_mask:0xf
    v_add_f32_dpp v21, v21, v21 row_ror:4 row_mask:0xf bank_mask:0xf
    s_nop 0
    v_add_f32_dpp v20, v20, v20 row_ror:8 row_mask:0xf bank_mask:0xf
    v_add_f32_dpp v21, v21, v21 row_ror:8 row_mask:0xf bank_mask:0xf
    v_mov_b32 v22, v20
    v_mov_b32 v23, v21
    s_nop 0
    v_permlane16_swap_b32 v20, v22
    v_permlane16_swap_b32 v21, v23
    v_add_f32 v20, v20, v22
    v_add_f32 v21, v21, v23
    v_mov_b32 v22, v20
    v_mov_b32 v23, v21
    s_nop 0
    v_permlane32_swap_b32 v20, v22
    v_permlane32_swap_b32 v21, v23
    v_add_f32 v20, v20, v22
    v_add_f32 v21, v21, v23
    v_mul_f32 v22, 0x3acccccd, v20
    v_mul_f32 v21, 0x3acccccd, v21
    v_fma_f32 v21, -v22, v22, v21
    v_max_f32 v21, 0, v21
    v_add_f32 v21, 0x3727c5ac, v21
    v_rsq_f32 v20, v21
    s_nop 0
    v_mul_f32_e64 v21, -v22, v20
    v_lshlrev_b32 v24, 16, v72
    v_and_b32 v25, 0xffff0000, v72
    v_lshlrev_b32 v26, 16, v73
    v_and_b32 v27, 0xffff0000, v73
    v_fma_f32 v24, v24, v20, v21
    v_fma_f32 v25, v25, v20, v21
    v_fma_f32 v26, v26, v20, v21
    v_fma_f32 v27, v27, v20, v21
L_nostats:
    s_waitcnt vmcnt(28)
    ds_read_b64_tr_b16 v[96:97], v15 offset:0
    ds_read_b64_tr_b16 v[98:99], v15 offset:512
    ds_read_b64_tr_b16 v[100:101], v15 offset:32
    ds_read_b64_tr_b16 v[102:103], v15 offset:544
    ds_read_b64_tr_b16 v[104:105], v15 offset:64
    ds_read_b64_tr_b16 v[106:107], v15 offset:576
    ds_read_b64_tr_b16 v[108:109], v15 offset:96
    ds_read_b64_tr_b16 v[110:111], v15 offset:608
    s_waitcnt lgkmcnt(7)
    ds_read_b64_tr_b16 v[112:113], v15 offset:4096
    ds_read_b64_tr_b16 v[114:115], v15 offset:4608
    ds_read_b64_tr_b16 v[116:117], v15 offset:4128
    ds_read_b64_tr_b16 v[118:119], v15 offset:4640
    ds_read_b64_tr_b16 v[120:121], v15 offset:4160
    ds_read_b64_tr_b16 v[122:123], v15 offset:4672
    ds_read_b64_tr_b16 v[124:125], v15 offset:4192
    ds_read_b64_tr_b16 v[126:127], v15 offset:4704
    s_waitcnt lgkmcnt(7)
    ds_read_b64_tr_b16 v[128:129], v15 offset:8192
    ds_read_b64_tr_b16 v[130:131], v15 offset:8704
    ds_read_b64_tr_b16 v[132:133], v15 offset:8224
    ds_read_b64_tr_b16 v[134:135], v15 offset:8736
    ds_read_b64_tr_b16 v[136:137], v15 offset:8256
    ds_read_b64_tr_b16 v[138:139], v15 offset:8768
    ds_read_b64_tr_b16 v[140:141], v15 offset:8288
    ds_read_b64_tr_b16 v[142:143], v15 offset:8800
    s_waitcnt lgkmcnt(7)
    ds_read_b64_tr_b16 v[144:145], v15 offset:12288
    ds_read_b64_tr_b16 v[146:147], v15 offset:12800
    ds_read_b64_tr_b16 v[148:149], v15 offset:12320
    ds_read_b64_tr_b16 v[150:151], v15 offset:12832
    ds_read_b64_tr_b16 v[152:153], v15 offset:12352
    ds_read_b64_tr_b16 v[154:155], v15 offset:12864
    ds_read_b64_tr_b16 v[156:157], v15 offset:12384
    ds_read_b64_tr_b16 v[158:159], v15 offset:12896
    s_waitcnt lgkmcnt(7)
    ds_read_b64_tr_b16 v[160:161], v15 offset:16384
    ds_read_b64_tr_b16 v[162:163], v15 offset:16896
    ds_read_b64_tr_b16 v[164:165], v15 offset:16416
    ds_read_b64_tr_b16 v[166:167], v15 offset:16928
    ds_read_b64_tr_b16 v[168:169], v15 offset:16448
    ds_read_b64_tr_b16 v[170:171], v15 offset:16960
    ds_read_b64_tr_b16 v[172:173], v15 offset:16480
    ds_read_b64_tr_b16 v[174:175], v15 offset:16992
    s_waitcnt lgkmcnt(0)
    v_mfma_f32_16x16x32_bf16 v[80:83], v[96:99], v[32:35], 0
    v_mfma_f32_16x16x32_bf16 v[84:87], v[100:103], v[32:35], 0
    v_mfma_f32_16x16x32_bf16 v[88:91], v[104:107], v[32:35], 0
    v_mfma_f32_16x16x32_bf16 v[92:95], v[108:111], v[32:35], 0
    v_mfma_f32_16x16x32_bf16 v[80:83], v[112:115], v[36:39], v[80:83]
    v_mfma_f32_16x16x32_bf16 v[84:87], v[116:119], v[36:39], v[84:87]
    v_mfma_f32_16x16x32_bf16 v[88:91], v[120:123], v[36:39], v[88:91]
    v_mfma_f32_16x16x32_bf16 v[92:95], v[124:127], v[36:39], v[92:95]
    v_mfma_f32_16x16x32_bf16 v[80:83], v[128:131], v[40:43], v[80:83]
    v_mfma_f32_16x16x32_bf16 v[84:87], v[132:135], v[40:43], v[84:87]
    v_mfma_f32_16x16x32_bf16 v[88:91], v[136:139], v[40:43], v[88:91]
    v_mfma_f32_16x16x32_bf16 v[92:95], v[140:143], v[40:43], v[92:95]
    v_mfma_f32_16x16x32_bf16 v[80:83], v[144:147], v[44:47], v[80:83]
    v_mfma_f32_16x16x32_bf16 v[84:87], v[148:151], v[44:47], v[84:87]
    v_mfma_f32_16x16x32_bf16 v[88:91], v[152:155], v[44:47], v[88:91]
    v_mfma_f32_16x16x32_bf16 v[92:95], v[156:159], v[44:47], v[92:95]
    v_mfma_f32_16x16x32_bf16 v[80:83], v[160:163], v[48:51], v[80:83]
    v_mfma_f32_16x16x32_bf16 v[84:87], v[164:167], v[48:51], v[84:87]
    v_mfma_f32_16x16x32_bf16 v[88:91], v[168:171], v[48:51], v[88:91]
    v_mfma_f32_16x16x32_bf16 v[92:95], v[172:175], v[48:51], v[92:95]
    s_cmp_ge_u32 s50, 20
    s_cbranch_scc1 L_adr_rest
    s_cmp_lt_u32 s50, 10
    s_cselect_b32 s34, 5120, 0
    s_cselect_b32 s35, s50, s52
    s_lshl_b32 s35, s35, 9
    s_add_u32 s34, s34, s35
    s_lshl_b32 s35, s51, 17
    s_add_u32 s34, s34, s35
    v_lshrrev_b32 v19, 1, v14
    v_lshl_add_u32 v19, v13, 1, v19
    v_lshlrev_b32 v19, 6, v19
    v_lshl_add_u32 v19, v12, 4, v19
    v_and_b32 v20, 1, v14
    v_lshl_add_u32 v19, v20, 3, v19
    s_branch L_adr_done
L_adr_rest:
    s_lshl_b32 s34, s51, 17
    s_lshl_b32 s35, s50, 9
    s_add_u32 s34, s34, s35
    s_add_u32 s34, s34, 0
    v_lshlrev_b32 v19, 7, v12
    v_lshl_add_u32 v19, v13, 5, v19
    v_lshl_add_u32 v19, v14, 3, v19
    s_nop 3
L_adr_done:
    v_add_u32 v19, s34, v19
    v_mov_b32_dpp v80, v84 quad_perm:[0,1,2,3] row_mask:0xf bank_mask:0x2
    v_mov_b32_dpp v81, v85 quad_perm:[0,1,2,3] row_mask:0xf bank_mask:0x2
    v_mov_b32_dpp v82, v86 quad_perm:[0,1,2,3] row_mask:0xf bank_mask:0x2
    v_mov_b32_dpp v83, v87 quad_perm:[0,1,2,3] row_mask:0xf bank_mask:0x2
    v_mov_b32_dpp v80, v88 quad_perm:[0,1,2,3] row_mask:0xf bank_mask:0x4
    v_mov_b32_dpp v81, v89 quad_perm:[0,1,2,3] row_mask:0xf bank_mask:0x4
    v_mov_b32_dpp v82, v90 quad_perm:[0,1,2,3] row_mask:0xf bank_mask:0x4
    v_mov_b32_dpp v83, v91 quad_perm:[0,1,2,3] row_mask:0xf bank_mask:0x4
    v_mov_b32_dpp v80, v92 quad_perm:[0,1,2,3] row_mask:0xf bank_mask:0x8
    v_mov_b32_dpp v81, v93 quad_perm:[0,1,2,3] row_mask:0xf bank_mask:0x8
    v_mov_b32_dpp v82, v94 quad_perm:[0,1,2,3] row_mask:0xf bank_mask:0x8
    v_mov_b32_dpp v83, v95 quad_perm:[0,1,2,3] row_mask:0xf bank_mask:0x8
    s_cmp_ge_u32 s52, 10
    s_cbranch_scc1 L_noz
    v_add_f32 v80, 0x3e800000, v80
    v_add_f32 v81, 0x3e800000, v81
    v_add_f32 v82, 0x3e800000, v82
    v_add_f32 v83, 0x3e800000, v83
    v_mul_f32 v80, v80, v24
    v_mul_f32 v81, v81, v25
    v_mul_f32 v82, v82, v26
    v_mul_f32 v83, v83, v27
L_noz:
    v_cvt_pk_bf16_f32 v20, v80, v81
    v_cvt_pk_bf16_f32 v21, v82, v83
    v_min_u32 v20, -2, v20
    v_min_u32 v21, -2, v21
    v_and_b32 v22, 15, v0
    v_lshlrev_b32 v22, 2, v22
    s_mov_b32 s35, 0
L_poll4:
    global_load_dword v23, v22, s[30:31] offset:128 sc1
    s_add_u32 s35, s35, 1
    s_waitcnt vmcnt(0)
    v_cmp_ne_u32 vcc, 1, v23
    s_cbranch_vccz L_done5
    s_sleep 8
    s_cmp_lt_u32 s35, 60000
    s_cbranch_scc1 L_poll4
L_done5:
    buffer_store_dwordx2 v[20:21], v19, s[44:47], 0 offen sc1
    s_branch L_p2
L_clear:
    s_sub_u32 s55, s2, 240
    s_lshr_b32 s34, s55, 2
    s_lshl_b32 s35, s34, 3
    s_lshr_b32 s54, 538124318, s35
    s_and_b32 s54, s54, 0xff
    s_lshl_b32 s54, s54, 10
    s_mul_i32 s34, s34, 524288
    s_lshl_b32 s35, s51, 17
    s_add_u32 s34, s34, s35
    v_lshl_add_u32 v19, v0, 4, s34
    v_mov_b32 v20, -1
    v_mov_b32 v21, -1
    v_mov_b32 v22, -1
    v_mov_b32 v23, -1
    s_mov_b32 s34, 0
L_clrloop:
    buffer_store_dwordx4 v[20:23], v19, s[44:47], s34 offen sc1
    s_add_u32 s34, s34, 1024
    s_cmp_lt_u32 s34, s54
    s_cbranch_scc1 L_clrloop
    v_lshlrev_b32 v1, 2, v0
    v_add_u32 v1, 98304, v1
    v_mov_b32 v2, -1
    v_mov_b32 v3, 0
    ds_write_b32 v1, v2
    ds_write_b32 v1, v2 offset:256
    ds_write_b32 v1, v3 offset:512
    ds_write_b32 v1, v3 offset:768
    s_waitcnt lgkmcnt(0)
    s_barrier
    s_lshl_b32 s34, s55, 2
    v_mov_b32 v24, s34
    v_mov_b32 v25, 1
    s_waitcnt vmcnt(0)
    s_mov_b64 exec, 1
    global_store_dword v24, v25, s[30:31] offset:128 sc1
    s_mov_b64 exec, -1
    s_getpc_b64 s[56:57]
L_pc7:
    s_sub_u32 s56, s56, L_pc7-adaLN_cond__sliding_block_cached__dense_activation_gelu__decode_kernel
    s_subb_u32 s57, s57, 0
    s_lshl_b32 s34, s61, 10
    v_lshl_add_u32 v9, v0, 4, s34
    v_min_u32 v9, L_codeend-adaLN_cond__sliding_block_cached__dense_activation_gelu__decode_kernel-16, v9
    global_load_dwordx4 v[76:79], v9, s[56:57]
    v_lshlrev_b32 v9, 21, v0
    s_mov_b64 exec, 7
    global_load_dword v76, v9, s[12:13]
    s_mov_b64 exec, 3
    global_load_dword v76, v9, s[16:17]
    global_load_dword v76, v9, s[20:21]
    s_mov_b64 exec, 1
    global_load_dword v76, v9, s[28:29]
    global_load_dword v76, v9, s[18:19]
    global_load_dword v76, v9, s[22:23]
    global_load_dword v76, v9, s[4:5]
    s_mov_b64 exec, -1
    s_and_b32 s34, s2, 31
    s_lshl_b32 s34, s34, 8
    s_lshr_b32 s35, s2, 7
    s_lshl_b32 s35, s35, 7
    s_add_u32 s49, s34, s35
    s_bfe_u32 s53, s2, 0x20005
    s_mul_i32 s34, s53, 1310720
    s_add_u32 s34, s34, s49
    v_lshl_add_u32 v16, v10, 13, v11
    v_add_u32 v16, s34, v16
    s_mov_b32 s36, s10
    s_mov_b32 s37, s11
    s_mov_b32 s38, 5242880
    s_mov_b32 m0, 20480
    s_mov_b32 s34, 0
L_dma8:
    buffer_load_dwordx4 v16, s[36:39], s34 offen  lds
    s_add_u32 m0, m0, 1024
    s_add_u32 s34, s34, 65536
    buffer_load_dwordx4 v16, s[36:39], s34 offen  lds
    s_add_u32 m0, m0, 1024
    s_add_u32 s34, s34, 65536
    buffer_load_dwordx4 v16, s[36:39], s34 offen  lds
    s_add_u32 m0, m0, 1024
    s_add_u32 s34, s34, 65536
    buffer_load_dwordx4 v16, s[36:39], s34 offen  lds
    s_add_u32 m0, m0, 1024
    s_add_u32 s34, s34, 65536
    s_cmp_lt_u32 s34, 1310720
    s_cbranch_scc1 L_dma8
    v_lshl_add_u32 v15, v14, 3, v13
    v_lshlrev_b32 v15, 7, v15
    v_lshl_add_u32 v15, v12, 3, v15
    v_and_b32 v22, 15, v0
    v_lshlrev_b32 v22, 2, v22
    s_mov_b32 s35, 0
L_poll9:
    global_load_dword v23, v22, s[30:31] offset:128 sc1
    s_add_u32 s35, s35, 1
    s_waitcnt vmcnt(0)
    v_cmp_ne_u32 vcc, 1, v23
    s_cbranch_vccz L_done10
    s_sleep 8
    s_cmp_lt_u32 s35, 60000
    s_cbranch_scc1 L_poll9
L_done10:
L_p2:
    v_mov_b32 v199, v19
    ds_read_b64_tr_b16 v[96:97], v15 offset:20480
    ds_read_b64_tr_b16 v[98:99], v15 offset:20992
    ds_read_b64_tr_b16 v[100:101], v15 offset:20512
    ds_read_b64_tr_b16 v[102:103], v15 offset:21024
    ds_read_b64_tr_b16 v[104:105], v15 offset:20544
    ds_read_b64_tr_b16 v[106:107], v15 offset:21056
    ds_read_b64_tr_b16 v[108:109], v15 offset:20576
    ds_read_b64_tr_b16 v[110:111], v15 offset:21088
    s_waitcnt lgkmcnt(7)
    ds_read_b64_tr_b16 v[112:113], v15 offset:24576
    ds_read_b64_tr_b16 v[114:115], v15 offset:25088
    ds_read_b64_tr_b16 v[116:117], v15 offset:24608
    ds_read_b64_tr_b16 v[118:119], v15 offset:25120
    ds_read_b64_tr_b16 v[120:121], v15 offset:24640
    ds_read_b64_tr_b16 v[122:123], v15 offset:25152
    ds_read_b64_tr_b16 v[124:125], v15 offset:24672
    ds_read_b64_tr_b16 v[126:127], v15 offset:25184
    s_waitcnt lgkmcnt(7)
    ds_read_b64_tr_b16 v[128:129], v15 offset:28672
    ds_read_b64_tr_b16 v[130:131], v15 offset:29184
    ds_read_b64_tr_b16 v[132:133], v15 offset:28704
    ds_read_b64_tr_b16 v[134:135], v15 offset:29216
    ds_read_b64_tr_b16 v[136:137], v15 offset:28736
    ds_read_b64_tr_b16 v[138:139], v15 offset:29248
    ds_read_b64_tr_b16 v[140:141], v15 offset:28768
    ds_read_b64_tr_b16 v[142:143], v15 offset:29280
    s_waitcnt lgkmcnt(7)
    ds_read_b64_tr_b16 v[144:145], v15 offset:32768
    ds_read_b64_tr_b16 v[146:147], v15 offset:33280
    ds_read_b64_tr_b16 v[148:149], v15 offset:32800
    ds_read_b64_tr_b16 v[150:151], v15 offset:33312
    ds_read_b64_tr_b16 v[152:153], v15 offset:32832
    ds_read_b64_tr_b16 v[154:155], v15 offset:33344
    ds_read_b64_tr_b16 v[156:157], v15 offset:32864
    ds_read_b64_tr_b16 v[158:159], v15 offset:33376
    s_waitcnt lgkmcnt(7)
    ds_read_b64_tr_b16 v[160:161], v15 offset:36864
    ds_read_b64_tr_b16 v[162:163], v15 offset:37376
    ds_read_b64_tr_b16 v[164:165], v15 offset:36896
    ds_read_b64_tr_b16 v[166:167], v15 offset:37408
    ds_read_b64_tr_b16 v[168:169], v15 offset:36928
    ds_read_b64_tr_b16 v[170:171], v15 offset:37440
    ds_read_b64_tr_b16 v[172:173], v15 offset:36960
    ds_read_b64_tr_b16 v[174:175], v15 offset:37472
    s_waitcnt lgkmcnt(0)
    s_mul_i32 s34, s53, 1280
    v_lshlrev_b32 v19, 17, v13
    v_lshl_add_u32 v19, v14, 6, v19
    v_lshl_add_u32 v19, v12, 4, v19
    v_add_u32 v19, s34, v19
    s_movk_i32 s48, 5120
    s_mov_b32 s56, 131072
    s_mov_b32 s57, 262144
    s_mov_b32 s58, 393216
    s_sub_u32 s34, s2, 80
    s_cmp_lt_u32 s34, 160
    s_cselect_b32 s54, 1, 0
    s_and_b32 s34, s2, 3
    s_cselect_b32 s54, 0, s54
    v_mov_b32 v180, 0
    v_mov_b32 v181, 0
    v_mov_b32 v182, 0
    v_mov_b32 v183, 0
    v_mov_b32 v184, 0
    v_mov_b32 v185, 0
    v_mov_b32 v186, 0
    v_mov_b32 v187, 0
    v_mov_b32 v22, 99072
    s_mov_b32 s35, 0
L_poll12:
    ds_read_b32 v23, v22
    s_add_u32 s35, s35, 1
    s_waitcnt lgkmcnt(0)
    v_cmp_gt_u32 vcc, 20, v23
    s_cbranch_vccz L_done13
    s_sleep 2
    s_cmp_lt_u32 s35, 60000
    s_cbranch_scc1 L_poll12
L_done13:
    s_mov_b32 s35, 0
L_poll15:
    buffer_load_dwordx4 v[32:35], v19, s[44:47], 0 offen offset:0 sc1
    buffer_load_dwordx4 v[36:39], v19, s[44:47], s48 offen offset:0 sc1
    buffer_load_dwordx4 v[40:43], v19, s[44:47], 0 offen offset:256 sc1
    buffer_load_dwordx4 v[44:47], v19, s[44:47], s48 offen offset:256 sc1
    buffer_load_dwordx4 v[48:51], v19, s[44:47], 0 offen offset:512 sc1
    buffer_load_dwordx4 v[52:55], v19, s[44:47], s48 offen offset:512 sc1
    buffer_load_dwordx4 v[56:59], v19, s[44:47], 0 offen offset:768 sc1
    buffer_load_dwordx4 v[60:63], v19, s[44:47], s48 offen offset:768 sc1
    buffer_load_dwordx4 v[64:67], v19, s[44:47], 0 offen offset:1024 sc1
    buffer_load_dwordx4 v[68:71], v19, s[44:47], s48 offen offset:1024 sc1
    s_cmp_eq_u32 s54, 0
    s_cbranch_scc1 L_hskip
    buffer_load_dwordx2 v[180:181], v199, s[44:47], 0 offen sc1
    buffer_load_dwordx2 v[182:183], v199, s[44:47], s56 offen sc1
    buffer_load_dwordx2 v[184:185], v199, s[44:47], s57 offen sc1
    buffer_load_dwordx2 v[186:187], v199, s[44:47], s58 offen sc1
L_hskip:
    s_add_u32 s35, s35, 1
    s_waitcnt vmcnt(0)
    v_max3_u32 v20, v32, v33, v34
    v_max3_u32 v20, v20, v35, v36
    v_max3_u32 v20, v20, v37, v38
    v_max3_u32 v20, v20, v39, v40
    v_max3_u32 v20, v20, v41, v42
    v_max3_u32 v20, v20, v43, v44
    v_max3_u32 v20, v20, v45, v46
    v_max3_u32 v20, v20, v47, v48
    v_max3_u32 v20, v20, v49, v50
    v_max3_u32 v20, v20, v51, v52
    v_max3_u32 v20, v20, v53, v54
    v_max3_u32 v20, v20, v55, v56
    v_max3_u32 v20, v20, v57, v58
    v_max3_u32 v20, v20, v59, v60
    v_max3_u32 v20, v20, v61, v62
    v_max3_u32 v20, v20, v63, v64
    v_max3_u32 v20, v20, v65, v66
    v_max3_u32 v20, v20, v67, v68
    v_max3_u32 v20, v20, v69, v70
    v_max3_u32 v20, v20, v71, v180
    v_max3_u32 v20, v20, v181, v182
    v_max3_u32 v20, v20, v183, v184
    v_max3_u32 v20, v20, v185, v186
    v_max_u32 v20, v20, v187
    v_cmp_eq_u32 vcc, -1, v20
    s_cbranch_vccz L_done16
    s_sleep 16
    s_cmp_lt_u32 s35, 60000
    s_cbranch_scc1 L_poll15
L_done16:
    v_mfma_f32_16x16x32_bf16 v[80:83], v[96:99], v[32:35], 0
    v_mfma_f32_16x16x32_bf16 v[84:87], v[100:103], v[32:35], 0
    v_mfma_f32_16x16x32_bf16 v[88:91], v[104:107], v[32:35], 0
    v_mfma_f32_16x16x32_bf16 v[92:95], v[108:111], v[32:35], 0
    v_mfma_f32_16x16x32_bf16 v[80:83], v[96:99], v[36:39], v[80:83]
    v_mfma_f32_16x16x32_bf16 v[84:87], v[100:103], v[36:39], v[84:87]
    v_mfma_f32_16x16x32_bf16 v[88:91], v[104:107], v[36:39], v[88:91]
    v_mfma_f32_16x16x32_bf16 v[92:95], v[108:111], v[36:39], v[92:95]
    v_mfma_f32_16x16x32_bf16 v[80:83], v[112:115], v[40:43], v[80:83]
    v_mfma_f32_16x16x32_bf16 v[84:87], v[116:119], v[40:43], v[84:87]
    v_mfma_f32_16x16x32_bf16 v[88:91], v[120:123], v[40:43], v[88:91]
    v_mfma_f32_16x16x32_bf16 v[92:95], v[124:127], v[40:43], v[92:95]
    v_mfma_f32_16x16x32_bf16 v[80:83], v[112:115], v[44:47], v[80:83]
    v_mfma_f32_16x16x32_bf16 v[84:87], v[116:119], v[44:47], v[84:87]
    v_mfma_f32_16x16x32_bf16 v[88:91], v[120:123], v[44:47], v[88:91]
    v_mfma_f32_16x16x32_bf16 v[92:95], v[124:127], v[44:47], v[92:95]
    v_mfma_f32_16x16x32_bf16 v[80:83], v[128:131], v[48:51], v[80:83]
    v_mfma_f32_16x16x32_bf16 v[84:87], v[132:135], v[48:51], v[84:87]
    v_mfma_f32_16x16x32_bf16 v[88:91], v[136:139], v[48:51], v[88:91]
    v_mfma_f32_16x16x32_bf16 v[92:95], v[140:143], v[48:51], v[92:95]
    v_mfma_f32_16x16x32_bf16 v[80:83], v[128:131], v[52:55], v[80:83]
    v_mfma_f32_16x16x32_bf16 v[84:87], v[132:135], v[52:55], v[84:87]
    v_mfma_f32_16x16x32_bf16 v[88:91], v[136:139], v[52:55], v[88:91]
    v_mfma_f32_16x16x32_bf16 v[92:95], v[140:143], v[52:55], v[92:95]
    v_mfma_f32_16x16x32_bf16 v[80:83], v[144:147], v[56:59], v[80:83]
    v_mfma_f32_16x16x32_bf16 v[84:87], v[148:151], v[56:59], v[84:87]
    v_mfma_f32_16x16x32_bf16 v[88:91], v[152:155], v[56:59], v[88:91]
    v_mfma_f32_16x16x32_bf16 v[92:95], v[156:159], v[56:59], v[92:95]
    v_mfma_f32_16x16x32_bf16 v[80:83], v[144:147], v[60:63], v[80:83]
    v_mfma_f32_16x16x32_bf16 v[84:87], v[148:151], v[60:63], v[84:87]
    v_mfma_f32_16x16x32_bf16 v[88:91], v[152:155], v[60:63], v[88:91]
    v_mfma_f32_16x16x32_bf16 v[92:95], v[156:159], v[60:63], v[92:95]
    v_mfma_f32_16x16x32_bf16 v[80:83], v[160:163], v[64:67], v[80:83]
    v_mfma_f32_16x16x32_bf16 v[84:87], v[164:167], v[64:67], v[84:87]
    v_mfma_f32_16x16x32_bf16 v[88:91], v[168:171], v[64:67], v[88:91]
    v_mfma_f32_16x16x32_bf16 v[92:95], v[172:175], v[64:67], v[92:95]
    v_mfma_f32_16x16x32_bf16 v[80:83], v[160:163], v[68:71], v[80:83]
    v_mfma_f32_16x16x32_bf16 v[84:87], v[164:167], v[68:71], v[84:87]
    v_mfma_f32_16x16x32_bf16 v[88:91], v[168:171], v[68:71], v[88:91]
    v_mfma_f32_16x16x32_bf16 v[92:95], v[172:175], v[68:71], v[92:95]
    s_lshl_b32 s34, s53, 17
    s_lshl_b32 s35, s49, 2
    s_add_u32 s34, s34, s35
    s_add_u32 s34, s34, 524288
    v_lshlrev_b32 v19, 7, v12
    v_lshl_add_u32 v19, v13, 5, v19
    v_lshl_add_u32 v19, v14, 3, v19
    v_add_u32 v19, s34, v19
    v_add_f32_dpp v20, v80, v80 row_ror:8 row_mask:0xf bank_mask:0x3
    v_add_f32_dpp v24, v84, v84 row_ror:8 row_mask:0xf bank_mask:0x3
    v_add_f32_dpp v21, v81, v81 row_ror:8 row_mask:0xf bank_mask:0x3
    v_add_f32_dpp v25, v85, v85 row_ror:8 row_mask:0xf bank_mask:0x3
    v_add_f32_dpp v22, v82, v82 row_ror:8 row_mask:0xf bank_mask:0x3
    v_add_f32_dpp v26, v86, v86 row_ror:8 row_mask:0xf bank_mask:0x3
    v_add_f32_dpp v23, v83, v83 row_ror:8 row_mask:0xf bank_mask:0x3
    v_add_f32_dpp v27, v87, v87 row_ror:8 row_mask:0xf bank_mask:0x3
    v_add_f32_dpp v20, v88, v88 row_ror:8 row_mask:0xf bank_mask:0xc
    v_add_f32_dpp v24, v92, v92 row_ror:8 row_mask:0xf bank_mask:0xc
    v_add_f32_dpp v21, v89, v89 row_ror:8 row_mask:0xf bank_mask:0xc
    v_add_f32_dpp v25, v93, v93 row_ror:8 row_mask:0xf bank_mask:0xc
    v_add_f32_dpp v22, v90, v90 row_ror:8 row_mask:0xf bank_mask:0xc
    v_add_f32_dpp v26, v94, v94 row_ror:8 row_mask:0xf bank_mask:0xc
    v_add_f32_dpp v23, v91, v91 row_ror:8 row_mask:0xf bank_mask:0xc
    v_add_f32_dpp v27, v95, v95 row_ror:8 row_mask:0xf bank_mask:0xc
    v_add_f32_dpp v28, v20, v20 row_shl:4 row_mask:0xf bank_mask:0x5
    v_add_f32_dpp v29, v21, v21 row_shl:4 row_mask:0xf bank_mask:0x5
    v_add_f32_dpp v30, v22, v22 row_shl:4 row_mask:0xf bank_mask:0x5
    v_add_f32_dpp v31, v23, v23 row_shl:4 row_mask:0xf bank_mask:0x5
    v_add_f32_dpp v28, v24, v24 row_shr:4 row_mask:0xf bank_mask:0xa
    v_add_f32_dpp v29, v25, v25 row_shr:4 row_mask:0xf bank_mask:0xa
    v_add_f32_dpp v30, v26, v26 row_shr:4 row_mask:0xf bank_mask:0xa
    v_add_f32_dpp v31, v27, v27 row_shr:4 row_mask:0xf bank_mask:0xa
    v_cvt_pk_bf16_f32 v20, v28, v29
    v_cvt_pk_bf16_f32 v21, v30, v31
    v_min_u32 v20, -2, v20
    v_min_u32 v21, -2, v21
    buffer_store_dwordx2 v[20:21], v19, s[44:47], 0 offen sc1
    s_cmp_eq_u32 s54, 0
    s_cbranch_scc1 L_nomf
    v_lshlrev_b32 v24, 16, v180
    v_and_b32 v25, 0xffff0000, v180
    v_lshlrev_b32 v26, 16, v181
    v_and_b32 v27, 0xffff0000, v181
    v_lshlrev_b32 v28, 16, v182
    v_and_b32 v29, 0xffff0000, v182
    v_lshlrev_b32 v30, 16, v183
    v_and_b32 v31, 0xffff0000, v183
    v_add_f32 v24, v24, v28
    v_add_f32 v25, v25, v29
    v_add_f32 v26, v26, v30
    v_add_f32 v27, v27, v31
    v_lshlrev_b32 v28, 16, v184
    v_and_b32 v29, 0xffff0000, v184
    v_lshlrev_b32 v30, 16, v185
    v_and_b32 v31, 0xffff0000, v185
    v_add_f32 v24, v24, v28
    v_add_f32 v25, v25, v29
    v_add_f32 v26, v26, v30
    v_add_f32 v27, v27, v31
    v_lshlrev_b32 v28, 16, v186
    v_and_b32 v29, 0xffff0000, v186
    v_lshlrev_b32 v30, 16, v187
    v_and_b32 v31, 0xffff0000, v187
    v_add_f32 v24, v24, v28
    v_add_f32 v25, v25, v29
    v_add_f32 v26, v26, v30
    v_add_f32 v27, v27, v31
    v_cvt_pk_bf16_f32 v22, v24, v25
    v_cvt_pk_bf16_f32 v23, v26, v27
    v_min_u32 v22, -2, v22
    v_min_u32 v23, -2, v23
    s_sub_u32 s34, s50, 20
    s_lshl_b32 s35, s34, 9
    v_subrev_u32 v199, s35, v199
    s_lshr_b32 s35, s34, 2
    s_lshl_b32 s35, s35, 9
    s_and_b32 s34, s34, 3
    s_lshl_b32 s34, s34, 17
    s_add_u32 s34, s34, s35
    s_add_u32 s34, s34, 1038336
    v_add_u32 v199, s34, v199
    buffer_store_dwordx2 v[22:23], v199, s[44:47], 0 offen sc1
L_nomf:
    s_and_b32 s34, s2, 127
    s_lshl_b32 s34, s34, 21
    s_lshr_b32 s35, s2, 7
    s_lshl_b32 s35, s35, 18
    s_add_u32 s34, s34, s35
    s_add_u32 s34, s34, 1572864
    s_mov_b32 s38, 0x40000
    s_mov_b32 s42, 0x40000
    s_waitcnt lgkmcnt(0)
    s_add_u32 s36, s6, s34
    s_addc_u32 s37, s7, 0
    s_add_u32 s40, s8, s34
    s_addc_u32 s41, s9, 0
    v_lshlrev_b32 v18, 4, v0
    s_mov_b32 s34, 258048
    buffer_load_dwordx4 v[128:131], v18, s[36:39], s34 offen offset:0 nt
    buffer_load_dwordx4 v[132:135], v18, s[36:39], s34 offen offset:1024 nt
    buffer_load_dwordx4 v[136:139], v18, s[36:39], s34 offen offset:2048 nt
    buffer_load_dwordx4 v[140:143], v18, s[36:39], s34 offen offset:3072 nt
    buffer_load_dwordx4 v[144:147], v18, s[40:43], s34 offen offset:0 nt
    buffer_load_dwordx4 v[148:151], v18, s[40:43], s34 offen offset:1024 nt
    buffer_load_dwordx4 v[152:155], v18, s[40:43], s34 offen offset:2048 nt
    buffer_load_dwordx4 v[156:159], v18, s[40:43], s34 offen offset:3072 nt
    s_and_b32 s34, s2, 31
    s_lshl_b32 s34, s34, 10
    s_lshl_b32 s35, s53, 7
    s_add_u32 s34, s34, s35
    s_add_u32 s34, s34, 524288
    v_lshrrev_b32 v19, 5, v0
    v_mul_u32_u24 v19, 384, v19
    v_lshl_add_u32 v19, v0, 2, v19
    v_add_u32 v19, s34, v19
    v_mov_b32 v22, 99072
    s_mov_b32 s35, 0
L_poll18:
    ds_read_b32 v23, v22
    s_add_u32 s35, s35, 1
    s_waitcnt lgkmcnt(0)
    v_cmp_gt_u32 vcc, 33, v23
    s_cbranch_vccz L_done19
    s_sleep 2
    s_cmp_lt_u32 s35, 60000
    s_cbranch_scc1 L_poll18
L_done19:
    s_mov_b32 s35, 0
L_poll21:
    buffer_load_dword v32, v19, s[44:47], 0 offen sc1
    buffer_load_dword v33, v19, s[44:47], s56 offen sc1
    buffer_load_dword v34, v19, s[44:47], s57 offen sc1
    buffer_load_dword v35, v19, s[44:47], s58 offen sc1
    s_add_u32 s35, s35, 1
    s_waitcnt vmcnt(0)
    v_max3_u32 v22, v32, v33, v34
    v_max_u32 v22, v22, v35
    v_cmp_eq_u32 vcc, -1, v22
    s_cbranch_vccz L_done22
    s_sleep 16
    s_cmp_lt_u32 s35, 60000
    s_cbranch_scc1 L_poll21
L_done22:
    v_lshlrev_b32 v36, 16, v32
    v_and_b32 v37, 0xffff0000, v32
    v_lshlrev_b32 v38, 16, v33
    v_and_b32 v39, 0xffff0000, v33
    v_lshlrev_b32 v40, 16, v34
    v_and_b32 v41, 0xffff0000, v34
    v_lshlrev_b32 v42, 16, v35
    v_and_b32 v43, 0xffff0000, v35
    v_pk_add_f32 v[36:37], v[36:37], v[38:39]
    v_pk_add_f32 v[40:41], v[40:41], v[42:43]
    v_pk_add_f32 v[36:37], v[36:37], v[40:41]
    v_cvt_pk_bf16_f32 v32, v36, v37
    v_min_u32 v32, -2, v32
    ds_write_b32 v1, v32
    s_getpc_b64 s[56:57]
L_pc24:
    s_sub_u32 s56, s56, L_pc24-adaLN_cond__sliding_block_cached__dense_activation_gelu__decode_kernel
    s_subb_u32 s57, s57, 0
    s_lshl_b32 s34, s61, 10
    v_lshl_add_u32 v9, v0, 4, s34
    v_min_u32 v9, L_codeend-adaLN_cond__sliding_block_cached__dense_activation_gelu__decode_kernel-16, v9
    global_load_dwordx4 v[76:79], v9, s[56:57]
    v_and_b32 v2, 15, v0
    v_lshlrev_b32 v2, 4, v2
    v_add_u32 v2, 98304, v2
    ds_read_b128 v[4:7], v2
    s_waitcnt lgkmcnt(0)
    v_dot2_f32_bf16 v8, v128, v4, 0
    v_dot2_f32_bf16 v9, v132, v4, 0
    v_dot2_f32_bf16 v10, v136, v4, 0
    v_dot2_f32_bf16 v11, v140, v4, 0
    v_dot2c_f32_bf16 v8, v129, v5
    v_dot2c_f32_bf16 v9, v133, v5
    v_dot2c_f32_bf16 v10, v137, v5
    v_dot2c_f32_bf16 v11, v141, v5
    v_dot2c_f32_bf16 v8, v130, v6
    v_dot2c_f32_bf16 v9, v134, v6
    v_dot2c_f32_bf16 v10, v138, v6
    v_dot2c_f32_bf16 v11, v142, v6
    v_dot2c_f32_bf16 v8, v131, v7
    v_dot2c_f32_bf16 v9, v135, v7
    v_dot2c_f32_bf16 v10, v139, v7
    v_dot2c_f32_bf16 v11, v143, v7
    v_add_f32_dpp v16, v8, v8 row_ror:8 row_mask:0xf bank_mask:0x3
    v_add_f32_dpp v16, v9, v9 row_ror:8 row_mask:0xf bank_mask:0xc
    v_add_f32_dpp v17, v10, v10 row_ror:8 row_mask:0xf bank_mask:0x3
    v_add_f32_dpp v17, v11, v11 row_ror:8 row_mask:0xf bank_mask:0xc
    v_add_f32_dpp v16, v16, v16 row_half_mirror row_mask:0xf bank_mask:0xf
    s_nop 0
    v_add_f32_dpp v17, v17, v17 row_half_mirror row_mask:0xf bank_mask:0xf
    v_add_f32_dpp v16, v16, v16 quad_perm:[1,0,3,2] row_mask:0xf bank_mask:0xf
    s_nop 0
    v_add_f32_dpp v17, v17, v17 quad_perm:[1,0,3,2] row_mask:0xf bank_mask:0xf
    v_add_f32_dpp v16, v16, v16 quad_perm:[2,3,0,1] row_mask:0xf bank_mask:0xf
    s_nop 0
    v_add_f32_dpp v17, v17, v17 quad_perm:[2,3,0,1] row_mask:0xf bank_mask:0xf
    v_max_f32 v8, v16, v17
    s_mov_b32 s34, 0x3e0293ee
    s_nop 0
    v_max_f32_dpp v8, v8, v8 row_ror:8 row_mask:0xf bank_mask:0xf
    v_mov_b32 v9, v8
    s_nop 1
    v_permlane16_swap_b32 v8, v9
    v_max_f32 v8, v8, v9
    v_mov_b32 v9, v8
    s_nop 1
    v_permlane32_swap_b32 v8, v9
    v_max_f32 v8, v8, v9
    v_mul_f32 v8, s34, v8
    v_fma_f32 v16, v16, s34, -v8
    v_fma_f32 v17, v17, s34, -v8
    v_exp_f32 v16, v16
    v_exp_f32 v17, v17
    s_nop 0
    v_add_f32 v9, v16, v17
    v_and_b32 v10, 1, v0
    v_lshlrev_b32 v10, 4, v10
    v_mov_b32 v11, 0xffff
    v_lshlrev_b32 v10, v10, v11
    v_bfe_u32 v11, v0, 1, 2
    v_cmp_eq_u32 vcc, 0, v11
    s_nop 1
    v_cndmask_b32 v20, 0, v10, vcc
    v_cmp_eq_u32 vcc, 1, v11
    s_nop 1
    v_cndmask_b32 v21, 0, v10, vcc
    v_cmp_eq_u32 vcc, 2, v11
    s_nop 1
    v_cndmask_b32 v22, 0, v10, vcc
    v_cmp_eq_u32 vcc, 3, v11
    s_nop 1
    v_cndmask_b32 v23, 0, v10, vcc
    v_add_f32_dpp v9, v9, v9 row_ror:8 row_mask:0xf bank_mask:0xf
    v_mov_b32 v10, v9
    s_nop 1
    v_permlane16_swap_b32 v9, v10
    v_add_f32 v9, v9, v10
    v_mov_b32 v10, v9
    s_nop 1
    v_permlane32_swap_b32 v9, v10
    v_add_f32 v9, v9, v10
    v_mov_b32 v10, 98616
    s_mov_b64 exec, 1
    ds_write_b64 v10, v[8:9]
    s_mov_b64 exec, -1
    v_cvt_pk_bf16_f32 v10, v16, v16
    v_and_b32 v24, v10, v20
    v_and_b32 v25, v10, v21
    v_and_b32 v26, v10, v22
    v_and_b32 v27, v10, v23
    s_nop 1
    v_mfma_f32_16x16x32_bf16 v[116:119], v[144:147], v[24:27], 0
    v_mfma_f32_16x16x32_bf16 v[120:123], v[148:151], v[24:27], 0
    v_cvt_pk_bf16_f32 v10, v17, v17
    v_and_b32 v28, v10, v20
    v_and_b32 v29, v10, v21
    v_and_b32 v30, v10, v22
    v_and_b32 v31, v10, v23
    s_nop 1
    v_mfma_f32_16x16x32_bf16 v[116:119], v[152:155], v[28:31], v[116:119]
    v_mfma_f32_16x16x32_bf16 v[120:123], v[156:159], v[28:31], v[120:123]
    s_nop 7
    v_mov_b32_dpp v116, v120 quad_perm:[0,1,2,3] row_mask:0xf bank_mask:0xc
    v_mov_b32_dpp v117, v121 quad_perm:[0,1,2,3] row_mask:0xf bank_mask:0xc
    v_mov_b32_dpp v118, v122 quad_perm:[0,1,2,3] row_mask:0xf bank_mask:0xc
    v_mov_b32_dpp v119, v123 quad_perm:[0,1,2,3] row_mask:0xf bank_mask:0xc
    s_mov_b32 s63, 0
    s_mov_b32 s62, s61
    s_cmp_lt_u32 s61, 20
    s_cbranch_scc1 L_rd25
    s_mul_i32 s62, s60, 12
    s_add_u32 s62, s62, s61
    s_sub_u32 s62, s62, 20
    s_mov_b32 s63, 1
    s_cmp_lt_u32 s62, 54
    s_cbranch_scc1 L_rd25
    s_cmp_lt_u32 s62, 56
    s_cselect_b32 s63, 3, 2
    s_sub_u32 s62, s62, 56
L_rd25:
    v_and_b32 v8, 3, v0
    v_bfe_u32 v9, v0, 2, 2
    v_lshrrev_b32 v10, 4, v0
    s_mov_b32 s55, 0x20000
    s_lshl_b32 s35, s62, 6
    s_and_b32 s49, s62, 1
    s_cmp_eq_u32 s63, 0
    s_cbranch_scc1 L_dp27
    s_cmp_eq_u32 s63, 1
    s_cbranch_scc1 L_dp28
    s_mov_b32 s52, s20
    s_mov_b32 s53, s21
    s_mov_b32 s54, 2211840
    v_mov_b32 v15, 0
    s_branch L_dp29
L_dp28:
    s_mov_b32 s52, s16
    s_mov_b32 s53, s17
    s_mov_b32 s54, 2211840
    v_lshl_add_u32 v15, v9, 3, v10
    v_mul_u32_u24 v15, 3456, v15
    v_lshl_add_u32 v15, v8, 4, v15
    v_add_u32 v15, s35, v15
    s_bfe_u32 s50, s3, 0x10001
    s_lshl_b32 s50, s50, 7
    s_and_b32 s34, s3, 1
    s_lshl_b32 s34, s34, 2
    s_add_u32 s50, s50, s34
    s_and_b32 s51, s3, 3
    s_lshl_b32 s51, s51, 5
    s_add_u32 s51, s51, 512
    s_mul_i32 s50, s50, 3456
    s_mul_i32 s51, s51, 3456
    s_branch L_dp29
L_dp27:
    s_mov_b32 s52, s12
    s_mov_b32 s53, s13
    s_mov_b32 s54, 5242880
    s_lshr_b32 s50, s3, 1
    s_lshl_b32 s50, s50, 3
    s_add_u32 s50, s50, s60
    s_and_b32 s51, s3, 1
    s_lshl_b32 s34, s50, 1
    s_add_u32 s34, s34, s51
    s_mul_i32 s34, s34, 81920
    s_add_u32 s34, s34, s35
    v_lshl_add_u32 v15, v9, 2, v10
    v_mul_u32_u24 v15, 2560, v15
    v_lshl_add_u32 v15, v8, 4, v15
    v_add_u32 v15, s34, v15
    s_lshl_b32 s56, s3, 12
    s_lshl_b32 s34, s49, 11
    s_add_u32 s56, s56, s34
    s_add_u32 s56, s56, 40960
    s_add_u32 s58, s56, 1024
    s_mul_i32 s57, s49, 40960
    s_add_u32 s59, s57, 1280
L_dp29:
    v_and_b32 v200, 3, v0
    v_bfe_u32 v201, v0, 2, 2
    v_lshrrev_b32 v202, 4, v0
    s_lshl_b32 s34, s3, 10
    s_add_u32 s34, s34, 122112
    v_lshl_add_u32 v203, v0, 4, s34
    s_movk_i32 s48, 5120
    v_mov_b32 v197, 0
    s_mov_b32 s40, 0
    s_mov_b32 s41, 0
    s_mov_b32 s42, 0
    s_cmp_eq_u32 s63, 0
    s_cbranch_scc1 L_d_wo
    s_cmp_eq_u32 s63, 2
    s_cbranch_scc1 L_d_w2
    s_cmp_eq_u32 s63, 3
    s_cbranch_scc1 L_d_none
    v_and_b32 v205, 15, v0
    v_lshlrev_b32 v205, 4, v205
    s_and_b32 s49, s3, 3
    s_mul_i32 s34, s49, 1280
    s_add_u32 s34, s34, 1053696
    v_lshl_add_u32 v206, v202, 17, v205
    v_add_u32 v206, s34, v206
    s_mul_i32 s34, s49, 3840
    v_add_u32 v205, s34, v205
    s_lshl_b32 s34, s62, 6
    v_lshlrev_b32 v5, 4, v14
    v_lshl_add_u32 v5, v12, 2, v5
    v_add_u32 v5, s34, v5
    global_load_dword v6, v5, s[18:19]
    v_and_b32 v7, 15, v0
    v_lshlrev_b32 v7, 4, v7
    v_mul_u32_u24 v8, 1280, v14
    v_add_u32 v8, v8, v7
    v_bfe_u32 v9, v0, 3, 1
    v_lshlrev_b32 v9, 17, v9
    v_lshl_add_u32 v9, v14, 7, v9
    v_and_b32 v10, 7, v0
    v_lshl_add_u32 v9, v10, 4, v9
    v_add_u32 v9, 1048576, v9
    s_mov_b32 s57, 262144
    v_mul_u32_u24 v5, 3840, v14
    v_add_u32 v5, v5, v7
    global_load_dwordx4 v[32:35], v8, s[4:5] offset:0
    global_load_dwordx4 v[36:39], v8, s[4:5] offset:256
    global_load_dwordx4 v[40:43], v8, s[4:5] offset:512
    global_load_dwordx4 v[44:47], v8, s[4:5] offset:768
    global_load_dwordx4 v[48:51], v8, s[4:5] offset:1024
    s_mov_b32 s35, 0
L_poll30:
    buffer_load_dwordx4 v[52:55], v9, s[44:47], s57 offen offset:1024 sc1
    buffer_load_dwordx4 v[56:59], v9, s[44:47], 0 offen offset:1536 sc1
    buffer_load_dwordx4 v[60:63], v9, s[44:47], s57 offen offset:1536 sc1
    buffer_load_dwordx4 v[64:67], v9, s[44:47], 0 offen offset:2048 sc1
    buffer_load_dwordx4 v[68:71], v9, s[44:47], s57 offen offset:2048 sc1
    buffer_load_dwordx4 v[72:75], v9, s[44:47], 0 offen offset:2560 sc1
    buffer_load_dwordx4 v[76:79], v9, s[44:47], s57 offen offset:2560 sc1
    buffer_load_dwordx4 v[80:83], v9, s[44:47], 0 offen offset:3072 sc1
    buffer_load_dwordx4 v[84:87], v9, s[44:47], s57 offen offset:3072 sc1
    buffer_load_dwordx4 v[88:91], v9, s[44:47], 0 offen offset:3584 sc1
    s_add_u32 s35, s35, 1
    s_waitcnt vmcnt(0)
    v_max3_u32 v28, v52, v53, v54
    v_max3_u32 v28, v28, v55, v56
    v_max3_u32 v28, v28, v57, v58
    v_max3_u32 v28, v28, v59, v60
    v_max3_u32 v28, v28, v61, v62
    v_max3_u32 v28, v28, v63, v64
    v_max3_u32 v28, v28, v65, v66
    v_max3_u32 v28, v28, v67, v68
    v_max3_u32 v28, v28, v69, v70
    v_max3_u32 v28, v28, v71, v72
    v_max3_u32 v28, v28, v73, v74
    v_max3_u32 v28, v28, v75, v76
    v_max3_u32 v28, v28, v77, v78
    v_max3_u32 v28, v28, v79, v80
    v_max3_u32 v28, v28, v81, v82
    v_max3_u32 v28, v28, v83, v84
    v_max3_u32 v28, v28, v85, v86
    v_max3_u32 v28, v28, v87, v88
    v_max3_u32 v28, v28, v89, v90
    v_max_u32 v28, v28, v91
    v_cmp_eq_u32 vcc, -1, v28
    s_cbranch_vccz L_done31
    s_sleep 16
    s_cmp_lt_u32 s35, 60000
    s_cbranch_scc1 L_poll30
L_done31:
    ds_write_b128 v5, v[32:35] offset:0
    ds_write_b128 v5, v[36:39] offset:256
    ds_write_b128 v5, v[40:43] offset:512
    ds_write_b128 v5, v[44:47] offset:768
    ds_write_b128 v5, v[48:51] offset:1024
    ds_write_b128 v5, v[52:55] offset:1280
    ds_write_b128 v5, v[56:59] offset:1536
    ds_write_b128 v5, v[60:63] offset:1792
    ds_write_b128 v5, v[64:67] offset:2048
    ds_write_b128 v5, v[68:71] offset:2304
    ds_write_b128 v5, v[72:75] offset:2560
    ds_write_b128 v5, v[76:79] offset:2816
    ds_write_b128 v5, v[80:83] offset:3072
    ds_write_b128 v5, v[84:87] offset:3328
    ds_write_b128 v5, v[88:91] offset:3584
    s_waitcnt lgkmcnt(0)
    v_lshlrev_b32 v100, 16, v6
    v_and_b32 v101, 0xffff0000, v6
    s_lshr_b32 s34, s62, 1
    s_lshl_b32 s34, s34, 7
    s_and_b32 s35, s62, 1
    s_mul_i32 s35, s35, 221184
    s_add_u32 s34, s34, s35
    v_lshrrev_b32 v197, 1, v0
    v_mul_u32_u24 v197, 3456, v197
    v_and_b32 v196, 1, v0
    v_lshl_add_u32 v197, v196, 6, v197
    v_add_u32 v197, s34, v197
    s_mov_b32 s40, 110592
    s_mov_b32 s41, 331776
    s_branch L_d_none
L_d_w2:
    s_lshl_b32 s34, s62, 5
    v_lshl_add_u32 v3, v14, 3, s34
    global_load_dwordx2 v[20:21], v3, s[22:23]
    v_mul_u32_u24 v112, 1280, v12
    v_add_u32 v112, v112, v3
    global_load_dwordx2 v[22:23], v112, s[4:5]
    s_lshr_b32 s34, s62, 2
    s_add_u32 s34, s34, 30
    s_lshr_b32 s35, s34, 2
    s_lshl_b32 s35, s35, 9
    s_and_b32 s34, s34, 3
    s_lshl_b32 s34, s34, 17
    s_add_u32 s34, s34, s35
    s_and_b32 s35, s62, 3
    s_mul_i32 s35, s35, 32
    s_add_u32 s34, s34, s35
    s_add_u32 s34, s34, 1048576
    v_lshlrev_b32 v5, 7, v12
    v_lshl_add_u32 v5, v14, 3, v5
    v_add_u32 v5, s34, v5
    s_waitcnt vmcnt(0)
    v_lshlrev_b32 v32, 16, v20
    v_and_b32 v33, 0xffff0000, v20
    v_lshlrev_b32 v34, 16, v21
    v_and_b32 v35, 0xffff0000, v21
    v_lshlrev_b32 v108, 16, v22
    v_and_b32 v109, 0xffff0000, v22
    v_lshlrev_b32 v110, 16, v23
    v_and_b32 v111, 0xffff0000, v23
    s_mov_b32 s35, 0
L_poll33:
    buffer_load_dwordx2 v[24:25], v5, s[44:47], 0 offen sc1
    s_add_u32 s35, s35, 1
    s_waitcnt vmcnt(0)
    v_max_u32 v28, v24, v25
    v_cmp_eq_u32 vcc, -1, v28
    s_cbranch_vccz L_done34
    s_sleep 16
    s_cmp_lt_u32 s35, 60000
    s_cbranch_scc1 L_poll33
L_done34:
    v_lshlrev_b32 v104, 16, v24
    v_and_b32 v105, 0xffff0000, v24
    v_lshlrev_b32 v106, 16, v25
    v_and_b32 v107, 0xffff0000, v25
    v_fma_f32 v108, v104, v32, v108
    v_fma_f32 v109, v105, v33, v109
    v_fma_f32 v110, v106, v34, v110
    v_fma_f32 v111, v107, v35, v111
    v_mul_f32 v108, 0x3e800000, v108
    v_mul_f32 v109, 0x3e800000, v109
    v_mul_f32 v110, 0x3e800000, v110
    v_mul_f32 v111, 0x3e800000, v111
    v_lshl_add_u32 v204, v13, 17, v112
    v_add_u32 v204, 1053696, v204
    s_lshr_b32 s34, s62, 2
    s_lshl_b32 s34, s34, 7
    s_and_b32 s35, s62, 3
    s_mul_i32 s35, s35, 81920
    s_add_u32 s34, s34, s35
    v_lshrrev_b32 v197, 1, v0
    v_mul_u32_u24 v197, 1280, v197
    v_and_b32 v196, 1, v0
    v_lshl_add_u32 v197, v196, 6, v197
    v_add_u32 v197, s34, v197
    s_mov_b32 s40, 40960
    s_mov_b32 s41, 286720
    s_branch L_d_none
L_d_wo:
    s_lshr_b32 s49, s3, 1
    s_lshl_b32 s49, s49, 17
    v_and_b32 v210, 7, v0
    s_lshl_b32 s34, s60, 12
    s_add_u32 s34, s34, s49
    s_add_u32 s34, s34, 1573120
    v_lshrrev_b32 v211, 3, v0
    v_lshl_add_u32 v204, v211, 9, s34
    s_lshl_b32 s35, s51, 7
    s_add_u32 s34, s34, s35
    s_sub_u32 s34, s34, 256
    v_lshrrev_b32 v211, 3, v0
    v_lshlrev_b32 v205, 9, v211
    v_lshl_add_u32 v205, v210, 4, v205
    v_add_u32 v205, s34, v205
    s_lshl_b32 s34, s3, 12
    s_add_u32 s34, s34, 40960
    v_lshrrev_b32 v206, 2, v0
    v_lshlrev_b32 v206, 6, v206
    v_lshl_add_u32 v206, v200, 3, v206
    v_add_u32 v206, s34, v206
    s_mul_i32 s34, s3, 1152
    s_add_u32 s34, s34, 107520
    v_mul_u32_u24 v207, 144, v211
    v_lshl_add_u32 v207, v210, 4, v207
    v_add_u32 v207, s34, v207
    v_mul_u32_u24 v208, 144, v210
    v_lshl_add_u32 v208, v202, 4, v208
    v_add_u32 v208, s34, v208
    v_mul_u32_u24 v212, 144, v211
    v_add_u32 v212, s34, v212
    v_mul_u32_u24 v213, 144, v210
    v_add_u32 v213, s34, v213
    v_and_b32 v211, 1, v211
    v_lshl_add_u32 v203, v211, 6, v208
    v_add_u32 v203, 14592, v203
    v_mov_b32 v210, 98816
    v_cmp_eq_u32 vcc, 0, v211
    s_nop 1
    v_cndmask_b32 v209, v208, v210, vcc
    v_cndmask_b32 v208, v210, v208, vcc
    v_mov_b32 v6, v14
    v_and_b32 v8, 7, v0
    s_lshl_b32 s35, s62, 6
    v_lshl_add_u32 v8, v8, 3, s35
    s_lshr_b32 s34, s62, 1
    s_add_u32 s34, s34, 0
    s_lshr_b32 s35, s34, 2
    s_lshl_b32 s35, s35, 9
    s_and_b32 s34, s34, 3
    s_lshl_b32 s34, s34, 17
    s_add_u32 s34, s34, s35
    s_and_b32 s35, s62, 1
    s_mul_i32 s35, s35, 64
    s_add_u32 s34, s34, s35
    s_add_u32 s34, s34, 1048576
    v_and_b32 v9, 7, v0
    v_lshlrev_b32 v9, 3, v9
    v_lshl_add_u32 v9, v6, 7, v9
    v_add_u32 v9, s34, v9
    s_lshr_b32 s34, s60, 2
    s_mul_i32 s34, s34, 5120
    s_and_b32 s35, s60, 3
    s_lshl_b32 s35, s35, 17
    s_add_u32 s34, s34, s35
    s_add_u32 s34, s34, 1053696
    v_mul_u32_u24 v112, 1280, v6
    v_add3_u32 v112, v112, v8, s34
    s_lshr_b32 s34, s62, 1
    s_lshl_b32 s34, s34, 7
    s_and_b32 s35, s62, 1
    s_mul_i32 s35, s35, 40960
    s_add_u32 s34, s34, s35
    s_mul_i32 s35, s60, 163840
    s_add_u32 s34, s34, s35
    v_lshrrev_b32 v197, 1, v0
    v_mul_u32_u24 v197, 1280, v197
    v_and_b32 v196, 1, v0
    v_lshl_add_u32 v197, v196, 6, v197
    v_add_u32 v197, s34, v197
    s_mov_b32 s40, 81920
    s_mov_b32 s41, 1228800
    s_mov_b32 s35, 0
L_poll36:
    buffer_load_dwordx2 v[32:33], v9, s[44:47], 0 offen sc1
    s_add_u32 s35, s35, 1
    s_waitcnt vmcnt(0)
    v_max_u32 v22, v32, v33
    v_cmp_eq_u32 vcc, -1, v22
    s_cbranch_vccz L_done37
    s_sleep 16
    s_cmp_lt_u32 s35, 60000
    s_cbranch_scc1 L_poll36
L_done37:
    v_lshlrev_b32 v100, 16, v32
    v_and_b32 v101, 0xffff0000, v32
    v_lshlrev_b32 v102, 16, v33
    v_and_b32 v103, 0xffff0000, v33
L_d_none:
    v_and_b32 v19, 7, v0
    v_lshlrev_b32 v19, 3, v19
    v_add_u32 v19, 98560, v19
    s_mov_b32 s35, 0
L_poll39:
    ds_read_b64 v[20:21], v19
    s_add_u32 s35, s35, 1
    s_waitcnt lgkmcnt(0)
    v_max_u32 v22, v20, v21
    v_cmp_eq_u32 vcc, -1, v22
    s_cbranch_vccz L_done40
    s_sleep 2
    s_cmp_lt_u32 s35, 60000
    s_cbranch_scc1 L_poll39
L_done40:
    v_max_f32_dpp v22, v20, v20 row_half_mirror row_mask:0xf bank_mask:0xf
    s_nop 1
    v_max_f32_dpp v22, v22, v22 quad_perm:[1,0,3,2] row_mask:0xf bank_mask:0xf
    s_nop 1
    v_max_f32_dpp v22, v22, v22 quad_perm:[2,3,0,1] row_mask:0xf bank_mask:0xf
    v_sub_f32 v20, v20, v22
    v_exp_f32 v20, v20
    s_nop 0
    v_mul_f32 v21, v21, v20
    s_nop 1
    v_add_f32_dpp v21, v21, v21 row_half_mirror row_mask:0xf bank_mask:0xf
    s_nop 1
    v_add_f32_dpp v21, v21, v21 quad_perm:[1,0,3,2] row_mask:0xf bank_mask:0xf
    s_nop 1
    v_add_f32_dpp v21, v21, v21 quad_perm:[2,3,0,1] row_mask:0xf bank_mask:0xf
    v_rcp_f32 v23, v21
    v_log_f32 v21, v21
    v_mul_f32 v20, v20, v23
    v_add_f32 v21, v21, v22
    v_min_u32 v21, -2, v21
    v_readlane_b32 s88, v20, 0
    v_readlane_b32 s90, v20, 1
    v_readlane_b32 s92, v20, 2
    v_readlane_b32 s94, v20, 3
    v_readlane_b32 s96, v20, 4
    v_readlane_b32 s98, v20, 5
    v_readlane_b32 s100, v20, 6
    v_readlane_b32 s89, v20, 7
    s_and_b32 s95, s61, 3
    s_lshl_b32 s95, s95, 17
    s_bfe_u32 s35, s2, 0x20005
    s_lshl_b32 s35, s35, 1
    s_lshr_b32 s91, s2, 7
    s_add_u32 s35, s35, s91
    v_mov_b32 v24, v21
    v_mov_b32 v25, v21
    v_mul_f32 v20, s89, v116
    v_mul_f32 v21, s89, v117
    v_mul_f32 v22, s89, v118
    v_mul_f32 v23, s89, v119
    s_lshl_b32 s34, s60, 12
    s_lshl_b32 s35, s35, 9
    s_add_u32 s34, s34, s35
    s_add_u32 s34, s34, s95
    s_add_u32 s34, s34, 1572864
    v_and_b32 v18, 7, v0
    v_lshl_add_u32 v18, v14, 3, v18
    v_bfe_u32 v19, v0, 3, 1
    v_lshl_add_u32 v18, v19, 5, v18
    v_lshl_add_u32 v18, v18, 3, s34
    v_lshlrev_b32 v19, 4, v0
    v_add_u32 v19, 99328, v19
    s_barrier
    s_cmp_ge_u32 s63, 1
    s_cbranch_scc1 L_nopf
    buffer_load_dword v250, v197, s[52:55], s42 offen
    s_add_u32 s42, s42, s40
    buffer_load_dword v250, v197, s[52:55], s42 offen
    s_add_u32 s42, s42, s41
    buffer_load_dword v250, v197, s[52:55], s42 offen
    s_add_u32 s42, s42, s40
    buffer_load_dword v250, v197, s[52:55], s42 offen
    s_add_u32 s42, s42, s41
    buffer_load_dword v250, v197, s[52:55], s42 offen
    s_add_u32 s42, s42, s40
    buffer_load_dword v250, v197, s[52:55], s42 offen
    s_add_u32 s42, s42, s41
    buffer_load_dword v250, v197, s[52:55], s42 offen
    s_add_u32 s42, s42, s40
    buffer_load_dword v250, v197, s[52:55], s42 offen
    s_add_u32 s42, s42, s41
L_nopf:
    s_barrier
    ds_read_b128 v[32:35], v19 offset:0
    ds_read_b128 v[36:39], v19 offset:1024
    ds_read_b128 v[40:43], v19 offset:2048
    ds_read_b128 v[44:47], v19 offset:3072
    ds_read_b128 v[48:51], v19 offset:4096
    ds_read_b128 v[52:55], v19 offset:5120
    ds_read_b128 v[56:59], v19 offset:6144
    s_waitcnt lgkmcnt(6)
    v_pk_fma_f32 v[20:21], v[32:33], s[88:89], v[20:21] op_sel_hi:[1,0,1]
    v_pk_fma_f32 v[22:23], v[34:35], s[88:89], v[22:23] op_sel_hi:[1,0,1]
    s_waitcnt lgkmcnt(5)
    v_pk_fma_f32 v[20:21], v[36:37], s[90:91], v[20:21] op_sel_hi:[1,0,1]
    v_pk_fma_f32 v[22:23], v[38:39], s[90:91], v[22:23] op_sel_hi:[1,0,1]
    s_waitcnt lgkmcnt(4)
    v_pk_fma_f32 v[20:21], v[40:41], s[92:93], v[20:21] op_sel_hi:[1,0,1]
    v_pk_fma_f32 v[22:23], v[42:43], s[92:93], v[22:23] op_sel_hi:[1,0,1]
    s_waitcnt lgkmcnt(3)
    v_pk_fma_f32 v[20:21], v[44:45], s[94:95], v[20:21] op_sel_hi:[1,0,1]
    v_pk_fma_f32 v[22:23], v[46:47], s[94:95], v[22:23] op_sel_hi:[1,0,1]
    s_waitcnt lgkmcnt(2)
    v_pk_fma_f32 v[20:21], v[48:49], s[96:97], v[20:21] op_sel_hi:[1,0,1]
    v_pk_fma_f32 v[22:23], v[50:51], s[96:97], v[22:23] op_sel_hi:[1,0,1]
    s_waitcnt lgkmcnt(1)
    v_pk_fma_f32 v[20:21], v[52:53], s[98:99], v[20:21] op_sel_hi:[1,0,1]
    v_pk_fma_f32 v[22:23], v[54:55], s[98:99], v[22:23] op_sel_hi:[1,0,1]
    s_waitcnt lgkmcnt(0)
    v_pk_fma_f32 v[20:21], v[56:57], s[100:101], v[20:21] op_sel_hi:[1,0,1]
    v_pk_fma_f32 v[22:23], v[58:59], s[100:101], v[22:23] op_sel_hi:[1,0,1]
    s_nop 0
    v_add_f32_dpp v20, v20, v20 row_ror:8 row_mask:0xf bank_mask:0xf
    v_add_f32_dpp v21, v21, v21 row_ror:8 row_mask:0xf bank_mask:0xf
    v_add_f32_dpp v22, v22, v22 row_ror:8 row_mask:0xf bank_mask:0xf
    v_add_f32_dpp v23, v23, v23 row_ror:8 row_mask:0xf bank_mask:0xf
    s_mov_b32 exec_lo, 0x00ff00ff
    s_mov_b32 exec_hi, 0x00ff00ff
    v_cvt_pk_bf16_f32 v24, v20, v21
    v_cvt_pk_bf16_f32 v25, v22, v23
    v_min_u32 v24, -2, v24
    v_min_u32 v25, -2, v25
    s_mov_b32 exec_lo, 16777215
    buffer_store_dwordx2 v[24:25], v18, s[44:47], 0 offen sc1
    s_mov_b64 exec, -1
    s_cmp_lt_u32 s63, 1
    s_cbranch_scc1 L_nopf2
    buffer_load_dword v250, v197, s[52:55], s42 offen
    s_add_u32 s42, s42, s40
    buffer_load_dword v250, v197, s[52:55], s42 offen
    s_add_u32 s42, s42, s41
    buffer_load_dword v250, v197, s[52:55], s42 offen
    s_add_u32 s42, s42, s40
    buffer_load_dword v250, v197, s[52:55], s42 offen
    s_add_u32 s42, s42, s41
    buffer_load_dword v250, v197, s[52:55], s42 offen
    s_add_u32 s42, s42, s40
    buffer_load_dword v250, v197, s[52:55], s42 offen
    s_add_u32 s42, s42, s41
    buffer_load_dword v250, v197, s[52:55], s42 offen
    s_add_u32 s42, s42, s40
    buffer_load_dword v250, v197, s[52:55], s42 offen
    s_add_u32 s42, s42, s41
L_nopf2:
    s_barrier
    s_cmp_eq_u32 s63, 0
    s_cbranch_scc1 L_r_wo
    buffer_load_dword v250, v197, s[52:55], s42 offen
    s_add_u32 s42, s42, s40
    buffer_load_dword v250, v197, s[52:55], s42 offen
    s_add_u32 s42, s42, s41
    s_cmp_eq_u32 s63, 1
    s_cbranch_scc1 L_r_w1
    buffer_load_dword v250, v197, s[52:55], s42 offen
    s_add_u32 s42, s42, s40
    buffer_load_dword v250, v197, s[52:55], s42 offen
    s_add_u32 s42, s42, s41
    buffer_load_dword v250, v197, s[52:55], s42 offen
    s_add_u32 s42, s42, s40
    buffer_load_dword v250, v197, s[52:55], s42 offen
    s_add_u32 s42, s42, s41
    s_cmp_eq_u32 s63, 2
    s_cbranch_scc1 L_w2_red
    s_branch L_fin
L_stream:
    s_sub_u32 s49, s3, 1
    s_lshl_b32 s49, s49, 12
    v_lshl_add_u32 v1, v0, 4, s49
    s_and_b32 s34, s2, 127
    s_lshl_b32 s34, s34, 21
    s_lshr_b32 s35, s2, 7
    s_lshl_b32 s35, s35, 18
    s_add_u32 s34, s34, s35
    s_add_u32 s34, s34, 1572864
    s_mov_b32 s38, 0x40000
    s_mov_b32 s42, 0x40000
    s_waitcnt lgkmcnt(0)
    s_add_u32 s36, s6, s34
    s_addc_u32 s37, s7, 0
    s_add_u32 s40, s8, s34
    s_addc_u32 s41, s9, 0
    s_mov_b32 s49, 0
    buffer_load_dwordx4 v[16:19], v1, s[36:39], s49 offen offset:0 nt
    buffer_load_dwordx4 v[160:163], v1, s[40:43], s49 offen offset:0 nt
    buffer_load_dwordx4 v[20:23], v1, s[36:39], s49 offen offset:1024 nt
    s_barrier
    s_waitcnt vmcnt(2)
    buffer_load_dwordx4 v[24:27], v1, s[36:39], s49 offen offset:2048 nt
    s_waitcnt vmcnt(2)
    buffer_load_dwordx4 v[28:31], v1, s[36:39], s49 offen offset:3072 nt
    s_waitcnt vmcnt(2)
    s_mov_b32 s49, 28672
    buffer_load_dwordx4 v[32:35], v1, s[36:39], s49 offen offset:0 nt
    s_waitcnt vmcnt(2)
    buffer_load_dwordx4 v[36:39], v1, s[36:39], s49 offen offset:1024 nt
    s_waitcnt vmcnt(2)
    buffer_load_dwordx4 v[40:43], v1, s[36:39], s49 offen offset:2048 nt
    s_add_u32 s44, s32, 0
    s_addc_u32 s45, s33, 0
    s_mov_b32 s63, 0
    s_mov_b32 s62, s61
    s_cmp_lt_u32 s61, 20
    s_cbranch_scc1 L_rd42
    s_mul_i32 s62, s60, 12
    s_add_u32 s62, s62, s61
    s_sub_u32 s62, s62, 20
    s_mov_b32 s63, 1
    s_cmp_lt_u32 s62, 54
    s_cbranch_scc1 L_rd42
    s_cmp_lt_u32 s62, 56
    s_cselect_b32 s63, 3, 2
    s_sub_u32 s62, s62, 56
L_rd42:
    v_and_b32 v8, 3, v0
    v_bfe_u32 v9, v0, 2, 2
    v_lshrrev_b32 v10, 4, v0
    s_mov_b32 s55, 0x20000
    s_lshl_b32 s35, s62, 6
    s_and_b32 s49, s62, 1
    s_cmp_eq_u32 s63, 0
    s_cbranch_scc1 L_dp44
    s_cmp_eq_u32 s63, 1
    s_cbranch_scc1 L_dp45
    s_mov_b32 s52, s20
    s_mov_b32 s53, s21
    s_mov_b32 s54, 2211840
    v_mov_b32 v15, 0
    s_branch L_dp46
L_dp45:
    s_mov_b32 s52, s16
    s_mov_b32 s53, s17
    s_mov_b32 s54, 2211840
    v_lshl_add_u32 v15, v9, 3, v10
    v_mul_u32_u24 v15, 3456, v15
    v_lshl_add_u32 v15, v8, 4, v15
    v_add_u32 v15, s35, v15
    s_bfe_u32 s50, s3, 0x10001
    s_lshl_b32 s50, s50, 7
    s_and_b32 s34, s3, 1
    s_lshl_b32 s34, s34, 2
    s_add_u32 s50, s50, s34
    s_and_b32 s51, s3, 3
    s_lshl_b32 s51, s51, 5
    s_add_u32 s51, s51, 512
    s_mul_i32 s50, s50, 3456
    s_mul_i32 s51, s51, 3456
    s_branch L_dp46
L_dp44:
    s_mov_b32 s52, s12
    s_mov_b32 s53, s13
    s_mov_b32 s54, 5242880
    s_lshr_b32 s50, s3, 1
    s_lshl_b32 s50, s50, 3
    s_add_u32 s50, s50, s60
    s_and_b32 s51, s3, 1
    s_lshl_b32 s34, s50, 1
    s_add_u32 s34, s34, s51
    s_mul_i32 s34, s34, 81920
    s_add_u32 s34, s34, s35
    v_lshl_add_u32 v15, v9, 2, v10
    v_mul_u32_u24 v15, 2560, v15
    v_lshl_add_u32 v15, v8, 4, v15
    v_add_u32 v15, s34, v15
    s_lshl_b32 s56, s3, 12
    s_lshl_b32 s34, s49, 11
    s_add_u32 s56, s56, s34
    s_add_u32 s56, s56, 40960
    s_add_u32 s58, s56, 1024
    s_mul_i32 s57, s49, 40960
    s_add_u32 s59, s57, 1280
L_dp46:
    v_and_b32 v2, 15, v0
    v_lshlrev_b32 v2, 4, v2
    v_add_u32 v2, 98304, v2
    s_waitcnt vmcnt(2)
    s_mov_b32 s49, 28672
    buffer_load_dwordx4 v[44:47], v1, s[36:39], s49 offen offset:3072 nt
    s_waitcnt vmcnt(2)
    s_mov_b32 s49, 57344
    buffer_load_dwordx4 v[48:51], v1, s[36:39], s49 offen offset:0 nt
    s_waitcnt vmcnt(2)
    buffer_load_dwordx4 v[52:55], v1, s[36:39], s49 offen offset:1024 nt
    s_waitcnt vmcnt(2)
    buffer_load_dwordx4 v[56:59], v1, s[36:39], s49 offen offset:2048 nt
    s_waitcnt vmcnt(2)
    buffer_load_dwordx4 v[60:63], v1, s[36:39], s49 offen offset:3072 nt
    s_waitcnt vmcnt(2)
    s_mov_b32 s49, 86016
    buffer_load_dwordx4 v[64:67], v1, s[36:39], s49 offen offset:0 nt
    s_waitcnt vmcnt(2)
    buffer_load_dwordx4 v[68:71], v1, s[36:39], s49 offen offset:1024 nt
    s_waitcnt vmcnt(2)
    buffer_load_dwordx4 v[72:75], v1, s[36:39], s49 offen offset:2048 nt
    s_waitcnt vmcnt(2)
    buffer_load_dwordx4 v[76:79], v1, s[36:39], s49 offen offset:3072 nt
    s_waitcnt vmcnt(2)
    s_mov_b32 s49, 114688
    buffer_load_dwordx4 v[80:83], v1, s[36:39], s49 offen offset:0 nt
    s_waitcnt vmcnt(2)
    buffer_load_dwordx4 v[84:87], v1, s[36:39], s49 offen offset:1024 nt
    s_waitcnt vmcnt(2)
    buffer_load_dwordx4 v[88:91], v1, s[36:39], s49 offen offset:2048 nt
    v_mov_b32 v3, 20
    ds_write_b32 v2, v3 offset:768
    s_waitcnt vmcnt(2)
    buffer_load_dwordx4 v[92:95], v1, s[36:39], s49 offen offset:3072 nt
    s_waitcnt vmcnt(2)
    s_mov_b32 s49, 143360
    buffer_load_dwordx4 v[96:99], v1, s[36:39], s49 offen offset:0 nt
    s_waitcnt vmcnt(2)
    buffer_load_dwordx4 v[100:103], v1, s[36:39], s49 offen offset:1024 nt
    s_waitcnt vmcnt(2)
    buffer_load_dwordx4 v[104:107], v1, s[36:39], s49 offen offset:2048 nt
    s_waitcnt vmcnt(2)
    buffer_load_dwordx4 v[108:111], v1, s[36:39], s49 offen offset:3072 nt
    s_waitcnt vmcnt(2)
    s_mov_b32 s49, 172032
    buffer_load_dwordx4 v[112:115], v1, s[36:39], s49 offen offset:0 nt
    s_waitcnt vmcnt(2)
    buffer_load_dwordx4 v[116:119], v1, s[36:39], s49 offen offset:1024 nt
    s_waitcnt vmcnt(2)
    buffer_load_dwordx4 v[120:123], v1, s[36:39], s49 offen offset:2048 nt
    s_waitcnt vmcnt(2)
    buffer_load_dwordx4 v[124:127], v1, s[36:39], s49 offen offset:3072 nt
    s_waitcnt vmcnt(2)
    s_mov_b32 s49, 200704
    buffer_load_dwordx4 v[128:131], v1, s[36:39], s49 offen offset:0 nt
    s_waitcnt vmcnt(2)
    buffer_load_dwordx4 v[132:135], v1, s[36:39], s49 offen offset:1024 nt
    s_waitcnt vmcnt(2)
    buffer_load_dwordx4 v[136:139], v1, s[36:39], s49 offen offset:2048 nt
    s_waitcnt vmcnt(2)
    buffer_load_dwordx4 v[140:143], v1, s[36:39], s49 offen offset:3072 nt
    v_mov_b32 v3, 33
    ds_write_b32 v2, v3 offset:768
    s_waitcnt vmcnt(2)
    s_mov_b32 s49, 229376
    buffer_load_dwordx4 v[144:147], v1, s[36:39], s49 offen offset:0 nt
    s_waitcnt vmcnt(2)
    buffer_load_dwordx4 v[148:151], v1, s[36:39], s49 offen offset:1024 nt
    s_waitcnt vmcnt(2)
    buffer_load_dwordx4 v[152:155], v1, s[36:39], s49 offen offset:2048 nt
    s_waitcnt vmcnt(2)
    buffer_load_dwordx4 v[156:159], v1, s[36:39], s49 offen offset:3072 nt
    s_waitcnt vmcnt(2)
    s_mov_b32 s49, 0
    buffer_load_dwordx4 v[164:167], v1, s[40:43], s49 offen offset:1024 nt
    s_waitcnt vmcnt(2)
    buffer_load_dwordx4 v[168:171], v1, s[40:43], s49 offen offset:2048 nt
    s_waitcnt vmcnt(2)
    buffer_load_dwordx4 v[172:175], v1, s[40:43], s49 offen offset:3072 nt
    s_waitcnt vmcnt(2)
    s_mov_b32 s49, 28672
    buffer_load_dwordx4 v[176:179], v1, s[40:43], s49 offen offset:0 nt
    s_waitcnt vmcnt(2)
    buffer_load_dwordx4 v[180:183], v1, s[40:43], s49 offen offset:1024 nt
    s_waitcnt vmcnt(2)
    buffer_load_dwordx4 v[184:187], v1, s[40:43], s49 offen offset:2048 nt
    s_waitcnt vmcnt(2)
    buffer_load_dwordx4 v[188:191], v1, s[40:43], s49 offen offset:3072 nt
    s_waitcnt vmcnt(2)
    s_cmp_ge_u32 s3, 4
    s_cbranch_scc1 L_sl47
    s_waitcnt vmcnt(1)
L_sl47:
    s_mov_b32 s49, 57344
    buffer_load_dwordx4 v[192:195], v1, s[40:43], s49 offen offset:0 nt
    s_waitcnt vmcnt(2)
    s_cmp_ge_u32 s3, 4
    s_cbranch_scc1 L_sl48
    s_waitcnt vmcnt(1)
L_sl48:
    buffer_load_dwordx4 v[196:199], v1, s[40:43], s49 offen offset:1024 nt
    s_waitcnt vmcnt(2)
    s_cmp_ge_u32 s3, 4
    s_cbranch_scc1 L_sl49
    s_waitcnt vmcnt(1)
L_sl49:
    buffer_load_dwordx4 v[200:203], v1, s[40:43], s49 offen offset:2048 nt
    s_waitcnt vmcnt(2)
    buffer_load_dwordx4 v[204:207], v1, s[40:43], s49 offen offset:3072 nt
    s_waitcnt vmcnt(2)
    s_mov_b32 s49, 86016
    buffer_load_dwordx4 v[208:211], v1, s[40:43], s49 offen offset:0 nt
    s_waitcnt vmcnt(2)
    buffer_load_dwordx4 v[212:215], v1, s[40:43], s49 offen offset:1024 nt
    s_waitcnt vmcnt(2)
    buffer_load_dwordx4 v[216:219], v1, s[40:43], s49 offen offset:2048 nt
    s_waitcnt vmcnt(2)
    buffer_load_dwordx4 v[220:223], v1, s[40:43], s49 offen offset:3072 nt
    s_waitcnt vmcnt(2)
    s_mov_b32 s49, 114688
    buffer_load_dwordx4 v[224:227], v1, s[40:43], s49 offen offset:0 nt
    s_waitcnt vmcnt(2)
    buffer_load_dwordx4 v[228:231], v1, s[40:43], s49 offen offset:1024 nt
    s_waitcnt vmcnt(2)
    buffer_load_dwordx4 v[232:235], v1, s[40:43], s49 offen offset:2048 nt
    s_waitcnt vmcnt(2)
    buffer_load_dwordx4 v[236:239], v1, s[40:43], s49 offen offset:3072 nt
    s_mov_b32 s35, 0
L_poll50:
    ds_read_b128 v[4:7], v2
    s_add_u32 s35, s35, 1
    s_waitcnt lgkmcnt(0)
    v_max3_u32 v3, v4, v5, v6
    v_max_u32 v3, v3, v7
    v_cmp_eq_u32 vcc, -1, v3
    s_cbranch_vccz L_done51
    s_sleep 2
    s_cmp_lt_u32 s35, 60000
    s_cbranch_scc1 L_poll50
L_done51:
    s_waitcnt vmcnt(2)
    s_mov_b32 s49, 143360
    buffer_load_dwordx4 v[240:243], v1, s[40:43], s49 offen offset:0 nt
    v_dot2_f32_bf16 v8, v16, v4, 0
    v_dot2_f32_bf16 v9, v20, v4, 0
    v_dot2_f32_bf16 v10, v24, v4, 0
    v_dot2_f32_bf16 v11, v28, v4, 0
    v_dot2c_f32_bf16 v8, v17, v5
    v_dot2c_f32_bf16 v9, v21, v5
    v_dot2c_f32_bf16 v10, v25, v5
    v_dot2c_f32_bf16 v11, v29, v5
    v_dot2c_f32_bf16 v8, v18, v6
    v_dot2c_f32_bf16 v9, v22, v6
    v_dot2c_f32_bf16 v10, v26, v6
    v_dot2c_f32_bf16 v11, v30, v6
    v_dot2c_f32_bf16 v8, v19, v7
    v_dot2c_f32_bf16 v9, v23, v7
    v_dot2c_f32_bf16 v10, v27, v7
    v_dot2c_f32_bf16 v11, v31, v7
    v_add_f32_dpp v12, v8, v8 row_ror:8 row_mask:0xf bank_mask:0x3
    v_add_f32_dpp v12, v9, v9 row_ror:8 row_mask:0xf bank_mask:0xc
    v_add_f32_dpp v13, v10, v10 row_ror:8 row_mask:0xf bank_mask:0x3
    v_add_f32_dpp v13, v11, v11 row_ror:8 row_mask:0xf bank_mask:0xc
    v_dot2_f32_bf16 v8, v32, v4, 0
    v_dot2_f32_bf16 v9, v36, v4, 0
    v_dot2_f32_bf16 v10, v40, v4, 0
    v_dot2_f32_bf16 v11, v44, v4, 0
    v_add_f32_dpp v12, v12, v12 row_half_mirror row_mask:0xf bank_mask:0xf
    v_add_f32_dpp v13, v13, v13 row_half_mirror row_mask:0xf bank_mask:0xf
    v_dot2c_f32_bf16 v8, v33, v5
    v_dot2c_f32_bf16 v9, v37, v5
    v_dot2c_f32_bf16 v10, v41, v5
    v_dot2c_f32_bf16 v11, v45, v5
    v_add_f32_dpp v12, v12, v12 quad_perm:[1,0,3,2] row_mask:0xf bank_mask:0xf
    v_add_f32_dpp v13, v13, v13 quad_perm:[1,0,3,2] row_mask:0xf bank_mask:0xf
    v_dot2c_f32_bf16 v8, v34, v6
    v_dot2c_f32_bf16 v9, v38, v6
    v_dot2c_f32_bf16 v10, v42, v6
    v_dot2c_f32_bf16 v11, v46, v6
    s_waitcnt vmcnt(2)
    buffer_load_dwordx4 v[244:247], v1, s[40:43], s49 offen offset:1024 nt
    v_add_f32_dpp v12, v12, v12 quad_perm:[2,3,0,1] row_mask:0xf bank_mask:0xf
    v_add_f32_dpp v13, v13, v13 quad_perm:[2,3,0,1] row_mask:0xf bank_mask:0xf
    v_dot2c_f32_bf16 v8, v35, v7
    v_dot2c_f32_bf16 v9, v39, v7
    v_dot2c_f32_bf16 v10, v43, v7
    v_dot2c_f32_bf16 v11, v47, v7
    v_add_f32_dpp v16, v8, v8 row_ror:8 row_mask:0xf bank_mask:0x3
    v_add_f32_dpp v16, v9, v9 row_ror:8 row_mask:0xf bank_mask:0xc
    v_add_f32_dpp v17, v10, v10 row_ror:8 row_mask:0xf bank_mask:0x3
    v_add_f32_dpp v17, v11, v11 row_ror:8 row_mask:0xf bank_mask:0xc
    v_dot2_f32_bf16 v8, v48, v4, 0
    v_dot2_f32_bf16 v9, v52, v4, 0
    v_dot2_f32_bf16 v10, v56, v4, 0
    v_dot2_f32_bf16 v11, v60, v4, 0
    v_add_f32_dpp v16, v16, v16 row_half_mirror row_mask:0xf bank_mask:0xf
    v_add_f32_dpp v17, v17, v17 row_half_mirror row_mask:0xf bank_mask:0xf
    v_dot2c_f32_bf16 v8, v49, v5
    v_dot2c_f32_bf16 v9, v53, v5
    v_dot2c_f32_bf16 v10, v57, v5
    v_dot2c_f32_bf16 v11, v61, v5
    v_add_f32_dpp v16, v16, v16 quad_perm:[1,0,3,2] row_mask:0xf bank_mask:0xf
    v_add_f32_dpp v17, v17, v17 quad_perm:[1,0,3,2] row_mask:0xf bank_mask:0xf
    v_dot2c_f32_bf16 v8, v50, v6
    v_dot2c_f32_bf16 v9, v54, v6
    v_dot2c_f32_bf16 v10, v58, v6
    v_dot2c_f32_bf16 v11, v62, v6
    v_add_f32_dpp v16, v16, v16 quad_perm:[2,3,0,1] row_mask:0xf bank_mask:0xf
    v_add_f32_dpp v17, v17, v17 quad_perm:[2,3,0,1] row_mask:0xf bank_mask:0xf
    v_dot2c_f32_bf16 v8, v51, v7
    v_dot2c_f32_bf16 v9, v55, v7
    v_dot2c_f32_bf16 v10, v59, v7
    v_dot2c_f32_bf16 v11, v63, v7
    v_add_f32_dpp v18, v8, v8 row_ror:8 row_mask:0xf bank_mask:0x3
    v_add_f32_dpp v18, v9, v9 row_ror:8 row_mask:0xf bank_mask:0xc
    v_add_f32_dpp v19, v10, v10 row_ror:8 row_mask:0xf bank_mask:0x3
    v_add_f32_dpp v19, v11, v11 row_ror:8 row_mask:0xf bank_mask:0xc
    s_waitcnt vmcnt(2)
    buffer_load_dwordx4 v[248:251], v1, s[40:43], s49 offen offset:2048 nt
    v_dot2_f32_bf16 v8, v64, v4, 0
    v_dot2_f32_bf16 v9, v68, v4, 0
    v_dot2_f32_bf16 v10, v72, v4, 0
    v_dot2_f32_bf16 v11, v76, v4, 0
    v_add_f32_dpp v18, v18, v18 row_half_mirror row_mask:0xf bank_mask:0xf
    v_add_f32_dpp v19, v19, v19 row_half_mirror row_mask:0xf bank_mask:0xf
    v_dot2c_f32_bf16 v8, v65, v5
    v_dot2c_f32_bf16 v9, v69, v5
    v_dot2c_f32_bf16 v10, v73, v5
    v_dot2c_f32_bf16 v11, v77, v5
    v_add_f32_dpp v18, v18, v18 quad_perm:[1,0,3,2] row_mask:0xf bank_mask:0xf
    v_add_f32_dpp v19, v19, v19 quad_perm:[1,0,3,2] row_mask:0xf bank_mask:0xf
    v_dot2c_f32_bf16 v8, v66, v6
    v_dot2c_f32_bf16 v9, v70, v6
    v_dot2c_f32_bf16 v10, v74, v6
    v_dot2c_f32_bf16 v11, v78, v6
    v_add_f32_dpp v18, v18, v18 quad_perm:[2,3,0,1] row_mask:0xf bank_mask:0xf
    v_add_f32_dpp v19, v19, v19 quad_perm:[2,3,0,1] row_mask:0xf bank_mask:0xf
    v_dot2c_f32_bf16 v8, v67, v7
    v_dot2c_f32_bf16 v9, v71, v7
    v_dot2c_f32_bf16 v10, v75, v7
    v_dot2c_f32_bf16 v11, v79, v7
    v_add_f32_dpp v20, v8, v8 row_ror:8 row_mask:0xf bank_mask:0x3
    v_add_f32_dpp v20, v9, v9 row_ror:8 row_mask:0xf bank_mask:0xc
    v_add_f32_dpp v21, v10, v10 row_ror:8 row_mask:0xf bank_mask:0x3
    v_add_f32_dpp v21, v11, v11 row_ror:8 row_mask:0xf bank_mask:0xc
    v_dot2_f32_bf16 v8, v80, v4, 0
    v_dot2_f32_bf16 v9, v84, v4, 0
    v_dot2_f32_bf16 v10, v88, v4, 0
    v_dot2_f32_bf16 v11, v92, v4, 0
    v_add_f32_dpp v20, v20, v20 row_half_mirror row_mask:0xf bank_mask:0xf
    v_add_f32_dpp v21, v21, v21 row_half_mirror row_mask:0xf bank_mask:0xf
    v_dot2c_f32_bf16 v8, v81, v5
    v_dot2c_f32_bf16 v9, v85, v5
    v_dot2c_f32_bf16 v10, v89, v5
    v_dot2c_f32_bf16 v11, v93, v5
    s_waitcnt vmcnt(2)
    buffer_load_dwordx4 v[252:255], v1, s[40:43], s49 offen offset:3072 nt
    v_add_f32_dpp v20, v20, v20 quad_perm:[1,0,3,2] row_mask:0xf bank_mask:0xf
    v_add_f32_dpp v21, v21, v21 quad_perm:[1,0,3,2] row_mask:0xf bank_mask:0xf
    v_dot2c_f32_bf16 v8, v82, v6
    v_dot2c_f32_bf16 v9, v86, v6
    v_dot2c_f32_bf16 v10, v90, v6
    v_dot2c_f32_bf16 v11, v94, v6
    v_add_f32_dpp v20, v20, v20 quad_perm:[2,3,0,1] row_mask:0xf bank_mask:0xf
    v_add_f32_dpp v21, v21, v21 quad_perm:[2,3,0,1] row_mask:0xf bank_mask:0xf
    v_dot2c_f32_bf16 v8, v83, v7
    v_dot2c_f32_bf16 v9, v87, v7
    v_dot2c_f32_bf16 v10, v91, v7
    v_dot2c_f32_bf16 v11, v95, v7
    v_add_f32_dpp v22, v8, v8 row_ror:8 row_mask:0xf bank_mask:0x3
    v_add_f32_dpp v22, v9, v9 row_ror:8 row_mask:0xf bank_mask:0xc
    v_add_f32_dpp v23, v10, v10 row_ror:8 row_mask:0xf bank_mask:0x3
    v_add_f32_dpp v23, v11, v11 row_ror:8 row_mask:0xf bank_mask:0xc
    v_dot2_f32_bf16 v8, v96, v4, 0
    v_dot2_f32_bf16 v9, v100, v4, 0
    v_dot2_f32_bf16 v10, v104, v4, 0
    v_dot2_f32_bf16 v11, v108, v4, 0
    v_add_f32_dpp v22, v22, v22 row_half_mirror row_mask:0xf bank_mask:0xf
    v_add_f32_dpp v23, v23, v23 row_half_mirror row_mask:0xf bank_mask:0xf
    v_dot2c_f32_bf16 v8, v97, v5
    v_dot2c_f32_bf16 v9, v101, v5
    v_dot2c_f32_bf16 v10, v105, v5
    v_dot2c_f32_bf16 v11, v109, v5
    v_add_f32_dpp v22, v22, v22 quad_perm:[1,0,3,2] row_mask:0xf bank_mask:0xf
    v_add_f32_dpp v23, v23, v23 quad_perm:[1,0,3,2] row_mask:0xf bank_mask:0xf
    v_dot2c_f32_bf16 v8, v98, v6
    v_dot2c_f32_bf16 v9, v102, v6
    v_dot2c_f32_bf16 v10, v106, v6
    v_dot2c_f32_bf16 v11, v110, v6
    v_add_f32_dpp v22, v22, v22 quad_perm:[2,3,0,1] row_mask:0xf bank_mask:0xf
    v_add_f32_dpp v23, v23, v23 quad_perm:[2,3,0,1] row_mask:0xf bank_mask:0xf
    v_dot2c_f32_bf16 v8, v99, v7
    v_dot2c_f32_bf16 v9, v103, v7
    s_waitcnt vmcnt(2)
    s_mov_b32 s49, 172032
    buffer_load_dwordx4 v[32:35], v1, s[40:43], s49 offen offset:0 nt
    v_dot2c_f32_bf16 v10, v107, v7
    v_dot2c_f32_bf16 v11, v111, v7
    v_add_f32_dpp v24, v8, v8 row_ror:8 row_mask:0xf bank_mask:0x3
    v_add_f32_dpp v24, v9, v9 row_ror:8 row_mask:0xf bank_mask:0xc
    v_add_f32_dpp v25, v10, v10 row_ror:8 row_mask:0xf bank_mask:0x3
    v_add_f32_dpp v25, v11, v11 row_ror:8 row_mask:0xf bank_mask:0xc
    v_dot2_f32_bf16 v8, v112, v4, 0
    v_dot2_f32_bf16 v9, v116, v4, 0
    v_dot2_f32_bf16 v10, v120, v4, 0
    v_dot2_f32_bf16 v11, v124, v4, 0
    v_add_f32_dpp v24, v24, v24 row_half_mirror row_mask:0xf bank_mask:0xf
    v_add_f32_dpp v25, v25, v25 row_half_mirror row_mask:0xf bank_mask:0xf
    v_dot2c_f32_bf16 v8, v113, v5
    v_dot2c_f32_bf16 v9, v117, v5
    v_dot2c_f32_bf16 v10, v121, v5
    v_dot2c_f32_bf16 v11, v125, v5
    v_add_f32_dpp v24, v24, v24 quad_perm:[1,0,3,2] row_mask:0xf bank_mask:0xf
    v_add_f32_dpp v25, v25, v25 quad_perm:[1,0,3,2] row_mask:0xf bank_mask:0xf
    v_dot2c_f32_bf16 v8, v114, v6
    v_dot2c_f32_bf16 v9, v118, v6
    v_dot2c_f32_bf16 v10, v122, v6
    v_dot2c_f32_bf16 v11, v126, v6
    v_add_f32_dpp v24, v24, v24 quad_perm:[2,3,0,1] row_mask:0xf bank_mask:0xf
    v_add_f32_dpp v25, v25, v25 quad_perm:[2,3,0,1] row_mask:0xf bank_mask:0xf
    v_dot2c_f32_bf16 v8, v115, v7
    v_dot2c_f32_bf16 v9, v119, v7
    v_dot2c_f32_bf16 v10, v123, v7
    v_dot2c_f32_bf16 v11, v127, v7
    v_add_f32_dpp v26, v8, v8 row_ror:8 row_mask:0xf bank_mask:0x3
    v_add_f32_dpp v26, v9, v9 row_ror:8 row_mask:0xf bank_mask:0xc
    v_add_f32_dpp v27, v10, v10 row_ror:8 row_mask:0xf bank_mask:0x3
    v_add_f32_dpp v27, v11, v11 row_ror:8 row_mask:0xf bank_mask:0xc
    v_dot2_f32_bf16 v8, v128, v4, 0
    v_dot2_f32_bf16 v9, v132, v4, 0
    v_dot2_f32_bf16 v10, v136, v4, 0
    v_dot2_f32_bf16 v11, v140, v4, 0
    s_waitcnt vmcnt(2)
    buffer_load_dwordx4 v[36:39], v1, s[40:43], s49 offen offset:1024 nt
    v_add_f32_dpp v26, v26, v26 row_half_mirror row_mask:0xf bank_mask:0xf
    v_add_f32_dpp v27, v27, v27 row_half_mirror row_mask:0xf bank_mask:0xf
    v_dot2c_f32_bf16 v8, v129, v5
    v_dot2c_f32_bf16 v9, v133, v5
    v_dot2c_f32_bf16 v10, v137, v5
    v_dot2c_f32_bf16 v11, v141, v5
    v_add_f32_dpp v26, v26, v26 quad_perm:[1,0,3,2] row_mask:0xf bank_mask:0xf
    v_add_f32_dpp v27, v27, v27 quad_perm:[1,0,3,2] row_mask:0xf bank_mask:0xf
    v_dot2c_f32_bf16 v8, v130, v6
    v_dot2c_f32_bf16 v9, v134, v6
    v_dot2c_f32_bf16 v10, v138, v6
    v_dot2c_f32_bf16 v11, v142, v6
    v_add_f32_dpp v26, v26, v26 quad_perm:[2,3,0,1] row_mask:0xf bank_mask:0xf
    v_add_f32_dpp v27, v27, v27 quad_perm:[2,3,0,1] row_mask:0xf bank_mask:0xf
    v_dot2c_f32_bf16 v8, v131, v7
    v_dot2c_f32_bf16 v9, v135, v7
    v_dot2c_f32_bf16 v10, v139, v7
    v_dot2c_f32_bf16 v11, v143, v7
    v_add_f32_dpp v28, v8, v8 row_ror:8 row_mask:0xf bank_mask:0x3
    v_add_f32_dpp v28, v9, v9 row_ror:8 row_mask:0xf bank_mask:0xc
    v_add_f32_dpp v29, v10, v10 row_ror:8 row_mask:0xf bank_mask:0x3
    v_add_f32_dpp v29, v11, v11 row_ror:8 row_mask:0xf bank_mask:0xc
    v_dot2_f32_bf16 v8, v144, v4, 0
    v_dot2_f32_bf16 v9, v148, v4, 0
    v_dot2_f32_bf16 v10, v152, v4, 0
    v_dot2_f32_bf16 v11, v156, v4, 0
    v_add_f32_dpp v28, v28, v28 row_half_mirror row_mask:0xf bank_mask:0xf
    v_add_f32_dpp v29, v29, v29 row_half_mirror row_mask:0xf bank_mask:0xf
    v_dot2c_f32_bf16 v8, v145, v5
    v_dot2c_f32_bf16 v9, v149, v5
    v_dot2c_f32_bf16 v10, v153, v5
    v_dot2c_f32_bf16 v11, v157, v5
    v_add_f32_dpp v28, v28, v28 quad_perm:[1,0,3,2] row_mask:0xf bank_mask:0xf
    v_add_f32_dpp v29, v29, v29 quad_perm:[1,0,3,2] row_mask:0xf bank_mask:0xf
    v_dot2c_f32_bf16 v8, v146, v6
    v_dot2c_f32_bf16 v9, v150, v6
    s_waitcnt vmcnt(2)
    buffer_load_dwordx4 v[40:43], v1, s[40:43], s49 offen offset:2048 nt
    v_dot2c_f32_bf16 v10, v154, v6
    v_dot2c_f32_bf16 v11, v158, v6
    v_add_f32_dpp v28, v28, v28 quad_perm:[2,3,0,1] row_mask:0xf bank_mask:0xf
    v_add_f32_dpp v29, v29, v29 quad_perm:[2,3,0,1] row_mask:0xf bank_mask:0xf
    v_dot2c_f32_bf16 v8, v147, v7
    v_dot2c_f32_bf16 v9, v151, v7
    v_dot2c_f32_bf16 v10, v155, v7
    v_dot2c_f32_bf16 v11, v159, v7
    v_add_f32_dpp v30, v8, v8 row_ror:8 row_mask:0xf bank_mask:0x3
    v_add_f32_dpp v30, v9, v9 row_ror:8 row_mask:0xf bank_mask:0xc
    v_add_f32_dpp v31, v10, v10 row_ror:8 row_mask:0xf bank_mask:0x3
    v_add_f32_dpp v31, v11, v11 row_ror:8 row_mask:0xf bank_mask:0xc
    v_add_f32_dpp v30, v30, v30 row_half_mirror row_mask:0xf bank_mask:0xf
    s_nop 0
    v_add_f32_dpp v31, v31, v31 row_half_mirror row_mask:0xf bank_mask:0xf
    v_add_f32_dpp v30, v30, v30 quad_perm:[1,0,3,2] row_mask:0xf bank_mask:0xf
    s_nop 0
    v_add_f32_dpp v31, v31, v31 quad_perm:[1,0,3,2] row_mask:0xf bank_mask:0xf
    v_add_f32_dpp v30, v30, v30 quad_perm:[2,3,0,1] row_mask:0xf bank_mask:0xf
    s_nop 0
    v_add_f32_dpp v31, v31, v31 quad_perm:[2,3,0,1] row_mask:0xf bank_mask:0xf
    v_max3_f32 v8, v12, v13, v16
    v_max3_f32 v8, v8, v17, v18
    v_max3_f32 v8, v8, v19, v20
    v_max3_f32 v8, v8, v21, v22
    v_max3_f32 v8, v8, v23, v24
    v_max3_f32 v8, v8, v25, v26
    v_max3_f32 v8, v8, v27, v28
    v_max3_f32 v8, v8, v29, v30
    v_max_f32 v8, v8, v31
    s_mov_b32 s34, 0x3e0293ee
    s_nop 0
    v_max_f32_dpp v8, v8, v8 row_ror:8 row_mask:0xf bank_mask:0xf
    v_mov_b32 v9, v8
    s_nop 1
    v_permlane16_swap_b32 v8, v9
    v_max_f32 v8, v8, v9
    v_mov_b32 v9, v8
    s_nop 1
    v_permlane32_swap_b32 v8, v9
    v_max_f32 v8, v8, v9
    v_mul_f32 v8, s34, v8
    s_waitcnt vmcnt(2)
    buffer_load_dwordx4 v[44:47], v1, s[40:43], s49 offen offset:3072 nt
    v_fma_f32 v12, v12, s34, -v8
    v_fma_f32 v13, v13, s34, -v8
    v_fma_f32 v16, v16, s34, -v8
    v_fma_f32 v17, v17, s34, -v8
    v_fma_f32 v18, v18, s34, -v8
    v_fma_f32 v19, v19, s34, -v8
    v_fma_f32 v20, v20, s34, -v8
    v_fma_f32 v21, v21, s34, -v8
    v_fma_f32 v22, v22, s34, -v8
    v_fma_f32 v23, v23, s34, -v8
    v_fma_f32 v24, v24, s34, -v8
    v_fma_f32 v25, v25, s34, -v8
    v_fma_f32 v26, v26, s34, -v8
    v_fma_f32 v27, v27, s34, -v8
    v_fma_f32 v28, v28, s34, -v8
    v_fma_f32 v29, v29, s34, -v8
    v_fma_f32 v30, v30, s34, -v8
    v_fma_f32 v31, v31, s34, -v8
    v_exp_f32 v12, v12
    v_exp_f32 v13, v13
    v_exp_f32 v16, v16
    v_exp_f32 v17, v17
    v_exp_f32 v18, v18
    v_exp_f32 v19, v19
    v_exp_f32 v20, v20
    v_exp_f32 v21, v21
    v_exp_f32 v22, v22
    v_exp_f32 v23, v23
    v_exp_f32 v24, v24
    v_exp_f32 v25, v25
    v_exp_f32 v26, v26
    v_exp_f32 v27, v27
    v_exp_f32 v28, v28
    v_exp_f32 v29, v29
    v_exp_f32 v30, v30
    v_exp_f32 v31, v31
    s_waitcnt vmcnt(2)
    s_mov_b32 s49, 200704
    buffer_load_dwordx4 v[48:51], v1, s[40:43], s49 offen offset:0 nt
    v_add_f32 v9, v12, v13
    v_add_f32 v9, v9, v16
    v_add_f32 v9, v9, v17
    v_add_f32 v9, v9, v18
    v_add_f32 v9, v9, v19
    v_add_f32 v9, v9, v20
    v_add_f32 v9, v9, v21
    v_add_f32 v9, v9, v22
    v_add_f32 v9, v9, v23
    v_add_f32 v9, v9, v24
    v_add_f32 v9, v9, v25
    v_add_f32 v9, v9, v26
    v_add_f32 v9, v9, v27
    v_add_f32 v9, v9, v28
    v_add_f32 v9, v9, v29
    v_add_f32 v9, v9, v30
    v_add_f32 v9, v9, v31
    v_and_b32 v10, 1, v0
    v_lshlrev_b32 v10, 4, v10
    v_mov_b32 v11, 0xffff
    v_lshlrev_b32 v10, v10, v11
    v_bfe_u32 v11, v0, 1, 2
    v_cmp_eq_u32 vcc, 0, v11
    s_nop 1
    v_cndmask_b32 v144, 0, v10, vcc
    v_cmp_eq_u32 vcc, 1, v11
    s_nop 1
    v_cndmask_b32 v145, 0, v10, vcc
    v_cmp_eq_u32 vcc, 2, v11
    s_nop 1
    v_cndmask_b32 v146, 0, v10, vcc
    v_cmp_eq_u32 vcc, 3, v11
    s_nop 1
    v_cndmask_b32 v147, 0, v10, vcc
    v_add_f32_dpp v9, v9, v9 row_ror:8 row_mask:0xf bank_mask:0xf
    v_mov_b32 v10, v9
    s_nop 1
    v_permlane16_swap_b32 v9, v10
    v_add_f32 v9, v9, v10
    v_mov_b32 v10, v9
    s_nop 1
    v_permlane32_swap_b32 v9, v10
    s_waitcnt vmcnt(2)
    buffer_load_dwordx4 v[52:55], v1, s[40:43], s49 offen offset:1024 nt
    v_add_f32 v9, v9, v10
    s_lshl_b32 s34, s3, 3
    s_add_u32 s34, s34, 98552
    v_mov_b32 v10, s34
    s_mov_b64 exec, 1
    ds_write_b64 v10, v[8:9]
    s_mov_b64 exec, -1
    s_lshl_b32 s34, s3, 10
    s_add_u32 s34, s34, 98304
    v_lshl_add_u32 v2, v0, 4, s34
    v_cvt_pk_bf16_f32 v10, v12, v12
    v_and_b32 v128, v10, v144
    v_and_b32 v129, v10, v145
    v_and_b32 v130, v10, v146
    v_and_b32 v131, v10, v147
    s_nop 1
    v_mfma_f32_16x16x32_bf16 v[148:151], v[160:163], v[128:131], 0
    v_mfma_f32_16x16x32_bf16 v[152:155], v[164:167], v[128:131], 0
    v_cvt_pk_bf16_f32 v10, v13, v13
    v_and_b32 v132, v10, v144
    v_and_b32 v133, v10, v145
    v_and_b32 v134, v10, v146
    v_and_b32 v135, v10, v147
    s_nop 1
    v_mfma_f32_16x16x32_bf16 v[148:151], v[168:171], v[132:135], v[148:151]
    v_mfma_f32_16x16x32_bf16 v[152:155], v[172:175], v[132:135], v[152:155]
    v_cvt_pk_bf16_f32 v10, v16, v16
    v_and_b32 v128, v10, v144
    v_and_b32 v129, v10, v145
    v_and_b32 v130, v10, v146
    v_and_b32 v131, v10, v147
    s_nop 1
    v_mfma_f32_16x16x32_bf16 v[148:151], v[176:179], v[128:131], v[148:151]
    v_mfma_f32_16x16x32_bf16 v[152:155], v[180:183], v[128:131], v[152:155]
    v_cvt_pk_bf16_f32 v10, v17, v17
    v_and_b32 v132, v10, v144
    v_and_b32 v133, v10, v145
    v_and_b32 v134, v10, v146
    v_and_b32 v135, v10, v147
    s_nop 1
    v_mfma_f32_16x16x32_bf16 v[148:151], v[184:187], v[132:135], v[148:151]
    v_mfma_f32_16x16x32_bf16 v[152:155], v[188:191], v[132:135], v[152:155]
    s_waitcnt vmcnt(2)
    buffer_load_dwordx4 v[56:59], v1, s[40:43], s49 offen offset:2048 nt
    v_cvt_pk_bf16_f32 v10, v18, v18
    v_and_b32 v128, v10, v144
    v_and_b32 v129, v10, v145
    v_and_b32 v130, v10, v146
    v_and_b32 v131, v10, v147
    s_nop 1
    v_mfma_f32_16x16x32_bf16 v[148:151], v[192:195], v[128:131], v[148:151]
    v_mfma_f32_16x16x32_bf16 v[152:155], v[196:199], v[128:131], v[152:155]
    v_cvt_pk_bf16_f32 v10, v19, v19
    v_and_b32 v132, v10, v144
    v_and_b32 v133, v10, v145
    v_and_b32 v134, v10, v146
    v_and_b32 v135, v10, v147
    s_nop 1
    v_mfma_f32_16x16x32_bf16 v[148:151], v[200:203], v[132:135], v[148:151]
    v_mfma_f32_16x16x32_bf16 v[152:155], v[204:207], v[132:135], v[152:155]
    v_cvt_pk_bf16_f32 v10, v20, v20
    v_and_b32 v128, v10, v144
    v_and_b32 v129, v10, v145
    v_and_b32 v130, v10, v146
    v_and_b32 v131, v10, v147
    s_nop 1
    v_mfma_f32_16x16x32_bf16 v[148:151], v[208:211], v[128:131], v[148:151]
    v_mfma_f32_16x16x32_bf16 v[152:155], v[212:215], v[128:131], v[152:155]
    v_cvt_pk_bf16_f32 v10, v21, v21
    v_and_b32 v132, v10, v144
    v_and_b32 v133, v10, v145
    v_and_b32 v134, v10, v146
    v_and_b32 v135, v10, v147
    s_nop 1
    v_mfma_f32_16x16x32_bf16 v[148:151], v[216:219], v[132:135], v[148:151]
    v_mfma_f32_16x16x32_bf16 v[152:155], v[220:223], v[132:135], v[152:155]
    v_cvt_pk_bf16_f32 v10, v22, v22
    v_and_b32 v128, v10, v144
    v_and_b32 v129, v10, v145
    v_and_b32 v130, v10, v146
    v_and_b32 v131, v10, v147
    s_nop 1
    v_mfma_f32_16x16x32_bf16 v[148:151], v[224:227], v[128:131], v[148:151]
    v_mfma_f32_16x16x32_bf16 v[152:155], v[228:231], v[128:131], v[152:155]
    v_cvt_pk_bf16_f32 v10, v23, v23
    s_waitcnt vmcnt(2)
    buffer_load_dwordx4 v[60:63], v1, s[40:43], s49 offen offset:3072 nt
    v_and_b32 v132, v10, v144
    v_and_b32 v133, v10, v145
    v_and_b32 v134, v10, v146
    v_and_b32 v135, v10, v147
    s_nop 1
    v_mfma_f32_16x16x32_bf16 v[148:151], v[232:235], v[132:135], v[148:151]
    v_mfma_f32_16x16x32_bf16 v[152:155], v[236:239], v[132:135], v[152:155]
    v_cvt_pk_bf16_f32 v10, v24, v24
    v_and_b32 v128, v10, v144
    v_and_b32 v129, v10, v145
    v_and_b32 v130, v10, v146
    v_and_b32 v131, v10, v147
    s_nop 1
    v_mfma_f32_16x16x32_bf16 v[148:151], v[240:243], v[128:131], v[148:151]
    v_mfma_f32_16x16x32_bf16 v[152:155], v[244:247], v[128:131], v[152:155]
    v_cvt_pk_bf16_f32 v10, v25, v25
    v_and_b32 v132, v10, v144
    v_and_b32 v133, v10, v145
    v_and_b32 v134, v10, v146
    v_and_b32 v135, v10, v147
    s_nop 1
    v_mfma_f32_16x16x32_bf16 v[148:151], v[248:251], v[132:135], v[148:151]
    v_mfma_f32_16x16x32_bf16 v[152:155], v[252:255], v[132:135], v[152:155]
    v_cvt_pk_bf16_f32 v10, v26, v26
    v_and_b32 v128, v10, v144
    v_and_b32 v129, v10, v145
    v_and_b32 v130, v10, v146
    v_and_b32 v131, v10, v147
    s_nop 1
    v_mfma_f32_16x16x32_bf16 v[148:151], v[32:35], v[128:131], v[148:151]
    v_mfma_f32_16x16x32_bf16 v[152:155], v[36:39], v[128:131], v[152:155]
    v_cvt_pk_bf16_f32 v10, v27, v27
    v_and_b32 v132, v10, v144
    v_and_b32 v133, v10, v145
    v_and_b32 v134, v10, v146
    v_and_b32 v135, v10, v147
    s_nop 1
    v_mfma_f32_16x16x32_bf16 v[148:151], v[40:43], v[132:135], v[148:151]
    v_mfma_f32_16x16x32_bf16 v[152:155], v[44:47], v[132:135], v[152:155]
    v_cvt_pk_bf16_f32 v10, v28, v28
    v_and_b32 v128, v10, v144
    s_waitcnt vmcnt(2)
    s_mov_b32 s49, 229376
    buffer_load_dwordx4 v[64:67], v1, s[40:43], s49 offen offset:0 nt
    v_and_b32 v129, v10, v145
    v_and_b32 v130, v10, v146
    v_and_b32 v131, v10, v147
    s_nop 1
    v_mfma_f32_16x16x32_bf16 v[148:151], v[48:51], v[128:131], v[148:151]
    v_mfma_f32_16x16x32_bf16 v[152:155], v[52:55], v[128:131], v[152:155]
    v_cvt_pk_bf16_f32 v10, v29, v29
    v_and_b32 v132, v10, v144
    v_and_b32 v133, v10, v145
    v_and_b32 v134, v10, v146
    v_and_b32 v135, v10, v147
    s_waitcnt vmcnt(2)
    buffer_load_dwordx4 v[68:71], v1, s[40:43], s49 offen offset:1024 nt
    s_waitcnt vmcnt(2)
    buffer_load_dwordx4 v[72:75], v1, s[40:43], s49 offen offset:2048 nt
    v_mfma_f32_16x16x32_bf16 v[148:151], v[56:59], v[132:135], v[148:151]
    v_mfma_f32_16x16x32_bf16 v[152:155], v[60:63], v[132:135], v[152:155]
    v_cvt_pk_bf16_f32 v10, v30, v30
    v_and_b32 v128, v10, v144
    v_and_b32 v129, v10, v145
    v_and_b32 v130, v10, v146
    v_and_b32 v131, v10, v147
    s_waitcnt vmcnt(2)
    buffer_load_dwordx4 v[76:79], v1, s[40:43], s49 offen offset:3072 nt
    s_barrier
    s_waitcnt vmcnt(2)
    v_mfma_f32_16x16x32_bf16 v[148:151], v[64:67], v[128:131], v[148:151]
    v_mfma_f32_16x16x32_bf16 v[152:155], v[68:71], v[128:131], v[152:155]
    v_cvt_pk_bf16_f32 v10, v31, v31
    v_and_b32 v132, v10, v144
    v_and_b32 v133, v10, v145
    v_and_b32 v134, v10, v146
    v_and_b32 v135, v10, v147
    s_waitcnt vmcnt(0)
    s_nop 0
    v_mfma_f32_16x16x32_bf16 v[148:151], v[72:75], v[132:135], v[148:151]
    v_mfma_f32_16x16x32_bf16 v[152:155], v[76:79], v[132:135], v[152:155]
    s_nop 7
    v_mov_b32_dpp v148, v152 quad_perm:[0,1,2,3] row_mask:0xf bank_mask:0xc
    v_mov_b32_dpp v149, v153 quad_perm:[0,1,2,3] row_mask:0xf bank_mask:0xc
    v_mov_b32_dpp v150, v154 quad_perm:[0,1,2,3] row_mask:0xf bank_mask:0xc
    v_mov_b32_dpp v151, v155 quad_perm:[0,1,2,3] row_mask:0xf bank_mask:0xc
    ds_write_b128 v2, v[148:151]
    s_waitcnt lgkmcnt(0)
    s_barrier
    v_and_b32 v200, 3, v0
    v_bfe_u32 v201, v0, 2, 2
    v_lshrrev_b32 v202, 4, v0
    s_lshl_b32 s34, s3, 10
    s_add_u32 s34, s34, 122112
    v_lshl_add_u32 v203, v0, 4, s34
    s_movk_i32 s48, 5120
    s_cmp_eq_u32 s63, 0
    s_cbranch_scc1 L_t_wo
    s_cmp_eq_u32 s63, 2
    s_cbranch_scc1 L_t_w2
    s_cmp_eq_u32 s63, 3
    s_cbranch_scc1 L_fin
    v_and_b32 v205, 15, v0
    v_lshlrev_b32 v205, 4, v205
    s_and_b32 s49, s3, 3
    s_mul_i32 s34, s49, 1280
    s_add_u32 s34, s34, 1053696
    v_lshl_add_u32 v206, v202, 17, v205
    v_add_u32 v206, s34, v206
    s_mul_i32 s34, s49, 3840
    v_add_u32 v205, s34, v205
    s_barrier
L_r_w1:
    s_cmp_lt_u32 s3, 4
    s_cbranch_scc1 L_w1_ln
    s_and_b32 s49, s3, 3
    s_lshl_b32 s42, s49, 11
    s_add_u32 s42, s42, 40960
    s_bitcmp1_b32 s62, 0
    s_cbranch_scc1 L_rot1
    s_add_u32 m0, s42, 0
    s_add_u32 s34, s50, 0
    buffer_load_dwordx4 v15, s[52:55], s34 offen  lds
    s_add_u32 m0, s42, 1024
    s_add_u32 s34, s50, 884736
    buffer_load_dwordx4 v15, s[52:55], s34 offen  lds
    s_add_u32 m0, s42, 8192
    s_add_u32 s34, s50, 110592
    buffer_load_dwordx4 v15, s[52:55], s34 offen  lds
    s_add_u32 m0, s42, 9216
    s_add_u32 s34, s50, 995328
    buffer_load_dwordx4 v15, s[52:55], s34 offen  lds
    s_add_u32 m0, s42, 32768
    s_add_u32 s34, s51, 0
    buffer_load_dwordx4 v15, s[52:55], s34 offen  lds
    s_add_u32 m0, s42, 33792
    s_add_u32 s34, s51, 13824
    buffer_load_dwordx4 v15, s[52:55], s34 offen  lds
    s_add_u32 m0, s42, 16384
    s_add_u32 s34, s50, 221184
    buffer_load_dwordx4 v15, s[52:55], s34 offen  lds
    s_add_u32 m0, s42, 17408
    s_add_u32 s34, s50, 1105920
    buffer_load_dwordx4 v15, s[52:55], s34 offen  lds
    s_add_u32 m0, s42, 24576
    s_add_u32 s34, s50, 331776
    buffer_load_dwordx4 v15, s[52:55], s34 offen  lds
    s_add_u32 m0, s42, 25600
    s_add_u32 s34, s50, 1216512
    buffer_load_dwordx4 v15, s[52:55], s34 offen  lds
    s_branch L_rot2
L_rot1:
    s_add_u32 m0, s42, 16384
    s_add_u32 s34, s50, 221184
    buffer_load_dwordx4 v15, s[52:55], s34 offen  lds
    s_add_u32 m0, s42, 17408
    s_add_u32 s34, s50, 1105920
    buffer_load_dwordx4 v15, s[52:55], s34 offen  lds
    s_add_u32 m0, s42, 24576
    s_add_u32 s34, s50, 331776
    buffer_load_dwordx4 v15, s[52:55], s34 offen  lds
    s_add_u32 m0, s42, 25600
    s_add_u32 s34, s50, 1216512
    buffer_load_dwordx4 v15, s[52:55], s34 offen  lds
    s_add_u32 m0, s42, 32768
    s_add_u32 s34, s51, 0
    buffer_load_dwordx4 v15, s[52:55], s34 offen  lds
    s_add_u32 m0, s42, 33792
    s_add_u32 s34, s51, 13824
    buffer_load_dwordx4 v15, s[52:55], s34 offen  lds
    s_add_u32 m0, s42, 0
    s_add_u32 s34, s50, 0
    buffer_load_dwordx4 v15, s[52:55], s34 offen  lds
    s_add_u32 m0, s42, 1024
    s_add_u32 s34, s50, 884736
    buffer_load_dwordx4 v15, s[52:55], s34 offen  lds
    s_add_u32 m0, s42, 8192
    s_add_u32 s34, s50, 110592
    buffer_load_dwordx4 v15, s[52:55], s34 offen  lds
    s_add_u32 m0, s42, 9216
    s_add_u32 s34, s50, 995328
    buffer_load_dwordx4 v15, s[52:55], s34 offen  lds
L_rot2:
    v_lshrrev_b32 v3, 2, v0
    v_lshlrev_b32 v3, 6, v3
    v_lshl_add_u32 v3, v200, 3, v3
    v_add_u32 v3, s42, v3
    s_lshl_b32 s35, s49, 6
    s_add_u32 s35, s35, 116736
    v_mul_u32_u24 v4, 1344, v200
    v_lshl_add_u32 v4, v202, 4, v4
    v_add_u32 v4, s35, v4
    s_lshl_b32 s35, s49, 11
    s_add_u32 s35, s35, 122112
    v_lshl_add_u32 v5, v0, 4, s35
    s_waitcnt vmcnt(0)
    s_barrier
    ds_read_b64_tr_b16 v[32:33], v3 offset:0
    ds_read_b64_tr_b16 v[34:35], v3 offset:1024
    ds_read_b64_tr_b16 v[36:37], v3 offset:32
    ds_read_b64_tr_b16 v[38:39], v3 offset:1056
    ds_read_b64_tr_b16 v[40:41], v3 offset:8192
    ds_read_b64_tr_b16 v[42:43], v3 offset:9216
    ds_read_b64_tr_b16 v[44:45], v3 offset:8224
    ds_read_b64_tr_b16 v[46:47], v3 offset:9248
    ds_read_b64_tr_b16 v[48:49], v3 offset:16384
    ds_read_b64_tr_b16 v[50:51], v3 offset:17408
    ds_read_b64_tr_b16 v[52:53], v3 offset:16416
    ds_read_b64_tr_b16 v[54:55], v3 offset:17440
    s_waitcnt lgkmcnt(4)
    ds_read_b64_tr_b16 v[56:57], v3 offset:24576
    ds_read_b64_tr_b16 v[58:59], v3 offset:25600
    ds_read_b64_tr_b16 v[60:61], v3 offset:24608
    ds_read_b64_tr_b16 v[62:63], v3 offset:25632
    ds_read_b64_tr_b16 v[64:65], v3 offset:32768
    ds_read_b64_tr_b16 v[66:67], v3 offset:33792
    ds_read_b64_tr_b16 v[68:69], v3 offset:32800
    ds_read_b64_tr_b16 v[70:71], v3 offset:33824
    s_waitcnt lgkmcnt(0)
    s_barrier
    ds_read_b128 v[140:143], v4 offset:0
    ds_read_b128 v[144:147], v4 offset:256
    ds_read_b128 v[148:151], v4 offset:512
    ds_read_b128 v[152:155], v4 offset:768
    ds_read_b128 v[156:159], v4 offset:1024
    s_waitcnt lgkmcnt(4)
    v_mfma_f32_16x16x32_bf16 v[20:23], v[32:35], v[140:143], 0
    v_mfma_f32_16x16x32_bf16 v[24:27], v[36:39], v[140:143], 0
    s_waitcnt lgkmcnt(3)
    v_mfma_f32_16x16x32_bf16 v[20:23], v[40:43], v[144:147], v[20:23]
    v_mfma_f32_16x16x32_bf16 v[24:27], v[44:47], v[144:147], v[24:27]
    s_waitcnt lgkmcnt(2)
    v_mfma_f32_16x16x32_bf16 v[20:23], v[48:51], v[148:151], v[20:23]
    v_mfma_f32_16x16x32_bf16 v[24:27], v[52:55], v[148:151], v[24:27]
    s_waitcnt lgkmcnt(1)
    v_mfma_f32_16x16x32_bf16 v[20:23], v[56:59], v[152:155], v[20:23]
    v_mfma_f32_16x16x32_bf16 v[24:27], v[60:63], v[152:155], v[24:27]
    s_waitcnt lgkmcnt(0)
    v_mfma_f32_16x16x32_bf16 v[20:23], v[64:67], v[156:159], v[20:23]
    v_mfma_f32_16x16x32_bf16 v[24:27], v[68:71], v[156:159], v[24:27]
    s_nop 6
    ds_write_b128 v5, v[20:23]
    ds_write_b128 v5, v[24:27] offset:1024
    s_waitcnt lgkmcnt(0)
    s_barrier
    s_branch L_fin
L_w1_ln:
    ds_read_b128 v[140:143], v205 offset:0
    ds_read_b128 v[144:147], v205 offset:256
    ds_read_b128 v[148:151], v205 offset:512
    ds_read_b128 v[152:155], v205 offset:768
    ds_read_b128 v[156:159], v205 offset:1024
    ds_read_b128 v[160:163], v205 offset:1280
    ds_read_b128 v[164:167], v205 offset:1536
    ds_read_b128 v[168:171], v205 offset:1792
    ds_read_b128 v[172:175], v205 offset:2048
    ds_read_b128 v[176:179], v205 offset:2304
    ds_read_b128 v[180:183], v205 offset:2560
    ds_read_b128 v[184:187], v205 offset:2816
    ds_read_b128 v[188:191], v205 offset:3072
    ds_read_b128 v[192:195], v205 offset:3328
    ds_read_b128 v[196:199], v205 offset:3584
    v_and_b32 v8, 1, v0
    v_lshlrev_b32 v8, 4, v8
    v_mov_b32 v9, 0xffff
    v_lshlrev_b32 v8, v8, v9
    v_bfe_u32 v9, v0, 1, 2
    v_cmp_eq_u32 vcc, 0, v9
    s_nop 1
    v_cndmask_b32 v16, 0, v8, vcc
    v_cmp_eq_u32 vcc, 1, v9
    s_nop 1
    v_cndmask_b32 v17, 0, v8, vcc
    v_cmp_eq_u32 vcc, 2, v9
    s_nop 1
    v_cndmask_b32 v18, 0, v8, vcc
    v_cmp_eq_u32 vcc, 3, v9
    s_nop 1
    v_cndmask_b32 v19, 0, v8, vcc
    v_bfe_u32 v8, v0, 3, 1
    v_cmp_eq_u32 vcc, 0, v8
    s_nop 1
    v_cndmask_b32 v20, 0, v16, vcc
    v_xor_b32 v24, v20, v16
    v_cndmask_b32 v21, 0, v17, vcc
    v_xor_b32 v25, v21, v17
    v_cndmask_b32 v22, 0, v18, vcc
    v_xor_b32 v26, v22, v18
    v_cndmask_b32 v23, 0, v19, vcc
    v_xor_b32 v27, v23, v19
    v_and_b32 v52, 0x3f803f80, v20
    v_and_b32 v60, 0x3e803e80, v20
    v_and_b32 v53, 0x3f803f80, v21
    v_and_b32 v61, 0x3e803e80, v21
    v_and_b32 v54, 0x3f803f80, v22
    v_and_b32 v62, 0x3e803e80, v22
    v_and_b32 v55, 0x3f803f80, v23
    v_and_b32 v63, 0x3e803e80, v23
    v_and_b32 v56, 0x3f803f80, v24
    v_and_b32 v64, 0x3e803e80, v24
    v_and_b32 v57, 0x3f803f80, v25
    v_and_b32 v65, 0x3e803e80, v25
    v_and_b32 v58, 0x3f803f80, v26
    v_and_b32 v66, 0x3e803e80, v26
    v_and_b32 v59, 0x3f803f80, v27
    v_and_b32 v67, 0x3e803e80, v27
    s_waitcnt lgkmcnt(0)
    v_mfma_f32_16x16x32_bf16 v[68:71], v[140:143], v[60:63], 0
    v_mfma_f32_16x16x32_bf16 v[68:71], v[144:147], v[64:67], v[68:71]
    v_mfma_f32_16x16x32_bf16 v[72:75], v[148:151], v[60:63], 0
    v_mfma_f32_16x16x32_bf16 v[72:75], v[152:155], v[64:67], v[72:75]
    v_mfma_f32_16x16x32_bf16 v[76:79], v[156:159], v[60:63], 0
    v_mfma_f32_16x16x32_bf16 v[116:119], v[160:163], v[60:63], 0
    v_mfma_f32_16x16x32_bf16 v[116:119], v[164:167], v[64:67], v[116:119]
    v_mfma_f32_16x16x32_bf16 v[120:123], v[168:171], v[60:63], 0
    v_mfma_f32_16x16x32_bf16 v[120:123], v[172:175], v[64:67], v[120:123]
    v_mfma_f32_16x16x32_bf16 v[124:127], v[176:179], v[60:63], 0
    v_mfma_f32_16x16x32_bf16 v[80:83], v[180:183], v[60:63], 1.0
    v_mfma_f32_16x16x32_bf16 v[80:83], v[184:187], v[64:67], v[80:83]
    v_mfma_f32_16x16x32_bf16 v[84:87], v[188:191], v[60:63], 1.0
    v_mfma_f32_16x16x32_bf16 v[84:87], v[192:195], v[64:67], v[84:87]
    v_mfma_f32_16x16x32_bf16 v[88:91], v[196:199], v[60:63], 1.0
    s_mul_i32 s34, s3, 1344
    s_add_u32 s34, s34, 116736
    v_lshl_add_u32 v7, v0, 4, s34
    v_lshlrev_b32 v8, 6, v202
    v_lshl_add_u32 v8, v200, 4, v8
    v_and_b32 v9, 1, v201
    v_lshl_add_u32 v8, v9, 3, v8
    v_add_u32 v8, s34, v8
    v_lshrrev_b32 v9, 5, v0
    v_lshlrev_b32 v9, 10, v9
    v_and_b32 v6, 1, v202
    v_lshl_add_u32 v9, v6, 9, v9
    v_bfe_u32 v6, v0, 1, 1
    v_lshl_add_u32 v9, v6, 8, v9
    v_lshl_add_u32 v9, v201, 4, v9
    v_and_b32 v6, 1, v0
    v_lshl_add_u32 v9, v6, 3, v9
    v_add_u32 v9, 122112, v9
    s_lshr_b32 s34, s62, 2
    s_lshl_b32 s34, s34, 8
    s_and_b32 s49, s62, 3
    s_lshl_b32 s49, s49, 17
    s_add_u32 s34, s34, s49
    s_add_u32 s34, s34, 1063936
    v_lshl_add_u32 v5, v0, 2, s34
    s_barrier
    s_mov_b32 s35, 0
    s_mov_b64 s[40:41], -1
    s_mov_b64 s[42:43], -1
L_pb:
    s_mov_b64 exec, s[40:41]
    s_cbranch_execz L_pbs0
    buffer_load_dwordx4 v[140:143], v206, s[44:47], 0 offen offset:0 sc1
    buffer_load_dwordx4 v[148:151], v206, s[44:47], 0 offen offset:256 sc1
    buffer_load_dwordx4 v[156:159], v206, s[44:47], 0 offen offset:512 sc1
    buffer_load_dwordx4 v[164:167], v206, s[44:47], 0 offen offset:768 sc1
    buffer_load_dwordx4 v[172:175], v206, s[44:47], 0 offen offset:1024 sc1
L_pbs0:
    s_mov_b64 exec, s[42:43]
    s_cbranch_execz L_pbs1
    buffer_load_dwordx4 v[144:147], v206, s[44:47], s48 offen offset:0 sc1
    buffer_load_dwordx4 v[152:155], v206, s[44:47], s48 offen offset:256 sc1
    buffer_load_dwordx4 v[160:163], v206, s[44:47], s48 offen offset:512 sc1
    buffer_load_dwordx4 v[168:171], v206, s[44:47], s48 offen offset:768 sc1
    buffer_load_dwordx4 v[176:179], v206, s[44:47], s48 offen offset:1024 sc1
L_pbs1:
    s_mov_b64 exec, -1
    s_add_u32 s35, s35, 1
    s_waitcnt vmcnt(0)
    v_max3_u32 v28, v140, v141, v142
    v_max3_u32 v29, v144, v145, v146
    v_max3_u32 v28, v28, v143, v148
    v_max3_u32 v29, v29, v147, v152
    v_max3_u32 v28, v28, v149, v150
    v_max3_u32 v29, v29, v153, v154
    v_max3_u32 v28, v28, v151, v156
    v_max3_u32 v29, v29, v155, v160
    v_max3_u32 v28, v28, v157, v158
    v_max3_u32 v29, v29, v161, v162
    v_max3_u32 v28, v28, v159, v164
    v_max3_u32 v29, v29, v163, v168
    v_max3_u32 v28, v28, v165, v166
    v_max3_u32 v29, v29, v169, v170
    v_max3_u32 v28, v28, v167, v172
    v_max3_u32 v29, v29, v171, v176
    v_max3_u32 v28, v28, v173, v174
    v_max3_u32 v29, v29, v177, v178
    v_max_u32 v28, v28, v175
    v_max_u32 v29, v29, v179
    v_cmp_eq_u32 s[40:41], -1, v28
    v_cmp_eq_u32 s[42:43], -1, v29
    v_mfma_f32_16x16x32_bf16 v[128:131], v[140:143], v[52:55], v[68:71]
    s_or_b64 vcc, s[40:41], s[42:43]
    s_cbranch_scc0 L_pbd
    s_cmp_lt_u32 s35, 60000
    s_cbranch_scc1 L_pb
L_pbd:
    v_mfma_f32_16x16x32_bf16 v[128:131], v[144:147], v[52:55], v[128:131]
    v_mfma_f32_16x16x32_bf16 v[128:131], v[148:151], v[56:59], v[128:131]
    v_mfma_f32_16x16x32_bf16 v[128:131], v[152:155], v[56:59], v[128:131]
    v_mfma_f32_16x16x32_bf16 v[132:135], v[156:159], v[52:55], v[72:75]
    v_mfma_f32_16x16x32_bf16 v[132:135], v[160:163], v[52:55], v[132:135]
    v_mfma_f32_16x16x32_bf16 v[132:135], v[164:167], v[56:59], v[132:135]
    v_mfma_f32_16x16x32_bf16 v[132:135], v[168:171], v[56:59], v[132:135]
    v_mfma_f32_16x16x32_bf16 v[136:139], v[172:175], v[52:55], v[76:79]
    v_mfma_f32_16x16x32_bf16 v[136:139], v[176:179], v[52:55], v[136:139]
    s_nop 1
    v_pk_add_f32 v[20:21], v[128:129], v[130:131]
    v_pk_mul_f32 v[22:23], v[128:129], v[128:129]
    v_pk_fma_f32 v[22:23], v[130:131], v[130:131], v[22:23]
    s_nop 0
    v_pk_add_f32 v[20:21], v[20:21], v[132:133]
    v_pk_fma_f32 v[22:23], v[132:133], v[132:133], v[22:23]
    v_pk_add_f32 v[20:21], v[20:21], v[134:135]
    v_pk_fma_f32 v[22:23], v[134:135], v[134:135], v[22:23]
    v_pk_add_f32 v[20:21], v[20:21], v[136:137]
    v_pk_fma_f32 v[22:23], v[136:137], v[136:137], v[22:23]
    v_pk_add_f32 v[20:21], v[20:21], v[138:139]
    v_pk_fma_f32 v[22:23], v[138:139], v[138:139], v[22:23]
    v_add_f32 v20, v20, v21
    v_add_f32 v21, v22, v23
    s_nop 0
    v_add_f32_dpp v20, v20, v20 row_ror:8 row_mask:0xf bank_mask:0xf
    v_add_f32_dpp v21, v21, v21 row_ror:8 row_mask:0xf bank_mask:0xf
    s_nop 0
    v_add_f32_dpp v20, v20, v20 row_ror:4 row_mask:0xf bank_mask:0xf
    v_add_f32_dpp v21, v21, v21 row_ror:4 row_mask:0xf bank_mask:0xf
    s_nop 0
    v_add_f32_dpp v20, v20, v20 row_ror:2 row_mask:0xf bank_mask:0xf
    v_add_f32_dpp v21, v21, v21 row_ror:2 row_mask:0xf bank_mask:0xf
    s_nop 0
    v_add_f32_dpp v20, v20, v20 row_ror:1 row_mask:0xf bank_mask:0xf
    v_add_f32_dpp v21, v21, v21 row_ror:1 row_mask:0xf bank_mask:0xf
    v_mov_b32 v22, v20
    v_mov_b32 v23, v21
    s_nop 0
    v_permlane16_swap_b32 v20, v22
    v_permlane16_swap_b32 v21, v23
    v_add_f32 v20, v20, v22
    v_add_f32 v21, v21, v23
    v_mov_b32 v22, v20
    v_mov_b32 v23, v21
    s_nop 0
    v_permlane32_swap_b32 v20, v22
    v_permlane32_swap_b32 v21, v23
    v_add_f32 v20, v20, v22
    v_add_f32 v21, v21, v23
    v_mul_f32 v22, 0x3acccccd, v20
    v_mul_f32 v21, 0x3acccccd, v21
    v_fma_f32 v21, -v22, v22, v21
    v_max_f32 v21, 0, v21
    v_add_f32 v21, 0x3727c5ac, v21
    v_rsq_f32 v20, v21
    s_nop 0
    v_mul_f32_e64 v21, -v22, v20
    v_pk_fma_f32 v[128:129], v[128:129], v[20:21], v[20:21] op_sel:[0,0,1] op_sel_hi:[1,0,1]
    v_pk_fma_f32 v[130:131], v[130:131], v[20:21], v[20:21] op_sel:[0,0,1] op_sel_hi:[1,0,1]
    v_pk_fma_f32 v[132:133], v[132:133], v[20:21], v[20:21] op_sel:[0,0,1] op_sel_hi:[1,0,1]
    v_pk_fma_f32 v[134:135], v[134:135], v[20:21], v[20:21] op_sel:[0,0,1] op_sel_hi:[1,0,1]
    v_pk_fma_f32 v[136:137], v[136:137], v[20:21], v[20:21] op_sel:[0,0,1] op_sel_hi:[1,0,1]
    v_pk_fma_f32 v[138:139], v[138:139], v[20:21], v[20:21] op_sel:[0,0,1] op_sel_hi:[1,0,1]
    v_pk_fma_f32 v[128:129], v[128:129], v[80:81], v[116:117]
    v_pk_fma_f32 v[130:131], v[130:131], v[82:83], v[118:119]
    v_pk_fma_f32 v[132:133], v[132:133], v[84:85], v[120:121]
    v_pk_fma_f32 v[134:135], v[134:135], v[86:87], v[122:123]
    v_pk_fma_f32 v[136:137], v[136:137], v[88:89], v[124:125]
    v_pk_fma_f32 v[138:139], v[138:139], v[90:91], v[126:127]
    v_cvt_pk_bf16_f32 v20, v128, v129
    v_cvt_pk_bf16_f32 v21, v130, v131
    v_cvt_pk_bf16_f32 v22, v132, v133
    v_cvt_pk_bf16_f32 v23, v134, v135
    v_cvt_pk_bf16_f32 v24, v136, v137
    v_cvt_pk_bf16_f32 v25, v138, v139
    ds_write_b128 v7, v[20:23]
    s_mov_b32 exec_lo, 0x00ff00ff
    s_mov_b32 exec_hi, 0x00ff00ff
    ds_write_b64 v8, v[24:25] offset:1024
    s_mov_b64 exec, -1
    s_waitcnt lgkmcnt(0)
    s_barrier
    s_barrier
    s_cmp_lg_u32 s3, 0
    s_cbranch_scc1 L_fin
    ds_read_b64 v[20:21], v9 offset:0
    ds_read_b64 v[22:23], v9 offset:2048
    ds_read_b64 v[24:25], v9 offset:4096
    ds_read_b64 v[26:27], v9 offset:6144
    s_mov_b32 s34, 0xbdd2d3e8
    v_mov_b32 v10, 0xc0135761
    s_waitcnt lgkmcnt(3)
    v_pk_add_f32 v[100:101], v[100:101], v[20:21]
    s_waitcnt lgkmcnt(2)
    v_pk_add_f32 v[100:101], v[100:101], v[22:23]
    s_waitcnt lgkmcnt(1)
    v_pk_add_f32 v[100:101], v[100:101], v[24:25]
    s_waitcnt lgkmcnt(0)
    v_pk_add_f32 v[100:101], v[100:101], v[26:27]
    v_pk_mul_f32 v[20:21], v[100:101], v[100:101]
    v_fma_f32 v20, v20, s34, v10
    v_fma_f32 v21, v21, s34, v10
    v_pk_mul_f32 v[20:21], v[20:21], v[100:101]
    v_exp_f32 v20, v20
    v_exp_f32 v21, v21
    v_add_f32 v20, 1.0, v20
    v_add_f32 v21, 1.0, v21
    v_rcp_f32 v20, v20
    v_rcp_f32 v21, v21
    s_nop 0
    v_pk_mul_f32 v[20:21], v[20:21], v[100:101]
    v_cvt_pk_bf16_f32 v20, v20, v21
    v_min_u32 v20, -2, v20
    buffer_store_dword v20, v5, s[44:47], 0 offen sc1
    s_branch L_fin
L_t_w2:
    v_bfe_u32 v205, v0, 3, 2
    v_lshlrev_b32 v204, 3, v205
    v_lshrrev_b32 v205, 5, v0
    v_lshl_add_u32 v204, v205, 2, v204
    v_bfe_u32 v205, v0, 1, 2
    v_add_u32 v204, v204, v205
    v_and_b32 v205, 1, v0
    s_sub_u32 s49, s3, 1
    v_mul_u32_u24 v204, 1280, v204
    v_lshl_add_u32 v204, v205, 4, v204
    s_lshl_b32 s34, s62, 5
    s_mul_i32 s35, s49, 327680
    s_add_u32 s34, s34, s35
    v_add_u32 v204, s34, v204
    s_lshl_b32 s50, s49, 13
    s_add_u32 s50, s50, 40960
    v_lshl_add_u32 v205, v0, 3, s50
    s_lshl_b32 s40, s62, 1
    s_add_u32 s41, s40, 8
    s_add_u32 s42, s40, 2
    s_barrier
L_w2_dma:
    s_and_b32 s34, s40, 7
    s_lshl_b32 s35, s34, 10
    s_add_u32 m0, s50, s35
    s_mul_i32 s34, s34, 40960
    buffer_load_dwordx4 v204, s[52:55], s34 offen  lds
    s_add_u32 s40, s40, 1
    s_cmp_lg_u32 s40, s42
    s_cbranch_scc1 L_w2_nw
    s_waitcnt vmcnt(0)
L_w2_nw:
    s_cmp_lt_u32 s40, s41
    s_cbranch_scc1 L_w2_dma
    s_lshl_b32 s34, s49, 9
    s_add_u32 s34, s34, 1063936
    s_cmp_eq_u32 s49, 6
    s_cselect_b32 s35, 1, 3
    v_lshlrev_b32 v6, 6, v202
    v_lshl_add_u32 v6, v200, 4, v6
    v_add_u32 v6, s34, v6
    v_lshl_add_u32 v4, v201, 17, v6
    v_min_u32 v5, s35, v201
    v_lshl_add_u32 v5, v5, 17, v6
    s_waitcnt vmcnt(0)
    ds_read_b64_tr_b16 v[32:33], v205 offset:0
    ds_read_b64_tr_b16 v[34:35], v205 offset:512
    ds_read_b64_tr_b16 v[36:37], v205 offset:1024
    ds_read_b64_tr_b16 v[38:39], v205 offset:1536
    ds_read_b64_tr_b16 v[40:41], v205 offset:2048
    ds_read_b64_tr_b16 v[42:43], v205 offset:2560
    ds_read_b64_tr_b16 v[44:45], v205 offset:3072
    ds_read_b64_tr_b16 v[46:47], v205 offset:3584
    s_waitcnt lgkmcnt(0)
    ds_read_b64_tr_b16 v[48:49], v205 offset:4096
    ds_read_b64_tr_b16 v[50:51], v205 offset:4608
    ds_read_b64_tr_b16 v[52:53], v205 offset:5120
    ds_read_b64_tr_b16 v[54:55], v205 offset:5632
    ds_read_b64_tr_b16 v[56:57], v205 offset:6144
    ds_read_b64_tr_b16 v[58:59], v205 offset:6656
    ds_read_b64_tr_b16 v[60:61], v205 offset:7168
    ds_read_b64_tr_b16 v[62:63], v205 offset:7680
    s_waitcnt lgkmcnt(0)
    s_barrier
    s_sleep 1
    s_mov_b32 s35, 0
L_poll53:
    buffer_load_dwordx4 v[64:67], v4, s[44:47], 0 offen sc1
    buffer_load_dwordx4 v[68:71], v5, s[44:47], 0 offen offset:256 sc1
    s_add_u32 s35, s35, 1
    s_waitcnt vmcnt(0)
    v_max3_u32 v28, v64, v65, v66
    v_max3_u32 v28, v28, v67, v68
    v_max3_u32 v28, v28, v69, v70
    v_max_u32 v28, v28, v71
    v_cmp_eq_u32 vcc, -1, v28
    s_cbranch_vccz L_done54
    s_cmp_lt_u32 s35, 60000
    s_cbranch_scc1 L_poll53
L_done54:
    v_mfma_f32_16x16x32_bf16 v[80:83], v[32:35], v[64:67], 0
    v_mfma_f32_16x16x32_bf16 v[84:87], v[36:39], v[64:67], 0
    v_mfma_f32_16x16x32_bf16 v[88:91], v[40:43], v[64:67], 0
    v_mfma_f32_16x16x32_bf16 v[92:95], v[44:47], v[64:67], 0
    v_mfma_f32_16x16x32_bf16 v[80:83], v[48:51], v[68:71], v[80:83]
    v_mfma_f32_16x16x32_bf16 v[84:87], v[52:55], v[68:71], v[84:87]
    v_mfma_f32_16x16x32_bf16 v[88:91], v[56:59], v[68:71], v[88:91]
    v_mfma_f32_16x16x32_bf16 v[92:95], v[60:63], v[68:71], v[92:95]
    s_nop 5
    v_mov_b32_dpp v80, v84 quad_perm:[0,1,2,3] row_mask:0xf bank_mask:0x2
    v_mov_b32_dpp v81, v85 quad_perm:[0,1,2,3] row_mask:0xf bank_mask:0x2
    v_mov_b32_dpp v82, v86 quad_perm:[0,1,2,3] row_mask:0xf bank_mask:0x2
    v_mov_b32_dpp v83, v87 quad_perm:[0,1,2,3] row_mask:0xf bank_mask:0x2
    v_mov_b32_dpp v80, v88 quad_perm:[0,1,2,3] row_mask:0xf bank_mask:0x4
    v_mov_b32_dpp v81, v89 quad_perm:[0,1,2,3] row_mask:0xf bank_mask:0x4
    v_mov_b32_dpp v82, v90 quad_perm:[0,1,2,3] row_mask:0xf bank_mask:0x4
    v_mov_b32_dpp v83, v91 quad_perm:[0,1,2,3] row_mask:0xf bank_mask:0x4
    v_mov_b32_dpp v80, v92 quad_perm:[0,1,2,3] row_mask:0xf bank_mask:0x8
    v_mov_b32_dpp v81, v93 quad_perm:[0,1,2,3] row_mask:0xf bank_mask:0x8
    v_mov_b32_dpp v82, v94 quad_perm:[0,1,2,3] row_mask:0xf bank_mask:0x8
    v_mov_b32_dpp v83, v95 quad_perm:[0,1,2,3] row_mask:0xf bank_mask:0x8
    ds_write_b128 v203, v[80:83]
    s_waitcnt lgkmcnt(0)
    s_barrier
    s_branch L_fin
L_w2_red:
    s_mov_b32 s35, 0
L_poll56:
    buffer_load_dwordx2 v[20:21], v204, s[44:47], 0 offen sc1
    buffer_load_dwordx2 v[22:23], v204, s[44:47], s48 offen sc1
    s_add_u32 s35, s35, 1
    s_waitcnt vmcnt(0)
    v_max3_u32 v28, v20, v21, v22
    v_max_u32 v28, v28, v23
    v_cmp_eq_u32 vcc, -1, v28
    s_cbranch_vccz L_done57
    s_sleep 12
    s_cmp_lt_u32 s35, 60000
    s_cbranch_scc1 L_poll56
L_done57:
    s_barrier
    v_lshlrev_b32 v44, 16, v20
    v_and_b32 v45, 0xffff0000, v20
    v_lshlrev_b32 v46, 16, v21
    v_and_b32 v47, 0xffff0000, v21
    v_lshlrev_b32 v48, 16, v22
    v_and_b32 v49, 0xffff0000, v22
    v_lshlrev_b32 v50, 16, v23
    v_and_b32 v51, 0xffff0000, v23
    v_add_f32 v108, v108, v44
    v_add_f32 v109, v109, v45
    v_add_f32 v110, v110, v46
    v_add_f32 v111, v111, v47
    v_add_f32 v108, v108, v48
    v_add_f32 v109, v109, v49
    v_add_f32 v110, v110, v50
    v_add_f32 v111, v111, v51
    s_barrier
    ds_read_b128 v[64:67], v203 offset:1024
    ds_read_b128 v[68:71], v203 offset:2048
    ds_read_b128 v[72:75], v203 offset:3072
    ds_read_b128 v[76:79], v203 offset:4096
    ds_read_b128 v[80:83], v203 offset:5120
    ds_read_b128 v[84:87], v203 offset:6144
    ds_read_b128 v[88:91], v203 offset:7168
    s_waitcnt lgkmcnt(5)
    v_pk_add_f32 v[64:65], v[64:65], v[68:69]
    v_pk_add_f32 v[66:67], v[66:67], v[70:71]
    s_waitcnt lgkmcnt(4)
    v_pk_add_f32 v[64:65], v[64:65], v[72:73]
    v_pk_add_f32 v[66:67], v[66:67], v[74:75]
    s_waitcnt lgkmcnt(3)
    v_pk_add_f32 v[64:65], v[64:65], v[76:77]
    v_pk_add_f32 v[66:67], v[66:67], v[78:79]
    s_waitcnt lgkmcnt(2)
    v_pk_add_f32 v[64:65], v[64:65], v[80:81]
    v_pk_add_f32 v[66:67], v[66:67], v[82:83]
    s_waitcnt lgkmcnt(1)
    v_pk_add_f32 v[64:65], v[64:65], v[84:85]
    v_pk_add_f32 v[66:67], v[66:67], v[86:87]
    s_waitcnt lgkmcnt(0)
    v_pk_add_f32 v[64:65], v[64:65], v[88:89]
    v_pk_add_f32 v[66:67], v[66:67], v[90:91]
    v_pk_fma_f32 v[64:65], v[64:65], v[104:105], v[108:109]
    v_pk_fma_f32 v[66:67], v[66:67], v[106:107], v[110:111]
    s_nop 0
    v_add_f32_dpp v64, v64, v64 row_ror:4 row_mask:0xf bank_mask:0xf
    v_add_f32_dpp v65, v65, v65 row_ror:4 row_mask:0xf bank_mask:0xf
    v_add_f32_dpp v66, v66, v66 row_ror:4 row_mask:0xf bank_mask:0xf
    v_add_f32_dpp v67, v67, v67 row_ror:4 row_mask:0xf bank_mask:0xf
    v_add_f32_dpp v64, v64, v64 row_ror:8 row_mask:0xf bank_mask:0xf
    v_add_f32_dpp v65, v65, v65 row_ror:8 row_mask:0xf bank_mask:0xf
    v_add_f32_dpp v66, v66, v66 row_ror:8 row_mask:0xf bank_mask:0xf
    v_add_f32_dpp v67, v67, v67 row_ror:8 row_mask:0xf bank_mask:0xf
    v_cvt_pk_bf16_f32 v20, v64, v65
    v_cvt_pk_bf16_f32 v21, v66, v67
    s_mov_b32 exec_lo, 0x000f000f
    s_mov_b32 exec_hi, 0x000f000f
    global_store_dwordx2 v112, v[20:21], s[28:29]
    s_mov_b64 exec, -1
    s_branch L_fin
L_t_wo:
    s_lshr_b32 s49, s3, 1
    s_lshl_b32 s49, s49, 17
    v_and_b32 v210, 7, v0
    s_lshl_b32 s34, s60, 12
    s_add_u32 s34, s34, s49
    s_add_u32 s34, s34, 1573120
    v_lshrrev_b32 v211, 3, v0
    v_lshl_add_u32 v204, v211, 9, s34
    s_lshl_b32 s35, s51, 7
    s_add_u32 s34, s34, s35
    s_sub_u32 s34, s34, 256
    v_lshrrev_b32 v211, 3, v0
    v_lshlrev_b32 v205, 9, v211
    v_lshl_add_u32 v205, v210, 4, v205
    v_add_u32 v205, s34, v205
    s_lshl_b32 s34, s3, 12
    s_add_u32 s34, s34, 40960
    v_lshrrev_b32 v206, 2, v0
    v_lshlrev_b32 v206, 6, v206
    v_lshl_add_u32 v206, v200, 3, v206
    v_add_u32 v206, s34, v206
    s_mul_i32 s34, s3, 1152
    s_add_u32 s34, s34, 107520
    v_mul_u32_u24 v207, 144, v211
    v_lshl_add_u32 v207, v210, 4, v207
    v_add_u32 v207, s34, v207
    v_mul_u32_u24 v208, 144, v210
    v_lshl_add_u32 v208, v202, 4, v208
    v_add_u32 v208, s34, v208
    v_mul_u32_u24 v212, 144, v211
    v_add_u32 v212, s34, v212
    v_mul_u32_u24 v213, 144, v210
    v_add_u32 v213, s34, v213
    v_and_b32 v211, 1, v211
    v_lshl_add_u32 v203, v211, 6, v208
    v_add_u32 v203, 14592, v203
    v_mov_b32 v210, 98816
    v_cmp_eq_u32 vcc, 0, v211
    s_nop 1
    v_cndmask_b32 v209, v208, v210, vcc
    v_cndmask_b32 v208, v210, v208, vcc
    s_barrier
L_r_wo:
    s_mov_b32 m0, s56
    s_nop 0
    buffer_load_dwordx4 v15, s[52:55], s57 offen  lds
    s_mov_b32 m0, s58
    s_nop 0
    buffer_load_dwordx4 v15, s[52:55], s59 offen  lds
    s_xor_b32 m0, s56, 2048
    s_sub_u32 s34, 40960, s57
    buffer_load_dwordx4 v15, s[52:55], s34 offen  lds
    s_xor_b32 m0, s58, 2048
    s_add_u32 s34, s34, 1280
    buffer_load_dwordx4 v15, s[52:55], s34 offen  lds
    s_mov_b32 s35, 0
    buffer_load_dwordx4 v[64:67], v205, s[44:47], 0 offen sc1
    buffer_load_dword v26, v204, s[44:47], 0 offen sc1
    s_waitcnt vmcnt(2)
    ds_read_b64_tr_b16 v[32:33], v206 offset:0
    ds_read_b64_tr_b16 v[34:35], v206 offset:1024
    ds_read_b64_tr_b16 v[36:37], v206 offset:32
    ds_read_b64_tr_b16 v[38:39], v206 offset:1056
    ds_read_b64_tr_b16 v[40:41], v206 offset:2048
    ds_read_b64_tr_b16 v[42:43], v206 offset:3072
    ds_read_b64_tr_b16 v[44:45], v206 offset:2080
    ds_read_b64_tr_b16 v[46:47], v206 offset:3104
    s_branch L_pam
L_pa:
    buffer_load_dwordx4 v[64:67], v205, s[44:47], 0 offen sc1
    buffer_load_dword v26, v204, s[44:47], 0 offen sc1
L_pam:
    s_add_u32 s35, s35, 1
    s_waitcnt vmcnt(0)
    ds_write_b128 v207, v[64:67]
    ds_write_b32 v212, v26 offset:128
    v_max3_u32 v28, v64, v65, v66
    v_max3_u32 v28, v28, v67, v26
    v_cmp_eq_u32 vcc, -1, v28
    s_cbranch_vccz L_pad
    s_mov_b64 exec, vcc
    s_cmp_lt_u32 s35, 60000
    s_cbranch_scc1 L_pa
L_pad:
    s_mov_b64 exec, -1
    ds_read_b32 v26, v213 offset:128
    ds_read_b128 v[68:71], v208 offset:0
    ds_read_b128 v[72:75], v209 offset:0
    ds_read_b128 v[76:79], v208 offset:64
    ds_read_b128 v[80:83], v209 offset:64
    s_waitcnt lgkmcnt(3)
    v_mfma_f32_16x16x32_bf16 v[20:23], v[32:35], v[68:71], 0
    s_waitcnt lgkmcnt(2)
    v_mfma_f32_16x16x32_bf16 v[20:23], v[36:39], v[72:75], v[20:23]
    s_waitcnt lgkmcnt(1)
    v_mfma_f32_16x16x32_bf16 v[20:23], v[40:43], v[76:79], v[20:23]
    s_waitcnt lgkmcnt(0)
    v_mfma_f32_16x16x32_bf16 v[20:23], v[44:47], v[80:83], v[20:23]
    v_sub_f32_dpp v26, v26, v26 quad_perm:[1,0,3,2] row_mask:0xf bank_mask:0xf
    v_exp_f32 v26, v26
    s_nop 0
    v_add_f32 v26, 1.0, v26
    v_rcp_f32 v26, v26
    s_nop 2
    v_pk_mul_f32 v[20:21], v[20:21], v[26:27] op_sel_hi:[1,0]
    v_pk_mul_f32 v[22:23], v[22:23], v[26:27] op_sel_hi:[1,0]
    ds_write_b128 v203, v[20:23]
    s_waitcnt lgkmcnt(0)
    s_barrier
    s_cmp_lg_u32 s3, 0
    s_cbranch_scc1 L_fin
    ds_read_b128 v[64:67], v207 offset:14592
    ds_read_b128 v[68:71], v207 offset:15744
    ds_read_b128 v[72:75], v207 offset:16896
    ds_read_b128 v[76:79], v207 offset:18048
    ds_read_b128 v[80:83], v207 offset:19200
    ds_read_b128 v[84:87], v207 offset:20352
    ds_read_b128 v[88:91], v207 offset:21504
    ds_read_b128 v[92:95], v207 offset:22656
    s_waitcnt lgkmcnt(6)
    v_pk_add_f32 v[64:65], v[64:65], v[68:69]
    v_pk_add_f32 v[66:67], v[66:67], v[70:71]
    s_waitcnt lgkmcnt(5)
    v_pk_add_f32 v[64:65], v[64:65], v[72:73]
    v_pk_add_f32 v[66:67], v[66:67], v[74:75]
    s_waitcnt lgkmcnt(4)
    v_pk_add_f32 v[64:65], v[64:65], v[76:77]
    v_pk_add_f32 v[66:67], v[66:67], v[78:79]
    s_waitcnt lgkmcnt(3)
    v_pk_add_f32 v[64:65], v[64:65], v[80:81]
    v_pk_add_f32 v[66:67], v[66:67], v[82:83]
    s_waitcnt lgkmcnt(2)
    v_pk_add_f32 v[64:65], v[64:65], v[84:85]
    v_pk_add_f32 v[66:67], v[66:67], v[86:87]
    s_waitcnt lgkmcnt(1)
    v_pk_add_f32 v[64:65], v[64:65], v[88:89]
    v_pk_add_f32 v[66:67], v[66:67], v[90:91]
    s_waitcnt lgkmcnt(0)
    v_pk_add_f32 v[64:65], v[64:65], v[92:93]
    v_pk_add_f32 v[66:67], v[66:67], v[94:95]
    v_pk_mul_f32 v[20:21], v[64:65], v[100:101]
    v_pk_mul_f32 v[22:23], v[66:67], v[102:103]
    s_nop 0
    v_add_f32_dpp v20, v20, v20 row_ror:8 row_mask:0xf bank_mask:0xf
    v_add_f32_dpp v21, v21, v21 row_ror:8 row_mask:0xf bank_mask:0xf
    v_add_f32_dpp v22, v22, v22 row_ror:8 row_mask:0xf bank_mask:0xf
    v_add_f32_dpp v23, v23, v23 row_ror:8 row_mask:0xf bank_mask:0xf
    v_cvt_pk_bf16_f32 v24, v20, v21
    v_cvt_pk_bf16_f32 v25, v22, v23
    v_min_u32 v24, -2, v24
    v_min_u32 v25, -2, v25
    s_mov_b32 exec_lo, 0x00ff00ff
    s_mov_b32 exec_hi, 0x00ff00ff
    buffer_store_dwordx2 v[24:25], v112, s[44:47], 0 offen sc1
    s_mov_b64 exec, -1
L_fin:
L_exit:
    s_endpgm
L_codeend:
.section .rodata,"a"
.p2align 6
.amdhsa_kernel adaLN_cond__sliding_block_cached__dense_activation_gelu__decode_kernel
  .amdhsa_next_free_vgpr 256
  .amdhsa_next_free_sgpr 102
  .amdhsa_accum_offset 256
  .amdhsa_group_segment_fixed_size 0
  .amdhsa_kernarg_size 120
  .amdhsa_user_sgpr_count 2
  .amdhsa_user_sgpr_kernarg_segment_ptr 1
  .amdhsa_system_sgpr_workgroup_id_x 1
  .amdhsa_float_denorm_mode_32 3
.end_amdhsa_kernel
```

```asm
; @launch grid=(256,1,1) block=(512,1,1) lds=131328
.amdgcn_target "amdgcn-amd-amdhsa--gfx950"
.text
.globl adaLN_cond__sliding_block_cached__dense_activation_gelu__decode_kernel
.p2align 8
.type adaLN_cond__sliding_block_cached__dense_activation_gelu__decode_kernel,@function
adaLN_cond__sliding_block_cached__dense_activation_gelu__decode_kernel:
    s_cmp_ge_u32 s2, 256
    s_cbranch_scc1 L_exit
    s_load_dwordx16 s[4:19], s[0:1], 0
    s_load_dwordx8 s[20:27], s[0:1], 64
    s_load_dwordx4 s[28:31], s[0:1], 96
    s_load_dwordx2 s[32:33], s[0:1], 112
    v_lshrrev_b32 v1, 6, v0
    v_and_b32 v0, 63, v0
    v_readfirstlane_b32 s3, v1
    s_and_b32 s60, s2, 7
    s_lshr_b32 s61, s2, 3
    s_mov_b32 s39, 0x20000
    s_mov_b32 s43, 0x20000
    s_mov_b32 s46, 524288
    s_mov_b32 s47, 0x20000
    s_cmp_lg_u32 s3, 0
    s_cbranch_scc1 L_stream
    s_setprio 3
    v_and_b32 v12, 3, v0
    v_bfe_u32 v13, v0, 2, 2
    v_lshrrev_b32 v14, 4, v0
    v_lshrrev_b32 v10, 3, v0
    v_and_b32 v11, 7, v0
    v_lshlrev_b32 v11, 4, v11
    s_lshr_b32 s50, s2, 2
    s_and_b32 s51, s2, 3
    s_mul_i32 s34, s51, 1228800
    s_lshl_b32 s35, s50, 7
    s_add_u32 s34, s34, s35
    v_mul_u32_u24 v17, 7680, v10
    v_add3_u32 v17, v17, v11, s34
    v_mul_u32_u24 v16, 1280, v12
    v_lshl_add_u32 v18, v14, 4, v16
    s_mul_i32 s34, s51, 320
    v_add_u32 v19, s34, v18
    s_mov_b32 s38, 4915200
    s_sub_u32 s52, s50, 10
    s_waitcnt lgkmcnt(0)
    s_add_u32 s44, s32, 0
    s_addc_u32 s45, s33, 0
    s_cmp_ge_u32 s2, 240
    s_cbranch_scc1 L_clear
    s_cmp_ge_u32 s52, 10
    s_cbranch_scc1 L_nox
    v_lshl_add_u32 v18, v13, 6, v18
    global_load_dwordx4 v[52:55], v18, s[4:5] offset:0
    global_load_dwordx4 v[56:59], v18, s[4:5] offset:256
    global_load_dwordx4 v[60:63], v18, s[4:5] offset:512
    global_load_dwordx4 v[64:67], v18, s[4:5] offset:768
    global_load_dwordx4 v[68:71], v18, s[4:5] offset:1024
    s_lshl_b32 s34, s52, 7
    v_lshl_add_u32 v16, v13, 5, v16
    v_lshl_add_u32 v16, v14, 3, v16
    v_add_u32 v16, s34, v16
    global_load_dwordx2 v[72:73], v16, s[4:5]
L_nox:
    global_load_dwordx4 v[32:35], v19, s[24:25] offset:0
    global_load_dwordx4 v[36:39], v19, s[24:25] offset:64
    global_load_dwordx4 v[40:43], v19, s[24:25] offset:128
    global_load_dwordx4 v[44:47], v19, s[24:25] offset:192
    global_load_dwordx4 v[48:51], v19, s[24:25] offset:256
    s_mov_b32 s36, s26
    s_mov_b32 s37, s27
    s_mov_b32 m0, 0
    s_mov_b32 s34, 0
L_dma1:
    buffer_load_dwordx4 v17, s[36:39], s34 offen  lds
    s_add_u32 m0, m0, 1024
    s_add_u32 s34, s34, 61440
    buffer_load_dwordx4 v17, s[36:39], s34 offen  lds
    s_add_u32 m0, m0, 1024
    s_add_u32 s34, s34, 61440
    buffer_load_dwordx4 v17, s[36:39], s34 offen  lds
    s_add_u32 m0, m0, 1024
    s_add_u32 s34, s34, 61440
    buffer_load_dwordx4 v17, s[36:39], s34 offen  lds
    s_add_u32 m0, m0, 1024
    s_add_u32 s34, s34, 61440
    s_cmp_lt_u32 s34, 1228800
    s_cbranch_scc1 L_dma1
    v_lshlrev_b32 v1, 2, v0
    v_add_u32 v1, 98304, v1
    v_mov_b32 v2, -1
    v_mov_b32 v3, 0
    ds_write_b32 v1, v2
    ds_write_b32 v1, v2 offset:256
    ds_write_b32 v1, v3 offset:512
    ds_write_b32 v1, v3 offset:768
    s_waitcnt lgkmcnt(0)
    s_barrier
    s_getpc_b64 s[56:57]
L_pc2:
    s_sub_u32 s56, s56, L_pc2-adaLN_cond__sliding_block_cached__dense_activation_gelu__decode_kernel
    s_subb_u32 s57, s57, 0
    s_lshl_b32 s34, s61, 10
    v_lshl_add_u32 v9, v0, 4, s34
    v_min_u32 v9, L_codeend-adaLN_cond__sliding_block_cached__dense_activation_gelu__decode_kernel-16, v9
    global_load_dwordx4 v[76:79], v9, s[56:57]
    s_and_b32 s34, s2, 31
    s_lshl_b32 s34, s34, 8
    s_lshr_b32 s35, s2, 7
    s_lshl_b32 s35, s35, 7
    s_add_u32 s49, s34, s35
    s_bfe_u32 s53, s2, 0x20005
    s_mul_i32 s34, s53, 1310720
    s_add_u32 s34, s34, s49
    v_lshl_add_u32 v16, v10, 13, v11
    v_add_u32 v16, s34, v16
    s_mov_b32 s36, s10
    s_mov_b32 s37, s11
    s_mov_b32 s38, 5242880
    s_mov_b32 m0, 20480
    s_mov_b32 s34, 0
L_dma3:
    buffer_load_dwordx4 v16, s[36:39], s34 offen  lds
    s_add_u32 m0, m0, 1024
    s_add_u32 s34, s34, 65536
    buffer_load_dwordx4 v16, s[36:39], s34 offen  lds
    s_add_u32 m0, m0, 1024
    s_add_u32 s34, s34, 65536
    buffer_load_dwordx4 v16, s[36:39], s34 offen  lds
    s_add_u32 m0, m0, 1024
    s_add_u32 s34, s34, 65536
    buffer_load_dwordx4 v16, s[36:39], s34 offen  lds
    s_add_u32 m0, m0, 1024
    s_add_u32 s34, s34, 65536
    s_cmp_lt_u32 s34, 1310720
    s_cbranch_scc1 L_dma3
    v_lshl_add_u32 v15, v14, 3, v13
    v_lshlrev_b32 v15, 7, v15
    v_lshl_add_u32 v15, v12, 3, v15
    s_waitcnt vmcnt(41)
    s_mov_b32 s34, 0xbfb8aa3b
    v_lshlrev_b32 v20, 16, v32
    v_and_b32 v21, 0xffff0000, v32
    v_lshlrev_b32 v22, 16, v33
    v_and_b32 v23, 0xffff0000, v33
    v_mul_f32 v24, s34, v20
    v_mul_f32 v25, s34, v21
    v_mul_f32 v26, s34, v22
    v_mul_f32 v27, s34, v23
    v_exp_f32 v24, v24
    v_exp_f32 v25, v25
    v_exp_f32 v26, v26
    v_exp_f32 v27, v27
    v_add_f32 v24, 1.0, v24
    v_add_f32 v25, 1.0, v25
    v_add_f32 v26, 1.0, v26
    v_add_f32 v27, 1.0, v27
    v_rcp_f32 v24, v24
    v_rcp_f32 v25, v25
    v_rcp_f32 v26, v26
    v_rcp_f32 v27, v27
    v_mul_f32 v24, v20, v24
    v_mul_f32 v25, v21, v25
    v_mul_f32 v26, v22, v26
    v_mul_f32 v27, v23, v27
    v_cvt_pk_bf16_f32 v32, v24, v25
    v_cvt_pk_bf16_f32 v33, v26, v27
    v_lshlrev_b32 v20, 16, v34
    v_and_b32 v21, 0xffff0000, v34
    v_lshlrev_b32 v22, 16, v35
    v_and_b32 v23, 0xffff0000, v35
    v_mul_f32 v24, s34, v20
    v_mul_f32 v25, s34, v21
    v_mul_f32 v26, s34, v22
    v_mul_f32 v27, s34, v23
    v_exp_f32 v24, v24
    v_exp_f32 v25, v25
    v_exp_f32 v26, v26
    v_exp_f32 v27, v27
    v_add_f32 v24, 1.0, v24
    v_add_f32 v25, 1.0, v25
    v_add_f32 v26, 1.0, v26
    v_add_f32 v27, 1.0, v27
    v_rcp_f32 v24, v24
    v_rcp_f32 v25, v25
    v_rcp_f32 v26, v26
    v_rcp_f32 v27, v27
    v_mul_f32 v24, v20, v24
    v_mul_f32 v25, v21, v25
    v_mul_f32 v26, v22, v26
    v_mul_f32 v27, v23, v27
    v_cvt_pk_bf16_f32 v34, v24, v25
    v_cvt_pk_bf16_f32 v35, v26, v27
    v_lshlrev_b32 v20, 16, v36
    v_and_b32 v21, 0xffff0000, v36
    v_lshlrev_b32 v22, 16, v37
    v_and_b32 v23, 0xffff0000, v37
    v_mul_f32 v24, s34, v20
    v_mul_f32 v25, s34, v21
    v_mul_f32 v26, s34, v22
    v_mul_f32 v27, s34, v23
    v_exp_f32 v24, v24
    v_exp_f32 v25, v25
    v_exp_f32 v26, v26
    v_exp_f32 v27, v27
    v_add_f32 v24, 1.0, v24
    v_add_f32 v25, 1.0, v25
    v_add_f32 v26, 1.0, v26
    v_add_f32 v27, 1.0, v27
    v_rcp_f32 v24, v24
    v_rcp_f32 v25, v25
    v_rcp_f32 v26, v26
    v_rcp_f32 v27, v27
    v_mul_f32 v24, v20, v24
    v_mul_f32 v25, v21, v25
    v_mul_f32 v26, v22, v26
    v_mul_f32 v27, v23, v27
    v_cvt_pk_bf16_f32 v36, v24, v25
    v_cvt_pk_bf16_f32 v37, v26, v27
    v_lshlrev_b32 v20, 16, v38
    v_and_b32 v21, 0xffff0000, v38
    v_lshlrev_b32 v22, 16, v39
    v_and_b32 v23, 0xffff0000, v39
    v_mul_f32 v24, s34, v20
    v_mul_f32 v25, s34, v21
    v_mul_f32 v26, s34, v22
    v_mul_f32 v27, s34, v23
    v_exp_f32 v24, v24
    v_exp_f32 v25, v25
    v_exp_f32 v26, v26
    v_exp_f32 v27, v27
    v_add_f32 v24, 1.0, v24
    v_add_f32 v25, 1.0, v25
    v_add_f32 v26, 1.0, v26
    v_add_f32 v27, 1.0, v27
    v_rcp_f32 v24, v24
    v_rcp_f32 v25, v25
    v_rcp_f32 v26, v26
    v_rcp_f32 v27, v27
    v_mul_f32 v24, v20, v24
    v_mul_f32 v25, v21, v25
    v_mul_f32 v26, v22, v26
    v_mul_f32 v27, v23, v27
    v_cvt_pk_bf16_f32 v38, v24, v25
    v_cvt_pk_bf16_f32 v39, v26, v27
    v_lshlrev_b32 v20, 16, v40
    v_and_b32 v21, 0xffff0000, v40
    v_lshlrev_b32 v22, 16, v41
    v_and_b32 v23, 0xffff0000, v41
    v_mul_f32 v24, s34, v20
    v_mul_f32 v25, s34, v21
    v_mul_f32 v26, s34, v22
    v_mul_f32 v27, s34, v23
    v_exp_f32 v24, v24
    v_exp_f32 v25, v25
    v_exp_f32 v26, v26
    v_exp_f32 v27, v27
    v_add_f32 v24, 1.0, v24
    v_add_f32 v25, 1.0, v25
    v_add_f32 v26, 1.0, v26
    v_add_f32 v27, 1.0, v27
    v_rcp_f32 v24, v24
    v_rcp_f32 v25, v25
    v_rcp_f32 v26, v26
    v_rcp_f32 v27, v27
    v_mul_f32 v24, v20, v24
    v_mul_f32 v25, v21, v25
    v_mul_f32 v26, v22, v26
    v_mul_f32 v27, v23, v27
    v_cvt_pk_bf16_f32 v40, v24, v25
    v_cvt_pk_bf16_f32 v41, v26, v27
    v_lshlrev_b32 v20, 16, v42
    v_and_b32 v21, 0xffff0000, v42
    v_lshlrev_b32 v22, 16, v43
    v_and_b32 v23, 0xffff0000, v43
    v_mul_f32 v24, s34, v20
    v_mul_f32 v25, s34, v21
    v_mul_f32 v26, s34, v22
    v_mul_f32 v27, s34, v23
    v_exp_f32 v24, v24
    v_exp_f32 v25, v25
    v_exp_f32 v26, v26
    v_exp_f32 v27, v27
    v_add_f32 v24, 1.0, v24
    v_add_f32 v25, 1.0, v25
    v_add_f32 v26, 1.0, v26
    v_add_f32 v27, 1.0, v27
    v_rcp_f32 v24, v24
    v_rcp_f32 v25, v25
    v_rcp_f32 v26, v26
    v_rcp_f32 v27, v27
    v_mul_f32 v24, v20, v24
    v_mul_f32 v25, v21, v25
    v_mul_f32 v26, v22, v26
    v_mul_f32 v27, v23, v27
    v_cvt_pk_bf16_f32 v42, v24, v25
    v_cvt_pk_bf16_f32 v43, v26, v27
    v_lshlrev_b32 v20, 16, v44
    v_and_b32 v21, 0xffff0000, v44
    v_lshlrev_b32 v22, 16, v45
    v_and_b32 v23, 0xffff0000, v45
    v_mul_f32 v24, s34, v20
    v_mul_f32 v25, s34, v21
    v_mul_f32 v26, s34, v22
    v_mul_f32 v27, s34, v23
    v_exp_f32 v24, v24
    v_exp_f32 v25, v25
    v_exp_f32 v26, v26
    v_exp_f32 v27, v27
    v_add_f32 v24, 1.0, v24
    v_add_f32 v25, 1.0, v25
    v_add_f32 v26, 1.0, v26
    v_add_f32 v27, 1.0, v27
    v_rcp_f32 v24, v24
    v_rcp_f32 v25, v25
    v_rcp_f32 v26, v26
    v_rcp_f32 v27, v27
    v_mul_f32 v24, v20, v24
    v_mul_f32 v25, v21, v25
    v_mul_f32 v26, v22, v26
    v_mul_f32 v27, v23, v27
    v_cvt_pk_bf16_f32 v44, v24, v25
    v_cvt_pk_bf16_f32 v45, v26, v27
    v_lshlrev_b32 v20, 16, v46
    v_and_b32 v21, 0xffff0000, v46
    v_lshlrev_b32 v22, 16, v47
    v_and_b32 v23, 0xffff0000, v47
    v_mul_f32 v24, s34, v20
    v_mul_f32 v25, s34, v21
    v_mul_f32 v26, s34, v22
    v_mul_f32 v27, s34, v23
    v_exp_f32 v24, v24
    v_exp_f32 v25, v25
    v_exp_f32 v26, v26
    v_exp_f32 v27, v27
    v_add_f32 v24, 1.0, v24
    v_add_f32 v25, 1.0, v25
    v_add_f32 v26, 1.0, v26
    v_add_f32 v27, 1.0, v27
    v_rcp_f32 v24, v24
    v_rcp_f32 v25, v25
    v_rcp_f32 v26, v26
    v_rcp_f32 v27, v27
    v_mul_f32 v24, v20, v24
    v_mul_f32 v25, v21, v25
    v_mul_f32 v26, v22, v26
    v_mul_f32 v27, v23, v27
    v_cvt_pk_bf16_f32 v46, v24, v25
    v_cvt_pk_bf16_f32 v47, v26, v27
    v_lshlrev_b32 v20, 16, v48
    v_and_b32 v21, 0xffff0000, v48
    v_lshlrev_b32 v22, 16, v49
    v_and_b32 v23, 0xffff0000, v49
    v_mul_f32 v24, s34, v20
    v_mul_f32 v25, s34, v21
    v_mul_f32 v26, s34, v22
    v_mul_f32 v27, s34, v23
    v_exp_f32 v24, v24
    v_exp_f32 v25, v25
    v_exp_f32 v26, v26
    v_exp_f32 v27, v27
    v_add_f32 v24, 1.0, v24
    v_add_f32 v25, 1.0, v25
    v_add_f32 v26, 1.0, v26
    v_add_f32 v27, 1.0, v27
    v_rcp_f32 v24, v24
    v_rcp_f32 v25, v25
    v_rcp_f32 v26, v26
    v_rcp_f32 v27, v27
    v_mul_f32 v24, v20, v24
    v_mul_f32 v25, v21, v25
    v_mul_f32 v26, v22, v26
    v_mul_f32 v27, v23, v27
    v_cvt_pk_bf16_f32 v48, v24, v25
    v_cvt_pk_bf16_f32 v49, v26, v27
    v_lshlrev_b32 v20, 16, v50
    v_and_b32 v21, 0xffff0000, v50
    v_lshlrev_b32 v22, 16, v51
    v_and_b32 v23, 0xffff0000, v51
    v_mul_f32 v24, s34, v20
    v_mul_f32 v25, s34, v21
    v_mul_f32 v26, s34, v22
    v_mul_f32 v27, s34, v23
    v_exp_f32 v24, v24
    v_exp_f32 v25, v25
    v_exp_f32 v26, v26
    v_exp_f32 v27, v27
    v_add_f32 v24, 1.0, v24
    v_add_f32 v25, 1.0, v25
    v_add_f32 v26, 1.0, v26
    v_add_f32 v27, 1.0, v27
    v_rcp_f32 v24, v24
    v_rcp_f32 v25, v25
    v_rcp_f32 v26, v26
    v_rcp_f32 v27, v27
    v_mul_f32 v24, v20, v24
    v_mul_f32 v25, v21, v25
    v_mul_f32 v26, v22, v26
    v_mul_f32 v27, v23, v27
    v_cvt_pk_bf16_f32 v50, v24, v25
    v_cvt_pk_bf16_f32 v51, v26, v27
    s_cmp_ge_u32 s52, 10
    s_cbranch_scc1 L_nostats
    v_mov_b32 v20, 0
    v_mov_b32 v21, 0
    v_mov_b32 v22, 0x3f803f80
    v_dot2c_f32_bf16 v20, v52, v22
    v_dot2c_f32_bf16 v21, v52, v52
    v_dot2c_f32_bf16 v20, v53, v22
    v_dot2c_f32_bf16 v21, v53, v53
    v_dot2c_f32_bf16 v20, v54, v22
    v_dot2c_f32_bf16 v21, v54, v54
    v_dot2c_f32_bf16 v20, v55, v22
    v_dot2c_f32_bf16 v21, v55, v55
    v_dot2c_f32_bf16 v20, v56, v22
    v_dot2c_f32_bf16 v21, v56, v56
    v_dot2c_f32_bf16 v20, v57, v22
    v_dot2c_f32_bf16 v21, v57, v57
    v_dot2c_f32_bf16 v20, v58, v22
    v_dot2c_f32_bf16 v21, v58, v58
    v_dot2c_f32_bf16 v20, v59, v22
    v_dot2c_f32_bf16 v21, v59, v59
    v_dot2c_f32_bf16 v20, v60, v22
    v_dot2c_f32_bf16 v21, v60, v60
    v_dot2c_f32_bf16 v20, v61, v22
    v_dot2c_f32_bf16 v21, v61, v61
    v_dot2c_f32_bf16 v20, v62, v22
    v_dot2c_f32_bf16 v21, v62, v62
    v_dot2c_f32_bf16 v20, v63, v22
    v_dot2c_f32_bf16 v21, v63, v63
    v_dot2c_f32_bf16 v20, v64, v22
    v_dot2c_f32_bf16 v21, v64, v64
    v_dot2c_f32_bf16 v20, v65, v22
    v_dot2c_f32_bf16 v21, v65, v65
    v_dot2c_f32_bf16 v20, v66, v22
    v_dot2c_f32_bf16 v21, v66, v66
    v_dot2c_f32_bf16 v20, v67, v22
    v_dot2c_f32_bf16 v21, v67, v67
    v_dot2c_f32_bf16 v20, v68, v22
    v_dot2c_f32_bf16 v21, v68, v68
    v_dot2c_f32_bf16 v20, v69, v22
    v_dot2c_f32_bf16 v21, v69, v69
    v_dot2c_f32_bf16 v20, v70, v22
    v_dot2c_f32_bf16 v21, v70, v70
    v_dot2c_f32_bf16 v20, v71, v22
    v_dot2c_f32_bf16 v21, v71, v71
    s_nop 1
    v_add_f32_dpp v20, v20, v20 row_ror:4 row_mask:0xf bank_mask:0xf
    v_add_f32_dpp v21, v21, v21 row_ror:4 row_mask:0xf bank_mask:0xf
    s_nop 0
    v_add_f32_dpp v20, v20, v20 row_ror:8 row_mask:0xf bank_mask:0xf
    v_add_f32_dpp v21, v21, v21 row_ror:8 row_mask:0xf bank_mask:0xf
    v_mov_b32 v22, v20
    v_mov_b32 v23, v21
    s_nop 0
    v_permlane16_swap_b32 v20, v22
    v_permlane16_swap_b32 v21, v23
    v_add_f32 v20, v20, v22
    v_add_f32 v21, v21, v23
    v_mov_b32 v22, v20
    v_mov_b32 v23, v21
    s_nop 0
    v_permlane32_swap_b32 v20, v22
    v_permlane32_swap_b32 v21, v23
    v_add_f32 v20, v20, v22
    v_add_f32 v21, v21, v23
    v_mul_f32 v22, 0x3acccccd, v20
    v_mul_f32 v21, 0x3acccccd, v21
    v_fma_f32 v21, -v22, v22, v21
    v_max_f32 v21, 0, v21
    v_add_f32 v21, 0x3727c5ac, v21
    v_rsq_f32 v20, v21
    s_nop 0
    v_mul_f32_e64 v21, -v22, v20
    v_lshlrev_b32 v24, 16, v72
    v_and_b32 v25, 0xffff0000, v72
    v_lshlrev_b32 v26, 16, v73
    v_and_b32 v27, 0xffff0000, v73
    v_fma_f32 v24, v24, v20, v21
    v_fma_f32 v25, v25, v20, v21
    v_fma_f32 v26, v26, v20, v21
    v_fma_f32 v27, v27, v20, v21
L_nostats:
    s_waitcnt vmcnt(21)
    ds_read_b64_tr_b16 v[96:97], v15 offset:0
    ds_read_b64_tr_b16 v[98:99], v15 offset:512
    ds_read_b64_tr_b16 v[100:101], v15 offset:32
    ds_read_b64_tr_b16 v[102:103], v15 offset:544
    ds_read_b64_tr_b16 v[104:105], v15 offset:64
    ds_read_b64_tr_b16 v[106:107], v15 offset:576
    ds_read_b64_tr_b16 v[108:109], v15 offset:96
    ds_read_b64_tr_b16 v[110:111], v15 offset:608
    s_waitcnt lgkmcnt(7)
    ds_read_b64_tr_b16 v[112:113], v15 offset:4096
    ds_read_b64_tr_b16 v[114:115], v15 offset:4608
    ds_read_b64_tr_b16 v[116:117], v15 offset:4128
    ds_read_b64_tr_b16 v[118:119], v15 offset:4640
    ds_read_b64_tr_b16 v[120:121], v15 offset:4160
    ds_read_b64_tr_b16 v[122:123], v15 offset:4672
    ds_read_b64_tr_b16 v[124:125], v15 offset:4192
    ds_read_b64_tr_b16 v[126:127], v15 offset:4704
    s_waitcnt lgkmcnt(7)
    ds_read_b64_tr_b16 v[128:129], v15 offset:8192
    ds_read_b64_tr_b16 v[130:131], v15 offset:8704
    ds_read_b64_tr_b16 v[132:133], v15 offset:8224
    ds_read_b64_tr_b16 v[134:135], v15 offset:8736
    ds_read_b64_tr_b16 v[136:137], v15 offset:8256
    ds_read_b64_tr_b16 v[138:139], v15 offset:8768
    ds_read_b64_tr_b16 v[140:141], v15 offset:8288
    ds_read_b64_tr_b16 v[142:143], v15 offset:8800
    s_waitcnt lgkmcnt(7)
    ds_read_b64_tr_b16 v[144:145], v15 offset:12288
    ds_read_b64_tr_b16 v[146:147], v15 offset:12800
    ds_read_b64_tr_b16 v[148:149], v15 offset:12320
    ds_read_b64_tr_b16 v[150:151], v15 offset:12832
    ds_read_b64_tr_b16 v[152:153], v15 offset:12352
    ds_read_b64_tr_b16 v[154:155], v15 offset:12864
    ds_read_b64_tr_b16 v[156:157], v15 offset:12384
    ds_read_b64_tr_b16 v[158:159], v15 offset:12896
    s_waitcnt lgkmcnt(7)
    ds_read_b64_tr_b16 v[160:161], v15 offset:16384
    ds_read_b64_tr_b16 v[162:163], v15 offset:16896
    ds_read_b64_tr_b16 v[164:165], v15 offset:16416
    ds_read_b64_tr_b16 v[166:167], v15 offset:16928
    ds_read_b64_tr_b16 v[168:169], v15 offset:16448
    ds_read_b64_tr_b16 v[170:171], v15 offset:16960
    ds_read_b64_tr_b16 v[172:173], v15 offset:16480
    ds_read_b64_tr_b16 v[174:175], v15 offset:16992
    s_waitcnt lgkmcnt(0)
    v_mfma_f32_16x16x32_bf16 v[80:83], v[96:99], v[32:35], 0
    v_mfma_f32_16x16x32_bf16 v[84:87], v[100:103], v[32:35], 0
    v_mfma_f32_16x16x32_bf16 v[88:91], v[104:107], v[32:35], 0
    v_mfma_f32_16x16x32_bf16 v[92:95], v[108:111], v[32:35], 0
    v_mfma_f32_16x16x32_bf16 v[80:83], v[112:115], v[36:39], v[80:83]
    v_mfma_f32_16x16x32_bf16 v[84:87], v[116:119], v[36:39], v[84:87]
    v_mfma_f32_16x16x32_bf16 v[88:91], v[120:123], v[36:39], v[88:91]
    v_mfma_f32_16x16x32_bf16 v[92:95], v[124:127], v[36:39], v[92:95]
    v_mfma_f32_16x16x32_bf16 v[80:83], v[128:131], v[40:43], v[80:83]
    v_mfma_f32_16x16x32_bf16 v[84:87], v[132:135], v[40:43], v[84:87]
    v_mfma_f32_16x16x32_bf16 v[88:91], v[136:139], v[40:43], v[88:91]
    v_mfma_f32_16x16x32_bf16 v[92:95], v[140:143], v[40:43], v[92:95]
    v_mfma_f32_16x16x32_bf16 v[80:83], v[144:147], v[44:47], v[80:83]
    v_mfma_f32_16x16x32_bf16 v[84:87], v[148:151], v[44:47], v[84:87]
    v_mfma_f32_16x16x32_bf16 v[88:91], v[152:155], v[44:47], v[88:91]
    v_mfma_f32_16x16x32_bf16 v[92:95], v[156:159], v[44:47], v[92:95]
    v_mfma_f32_16x16x32_bf16 v[80:83], v[160:163], v[48:51], v[80:83]
    v_mfma_f32_16x16x32_bf16 v[84:87], v[164:167], v[48:51], v[84:87]
    v_mfma_f32_16x16x32_bf16 v[88:91], v[168:171], v[48:51], v[88:91]
    v_mfma_f32_16x16x32_bf16 v[92:95], v[172:175], v[48:51], v[92:95]
    s_cmp_ge_u32 s50, 20
    s_cbranch_scc1 L_adr_rest
    s_cmp_lt_u32 s50, 10
    s_cselect_b32 s34, 5120, 0
    s_cselect_b32 s35, s50, s52
    s_lshl_b32 s35, s35, 9
    s_add_u32 s34, s34, s35
    s_lshl_b32 s35, s51, 17
    s_add_u32 s34, s34, s35
    v_lshrrev_b32 v19, 1, v14
    v_lshl_add_u32 v19, v13, 1, v19
    v_lshlrev_b32 v19, 6, v19
    v_lshl_add_u32 v19, v12, 4, v19
    v_and_b32 v20, 1, v14
    v_lshl_add_u32 v19, v20, 3, v19
    s_branch L_adr_done
L_adr_rest:
    s_lshl_b32 s34, s51, 17
    s_lshl_b32 s35, s50, 9
    s_add_u32 s34, s34, s35
    s_add_u32 s34, s34, 0
    v_lshlrev_b32 v19, 7, v12
    v_lshl_add_u32 v19, v13, 5, v19
    v_lshl_add_u32 v19, v14, 3, v19
    s_nop 3
L_adr_done:
    v_add_u32 v19, s34, v19
    v_mov_b32_dpp v80, v84 quad_perm:[0,1,2,3] row_mask:0xf bank_mask:0x2
    v_mov_b32_dpp v81, v85 quad_perm:[0,1,2,3] row_mask:0xf bank_mask:0x2
    v_mov_b32_dpp v82, v86 quad_perm:[0,1,2,3] row_mask:0xf bank_mask:0x2
    v_mov_b32_dpp v83, v87 quad_perm:[0,1,2,3] row_mask:0xf bank_mask:0x2
    v_mov_b32_dpp v80, v88 quad_perm:[0,1,2,3] row_mask:0xf bank_mask:0x4
    v_mov_b32_dpp v81, v89 quad_perm:[0,1,2,3] row_mask:0xf bank_mask:0x4
    v_mov_b32_dpp v82, v90 quad_perm:[0,1,2,3] row_mask:0xf bank_mask:0x4
    v_mov_b32_dpp v83, v91 quad_perm:[0,1,2,3] row_mask:0xf bank_mask:0x4
    v_mov_b32_dpp v80, v92 quad_perm:[0,1,2,3] row_mask:0xf bank_mask:0x8
    v_mov_b32_dpp v81, v93 quad_perm:[0,1,2,3] row_mask:0xf bank_mask:0x8
    v_mov_b32_dpp v82, v94 quad_perm:[0,1,2,3] row_mask:0xf bank_mask:0x8
    v_mov_b32_dpp v83, v95 quad_perm:[0,1,2,3] row_mask:0xf bank_mask:0x8
    s_cmp_ge_u32 s52, 10
    s_cbranch_scc1 L_noz
    v_add_f32 v80, 0x3e800000, v80
    v_add_f32 v81, 0x3e800000, v81
    v_add_f32 v82, 0x3e800000, v82
    v_add_f32 v83, 0x3e800000, v83
    v_mul_f32 v80, v80, v24
    v_mul_f32 v81, v81, v25
    v_mul_f32 v82, v82, v26
    v_mul_f32 v83, v83, v27
L_noz:
    v_cvt_pk_bf16_f32 v20, v80, v81
    v_cvt_pk_bf16_f32 v21, v82, v83
    v_min_u32 v20, -2, v20
    v_min_u32 v21, -2, v21
    v_and_b32 v22, 15, v0
    v_lshlrev_b32 v22, 2, v22
    s_mov_b32 s35, 0
L_poll4:
    global_load_dword v23, v22, s[30:31] offset:128 sc1
    s_add_u32 s35, s35, 1
    s_waitcnt vmcnt(0)
    v_cmp_ne_u32 vcc, 1, v23
    s_cbranch_vccz L_done5
    s_sleep 8
    s_cmp_lt_u32 s35, 60000
    s_cbranch_scc1 L_poll4
L_done5:
    buffer_store_dwordx2 v[20:21], v19, s[44:47], 0 offen sc1
    s_branch L_p2
L_clear:
    s_sub_u32 s55, s2, 240
    s_lshr_b32 s34, s55, 2
    s_lshl_b32 s35, s34, 3
    s_lshr_b32 s54, 538124318, s35
    s_and_b32 s54, s54, 0xff
    s_lshl_b32 s54, s54, 10
    s_mul_i32 s34, s34, 32768
    s_lshl_b32 s35, s51, 17
    s_add_u32 s34, s34, s35
    v_lshl_add_u32 v19, v0, 4, s34
    v_mov_b32 v20, -1
    v_mov_b32 v21, -1
    v_mov_b32 v22, -1
    v_mov_b32 v23, -1
    s_mov_b32 s34, 0
L_clrloop:
    buffer_store_dwordx4 v[20:23], v19, s[44:47], s34 offen sc1
    s_add_u32 s34, s34, 1024
    s_cmp_lt_u32 s34, s54
    s_cbranch_scc1 L_clrloop
    v_lshlrev_b32 v1, 2, v0
    v_add_u32 v1, 98304, v1
    v_mov_b32 v2, -1
    v_mov_b32 v3, 0
    ds_write_b32 v1, v2
    ds_write_b32 v1, v2 offset:256
    ds_write_b32 v1, v3 offset:512
    ds_write_b32 v1, v3 offset:768
    s_waitcnt lgkmcnt(0)
    s_barrier
    s_lshl_b32 s34, s55, 2
    v_mov_b32 v24, s34
    v_mov_b32 v25, 1
    s_waitcnt vmcnt(0)
    s_mov_b64 exec, 1
    global_store_dword v24, v25, s[30:31] offset:128 sc1
    s_mov_b64 exec, -1
    s_getpc_b64 s[56:57]
L_pc7:
    s_sub_u32 s56, s56, L_pc7-adaLN_cond__sliding_block_cached__dense_activation_gelu__decode_kernel
    s_subb_u32 s57, s57, 0
    s_lshl_b32 s34, s61, 10
    v_lshl_add_u32 v9, v0, 4, s34
    v_min_u32 v9, L_codeend-adaLN_cond__sliding_block_cached__dense_activation_gelu__decode_kernel-16, v9
    global_load_dwordx4 v[76:79], v9, s[56:57]
    s_and_b32 s34, s2, 31
    s_lshl_b32 s34, s34, 8
    s_lshr_b32 s35, s2, 7
    s_lshl_b32 s35, s35, 7
    s_add_u32 s49, s34, s35
    s_bfe_u32 s53, s2, 0x20005
    s_mul_i32 s34, s53, 1310720
    s_add_u32 s34, s34, s49
    v_lshl_add_u32 v16, v10, 13, v11
    v_add_u32 v16, s34, v16
    s_mov_b32 s36, s10
    s_mov_b32 s37, s11
    s_mov_b32 s38, 5242880
    s_mov_b32 m0, 20480
    s_mov_b32 s34, 0
L_dma8:
    buffer_load_dwordx4 v16, s[36:39], s34 offen  lds
    s_add_u32 m0, m0, 1024
    s_add_u32 s34, s34, 65536
    buffer_load_dwordx4 v16, s[36:39], s34 offen  lds
    s_add_u32 m0, m0, 1024
    s_add_u32 s34, s34, 65536
    buffer_load_dwordx4 v16, s[36:39], s34 offen  lds
    s_add_u32 m0, m0, 1024
    s_add_u32 s34, s34, 65536
    buffer_load_dwordx4 v16, s[36:39], s34 offen  lds
    s_add_u32 m0, m0, 1024
    s_add_u32 s34, s34, 65536
    s_cmp_lt_u32 s34, 1310720
    s_cbranch_scc1 L_dma8
    v_lshl_add_u32 v15, v14, 3, v13
    v_lshlrev_b32 v15, 7, v15
    v_lshl_add_u32 v15, v12, 3, v15
    v_and_b32 v22, 15, v0
    v_lshlrev_b32 v22, 2, v22
    s_mov_b32 s35, 0
L_poll9:
    global_load_dword v23, v22, s[30:31] offset:128 sc1
    s_add_u32 s35, s35, 1
    s_waitcnt vmcnt(0)
    v_cmp_ne_u32 vcc, 1, v23
    s_cbranch_vccz L_done10
    s_sleep 8
    s_cmp_lt_u32 s35, 60000
    s_cbranch_scc1 L_poll9
L_done10:
L_p2:
    v_mov_b32 v199, v19
    ds_read_b64_tr_b16 v[96:97], v15 offset:20480
    ds_read_b64_tr_b16 v[98:99], v15 offset:20992
    ds_read_b64_tr_b16 v[100:101], v15 offset:20512
    ds_read_b64_tr_b16 v[102:103], v15 offset:21024
    ds_read_b64_tr_b16 v[104:105], v15 offset:20544
    ds_read_b64_tr_b16 v[106:107], v15 offset:21056
    ds_read_b64_tr_b16 v[108:109], v15 offset:20576
    ds_read_b64_tr_b16 v[110:111], v15 offset:21088
    s_waitcnt lgkmcnt(7)
    ds_read_b64_tr_b16 v[112:113], v15 offset:24576
    ds_read_b64_tr_b16 v[114:115], v15 offset:25088
    ds_read_b64_tr_b16 v[116:117], v15 offset:24608
    ds_read_b64_tr_b16 v[118:119], v15 offset:25120
    ds_read_b64_tr_b16 v[120:121], v15 offset:24640
    ds_read_b64_tr_b16 v[122:123], v15 offset:25152
    ds_read_b64_tr_b16 v[124:125], v15 offset:24672
    ds_read_b64_tr_b16 v[126:127], v15 offset:25184
    s_waitcnt lgkmcnt(7)
    ds_read_b64_tr_b16 v[128:129], v15 offset:28672
    ds_read_b64_tr_b16 v[130:131], v15 offset:29184
    ds_read_b64_tr_b16 v[132:133], v15 offset:28704
    ds_read_b64_tr_b16 v[134:135], v15 offset:29216
    ds_read_b64_tr_b16 v[136:137], v15 offset:28736
    ds_read_b64_tr_b16 v[138:139], v15 offset:29248
    ds_read_b64_tr_b16 v[140:141], v15 offset:28768
    ds_read_b64_tr_b16 v[142:143], v15 offset:29280
    s_waitcnt lgkmcnt(7)
    ds_read_b64_tr_b16 v[144:145], v15 offset:32768
    ds_read_b64_tr_b16 v[146:147], v15 offset:33280
    ds_read_b64_tr_b16 v[148:149], v15 offset:32800
    ds_read_b64_tr_b16 v[150:151], v15 offset:33312
    ds_read_b64_tr_b16 v[152:153], v15 offset:32832
    ds_read_b64_tr_b16 v[154:155], v15 offset:33344
    ds_read_b64_tr_b16 v[156:157], v15 offset:32864
    ds_read_b64_tr_b16 v[158:159], v15 offset:33376
    s_waitcnt lgkmcnt(7)
    ds_read_b64_tr_b16 v[160:161], v15 offset:36864
    ds_read_b64_tr_b16 v[162:163], v15 offset:37376
    ds_read_b64_tr_b16 v[164:165], v15 offset:36896
    ds_read_b64_tr_b16 v[166:167], v15 offset:37408
    ds_read_b64_tr_b16 v[168:169], v15 offset:36928
    ds_read_b64_tr_b16 v[170:171], v15 offset:37440
    ds_read_b64_tr_b16 v[172:173], v15 offset:36960
    ds_read_b64_tr_b16 v[174:175], v15 offset:37472
    s_waitcnt lgkmcnt(0)
    s_mul_i32 s34, s53, 1280
    v_lshlrev_b32 v19, 17, v13
    v_lshl_add_u32 v19, v14, 6, v19
    v_lshl_add_u32 v19, v12, 4, v19
    v_add_u32 v19, s34, v19
    s_movk_i32 s48, 5120
    s_mov_b32 s56, 131072
    s_mov_b32 s57, 262144
    s_mov_b32 s58, 393216
    s_sub_u32 s34, s2, 80
    s_cmp_lt_u32 s34, 160
    s_cselect_b32 s54, 1, 0
    s_and_b32 s34, s2, 3
    s_cselect_b32 s54, 0, s54
    v_mov_b32 v180, 0
    v_mov_b32 v181, 0
    v_mov_b32 v182, 0
    v_mov_b32 v183, 0
    v_mov_b32 v184, 0
    v_mov_b32 v185, 0
    v_mov_b32 v186, 0
    v_mov_b32 v187, 0
    v_mov_b32 v22, 99072
    s_mov_b32 s35, 0
L_poll12:
    ds_read_b32 v23, v22
    s_add_u32 s35, s35, 1
    s_waitcnt lgkmcnt(0)
    v_cmp_gt_u32 vcc, 19, v23
    s_cbranch_vccz L_done13
    s_sleep 2
    s_cmp_lt_u32 s35, 60000
    s_cbranch_scc1 L_poll12
L_done13:
    s_mov_b32 s35, 0
L_poll15:
    buffer_load_dwordx4 v[32:35], v19, s[44:47], 0 offen offset:0 sc1
    buffer_load_dwordx4 v[36:39], v19, s[44:47], s48 offen offset:0 sc1
    buffer_load_dwordx4 v[40:43], v19, s[44:47], 0 offen offset:256 sc1
    buffer_load_dwordx4 v[44:47], v19, s[44:47], s48 offen offset:256 sc1
    buffer_load_dwordx4 v[48:51], v19, s[44:47], 0 offen offset:512 sc1
    buffer_load_dwordx4 v[52:55], v19, s[44:47], s48 offen offset:512 sc1
    buffer_load_dwordx4 v[56:59], v19, s[44:47], 0 offen offset:768 sc1
    buffer_load_dwordx4 v[60:63], v19, s[44:47], s48 offen offset:768 sc1
    buffer_load_dwordx4 v[64:67], v19, s[44:47], 0 offen offset:1024 sc1
    buffer_load_dwordx4 v[68:71], v19, s[44:47], s48 offen offset:1024 sc1
    s_cmp_eq_u32 s54, 0
    s_cbranch_scc1 L_hskip
    buffer_load_dwordx2 v[180:181], v199, s[44:47], 0 offen sc1
    buffer_load_dwordx2 v[182:183], v199, s[44:47], s56 offen sc1
    buffer_load_dwordx2 v[184:185], v199, s[44:47], s57 offen sc1
    buffer_load_dwordx2 v[186:187], v199, s[44:47], s58 offen sc1
L_hskip:
    s_add_u32 s35, s35, 1
    s_waitcnt vmcnt(0)
    v_max3_u32 v20, v32, v33, v34
    v_max3_u32 v20, v20, v35, v36
    v_max3_u32 v20, v20, v37, v38
    v_max3_u32 v20, v20, v39, v40
    v_max3_u32 v20, v20, v41, v42
    v_max3_u32 v20, v20, v43, v44
    v_max3_u32 v20, v20, v45, v46
    v_max3_u32 v20, v20, v47, v48
    v_max3_u32 v20, v20, v49, v50
    v_max3_u32 v20, v20, v51, v52
    v_max3_u32 v20, v20, v53, v54
    v_max3_u32 v20, v20, v55, v56
    v_max3_u32 v20, v20, v57, v58
    v_max3_u32 v20, v20, v59, v60
    v_max3_u32 v20, v20, v61, v62
    v_max3_u32 v20, v20, v63, v64
    v_max3_u32 v20, v20, v65, v66
    v_max3_u32 v20, v20, v67, v68
    v_max3_u32 v20, v20, v69, v70
    v_max3_u32 v20, v20, v71, v180
    v_max3_u32 v20, v20, v181, v182
    v_max3_u32 v20, v20, v183, v184
    v_max3_u32 v20, v20, v185, v186
    v_max_u32 v20, v20, v187
    v_cmp_eq_u32 vcc, -1, v20
    s_cbranch_vccz L_done16
    s_sleep 16
    s_cmp_lt_u32 s35, 60000
    s_cbranch_scc1 L_poll15
L_done16:
    v_mfma_f32_16x16x32_bf16 v[80:83], v[96:99], v[32:35], 0
    v_mfma_f32_16x16x32_bf16 v[84:87], v[100:103], v[32:35], 0
    v_mfma_f32_16x16x32_bf16 v[88:91], v[104:107], v[32:35], 0
    v_mfma_f32_16x16x32_bf16 v[92:95], v[108:111], v[32:35], 0
    v_mfma_f32_16x16x32_bf16 v[80:83], v[96:99], v[36:39], v[80:83]
    v_mfma_f32_16x16x32_bf16 v[84:87], v[100:103], v[36:39], v[84:87]
    v_mfma_f32_16x16x32_bf16 v[88:91], v[104:107], v[36:39], v[88:91]
    v_mfma_f32_16x16x32_bf16 v[92:95], v[108:111], v[36:39], v[92:95]
    v_mfma_f32_16x16x32_bf16 v[80:83], v[112:115], v[40:43], v[80:83]
    v_mfma_f32_16x16x32_bf16 v[84:87], v[116:119], v[40:43], v[84:87]
    v_mfma_f32_16x16x32_bf16 v[88:91], v[120:123], v[40:43], v[88:91]
    v_mfma_f32_16x16x32_bf16 v[92:95], v[124:127], v[40:43], v[92:95]
    v_mfma_f32_16x16x32_bf16 v[80:83], v[112:115], v[44:47], v[80:83]
    v_mfma_f32_16x16x32_bf16 v[84:87], v[116:119], v[44:47], v[84:87]
    v_mfma_f32_16x16x32_bf16 v[88:91], v[120:123], v[44:47], v[88:91]
    v_mfma_f32_16x16x32_bf16 v[92:95], v[124:127], v[44:47], v[92:95]
    v_mfma_f32_16x16x32_bf16 v[80:83], v[128:131], v[48:51], v[80:83]
    v_mfma_f32_16x16x32_bf16 v[84:87], v[132:135], v[48:51], v[84:87]
    v_mfma_f32_16x16x32_bf16 v[88:91], v[136:139], v[48:51], v[88:91]
    v_mfma_f32_16x16x32_bf16 v[92:95], v[140:143], v[48:51], v[92:95]
    v_mfma_f32_16x16x32_bf16 v[80:83], v[128:131], v[52:55], v[80:83]
    v_mfma_f32_16x16x32_bf16 v[84:87], v[132:135], v[52:55], v[84:87]
    v_mfma_f32_16x16x32_bf16 v[88:91], v[136:139], v[52:55], v[88:91]
    v_mfma_f32_16x16x32_bf16 v[92:95], v[140:143], v[52:55], v[92:95]
    v_mfma_f32_16x16x32_bf16 v[80:83], v[144:147], v[56:59], v[80:83]
    v_mfma_f32_16x16x32_bf16 v[84:87], v[148:151], v[56:59], v[84:87]
    v_mfma_f32_16x16x32_bf16 v[88:91], v[152:155], v[56:59], v[88:91]
    v_mfma_f32_16x16x32_bf16 v[92:95], v[156:159], v[56:59], v[92:95]
    v_mfma_f32_16x16x32_bf16 v[80:83], v[144:147], v[60:63], v[80:83]
    v_mfma_f32_16x16x32_bf16 v[84:87], v[148:151], v[60:63], v[84:87]
    v_mfma_f32_16x16x32_bf16 v[88:91], v[152:155], v[60:63], v[88:91]
    v_mfma_f32_16x16x32_bf16 v[92:95], v[156:159], v[60:63], v[92:95]
    v_mfma_f32_16x16x32_bf16 v[80:83], v[160:163], v[64:67], v[80:83]
    v_mfma_f32_16x16x32_bf16 v[84:87], v[164:167], v[64:67], v[84:87]
    v_mfma_f32_16x16x32_bf16 v[88:91], v[168:171], v[64:67], v[88:91]
    v_mfma_f32_16x16x32_bf16 v[92:95], v[172:175], v[64:67], v[92:95]
    v_mfma_f32_16x16x32_bf16 v[80:83], v[160:163], v[68:71], v[80:83]
    v_mfma_f32_16x16x32_bf16 v[84:87], v[164:167], v[68:71], v[84:87]
    v_mfma_f32_16x16x32_bf16 v[88:91], v[168:171], v[68:71], v[88:91]
    v_mfma_f32_16x16x32_bf16 v[92:95], v[172:175], v[68:71], v[92:95]
    s_lshl_b32 s34, s53, 17
    s_lshl_b32 s35, s49, 2
    s_add_u32 s34, s34, s35
    s_add_u32 s34, s34, 32768
    v_lshlrev_b32 v19, 7, v12
    v_lshl_add_u32 v19, v13, 5, v19
    v_lshl_add_u32 v19, v14, 3, v19
    v_add_u32 v19, s34, v19
    v_add_f32_dpp v20, v80, v80 row_ror:8 row_mask:0xf bank_mask:0x3
    v_add_f32_dpp v24, v84, v84 row_ror:8 row_mask:0xf bank_mask:0x3
    v_add_f32_dpp v21, v81, v81 row_ror:8 row_mask:0xf bank_mask:0x3
    v_add_f32_dpp v25, v85, v85 row_ror:8 row_mask:0xf bank_mask:0x3
    v_add_f32_dpp v22, v82, v82 row_ror:8 row_mask:0xf bank_mask:0x3
    v_add_f32_dpp v26, v86, v86 row_ror:8 row_mask:0xf bank_mask:0x3
    v_add_f32_dpp v23, v83, v83 row_ror:8 row_mask:0xf bank_mask:0x3
    v_add_f32_dpp v27, v87, v87 row_ror:8 row_mask:0xf bank_mask:0x3
    v_add_f32_dpp v20, v88, v88 row_ror:8 row_mask:0xf bank_mask:0xc
    v_add_f32_dpp v24, v92, v92 row_ror:8 row_mask:0xf bank_mask:0xc
    v_add_f32_dpp v21, v89, v89 row_ror:8 row_mask:0xf bank_mask:0xc
    v_add_f32_dpp v25, v93, v93 row_ror:8 row_mask:0xf bank_mask:0xc
    v_add_f32_dpp v22, v90, v90 row_ror:8 row_mask:0xf bank_mask:0xc
    v_add_f32_dpp v26, v94, v94 row_ror:8 row_mask:0xf bank_mask:0xc
    v_add_f32_dpp v23, v91, v91 row_ror:8 row_mask:0xf bank_mask:0xc
    v_add_f32_dpp v27, v95, v95 row_ror:8 row_mask:0xf bank_mask:0xc
    v_add_f32_dpp v28, v20, v20 row_shl:4 row_mask:0xf bank_mask:0x5
    v_add_f32_dpp v29, v21, v21 row_shl:4 row_mask:0xf bank_mask:0x5
    v_add_f32_dpp v30, v22, v22 row_shl:4 row_mask:0xf bank_mask:0x5
    v_add_f32_dpp v31, v23, v23 row_shl:4 row_mask:0xf bank_mask:0x5
    v_add_f32_dpp v28, v24, v24 row_shr:4 row_mask:0xf bank_mask:0xa
    v_add_f32_dpp v29, v25, v25 row_shr:4 row_mask:0xf bank_mask:0xa
    v_add_f32_dpp v30, v26, v26 row_shr:4 row_mask:0xf bank_mask:0xa
    v_add_f32_dpp v31, v27, v27 row_shr:4 row_mask:0xf bank_mask:0xa
    v_cvt_pk_bf16_f32 v20, v28, v29
    v_cvt_pk_bf16_f32 v21, v30, v31
    v_min_u32 v20, -2, v20
    v_min_u32 v21, -2, v21
    buffer_store_dwordx2 v[20:21], v19, s[44:47], 0 offen sc1
    s_cmp_eq_u32 s54, 0
    s_cbranch_scc1 L_nomf
    v_lshlrev_b32 v24, 16, v180
    v_and_b32 v25, 0xffff0000, v180
    v_lshlrev_b32 v26, 16, v181
    v_and_b32 v27, 0xffff0000, v181
    v_lshlrev_b32 v28, 16, v182
    v_and_b32 v29, 0xffff0000, v182
    v_lshlrev_b32 v30, 16, v183
    v_and_b32 v31, 0xffff0000, v183
    v_add_f32 v24, v24, v28
    v_add_f32 v25, v25, v29
    v_add_f32 v26, v26, v30
    v_add_f32 v27, v27, v31
    v_lshlrev_b32 v28, 16, v184
    v_and_b32 v29, 0xffff0000, v184
    v_lshlrev_b32 v30, 16, v185
    v_and_b32 v31, 0xffff0000, v185
    v_add_f32 v24, v24, v28
    v_add_f32 v25, v25, v29
    v_add_f32 v26, v26, v30
    v_add_f32 v27, v27, v31
    v_lshlrev_b32 v28, 16, v186
    v_and_b32 v29, 0xffff0000, v186
    v_lshlrev_b32 v30, 16, v187
    v_and_b32 v31, 0xffff0000, v187
    v_add_f32 v24, v24, v28
    v_add_f32 v25, v25, v29
    v_add_f32 v26, v26, v30
    v_add_f32 v27, v27, v31
    v_cvt_pk_bf16_f32 v22, v24, v25
    v_cvt_pk_bf16_f32 v23, v26, v27
    v_min_u32 v22, -2, v22
    v_min_u32 v23, -2, v23
    s_sub_u32 s34, s50, 20
    s_lshl_b32 s35, s34, 9
    v_subrev_u32 v199, s35, v199
    s_lshr_b32 s35, s34, 2
    s_lshl_b32 s35, s35, 9
    s_and_b32 s34, s34, 3
    s_lshl_b32 s34, s34, 17
    s_add_u32 s34, s34, s35
    s_add_u32 s34, s34, 55296
    v_add_u32 v199, s34, v199
    buffer_store_dwordx2 v[22:23], v199, s[44:47], 0 offen sc1
L_nomf:
    s_and_b32 s34, s2, 127
    s_lshl_b32 s34, s34, 21
    s_lshr_b32 s35, s2, 7
    s_lshl_b32 s35, s35, 18
    s_add_u32 s34, s34, s35
    s_add_u32 s34, s34, 1572864
    s_mov_b32 s38, 0x40000
    s_mov_b32 s42, 0x40000
    s_waitcnt lgkmcnt(0)
    s_add_u32 s36, s6, s34
    s_addc_u32 s37, s7, 0
    s_add_u32 s40, s8, s34
    s_addc_u32 s41, s9, 0
    v_lshlrev_b32 v18, 4, v0
    s_mov_b32 s34, 258048
    buffer_load_dwordx4 v[128:131], v18, s[36:39], s34 offen offset:0 nt
    buffer_load_dwordx4 v[132:135], v18, s[36:39], s34 offen offset:1024 nt
    buffer_load_dwordx4 v[136:139], v18, s[36:39], s34 offen offset:2048 nt
    buffer_load_dwordx4 v[140:143], v18, s[36:39], s34 offen offset:3072 nt
    buffer_load_dwordx4 v[144:147], v18, s[40:43], s34 offen offset:0 nt
    buffer_load_dwordx4 v[148:151], v18, s[40:43], s34 offen offset:1024 nt
    buffer_load_dwordx4 v[152:155], v18, s[40:43], s34 offen offset:2048 nt
    buffer_load_dwordx4 v[156:159], v18, s[40:43], s34 offen offset:3072 nt
    s_and_b32 s34, s2, 31
    s_lshl_b32 s34, s34, 10
    s_lshl_b32 s35, s53, 7
    s_add_u32 s34, s34, s35
    s_add_u32 s34, s34, 32768
    v_lshrrev_b32 v19, 5, v0
    v_mul_u32_u24 v19, 384, v19
    v_lshl_add_u32 v19, v0, 2, v19
    v_add_u32 v19, s34, v19
    v_mov_b32 v22, 99072
    s_mov_b32 s35, 0
L_poll18:
    ds_read_b32 v23, v22
    s_add_u32 s35, s35, 1
    s_waitcnt lgkmcnt(0)
    v_cmp_gt_u32 vcc, 31, v23
    s_cbranch_vccz L_done19
    s_sleep 2
    s_cmp_lt_u32 s35, 60000
    s_cbranch_scc1 L_poll18
L_done19:
    s_mov_b32 s35, 0
L_poll21:
    buffer_load_dword v32, v19, s[44:47], 0 offen sc1
    buffer_load_dword v33, v19, s[44:47], s56 offen sc1
    buffer_load_dword v34, v19, s[44:47], s57 offen sc1
    buffer_load_dword v35, v19, s[44:47], s58 offen sc1
    s_add_u32 s35, s35, 1
    s_waitcnt vmcnt(0)
    v_max3_u32 v22, v32, v33, v34
    v_max_u32 v22, v22, v35
    v_cmp_eq_u32 vcc, -1, v22
    s_cbranch_vccz L_done22
    s_sleep 16
    s_cmp_lt_u32 s35, 60000
    s_cbranch_scc1 L_poll21
L_done22:
    v_lshlrev_b32 v36, 16, v32
    v_and_b32 v37, 0xffff0000, v32
    v_lshlrev_b32 v38, 16, v33
    v_and_b32 v39, 0xffff0000, v33
    v_lshlrev_b32 v40, 16, v34
    v_and_b32 v41, 0xffff0000, v34
    v_lshlrev_b32 v42, 16, v35
    v_and_b32 v43, 0xffff0000, v35
    v_pk_add_f32 v[36:37], v[36:37], v[38:39]
    v_pk_add_f32 v[40:41], v[40:41], v[42:43]
    v_pk_add_f32 v[36:37], v[36:37], v[40:41]
    v_cvt_pk_bf16_f32 v32, v36, v37
    v_min_u32 v32, -2, v32
    ds_write_b32 v1, v32
    v_and_b32 v2, 15, v0
    v_lshlrev_b32 v2, 4, v2
    v_add_u32 v2, 98304, v2
    ds_read_b128 v[4:7], v2
    s_waitcnt lgkmcnt(0)
    v_dot2_f32_bf16 v8, v128, v4, 0
    v_dot2_f32_bf16 v9, v132, v4, 0
    v_dot2_f32_bf16 v10, v136, v4, 0
    v_dot2_f32_bf16 v11, v140, v4, 0
    v_dot2c_f32_bf16 v8, v129, v5
    v_dot2c_f32_bf16 v9, v133, v5
    v_dot2c_f32_bf16 v10, v137, v5
    v_dot2c_f32_bf16 v11, v141, v5
    v_dot2c_f32_bf16 v8, v130, v6
    v_dot2c_f32_bf16 v9, v134, v6
    v_dot2c_f32_bf16 v10, v138, v6
    v_dot2c_f32_bf16 v11, v142, v6
    v_dot2c_f32_bf16 v8, v131, v7
    v_dot2c_f32_bf16 v9, v135, v7
    v_dot2c_f32_bf16 v10, v139, v7
    v_dot2c_f32_bf16 v11, v143, v7
    v_add_f32_dpp v16, v8, v8 row_ror:8 row_mask:0xf bank_mask:0x3
    v_add_f32_dpp v16, v9, v9 row_ror:8 row_mask:0xf bank_mask:0xc
    v_add_f32_dpp v17, v10, v10 row_ror:8 row_mask:0xf bank_mask:0x3
    v_add_f32_dpp v17, v11, v11 row_ror:8 row_mask:0xf bank_mask:0xc
    v_add_f32_dpp v16, v16, v16 row_half_mirror row_mask:0xf bank_mask:0xf
    s_nop 0
    v_add_f32_dpp v17, v17, v17 row_half_mirror row_mask:0xf bank_mask:0xf
    v_add_f32_dpp v16, v16, v16 quad_perm:[1,0,3,2] row_mask:0xf bank_mask:0xf
    s_nop 0
    v_add_f32_dpp v17, v17, v17 quad_perm:[1,0,3,2] row_mask:0xf bank_mask:0xf
    v_add_f32_dpp v16, v16, v16 quad_perm:[2,3,0,1] row_mask:0xf bank_mask:0xf
    s_nop 0
    v_add_f32_dpp v17, v17, v17 quad_perm:[2,3,0,1] row_mask:0xf bank_mask:0xf
    v_max_f32 v8, v16, v17
    s_mov_b32 s34, 0x3e0293ee
    s_nop 0
    v_max_f32_dpp v8, v8, v8 row_ror:8 row_mask:0xf bank_mask:0xf
    v_mov_b32 v9, v8
    s_nop 1
    v_permlane16_swap_b32 v8, v9
    v_max_f32 v8, v8, v9
    v_mov_b32 v9, v8
    s_nop 1
    v_permlane32_swap_b32 v8, v9
    v_max_f32 v8, v8, v9
    v_mul_f32 v8, s34, v8
    v_fma_f32 v16, v16, s34, -v8
    v_fma_f32 v17, v17, s34, -v8
    v_exp_f32 v16, v16
    v_exp_f32 v17, v17
    s_nop 0
    v_add_f32 v9, v16, v17
    v_and_b32 v10, 1, v0
    v_lshlrev_b32 v10, 4, v10
    v_mov_b32 v11, 0xffff
    v_lshlrev_b32 v10, v10, v11
    v_bfe_u32 v11, v0, 1, 2
    v_cmp_eq_u32 vcc, 0, v11
    s_nop 1
    v_cndmask_b32 v20, 0, v10, vcc
    v_cmp_eq_u32 vcc, 1, v11
    s_nop 1
    v_cndmask_b32 v21, 0, v10, vcc
    v_cmp_eq_u32 vcc, 2, v11
    s_nop 1
    v_cndmask_b32 v22, 0, v10, vcc
    v_cmp_eq_u32 vcc, 3, v11
    s_nop 1
    v_cndmask_b32 v23, 0, v10, vcc
    v_add_f32_dpp v9, v9, v9 row_ror:8 row_mask:0xf bank_mask:0xf
    v_mov_b32 v10, v9
    s_nop 1
    v_permlane16_swap_b32 v9, v10
    v_add_f32 v9, v9, v10
    v_mov_b32 v10, v9
    s_nop 1
    v_permlane32_swap_b32 v9, v10
    v_add_f32 v9, v9, v10
    v_mov_b32 v10, 98616
    s_mov_b64 exec, 1
    ds_write_b64 v10, v[8:9]
    s_mov_b64 exec, -1
    v_cvt_pk_bf16_f32 v10, v16, v16
    v_and_b32 v24, v10, v20
    v_and_b32 v25, v10, v21
    v_and_b32 v26, v10, v22
    v_and_b32 v27, v10, v23
    s_nop 1
    v_mfma_f32_16x16x32_bf16 v[116:119], v[144:147], v[24:27], 0
    v_mfma_f32_16x16x32_bf16 v[120:123], v[148:151], v[24:27], 0
    v_cvt_pk_bf16_f32 v10, v17, v17
    v_and_b32 v28, v10, v20
    v_and_b32 v29, v10, v21
    v_and_b32 v30, v10, v22
    v_and_b32 v31, v10, v23
    s_nop 1
    v_mfma_f32_16x16x32_bf16 v[116:119], v[152:155], v[28:31], v[116:119]
    v_mfma_f32_16x16x32_bf16 v[120:123], v[156:159], v[28:31], v[120:123]
    s_nop 7
    v_mov_b32_dpp v116, v120 quad_perm:[0,1,2,3] row_mask:0xf bank_mask:0xc
    v_mov_b32_dpp v117, v121 quad_perm:[0,1,2,3] row_mask:0xf bank_mask:0xc
    v_mov_b32_dpp v118, v122 quad_perm:[0,1,2,3] row_mask:0xf bank_mask:0xc
    v_mov_b32_dpp v119, v123 quad_perm:[0,1,2,3] row_mask:0xf bank_mask:0xc
    s_mov_b32 s63, 0
    s_mov_b32 s62, s61
    s_cmp_lt_u32 s61, 20
    s_cbranch_scc1 L_rd24
    s_mul_i32 s62, s60, 12
    s_add_u32 s62, s62, s61
    s_sub_u32 s62, s62, 20
    s_mov_b32 s63, 1
    s_cmp_lt_u32 s62, 54
    s_cbranch_scc1 L_rd24
    s_cmp_lt_u32 s62, 56
    s_cselect_b32 s63, 3, 2
    s_sub_u32 s62, s62, 56
L_rd24:
    v_and_b32 v8, 3, v0
    v_bfe_u32 v9, v0, 2, 2
    v_lshrrev_b32 v10, 4, v0
    s_mov_b32 s55, 0x20000
    s_lshl_b32 s35, s62, 6
    s_and_b32 s49, s62, 1
    s_cmp_eq_u32 s63, 0
    s_cbranch_scc1 L_dp26
    s_cmp_eq_u32 s63, 1
    s_cbranch_scc1 L_dp27
    s_mov_b32 s52, s20
    s_mov_b32 s53, s21
    s_mov_b32 s54, 2211840
    v_mov_b32 v15, 0
    s_branch L_dp28
L_dp27:
    s_mov_b32 s52, s16
    s_mov_b32 s53, s17
    s_mov_b32 s54, 2211840
    v_lshl_add_u32 v15, v9, 3, v10
    v_mul_u32_u24 v15, 3456, v15
    v_lshl_add_u32 v15, v8, 4, v15
    v_add_u32 v15, s35, v15
    s_bfe_u32 s50, s3, 0x10001
    s_lshl_b32 s50, s50, 7
    s_and_b32 s34, s3, 1
    s_lshl_b32 s34, s34, 2
    s_add_u32 s50, s50, s34
    s_and_b32 s51, s3, 3
    s_lshl_b32 s51, s51, 5
    s_add_u32 s51, s51, 512
    s_mul_i32 s50, s50, 3456
    s_mul_i32 s51, s51, 3456
    s_branch L_dp28
L_dp26:
    s_mov_b32 s52, s12
    s_mov_b32 s53, s13
    s_mov_b32 s54, 5242880
    s_lshr_b32 s50, s3, 1
    s_lshl_b32 s50, s50, 3
    s_add_u32 s50, s50, s60
    s_and_b32 s51, s3, 1
    s_lshl_b32 s34, s50, 1
    s_add_u32 s34, s34, s51
    s_mul_i32 s34, s34, 81920
    s_add_u32 s34, s34, s35
    v_lshl_add_u32 v15, v9, 2, v10
    v_mul_u32_u24 v15, 2560, v15
    v_lshl_add_u32 v15, v8, 4, v15
    v_add_u32 v15, s34, v15
    s_lshl_b32 s56, s3, 12
    s_lshl_b32 s34, s49, 11
    s_add_u32 s56, s56, s34
    s_add_u32 s56, s56, 40960
    s_add_u32 s58, s56, 1024
    s_mul_i32 s57, s49, 40960
    s_add_u32 s59, s57, 1280
L_dp28:
    v_and_b32 v200, 3, v0
    v_bfe_u32 v201, v0, 2, 2
    v_lshrrev_b32 v202, 4, v0
    s_lshl_b32 s34, s3, 10
    s_add_u32 s34, s34, 122112
    v_lshl_add_u32 v203, v0, 4, s34
    s_movk_i32 s48, 5120
    v_mov_b32 v197, 0
    s_mov_b32 s40, 0
    s_mov_b32 s41, 0
    s_mov_b32 s42, 0
    s_cmp_eq_u32 s63, 0
    s_cbranch_scc1 L_d_wo
    s_cmp_eq_u32 s63, 2
    s_cbranch_scc1 L_d_w2
    s_cmp_eq_u32 s63, 3
    s_cbranch_scc1 L_d_none
    v_and_b32 v205, 15, v0
    v_lshlrev_b32 v205, 4, v205
    s_and_b32 s49, s3, 3
    s_mul_i32 s34, s49, 1280
    s_add_u32 s34, s34, 70656
    v_lshl_add_u32 v206, v202, 17, v205
    v_add_u32 v206, s34, v206
    s_mul_i32 s34, s49, 3840
    v_add_u32 v205, s34, v205
    s_lshl_b32 s34, s62, 6
    v_lshlrev_b32 v5, 4, v14
    v_lshl_add_u32 v5, v12, 2, v5
    v_add_u32 v5, s34, v5
    global_load_dword v6, v5, s[18:19]
    v_and_b32 v7, 15, v0
    v_lshlrev_b32 v7, 4, v7
    v_mul_u32_u24 v8, 1280, v14
    v_add_u32 v8, v8, v7
    v_bfe_u32 v9, v0, 3, 1
    v_lshlrev_b32 v9, 17, v9
    v_lshl_add_u32 v9, v14, 7, v9
    v_and_b32 v10, 7, v0
    v_lshl_add_u32 v9, v10, 4, v9
    v_add_u32 v9, 65536, v9
    s_mov_b32 s57, 262144
    v_mul_u32_u24 v5, 3840, v14
    v_add_u32 v5, v5, v7
    global_load_dwordx4 v[32:35], v8, s[4:5] offset:0
    global_load_dwordx4 v[36:39], v8, s[4:5] offset:256
    global_load_dwordx4 v[40:43], v8, s[4:5] offset:512
    global_load_dwordx4 v[44:47], v8, s[4:5] offset:768
    global_load_dwordx4 v[48:51], v8, s[4:5] offset:1024
    s_mov_b32 s35, 0
L_poll29:
    buffer_load_dwordx4 v[52:55], v9, s[44:47], s57 offen offset:1024 sc1
    buffer_load_dwordx4 v[56:59], v9, s[44:47], 0 offen offset:1536 sc1
    buffer_load_dwordx4 v[60:63], v9, s[44:47], s57 offen offset:1536 sc1
    buffer_load_dwordx4 v[64:67], v9, s[44:47], 0 offen offset:2048 sc1
    buffer_load_dwordx4 v[68:71], v9, s[44:47], s57 offen offset:2048 sc1
    buffer_load_dwordx4 v[72:75], v9, s[44:47], 0 offen offset:2560 sc1
    buffer_load_dwordx4 v[76:79], v9, s[44:47], s57 offen offset:2560 sc1
    buffer_load_dwordx4 v[80:83], v9, s[44:47], 0 offen offset:3072 sc1
    buffer_load_dwordx4 v[84:87], v9, s[44:47], s57 offen offset:3072 sc1
    buffer_load_dwordx4 v[88:91], v9, s[44:47], 0 offen offset:3584 sc1
    s_add_u32 s35, s35, 1
    s_waitcnt vmcnt(0)
    v_max3_u32 v28, v52, v53, v54
    v_max3_u32 v28, v28, v55, v56
    v_max3_u32 v28, v28, v57, v58
    v_max3_u32 v28, v28, v59, v60
    v_max3_u32 v28, v28, v61, v62
    v_max3_u32 v28, v28, v63, v64
    v_max3_u32 v28, v28, v65, v66
    v_max3_u32 v28, v28, v67, v68
    v_max3_u32 v28, v28, v69, v70
    v_max3_u32 v28, v28, v71, v72
    v_max3_u32 v28, v28, v73, v74
    v_max3_u32 v28, v28, v75, v76
    v_max3_u32 v28, v28, v77, v78
    v_max3_u32 v28, v28, v79, v80
    v_max3_u32 v28, v28, v81, v82
    v_max3_u32 v28, v28, v83, v84
    v_max3_u32 v28, v28, v85, v86
    v_max3_u32 v28, v28, v87, v88
    v_max3_u32 v28, v28, v89, v90
    v_max_u32 v28, v28, v91
    v_cmp_eq_u32 vcc, -1, v28
    s_cbranch_vccz L_done30
    s_sleep 16
    s_cmp_lt_u32 s35, 60000
    s_cbranch_scc1 L_poll29
L_done30:
    ds_write_b128 v5, v[32:35] offset:0
    ds_write_b128 v5, v[36:39] offset:256
    ds_write_b128 v5, v[40:43] offset:512
    ds_write_b128 v5, v[44:47] offset:768
    ds_write_b128 v5, v[48:51] offset:1024
    ds_write_b128 v5, v[52:55] offset:1280
    ds_write_b128 v5, v[56:59] offset:1536
    ds_write_b128 v5, v[60:63] offset:1792
    ds_write_b128 v5, v[64:67] offset:2048
    ds_write_b128 v5, v[68:71] offset:2304
    ds_write_b128 v5, v[72:75] offset:2560
    ds_write_b128 v5, v[76:79] offset:2816
    ds_write_b128 v5, v[80:83] offset:3072
    ds_write_b128 v5, v[84:87] offset:3328
    ds_write_b128 v5, v[88:91] offset:3584
    s_waitcnt lgkmcnt(0)
    v_lshlrev_b32 v100, 16, v6
    v_and_b32 v101, 0xffff0000, v6
    s_lshr_b32 s34, s62, 1
    s_lshl_b32 s34, s34, 7
    s_and_b32 s35, s62, 1
    s_mul_i32 s35, s35, 221184
    s_add_u32 s34, s34, s35
    v_lshrrev_b32 v197, 1, v0
    v_mul_u32_u24 v197, 3456, v197
    v_and_b32 v196, 1, v0
    v_lshl_add_u32 v197, v196, 6, v197
    v_add_u32 v197, s34, v197
    s_mov_b32 s40, 110592
    s_mov_b32 s41, 331776
    s_branch L_d_none
L_d_w2:
    s_lshl_b32 s34, s62, 5
    v_lshl_add_u32 v3, v14, 3, s34
    global_load_dwordx2 v[20:21], v3, s[22:23]
    v_mul_u32_u24 v112, 1280, v12
    v_add_u32 v112, v112, v3
    global_load_dwordx2 v[22:23], v112, s[4:5]
    s_lshr_b32 s34, s62, 2
    s_add_u32 s34, s34, 30
    s_lshr_b32 s35, s34, 2
    s_lshl_b32 s35, s35, 9
    s_and_b32 s34, s34, 3
    s_lshl_b32 s34, s34, 17
    s_add_u32 s34, s34, s35
    s_and_b32 s35, s62, 3
    s_mul_i32 s35, s35, 32
    s_add_u32 s34, s34, s35
    s_add_u32 s34, s34, 65536
    v_lshlrev_b32 v5, 7, v12
    v_lshl_add_u32 v5, v14, 3, v5
    v_add_u32 v5, s34, v5
    s_waitcnt vmcnt(0)
    v_lshlrev_b32 v32, 16, v20
    v_and_b32 v33, 0xffff0000, v20
    v_lshlrev_b32 v34, 16, v21
    v_and_b32 v35, 0xffff0000, v21
    v_lshlrev_b32 v108, 16, v22
    v_and_b32 v109, 0xffff0000, v22
    v_lshlrev_b32 v110, 16, v23
    v_and_b32 v111, 0xffff0000, v23
    s_mov_b32 s35, 0
L_poll32:
    buffer_load_dwordx2 v[24:25], v5, s[44:47], 0 offen sc1
    s_add_u32 s35, s35, 1
    s_waitcnt vmcnt(0)
    v_max_u32 v28, v24, v25
    v_cmp_eq_u32 vcc, -1, v28
    s_cbranch_vccz L_done33
    s_sleep 16
    s_cmp_lt_u32 s35, 60000
    s_cbranch_scc1 L_poll32
L_done33:
    v_lshlrev_b32 v104, 16, v24
    v_and_b32 v105, 0xffff0000, v24
    v_lshlrev_b32 v106, 16, v25
    v_and_b32 v107, 0xffff0000, v25
    v_fma_f32 v108, v104, v32, v108
    v_fma_f32 v109, v105, v33, v109
    v_fma_f32 v110, v106, v34, v110
    v_fma_f32 v111, v107, v35, v111
    v_mul_f32 v108, 0x3e800000, v108
    v_mul_f32 v109, 0x3e800000, v109
    v_mul_f32 v110, 0x3e800000, v110
    v_mul_f32 v111, 0x3e800000, v111
    v_lshl_add_u32 v204, v13, 17, v112
    v_add_u32 v204, 70656, v204
    s_lshr_b32 s34, s62, 2
    s_lshl_b32 s34, s34, 7
    s_and_b32 s35, s62, 3
    s_mul_i32 s35, s35, 81920
    s_add_u32 s34, s34, s35
    v_lshrrev_b32 v197, 1, v0
    v_mul_u32_u24 v197, 1280, v197
    v_and_b32 v196, 1, v0
    v_lshl_add_u32 v197, v196, 6, v197
    v_add_u32 v197, s34, v197
    s_mov_b32 s40, 40960
    s_mov_b32 s41, 286720
    s_branch L_d_none
L_d_wo:
    s_lshr_b32 s49, s3, 1
    s_lshl_b32 s49, s49, 17
    v_and_b32 v210, 7, v0
    s_lshl_b32 s34, s60, 12
    s_add_u32 s34, s34, s49
    s_add_u32 s34, s34, 98560
    v_lshrrev_b32 v211, 3, v0
    v_lshl_add_u32 v204, v211, 9, s34
    s_lshl_b32 s35, s51, 7
    s_add_u32 s34, s34, s35
    s_sub_u32 s34, s34, 256
    v_lshrrev_b32 v211, 3, v0
    v_lshlrev_b32 v205, 9, v211
    v_lshl_add_u32 v205, v210, 4, v205
    v_add_u32 v205, s34, v205
    s_lshl_b32 s34, s3, 12
    s_add_u32 s34, s34, 40960
    v_lshrrev_b32 v206, 2, v0
    v_lshlrev_b32 v206, 6, v206
    v_lshl_add_u32 v206, v200, 3, v206
    v_add_u32 v206, s34, v206
    s_mul_i32 s34, s3, 1152
    s_add_u32 s34, s34, 107520
    v_mul_u32_u24 v207, 144, v211
    v_lshl_add_u32 v207, v210, 4, v207
    v_add_u32 v207, s34, v207
    v_mul_u32_u24 v208, 144, v210
    v_lshl_add_u32 v208, v202, 4, v208
    v_add_u32 v208, s34, v208
    v_mul_u32_u24 v212, 144, v211
    v_add_u32 v212, s34, v212
    v_mul_u32_u24 v213, 144, v210
    v_add_u32 v213, s34, v213
    v_and_b32 v211, 1, v211
    v_lshl_add_u32 v203, v211, 6, v208
    v_add_u32 v203, 14592, v203
    v_mov_b32 v210, 98816
    v_cmp_eq_u32 vcc, 0, v211
    s_nop 1
    v_cndmask_b32 v209, v208, v210, vcc
    v_cndmask_b32 v208, v210, v208, vcc
    v_mov_b32 v6, v14
    v_and_b32 v8, 7, v0
    s_lshl_b32 s35, s62, 6
    v_lshl_add_u32 v8, v8, 3, s35
    s_lshr_b32 s34, s62, 1
    s_add_u32 s34, s34, 0
    s_lshr_b32 s35, s34, 2
    s_lshl_b32 s35, s35, 9
    s_and_b32 s34, s34, 3
    s_lshl_b32 s34, s34, 17
    s_add_u32 s34, s34, s35
    s_and_b32 s35, s62, 1
    s_mul_i32 s35, s35, 64
    s_add_u32 s34, s34, s35
    s_add_u32 s34, s34, 65536
    v_and_b32 v9, 7, v0
    v_lshlrev_b32 v9, 3, v9
    v_lshl_add_u32 v9, v6, 7, v9
    v_add_u32 v9, s34, v9
    s_lshr_b32 s34, s60, 2
    s_mul_i32 s34, s34, 5120
    s_and_b32 s35, s60, 3
    s_lshl_b32 s35, s35, 17
    s_add_u32 s34, s34, s35
    s_add_u32 s34, s34, 70656
    v_mul_u32_u24 v112, 1280, v6
    v_add3_u32 v112, v112, v8, s34
    s_lshr_b32 s34, s62, 1
    s_lshl_b32 s34, s34, 7
    s_and_b32 s35, s62, 1
    s_mul_i32 s35, s35, 40960
    s_add_u32 s34, s34, s35
    s_mul_i32 s35, s60, 163840
    s_add_u32 s34, s34, s35
    v_lshrrev_b32 v197, 1, v0
    v_mul_u32_u24 v197, 1280, v197
    v_and_b32 v196, 1, v0
    v_lshl_add_u32 v197, v196, 6, v197
    v_add_u32 v197, s34, v197
    s_mov_b32 s40, 81920
    s_mov_b32 s41, 1228800
    s_mov_b32 s35, 0
L_poll35:
    buffer_load_dwordx2 v[32:33], v9, s[44:47], 0 offen sc1
    s_add_u32 s35, s35, 1
    s_waitcnt vmcnt(0)
    v_max_u32 v22, v32, v33
    v_cmp_eq_u32 vcc, -1, v22
    s_cbranch_vccz L_done36
    s_sleep 16
    s_cmp_lt_u32 s35, 60000
    s_cbranch_scc1 L_poll35
L_done36:
    v_lshlrev_b32 v100, 16, v32
    v_and_b32 v101, 0xffff0000, v32
    v_lshlrev_b32 v102, 16, v33
    v_and_b32 v103, 0xffff0000, v33
L_d_none:
    v_and_b32 v19, 7, v0
    v_lshlrev_b32 v19, 3, v19
    v_add_u32 v19, 98560, v19
    s_mov_b32 s35, 0
L_poll38:
    ds_read_b64 v[20:21], v19
    s_add_u32 s35, s35, 1
    s_waitcnt lgkmcnt(0)
    v_max_u32 v22, v20, v21
    v_cmp_eq_u32 vcc, -1, v22
    s_cbranch_vccz L_done39
    s_sleep 2
    s_cmp_lt_u32 s35, 60000
    s_cbranch_scc1 L_poll38
L_done39:
    v_max_f32_dpp v22, v20, v20 row_half_mirror row_mask:0xf bank_mask:0xf
    s_nop 1
    v_max_f32_dpp v22, v22, v22 quad_perm:[1,0,3,2] row_mask:0xf bank_mask:0xf
    s_nop 1
    v_max_f32_dpp v22, v22, v22 quad_perm:[2,3,0,1] row_mask:0xf bank_mask:0xf
    v_sub_f32 v20, v20, v22
    v_exp_f32 v20, v20
    s_nop 0
    v_mul_f32 v21, v21, v20
    s_nop 1
    v_add_f32_dpp v21, v21, v21 row_half_mirror row_mask:0xf bank_mask:0xf
    s_nop 1
    v_add_f32_dpp v21, v21, v21 quad_perm:[1,0,3,2] row_mask:0xf bank_mask:0xf
    s_nop 1
    v_add_f32_dpp v21, v21, v21 quad_perm:[2,3,0,1] row_mask:0xf bank_mask:0xf
    v_rcp_f32 v23, v21
    v_log_f32 v21, v21
    v_mul_f32 v20, v20, v23
    v_add_f32 v21, v21, v22
    v_min_u32 v21, -2, v21
    v_readlane_b32 s88, v20, 0
    v_readlane_b32 s90, v20, 1
    v_readlane_b32 s92, v20, 2
    v_readlane_b32 s94, v20, 3
    v_readlane_b32 s96, v20, 4
    v_readlane_b32 s98, v20, 5
    v_readlane_b32 s100, v20, 6
    v_readlane_b32 s89, v20, 7
    s_and_b32 s95, s61, 3
    s_lshl_b32 s95, s95, 17
    s_bfe_u32 s35, s2, 0x20005
    s_lshl_b32 s35, s35, 1
    s_lshr_b32 s91, s2, 7
    s_add_u32 s35, s35, s91
    v_mov_b32 v24, v21
    v_mov_b32 v25, v21
    v_mul_f32 v20, s89, v116
    v_mul_f32 v21, s89, v117
    v_mul_f32 v22, s89, v118
    v_mul_f32 v23, s89, v119
    s_lshl_b32 s34, s60, 12
    s_lshl_b32 s35, s35, 9
    s_add_u32 s34, s34, s35
    s_add_u32 s34, s34, s95
    s_add_u32 s34, s34, 98304
    v_and_b32 v18, 7, v0
    v_lshl_add_u32 v18, v14, 3, v18
    v_bfe_u32 v19, v0, 3, 1
    v_lshl_add_u32 v18, v19, 5, v18
    v_lshl_add_u32 v18, v18, 3, s34
    v_lshlrev_b32 v19, 4, v0
    v_add_u32 v19, 99328, v19
    s_barrier
    s_cmp_ge_u32 s63, 1
    s_cbranch_scc1 L_nopf
    buffer_load_dword v250, v197, s[52:55], s42 offen
    s_add_u32 s42, s42, s40
    buffer_load_dword v250, v197, s[52:55], s42 offen
    s_add_u32 s42, s42, s41
    buffer_load_dword v250, v197, s[52:55], s42 offen
    s_add_u32 s42, s42, s40
    buffer_load_dword v250, v197, s[52:55], s42 offen
    s_add_u32 s42, s42, s41
    buffer_load_dword v250, v197, s[52:55], s42 offen
    s_add_u32 s42, s42, s40
    buffer_load_dword v250, v197, s[52:55], s42 offen
    s_add_u32 s42, s42, s41
    buffer_load_dword v250, v197, s[52:55], s42 offen
    s_add_u32 s42, s42, s40
    buffer_load_dword v250, v197, s[52:55], s42 offen
    s_add_u32 s42, s42, s41
L_nopf:
    s_barrier
    ds_read_b128 v[32:35], v19 offset:0
    ds_read_b128 v[36:39], v19 offset:1024
    ds_read_b128 v[40:43], v19 offset:2048
    ds_read_b128 v[44:47], v19 offset:3072
    ds_read_b128 v[48:51], v19 offset:4096
    ds_read_b128 v[52:55], v19 offset:5120
    ds_read_b128 v[56:59], v19 offset:6144
    s_waitcnt lgkmcnt(6)
    v_pk_fma_f32 v[20:21], v[32:33], s[88:89], v[20:21] op_sel_hi:[1,0,1]
    v_pk_fma_f32 v[22:23], v[34:35], s[88:89], v[22:23] op_sel_hi:[1,0,1]
    s_waitcnt lgkmcnt(5)
    v_pk_fma_f32 v[20:21], v[36:37], s[90:91], v[20:21] op_sel_hi:[1,0,1]
    v_pk_fma_f32 v[22:23], v[38:39], s[90:91], v[22:23] op_sel_hi:[1,0,1]
    s_waitcnt lgkmcnt(4)
    v_pk_fma_f32 v[20:21], v[40:41], s[92:93], v[20:21] op_sel_hi:[1,0,1]
    v_pk_fma_f32 v[22:23], v[42:43], s[92:93], v[22:23] op_sel_hi:[1,0,1]
    s_waitcnt lgkmcnt(3)
    v_pk_fma_f32 v[20:21], v[44:45], s[94:95], v[20:21] op_sel_hi:[1,0,1]
    v_pk_fma_f32 v[22:23], v[46:47], s[94:95], v[22:23] op_sel_hi:[1,0,1]
    s_waitcnt lgkmcnt(2)
    v_pk_fma_f32 v[20:21], v[48:49], s[96:97], v[20:21] op_sel_hi:[1,0,1]
    v_pk_fma_f32 v[22:23], v[50:51], s[96:97], v[22:23] op_sel_hi:[1,0,1]
    s_waitcnt lgkmcnt(1)
    v_pk_fma_f32 v[20:21], v[52:53], s[98:99], v[20:21] op_sel_hi:[1,0,1]
    v_pk_fma_f32 v[22:23], v[54:55], s[98:99], v[22:23] op_sel_hi:[1,0,1]
    s_waitcnt lgkmcnt(0)
    v_pk_fma_f32 v[20:21], v[56:57], s[100:101], v[20:21] op_sel_hi:[1,0,1]
    v_pk_fma_f32 v[22:23], v[58:59], s[100:101], v[22:23] op_sel_hi:[1,0,1]
    s_nop 0
    v_add_f32_dpp v20, v20, v20 row_ror:8 row_mask:0xf bank_mask:0xf
    v_add_f32_dpp v21, v21, v21 row_ror:8 row_mask:0xf bank_mask:0xf
    v_add_f32_dpp v22, v22, v22 row_ror:8 row_mask:0xf bank_mask:0xf
    v_add_f32_dpp v23, v23, v23 row_ror:8 row_mask:0xf bank_mask:0xf
    s_mov_b32 exec_lo, 0x00ff00ff
    s_mov_b32 exec_hi, 0x00ff00ff
    v_cvt_pk_bf16_f32 v24, v20, v21
    v_cvt_pk_bf16_f32 v25, v22, v23
    v_min_u32 v24, -2, v24
    v_min_u32 v25, -2, v25
    s_mov_b32 exec_lo, 16777215
    buffer_store_dwordx2 v[24:25], v18, s[44:47], 0 offen sc1
    s_mov_b64 exec, -1
    s_cmp_lt_u32 s63, 1
    s_cbranch_scc1 L_nopf2
    buffer_load_dword v250, v197, s[52:55], s42 offen
    s_add_u32 s42, s42, s40
    buffer_load_dword v250, v197, s[52:55], s42 offen
    s_add_u32 s42, s42, s41
    buffer_load_dword v250, v197, s[52:55], s42 offen
    s_add_u32 s42, s42, s40
    buffer_load_dword v250, v197, s[52:55], s42 offen
    s_add_u32 s42, s42, s41
    buffer_load_dword v250, v197, s[52:55], s42 offen
    s_add_u32 s42, s42, s40
    buffer_load_dword v250, v197, s[52:55], s42 offen
    s_add_u32 s42, s42, s41
    buffer_load_dword v250, v197, s[52:55], s42 offen
    s_add_u32 s42, s42, s40
    buffer_load_dword v250, v197, s[52:55], s42 offen
    s_add_u32 s42, s42, s41
L_nopf2:
    s_barrier
    s_cmp_eq_u32 s63, 0
    s_cbranch_scc1 L_r_wo
    buffer_load_dword v250, v197, s[52:55], s42 offen
    s_add_u32 s42, s42, s40
    buffer_load_dword v250, v197, s[52:55], s42 offen
    s_add_u32 s42, s42, s41
    s_cmp_eq_u32 s63, 1
    s_cbranch_scc1 L_r_w1
    buffer_load_dword v250, v197, s[52:55], s42 offen
    s_add_u32 s42, s42, s40
    buffer_load_dword v250, v197, s[52:55], s42 offen
    s_add_u32 s42, s42, s41
    buffer_load_dword v250, v197, s[52:55], s42 offen
    s_add_u32 s42, s42, s40
    buffer_load_dword v250, v197, s[52:55], s42 offen
    s_add_u32 s42, s42, s41
    s_cmp_eq_u32 s63, 2
    s_cbranch_scc1 L_w2_red
    s_branch L_fin
L_stream:
    s_sub_u32 s49, s3, 1
    s_lshl_b32 s49, s49, 12
    v_lshl_add_u32 v1, v0, 4, s49
    s_and_b32 s34, s2, 127
    s_lshl_b32 s34, s34, 21
    s_lshr_b32 s35, s2, 7
    s_lshl_b32 s35, s35, 18
    s_add_u32 s34, s34, s35
    s_add_u32 s34, s34, 1572864
    s_mov_b32 s38, 0x40000
    s_mov_b32 s42, 0x40000
    s_waitcnt lgkmcnt(0)
    s_add_u32 s36, s6, s34
    s_addc_u32 s37, s7, 0
    s_add_u32 s40, s8, s34
    s_addc_u32 s41, s9, 0
    s_mov_b32 s49, 0
    buffer_load_dwordx4 v[16:19], v1, s[36:39], s49 offen offset:0 nt
    buffer_load_dwordx4 v[20:23], v1, s[36:39], s49 offen offset:1024 nt
    buffer_load_dwordx4 v[24:27], v1, s[36:39], s49 offen offset:2048 nt
    s_barrier
    s_waitcnt vmcnt(2)
    buffer_load_dwordx4 v[28:31], v1, s[36:39], s49 offen offset:3072 nt
    s_waitcnt vmcnt(2)
    s_mov_b32 s49, 28672
    buffer_load_dwordx4 v[32:35], v1, s[36:39], s49 offen offset:0 nt
    s_waitcnt vmcnt(2)
    buffer_load_dwordx4 v[36:39], v1, s[36:39], s49 offen offset:1024 nt
    s_waitcnt vmcnt(2)
    buffer_load_dwordx4 v[40:43], v1, s[36:39], s49 offen offset:2048 nt
    s_waitcnt vmcnt(2)
    buffer_load_dwordx4 v[44:47], v1, s[36:39], s49 offen offset:3072 nt
    s_add_u32 s44, s32, 0
    s_addc_u32 s45, s33, 0
    s_mov_b32 s63, 0
    s_mov_b32 s62, s61
    s_cmp_lt_u32 s61, 20
    s_cbranch_scc1 L_rd41
    s_mul_i32 s62, s60, 12
    s_add_u32 s62, s62, s61
    s_sub_u32 s62, s62, 20
    s_mov_b32 s63, 1
    s_cmp_lt_u32 s62, 54
    s_cbranch_scc1 L_rd41
    s_cmp_lt_u32 s62, 56
    s_cselect_b32 s63, 3, 2
    s_sub_u32 s62, s62, 56
L_rd41:
    v_and_b32 v8, 3, v0
    v_bfe_u32 v9, v0, 2, 2
    v_lshrrev_b32 v10, 4, v0
    s_mov_b32 s55, 0x20000
    s_lshl_b32 s35, s62, 6
    s_and_b32 s49, s62, 1
    s_cmp_eq_u32 s63, 0
    s_cbranch_scc1 L_dp43
    s_cmp_eq_u32 s63, 1
    s_cbranch_scc1 L_dp44
    s_mov_b32 s52, s20
    s_mov_b32 s53, s21
    s_mov_b32 s54, 2211840
    v_mov_b32 v15, 0
    s_branch L_dp45
L_dp44:
    s_mov_b32 s52, s16
    s_mov_b32 s53, s17
    s_mov_b32 s54, 2211840
    v_lshl_add_u32 v15, v9, 3, v10
    v_mul_u32_u24 v15, 3456, v15
    v_lshl_add_u32 v15, v8, 4, v15
    v_add_u32 v15, s35, v15
    s_bfe_u32 s50, s3, 0x10001
    s_lshl_b32 s50, s50, 7
    s_and_b32 s34, s3, 1
    s_lshl_b32 s34, s34, 2
    s_add_u32 s50, s50, s34
    s_and_b32 s51, s3, 3
    s_lshl_b32 s51, s51, 5
    s_add_u32 s51, s51, 512
    s_mul_i32 s50, s50, 3456
    s_mul_i32 s51, s51, 3456
    s_branch L_dp45
L_dp43:
    s_mov_b32 s52, s12
    s_mov_b32 s53, s13
    s_mov_b32 s54, 5242880
    s_lshr_b32 s50, s3, 1
    s_lshl_b32 s50, s50, 3
    s_add_u32 s50, s50, s60
    s_and_b32 s51, s3, 1
    s_lshl_b32 s34, s50, 1
    s_add_u32 s34, s34, s51
    s_mul_i32 s34, s34, 81920
    s_add_u32 s34, s34, s35
    v_lshl_add_u32 v15, v9, 2, v10
    v_mul_u32_u24 v15, 2560, v15
    v_lshl_add_u32 v15, v8, 4, v15
    v_add_u32 v15, s34, v15
    s_lshl_b32 s56, s3, 12
    s_lshl_b32 s34, s49, 11
    s_add_u32 s56, s56, s34
    s_add_u32 s56, s56, 40960
    s_add_u32 s58, s56, 1024
    s_mul_i32 s57, s49, 40960
    s_add_u32 s59, s57, 1280
L_dp45:
    v_and_b32 v2, 15, v0
    v_lshlrev_b32 v2, 4, v2
    v_add_u32 v2, 98304, v2
    s_waitcnt vmcnt(2)
    s_mov_b32 s49, 57344
    buffer_load_dwordx4 v[48:51], v1, s[36:39], s49 offen offset:0 nt
    s_waitcnt vmcnt(2)
    buffer_load_dwordx4 v[52:55], v1, s[36:39], s49 offen offset:1024 nt
    s_waitcnt vmcnt(2)
    buffer_load_dwordx4 v[56:59], v1, s[36:39], s49 offen offset:2048 nt
    s_waitcnt vmcnt(2)
    buffer_load_dwordx4 v[60:63], v1, s[36:39], s49 offen offset:3072 nt
    s_waitcnt vmcnt(2)
    s_mov_b32 s49, 86016
    buffer_load_dwordx4 v[64:67], v1, s[36:39], s49 offen offset:0 nt
    s_waitcnt vmcnt(2)
    buffer_load_dwordx4 v[68:71], v1, s[36:39], s49 offen offset:1024 nt
    s_waitcnt vmcnt(2)
    buffer_load_dwordx4 v[72:75], v1, s[36:39], s49 offen offset:2048 nt
    s_waitcnt vmcnt(2)
    buffer_load_dwordx4 v[76:79], v1, s[36:39], s49 offen offset:3072 nt
    s_waitcnt vmcnt(2)
    s_mov_b32 s49, 114688
    buffer_load_dwordx4 v[80:83], v1, s[36:39], s49 offen offset:0 nt
    s_waitcnt vmcnt(2)
    buffer_load_dwordx4 v[84:87], v1, s[36:39], s49 offen offset:1024 nt
    s_waitcnt vmcnt(2)
    buffer_load_dwordx4 v[88:91], v1, s[36:39], s49 offen offset:2048 nt
    v_mov_b32 v3, 19
    ds_write_b32 v2, v3 offset:768
    s_waitcnt vmcnt(2)
    buffer_load_dwordx4 v[92:95], v1, s[36:39], s49 offen offset:3072 nt
    s_waitcnt vmcnt(2)
    s_mov_b32 s49, 143360
    buffer_load_dwordx4 v[96:99], v1, s[36:39], s49 offen offset:0 nt
    s_waitcnt vmcnt(2)
    buffer_load_dwordx4 v[100:103], v1, s[36:39], s49 offen offset:1024 nt
    s_waitcnt vmcnt(2)
    buffer_load_dwordx4 v[104:107], v1, s[36:39], s49 offen offset:2048 nt
    s_waitcnt vmcnt(2)
    buffer_load_dwordx4 v[108:111], v1, s[36:39], s49 offen offset:3072 nt
    s_waitcnt vmcnt(2)
    s_mov_b32 s49, 172032
    buffer_load_dwordx4 v[112:115], v1, s[36:39], s49 offen offset:0 nt
    s_waitcnt vmcnt(2)
    buffer_load_dwordx4 v[116:119], v1, s[36:39], s49 offen offset:1024 nt
    s_waitcnt vmcnt(2)
    buffer_load_dwordx4 v[120:123], v1, s[36:39], s49 offen offset:2048 nt
    s_waitcnt vmcnt(2)
    buffer_load_dwordx4 v[124:127], v1, s[36:39], s49 offen offset:3072 nt
    s_waitcnt vmcnt(2)
    s_mov_b32 s49, 200704
    buffer_load_dwordx4 v[128:131], v1, s[36:39], s49 offen offset:0 nt
    s_waitcnt vmcnt(2)
    buffer_load_dwordx4 v[132:135], v1, s[36:39], s49 offen offset:1024 nt
    s_waitcnt vmcnt(2)
    buffer_load_dwordx4 v[136:139], v1, s[36:39], s49 offen offset:2048 nt
    v_mov_b32 v3, 31
    ds_write_b32 v2, v3 offset:768
    s_waitcnt vmcnt(2)
    buffer_load_dwordx4 v[140:143], v1, s[36:39], s49 offen offset:3072 nt
    s_waitcnt vmcnt(2)
    s_mov_b32 s49, 229376
    buffer_load_dwordx4 v[144:147], v1, s[36:39], s49 offen offset:0 nt
    s_waitcnt vmcnt(2)
    buffer_load_dwordx4 v[148:151], v1, s[36:39], s49 offen offset:1024 nt
    s_waitcnt vmcnt(2)
    buffer_load_dwordx4 v[152:155], v1, s[36:39], s49 offen offset:2048 nt
    s_waitcnt vmcnt(2)
    buffer_load_dwordx4 v[156:159], v1, s[36:39], s49 offen offset:3072 nt
    s_waitcnt vmcnt(2)
    s_mov_b32 s49, 0
    buffer_load_dwordx4 v[160:163], v1, s[40:43], s49 offen offset:0 nt
    s_waitcnt vmcnt(2)
    buffer_load_dwordx4 v[164:167], v1, s[40:43], s49 offen offset:1024 nt
    s_waitcnt vmcnt(2)
    buffer_load_dwordx4 v[168:171], v1, s[40:43], s49 offen offset:2048 nt
    s_waitcnt vmcnt(2)
    buffer_load_dwordx4 v[172:175], v1, s[40:43], s49 offen offset:3072 nt
    s_waitcnt vmcnt(2)
    s_mov_b32 s49, 28672
    buffer_load_dwordx4 v[176:179], v1, s[40:43], s49 offen offset:0 nt
    s_waitcnt vmcnt(2)
    buffer_load_dwordx4 v[180:183], v1, s[40:43], s49 offen offset:1024 nt
    s_waitcnt vmcnt(2)
    buffer_load_dwordx4 v[184:187], v1, s[40:43], s49 offen offset:2048 nt
    s_waitcnt vmcnt(2)
    buffer_load_dwordx4 v[188:191], v1, s[40:43], s49 offen offset:3072 nt
    s_waitcnt vmcnt(2)
    s_cmp_ge_u32 s3, 4
    s_cbranch_scc1 L_sl46
    s_waitcnt vmcnt(1)
L_sl46:
    s_mov_b32 s49, 57344
    buffer_load_dwordx4 v[192:195], v1, s[40:43], s49 offen offset:0 nt
    s_waitcnt vmcnt(2)
    s_cmp_ge_u32 s3, 4
    s_cbranch_scc1 L_sl47
    s_waitcnt vmcnt(1)
L_sl47:
    buffer_load_dwordx4 v[196:199], v1, s[40:43], s49 offen offset:1024 nt
    s_waitcnt vmcnt(2)
    s_cmp_ge_u32 s3, 4
    s_cbranch_scc1 L_sl48
    s_waitcnt vmcnt(1)
L_sl48:
    buffer_load_dwordx4 v[200:203], v1, s[40:43], s49 offen offset:2048 nt
    s_waitcnt vmcnt(2)
    buffer_load_dwordx4 v[204:207], v1, s[40:43], s49 offen offset:3072 nt
    s_waitcnt vmcnt(2)
    s_mov_b32 s49, 86016
    buffer_load_dwordx4 v[208:211], v1, s[40:43], s49 offen offset:0 nt
    s_waitcnt vmcnt(2)
    buffer_load_dwordx4 v[212:215], v1, s[40:43], s49 offen offset:1024 nt
    s_waitcnt vmcnt(2)
    buffer_load_dwordx4 v[216:219], v1, s[40:43], s49 offen offset:2048 nt
    s_waitcnt vmcnt(2)
    buffer_load_dwordx4 v[220:223], v1, s[40:43], s49 offen offset:3072 nt
    s_waitcnt vmcnt(2)
    s_mov_b32 s49, 114688
    buffer_load_dwordx4 v[224:227], v1, s[40:43], s49 offen offset:0 nt
    s_waitcnt vmcnt(2)
    buffer_load_dwordx4 v[228:231], v1, s[40:43], s49 offen offset:1024 nt
    s_waitcnt vmcnt(2)
    buffer_load_dwordx4 v[232:235], v1, s[40:43], s49 offen offset:2048 nt
    s_waitcnt vmcnt(2)
    buffer_load_dwordx4 v[236:239], v1, s[40:43], s49 offen offset:3072 nt
    s_mov_b32 s35, 0
L_poll49:
    ds_read_b128 v[4:7], v2
    s_add_u32 s35, s35, 1
    s_waitcnt lgkmcnt(0)
    v_max3_u32 v3, v4, v5, v6
    v_max_u32 v3, v3, v7
    v_cmp_eq_u32 vcc, -1, v3
    s_cbranch_vccz L_done50
    s_sleep 2
    s_cmp_lt_u32 s35, 60000
    s_cbranch_scc1 L_poll49
L_done50:
    s_waitcnt vmcnt(2)
    s_mov_b32 s49, 143360
    buffer_load_dwordx4 v[240:243], v1, s[40:43], s49 offen offset:0 nt
    v_dot2_f32_bf16 v8, v16, v4, 0
    v_dot2_f32_bf16 v9, v20, v4, 0
    v_dot2_f32_bf16 v10, v24, v4, 0
    v_dot2_f32_bf16 v11, v28, v4, 0
    v_dot2c_f32_bf16 v8, v17, v5
    v_dot2c_f32_bf16 v9, v21, v5
    v_dot2c_f32_bf16 v10, v25, v5
    v_dot2c_f32_bf16 v11, v29, v5
    v_dot2c_f32_bf16 v8, v18, v6
    v_dot2c_f32_bf16 v9, v22, v6
    v_dot2c_f32_bf16 v10, v26, v6
    v_dot2c_f32_bf16 v11, v30, v6
    v_dot2c_f32_bf16 v8, v19, v7
    v_dot2c_f32_bf16 v9, v23, v7
    v_dot2c_f32_bf16 v10, v27, v7
    v_dot2c_f32_bf16 v11, v31, v7
    v_add_f32_dpp v12, v8, v8 row_ror:8 row_mask:0xf bank_mask:0x3
    v_add_f32_dpp v12, v9, v9 row_ror:8 row_mask:0xf bank_mask:0xc
    v_add_f32_dpp v13, v10, v10 row_ror:8 row_mask:0xf bank_mask:0x3
    v_add_f32_dpp v13, v11, v11 row_ror:8 row_mask:0xf bank_mask:0xc
    v_dot2_f32_bf16 v8, v32, v4, 0
    v_dot2_f32_bf16 v9, v36, v4, 0
    v_dot2_f32_bf16 v10, v40, v4, 0
    v_dot2_f32_bf16 v11, v44, v4, 0
    v_add_f32_dpp v12, v12, v12 row_half_mirror row_mask:0xf bank_mask:0xf
    v_add_f32_dpp v13, v13, v13 row_half_mirror row_mask:0xf bank_mask:0xf
    v_dot2c_f32_bf16 v8, v33, v5
    v_dot2c_f32_bf16 v9, v37, v5
    v_dot2c_f32_bf16 v10, v41, v5
    v_dot2c_f32_bf16 v11, v45, v5
    v_add_f32_dpp v12, v12, v12 quad_perm:[1,0,3,2] row_mask:0xf bank_mask:0xf
    v_add_f32_dpp v13, v13, v13 quad_perm:[1,0,3,2] row_mask:0xf bank_mask:0xf
    v_dot2c_f32_bf16 v8, v34, v6
    v_dot2c_f32_bf16 v9, v38, v6
    v_dot2c_f32_bf16 v10, v42, v6
    v_dot2c_f32_bf16 v11, v46, v6
    s_waitcnt vmcnt(2)
    buffer_load_dwordx4 v[244:247], v1, s[40:43], s49 offen offset:1024 nt
    v_add_f32_dpp v12, v12, v12 quad_perm:[2,3,0,1] row_mask:0xf bank_mask:0xf
    v_add_f32_dpp v13, v13, v13 quad_perm:[2,3,0,1] row_mask:0xf bank_mask:0xf
    v_dot2c_f32_bf16 v8, v35, v7
    v_dot2c_f32_bf16 v9, v39, v7
    v_dot2c_f32_bf16 v10, v43, v7
    v_dot2c_f32_bf16 v11, v47, v7
    v_add_f32_dpp v16, v8, v8 row_ror:8 row_mask:0xf bank_mask:0x3
    v_add_f32_dpp v16, v9, v9 row_ror:8 row_mask:0xf bank_mask:0xc
    v_add_f32_dpp v17, v10, v10 row_ror:8 row_mask:0xf bank_mask:0x3
    v_add_f32_dpp v17, v11, v11 row_ror:8 row_mask:0xf bank_mask:0xc
    v_dot2_f32_bf16 v8, v48, v4, 0
    v_dot2_f32_bf16 v9, v52, v4, 0
    v_dot2_f32_bf16 v10, v56, v4, 0
    v_dot2_f32_bf16 v11, v60, v4, 0
    v_add_f32_dpp v16, v16, v16 row_half_mirror row_mask:0xf bank_mask:0xf
    v_add_f32_dpp v17, v17, v17 row_half_mirror row_mask:0xf bank_mask:0xf
    v_dot2c_f32_bf16 v8, v49, v5
    v_dot2c_f32_bf16 v9, v53, v5
    v_dot2c_f32_bf16 v10, v57, v5
    v_dot2c_f32_bf16 v11, v61, v5
    v_add_f32_dpp v16, v16, v16 quad_perm:[1,0,3,2] row_mask:0xf bank_mask:0xf
    v_add_f32_dpp v17, v17, v17 quad_perm:[1,0,3,2] row_mask:0xf bank_mask:0xf
    v_dot2c_f32_bf16 v8, v50, v6
    v_dot2c_f32_bf16 v9, v54, v6
    v_dot2c_f32_bf16 v10, v58, v6
    v_dot2c_f32_bf16 v11, v62, v6
    v_add_f32_dpp v16, v16, v16 quad_perm:[2,3,0,1] row_mask:0xf bank_mask:0xf
    v_add_f32_dpp v17, v17, v17 quad_perm:[2,3,0,1] row_mask:0xf bank_mask:0xf
    v_dot2c_f32_bf16 v8, v51, v7
    v_dot2c_f32_bf16 v9, v55, v7
    v_dot2c_f32_bf16 v10, v59, v7
    v_dot2c_f32_bf16 v11, v63, v7
    v_add_f32_dpp v18, v8, v8 row_ror:8 row_mask:0xf bank_mask:0x3
    v_add_f32_dpp v18, v9, v9 row_ror:8 row_mask:0xf bank_mask:0xc
    v_add_f32_dpp v19, v10, v10 row_ror:8 row_mask:0xf bank_mask:0x3
    v_add_f32_dpp v19, v11, v11 row_ror:8 row_mask:0xf bank_mask:0xc
    s_waitcnt vmcnt(2)
    buffer_load_dwordx4 v[248:251], v1, s[40:43], s49 offen offset:2048 nt
    v_dot2_f32_bf16 v8, v64, v4, 0
    v_dot2_f32_bf16 v9, v68, v4, 0
    v_dot2_f32_bf16 v10, v72, v4, 0
    v_dot2_f32_bf16 v11, v76, v4, 0
    v_add_f32_dpp v18, v18, v18 row_half_mirror row_mask:0xf bank_mask:0xf
    v_add_f32_dpp v19, v19, v19 row_half_mirror row_mask:0xf bank_mask:0xf
    v_dot2c_f32_bf16 v8, v65, v5
    v_dot2c_f32_bf16 v9, v69, v5
    v_dot2c_f32_bf16 v10, v73, v5
    v_dot2c_f32_bf16 v11, v77, v5
    v_add_f32_dpp v18, v18, v18 quad_perm:[1,0,3,2] row_mask:0xf bank_mask:0xf
    v_add_f32_dpp v19, v19, v19 quad_perm:[1,0,3,2] row_mask:0xf bank_mask:0xf
    v_dot2c_f32_bf16 v8, v66, v6
    v_dot2c_f32_bf16 v9, v70, v6
    v_dot2c_f32_bf16 v10, v74, v6
    v_dot2c_f32_bf16 v11, v78, v6
    v_add_f32_dpp v18, v18, v18 quad_perm:[2,3,0,1] row_mask:0xf bank_mask:0xf
    v_add_f32_dpp v19, v19, v19 quad_perm:[2,3,0,1] row_mask:0xf bank_mask:0xf
    v_dot2c_f32_bf16 v8, v67, v7
    v_dot2c_f32_bf16 v9, v71, v7
    v_dot2c_f32_bf16 v10, v75, v7
    v_dot2c_f32_bf16 v11, v79, v7
    v_add_f32_dpp v20, v8, v8 row_ror:8 row_mask:0xf bank_mask:0x3
    v_add_f32_dpp v20, v9, v9 row_ror:8 row_mask:0xf bank_mask:0xc
    v_add_f32_dpp v21, v10, v10 row_ror:8 row_mask:0xf bank_mask:0x3
    v_add_f32_dpp v21, v11, v11 row_ror:8 row_mask:0xf bank_mask:0xc
    v_dot2_f32_bf16 v8, v80, v4, 0
    v_dot2_f32_bf16 v9, v84, v4, 0
    v_dot2_f32_bf16 v10, v88, v4, 0
    v_dot2_f32_bf16 v11, v92, v4, 0
    v_add_f32_dpp v20, v20, v20 row_half_mirror row_mask:0xf bank_mask:0xf
    v_add_f32_dpp v21, v21, v21 row_half_mirror row_mask:0xf bank_mask:0xf
    v_dot2c_f32_bf16 v8, v81, v5
    v_dot2c_f32_bf16 v9, v85, v5
    v_dot2c_f32_bf16 v10, v89, v5
    v_dot2c_f32_bf16 v11, v93, v5
    s_waitcnt vmcnt(2)
    buffer_load_dwordx4 v[252:255], v1, s[40:43], s49 offen offset:3072 nt
    v_add_f32_dpp v20, v20, v20 quad_perm:[1,0,3,2] row_mask:0xf bank_mask:0xf
    v_add_f32_dpp v21, v21, v21 quad_perm:[1,0,3,2] row_mask:0xf bank_mask:0xf
    v_dot2c_f32_bf16 v8, v82, v6
    v_dot2c_f32_bf16 v9, v86, v6
    v_dot2c_f32_bf16 v10, v90, v6
    v_dot2c_f32_bf16 v11, v94, v6
    v_add_f32_dpp v20, v20, v20 quad_perm:[2,3,0,1] row_mask:0xf bank_mask:0xf
    v_add_f32_dpp v21, v21, v21 quad_perm:[2,3,0,1] row_mask:0xf bank_mask:0xf
    v_dot2c_f32_bf16 v8, v83, v7
    v_dot2c_f32_bf16 v9, v87, v7
    v_dot2c_f32_bf16 v10, v91, v7
    v_dot2c_f32_bf16 v11, v95, v7
    v_add_f32_dpp v22, v8, v8 row_ror:8 row_mask:0xf bank_mask:0x3
    v_add_f32_dpp v22, v9, v9 row_ror:8 row_mask:0xf bank_mask:0xc
    v_add_f32_dpp v23, v10, v10 row_ror:8 row_mask:0xf bank_mask:0x3
    v_add_f32_dpp v23, v11, v11 row_ror:8 row_mask:0xf bank_mask:0xc
    v_dot2_f32_bf16 v8, v96, v4, 0
    v_dot2_f32_bf16 v9, v100, v4, 0
    v_dot2_f32_bf16 v10, v104, v4, 0
    v_dot2_f32_bf16 v11, v108, v4, 0
    v_add_f32_dpp v22, v22, v22 row_half_mirror row_mask:0xf bank_mask:0xf
    v_add_f32_dpp v23, v23, v23 row_half_mirror row_mask:0xf bank_mask:0xf
    v_dot2c_f32_bf16 v8, v97, v5
    v_dot2c_f32_bf16 v9, v101, v5
    v_dot2c_f32_bf16 v10, v105, v5
    v_dot2c_f32_bf16 v11, v109, v5
    v_add_f32_dpp v22, v22, v22 quad_perm:[1,0,3,2] row_mask:0xf bank_mask:0xf
    v_add_f32_dpp v23, v23, v23 quad_perm:[1,0,3,2] row_mask:0xf bank_mask:0xf
    v_dot2c_f32_bf16 v8, v98, v6
    v_dot2c_f32_bf16 v9, v102, v6
    v_dot2c_f32_bf16 v10, v106, v6
    v_dot2c_f32_bf16 v11, v110, v6
    v_add_f32_dpp v22, v22, v22 quad_perm:[2,3,0,1] row_mask:0xf bank_mask:0xf
    v_add_f32_dpp v23, v23, v23 quad_perm:[2,3,0,1] row_mask:0xf bank_mask:0xf
    v_dot2c_f32_bf16 v8, v99, v7
    v_dot2c_f32_bf16 v9, v103, v7
    s_waitcnt vmcnt(2)
    s_mov_b32 s49, 172032
    buffer_load_dwordx4 v[32:35], v1, s[40:43], s49 offen offset:0 nt
    v_dot2c_f32_bf16 v10, v107, v7
    v_dot2c_f32_bf16 v11, v111, v7
    v_add_f32_dpp v24, v8, v8 row_ror:8 row_mask:0xf bank_mask:0x3
    v_add_f32_dpp v24, v9, v9 row_ror:8 row_mask:0xf bank_mask:0xc
    v_add_f32_dpp v25, v10, v10 row_ror:8 row_mask:0xf bank_mask:0x3
    v_add_f32_dpp v25, v11, v11 row_ror:8 row_mask:0xf bank_mask:0xc
    v_dot2_f32_bf16 v8, v112, v4, 0
    v_dot2_f32_bf16 v9, v116, v4, 0
    v_dot2_f32_bf16 v10, v120, v4, 0
    v_dot2_f32_bf16 v11, v124, v4, 0
    v_add_f32_dpp v24, v24, v24 row_half_mirror row_mask:0xf bank_mask:0xf
    v_add_f32_dpp v25, v25, v25 row_half_mirror row_mask:0xf bank_mask:0xf
    v_dot2c_f32_bf16 v8, v113, v5
    v_dot2c_f32_bf16 v9, v117, v5
    v_dot2c_f32_bf16 v10, v121, v5
    v_dot2c_f32_bf16 v11, v125, v5
    v_add_f32_dpp v24, v24, v24 quad_perm:[1,0,3,2] row_mask:0xf bank_mask:0xf
    v_add_f32_dpp v25, v25, v25 quad_perm:[1,0,3,2] row_mask:0xf bank_mask:0xf
    v_dot2c_f32_bf16 v8, v114, v6
    v_dot2c_f32_bf16 v9, v118, v6
    v_dot2c_f32_bf16 v10, v122, v6
    v_dot2c_f32_bf16 v11, v126, v6
    v_add_f32_dpp v24, v24, v24 quad_perm:[2,3,0,1] row_mask:0xf bank_mask:0xf
    v_add_f32_dpp v25, v25, v25 quad_perm:[2,3,0,1] row_mask:0xf bank_mask:0xf
    v_dot2c_f32_bf16 v8, v115, v7
    v_dot2c_f32_bf16 v9, v119, v7
    v_dot2c_f32_bf16 v10, v123, v7
    v_dot2c_f32_bf16 v11, v127, v7
    v_add_f32_dpp v26, v8, v8 row_ror:8 row_mask:0xf bank_mask:0x3
    v_add_f32_dpp v26, v9, v9 row_ror:8 row_mask:0xf bank_mask:0xc
    v_add_f32_dpp v27, v10, v10 row_ror:8 row_mask:0xf bank_mask:0x3
    v_add_f32_dpp v27, v11, v11 row_ror:8 row_mask:0xf bank_mask:0xc
    v_dot2_f32_bf16 v8, v128, v4, 0
    v_dot2_f32_bf16 v9, v132, v4, 0
    v_dot2_f32_bf16 v10, v136, v4, 0
    v_dot2_f32_bf16 v11, v140, v4, 0
    s_waitcnt vmcnt(2)
    buffer_load_dwordx4 v[36:39], v1, s[40:43], s49 offen offset:1024 nt
    v_add_f32_dpp v26, v26, v26 row_half_mirror row_mask:0xf bank_mask:0xf
    v_add_f32_dpp v27, v27, v27 row_half_mirror row_mask:0xf bank_mask:0xf
    v_dot2c_f32_bf16 v8, v129, v5
    v_dot2c_f32_bf16 v9, v133, v5
    v_dot2c_f32_bf16 v10, v137, v5
    v_dot2c_f32_bf16 v11, v141, v5
    v_add_f32_dpp v26, v26, v26 quad_perm:[1,0,3,2] row_mask:0xf bank_mask:0xf
    v_add_f32_dpp v27, v27, v27 quad_perm:[1,0,3,2] row_mask:0xf bank_mask:0xf
    v_dot2c_f32_bf16 v8, v130, v6
    v_dot2c_f32_bf16 v9, v134, v6
    v_dot2c_f32_bf16 v10, v138, v6
    v_dot2c_f32_bf16 v11, v142, v6
    v_add_f32_dpp v26, v26, v26 quad_perm:[2,3,0,1] row_mask:0xf bank_mask:0xf
    v_add_f32_dpp v27, v27, v27 quad_perm:[2,3,0,1] row_mask:0xf bank_mask:0xf
    v_dot2c_f32_bf16 v8, v131, v7
    v_dot2c_f32_bf16 v9, v135, v7
    v_dot2c_f32_bf16 v10, v139, v7
    v_dot2c_f32_bf16 v11, v143, v7
    v_add_f32_dpp v28, v8, v8 row_ror:8 row_mask:0xf bank_mask:0x3
    v_add_f32_dpp v28, v9, v9 row_ror:8 row_mask:0xf bank_mask:0xc
    v_add_f32_dpp v29, v10, v10 row_ror:8 row_mask:0xf bank_mask:0x3
    v_add_f32_dpp v29, v11, v11 row_ror:8 row_mask:0xf bank_mask:0xc
    v_dot2_f32_bf16 v8, v144, v4, 0
    v_dot2_f32_bf16 v9, v148, v4, 0
    v_dot2_f32_bf16 v10, v152, v4, 0
    v_dot2_f32_bf16 v11, v156, v4, 0
    v_add_f32_dpp v28, v28, v28 row_half_mirror row_mask:0xf bank_mask:0xf
    v_add_f32_dpp v29, v29, v29 row_half_mirror row_mask:0xf bank_mask:0xf
    v_dot2c_f32_bf16 v8, v145, v5
    v_dot2c_f32_bf16 v9, v149, v5
    v_dot2c_f32_bf16 v10, v153, v5
    v_dot2c_f32_bf16 v11, v157, v5
    v_add_f32_dpp v28, v28, v28 quad_perm:[1,0,3,2] row_mask:0xf bank_mask:0xf
    v_add_f32_dpp v29, v29, v29 quad_perm:[1,0,3,2] row_mask:0xf bank_mask:0xf
    v_dot2c_f32_bf16 v8, v146, v6
    v_dot2c_f32_bf16 v9, v150, v6
    buffer_load_dwordx4 v[40:43], v1, s[40:43], s49 offen offset:2048 nt
    v_dot2c_f32_bf16 v10, v154, v6
    v_dot2c_f32_bf16 v11, v158, v6
    v_add_f32_dpp v28, v28, v28 quad_perm:[2,3,0,1] row_mask:0xf bank_mask:0xf
    v_add_f32_dpp v29, v29, v29 quad_perm:[2,3,0,1] row_mask:0xf bank_mask:0xf
    v_dot2c_f32_bf16 v8, v147, v7
    v_dot2c_f32_bf16 v9, v151, v7
    v_dot2c_f32_bf16 v10, v155, v7
    v_dot2c_f32_bf16 v11, v159, v7
    v_add_f32_dpp v30, v8, v8 row_ror:8 row_mask:0xf bank_mask:0x3
    v_add_f32_dpp v30, v9, v9 row_ror:8 row_mask:0xf bank_mask:0xc
    v_add_f32_dpp v31, v10, v10 row_ror:8 row_mask:0xf bank_mask:0x3
    v_add_f32_dpp v31, v11, v11 row_ror:8 row_mask:0xf bank_mask:0xc
    v_add_f32_dpp v30, v30, v30 row_half_mirror row_mask:0xf bank_mask:0xf
    s_nop 0
    v_add_f32_dpp v31, v31, v31 row_half_mirror row_mask:0xf bank_mask:0xf
    v_add_f32_dpp v30, v30, v30 quad_perm:[1,0,3,2] row_mask:0xf bank_mask:0xf
    s_nop 0
    v_add_f32_dpp v31, v31, v31 quad_perm:[1,0,3,2] row_mask:0xf bank_mask:0xf
    v_add_f32_dpp v30, v30, v30 quad_perm:[2,3,0,1] row_mask:0xf bank_mask:0xf
    s_nop 0
    v_add_f32_dpp v31, v31, v31 quad_perm:[2,3,0,1] row_mask:0xf bank_mask:0xf
    v_max3_f32 v8, v12, v13, v16
    v_max3_f32 v8, v8, v17, v18
    v_max3_f32 v8, v8, v19, v20
    v_max3_f32 v8, v8, v21, v22
    v_max3_f32 v8, v8, v23, v24
    v_max3_f32 v8, v8, v25, v26
    v_max3_f32 v8, v8, v27, v28
    v_max3_f32 v8, v8, v29, v30
    v_max_f32 v8, v8, v31
    s_mov_b32 s34, 0x3e0293ee
    s_nop 0
    v_max_f32_dpp v8, v8, v8 row_ror:8 row_mask:0xf bank_mask:0xf
    v_mov_b32 v9, v8
    s_nop 1
    v_permlane16_swap_b32 v8, v9
    v_max_f32 v8, v8, v9
    v_mov_b32 v9, v8
    s_nop 1
    v_permlane32_swap_b32 v8, v9
    v_max_f32 v8, v8, v9
    v_mul_f32 v8, s34, v8
    s_waitcnt vmcnt(3)
    buffer_load_dwordx4 v[44:47], v1, s[40:43], s49 offen offset:3072 nt
    v_fma_f32 v12, v12, s34, -v8
    v_fma_f32 v13, v13, s34, -v8
    v_fma_f32 v16, v16, s34, -v8
    v_fma_f32 v17, v17, s34, -v8
    v_fma_f32 v18, v18, s34, -v8
    v_fma_f32 v19, v19, s34, -v8
    v_fma_f32 v20, v20, s34, -v8
    v_fma_f32 v21, v21, s34, -v8
    v_fma_f32 v22, v22, s34, -v8
    v_fma_f32 v23, v23, s34, -v8
    v_fma_f32 v24, v24, s34, -v8
    v_fma_f32 v25, v25, s34, -v8
    v_fma_f32 v26, v26, s34, -v8
    v_fma_f32 v27, v27, s34, -v8
    v_fma_f32 v28, v28, s34, -v8
    v_fma_f32 v29, v29, s34, -v8
    v_fma_f32 v30, v30, s34, -v8
    v_fma_f32 v31, v31, s34, -v8
    v_exp_f32 v12, v12
    v_exp_f32 v13, v13
    v_exp_f32 v16, v16
    v_exp_f32 v17, v17
    v_exp_f32 v18, v18
    v_exp_f32 v19, v19
    v_exp_f32 v20, v20
    v_exp_f32 v21, v21
    v_exp_f32 v22, v22
    v_exp_f32 v23, v23
    v_exp_f32 v24, v24
    v_exp_f32 v25, v25
    v_exp_f32 v26, v26
    v_exp_f32 v27, v27
    v_exp_f32 v28, v28
    v_exp_f32 v29, v29
    v_exp_f32 v30, v30
    v_exp_f32 v31, v31
    s_waitcnt vmcnt(3)
    s_mov_b32 s49, 200704
    buffer_load_dwordx4 v[48:51], v1, s[40:43], s49 offen offset:0 nt
    v_add_f32 v9, v12, v13
    v_add_f32 v9, v9, v16
    v_add_f32 v9, v9, v17
    v_add_f32 v9, v9, v18
    v_add_f32 v9, v9, v19
    v_add_f32 v9, v9, v20
    v_add_f32 v9, v9, v21
    v_add_f32 v9, v9, v22
    v_add_f32 v9, v9, v23
    v_add_f32 v9, v9, v24
    v_add_f32 v9, v9, v25
    v_add_f32 v9, v9, v26
    v_add_f32 v9, v9, v27
    v_add_f32 v9, v9, v28
    v_add_f32 v9, v9, v29
    v_add_f32 v9, v9, v30
    v_add_f32 v9, v9, v31
    v_and_b32 v10, 1, v0
    v_lshlrev_b32 v10, 4, v10
    v_mov_b32 v11, 0xffff
    v_lshlrev_b32 v10, v10, v11
    v_bfe_u32 v11, v0, 1, 2
    v_cmp_eq_u32 vcc, 0, v11
    s_nop 1
    v_cndmask_b32 v144, 0, v10, vcc
    v_cmp_eq_u32 vcc, 1, v11
    s_nop 1
    v_cndmask_b32 v145, 0, v10, vcc
    v_cmp_eq_u32 vcc, 2, v11
    s_nop 1
    v_cndmask_b32 v146, 0, v10, vcc
    v_cmp_eq_u32 vcc, 3, v11
    s_nop 1
    v_cndmask_b32 v147, 0, v10, vcc
    v_add_f32_dpp v9, v9, v9 row_ror:8 row_mask:0xf bank_mask:0xf
    v_mov_b32 v10, v9
    s_nop 1
    v_permlane16_swap_b32 v9, v10
    v_add_f32 v9, v9, v10
    v_mov_b32 v10, v9
    s_nop 1
    v_permlane32_swap_b32 v9, v10
    s_waitcnt vmcnt(3)
    buffer_load_dwordx4 v[52:55], v1, s[40:43], s49 offen offset:1024 nt
    v_add_f32 v9, v9, v10
    s_lshl_b32 s34, s3, 3
    s_add_u32 s34, s34, 98552
    v_mov_b32 v10, s34
    s_mov_b64 exec, 1
    ds_write_b64 v10, v[8:9]
    s_mov_b64 exec, -1
    s_lshl_b32 s34, s3, 10
    s_add_u32 s34, s34, 98304
    v_lshl_add_u32 v2, v0, 4, s34
    v_cvt_pk_bf16_f32 v10, v12, v12
    v_and_b32 v128, v10, v144
    v_and_b32 v129, v10, v145
    v_and_b32 v130, v10, v146
    v_and_b32 v131, v10, v147
    s_nop 1
    v_mfma_f32_16x16x32_bf16 v[148:151], v[160:163], v[128:131], 0
    v_mfma_f32_16x16x32_bf16 v[152:155], v[164:167], v[128:131], 0
    v_cvt_pk_bf16_f32 v10, v13, v13
    v_and_b32 v132, v10, v144
    v_and_b32 v133, v10, v145
    v_and_b32 v134, v10, v146
    v_and_b32 v135, v10, v147
    s_nop 1
    v_mfma_f32_16x16x32_bf16 v[148:151], v[168:171], v[132:135], v[148:151]
    v_mfma_f32_16x16x32_bf16 v[152:155], v[172:175], v[132:135], v[152:155]
    v_cvt_pk_bf16_f32 v10, v16, v16
    v_and_b32 v128, v10, v144
    v_and_b32 v129, v10, v145
    v_and_b32 v130, v10, v146
    v_and_b32 v131, v10, v147
    s_nop 1
    v_mfma_f32_16x16x32_bf16 v[148:151], v[176:179], v[128:131], v[148:151]
    v_mfma_f32_16x16x32_bf16 v[152:155], v[180:183], v[128:131], v[152:155]
    v_cvt_pk_bf16_f32 v10, v17, v17
    v_and_b32 v132, v10, v144
    v_and_b32 v133, v10, v145
    v_and_b32 v134, v10, v146
    v_and_b32 v135, v10, v147
    s_nop 1
    v_mfma_f32_16x16x32_bf16 v[148:151], v[184:187], v[132:135], v[148:151]
    v_mfma_f32_16x16x32_bf16 v[152:155], v[188:191], v[132:135], v[152:155]
    s_waitcnt vmcnt(3)
    buffer_load_dwordx4 v[56:59], v1, s[40:43], s49 offen offset:2048 nt
    v_cvt_pk_bf16_f32 v10, v18, v18
    v_and_b32 v128, v10, v144
    v_and_b32 v129, v10, v145
    v_and_b32 v130, v10, v146
    v_and_b32 v131, v10, v147
    s_nop 1
    v_mfma_f32_16x16x32_bf16 v[148:151], v[192:195], v[128:131], v[148:151]
    v_mfma_f32_16x16x32_bf16 v[152:155], v[196:199], v[128:131], v[152:155]
    v_cvt_pk_bf16_f32 v10, v19, v19
    v_and_b32 v132, v10, v144
    v_and_b32 v133, v10, v145
    v_and_b32 v134, v10, v146
    v_and_b32 v135, v10, v147
    s_nop 1
    v_mfma_f32_16x16x32_bf16 v[148:151], v[200:203], v[132:135], v[148:151]
    v_mfma_f32_16x16x32_bf16 v[152:155], v[204:207], v[132:135], v[152:155]
    v_cvt_pk_bf16_f32 v10, v20, v20
    v_and_b32 v128, v10, v144
    v_and_b32 v129, v10, v145
    v_and_b32 v130, v10, v146
    v_and_b32 v131, v10, v147
    s_nop 1
    v_mfma_f32_16x16x32_bf16 v[148:151], v[208:211], v[128:131], v[148:151]
    v_mfma_f32_16x16x32_bf16 v[152:155], v[212:215], v[128:131], v[152:155]
    v_cvt_pk_bf16_f32 v10, v21, v21
    v_and_b32 v132, v10, v144
    v_and_b32 v133, v10, v145
    v_and_b32 v134, v10, v146
    v_and_b32 v135, v10, v147
    s_nop 1
    v_mfma_f32_16x16x32_bf16 v[148:151], v[216:219], v[132:135], v[148:151]
    v_mfma_f32_16x16x32_bf16 v[152:155], v[220:223], v[132:135], v[152:155]
    v_cvt_pk_bf16_f32 v10, v22, v22
    v_and_b32 v128, v10, v144
    v_and_b32 v129, v10, v145
    v_and_b32 v130, v10, v146
    v_and_b32 v131, v10, v147
    s_nop 1
    v_mfma_f32_16x16x32_bf16 v[148:151], v[224:227], v[128:131], v[148:151]
    v_mfma_f32_16x16x32_bf16 v[152:155], v[228:231], v[128:131], v[152:155]
    v_cvt_pk_bf16_f32 v10, v23, v23
    s_waitcnt vmcnt(3)
    buffer_load_dwordx4 v[60:63], v1, s[40:43], s49 offen offset:3072 nt
    v_and_b32 v132, v10, v144
    v_and_b32 v133, v10, v145
    v_and_b32 v134, v10, v146
    v_and_b32 v135, v10, v147
    s_nop 1
    v_mfma_f32_16x16x32_bf16 v[148:151], v[232:235], v[132:135], v[148:151]
    v_mfma_f32_16x16x32_bf16 v[152:155], v[236:239], v[132:135], v[152:155]
    v_cvt_pk_bf16_f32 v10, v24, v24
    v_and_b32 v128, v10, v144
    v_and_b32 v129, v10, v145
    v_and_b32 v130, v10, v146
    v_and_b32 v131, v10, v147
    s_nop 1
    v_mfma_f32_16x16x32_bf16 v[148:151], v[240:243], v[128:131], v[148:151]
    v_mfma_f32_16x16x32_bf16 v[152:155], v[244:247], v[128:131], v[152:155]
    v_cvt_pk_bf16_f32 v10, v25, v25
    v_and_b32 v132, v10, v144
    v_and_b32 v133, v10, v145
    v_and_b32 v134, v10, v146
    v_and_b32 v135, v10, v147
    s_nop 1
    v_mfma_f32_16x16x32_bf16 v[148:151], v[248:251], v[132:135], v[148:151]
    v_mfma_f32_16x16x32_bf16 v[152:155], v[252:255], v[132:135], v[152:155]
    v_cvt_pk_bf16_f32 v10, v26, v26
    v_and_b32 v128, v10, v144
    v_and_b32 v129, v10, v145
    v_and_b32 v130, v10, v146
    v_and_b32 v131, v10, v147
    s_nop 1
    v_mfma_f32_16x16x32_bf16 v[148:151], v[32:35], v[128:131], v[148:151]
    v_mfma_f32_16x16x32_bf16 v[152:155], v[36:39], v[128:131], v[152:155]
    v_cvt_pk_bf16_f32 v10, v27, v27
    v_and_b32 v132, v10, v144
    v_and_b32 v133, v10, v145
    v_and_b32 v134, v10, v146
    v_and_b32 v135, v10, v147
    s_nop 1
    v_mfma_f32_16x16x32_bf16 v[148:151], v[40:43], v[132:135], v[148:151]
    v_mfma_f32_16x16x32_bf16 v[152:155], v[44:47], v[132:135], v[152:155]
    v_cvt_pk_bf16_f32 v10, v28, v28
    v_and_b32 v128, v10, v144
    s_waitcnt vmcnt(3)
    s_mov_b32 s49, 229376
    buffer_load_dwordx4 v[64:67], v1, s[40:43], s49 offen offset:0 nt
    v_and_b32 v129, v10, v145
    v_and_b32 v130, v10, v146
    v_and_b32 v131, v10, v147
    s_waitcnt vmcnt(3)
    buffer_load_dwordx4 v[68:71], v1, s[40:43], s49 offen offset:1024 nt
    v_mfma_f32_16x16x32_bf16 v[148:151], v[48:51], v[128:131], v[148:151]
    v_mfma_f32_16x16x32_bf16 v[152:155], v[52:55], v[128:131], v[152:155]
    v_cvt_pk_bf16_f32 v10, v29, v29
    v_and_b32 v132, v10, v144
    v_and_b32 v133, v10, v145
    v_and_b32 v134, v10, v146
    v_and_b32 v135, v10, v147
    s_waitcnt vmcnt(3)
    buffer_load_dwordx4 v[72:75], v1, s[40:43], s49 offen offset:2048 nt
    s_waitcnt vmcnt(3)
    buffer_load_dwordx4 v[76:79], v1, s[40:43], s49 offen offset:3072 nt
    s_barrier
    v_mfma_f32_16x16x32_bf16 v[148:151], v[56:59], v[132:135], v[148:151]
    v_mfma_f32_16x16x32_bf16 v[152:155], v[60:63], v[132:135], v[152:155]
    v_cvt_pk_bf16_f32 v10, v30, v30
    v_and_b32 v128, v10, v144
    v_and_b32 v129, v10, v145
    v_and_b32 v130, v10, v146
    v_and_b32 v131, v10, v147
    s_waitcnt vmcnt(2)
    s_nop 0
    v_mfma_f32_16x16x32_bf16 v[148:151], v[64:67], v[128:131], v[148:151]
    v_mfma_f32_16x16x32_bf16 v[152:155], v[68:71], v[128:131], v[152:155]
    v_cvt_pk_bf16_f32 v10, v31, v31
    v_and_b32 v132, v10, v144
    v_and_b32 v133, v10, v145
    v_and_b32 v134, v10, v146
    v_and_b32 v135, v10, v147
    s_waitcnt vmcnt(0)
    s_nop 0
    v_mfma_f32_16x16x32_bf16 v[148:151], v[72:75], v[132:135], v[148:151]
    v_mfma_f32_16x16x32_bf16 v[152:155], v[76:79], v[132:135], v[152:155]
    s_nop 7
    v_mov_b32_dpp v148, v152 quad_perm:[0,1,2,3] row_mask:0xf bank_mask:0xc
    v_mov_b32_dpp v149, v153 quad_perm:[0,1,2,3] row_mask:0xf bank_mask:0xc
    v_mov_b32_dpp v150, v154 quad_perm:[0,1,2,3] row_mask:0xf bank_mask:0xc
    v_mov_b32_dpp v151, v155 quad_perm:[0,1,2,3] row_mask:0xf bank_mask:0xc
    ds_write_b128 v2, v[148:151]
    s_waitcnt lgkmcnt(0)
    s_barrier
    v_and_b32 v200, 3, v0
    v_bfe_u32 v201, v0, 2, 2
    v_lshrrev_b32 v202, 4, v0
    s_lshl_b32 s34, s3, 10
    s_add_u32 s34, s34, 122112
    v_lshl_add_u32 v203, v0, 4, s34
    s_movk_i32 s48, 5120
    s_cmp_eq_u32 s63, 0
    s_cbranch_scc1 L_t_wo
    s_cmp_eq_u32 s63, 2
    s_cbranch_scc1 L_t_w2
    s_cmp_eq_u32 s63, 3
    s_cbranch_scc1 L_fin
    v_and_b32 v205, 15, v0
    v_lshlrev_b32 v205, 4, v205
    s_and_b32 s49, s3, 3
    s_mul_i32 s34, s49, 1280
    s_add_u32 s34, s34, 70656
    v_lshl_add_u32 v206, v202, 17, v205
    v_add_u32 v206, s34, v206
    s_mul_i32 s34, s49, 3840
    v_add_u32 v205, s34, v205
    s_barrier
L_r_w1:
    s_cmp_lt_u32 s3, 4
    s_cbranch_scc1 L_w1_ln
    s_and_b32 s49, s3, 3
    s_lshl_b32 s42, s49, 11
    s_add_u32 s42, s42, 40960
    s_bitcmp1_b32 s62, 0
    s_cbranch_scc1 L_rot1
    s_add_u32 m0, s42, 0
    s_add_u32 s34, s50, 0
    buffer_load_dwordx4 v15, s[52:55], s34 offen  lds
    s_add_u32 m0, s42, 1024
    s_add_u32 s34, s50, 884736
    buffer_load_dwordx4 v15, s[52:55], s34 offen  lds
    s_add_u32 m0, s42, 8192
    s_add_u32 s34, s50, 110592
    buffer_load_dwordx4 v15, s[52:55], s34 offen  lds
    s_add_u32 m0, s42, 9216
    s_add_u32 s34, s50, 995328
    buffer_load_dwordx4 v15, s[52:55], s34 offen  lds
    s_add_u32 m0, s42, 32768
    s_add_u32 s34, s51, 0
    buffer_load_dwordx4 v15, s[52:55], s34 offen  lds
    s_add_u32 m0, s42, 33792
    s_add_u32 s34, s51, 13824
    buffer_load_dwordx4 v15, s[52:55], s34 offen  lds
    s_add_u32 m0, s42, 16384
    s_add_u32 s34, s50, 221184
    buffer_load_dwordx4 v15, s[52:55], s34 offen  lds
    s_add_u32 m0, s42, 17408
    s_add_u32 s34, s50, 1105920
    buffer_load_dwordx4 v15, s[52:55], s34 offen  lds
    s_add_u32 m0, s42, 24576
    s_add_u32 s34, s50, 331776
    buffer_load_dwordx4 v15, s[52:55], s34 offen  lds
    s_add_u32 m0, s42, 25600
    s_add_u32 s34, s50, 1216512
    buffer_load_dwordx4 v15, s[52:55], s34 offen  lds
    s_branch L_rot2
L_rot1:
    s_add_u32 m0, s42, 16384
    s_add_u32 s34, s50, 221184
    buffer_load_dwordx4 v15, s[52:55], s34 offen  lds
    s_add_u32 m0, s42, 17408
    s_add_u32 s34, s50, 1105920
    buffer_load_dwordx4 v15, s[52:55], s34 offen  lds
    s_add_u32 m0, s42, 24576
    s_add_u32 s34, s50, 331776
    buffer_load_dwordx4 v15, s[52:55], s34 offen  lds
    s_add_u32 m0, s42, 25600
    s_add_u32 s34, s50, 1216512
    buffer_load_dwordx4 v15, s[52:55], s34 offen  lds
    s_add_u32 m0, s42, 32768
    s_add_u32 s34, s51, 0
    buffer_load_dwordx4 v15, s[52:55], s34 offen  lds
    s_add_u32 m0, s42, 33792
    s_add_u32 s34, s51, 13824
    buffer_load_dwordx4 v15, s[52:55], s34 offen  lds
    s_add_u32 m0, s42, 0
    s_add_u32 s34, s50, 0
    buffer_load_dwordx4 v15, s[52:55], s34 offen  lds
    s_add_u32 m0, s42, 1024
    s_add_u32 s34, s50, 884736
    buffer_load_dwordx4 v15, s[52:55], s34 offen  lds
    s_add_u32 m0, s42, 8192
    s_add_u32 s34, s50, 110592
    buffer_load_dwordx4 v15, s[52:55], s34 offen  lds
    s_add_u32 m0, s42, 9216
    s_add_u32 s34, s50, 995328
    buffer_load_dwordx4 v15, s[52:55], s34 offen  lds
L_rot2:
    v_lshrrev_b32 v3, 2, v0
    v_lshlrev_b32 v3, 6, v3
    v_lshl_add_u32 v3, v200, 3, v3
    v_add_u32 v3, s42, v3
    s_lshl_b32 s35, s49, 6
    s_add_u32 s35, s35, 116736
    v_mul_u32_u24 v4, 1344, v200
    v_lshl_add_u32 v4, v202, 4, v4
    v_add_u32 v4, s35, v4
    s_lshl_b32 s35, s49, 11
    s_add_u32 s35, s35, 122112
    v_lshl_add_u32 v5, v0, 4, s35
    s_waitcnt vmcnt(0)
    s_barrier
    ds_read_b64_tr_b16 v[32:33], v3 offset:0
    ds_read_b64_tr_b16 v[34:35], v3 offset:1024
    ds_read_b64_tr_b16 v[36:37], v3 offset:32
    ds_read_b64_tr_b16 v[38:39], v3 offset:1056
    ds_read_b64_tr_b16 v[40:41], v3 offset:8192
    ds_read_b64_tr_b16 v[42:43], v3 offset:9216
    ds_read_b64_tr_b16 v[44:45], v3 offset:8224
    ds_read_b64_tr_b16 v[46:47], v3 offset:9248
    ds_read_b64_tr_b16 v[48:49], v3 offset:16384
    ds_read_b64_tr_b16 v[50:51], v3 offset:17408
    ds_read_b64_tr_b16 v[52:53], v3 offset:16416
    ds_read_b64_tr_b16 v[54:55], v3 offset:17440
    s_waitcnt lgkmcnt(4)
    ds_read_b64_tr_b16 v[56:57], v3 offset:24576
    ds_read_b64_tr_b16 v[58:59], v3 offset:25600
    ds_read_b64_tr_b16 v[60:61], v3 offset:24608
    ds_read_b64_tr_b16 v[62:63], v3 offset:25632
    ds_read_b64_tr_b16 v[64:65], v3 offset:32768
    ds_read_b64_tr_b16 v[66:67], v3 offset:33792
    ds_read_b64_tr_b16 v[68:69], v3 offset:32800
    ds_read_b64_tr_b16 v[70:71], v3 offset:33824
    s_waitcnt lgkmcnt(0)
    s_barrier
    ds_read_b128 v[140:143], v4 offset:0
    ds_read_b128 v[144:147], v4 offset:256
    ds_read_b128 v[148:151], v4 offset:512
    ds_read_b128 v[152:155], v4 offset:768
    ds_read_b128 v[156:159], v4 offset:1024
    s_waitcnt lgkmcnt(4)
    v_mfma_f32_16x16x32_bf16 v[20:23], v[32:35], v[140:143], 0
    v_mfma_f32_16x16x32_bf16 v[24:27], v[36:39], v[140:143], 0
    s_waitcnt lgkmcnt(3)
    v_mfma_f32_16x16x32_bf16 v[20:23], v[40:43], v[144:147], v[20:23]
    v_mfma_f32_16x16x32_bf16 v[24:27], v[44:47], v[144:147], v[24:27]
    s_waitcnt lgkmcnt(2)
    v_mfma_f32_16x16x32_bf16 v[20:23], v[48:51], v[148:151], v[20:23]
    v_mfma_f32_16x16x32_bf16 v[24:27], v[52:55], v[148:151], v[24:27]
    s_waitcnt lgkmcnt(1)
    v_mfma_f32_16x16x32_bf16 v[20:23], v[56:59], v[152:155], v[20:23]
    v_mfma_f32_16x16x32_bf16 v[24:27], v[60:63], v[152:155], v[24:27]
    s_waitcnt lgkmcnt(0)
    v_mfma_f32_16x16x32_bf16 v[20:23], v[64:67], v[156:159], v[20:23]
    v_mfma_f32_16x16x32_bf16 v[24:27], v[68:71], v[156:159], v[24:27]
    s_nop 6
    ds_write_b128 v5, v[20:23]
    ds_write_b128 v5, v[24:27] offset:1024
    s_waitcnt lgkmcnt(0)
    s_barrier
    s_branch L_fin
L_w1_ln:
    ds_read_b128 v[140:143], v205 offset:0
    ds_read_b128 v[144:147], v205 offset:256
    ds_read_b128 v[148:151], v205 offset:512
    ds_read_b128 v[152:155], v205 offset:768
    ds_read_b128 v[156:159], v205 offset:1024
    ds_read_b128 v[160:163], v205 offset:1280
    ds_read_b128 v[164:167], v205 offset:1536
    ds_read_b128 v[168:171], v205 offset:1792
    ds_read_b128 v[172:175], v205 offset:2048
    ds_read_b128 v[176:179], v205 offset:2304
    ds_read_b128 v[180:183], v205 offset:2560
    ds_read_b128 v[184:187], v205 offset:2816
    ds_read_b128 v[188:191], v205 offset:3072
    ds_read_b128 v[192:195], v205 offset:3328
    ds_read_b128 v[196:199], v205 offset:3584
    v_and_b32 v8, 1, v0
    v_lshlrev_b32 v8, 4, v8
    v_mov_b32 v9, 0xffff
    v_lshlrev_b32 v8, v8, v9
    v_bfe_u32 v9, v0, 1, 2
    v_cmp_eq_u32 vcc, 0, v9
    s_nop 1
    v_cndmask_b32 v16, 0, v8, vcc
    v_cmp_eq_u32 vcc, 1, v9
    s_nop 1
    v_cndmask_b32 v17, 0, v8, vcc
    v_cmp_eq_u32 vcc, 2, v9
    s_nop 1
    v_cndmask_b32 v18, 0, v8, vcc
    v_cmp_eq_u32 vcc, 3, v9
    s_nop 1
    v_cndmask_b32 v19, 0, v8, vcc
    v_bfe_u32 v8, v0, 3, 1
    v_cmp_eq_u32 vcc, 0, v8
    s_nop 1
    v_cndmask_b32 v20, 0, v16, vcc
    v_xor_b32 v24, v20, v16
    v_cndmask_b32 v21, 0, v17, vcc
    v_xor_b32 v25, v21, v17
    v_cndmask_b32 v22, 0, v18, vcc
    v_xor_b32 v26, v22, v18
    v_cndmask_b32 v23, 0, v19, vcc
    v_xor_b32 v27, v23, v19
    v_and_b32 v52, 0x3f803f80, v20
    v_and_b32 v60, 0x3e803e80, v20
    v_and_b32 v53, 0x3f803f80, v21
    v_and_b32 v61, 0x3e803e80, v21
    v_and_b32 v54, 0x3f803f80, v22
    v_and_b32 v62, 0x3e803e80, v22
    v_and_b32 v55, 0x3f803f80, v23
    v_and_b32 v63, 0x3e803e80, v23
    v_and_b32 v56, 0x3f803f80, v24
    v_and_b32 v64, 0x3e803e80, v24
    v_and_b32 v57, 0x3f803f80, v25
    v_and_b32 v65, 0x3e803e80, v25
    v_and_b32 v58, 0x3f803f80, v26
    v_and_b32 v66, 0x3e803e80, v26
    v_and_b32 v59, 0x3f803f80, v27
    v_and_b32 v67, 0x3e803e80, v27
    s_waitcnt lgkmcnt(0)
    v_mfma_f32_16x16x32_bf16 v[68:71], v[140:143], v[60:63], 0
    v_mfma_f32_16x16x32_bf16 v[68:71], v[144:147], v[64:67], v[68:71]
    v_mfma_f32_16x16x32_bf16 v[72:75], v[148:151], v[60:63], 0
    v_mfma_f32_16x16x32_bf16 v[72:75], v[152:155], v[64:67], v[72:75]
    v_mfma_f32_16x16x32_bf16 v[76:79], v[156:159], v[60:63], 0
    v_mfma_f32_16x16x32_bf16 v[116:119], v[160:163], v[60:63], 0
    v_mfma_f32_16x16x32_bf16 v[116:119], v[164:167], v[64:67], v[116:119]
    v_mfma_f32_16x16x32_bf16 v[120:123], v[168:171], v[60:63], 0
    v_mfma_f32_16x16x32_bf16 v[120:123], v[172:175], v[64:67], v[120:123]
    v_mfma_f32_16x16x32_bf16 v[124:127], v[176:179], v[60:63], 0
    v_mfma_f32_16x16x32_bf16 v[80:83], v[180:183], v[60:63], 1.0
    v_mfma_f32_16x16x32_bf16 v[80:83], v[184:187], v[64:67], v[80:83]
    v_mfma_f32_16x16x32_bf16 v[84:87], v[188:191], v[60:63], 1.0
    v_mfma_f32_16x16x32_bf16 v[84:87], v[192:195], v[64:67], v[84:87]
    v_mfma_f32_16x16x32_bf16 v[88:91], v[196:199], v[60:63], 1.0
    s_mul_i32 s34, s3, 1344
    s_add_u32 s34, s34, 116736
    v_lshl_add_u32 v7, v0, 4, s34
    v_lshlrev_b32 v8, 6, v202
    v_lshl_add_u32 v8, v200, 4, v8
    v_and_b32 v9, 1, v201
    v_lshl_add_u32 v8, v9, 3, v8
    v_add_u32 v8, s34, v8
    v_lshrrev_b32 v9, 5, v0
    v_lshlrev_b32 v9, 10, v9
    v_and_b32 v6, 1, v202
    v_lshl_add_u32 v9, v6, 9, v9
    v_bfe_u32 v6, v0, 1, 1
    v_lshl_add_u32 v9, v6, 8, v9
    v_lshl_add_u32 v9, v201, 4, v9
    v_and_b32 v6, 1, v0
    v_lshl_add_u32 v9, v6, 3, v9
    v_add_u32 v9, 122112, v9
    s_lshr_b32 s34, s62, 2
    s_lshl_b32 s34, s34, 8
    s_and_b32 s49, s62, 3
    s_lshl_b32 s49, s49, 17
    s_add_u32 s34, s34, s49
    s_add_u32 s34, s34, 80896
    v_lshl_add_u32 v5, v0, 2, s34
    s_barrier
    s_mov_b32 s35, 0
    s_mov_b64 s[40:41], -1
    s_mov_b64 s[42:43], -1
L_pb:
    s_mov_b64 exec, s[40:41]
    s_cbranch_execz L_pbs0
    buffer_load_dwordx4 v[140:143], v206, s[44:47], 0 offen offset:0 sc1
    buffer_load_dwordx4 v[148:151], v206, s[44:47], 0 offen offset:256 sc1
    buffer_load_dwordx4 v[156:159], v206, s[44:47], 0 offen offset:512 sc1
    buffer_load_dwordx4 v[164:167], v206, s[44:47], 0 offen offset:768 sc1
    buffer_load_dwordx4 v[172:175], v206, s[44:47], 0 offen offset:1024 sc1
L_pbs0:
    s_mov_b64 exec, s[42:43]
    s_cbranch_execz L_pbs1
    buffer_load_dwordx4 v[144:147], v206, s[44:47], s48 offen offset:0 sc1
    buffer_load_dwordx4 v[152:155], v206, s[44:47], s48 offen offset:256 sc1
    buffer_load_dwordx4 v[160:163], v206, s[44:47], s48 offen offset:512 sc1
    buffer_load_dwordx4 v[168:171], v206, s[44:47], s48 offen offset:768 sc1
    buffer_load_dwordx4 v[176:179], v206, s[44:47], s48 offen offset:1024 sc1
L_pbs1:
    s_mov_b64 exec, -1
    s_add_u32 s35, s35, 1
    s_waitcnt vmcnt(0)
    v_max3_u32 v28, v140, v141, v142
    v_max3_u32 v29, v144, v145, v146
    v_max3_u32 v28, v28, v143, v148
    v_max3_u32 v29, v29, v147, v152
    v_max3_u32 v28, v28, v149, v150
    v_max3_u32 v29, v29, v153, v154
    v_max3_u32 v28, v28, v151, v156
    v_max3_u32 v29, v29, v155, v160
    v_max3_u32 v28, v28, v157, v158
    v_max3_u32 v29, v29, v161, v162
    v_max3_u32 v28, v28, v159, v164
    v_max3_u32 v29, v29, v163, v168
    v_max3_u32 v28, v28, v165, v166
    v_max3_u32 v29, v29, v169, v170
    v_max3_u32 v28, v28, v167, v172
    v_max3_u32 v29, v29, v171, v176
    v_max3_u32 v28, v28, v173, v174
    v_max3_u32 v29, v29, v177, v178
    v_max_u32 v28, v28, v175
    v_max_u32 v29, v29, v179
    v_cmp_eq_u32 s[40:41], -1, v28
    v_cmp_eq_u32 s[42:43], -1, v29
    v_mfma_f32_16x16x32_bf16 v[128:131], v[140:143], v[52:55], v[68:71]
    s_or_b64 vcc, s[40:41], s[42:43]
    s_cbranch_scc0 L_pbd
    s_cmp_lt_u32 s35, 60000
    s_cbranch_scc1 L_pb
L_pbd:
    v_mfma_f32_16x16x32_bf16 v[128:131], v[144:147], v[52:55], v[128:131]
    v_mfma_f32_16x16x32_bf16 v[128:131], v[148:151], v[56:59], v[128:131]
    v_mfma_f32_16x16x32_bf16 v[128:131], v[152:155], v[56:59], v[128:131]
    v_mfma_f32_16x16x32_bf16 v[132:135], v[156:159], v[52:55], v[72:75]
    v_mfma_f32_16x16x32_bf16 v[132:135], v[160:163], v[52:55], v[132:135]
    v_mfma_f32_16x16x32_bf16 v[132:135], v[164:167], v[56:59], v[132:135]
    v_mfma_f32_16x16x32_bf16 v[132:135], v[168:171], v[56:59], v[132:135]
    v_mfma_f32_16x16x32_bf16 v[136:139], v[172:175], v[52:55], v[76:79]
    v_mfma_f32_16x16x32_bf16 v[136:139], v[176:179], v[52:55], v[136:139]
    s_nop 1
    v_pk_add_f32 v[20:21], v[128:129], v[130:131]
    v_pk_mul_f32 v[22:23], v[128:129], v[128:129]
    v_pk_fma_f32 v[22:23], v[130:131], v[130:131], v[22:23]
    s_nop 0
    v_pk_add_f32 v[20:21], v[20:21], v[132:133]
    v_pk_fma_f32 v[22:23], v[132:133], v[132:133], v[22:23]
    v_pk_add_f32 v[20:21], v[20:21], v[134:135]
    v_pk_fma_f32 v[22:23], v[134:135], v[134:135], v[22:23]
    v_pk_add_f32 v[20:21], v[20:21], v[136:137]
    v_pk_fma_f32 v[22:23], v[136:137], v[136:137], v[22:23]
    v_pk_add_f32 v[20:21], v[20:21], v[138:139]
    v_pk_fma_f32 v[22:23], v[138:139], v[138:139], v[22:23]
    v_add_f32 v20, v20, v21
    v_add_f32 v21, v22, v23
    s_nop 0
    v_add_f32_dpp v20, v20, v20 row_ror:8 row_mask:0xf bank_mask:0xf
    v_add_f32_dpp v21, v21, v21 row_ror:8 row_mask:0xf bank_mask:0xf
    s_nop 0
    v_add_f32_dpp v20, v20, v20 row_ror:4 row_mask:0xf bank_mask:0xf
    v_add_f32_dpp v21, v21, v21 row_ror:4 row_mask:0xf bank_mask:0xf
    s_nop 0
    v_add_f32_dpp v20, v20, v20 row_ror:2 row_mask:0xf bank_mask:0xf
    v_add_f32_dpp v21, v21, v21 row_ror:2 row_mask:0xf bank_mask:0xf
    s_nop 0
    v_add_f32_dpp v20, v20, v20 row_ror:1 row_mask:0xf bank_mask:0xf
    v_add_f32_dpp v21, v21, v21 row_ror:1 row_mask:0xf bank_mask:0xf
    v_mov_b32 v22, v20
    v_mov_b32 v23, v21
    s_nop 0
    v_permlane16_swap_b32 v20, v22
    v_permlane16_swap_b32 v21, v23
    v_add_f32 v20, v20, v22
    v_add_f32 v21, v21, v23
    v_mov_b32 v22, v20
    v_mov_b32 v23, v21
    s_nop 0
    v_permlane32_swap_b32 v20, v22
    v_permlane32_swap_b32 v21, v23
    v_add_f32 v20, v20, v22
    v_add_f32 v21, v21, v23
    v_mul_f32 v22, 0x3acccccd, v20
    v_mul_f32 v21, 0x3acccccd, v21
    v_fma_f32 v21, -v22, v22, v21
    v_max_f32 v21, 0, v21
    v_add_f32 v21, 0x3727c5ac, v21
    v_rsq_f32 v20, v21
    s_nop 0
    v_mul_f32_e64 v21, -v22, v20
    v_pk_fma_f32 v[128:129], v[128:129], v[20:21], v[20:21] op_sel:[0,0,1] op_sel_hi:[1,0,1]
    v_pk_fma_f32 v[130:131], v[130:131], v[20:21], v[20:21] op_sel:[0,0,1] op_sel_hi:[1,0,1]
    v_pk_fma_f32 v[132:133], v[132:133], v[20:21], v[20:21] op_sel:[0,0,1] op_sel_hi:[1,0,1]
    v_pk_fma_f32 v[134:135], v[134:135], v[20:21], v[20:21] op_sel:[0,0,1] op_sel_hi:[1,0,1]
    v_pk_fma_f32 v[136:137], v[136:137], v[20:21], v[20:21] op_sel:[0,0,1] op_sel_hi:[1,0,1]
    v_pk_fma_f32 v[138:139], v[138:139], v[20:21], v[20:21] op_sel:[0,0,1] op_sel_hi:[1,0,1]
    v_pk_fma_f32 v[128:129], v[128:129], v[80:81], v[116:117]
    v_pk_fma_f32 v[130:131], v[130:131], v[82:83], v[118:119]
    v_pk_fma_f32 v[132:133], v[132:133], v[84:85], v[120:121]
    v_pk_fma_f32 v[134:135], v[134:135], v[86:87], v[122:123]
    v_pk_fma_f32 v[136:137], v[136:137], v[88:89], v[124:125]
    v_pk_fma_f32 v[138:139], v[138:139], v[90:91], v[126:127]
    v_cvt_pk_bf16_f32 v20, v128, v129
    v_cvt_pk_bf16_f32 v21, v130, v131
    v_cvt_pk_bf16_f32 v22, v132, v133
    v_cvt_pk_bf16_f32 v23, v134, v135
    v_cvt_pk_bf16_f32 v24, v136, v137
    v_cvt_pk_bf16_f32 v25, v138, v139
    ds_write_b128 v7, v[20:23]
    s_mov_b32 exec_lo, 0x00ff00ff
    s_mov_b32 exec_hi, 0x00ff00ff
    ds_write_b64 v8, v[24:25] offset:1024
    s_mov_b64 exec, -1
    s_waitcnt lgkmcnt(0)
    s_barrier
    s_barrier
    s_cmp_lg_u32 s3, 0
    s_cbranch_scc1 L_fin
    ds_read_b64 v[20:21], v9 offset:0
    ds_read_b64 v[22:23], v9 offset:2048
    ds_read_b64 v[24:25], v9 offset:4096
    ds_read_b64 v[26:27], v9 offset:6144
    s_mov_b32 s34, 0xbdd2d3e8
    v_mov_b32 v10, 0xc0135761
    s_waitcnt lgkmcnt(3)
    v_pk_add_f32 v[100:101], v[100:101], v[20:21]
    s_waitcnt lgkmcnt(2)
    v_pk_add_f32 v[100:101], v[100:101], v[22:23]
    s_waitcnt lgkmcnt(1)
    v_pk_add_f32 v[100:101], v[100:101], v[24:25]
    s_waitcnt lgkmcnt(0)
    v_pk_add_f32 v[100:101], v[100:101], v[26:27]
    v_pk_mul_f32 v[20:21], v[100:101], v[100:101]
    v_fma_f32 v20, v20, s34, v10
    v_fma_f32 v21, v21, s34, v10
    v_pk_mul_f32 v[20:21], v[20:21], v[100:101]
    v_exp_f32 v20, v20
    v_exp_f32 v21, v21
    v_add_f32 v20, 1.0, v20
    v_add_f32 v21, 1.0, v21
    v_rcp_f32 v20, v20
    v_rcp_f32 v21, v21
    s_nop 0
    v_pk_mul_f32 v[20:21], v[20:21], v[100:101]
    v_cvt_pk_bf16_f32 v20, v20, v21
    v_min_u32 v20, -2, v20
    buffer_store_dword v20, v5, s[44:47], 0 offen sc1
    s_branch L_fin
L_t_w2:
    v_bfe_u32 v205, v0, 3, 2
    v_lshlrev_b32 v204, 3, v205
    v_lshrrev_b32 v205, 5, v0
    v_lshl_add_u32 v204, v205, 2, v204
    v_bfe_u32 v205, v0, 1, 2
    v_add_u32 v204, v204, v205
    v_and_b32 v205, 1, v0
    s_sub_u32 s49, s3, 1
    v_mul_u32_u24 v204, 1280, v204
    v_lshl_add_u32 v204, v205, 4, v204
    s_lshl_b32 s34, s62, 5
    s_mul_i32 s35, s49, 327680
    s_add_u32 s34, s34, s35
    v_add_u32 v204, s34, v204
    s_lshl_b32 s50, s49, 13
    s_add_u32 s50, s50, 40960
    v_lshl_add_u32 v205, v0, 3, s50
    s_lshl_b32 s40, s62, 1
    s_add_u32 s41, s40, 8
    s_add_u32 s42, s40, 2
    s_barrier
L_w2_dma:
    s_and_b32 s34, s40, 7
    s_lshl_b32 s35, s34, 10
    s_add_u32 m0, s50, s35
    s_mul_i32 s34, s34, 40960
    buffer_load_dwordx4 v204, s[52:55], s34 offen  lds
    s_add_u32 s40, s40, 1
    s_cmp_lg_u32 s40, s42
    s_cbranch_scc1 L_w2_nw
    s_waitcnt vmcnt(0)
L_w2_nw:
    s_cmp_lt_u32 s40, s41
    s_cbranch_scc1 L_w2_dma
    s_lshl_b32 s34, s49, 9
    s_add_u32 s34, s34, 80896
    s_cmp_eq_u32 s49, 6
    s_cselect_b32 s35, 1, 3
    v_lshlrev_b32 v6, 6, v202
    v_lshl_add_u32 v6, v200, 4, v6
    v_add_u32 v6, s34, v6
    v_lshl_add_u32 v4, v201, 17, v6
    v_min_u32 v5, s35, v201
    v_lshl_add_u32 v5, v5, 17, v6
    s_waitcnt vmcnt(0)
    ds_read_b64_tr_b16 v[32:33], v205 offset:0
    ds_read_b64_tr_b16 v[34:35], v205 offset:512
    ds_read_b64_tr_b16 v[36:37], v205 offset:1024
    ds_read_b64_tr_b16 v[38:39], v205 offset:1536
    ds_read_b64_tr_b16 v[40:41], v205 offset:2048
    ds_read_b64_tr_b16 v[42:43], v205 offset:2560
    ds_read_b64_tr_b16 v[44:45], v205 offset:3072
    ds_read_b64_tr_b16 v[46:47], v205 offset:3584
    s_waitcnt lgkmcnt(0)
    ds_read_b64_tr_b16 v[48:49], v205 offset:4096
    ds_read_b64_tr_b16 v[50:51], v205 offset:4608
    ds_read_b64_tr_b16 v[52:53], v205 offset:5120
    ds_read_b64_tr_b16 v[54:55], v205 offset:5632
    ds_read_b64_tr_b16 v[56:57], v205 offset:6144
    ds_read_b64_tr_b16 v[58:59], v205 offset:6656
    ds_read_b64_tr_b16 v[60:61], v205 offset:7168
    ds_read_b64_tr_b16 v[62:63], v205 offset:7680
    s_waitcnt lgkmcnt(0)
    s_barrier
    s_sleep 1
    s_mov_b32 s35, 0
L_poll52:
    buffer_load_dwordx4 v[64:67], v4, s[44:47], 0 offen sc1
    buffer_load_dwordx4 v[68:71], v5, s[44:47], 0 offen offset:256 sc1
    s_add_u32 s35, s35, 1
    s_waitcnt vmcnt(0)
    v_max3_u32 v28, v64, v65, v66
    v_max3_u32 v28, v28, v67, v68
    v_max3_u32 v28, v28, v69, v70
    v_max_u32 v28, v28, v71
    v_cmp_eq_u32 vcc, -1, v28
    s_cbranch_vccz L_done53
    s_cmp_lt_u32 s35, 60000
    s_cbranch_scc1 L_poll52
L_done53:
    v_mfma_f32_16x16x32_bf16 v[80:83], v[32:35], v[64:67], 0
    v_mfma_f32_16x16x32_bf16 v[84:87], v[36:39], v[64:67], 0
    v_mfma_f32_16x16x32_bf16 v[88:91], v[40:43], v[64:67], 0
    v_mfma_f32_16x16x32_bf16 v[92:95], v[44:47], v[64:67], 0
    v_mfma_f32_16x16x32_bf16 v[80:83], v[48:51], v[68:71], v[80:83]
    v_mfma_f32_16x16x32_bf16 v[84:87], v[52:55], v[68:71], v[84:87]
    v_mfma_f32_16x16x32_bf16 v[88:91], v[56:59], v[68:71], v[88:91]
    v_mfma_f32_16x16x32_bf16 v[92:95], v[60:63], v[68:71], v[92:95]
    s_nop 5
    v_mov_b32_dpp v80, v84 quad_perm:[0,1,2,3] row_mask:0xf bank_mask:0x2
    v_mov_b32_dpp v81, v85 quad_perm:[0,1,2,3] row_mask:0xf bank_mask:0x2
    v_mov_b32_dpp v82, v86 quad_perm:[0,1,2,3] row_mask:0xf bank_mask:0x2
    v_mov_b32_dpp v83, v87 quad_perm:[0,1,2,3] row_mask:0xf bank_mask:0x2
    v_mov_b32_dpp v80, v88 quad_perm:[0,1,2,3] row_mask:0xf bank_mask:0x4
    v_mov_b32_dpp v81, v89 quad_perm:[0,1,2,3] row_mask:0xf bank_mask:0x4
    v_mov_b32_dpp v82, v90 quad_perm:[0,1,2,3] row_mask:0xf bank_mask:0x4
    v_mov_b32_dpp v83, v91 quad_perm:[0,1,2,3] row_mask:0xf bank_mask:0x4
    v_mov_b32_dpp v80, v92 quad_perm:[0,1,2,3] row_mask:0xf bank_mask:0x8
    v_mov_b32_dpp v81, v93 quad_perm:[0,1,2,3] row_mask:0xf bank_mask:0x8
    v_mov_b32_dpp v82, v94 quad_perm:[0,1,2,3] row_mask:0xf bank_mask:0x8
    v_mov_b32_dpp v83, v95 quad_perm:[0,1,2,3] row_mask:0xf bank_mask:0x8
    ds_write_b128 v203, v[80:83]
    s_waitcnt lgkmcnt(0)
    s_barrier
    s_branch L_fin
L_w2_red:
    s_mov_b32 s35, 0
L_poll55:
    buffer_load_dwordx2 v[20:21], v204, s[44:47], 0 offen sc1
    buffer_load_dwordx2 v[22:23], v204, s[44:47], s48 offen sc1
    s_add_u32 s35, s35, 1
    s_waitcnt vmcnt(0)
    v_max3_u32 v28, v20, v21, v22
    v_max_u32 v28, v28, v23
    v_cmp_eq_u32 vcc, -1, v28
    s_cbranch_vccz L_done56
    s_sleep 12
    s_cmp_lt_u32 s35, 60000
    s_cbranch_scc1 L_poll55
L_done56:
    s_barrier
    v_lshlrev_b32 v44, 16, v20
    v_and_b32 v45, 0xffff0000, v20
    v_lshlrev_b32 v46, 16, v21
    v_and_b32 v47, 0xffff0000, v21
    v_lshlrev_b32 v48, 16, v22
    v_and_b32 v49, 0xffff0000, v22
    v_lshlrev_b32 v50, 16, v23
    v_and_b32 v51, 0xffff0000, v23
    v_add_f32 v108, v108, v44
    v_add_f32 v109, v109, v45
    v_add_f32 v110, v110, v46
    v_add_f32 v111, v111, v47
    v_add_f32 v108, v108, v48
    v_add_f32 v109, v109, v49
    v_add_f32 v110, v110, v50
    v_add_f32 v111, v111, v51
    s_barrier
    ds_read_b128 v[64:67], v203 offset:1024
    ds_read_b128 v[68:71], v203 offset:2048
    ds_read_b128 v[72:75], v203 offset:3072
    ds_read_b128 v[76:79], v203 offset:4096
    ds_read_b128 v[80:83], v203 offset:5120
    ds_read_b128 v[84:87], v203 offset:6144
    ds_read_b128 v[88:91], v203 offset:7168
    s_waitcnt lgkmcnt(5)
    v_pk_add_f32 v[64:65], v[64:65], v[68:69]
    v_pk_add_f32 v[66:67], v[66:67], v[70:71]
    s_waitcnt lgkmcnt(4)
    v_pk_add_f32 v[64:65], v[64:65], v[72:73]
    v_pk_add_f32 v[66:67], v[66:67], v[74:75]
    s_waitcnt lgkmcnt(3)
    v_pk_add_f32 v[64:65], v[64:65], v[76:77]
    v_pk_add_f32 v[66:67], v[66:67], v[78:79]
    s_waitcnt lgkmcnt(2)
    v_pk_add_f32 v[64:65], v[64:65], v[80:81]
    v_pk_add_f32 v[66:67], v[66:67], v[82:83]
    s_waitcnt lgkmcnt(1)
    v_pk_add_f32 v[64:65], v[64:65], v[84:85]
    v_pk_add_f32 v[66:67], v[66:67], v[86:87]
    s_waitcnt lgkmcnt(0)
    v_pk_add_f32 v[64:65], v[64:65], v[88:89]
    v_pk_add_f32 v[66:67], v[66:67], v[90:91]
    v_pk_fma_f32 v[64:65], v[64:65], v[104:105], v[108:109]
    v_pk_fma_f32 v[66:67], v[66:67], v[106:107], v[110:111]
    s_nop 0
    v_add_f32_dpp v64, v64, v64 row_ror:4 row_mask:0xf bank_mask:0xf
    v_add_f32_dpp v65, v65, v65 row_ror:4 row_mask:0xf bank_mask:0xf
    v_add_f32_dpp v66, v66, v66 row_ror:4 row_mask:0xf bank_mask:0xf
    v_add_f32_dpp v67, v67, v67 row_ror:4 row_mask:0xf bank_mask:0xf
    v_add_f32_dpp v64, v64, v64 row_ror:8 row_mask:0xf bank_mask:0xf
    v_add_f32_dpp v65, v65, v65 row_ror:8 row_mask:0xf bank_mask:0xf
    v_add_f32_dpp v66, v66, v66 row_ror:8 row_mask:0xf bank_mask:0xf
    v_add_f32_dpp v67, v67, v67 row_ror:8 row_mask:0xf bank_mask:0xf
    v_cvt_pk_bf16_f32 v20, v64, v65
    v_cvt_pk_bf16_f32 v21, v66, v67
    s_mov_b32 exec_lo, 0x000f000f
    s_mov_b32 exec_hi, 0x000f000f
    global_store_dwordx2 v112, v[20:21], s[28:29]
    s_mov_b64 exec, -1
    s_branch L_fin
L_t_wo:
    s_lshr_b32 s49, s3, 1
    s_lshl_b32 s49, s49, 17
    v_and_b32 v210, 7, v0
    s_lshl_b32 s34, s60, 12
    s_add_u32 s34, s34, s49
    s_add_u32 s34, s34, 98560
    v_lshrrev_b32 v211, 3, v0
    v_lshl_add_u32 v204, v211, 9, s34
    s_lshl_b32 s35, s51, 7
    s_add_u32 s34, s34, s35
    s_sub_u32 s34, s34, 256
    v_lshrrev_b32 v211, 3, v0
    v_lshlrev_b32 v205, 9, v211
    v_lshl_add_u32 v205, v210, 4, v205
    v_add_u32 v205, s34, v205
    s_lshl_b32 s34, s3, 12
    s_add_u32 s34, s34, 40960
    v_lshrrev_b32 v206, 2, v0
    v_lshlrev_b32 v206, 6, v206
    v_lshl_add_u32 v206, v200, 3, v206
    v_add_u32 v206, s34, v206
    s_mul_i32 s34, s3, 1152
    s_add_u32 s34, s34, 107520
    v_mul_u32_u24 v207, 144, v211
    v_lshl_add_u32 v207, v210, 4, v207
    v_add_u32 v207, s34, v207
    v_mul_u32_u24 v208, 144, v210
    v_lshl_add_u32 v208, v202, 4, v208
    v_add_u32 v208, s34, v208
    v_mul_u32_u24 v212, 144, v211
    v_add_u32 v212, s34, v212
    v_mul_u32_u24 v213, 144, v210
    v_add_u32 v213, s34, v213
    v_and_b32 v211, 1, v211
    v_lshl_add_u32 v203, v211, 6, v208
    v_add_u32 v203, 14592, v203
    v_mov_b32 v210, 98816
    v_cmp_eq_u32 vcc, 0, v211
    s_nop 1
    v_cndmask_b32 v209, v208, v210, vcc
    v_cndmask_b32 v208, v210, v208, vcc
    s_barrier
L_r_wo:
    s_mov_b32 m0, s56
    s_nop 0
    buffer_load_dwordx4 v15, s[52:55], s57 offen  lds
    s_mov_b32 m0, s58
    s_nop 0
    buffer_load_dwordx4 v15, s[52:55], s59 offen  lds
    s_xor_b32 m0, s56, 2048
    s_sub_u32 s34, 40960, s57
    buffer_load_dwordx4 v15, s[52:55], s34 offen  lds
    s_xor_b32 m0, s58, 2048
    s_add_u32 s34, s34, 1280
    buffer_load_dwordx4 v15, s[52:55], s34 offen  lds
    s_mov_b32 s35, 0
    buffer_load_dwordx4 v[64:67], v205, s[44:47], 0 offen sc1
    buffer_load_dword v26, v204, s[44:47], 0 offen sc1
    s_waitcnt vmcnt(2)
    ds_read_b64_tr_b16 v[32:33], v206 offset:0
    ds_read_b64_tr_b16 v[34:35], v206 offset:1024
    ds_read_b64_tr_b16 v[36:37], v206 offset:32
    ds_read_b64_tr_b16 v[38:39], v206 offset:1056
    ds_read_b64_tr_b16 v[40:41], v206 offset:2048
    ds_read_b64_tr_b16 v[42:43], v206 offset:3072
    ds_read_b64_tr_b16 v[44:45], v206 offset:2080
    ds_read_b64_tr_b16 v[46:47], v206 offset:3104
    s_branch L_pam
L_pa:
    buffer_load_dwordx4 v[64:67], v205, s[44:47], 0 offen sc1
    buffer_load_dword v26, v204, s[44:47], 0 offen sc1
L_pam:
    s_add_u32 s35, s35, 1
    s_waitcnt vmcnt(0)
    ds_write_b128 v207, v[64:67]
    ds_write_b32 v212, v26 offset:128
    v_max3_u32 v28, v64, v65, v66
    v_max3_u32 v28, v28, v67, v26
    v_cmp_eq_u32 vcc, -1, v28
    s_cbranch_vccz L_pad
    s_mov_b64 exec, vcc
    s_cmp_lt_u32 s35, 60000
    s_cbranch_scc1 L_pa
L_pad:
    s_mov_b64 exec, -1
    ds_read_b32 v26, v213 offset:128
    ds_read_b128 v[68:71], v208 offset:0
    ds_read_b128 v[72:75], v209 offset:0
    ds_read_b128 v[76:79], v208 offset:64
    ds_read_b128 v[80:83], v209 offset:64
    s_waitcnt lgkmcnt(3)
    v_mfma_f32_16x16x32_bf16 v[20:23], v[32:35], v[68:71], 0
    s_waitcnt lgkmcnt(2)
    v_mfma_f32_16x16x32_bf16 v[20:23], v[36:39], v[72:75], v[20:23]
    s_waitcnt lgkmcnt(1)
    v_mfma_f32_16x16x32_bf16 v[20:23], v[40:43], v[76:79], v[20:23]
    s_waitcnt lgkmcnt(0)
    v_mfma_f32_16x16x32_bf16 v[20:23], v[44:47], v[80:83], v[20:23]
    v_sub_f32_dpp v26, v26, v26 quad_perm:[1,0,3,2] row_mask:0xf bank_mask:0xf
    v_exp_f32 v26, v26
    s_nop 0
    v_add_f32 v26, 1.0, v26
    v_rcp_f32 v26, v26
    s_nop 2
    v_pk_mul_f32 v[20:21], v[20:21], v[26:27] op_sel_hi:[1,0]
    v_pk_mul_f32 v[22:23], v[22:23], v[26:27] op_sel_hi:[1,0]
    ds_write_b128 v203, v[20:23]
    s_waitcnt lgkmcnt(0)
    s_barrier
    s_cmp_lg_u32 s3, 0
    s_cbranch_scc1 L_fin
    ds_read_b128 v[64:67], v207 offset:14592
    ds_read_b128 v[68:71], v207 offset:15744
    ds_read_b128 v[72:75], v207 offset:16896
    ds_read_b128 v[76:79], v207 offset:18048
    ds_read_b128 v[80:83], v207 offset:19200
    ds_read_b128 v[84:87], v207 offset:20352
    ds_read_b128 v[88:91], v207 offset:21504
    ds_read_b128 v[92:95], v207 offset:22656
    s_waitcnt lgkmcnt(6)
    v_pk_add_f32 v[64:65], v[64:65], v[68:69]
    v_pk_add_f32 v[66:67], v[66:67], v[70:71]
    s_waitcnt lgkmcnt(5)
    v_pk_add_f32 v[64:65], v[64:65], v[72:73]
    v_pk_add_f32 v[66:67], v[66:67], v[74:75]
    s_waitcnt lgkmcnt(4)
    v_pk_add_f32 v[64:65], v[64:65], v[76:77]
    v_pk_add_f32 v[66:67], v[66:67], v[78:79]
    s_waitcnt lgkmcnt(3)
    v_pk_add_f32 v[64:65], v[64:65], v[80:81]
    v_pk_add_f32 v[66:67], v[66:67], v[82:83]
    s_waitcnt lgkmcnt(2)
    v_pk_add_f32 v[64:65], v[64:65], v[84:85]
    v_pk_add_f32 v[66:67], v[66:67], v[86:87]
    s_waitcnt lgkmcnt(1)
    v_pk_add_f32 v[64:65], v[64:65], v[88:89]
    v_pk_add_f32 v[66:67], v[66:67], v[90:91]
    s_waitcnt lgkmcnt(0)
    v_pk_add_f32 v[64:65], v[64:65], v[92:93]
    v_pk_add_f32 v[66:67], v[66:67], v[94:95]
    v_pk_mul_f32 v[20:21], v[64:65], v[100:101]
    v_pk_mul_f32 v[22:23], v[66:67], v[102:103]
    s_nop 0
    v_add_f32_dpp v20, v20, v20 row_ror:8 row_mask:0xf bank_mask:0xf
    v_add_f32_dpp v21, v21, v21 row_ror:8 row_mask:0xf bank_mask:0xf
    v_add_f32_dpp v22, v22, v22 row_ror:8 row_mask:0xf bank_mask:0xf
    v_add_f32_dpp v23, v23, v23 row_ror:8 row_mask:0xf bank_mask:0xf
    v_cvt_pk_bf16_f32 v24, v20, v21
    v_cvt_pk_bf16_f32 v25, v22, v23
    v_min_u32 v24, -2, v24
    v_min_u32 v25, -2, v25
    s_mov_b32 exec_lo, 0x00ff00ff
    s_mov_b32 exec_hi, 0x00ff00ff
    buffer_store_dwordx2 v[24:25], v112, s[44:47], 0 offen sc1
    s_mov_b64 exec, -1
L_fin:
L_exit:
    s_endpgm
L_codeend:
.section .rodata,"a"
.p2align 6
.amdhsa_kernel adaLN_cond__sliding_block_cached__dense_activation_gelu__decode_kernel
  .amdhsa_next_free_vgpr 256
  .amdhsa_next_free_sgpr 102
  .amdhsa_accum_offset 256
  .amdhsa_group_segment_fixed_size 0
  .amdhsa_kernarg_size 120
  .amdhsa_user_sgpr_count 2
  .amdhsa_user_sgpr_kernarg_segment_ptr 1
  .amdhsa_system_sgpr_workgroup_id_x 1
  .amdhsa_float_denorm_mode_32 3
.end_amdhsa_kernel
```

```asm
; @launch grid=(256,1,1) block=(512,1,1) lds=131328
.amdgcn_target "amdgcn-amd-amdhsa--gfx950"
.text
.globl adaLN_cond__sliding_block_cached__dense_activation_gelu__decode_kernel
.p2align 8
.type adaLN_cond__sliding_block_cached__dense_activation_gelu__decode_kernel,@function
adaLN_cond__sliding_block_cached__dense_activation_gelu__decode_kernel:
    s_cmp_ge_u32 s2, 256
    s_cbranch_scc1 L_exit
    s_load_dwordx16 s[4:19], s[0:1], 0
    s_load_dwordx8 s[20:27], s[0:1], 64
    s_load_dwordx4 s[28:31], s[0:1], 96
    s_load_dwordx2 s[32:33], s[0:1], 112
    v_lshrrev_b32 v1, 6, v0
    v_and_b32 v0, 63, v0
    v_readfirstlane_b32 s3, v1
    s_and_b32 s60, s2, 7
    s_lshr_b32 s61, s2, 3
    s_mov_b32 s39, 0x20000
    s_mov_b32 s43, 0x20000
    s_mov_b32 s46, 524288
    s_mov_b32 s47, 0x20000
    s_cmp_lg_u32 s3, 0
    s_cbranch_scc1 L_stream
    s_setprio 3
    v_and_b32 v12, 3, v0
    v_bfe_u32 v13, v0, 2, 2
    v_lshrrev_b32 v14, 4, v0
    v_lshrrev_b32 v10, 3, v0
    v_and_b32 v11, 7, v0
    v_lshlrev_b32 v11, 4, v11
    s_lshr_b32 s50, s2, 2
    s_and_b32 s51, s2, 3
    s_mul_i32 s34, s51, 1228800
    s_lshl_b32 s35, s50, 7
    s_add_u32 s34, s34, s35
    v_mul_u32_u24 v17, 7680, v10
    v_add3_u32 v17, v17, v11, s34
    v_mul_u32_u24 v16, 1280, v12
    v_lshl_add_u32 v18, v14, 4, v16
    s_mul_i32 s34, s51, 320
    v_add_u32 v19, s34, v18
    s_mov_b32 s38, 4915200
    s_sub_u32 s52, s50, 10
    s_waitcnt lgkmcnt(0)
    s_add_u32 s44, s32, 0
    s_addc_u32 s45, s33, 0
    s_cmp_ge_u32 s2, 240
    s_cbranch_scc1 L_clear
    s_cmp_ge_u32 s52, 10
    s_cbranch_scc1 L_nox
    v_lshl_add_u32 v18, v13, 6, v18
    global_load_dwordx4 v[52:55], v18, s[4:5] offset:0
    global_load_dwordx4 v[56:59], v18, s[4:5] offset:256
    global_load_dwordx4 v[60:63], v18, s[4:5] offset:512
    global_load_dwordx4 v[64:67], v18, s[4:5] offset:768
    global_load_dwordx4 v[68:71], v18, s[4:5] offset:1024
    s_lshl_b32 s34, s52, 7
    v_lshl_add_u32 v16, v13, 5, v16
    v_lshl_add_u32 v16, v14, 3, v16
    v_add_u32 v16, s34, v16
    global_load_dwordx2 v[72:73], v16, s[4:5]
L_nox:
    global_load_dwordx4 v[32:35], v19, s[24:25] offset:0
    global_load_dwordx4 v[36:39], v19, s[24:25] offset:64
    global_load_dwordx4 v[40:43], v19, s[24:25] offset:128
    global_load_dwordx4 v[44:47], v19, s[24:25] offset:192
    global_load_dwordx4 v[48:51], v19, s[24:25] offset:256
    s_mov_b32 s36, s26
    s_mov_b32 s37, s27
    s_mov_b32 m0, 0
    s_mov_b32 s34, 0
L_dma1:
    buffer_load_dwordx4 v17, s[36:39], s34 offen  lds
    s_add_u32 m0, m0, 1024
    s_add_u32 s34, s34, 61440
    buffer_load_dwordx4 v17, s[36:39], s34 offen  lds
    s_add_u32 m0, m0, 1024
    s_add_u32 s34, s34, 61440
    buffer_load_dwordx4 v17, s[36:39], s34 offen  lds
    s_add_u32 m0, m0, 1024
    s_add_u32 s34, s34, 61440
    buffer_load_dwordx4 v17, s[36:39], s34 offen  lds
    s_add_u32 m0, m0, 1024
    s_add_u32 s34, s34, 61440
    s_cmp_lt_u32 s34, 1228800
    s_cbranch_scc1 L_dma1
    v_lshlrev_b32 v1, 2, v0
    v_add_u32 v1, 98304, v1
    v_mov_b32 v2, -1
    v_mov_b32 v3, 0
    ds_write_b32 v1, v2
    ds_write_b32 v1, v2 offset:256
    ds_write_b32 v1, v3 offset:512
    ds_write_b32 v1, v3 offset:768
    s_waitcnt lgkmcnt(0)
    s_barrier
    s_getpc_b64 s[56:57]
L_pc2:
    s_sub_u32 s56, s56, L_pc2-adaLN_cond__sliding_block_cached__dense_activation_gelu__decode_kernel
    s_subb_u32 s57, s57, 0
    s_lshl_b32 s34, s61, 10
    v_lshl_add_u32 v9, v0, 4, s34
    v_min_u32 v9, L_codeend-adaLN_cond__sliding_block_cached__dense_activation_gelu__decode_kernel-16, v9
    global_load_dwordx4 v[76:79], v9, s[56:57]
    s_and_b32 s34, s2, 31
    s_lshl_b32 s34, s34, 8
    s_lshr_b32 s35, s2, 7
    s_lshl_b32 s35, s35, 7
    s_add_u32 s49, s34, s35
    s_bfe_u32 s53, s2, 0x20005
    s_mul_i32 s34, s53, 1310720
    s_add_u32 s34, s34, s49
    v_lshl_add_u32 v16, v10, 13, v11
    v_add_u32 v16, s34, v16
    s_mov_b32 s36, s10
    s_mov_b32 s37, s11
    s_mov_b32 s38, 5242880
    s_mov_b32 m0, 20480
    s_mov_b32 s34, 0
L_dma3:
    buffer_load_dwordx4 v16, s[36:39], s34 offen  lds
    s_add_u32 m0, m0, 1024
    s_add_u32 s34, s34, 65536
    buffer_load_dwordx4 v16, s[36:39], s34 offen  lds
    s_add_u32 m0, m0, 1024
    s_add_u32 s34, s34, 65536
    buffer_load_dwordx4 v16, s[36:39], s34 offen  lds
    s_add_u32 m0, m0, 1024
    s_add_u32 s34, s34, 65536
    buffer_load_dwordx4 v16, s[36:39], s34 offen  lds
    s_add_u32 m0, m0, 1024
    s_add_u32 s34, s34, 65536
    s_cmp_lt_u32 s34, 1310720
    s_cbranch_scc1 L_dma3
    v_lshl_add_u32 v15, v14, 3, v13
    v_lshlrev_b32 v15, 7, v15
    v_lshl_add_u32 v15, v12, 3, v15
    s_waitcnt vmcnt(41)
    s_mov_b32 s34, 0xbfb8aa3b
    v_lshlrev_b32 v20, 16, v32
    v_and_b32 v21, 0xffff0000, v32
    v_lshlrev_b32 v22, 16, v33
    v_and_b32 v23, 0xffff0000, v33
    v_mul_f32 v24, s34, v20
    v_mul_f32 v25, s34, v21
    v_mul_f32 v26, s34, v22
    v_mul_f32 v27, s34, v23
    v_exp_f32 v24, v24
    v_exp_f32 v25, v25
    v_exp_f32 v26, v26
    v_exp_f32 v27, v27
    v_add_f32 v24, 1.0, v24
    v_add_f32 v25, 1.0, v25
    v_add_f32 v26, 1.0, v26
    v_add_f32 v27, 1.0, v27
    v_rcp_f32 v24, v24
    v_rcp_f32 v25, v25
    v_rcp_f32 v26, v26
    v_rcp_f32 v27, v27
    v_mul_f32 v24, v20, v24
    v_mul_f32 v25, v21, v25
    v_mul_f32 v26, v22, v26
    v_mul_f32 v27, v23, v27
    v_cvt_pk_bf16_f32 v32, v24, v25
    v_cvt_pk_bf16_f32 v33, v26, v27
    v_lshlrev_b32 v20, 16, v34
    v_and_b32 v21, 0xffff0000, v34
    v_lshlrev_b32 v22, 16, v35
    v_and_b32 v23, 0xffff0000, v35
    v_mul_f32 v24, s34, v20
    v_mul_f32 v25, s34, v21
    v_mul_f32 v26, s34, v22
    v_mul_f32 v27, s34, v23
    v_exp_f32 v24, v24
    v_exp_f32 v25, v25
    v_exp_f32 v26, v26
    v_exp_f32 v27, v27
    v_add_f32 v24, 1.0, v24
    v_add_f32 v25, 1.0, v25
    v_add_f32 v26, 1.0, v26
    v_add_f32 v27, 1.0, v27
    v_rcp_f32 v24, v24
    v_rcp_f32 v25, v25
    v_rcp_f32 v26, v26
    v_rcp_f32 v27, v27
    v_mul_f32 v24, v20, v24
    v_mul_f32 v25, v21, v25
    v_mul_f32 v26, v22, v26
    v_mul_f32 v27, v23, v27
    v_cvt_pk_bf16_f32 v34, v24, v25
    v_cvt_pk_bf16_f32 v35, v26, v27
    v_lshlrev_b32 v20, 16, v36
    v_and_b32 v21, 0xffff0000, v36
    v_lshlrev_b32 v22, 16, v37
    v_and_b32 v23, 0xffff0000, v37
    v_mul_f32 v24, s34, v20
    v_mul_f32 v25, s34, v21
    v_mul_f32 v26, s34, v22
    v_mul_f32 v27, s34, v23
    v_exp_f32 v24, v24
    v_exp_f32 v25, v25
    v_exp_f32 v26, v26
    v_exp_f32 v27, v27
    v_add_f32 v24, 1.0, v24
    v_add_f32 v25, 1.0, v25
    v_add_f32 v26, 1.0, v26
    v_add_f32 v27, 1.0, v27
    v_rcp_f32 v24, v24
    v_rcp_f32 v25, v25
    v_rcp_f32 v26, v26
    v_rcp_f32 v27, v27
    v_mul_f32 v24, v20, v24
    v_mul_f32 v25, v21, v25
    v_mul_f32 v26, v22, v26
    v_mul_f32 v27, v23, v27
    v_cvt_pk_bf16_f32 v36, v24, v25
    v_cvt_pk_bf16_f32 v37, v26, v27
    v_lshlrev_b32 v20, 16, v38
    v_and_b32 v21, 0xffff0000, v38
    v_lshlrev_b32 v22, 16, v39
    v_and_b32 v23, 0xffff0000, v39
    v_mul_f32 v24, s34, v20
    v_mul_f32 v25, s34, v21
    v_mul_f32 v26, s34, v22
    v_mul_f32 v27, s34, v23
    v_exp_f32 v24, v24
    v_exp_f32 v25, v25
    v_exp_f32 v26, v26
    v_exp_f32 v27, v27
    v_add_f32 v24, 1.0, v24
    v_add_f32 v25, 1.0, v25
    v_add_f32 v26, 1.0, v26
    v_add_f32 v27, 1.0, v27
    v_rcp_f32 v24, v24
    v_rcp_f32 v25, v25
    v_rcp_f32 v26, v26
    v_rcp_f32 v27, v27
    v_mul_f32 v24, v20, v24
    v_mul_f32 v25, v21, v25
    v_mul_f32 v26, v22, v26
    v_mul_f32 v27, v23, v27
    v_cvt_pk_bf16_f32 v38, v24, v25
    v_cvt_pk_bf16_f32 v39, v26, v27
    v_lshlrev_b32 v20, 16, v40
    v_and_b32 v21, 0xffff0000, v40
    v_lshlrev_b32 v22, 16, v41
    v_and_b32 v23, 0xffff0000, v41
    v_mul_f32 v24, s34, v20
    v_mul_f32 v25, s34, v21
    v_mul_f32 v26, s34, v22
    v_mul_f32 v27, s34, v23
    v_exp_f32 v24, v24
    v_exp_f32 v25, v25
    v_exp_f32 v26, v26
    v_exp_f32 v27, v27
    v_add_f32 v24, 1.0, v24
    v_add_f32 v25, 1.0, v25
    v_add_f32 v26, 1.0, v26
    v_add_f32 v27, 1.0, v27
    v_rcp_f32 v24, v24
    v_rcp_f32 v25, v25
    v_rcp_f32 v26, v26
    v_rcp_f32 v27, v27
    v_mul_f32 v24, v20, v24
    v_mul_f32 v25, v21, v25
    v_mul_f32 v26, v22, v26
    v_mul_f32 v27, v23, v27
    v_cvt_pk_bf16_f32 v40, v24, v25
    v_cvt_pk_bf16_f32 v41, v26, v27
    v_lshlrev_b32 v20, 16, v42
    v_and_b32 v21, 0xffff0000, v42
    v_lshlrev_b32 v22, 16, v43
    v_and_b32 v23, 0xffff0000, v43
    v_mul_f32 v24, s34, v20
    v_mul_f32 v25, s34, v21
    v_mul_f32 v26, s34, v22
    v_mul_f32 v27, s34, v23
    v_exp_f32 v24, v24
    v_exp_f32 v25, v25
    v_exp_f32 v26, v26
    v_exp_f32 v27, v27
    v_add_f32 v24, 1.0, v24
    v_add_f32 v25, 1.0, v25
    v_add_f32 v26, 1.0, v26
    v_add_f32 v27, 1.0, v27
    v_rcp_f32 v24, v24
    v_rcp_f32 v25, v25
    v_rcp_f32 v26, v26
    v_rcp_f32 v27, v27
    v_mul_f32 v24, v20, v24
    v_mul_f32 v25, v21, v25
    v_mul_f32 v26, v22, v26
    v_mul_f32 v27, v23, v27
    v_cvt_pk_bf16_f32 v42, v24, v25
    v_cvt_pk_bf16_f32 v43, v26, v27
    v_lshlrev_b32 v20, 16, v44
    v_and_b32 v21, 0xffff0000, v44
    v_lshlrev_b32 v22, 16, v45
    v_and_b32 v23, 0xffff0000, v45
    v_mul_f32 v24, s34, v20
    v_mul_f32 v25, s34, v21
    v_mul_f32 v26, s34, v22
    v_mul_f32 v27, s34, v23
    v_exp_f32 v24, v24
    v_exp_f32 v25, v25
    v_exp_f32 v26, v26
    v_exp_f32 v27, v27
    v_add_f32 v24, 1.0, v24
    v_add_f32 v25, 1.0, v25
    v_add_f32 v26, 1.0, v26
    v_add_f32 v27, 1.0, v27
    v_rcp_f32 v24, v24
    v_rcp_f32 v25, v25
    v_rcp_f32 v26, v26
    v_rcp_f32 v27, v27
    v_mul_f32 v24, v20, v24
    v_mul_f32 v25, v21, v25
    v_mul_f32 v26, v22, v26
    v_mul_f32 v27, v23, v27
    v_cvt_pk_bf16_f32 v44, v24, v25
    v_cvt_pk_bf16_f32 v45, v26, v27
    v_lshlrev_b32 v20, 16, v46
    v_and_b32 v21, 0xffff0000, v46
    v_lshlrev_b32 v22, 16, v47
    v_and_b32 v23, 0xffff0000, v47
    v_mul_f32 v24, s34, v20
    v_mul_f32 v25, s34, v21
    v_mul_f32 v26, s34, v22
    v_mul_f32 v27, s34, v23
    v_exp_f32 v24, v24
    v_exp_f32 v25, v25
    v_exp_f32 v26, v26
    v_exp_f32 v27, v27
    v_add_f32 v24, 1.0, v24
    v_add_f32 v25, 1.0, v25
    v_add_f32 v26, 1.0, v26
    v_add_f32 v27, 1.0, v27
    v_rcp_f32 v24, v24
    v_rcp_f32 v25, v25
    v_rcp_f32 v26, v26
    v_rcp_f32 v27, v27
    v_mul_f32 v24, v20, v24
    v_mul_f32 v25, v21, v25
    v_mul_f32 v26, v22, v26
    v_mul_f32 v27, v23, v27
    v_cvt_pk_bf16_f32 v46, v24, v25
    v_cvt_pk_bf16_f32 v47, v26, v27
    v_lshlrev_b32 v20, 16, v48
    v_and_b32 v21, 0xffff0000, v48
    v_lshlrev_b32 v22, 16, v49
    v_and_b32 v23, 0xffff0000, v49
    v_mul_f32 v24, s34, v20
    v_mul_f32 v25, s34, v21
    v_mul_f32 v26, s34, v22
    v_mul_f32 v27, s34, v23
    v_exp_f32 v24, v24
    v_exp_f32 v25, v25
    v_exp_f32 v26, v26
    v_exp_f32 v27, v27
    v_add_f32 v24, 1.0, v24
    v_add_f32 v25, 1.0, v25
    v_add_f32 v26, 1.0, v26
    v_add_f32 v27, 1.0, v27
    v_rcp_f32 v24, v24
    v_rcp_f32 v25, v25
    v_rcp_f32 v26, v26
    v_rcp_f32 v27, v27
    v_mul_f32 v24, v20, v24
    v_mul_f32 v25, v21, v25
    v_mul_f32 v26, v22, v26
    v_mul_f32 v27, v23, v27
    v_cvt_pk_bf16_f32 v48, v24, v25
    v_cvt_pk_bf16_f32 v49, v26, v27
    v_lshlrev_b32 v20, 16, v50
    v_and_b32 v21, 0xffff0000, v50
    v_lshlrev_b32 v22, 16, v51
    v_and_b32 v23, 0xffff0000, v51
    v_mul_f32 v24, s34, v20
    v_mul_f32 v25, s34, v21
    v_mul_f32 v26, s34, v22
    v_mul_f32 v27, s34, v23
    v_exp_f32 v24, v24
    v_exp_f32 v25, v25
    v_exp_f32 v26, v26
    v_exp_f32 v27, v27
    v_add_f32 v24, 1.0, v24
    v_add_f32 v25, 1.0, v25
    v_add_f32 v26, 1.0, v26
    v_add_f32 v27, 1.0, v27
    v_rcp_f32 v24, v24
    v_rcp_f32 v25, v25
    v_rcp_f32 v26, v26
    v_rcp_f32 v27, v27
    v_mul_f32 v24, v20, v24
    v_mul_f32 v25, v21, v25
    v_mul_f32 v26, v22, v26
    v_mul_f32 v27, v23, v27
    v_cvt_pk_bf16_f32 v50, v24, v25
    v_cvt_pk_bf16_f32 v51, v26, v27
    s_cmp_ge_u32 s52, 10
    s_cbranch_scc1 L_nostats
    v_mov_b32 v20, 0
    v_mov_b32 v21, 0
    v_mov_b32 v22, 0x3f803f80
    v_dot2c_f32_bf16 v20, v52, v22
    v_dot2c_f32_bf16 v21, v52, v52
    v_dot2c_f32_bf16 v20, v53, v22
    v_dot2c_f32_bf16 v21, v53, v53
    v_dot2c_f32_bf16 v20, v54, v22
    v_dot2c_f32_bf16 v21, v54, v54
    v_dot2c_f32_bf16 v20, v55, v22
    v_dot2c_f32_bf16 v21, v55, v55
    v_dot2c_f32_bf16 v20, v56, v22
    v_dot2c_f32_bf16 v21, v56, v56
    v_dot2c_f32_bf16 v20, v57, v22
    v_dot2c_f32_bf16 v21, v57, v57
    v_dot2c_f32_bf16 v20, v58, v22
    v_dot2c_f32_bf16 v21, v58, v58
    v_dot2c_f32_bf16 v20, v59, v22
    v_dot2c_f32_bf16 v21, v59, v59
    v_dot2c_f32_bf16 v20, v60, v22
    v_dot2c_f32_bf16 v21, v60, v60
    v_dot2c_f32_bf16 v20, v61, v22
    v_dot2c_f32_bf16 v21, v61, v61
    v_dot2c_f32_bf16 v20, v62, v22
    v_dot2c_f32_bf16 v21, v62, v62
    v_dot2c_f32_bf16 v20, v63, v22
    v_dot2c_f32_bf16 v21, v63, v63
    v_dot2c_f32_bf16 v20, v64, v22
    v_dot2c_f32_bf16 v21, v64, v64
    v_dot2c_f32_bf16 v20, v65, v22
    v_dot2c_f32_bf16 v21, v65, v65
    v_dot2c_f32_bf16 v20, v66, v22
    v_dot2c_f32_bf16 v21, v66, v66
    v_dot2c_f32_bf16 v20, v67, v22
    v_dot2c_f32_bf16 v21, v67, v67
    v_dot2c_f32_bf16 v20, v68, v22
    v_dot2c_f32_bf16 v21, v68, v68
    v_dot2c_f32_bf16 v20, v69, v22
    v_dot2c_f32_bf16 v21, v69, v69
    v_dot2c_f32_bf16 v20, v70, v22
    v_dot2c_f32_bf16 v21, v70, v70
    v_dot2c_f32_bf16 v20, v71, v22
    v_dot2c_f32_bf16 v21, v71, v71
    s_nop 1
    v_add_f32_dpp v20, v20, v20 row_ror:4 row_mask:0xf bank_mask:0xf
    v_add_f32_dpp v21, v21, v21 row_ror:4 row_mask:0xf bank_mask:0xf
    s_nop 0
    v_add_f32_dpp v20, v20, v20 row_ror:8 row_mask:0xf bank_mask:0xf
    v_add_f32_dpp v21, v21, v21 row_ror:8 row_mask:0xf bank_mask:0xf
    v_mov_b32 v22, v20
    v_mov_b32 v23, v21
    s_nop 0
    v_permlane16_swap_b32 v20, v22
    v_permlane16_swap_b32 v21, v23
    v_add_f32 v20, v20, v22
    v_add_f32 v21, v21, v23
    v_mov_b32 v22, v20
    v_mov_b32 v23, v21
    s_nop 0
    v_permlane32_swap_b32 v20, v22
    v_permlane32_swap_b32 v21, v23
    v_add_f32 v20, v20, v22
    v_add_f32 v21, v21, v23
    v_mul_f32 v22, 0x3acccccd, v20
    v_mul_f32 v21, 0x3acccccd, v21
    v_fma_f32 v21, -v22, v22, v21
    v_max_f32 v21, 0, v21
    v_add_f32 v21, 0x3727c5ac, v21
    v_rsq_f32 v20, v21
    s_nop 0
    v_mul_f32_e64 v21, -v22, v20
    v_lshlrev_b32 v24, 16, v72
    v_and_b32 v25, 0xffff0000, v72
    v_lshlrev_b32 v26, 16, v73
    v_and_b32 v27, 0xffff0000, v73
    v_fma_f32 v24, v24, v20, v21
    v_fma_f32 v25, v25, v20, v21
    v_fma_f32 v26, v26, v20, v21
    v_fma_f32 v27, v27, v20, v21
L_nostats:
    s_waitcnt vmcnt(21)
    ds_read_b64_tr_b16 v[96:97], v15 offset:0
    ds_read_b64_tr_b16 v[98:99], v15 offset:512
    ds_read_b64_tr_b16 v[100:101], v15 offset:32
    ds_read_b64_tr_b16 v[102:103], v15 offset:544
    ds_read_b64_tr_b16 v[104:105], v15 offset:64
    ds_read_b64_tr_b16 v[106:107], v15 offset:576
    ds_read_b64_tr_b16 v[108:109], v15 offset:96
    ds_read_b64_tr_b16 v[110:111], v15 offset:608
    s_waitcnt lgkmcnt(7)
    ds_read_b64_tr_b16 v[112:113], v15 offset:4096
    ds_read_b64_tr_b16 v[114:115], v15 offset:4608
    ds_read_b64_tr_b16 v[116:117], v15 offset:4128
    ds_read_b64_tr_b16 v[118:119], v15 offset:4640
    ds_read_b64_tr_b16 v[120:121], v15 offset:4160
    ds_read_b64_tr_b16 v[122:123], v15 offset:4672
    ds_read_b64_tr_b16 v[124:125], v15 offset:4192
    ds_read_b64_tr_b16 v[126:127], v15 offset:4704
    s_waitcnt lgkmcnt(7)
    ds_read_b64_tr_b16 v[128:129], v15 offset:8192
    ds_read_b64_tr_b16 v[130:131], v15 offset:8704
    ds_read_b64_tr_b16 v[132:133], v15 offset:8224
    ds_read_b64_tr_b16 v[134:135], v15 offset:8736
    ds_read_b64_tr_b16 v[136:137], v15 offset:8256
    ds_read_b64_tr_b16 v[138:139], v15 offset:8768
    ds_read_b64_tr_b16 v[140:141], v15 offset:8288
    ds_read_b64_tr_b16 v[142:143], v15 offset:8800
    s_waitcnt lgkmcnt(7)
    ds_read_b64_tr_b16 v[144:145], v15 offset:12288
    ds_read_b64_tr_b16 v[146:147], v15 offset:12800
    ds_read_b64_tr_b16 v[148:149], v15 offset:12320
    ds_read_b64_tr_b16 v[150:151], v15 offset:12832
    ds_read_b64_tr_b16 v[152:153], v15 offset:12352
    ds_read_b64_tr_b16 v[154:155], v15 offset:12864
    ds_read_b64_tr_b16 v[156:157], v15 offset:12384
    ds_read_b64_tr_b16 v[158:159], v15 offset:12896
    s_waitcnt lgkmcnt(7)
    ds_read_b64_tr_b16 v[160:161], v15 offset:16384
    ds_read_b64_tr_b16 v[162:163], v15 offset:16896
    ds_read_b64_tr_b16 v[164:165], v15 offset:16416
    ds_read_b64_tr_b16 v[166:167], v15 offset:16928
    ds_read_b64_tr_b16 v[168:169], v15 offset:16448
    ds_read_b64_tr_b16 v[170:171], v15 offset:16960
    ds_read_b64_tr_b16 v[172:173], v15 offset:16480
    ds_read_b64_tr_b16 v[174:175], v15 offset:16992
    s_waitcnt lgkmcnt(0)
    v_mfma_f32_16x16x32_bf16 v[80:83], v[96:99], v[32:35], 0
    v_mfma_f32_16x16x32_bf16 v[84:87], v[100:103], v[32:35], 0
    v_mfma_f32_16x16x32_bf16 v[88:91], v[104:107], v[32:35], 0
    v_mfma_f32_16x16x32_bf16 v[92:95], v[108:111], v[32:35], 0
    v_mfma_f32_16x16x32_bf16 v[80:83], v[112:115], v[36:39], v[80:83]
    v_mfma_f32_16x16x32_bf16 v[84:87], v[116:119], v[36:39], v[84:87]
    v_mfma_f32_16x16x32_bf16 v[88:91], v[120:123], v[36:39], v[88:91]
    v_mfma_f32_16x16x32_bf16 v[92:95], v[124:127], v[36:39], v[92:95]
    v_mfma_f32_16x16x32_bf16 v[80:83], v[128:131], v[40:43], v[80:83]
    v_mfma_f32_16x16x32_bf16 v[84:87], v[132:135], v[40:43], v[84:87]
    v_mfma_f32_16x16x32_bf16 v[88:91], v[136:139], v[40:43], v[88:91]
    v_mfma_f32_16x16x32_bf16 v[92:95], v[140:143], v[40:43], v[92:95]
    v_mfma_f32_16x16x32_bf16 v[80:83], v[144:147], v[44:47], v[80:83]
    v_mfma_f32_16x16x32_bf16 v[84:87], v[148:151], v[44:47], v[84:87]
    v_mfma_f32_16x16x32_bf16 v[88:91], v[152:155], v[44:47], v[88:91]
    v_mfma_f32_16x16x32_bf16 v[92:95], v[156:159], v[44:47], v[92:95]
    v_mfma_f32_16x16x32_bf16 v[80:83], v[160:163], v[48:51], v[80:83]
    v_mfma_f32_16x16x32_bf16 v[84:87], v[164:167], v[48:51], v[84:87]
    v_mfma_f32_16x16x32_bf16 v[88:91], v[168:171], v[48:51], v[88:91]
    v_mfma_f32_16x16x32_bf16 v[92:95], v[172:175], v[48:51], v[92:95]
    s_cmp_ge_u32 s50, 20
    s_cbranch_scc1 L_adr_rest
    s_cmp_lt_u32 s50, 10
    s_cselect_b32 s34, 5120, 0
    s_cselect_b32 s35, s50, s52
    s_lshl_b32 s35, s35, 9
    s_add_u32 s34, s34, s35
    s_lshl_b32 s35, s51, 17
    s_add_u32 s34, s34, s35
    v_lshrrev_b32 v19, 1, v14
    v_lshl_add_u32 v19, v13, 1, v19
    v_lshlrev_b32 v19, 6, v19
    v_lshl_add_u32 v19, v12, 4, v19
    v_and_b32 v20, 1, v14
    v_lshl_add_u32 v19, v20, 3, v19
    s_branch L_adr_done
L_adr_rest:
    s_lshl_b32 s34, s51, 17
    s_lshl_b32 s35, s50, 9
    s_add_u32 s34, s34, s35
    s_add_u32 s34, s34, 0
    v_lshlrev_b32 v19, 7, v12
    v_lshl_add_u32 v19, v13, 5, v19
    v_lshl_add_u32 v19, v14, 3, v19
    s_nop 3
L_adr_done:
    v_add_u32 v19, s34, v19
    v_mov_b32_dpp v80, v84 quad_perm:[0,1,2,3] row_mask:0xf bank_mask:0x2
    v_mov_b32_dpp v81, v85 quad_perm:[0,1,2,3] row_mask:0xf bank_mask:0x2
    v_mov_b32_dpp v82, v86 quad_perm:[0,1,2,3] row_mask:0xf bank_mask:0x2
    v_mov_b32_dpp v83, v87 quad_perm:[0,1,2,3] row_mask:0xf bank_mask:0x2
    v_mov_b32_dpp v80, v88 quad_perm:[0,1,2,3] row_mask:0xf bank_mask:0x4
    v_mov_b32_dpp v81, v89 quad_perm:[0,1,2,3] row_mask:0xf bank_mask:0x4
    v_mov_b32_dpp v82, v90 quad_perm:[0,1,2,3] row_mask:0xf bank_mask:0x4
    v_mov_b32_dpp v83, v91 quad_perm:[0,1,2,3] row_mask:0xf bank_mask:0x4
    v_mov_b32_dpp v80, v92 quad_perm:[0,1,2,3] row_mask:0xf bank_mask:0x8
    v_mov_b32_dpp v81, v93 quad_perm:[0,1,2,3] row_mask:0xf bank_mask:0x8
    v_mov_b32_dpp v82, v94 quad_perm:[0,1,2,3] row_mask:0xf bank_mask:0x8
    v_mov_b32_dpp v83, v95 quad_perm:[0,1,2,3] row_mask:0xf bank_mask:0x8
    s_cmp_ge_u32 s52, 10
    s_cbranch_scc1 L_noz
    v_add_f32 v80, 0x3e800000, v80
    v_add_f32 v81, 0x3e800000, v81
    v_add_f32 v82, 0x3e800000, v82
    v_add_f32 v83, 0x3e800000, v83
    v_mul_f32 v80, v80, v24
    v_mul_f32 v81, v81, v25
    v_mul_f32 v82, v82, v26
    v_mul_f32 v83, v83, v27
L_noz:
    v_cvt_pk_bf16_f32 v20, v80, v81
    v_cvt_pk_bf16_f32 v21, v82, v83
    v_min_u32 v20, -2, v20
    v_min_u32 v21, -2, v21
    v_and_b32 v22, 15, v0
    v_lshlrev_b32 v22, 2, v22
    s_mov_b32 s35, 0
L_poll4:
    global_load_dword v23, v22, s[30:31] offset:128 sc1
    s_add_u32 s35, s35, 1
    s_waitcnt vmcnt(0)
    v_cmp_ne_u32 vcc, 1, v23
    s_cbranch_vccz L_done5
    s_sleep 8
    s_cmp_lt_u32 s35, 60000
    s_cbranch_scc1 L_poll4
L_done5:
    buffer_store_dwordx2 v[20:21], v19, s[44:47], 0 offen sc1
    s_branch L_p2
L_clear:
    s_sub_u32 s55, s2, 240
    s_lshr_b32 s34, s55, 2
    s_lshl_b32 s35, s34, 3
    s_lshr_b32 s54, 538124318, s35
    s_and_b32 s54, s54, 0xff
    s_lshl_b32 s54, s54, 10
    s_mul_i32 s34, s34, 32768
    s_lshl_b32 s35, s51, 17
    s_add_u32 s34, s34, s35
    v_lshl_add_u32 v19, v0, 4, s34
    v_mov_b32 v20, -1
    v_mov_b32 v21, -1
    v_mov_b32 v22, -1
    v_mov_b32 v23, -1
    s_mov_b32 s34, 0
L_clrloop:
    buffer_store_dwordx4 v[20:23], v19, s[44:47], s34 offen sc1
    s_add_u32 s34, s34, 1024
    s_cmp_lt_u32 s34, s54
    s_cbranch_scc1 L_clrloop
    v_lshlrev_b32 v1, 2, v0
    v_add_u32 v1, 98304, v1
    v_mov_b32 v2, -1
    v_mov_b32 v3, 0
    ds_write_b32 v1, v2
    ds_write_b32 v1, v2 offset:256
    ds_write_b32 v1, v3 offset:512
    ds_write_b32 v1, v3 offset:768
    s_waitcnt lgkmcnt(0)
    s_barrier
    s_lshl_b32 s34, s55, 2
    v_mov_b32 v24, s34
    v_mov_b32 v25, 1
    s_waitcnt vmcnt(0)
    s_mov_b64 exec, 1
    global_store_dword v24, v25, s[30:31] offset:128 sc1
    s_mov_b64 exec, -1
    s_getpc_b64 s[56:57]
L_pc7:
    s_sub_u32 s56, s56, L_pc7-adaLN_cond__sliding_block_cached__dense_activation_gelu__decode_kernel
    s_subb_u32 s57, s57, 0
    s_lshl_b32 s34, s61, 10
    v_lshl_add_u32 v9, v0, 4, s34
    v_min_u32 v9, L_codeend-adaLN_cond__sliding_block_cached__dense_activation_gelu__decode_kernel-16, v9
    global_load_dwordx4 v[76:79], v9, s[56:57]
    s_and_b32 s34, s2, 31
    s_lshl_b32 s34, s34, 8
    s_lshr_b32 s35, s2, 7
    s_lshl_b32 s35, s35, 7
    s_add_u32 s49, s34, s35
    s_bfe_u32 s53, s2, 0x20005
    s_mul_i32 s34, s53, 1310720
    s_add_u32 s34, s34, s49
    v_lshl_add_u32 v16, v10, 13, v11
    v_add_u32 v16, s34, v16
    s_mov_b32 s36, s10
    s_mov_b32 s37, s11
    s_mov_b32 s38, 5242880
    s_mov_b32 m0, 20480
    s_mov_b32 s34, 0
L_dma8:
    buffer_load_dwordx4 v16, s[36:39], s34 offen  lds
    s_add_u32 m0, m0, 1024
    s_add_u32 s34, s34, 65536
    buffer_load_dwordx4 v16, s[36:39], s34 offen  lds
    s_add_u32 m0, m0, 1024
    s_add_u32 s34, s34, 65536
    buffer_load_dwordx4 v16, s[36:39], s34 offen  lds
    s_add_u32 m0, m0, 1024
    s_add_u32 s34, s34, 65536
    buffer_load_dwordx4 v16, s[36:39], s34 offen  lds
    s_add_u32 m0, m0, 1024
    s_add_u32 s34, s34, 65536
    s_cmp_lt_u32 s34, 1310720
    s_cbranch_scc1 L_dma8
    v_lshl_add_u32 v15, v14, 3, v13
    v_lshlrev_b32 v15, 7, v15
    v_lshl_add_u32 v15, v12, 3, v15
    v_and_b32 v22, 15, v0
    v_lshlrev_b32 v22, 2, v22
    s_mov_b32 s35, 0
L_poll9:
    global_load_dword v23, v22, s[30:31] offset:128 sc1
    s_add_u32 s35, s35, 1
    s_waitcnt vmcnt(0)
    v_cmp_ne_u32 vcc, 1, v23
    s_cbranch_vccz L_done10
    s_sleep 8
    s_cmp_lt_u32 s35, 60000
    s_cbranch_scc1 L_poll9
L_done10:
L_p2:
    v_mov_b32 v199, v19
    ds_read_b64_tr_b16 v[96:97], v15 offset:20480
    ds_read_b64_tr_b16 v[98:99], v15 offset:20992
    ds_read_b64_tr_b16 v[100:101], v15 offset:20512
    ds_read_b64_tr_b16 v[102:103], v15 offset:21024
    ds_read_b64_tr_b16 v[104:105], v15 offset:20544
    ds_read_b64_tr_b16 v[106:107], v15 offset:21056
    ds_read_b64_tr_b16 v[108:109], v15 offset:20576
    ds_read_b64_tr_b16 v[110:111], v15 offset:21088
    s_waitcnt lgkmcnt(7)
    ds_read_b64_tr_b16 v[112:113], v15 offset:24576
    ds_read_b64_tr_b16 v[114:115], v15 offset:25088
    ds_read_b64_tr_b16 v[116:117], v15 offset:24608
    ds_read_b64_tr_b16 v[118:119], v15 offset:25120
    ds_read_b64_tr_b16 v[120:121], v15 offset:24640
    ds_read_b64_tr_b16 v[122:123], v15 offset:25152
    ds_read_b64_tr_b16 v[124:125], v15 offset:24672
    ds_read_b64_tr_b16 v[126:127], v15 offset:25184
    s_waitcnt lgkmcnt(7)
    ds_read_b64_tr_b16 v[128:129], v15 offset:28672
    ds_read_b64_tr_b16 v[130:131], v15 offset:29184
    ds_read_b64_tr_b16 v[132:133], v15 offset:28704
    ds_read_b64_tr_b16 v[134:135], v15 offset:29216
    ds_read_b64_tr_b16 v[136:137], v15 offset:28736
    ds_read_b64_tr_b16 v[138:139], v15 offset:29248
    ds_read_b64_tr_b16 v[140:141], v15 offset:28768
    ds_read_b64_tr_b16 v[142:143], v15 offset:29280
    s_waitcnt lgkmcnt(7)
    ds_read_b64_tr_b16 v[144:145], v15 offset:32768
    ds_read_b64_tr_b16 v[146:147], v15 offset:33280
    ds_read_b64_tr_b16 v[148:149], v15 offset:32800
    ds_read_b64_tr_b16 v[150:151], v15 offset:33312
    ds_read_b64_tr_b16 v[152:153], v15 offset:32832
    ds_read_b64_tr_b16 v[154:155], v15 offset:33344
    ds_read_b64_tr_b16 v[156:157], v15 offset:32864
    ds_read_b64_tr_b16 v[158:159], v15 offset:33376
    s_waitcnt lgkmcnt(7)
    ds_read_b64_tr_b16 v[160:161], v15 offset:36864
    ds_read_b64_tr_b16 v[162:163], v15 offset:37376
    ds_read_b64_tr_b16 v[164:165], v15 offset:36896
    ds_read_b64_tr_b16 v[166:167], v15 offset:37408
    ds_read_b64_tr_b16 v[168:169], v15 offset:36928
    ds_read_b64_tr_b16 v[170:171], v15 offset:37440
    ds_read_b64_tr_b16 v[172:173], v15 offset:36960
    ds_read_b64_tr_b16 v[174:175], v15 offset:37472
    s_waitcnt lgkmcnt(0)
    s_mul_i32 s34, s53, 1280
    v_lshlrev_b32 v19, 17, v13
    v_lshl_add_u32 v19, v14, 6, v19
    v_lshl_add_u32 v19, v12, 4, v19
    v_add_u32 v19, s34, v19
    s_movk_i32 s48, 5120
    s_mov_b32 s56, 131072
    s_mov_b32 s57, 262144
    s_mov_b32 s58, 393216
    s_sub_u32 s34, s2, 80
    s_cmp_lt_u32 s34, 160
    s_cselect_b32 s54, 1, 0
    s_and_b32 s34, s2, 3
    s_cselect_b32 s54, 0, s54
    v_mov_b32 v180, 0
    v_mov_b32 v181, 0
    v_mov_b32 v182, 0
    v_mov_b32 v183, 0
    v_mov_b32 v184, 0
    v_mov_b32 v185, 0
    v_mov_b32 v186, 0
    v_mov_b32 v187, 0
    v_mov_b32 v22, 99072
    s_mov_b32 s35, 0
L_poll12:
    ds_read_b32 v23, v22
    s_add_u32 s35, s35, 1
    s_waitcnt lgkmcnt(0)
    v_cmp_gt_u32 vcc, 19, v23
    s_cbranch_vccz L_done13
    s_sleep 2
    s_cmp_lt_u32 s35, 60000
    s_cbranch_scc1 L_poll12
L_done13:
    s_mov_b32 s35, 0
L_poll15:
    buffer_load_dwordx4 v[32:35], v19, s[44:47], 0 offen offset:0 sc1
    buffer_load_dwordx4 v[36:39], v19, s[44:47], s48 offen offset:0 sc1
    buffer_load_dwordx4 v[40:43], v19, s[44:47], 0 offen offset:256 sc1
    buffer_load_dwordx4 v[44:47], v19, s[44:47], s48 offen offset:256 sc1
    buffer_load_dwordx4 v[48:51], v19, s[44:47], 0 offen offset:512 sc1
    buffer_load_dwordx4 v[52:55], v19, s[44:47], s48 offen offset:512 sc1
    buffer_load_dwordx4 v[56:59], v19, s[44:47], 0 offen offset:768 sc1
    buffer_load_dwordx4 v[60:63], v19, s[44:47], s48 offen offset:768 sc1
    buffer_load_dwordx4 v[64:67], v19, s[44:47], 0 offen offset:1024 sc1
    buffer_load_dwordx4 v[68:71], v19, s[44:47], s48 offen offset:1024 sc1
    s_cmp_eq_u32 s54, 0
    s_cbranch_scc1 L_hskip
    buffer_load_dwordx2 v[180:181], v199, s[44:47], 0 offen sc1
    buffer_load_dwordx2 v[182:183], v199, s[44:47], s56 offen sc1
    buffer_load_dwordx2 v[184:185], v199, s[44:47], s57 offen sc1
    buffer_load_dwordx2 v[186:187], v199, s[44:47], s58 offen sc1
L_hskip:
    s_add_u32 s35, s35, 1
    s_waitcnt vmcnt(0)
    v_max3_u32 v20, v32, v33, v34
    v_max3_u32 v20, v20, v35, v36
    v_max3_u32 v20, v20, v37, v38
    v_max3_u32 v20, v20, v39, v40
    v_max3_u32 v20, v20, v41, v42
    v_max3_u32 v20, v20, v43, v44
    v_max3_u32 v20, v20, v45, v46
    v_max3_u32 v20, v20, v47, v48
    v_max3_u32 v20, v20, v49, v50
    v_max3_u32 v20, v20, v51, v52
    v_max3_u32 v20, v20, v53, v54
    v_max3_u32 v20, v20, v55, v56
    v_max3_u32 v20, v20, v57, v58
    v_max3_u32 v20, v20, v59, v60
    v_max3_u32 v20, v20, v61, v62
    v_max3_u32 v20, v20, v63, v64
    v_max3_u32 v20, v20, v65, v66
    v_max3_u32 v20, v20, v67, v68
    v_max3_u32 v20, v20, v69, v70
    v_max3_u32 v20, v20, v71, v180
    v_max3_u32 v20, v20, v181, v182
    v_max3_u32 v20, v20, v183, v184
    v_max3_u32 v20, v20, v185, v186
    v_max_u32 v20, v20, v187
    v_cmp_eq_u32 vcc, -1, v20
    s_cbranch_vccz L_done16
    s_sleep 16
    s_cmp_lt_u32 s35, 60000
    s_cbranch_scc1 L_poll15
L_done16:
    v_mfma_f32_16x16x32_bf16 v[80:83], v[96:99], v[32:35], 0
    v_mfma_f32_16x16x32_bf16 v[84:87], v[100:103], v[32:35], 0
    v_mfma_f32_16x16x32_bf16 v[88:91], v[104:107], v[32:35], 0
    v_mfma_f32_16x16x32_bf16 v[92:95], v[108:111], v[32:35], 0
    v_mfma_f32_16x16x32_bf16 v[80:83], v[96:99], v[36:39], v[80:83]
    v_mfma_f32_16x16x32_bf16 v[84:87], v[100:103], v[36:39], v[84:87]
    v_mfma_f32_16x16x32_bf16 v[88:91], v[104:107], v[36:39], v[88:91]
    v_mfma_f32_16x16x32_bf16 v[92:95], v[108:111], v[36:39], v[92:95]
    v_mfma_f32_16x16x32_bf16 v[80:83], v[112:115], v[40:43], v[80:83]
    v_mfma_f32_16x16x32_bf16 v[84:87], v[116:119], v[40:43], v[84:87]
    v_mfma_f32_16x16x32_bf16 v[88:91], v[120:123], v[40:43], v[88:91]
    v_mfma_f32_16x16x32_bf16 v[92:95], v[124:127], v[40:43], v[92:95]
    v_mfma_f32_16x16x32_bf16 v[80:83], v[112:115], v[44:47], v[80:83]
    v_mfma_f32_16x16x32_bf16 v[84:87], v[116:119], v[44:47], v[84:87]
    v_mfma_f32_16x16x32_bf16 v[88:91], v[120:123], v[44:47], v[88:91]
    v_mfma_f32_16x16x32_bf16 v[92:95], v[124:127], v[44:47], v[92:95]
    v_mfma_f32_16x16x32_bf16 v[80:83], v[128:131], v[48:51], v[80:83]
    v_mfma_f32_16x16x32_bf16 v[84:87], v[132:135], v[48:51], v[84:87]
    v_mfma_f32_16x16x32_bf16 v[88:91], v[136:139], v[48:51], v[88:91]
    v_mfma_f32_16x16x32_bf16 v[92:95], v[140:143], v[48:51], v[92:95]
    v_mfma_f32_16x16x32_bf16 v[80:83], v[128:131], v[52:55], v[80:83]
    v_mfma_f32_16x16x32_bf16 v[84:87], v[132:135], v[52:55], v[84:87]
    v_mfma_f32_16x16x32_bf16 v[88:91], v[136:139], v[52:55], v[88:91]
    v_mfma_f32_16x16x32_bf16 v[92:95], v[140:143], v[52:55], v[92:95]
    v_mfma_f32_16x16x32_bf16 v[80:83], v[144:147], v[56:59], v[80:83]
    v_mfma_f32_16x16x32_bf16 v[84:87], v[148:151], v[56:59], v[84:87]
    v_mfma_f32_16x16x32_bf16 v[88:91], v[152:155], v[56:59], v[88:91]
    v_mfma_f32_16x16x32_bf16 v[92:95], v[156:159], v[56:59], v[92:95]
    v_mfma_f32_16x16x32_bf16 v[80:83], v[144:147], v[60:63], v[80:83]
    v_mfma_f32_16x16x32_bf16 v[84:87], v[148:151], v[60:63], v[84:87]
    v_mfma_f32_16x16x32_bf16 v[88:91], v[152:155], v[60:63], v[88:91]
    v_mfma_f32_16x16x32_bf16 v[92:95], v[156:159], v[60:63], v[92:95]
    v_mfma_f32_16x16x32_bf16 v[80:83], v[160:163], v[64:67], v[80:83]
    v_mfma_f32_16x16x32_bf16 v[84:87], v[164:167], v[64:67], v[84:87]
    v_mfma_f32_16x16x32_bf16 v[88:91], v[168:171], v[64:67], v[88:91]
    v_mfma_f32_16x16x32_bf16 v[92:95], v[172:175], v[64:67], v[92:95]
    v_mfma_f32_16x16x32_bf16 v[80:83], v[160:163], v[68:71], v[80:83]
    v_mfma_f32_16x16x32_bf16 v[84:87], v[164:167], v[68:71], v[84:87]
    v_mfma_f32_16x16x32_bf16 v[88:91], v[168:171], v[68:71], v[88:91]
    v_mfma_f32_16x16x32_bf16 v[92:95], v[172:175], v[68:71], v[92:95]
    s_lshl_b32 s34, s53, 17
    s_lshl_b32 s35, s49, 2
    s_add_u32 s34, s34, s35
    s_add_u32 s34, s34, 32768
    v_lshlrev_b32 v19, 7, v12
    v_lshl_add_u32 v19, v13, 5, v19
    v_lshl_add_u32 v19, v14, 3, v19
    v_add_u32 v19, s34, v19
    v_add_f32_dpp v20, v80, v80 row_ror:8 row_mask:0xf bank_mask:0x3
    v_add_f32_dpp v24, v84, v84 row_ror:8 row_mask:0xf bank_mask:0x3
    v_add_f32_dpp v21, v81, v81 row_ror:8 row_mask:0xf bank_mask:0x3
    v_add_f32_dpp v25, v85, v85 row_ror:8 row_mask:0xf bank_mask:0x3
    v_add_f32_dpp v22, v82, v82 row_ror:8 row_mask:0xf bank_mask:0x3
    v_add_f32_dpp v26, v86, v86 row_ror:8 row_mask:0xf bank_mask:0x3
    v_add_f32_dpp v23, v83, v83 row_ror:8 row_mask:0xf bank_mask:0x3
    v_add_f32_dpp v27, v87, v87 row_ror:8 row_mask:0xf bank_mask:0x3
    v_add_f32_dpp v20, v88, v88 row_ror:8 row_mask:0xf bank_mask:0xc
    v_add_f32_dpp v24, v92, v92 row_ror:8 row_mask:0xf bank_mask:0xc
    v_add_f32_dpp v21, v89, v89 row_ror:8 row_mask:0xf bank_mask:0xc
    v_add_f32_dpp v25, v93, v93 row_ror:8 row_mask:0xf bank_mask:0xc
    v_add_f32_dpp v22, v90, v90 row_ror:8 row_mask:0xf bank_mask:0xc
    v_add_f32_dpp v26, v94, v94 row_ror:8 row_mask:0xf bank_mask:0xc
    v_add_f32_dpp v23, v91, v91 row_ror:8 row_mask:0xf bank_mask:0xc
    v_add_f32_dpp v27, v95, v95 row_ror:8 row_mask:0xf bank_mask:0xc
    v_add_f32_dpp v28, v20, v20 row_shl:4 row_mask:0xf bank_mask:0x5
    v_add_f32_dpp v29, v21, v21 row_shl:4 row_mask:0xf bank_mask:0x5
    v_add_f32_dpp v30, v22, v22 row_shl:4 row_mask:0xf bank_mask:0x5
    v_add_f32_dpp v31, v23, v23 row_shl:4 row_mask:0xf bank_mask:0x5
    v_add_f32_dpp v28, v24, v24 row_shr:4 row_mask:0xf bank_mask:0xa
    v_add_f32_dpp v29, v25, v25 row_shr:4 row_mask:0xf bank_mask:0xa
    v_add_f32_dpp v30, v26, v26 row_shr:4 row_mask:0xf bank_mask:0xa
    v_add_f32_dpp v31, v27, v27 row_shr:4 row_mask:0xf bank_mask:0xa
    v_cvt_pk_bf16_f32 v20, v28, v29
    v_cvt_pk_bf16_f32 v21, v30, v31
    v_min_u32 v20, -2, v20
    v_min_u32 v21, -2, v21
    buffer_store_dwordx2 v[20:21], v19, s[44:47], 0 offen sc1
    s_cmp_eq_u32 s54, 0
    s_cbranch_scc1 L_nomf
    v_lshlrev_b32 v24, 16, v180
    v_and_b32 v25, 0xffff0000, v180
    v_lshlrev_b32 v26, 16, v181
    v_and_b32 v27, 0xffff0000, v181
    v_lshlrev_b32 v28, 16, v182
    v_and_b32 v29, 0xffff0000, v182
    v_lshlrev_b32 v30, 16, v183
    v_and_b32 v31, 0xffff0000, v183
    v_add_f32 v24, v24, v28
    v_add_f32 v25, v25, v29
    v_add_f32 v26, v26, v30
    v_add_f32 v27, v27, v31
    v_lshlrev_b32 v28, 16, v184
    v_and_b32 v29, 0xffff0000, v184
    v_lshlrev_b32 v30, 16, v185
    v_and_b32 v31, 0xffff0000, v185
    v_add_f32 v24, v24, v28
    v_add_f32 v25, v25, v29
    v_add_f32 v26, v26, v30
    v_add_f32 v27, v27, v31
    v_lshlrev_b32 v28, 16, v186
    v_and_b32 v29, 0xffff0000, v186
    v_lshlrev_b32 v30, 16, v187
    v_and_b32 v31, 0xffff0000, v187
    v_add_f32 v24, v24, v28
    v_add_f32 v25, v25, v29
    v_add_f32 v26, v26, v30
    v_add_f32 v27, v27, v31
    v_cvt_pk_bf16_f32 v22, v24, v25
    v_cvt_pk_bf16_f32 v23, v26, v27
    v_min_u32 v22, -2, v22
    v_min_u32 v23, -2, v23
    s_sub_u32 s34, s50, 20
    s_lshl_b32 s35, s34, 9
    v_subrev_u32 v199, s35, v199
    s_lshr_b32 s35, s34, 2
    s_lshl_b32 s35, s35, 9
    s_and_b32 s34, s34, 3
    s_lshl_b32 s34, s34, 17
    s_add_u32 s34, s34, s35
    s_add_u32 s34, s34, 55296
    v_add_u32 v199, s34, v199
    buffer_store_dwordx2 v[22:23], v199, s[44:47], 0 offen sc1
L_nomf:
    s_and_b32 s34, s2, 127
    s_lshl_b32 s34, s34, 21
    s_lshr_b32 s35, s2, 7
    s_lshl_b32 s35, s35, 18
    s_add_u32 s34, s34, s35
    s_add_u32 s34, s34, 1572864
    s_mov_b32 s38, 0x40000
    s_mov_b32 s42, 0x40000
    s_waitcnt lgkmcnt(0)
    s_add_u32 s36, s6, s34
    s_addc_u32 s37, s7, 0
    s_add_u32 s40, s8, s34
    s_addc_u32 s41, s9, 0
    v_lshlrev_b32 v18, 4, v0
    s_mov_b32 s34, 258048
    buffer_load_dwordx4 v[128:131], v18, s[36:39], s34 offen offset:0 nt
    buffer_load_dwordx4 v[132:135], v18, s[36:39], s34 offen offset:1024 nt
    buffer_load_dwordx4 v[136:139], v18, s[36:39], s34 offen offset:2048 nt
    buffer_load_dwordx4 v[140:143], v18, s[36:39], s34 offen offset:3072 nt
    buffer_load_dwordx4 v[144:147], v18, s[40:43], s34 offen offset:0 nt
    buffer_load_dwordx4 v[148:151], v18, s[40:43], s34 offen offset:1024 nt
    buffer_load_dwordx4 v[152:155], v18, s[40:43], s34 offen offset:2048 nt
    buffer_load_dwordx4 v[156:159], v18, s[40:43], s34 offen offset:3072 nt
    s_and_b32 s34, s2, 31
    s_lshl_b32 s34, s34, 10
    s_lshl_b32 s35, s53, 7
    s_add_u32 s34, s34, s35
    s_add_u32 s34, s34, 32768
    v_lshrrev_b32 v19, 5, v0
    v_mul_u32_u24 v19, 384, v19
    v_lshl_add_u32 v19, v0, 2, v19
    v_add_u32 v19, s34, v19
    v_mov_b32 v22, 99072
    s_mov_b32 s35, 0
L_poll18:
    ds_read_b32 v23, v22
    s_add_u32 s35, s35, 1
    s_waitcnt lgkmcnt(0)
    v_cmp_gt_u32 vcc, 31, v23
    s_cbranch_vccz L_done19
    s_sleep 2
    s_cmp_lt_u32 s35, 60000
    s_cbranch_scc1 L_poll18
L_done19:
    s_mov_b32 s35, 0
L_poll21:
    buffer_load_dword v32, v19, s[44:47], 0 offen sc1
    buffer_load_dword v33, v19, s[44:47], s56 offen sc1
    buffer_load_dword v34, v19, s[44:47], s57 offen sc1
    buffer_load_dword v35, v19, s[44:47], s58 offen sc1
    s_add_u32 s35, s35, 1
    s_waitcnt vmcnt(0)
    v_max3_u32 v22, v32, v33, v34
    v_max_u32 v22, v22, v35
    v_cmp_eq_u32 vcc, -1, v22
    s_cbranch_vccz L_done22
    s_sleep 16
    s_cmp_lt_u32 s35, 60000
    s_cbranch_scc1 L_poll21
L_done22:
    v_lshlrev_b32 v36, 16, v32
    v_and_b32 v37, 0xffff0000, v32
    v_lshlrev_b32 v38, 16, v33
    v_and_b32 v39, 0xffff0000, v33
    v_lshlrev_b32 v40, 16, v34
    v_and_b32 v41, 0xffff0000, v34
    v_lshlrev_b32 v42, 16, v35
    v_and_b32 v43, 0xffff0000, v35
    v_pk_add_f32 v[36:37], v[36:37], v[38:39]
    v_pk_add_f32 v[40:41], v[40:41], v[42:43]
    v_pk_add_f32 v[36:37], v[36:37], v[40:41]
    v_cvt_pk_bf16_f32 v32, v36, v37
    v_min_u32 v32, -2, v32
    ds_write_b32 v1, v32
    v_and_b32 v2, 15, v0
    v_lshlrev_b32 v2, 4, v2
    v_add_u32 v2, 98304, v2
    ds_read_b128 v[4:7], v2
    s_waitcnt lgkmcnt(0)
    v_dot2_f32_bf16 v8, v128, v4, 0
    v_dot2_f32_bf16 v9, v132, v4, 0
    v_dot2_f32_bf16 v10, v136, v4, 0
    v_dot2_f32_bf16 v11, v140, v4, 0
    v_dot2c_f32_bf16 v8, v129, v5
    v_dot2c_f32_bf16 v9, v133, v5
    v_dot2c_f32_bf16 v10, v137, v5
    v_dot2c_f32_bf16 v11, v141, v5
    v_dot2c_f32_bf16 v8, v130, v6
    v_dot2c_f32_bf16 v9, v134, v6
    v_dot2c_f32_bf16 v10, v138, v6
    v_dot2c_f32_bf16 v11, v142, v6
    v_dot2c_f32_bf16 v8, v131, v7
    v_dot2c_f32_bf16 v9, v135, v7
    v_dot2c_f32_bf16 v10, v139, v7
    v_dot2c_f32_bf16 v11, v143, v7
    v_add_f32_dpp v16, v8, v8 row_ror:8 row_mask:0xf bank_mask:0x3
    v_add_f32_dpp v16, v9, v9 row_ror:8 row_mask:0xf bank_mask:0xc
    v_add_f32_dpp v17, v10, v10 row_ror:8 row_mask:0xf bank_mask:0x3
    v_add_f32_dpp v17, v11, v11 row_ror:8 row_mask:0xf bank_mask:0xc
    v_add_f32_dpp v16, v16, v16 row_half_mirror row_mask:0xf bank_mask:0xf
    s_nop 0
    v_add_f32_dpp v17, v17, v17 row_half_mirror row_mask:0xf bank_mask:0xf
    v_add_f32_dpp v16, v16, v16 quad_perm:[1,0,3,2] row_mask:0xf bank_mask:0xf
    s_nop 0
    v_add_f32_dpp v17, v17, v17 quad_perm:[1,0,3,2] row_mask:0xf bank_mask:0xf
    v_add_f32_dpp v16, v16, v16 quad_perm:[2,3,0,1] row_mask:0xf bank_mask:0xf
    s_nop 0
    v_add_f32_dpp v17, v17, v17 quad_perm:[2,3,0,1] row_mask:0xf bank_mask:0xf
    v_max_f32 v8, v16, v17
    s_mov_b32 s34, 0x3e0293ee
    s_nop 0
    v_max_f32_dpp v8, v8, v8 row_ror:8 row_mask:0xf bank_mask:0xf
    v_mov_b32 v9, v8
    s_nop 1
    v_permlane16_swap_b32 v8, v9
    v_max_f32 v8, v8, v9
    v_mov_b32 v9, v8
    s_nop 1
    v_permlane32_swap_b32 v8, v9
    v_max_f32 v8, v8, v9
    v_mul_f32 v8, s34, v8
    v_fma_f32 v16, v16, s34, -v8
    v_fma_f32 v17, v17, s34, -v8
    v_exp_f32 v16, v16
    v_exp_f32 v17, v17
    s_nop 0
    v_add_f32 v9, v16, v17
    v_and_b32 v10, 1, v0
    v_lshlrev_b32 v10, 4, v10
    v_mov_b32 v11, 0xffff
    v_lshlrev_b32 v10, v10, v11
    v_bfe_u32 v11, v0, 1, 2
    v_cmp_eq_u32 vcc, 0, v11
    s_nop 1
    v_cndmask_b32 v20, 0, v10, vcc
    v_cmp_eq_u32 vcc, 1, v11
    s_nop 1
    v_cndmask_b32 v21, 0, v10, vcc
    v_cmp_eq_u32 vcc, 2, v11
    s_nop 1
    v_cndmask_b32 v22, 0, v10, vcc
    v_cmp_eq_u32 vcc, 3, v11
    s_nop 1
    v_cndmask_b32 v23, 0, v10, vcc
    v_add_f32_dpp v9, v9, v9 row_ror:8 row_mask:0xf bank_mask:0xf
    v_mov_b32 v10, v9
    s_nop 1
    v_permlane16_swap_b32 v9, v10
    v_add_f32 v9, v9, v10
    v_mov_b32 v10, v9
    s_nop 1
    v_permlane32_swap_b32 v9, v10
    v_add_f32 v9, v9, v10
    v_mov_b32 v10, 98616
    s_mov_b64 exec, 1
    ds_write_b64 v10, v[8:9]
    s_mov_b64 exec, -1
    v_cvt_pk_bf16_f32 v10, v16, v16
    v_and_b32 v24, v10, v20
    v_and_b32 v25, v10, v21
    v_and_b32 v26, v10, v22
    v_and_b32 v27, v10, v23
    s_nop 1
    v_mfma_f32_16x16x32_bf16 v[116:119], v[144:147], v[24:27], 0
    v_mfma_f32_16x16x32_bf16 v[120:123], v[148:151], v[24:27], 0
    v_cvt_pk_bf16_f32 v10, v17, v17
    v_and_b32 v28, v10, v20
    v_and_b32 v29, v10, v21
    v_and_b32 v30, v10, v22
    v_and_b32 v31, v10, v23
    s_nop 1
    v_mfma_f32_16x16x32_bf16 v[116:119], v[152:155], v[28:31], v[116:119]
    v_mfma_f32_16x16x32_bf16 v[120:123], v[156:159], v[28:31], v[120:123]
    s_nop 7
    v_mov_b32_dpp v116, v120 quad_perm:[0,1,2,3] row_mask:0xf bank_mask:0xc
    v_mov_b32_dpp v117, v121 quad_perm:[0,1,2,3] row_mask:0xf bank_mask:0xc
    v_mov_b32_dpp v118, v122 quad_perm:[0,1,2,3] row_mask:0xf bank_mask:0xc
    v_mov_b32_dpp v119, v123 quad_perm:[0,1,2,3] row_mask:0xf bank_mask:0xc
    s_mov_b32 s63, 0
    s_mov_b32 s62, s61
    s_cmp_lt_u32 s61, 20
    s_cbranch_scc1 L_rd24
    s_mul_i32 s62, s60, 12
    s_add_u32 s62, s62, s61
    s_sub_u32 s62, s62, 20
    s_mov_b32 s63, 1
    s_cmp_lt_u32 s62, 54
    s_cbranch_scc1 L_rd24
    s_cmp_lt_u32 s62, 56
    s_cselect_b32 s63, 3, 2
    s_sub_u32 s62, s62, 56
L_rd24:
    v_and_b32 v8, 3, v0
    v_bfe_u32 v9, v0, 2, 2
    v_lshrrev_b32 v10, 4, v0
    s_mov_b32 s55, 0x20000
    s_lshl_b32 s35, s62, 6
    s_and_b32 s49, s62, 1
    s_cmp_eq_u32 s63, 0
    s_cbranch_scc1 L_dp26
    s_cmp_eq_u32 s63, 1
    s_cbranch_scc1 L_dp27
    s_mov_b32 s52, s20
    s_mov_b32 s53, s21
    s_mov_b32 s54, 2211840
    v_mov_b32 v15, 0
    s_branch L_dp28
L_dp27:
    s_mov_b32 s52, s16
    s_mov_b32 s53, s17
    s_mov_b32 s54, 2211840
    v_lshl_add_u32 v15, v9, 3, v10
    v_mul_u32_u24 v15, 3456, v15
    v_lshl_add_u32 v15, v8, 4, v15
    v_add_u32 v15, s35, v15
    s_bfe_u32 s50, s3, 0x10001
    s_lshl_b32 s50, s50, 7
    s_and_b32 s34, s3, 1
    s_lshl_b32 s34, s34, 2
    s_add_u32 s50, s50, s34
    s_and_b32 s51, s3, 3
    s_lshl_b32 s51, s51, 5
    s_add_u32 s51, s51, 512
    s_mul_i32 s50, s50, 3456
    s_mul_i32 s51, s51, 3456
    s_branch L_dp28
L_dp26:
    s_mov_b32 s52, s12
    s_mov_b32 s53, s13
    s_mov_b32 s54, 5242880
    s_lshr_b32 s50, s3, 1
    s_lshl_b32 s50, s50, 3
    s_add_u32 s50, s50, s60
    s_and_b32 s51, s3, 1
    s_lshl_b32 s34, s50, 1
    s_add_u32 s34, s34, s51
    s_mul_i32 s34, s34, 81920
    s_add_u32 s34, s34, s35
    v_lshl_add_u32 v15, v9, 2, v10
    v_mul_u32_u24 v15, 2560, v15
    v_lshl_add_u32 v15, v8, 4, v15
    v_add_u32 v15, s34, v15
    s_lshl_b32 s56, s3, 12
    s_lshl_b32 s34, s49, 11
    s_add_u32 s56, s56, s34
    s_add_u32 s56, s56, 40960
    s_add_u32 s58, s56, 1024
    s_mul_i32 s57, s49, 40960
    s_add_u32 s59, s57, 1280
L_dp28:
    v_and_b32 v200, 3, v0
    v_bfe_u32 v201, v0, 2, 2
    v_lshrrev_b32 v202, 4, v0
    s_lshl_b32 s34, s3, 10
    s_add_u32 s34, s34, 122112
    v_lshl_add_u32 v203, v0, 4, s34
    s_movk_i32 s48, 5120
    v_mov_b32 v197, 0
    s_mov_b32 s40, 0
    s_mov_b32 s41, 0
    s_mov_b32 s42, 0
    s_cmp_eq_u32 s63, 0
    s_cbranch_scc1 L_d_wo
    s_cmp_eq_u32 s63, 2
    s_cbranch_scc1 L_d_w2
    s_cmp_eq_u32 s63, 3
    s_cbranch_scc1 L_d_none
    v_and_b32 v205, 15, v0
    v_lshlrev_b32 v205, 4, v205
    s_and_b32 s49, s3, 3
    s_mul_i32 s34, s49, 1280
    s_add_u32 s34, s34, 70656
    v_lshl_add_u32 v206, v202, 17, v205
    v_add_u32 v206, s34, v206
    s_mul_i32 s34, s49, 3840
    v_add_u32 v205, s34, v205
    s_lshl_b32 s34, s62, 6
    v_lshlrev_b32 v5, 4, v14
    v_lshl_add_u32 v5, v12, 2, v5
    v_add_u32 v5, s34, v5
    global_load_dword v6, v5, s[18:19]
    v_and_b32 v7, 15, v0
    v_lshlrev_b32 v7, 4, v7
    v_mul_u32_u24 v8, 1280, v14
    v_add_u32 v8, v8, v7
    v_bfe_u32 v9, v0, 3, 1
    v_lshlrev_b32 v9, 17, v9
    v_lshl_add_u32 v9, v14, 7, v9
    v_and_b32 v10, 7, v0
    v_lshl_add_u32 v9, v10, 4, v9
    v_add_u32 v9, 65536, v9
    s_mov_b32 s57, 262144
    v_mul_u32_u24 v5, 3840, v14
    v_add_u32 v5, v5, v7
    global_load_dwordx4 v[32:35], v8, s[4:5] offset:0
    global_load_dwordx4 v[36:39], v8, s[4:5] offset:256
    global_load_dwordx4 v[40:43], v8, s[4:5] offset:512
    global_load_dwordx4 v[44:47], v8, s[4:5] offset:768
    global_load_dwordx4 v[48:51], v8, s[4:5] offset:1024
    s_mov_b32 s35, 0
L_poll29:
    buffer_load_dwordx4 v[52:55], v9, s[44:47], s57 offen offset:1024 sc1
    buffer_load_dwordx4 v[56:59], v9, s[44:47], 0 offen offset:1536 sc1
    buffer_load_dwordx4 v[60:63], v9, s[44:47], s57 offen offset:1536 sc1
    buffer_load_dwordx4 v[64:67], v9, s[44:47], 0 offen offset:2048 sc1
    buffer_load_dwordx4 v[68:71], v9, s[44:47], s57 offen offset:2048 sc1
    buffer_load_dwordx4 v[72:75], v9, s[44:47], 0 offen offset:2560 sc1
    buffer_load_dwordx4 v[76:79], v9, s[44:47], s57 offen offset:2560 sc1
    buffer_load_dwordx4 v[80:83], v9, s[44:47], 0 offen offset:3072 sc1
    buffer_load_dwordx4 v[84:87], v9, s[44:47], s57 offen offset:3072 sc1
    buffer_load_dwordx4 v[88:91], v9, s[44:47], 0 offen offset:3584 sc1
    s_add_u32 s35, s35, 1
    s_waitcnt vmcnt(0)
    v_max3_u32 v28, v52, v53, v54
    v_max3_u32 v28, v28, v55, v56
    v_max3_u32 v28, v28, v57, v58
    v_max3_u32 v28, v28, v59, v60
    v_max3_u32 v28, v28, v61, v62
    v_max3_u32 v28, v28, v63, v64
    v_max3_u32 v28, v28, v65, v66
    v_max3_u32 v28, v28, v67, v68
    v_max3_u32 v28, v28, v69, v70
    v_max3_u32 v28, v28, v71, v72
    v_max3_u32 v28, v28, v73, v74
    v_max3_u32 v28, v28, v75, v76
    v_max3_u32 v28, v28, v77, v78
    v_max3_u32 v28, v28, v79, v80
    v_max3_u32 v28, v28, v81, v82
    v_max3_u32 v28, v28, v83, v84
    v_max3_u32 v28, v28, v85, v86
    v_max3_u32 v28, v28, v87, v88
    v_max3_u32 v28, v28, v89, v90
    v_max_u32 v28, v28, v91
    v_cmp_eq_u32 vcc, -1, v28
    s_cbranch_vccz L_done30
    s_sleep 16
    s_cmp_lt_u32 s35, 60000
    s_cbranch_scc1 L_poll29
L_done30:
    ds_write_b128 v5, v[32:35] offset:0
    ds_write_b128 v5, v[36:39] offset:256
    ds_write_b128 v5, v[40:43] offset:512
    ds_write_b128 v5, v[44:47] offset:768
    ds_write_b128 v5, v[48:51] offset:1024
    ds_write_b128 v5, v[52:55] offset:1280
    ds_write_b128 v5, v[56:59] offset:1536
    ds_write_b128 v5, v[60:63] offset:1792
    ds_write_b128 v5, v[64:67] offset:2048
    ds_write_b128 v5, v[68:71] offset:2304
    ds_write_b128 v5, v[72:75] offset:2560
    ds_write_b128 v5, v[76:79] offset:2816
    ds_write_b128 v5, v[80:83] offset:3072
    ds_write_b128 v5, v[84:87] offset:3328
    ds_write_b128 v5, v[88:91] offset:3584
    s_waitcnt lgkmcnt(0)
    v_lshlrev_b32 v100, 16, v6
    v_and_b32 v101, 0xffff0000, v6
    s_lshr_b32 s34, s62, 1
    s_lshl_b32 s34, s34, 7
    s_and_b32 s35, s62, 1
    s_mul_i32 s35, s35, 221184
    s_add_u32 s34, s34, s35
    v_lshrrev_b32 v197, 1, v0
    v_mul_u32_u24 v197, 3456, v197
    v_and_b32 v196, 1, v0
    v_lshl_add_u32 v197, v196, 6, v197
    v_add_u32 v197, s34, v197
    s_mov_b32 s40, 110592
    s_mov_b32 s41, 331776
    s_branch L_d_none
L_d_w2:
    s_lshl_b32 s34, s62, 5
    v_lshl_add_u32 v3, v14, 3, s34
    global_load_dwordx2 v[20:21], v3, s[22:23]
    v_mul_u32_u24 v112, 1280, v12
    v_add_u32 v112, v112, v3
    global_load_dwordx2 v[22:23], v112, s[4:5]
    s_lshr_b32 s34, s62, 2
    s_add_u32 s34, s34, 30
    s_lshr_b32 s35, s34, 2
    s_lshl_b32 s35, s35, 9
    s_and_b32 s34, s34, 3
    s_lshl_b32 s34, s34, 17
    s_add_u32 s34, s34, s35
    s_and_b32 s35, s62, 3
    s_mul_i32 s35, s35, 32
    s_add_u32 s34, s34, s35
    s_add_u32 s34, s34, 65536
    v_lshlrev_b32 v5, 7, v12
    v_lshl_add_u32 v5, v14, 3, v5
    v_add_u32 v5, s34, v5
    s_waitcnt vmcnt(0)
    v_lshlrev_b32 v32, 16, v20
    v_and_b32 v33, 0xffff0000, v20
    v_lshlrev_b32 v34, 16, v21
    v_and_b32 v35, 0xffff0000, v21
    v_lshlrev_b32 v108, 16, v22
    v_and_b32 v109, 0xffff0000, v22
    v_lshlrev_b32 v110, 16, v23
    v_and_b32 v111, 0xffff0000, v23
    s_mov_b32 s35, 0
L_poll32:
    buffer_load_dwordx2 v[24:25], v5, s[44:47], 0 offen sc1
    s_add_u32 s35, s35, 1
    s_waitcnt vmcnt(0)
    v_max_u32 v28, v24, v25
    v_cmp_eq_u32 vcc, -1, v28
    s_cbranch_vccz L_done33
    s_sleep 16
    s_cmp_lt_u32 s35, 60000
    s_cbranch_scc1 L_poll32
L_done33:
    v_lshlrev_b32 v104, 16, v24
    v_and_b32 v105, 0xffff0000, v24
    v_lshlrev_b32 v106, 16, v25
    v_and_b32 v107, 0xffff0000, v25
    v_fma_f32 v108, v104, v32, v108
    v_fma_f32 v109, v105, v33, v109
    v_fma_f32 v110, v106, v34, v110
    v_fma_f32 v111, v107, v35, v111
    v_mul_f32 v108, 0x3e800000, v108
    v_mul_f32 v109, 0x3e800000, v109
    v_mul_f32 v110, 0x3e800000, v110
    v_mul_f32 v111, 0x3e800000, v111
    v_lshl_add_u32 v204, v13, 17, v112
    v_add_u32 v204, 70656, v204
    s_lshr_b32 s34, s62, 2
    s_lshl_b32 s34, s34, 7
    s_and_b32 s35, s62, 3
    s_mul_i32 s35, s35, 81920
    s_add_u32 s34, s34, s35
    v_lshrrev_b32 v197, 1, v0
    v_mul_u32_u24 v197, 1280, v197
    v_and_b32 v196, 1, v0
    v_lshl_add_u32 v197, v196, 6, v197
    v_add_u32 v197, s34, v197
    s_mov_b32 s40, 40960
    s_mov_b32 s41, 286720
    s_branch L_d_none
L_d_wo:
    s_lshr_b32 s49, s3, 1
    s_lshl_b32 s49, s49, 17
    v_and_b32 v210, 7, v0
    s_lshl_b32 s34, s60, 12
    s_add_u32 s34, s34, s49
    s_add_u32 s34, s34, 98560
    v_lshrrev_b32 v211, 3, v0
    v_lshl_add_u32 v204, v211, 9, s34
    s_lshl_b32 s35, s51, 7
    s_add_u32 s34, s34, s35
    s_sub_u32 s34, s34, 256
    v_lshrrev_b32 v211, 3, v0
    v_lshlrev_b32 v205, 9, v211
    v_lshl_add_u32 v205, v210, 4, v205
    v_add_u32 v205, s34, v205
    s_lshl_b32 s34, s3, 12
    s_add_u32 s34, s34, 40960
    v_lshrrev_b32 v206, 2, v0
    v_lshlrev_b32 v206, 6, v206
    v_lshl_add_u32 v206, v200, 3, v206
    v_add_u32 v206, s34, v206
    s_mul_i32 s34, s3, 1152
    s_add_u32 s34, s34, 107520
    v_mul_u32_u24 v207, 144, v211
    v_lshl_add_u32 v207, v210, 4, v207
    v_add_u32 v207, s34, v207
    v_mul_u32_u24 v208, 144, v210
    v_lshl_add_u32 v208, v202, 4, v208
    v_add_u32 v208, s34, v208
    v_mul_u32_u24 v212, 144, v211
    v_add_u32 v212, s34, v212
    v_mul_u32_u24 v213, 144, v210
    v_add_u32 v213, s34, v213
    v_and_b32 v211, 1, v211
    v_lshl_add_u32 v203, v211, 6, v208
    v_add_u32 v203, 14592, v203
    v_mov_b32 v210, 98816
    v_cmp_eq_u32 vcc, 0, v211
    s_nop 1
    v_cndmask_b32 v209, v208, v210, vcc
    v_cndmask_b32 v208, v210, v208, vcc
    v_mov_b32 v6, v14
    v_and_b32 v8, 7, v0
    s_lshl_b32 s35, s62, 6
    v_lshl_add_u32 v8, v8, 3, s35
    s_lshr_b32 s34, s62, 1
    s_add_u32 s34, s34, 0
    s_lshr_b32 s35, s34, 2
    s_lshl_b32 s35, s35, 9
    s_and_b32 s34, s34, 3
    s_lshl_b32 s34, s34, 17
    s_add_u32 s34, s34, s35
    s_and_b32 s35, s62, 1
    s_mul_i32 s35, s35, 64
    s_add_u32 s34, s34, s35
    s_add_u32 s34, s34, 65536
    v_and_b32 v9, 7, v0
    v_lshlrev_b32 v9, 3, v9
    v_lshl_add_u32 v9, v6, 7, v9
    v_add_u32 v9, s34, v9
    s_lshr_b32 s34, s60, 2
    s_mul_i32 s34, s34, 5120
    s_and_b32 s35, s60, 3
    s_lshl_b32 s35, s35, 17
    s_add_u32 s34, s34, s35
    s_add_u32 s34, s34, 70656
    v_mul_u32_u24 v112, 1280, v6
    v_add3_u32 v112, v112, v8, s34
    s_mul_i32 s34, s62, 52
    s_lshr_b32 s34, s34, 8
    s_mul_i32 s35, s34, 5
    s_sub_u32 s35, s62, s35
    s_mul_i32 s34, s34, 1310720
    s_lshl_b32 s35, s35, 15
    s_add_u32 s34, s34, s35
    s_mul_i32 s35, s60, 163840
    s_add_u32 s34, s34, s35
    v_lshl_add_u32 v197, v0, 6, s34
    s_movk_i32 s40, 4096
    s_movk_i32 s41, 4096
    s_mov_b32 s35, 0
L_poll35:
    buffer_load_dwordx2 v[32:33], v9, s[44:47], 0 offen sc1
    s_add_u32 s35, s35, 1
    s_waitcnt vmcnt(0)
    v_max_u32 v22, v32, v33
    v_cmp_eq_u32 vcc, -1, v22
    s_cbranch_vccz L_done36
    s_sleep 16
    s_cmp_lt_u32 s35, 60000
    s_cbranch_scc1 L_poll35
L_done36:
    v_lshlrev_b32 v100, 16, v32
    v_and_b32 v101, 0xffff0000, v32
    v_lshlrev_b32 v102, 16, v33
    v_and_b32 v103, 0xffff0000, v33
L_d_none:
    v_and_b32 v19, 7, v0
    v_lshlrev_b32 v19, 3, v19
    v_add_u32 v19, 98560, v19
    s_mov_b32 s35, 0
L_poll38:
    ds_read_b64 v[20:21], v19
    s_add_u32 s35, s35, 1
    s_waitcnt lgkmcnt(0)
    v_max_u32 v22, v20, v21
    v_cmp_eq_u32 vcc, -1, v22
    s_cbranch_vccz L_done39
    s_sleep 2
    s_cmp_lt_u32 s35, 60000
    s_cbranch_scc1 L_poll38
L_done39:
    v_max_f32_dpp v22, v20, v20 row_half_mirror row_mask:0xf bank_mask:0xf
    s_nop 1
    v_max_f32_dpp v22, v22, v22 quad_perm:[1,0,3,2] row_mask:0xf bank_mask:0xf
    s_nop 1
    v_max_f32_dpp v22, v22, v22 quad_perm:[2,3,0,1] row_mask:0xf bank_mask:0xf
    v_sub_f32 v20, v20, v22
    v_exp_f32 v20, v20
    s_nop 0
    v_mul_f32 v21, v21, v20
    s_nop 1
    v_add_f32_dpp v21, v21, v21 row_half_mirror row_mask:0xf bank_mask:0xf
    s_nop 1
    v_add_f32_dpp v21, v21, v21 quad_perm:[1,0,3,2] row_mask:0xf bank_mask:0xf
    s_nop 1
    v_add_f32_dpp v21, v21, v21 quad_perm:[2,3,0,1] row_mask:0xf bank_mask:0xf
    v_rcp_f32 v23, v21
    v_log_f32 v21, v21
    v_mul_f32 v20, v20, v23
    v_add_f32 v21, v21, v22
    v_min_u32 v21, -2, v21
    v_readlane_b32 s88, v20, 0
    v_readlane_b32 s90, v20, 1
    v_readlane_b32 s92, v20, 2
    v_readlane_b32 s94, v20, 3
    v_readlane_b32 s96, v20, 4
    v_readlane_b32 s98, v20, 5
    v_readlane_b32 s100, v20, 6
    v_readlane_b32 s89, v20, 7
    s_and_b32 s95, s61, 3
    s_lshl_b32 s95, s95, 17
    s_bfe_u32 s35, s2, 0x20005
    s_lshl_b32 s35, s35, 1
    s_lshr_b32 s91, s2, 7
    s_add_u32 s35, s35, s91
    v_mov_b32 v24, v21
    v_mov_b32 v25, v21
    v_mul_f32 v20, s89, v116
    v_mul_f32 v21, s89, v117
    v_mul_f32 v22, s89, v118
    v_mul_f32 v23, s89, v119
    s_lshl_b32 s34, s60, 12
    s_lshl_b32 s35, s35, 9
    s_add_u32 s34, s34, s35
    s_add_u32 s34, s34, s95
    s_add_u32 s34, s34, 98304
    v_and_b32 v18, 7, v0
    v_lshl_add_u32 v18, v14, 3, v18
    v_bfe_u32 v19, v0, 3, 1
    v_lshl_add_u32 v18, v19, 5, v18
    v_lshl_add_u32 v18, v18, 3, s34
    v_lshlrev_b32 v19, 4, v0
    v_add_u32 v19, 99328, v19
    s_barrier
    s_cmp_ge_u32 s63, 1
    s_cbranch_scc1 L_nopf
    buffer_load_dword v250, v197, s[52:55], s42 offen
    s_add_u32 s42, s42, s40
    buffer_load_dword v250, v197, s[52:55], s42 offen
    s_add_u32 s42, s42, s41
    buffer_load_dword v250, v197, s[52:55], s42 offen
    s_add_u32 s42, s42, s40
    buffer_load_dword v250, v197, s[52:55], s42 offen
    s_add_u32 s42, s42, s41
    buffer_load_dword v250, v197, s[52:55], s42 offen
    s_add_u32 s42, s42, s40
    buffer_load_dword v250, v197, s[52:55], s42 offen
    s_add_u32 s42, s42, s41
    buffer_load_dword v250, v197, s[52:55], s42 offen
    s_add_u32 s42, s42, s40
    buffer_load_dword v250, v197, s[52:55], s42 offen
    s_add_u32 s42, s42, s41
L_nopf:
    s_barrier
    ds_read_b128 v[32:35], v19 offset:0
    ds_read_b128 v[36:39], v19 offset:1024
    ds_read_b128 v[40:43], v19 offset:2048
    ds_read_b128 v[44:47], v19 offset:3072
    ds_read_b128 v[48:51], v19 offset:4096
    ds_read_b128 v[52:55], v19 offset:5120
    ds_read_b128 v[56:59], v19 offset:6144
    s_waitcnt lgkmcnt(6)
    v_pk_fma_f32 v[20:21], v[32:33], s[88:89], v[20:21] op_sel_hi:[1,0,1]
    v_pk_fma_f32 v[22:23], v[34:35], s[88:89], v[22:23] op_sel_hi:[1,0,1]
    s_waitcnt lgkmcnt(5)
    v_pk_fma_f32 v[20:21], v[36:37], s[90:91], v[20:21] op_sel_hi:[1,0,1]
    v_pk_fma_f32 v[22:23], v[38:39], s[90:91], v[22:23] op_sel_hi:[1,0,1]
    s_waitcnt lgkmcnt(4)
    v_pk_fma_f32 v[20:21], v[40:41], s[92:93], v[20:21] op_sel_hi:[1,0,1]
    v_pk_fma_f32 v[22:23], v[42:43], s[92:93], v[22:23] op_sel_hi:[1,0,1]
    s_waitcnt lgkmcnt(3)
    v_pk_fma_f32 v[20:21], v[44:45], s[94:95], v[20:21] op_sel_hi:[1,0,1]
    v_pk_fma_f32 v[22:23], v[46:47], s[94:95], v[22:23] op_sel_hi:[1,0,1]
    s_waitcnt lgkmcnt(2)
    v_pk_fma_f32 v[20:21], v[48:49], s[96:97], v[20:21] op_sel_hi:[1,0,1]
    v_pk_fma_f32 v[22:23], v[50:51], s[96:97], v[22:23] op_sel_hi:[1,0,1]
    s_waitcnt lgkmcnt(1)
    v_pk_fma_f32 v[20:21], v[52:53], s[98:99], v[20:21] op_sel_hi:[1,0,1]
    v_pk_fma_f32 v[22:23], v[54:55], s[98:99], v[22:23] op_sel_hi:[1,0,1]
    s_waitcnt lgkmcnt(0)
    v_pk_fma_f32 v[20:21], v[56:57], s[100:101], v[20:21] op_sel_hi:[1,0,1]
    v_pk_fma_f32 v[22:23], v[58:59], s[100:101], v[22:23] op_sel_hi:[1,0,1]
    s_nop 0
    v_add_f32_dpp v20, v20, v20 row_ror:8 row_mask:0xf bank_mask:0xf
    v_add_f32_dpp v21, v21, v21 row_ror:8 row_mask:0xf bank_mask:0xf
    v_add_f32_dpp v22, v22, v22 row_ror:8 row_mask:0xf bank_mask:0xf
    v_add_f32_dpp v23, v23, v23 row_ror:8 row_mask:0xf bank_mask:0xf
    s_mov_b32 exec_lo, 0x00ff00ff
    s_mov_b32 exec_hi, 0x00ff00ff
    v_cvt_pk_bf16_f32 v24, v20, v21
    v_cvt_pk_bf16_f32 v25, v22, v23
    v_min_u32 v24, -2, v24
    v_min_u32 v25, -2, v25
    s_mov_b32 exec_lo, 16777215
    buffer_store_dwordx2 v[24:25], v18, s[44:47], 0 offen sc1
    s_mov_b64 exec, -1
    s_cmp_lt_u32 s63, 1
    s_cbranch_scc1 L_nopf2
    buffer_load_dword v250, v197, s[52:55], s42 offen
    s_add_u32 s42, s42, s40
    buffer_load_dword v250, v197, s[52:55], s42 offen
    s_add_u32 s42, s42, s41
    buffer_load_dword v250, v197, s[52:55], s42 offen
    s_add_u32 s42, s42, s40
    buffer_load_dword v250, v197, s[52:55], s42 offen
    s_add_u32 s42, s42, s41
    buffer_load_dword v250, v197, s[52:55], s42 offen
    s_add_u32 s42, s42, s40
    buffer_load_dword v250, v197, s[52:55], s42 offen
    s_add_u32 s42, s42, s41
    buffer_load_dword v250, v197, s[52:55], s42 offen
    s_add_u32 s42, s42, s40
    buffer_load_dword v250, v197, s[52:55], s42 offen
    s_add_u32 s42, s42, s41
L_nopf2:
    s_barrier
    s_cmp_eq_u32 s63, 0
    s_cbranch_scc1 L_r_wo2
    buffer_load_dword v250, v197, s[52:55], s42 offen
    s_add_u32 s42, s42, s40
    buffer_load_dword v250, v197, s[52:55], s42 offen
    s_add_u32 s42, s42, s41
    s_cmp_eq_u32 s63, 1
    s_cbranch_scc1 L_r_w1
    buffer_load_dword v250, v197, s[52:55], s42 offen
    s_add_u32 s42, s42, s40
    buffer_load_dword v250, v197, s[52:55], s42 offen
    s_add_u32 s42, s42, s41
    buffer_load_dword v250, v197, s[52:55], s42 offen
    s_add_u32 s42, s42, s40
    buffer_load_dword v250, v197, s[52:55], s42 offen
    s_add_u32 s42, s42, s41
    s_cmp_eq_u32 s63, 2
    s_cbranch_scc1 L_w2_red
    s_branch L_fin
L_stream:
    s_sub_u32 s49, s3, 1
    s_lshl_b32 s49, s49, 12
    v_lshl_add_u32 v1, v0, 4, s49
    s_and_b32 s34, s2, 127
    s_lshl_b32 s34, s34, 21
    s_lshr_b32 s35, s2, 7
    s_lshl_b32 s35, s35, 18
    s_add_u32 s34, s34, s35
    s_add_u32 s34, s34, 1572864
    s_mov_b32 s38, 0x40000
    s_mov_b32 s42, 0x40000
    s_waitcnt lgkmcnt(0)
    s_add_u32 s36, s6, s34
    s_addc_u32 s37, s7, 0
    s_add_u32 s40, s8, s34
    s_addc_u32 s41, s9, 0
    s_mov_b32 s49, 0
    buffer_load_dwordx4 v[16:19], v1, s[36:39], s49 offen offset:0 nt
    buffer_load_dwordx4 v[20:23], v1, s[36:39], s49 offen offset:1024 nt
    buffer_load_dwordx4 v[24:27], v1, s[36:39], s49 offen offset:2048 nt
    s_barrier
    s_waitcnt vmcnt(2)
    buffer_load_dwordx4 v[28:31], v1, s[36:39], s49 offen offset:3072 nt
    s_waitcnt vmcnt(2)
    s_mov_b32 s49, 28672
    buffer_load_dwordx4 v[32:35], v1, s[36:39], s49 offen offset:0 nt
    s_waitcnt vmcnt(2)
    buffer_load_dwordx4 v[36:39], v1, s[36:39], s49 offen offset:1024 nt
    s_waitcnt vmcnt(2)
    buffer_load_dwordx4 v[40:43], v1, s[36:39], s49 offen offset:2048 nt
    s_waitcnt vmcnt(2)
    buffer_load_dwordx4 v[44:47], v1, s[36:39], s49 offen offset:3072 nt
    s_add_u32 s44, s32, 0
    s_addc_u32 s45, s33, 0
    s_mov_b32 s63, 0
    s_mov_b32 s62, s61
    s_cmp_lt_u32 s61, 20
    s_cbranch_scc1 L_rd41
    s_mul_i32 s62, s60, 12
    s_add_u32 s62, s62, s61
    s_sub_u32 s62, s62, 20
    s_mov_b32 s63, 1
    s_cmp_lt_u32 s62, 54
    s_cbranch_scc1 L_rd41
    s_cmp_lt_u32 s62, 56
    s_cselect_b32 s63, 3, 2
    s_sub_u32 s62, s62, 56
L_rd41:
    v_and_b32 v8, 3, v0
    v_bfe_u32 v9, v0, 2, 2
    v_lshrrev_b32 v10, 4, v0
    s_mov_b32 s55, 0x20000
    s_lshl_b32 s35, s62, 6
    s_and_b32 s49, s62, 1
    s_cmp_eq_u32 s63, 0
    s_cbranch_scc1 L_dp43
    s_cmp_eq_u32 s63, 1
    s_cbranch_scc1 L_dp44
    s_mov_b32 s52, s20
    s_mov_b32 s53, s21
    s_mov_b32 s54, 2211840
    v_mov_b32 v15, 0
    s_branch L_dp45
L_dp44:
    s_mov_b32 s52, s16
    s_mov_b32 s53, s17
    s_mov_b32 s54, 2211840
    v_lshl_add_u32 v15, v9, 3, v10
    v_mul_u32_u24 v15, 3456, v15
    v_lshl_add_u32 v15, v8, 4, v15
    v_add_u32 v15, s35, v15
    s_bfe_u32 s50, s3, 0x10001
    s_lshl_b32 s50, s50, 7
    s_and_b32 s34, s3, 1
    s_lshl_b32 s34, s34, 2
    s_add_u32 s50, s50, s34
    s_and_b32 s51, s3, 3
    s_lshl_b32 s51, s51, 5
    s_add_u32 s51, s51, 512
    s_mul_i32 s50, s50, 3456
    s_mul_i32 s51, s51, 3456
    s_branch L_dp45
L_dp43:
    s_mov_b32 s52, s12
    s_mov_b32 s53, s13
    s_mov_b32 s54, 5242880
    s_lshr_b32 s50, s3, 1
    s_lshl_b32 s50, s50, 3
    s_add_u32 s50, s50, s60
    s_and_b32 s51, s3, 1
    s_lshl_b32 s34, s50, 1
    s_add_u32 s34, s34, s51
    s_mul_i32 s34, s34, 81920
    s_add_u32 s34, s34, s35
    v_lshl_add_u32 v15, v9, 2, v10
    v_mul_u32_u24 v15, 2560, v15
    v_lshl_add_u32 v15, v8, 4, v15
    v_add_u32 v15, s34, v15
    s_lshl_b32 s56, s3, 12
    s_lshl_b32 s34, s49, 11
    s_add_u32 s56, s56, s34
    s_add_u32 s56, s56, 40960
    s_add_u32 s58, s56, 1024
    s_mul_i32 s57, s49, 40960
    s_add_u32 s59, s57, 1280
L_dp45:
    v_and_b32 v2, 15, v0
    v_lshlrev_b32 v2, 4, v2
    v_add_u32 v2, 98304, v2
    s_waitcnt vmcnt(2)
    s_mov_b32 s49, 57344
    buffer_load_dwordx4 v[48:51], v1, s[36:39], s49 offen offset:0 nt
    s_waitcnt vmcnt(2)
    buffer_load_dwordx4 v[52:55], v1, s[36:39], s49 offen offset:1024 nt
    s_waitcnt vmcnt(2)
    s_cmp_ge_u32 s3, 4
    s_cbranch_scc1 L_sl46
    s_waitcnt vmcnt(1)
L_sl46:
    buffer_load_dwordx4 v[56:59], v1, s[36:39], s49 offen offset:2048 nt
    s_waitcnt vmcnt(2)
    s_cmp_ge_u32 s3, 4
    s_cbranch_scc1 L_sl47
    s_waitcnt vmcnt(1)
L_sl47:
    buffer_load_dwordx4 v[60:63], v1, s[36:39], s49 offen offset:3072 nt
    s_waitcnt vmcnt(2)
    s_cmp_ge_u32 s3, 4
    s_cbranch_scc1 L_sl48
    s_waitcnt vmcnt(1)
L_sl48:
    s_mov_b32 s49, 86016
    buffer_load_dwordx4 v[64:67], v1, s[36:39], s49 offen offset:0 nt
    s_waitcnt vmcnt(2)
    buffer_load_dwordx4 v[68:71], v1, s[36:39], s49 offen offset:1024 nt
    s_waitcnt vmcnt(2)
    buffer_load_dwordx4 v[72:75], v1, s[36:39], s49 offen offset:2048 nt
    s_waitcnt vmcnt(2)
    buffer_load_dwordx4 v[76:79], v1, s[36:39], s49 offen offset:3072 nt
    s_waitcnt vmcnt(2)
    s_mov_b32 s49, 114688
    buffer_load_dwordx4 v[80:83], v1, s[36:39], s49 offen offset:0 nt
    s_waitcnt vmcnt(2)
    buffer_load_dwordx4 v[84:87], v1, s[36:39], s49 offen offset:1024 nt
    s_waitcnt vmcnt(2)
    buffer_load_dwordx4 v[88:91], v1, s[36:39], s49 offen offset:2048 nt
    v_mov_b32 v3, 19
    ds_write_b32 v2, v3 offset:768
    s_waitcnt vmcnt(2)
    buffer_load_dwordx4 v[92:95], v1, s[36:39], s49 offen offset:3072 nt
    s_waitcnt vmcnt(2)
    s_mov_b32 s49, 143360
    buffer_load_dwordx4 v[96:99], v1, s[36:39], s49 offen offset:0 nt
    s_waitcnt vmcnt(2)
    buffer_load_dwordx4 v[100:103], v1, s[36:39], s49 offen offset:1024 nt
    s_waitcnt vmcnt(2)
    buffer_load_dwordx4 v[104:107], v1, s[36:39], s49 offen offset:2048 nt
    s_waitcnt vmcnt(2)
    buffer_load_dwordx4 v[108:111], v1, s[36:39], s49 offen offset:3072 nt
    s_waitcnt vmcnt(2)
    s_mov_b32 s49, 172032
    buffer_load_dwordx4 v[112:115], v1, s[36:39], s49 offen offset:0 nt
    s_waitcnt vmcnt(2)
    buffer_load_dwordx4 v[116:119], v1, s[36:39], s49 offen offset:1024 nt
    s_waitcnt vmcnt(2)
    buffer_load_dwordx4 v[120:123], v1, s[36:39], s49 offen offset:2048 nt
    s_waitcnt vmcnt(2)
    buffer_load_dwordx4 v[124:127], v1, s[36:39], s49 offen offset:3072 nt
    s_waitcnt vmcnt(2)
    s_mov_b32 s49, 200704
    buffer_load_dwordx4 v[128:131], v1, s[36:39], s49 offen offset:0 nt
    s_waitcnt vmcnt(2)
    buffer_load_dwordx4 v[132:135], v1, s[36:39], s49 offen offset:1024 nt
    s_waitcnt vmcnt(2)
    buffer_load_dwordx4 v[136:139], v1, s[36:39], s49 offen offset:2048 nt
    v_mov_b32 v3, 31
    ds_write_b32 v2, v3 offset:768
    s_waitcnt vmcnt(2)
    buffer_load_dwordx4 v[140:143], v1, s[36:39], s49 offen offset:3072 nt
    s_waitcnt vmcnt(2)
    s_mov_b32 s49, 229376
    buffer_load_dwordx4 v[144:147], v1, s[36:39], s49 offen offset:0 nt
    s_waitcnt vmcnt(2)
    buffer_load_dwordx4 v[148:151], v1, s[36:39], s49 offen offset:1024 nt
    s_waitcnt vmcnt(2)
    buffer_load_dwordx4 v[152:155], v1, s[36:39], s49 offen offset:2048 nt
    s_waitcnt vmcnt(2)
    buffer_load_dwordx4 v[156:159], v1, s[36:39], s49 offen offset:3072 nt
    s_waitcnt vmcnt(2)
    s_mov_b32 s49, 0
    buffer_load_dwordx4 v[160:163], v1, s[40:43], s49 offen offset:0 nt
    s_waitcnt vmcnt(2)
    buffer_load_dwordx4 v[164:167], v1, s[40:43], s49 offen offset:1024 nt
    s_waitcnt vmcnt(2)
    buffer_load_dwordx4 v[168:171], v1, s[40:43], s49 offen offset:2048 nt
    s_waitcnt vmcnt(2)
    buffer_load_dwordx4 v[172:175], v1, s[40:43], s49 offen offset:3072 nt
    s_waitcnt vmcnt(2)
    s_mov_b32 s49, 28672
    buffer_load_dwordx4 v[176:179], v1, s[40:43], s49 offen offset:0 nt
    s_waitcnt vmcnt(2)
    buffer_load_dwordx4 v[180:183], v1, s[40:43], s49 offen offset:1024 nt
    s_waitcnt vmcnt(2)
    buffer_load_dwordx4 v[184:187], v1, s[40:43], s49 offen offset:2048 nt
    s_waitcnt vmcnt(2)
    buffer_load_dwordx4 v[188:191], v1, s[40:43], s49 offen offset:3072 nt
    s_waitcnt vmcnt(2)
    s_mov_b32 s49, 57344
    buffer_load_dwordx4 v[192:195], v1, s[40:43], s49 offen offset:0 nt
    s_waitcnt vmcnt(2)
    buffer_load_dwordx4 v[196:199], v1, s[40:43], s49 offen offset:1024 nt
    s_waitcnt vmcnt(2)
    buffer_load_dwordx4 v[200:203], v1, s[40:43], s49 offen offset:2048 nt
    s_waitcnt vmcnt(2)
    buffer_load_dwordx4 v[204:207], v1, s[40:43], s49 offen offset:3072 nt
    s_waitcnt vmcnt(2)
    s_mov_b32 s49, 86016
    buffer_load_dwordx4 v[208:211], v1, s[40:43], s49 offen offset:0 nt
    s_waitcnt vmcnt(2)
    buffer_load_dwordx4 v[212:215], v1, s[40:43], s49 offen offset:1024 nt
    s_waitcnt vmcnt(2)
    buffer_load_dwordx4 v[216:219], v1, s[40:43], s49 offen offset:2048 nt
    s_waitcnt vmcnt(2)
    buffer_load_dwordx4 v[220:223], v1, s[40:43], s49 offen offset:3072 nt
    s_waitcnt vmcnt(2)
    s_mov_b32 s49, 114688
    buffer_load_dwordx4 v[224:227], v1, s[40:43], s49 offen offset:0 nt
    s_waitcnt vmcnt(2)
    buffer_load_dwordx4 v[228:231], v1, s[40:43], s49 offen offset:1024 nt
    s_waitcnt vmcnt(2)
    buffer_load_dwordx4 v[232:235], v1, s[40:43], s49 offen offset:2048 nt
    s_waitcnt vmcnt(2)
    buffer_load_dwordx4 v[236:239], v1, s[40:43], s49 offen offset:3072 nt
    s_mov_b32 s35, 0
L_poll49:
    ds_read_b128 v[4:7], v2
    s_add_u32 s35, s35, 1
    s_waitcnt lgkmcnt(0)
    v_max3_u32 v3, v4, v5, v6
    v_max_u32 v3, v3, v7
    v_cmp_eq_u32 vcc, -1, v3
    s_cbranch_vccz L_done50
    s_sleep 2
    s_cmp_lt_u32 s35, 60000
    s_cbranch_scc1 L_poll49
L_done50:
    s_waitcnt vmcnt(2)
    s_mov_b32 s49, 143360
    buffer_load_dwordx4 v[240:243], v1, s[40:43], s49 offen offset:0 nt
    v_dot2_f32_bf16 v8, v16, v4, 0
    v_dot2_f32_bf16 v9, v20, v4, 0
    v_dot2_f32_bf16 v10, v24, v4, 0
    v_dot2_f32_bf16 v11, v28, v4, 0
    v_dot2c_f32_bf16 v8, v17, v5
    v_dot2c_f32_bf16 v9, v21, v5
    v_dot2c_f32_bf16 v10, v25, v5
    v_dot2c_f32_bf16 v11, v29, v5
    v_dot2c_f32_bf16 v8, v18, v6
    v_dot2c_f32_bf16 v9, v22, v6
    v_dot2c_f32_bf16 v10, v26, v6
    v_dot2c_f32_bf16 v11, v30, v6
    v_dot2c_f32_bf16 v8, v19, v7
    v_dot2c_f32_bf16 v9, v23, v7
    v_dot2c_f32_bf16 v10, v27, v7
    v_dot2c_f32_bf16 v11, v31, v7
    v_add_f32_dpp v12, v8, v8 row_ror:8 row_mask:0xf bank_mask:0x3
    v_add_f32_dpp v12, v9, v9 row_ror:8 row_mask:0xf bank_mask:0xc
    v_add_f32_dpp v13, v10, v10 row_ror:8 row_mask:0xf bank_mask:0x3
    v_add_f32_dpp v13, v11, v11 row_ror:8 row_mask:0xf bank_mask:0xc
    v_dot2_f32_bf16 v8, v32, v4, 0
    v_dot2_f32_bf16 v9, v36, v4, 0
    v_dot2_f32_bf16 v10, v40, v4, 0
    v_dot2_f32_bf16 v11, v44, v4, 0
    v_add_f32_dpp v12, v12, v12 row_half_mirror row_mask:0xf bank_mask:0xf
    v_add_f32_dpp v13, v13, v13 row_half_mirror row_mask:0xf bank_mask:0xf
    v_dot2c_f32_bf16 v8, v33, v5
    v_dot2c_f32_bf16 v9, v37, v5
    v_dot2c_f32_bf16 v10, v41, v5
    v_dot2c_f32_bf16 v11, v45, v5
    v_add_f32_dpp v12, v12, v12 quad_perm:[1,0,3,2] row_mask:0xf bank_mask:0xf
    v_add_f32_dpp v13, v13, v13 quad_perm:[1,0,3,2] row_mask:0xf bank_mask:0xf
    v_dot2c_f32_bf16 v8, v34, v6
    v_dot2c_f32_bf16 v9, v38, v6
    v_dot2c_f32_bf16 v10, v42, v6
    v_dot2c_f32_bf16 v11, v46, v6
    s_waitcnt vmcnt(2)
    buffer_load_dwordx4 v[244:247], v1, s[40:43], s49 offen offset:1024 nt
    v_add_f32_dpp v12, v12, v12 quad_perm:[2,3,0,1] row_mask:0xf bank_mask:0xf
    v_add_f32_dpp v13, v13, v13 quad_perm:[2,3,0,1] row_mask:0xf bank_mask:0xf
    v_dot2c_f32_bf16 v8, v35, v7
    v_dot2c_f32_bf16 v9, v39, v7
    v_dot2c_f32_bf16 v10, v43, v7
    v_dot2c_f32_bf16 v11, v47, v7
    v_add_f32_dpp v16, v8, v8 row_ror:8 row_mask:0xf bank_mask:0x3
    v_add_f32_dpp v16, v9, v9 row_ror:8 row_mask:0xf bank_mask:0xc
    v_add_f32_dpp v17, v10, v10 row_ror:8 row_mask:0xf bank_mask:0x3
    v_add_f32_dpp v17, v11, v11 row_ror:8 row_mask:0xf bank_mask:0xc
    v_dot2_f32_bf16 v8, v48, v4, 0
    v_dot2_f32_bf16 v9, v52, v4, 0
    v_dot2_f32_bf16 v10, v56, v4, 0
    v_dot2_f32_bf16 v11, v60, v4, 0
    v_add_f32_dpp v16, v16, v16 row_half_mirror row_mask:0xf bank_mask:0xf
    v_add_f32_dpp v17, v17, v17 row_half_mirror row_mask:0xf bank_mask:0xf
    v_dot2c_f32_bf16 v8, v49, v5
    v_dot2c_f32_bf16 v9, v53, v5
    v_dot2c_f32_bf16 v10, v57, v5
    v_dot2c_f32_bf16 v11, v61, v5
    v_add_f32_dpp v16, v16, v16 quad_perm:[1,0,3,2] row_mask:0xf bank_mask:0xf
    v_add_f32_dpp v17, v17, v17 quad_perm:[1,0,3,2] row_mask:0xf bank_mask:0xf
    v_dot2c_f32_bf16 v8, v50, v6
    v_dot2c_f32_bf16 v9, v54, v6
    v_dot2c_f32_bf16 v10, v58, v6
    v_dot2c_f32_bf16 v11, v62, v6
    v_add_f32_dpp v16, v16, v16 quad_perm:[2,3,0,1] row_mask:0xf bank_mask:0xf
    v_add_f32_dpp v17, v17, v17 quad_perm:[2,3,0,1] row_mask:0xf bank_mask:0xf
    v_dot2c_f32_bf16 v8, v51, v7
    v_dot2c_f32_bf16 v9, v55, v7
    v_dot2c_f32_bf16 v10, v59, v7
    v_dot2c_f32_bf16 v11, v63, v7
    v_add_f32_dpp v18, v8, v8 row_ror:8 row_mask:0xf bank_mask:0x3
    v_add_f32_dpp v18, v9, v9 row_ror:8 row_mask:0xf bank_mask:0xc
    v_add_f32_dpp v19, v10, v10 row_ror:8 row_mask:0xf bank_mask:0x3
    v_add_f32_dpp v19, v11, v11 row_ror:8 row_mask:0xf bank_mask:0xc
    s_waitcnt vmcnt(2)
    buffer_load_dwordx4 v[248:251], v1, s[40:43], s49 offen offset:2048 nt
    v_dot2_f32_bf16 v8, v64, v4, 0
    v_dot2_f32_bf16 v9, v68, v4, 0
    v_dot2_f32_bf16 v10, v72, v4, 0
    v_dot2_f32_bf16 v11, v76, v4, 0
    v_add_f32_dpp v18, v18, v18 row_half_mirror row_mask:0xf bank_mask:0xf
    v_add_f32_dpp v19, v19, v19 row_half_mirror row_mask:0xf bank_mask:0xf
    v_dot2c_f32_bf16 v8, v65, v5
    v_dot2c_f32_bf16 v9, v69, v5
    v_dot2c_f32_bf16 v10, v73, v5
    v_dot2c_f32_bf16 v11, v77, v5
    v_add_f32_dpp v18, v18, v18 quad_perm:[1,0,3,2] row_mask:0xf bank_mask:0xf
    v_add_f32_dpp v19, v19, v19 quad_perm:[1,0,3,2] row_mask:0xf bank_mask:0xf
    v_dot2c_f32_bf16 v8, v66, v6
    v_dot2c_f32_bf16 v9, v70, v6
    v_dot2c_f32_bf16 v10, v74, v6
    v_dot2c_f32_bf16 v11, v78, v6
    v_add_f32_dpp v18, v18, v18 quad_perm:[2,3,0,1] row_mask:0xf bank_mask:0xf
    v_add_f32_dpp v19, v19, v19 quad_perm:[2,3,0,1] row_mask:0xf bank_mask:0xf
    v_dot2c_f32_bf16 v8, v67, v7
    v_dot2c_f32_bf16 v9, v71, v7
    v_dot2c_f32_bf16 v10, v75, v7
    v_dot2c_f32_bf16 v11, v79, v7
    v_add_f32_dpp v20, v8, v8 row_ror:8 row_mask:0xf bank_mask:0x3
    v_add_f32_dpp v20, v9, v9 row_ror:8 row_mask:0xf bank_mask:0xc
    v_add_f32_dpp v21, v10, v10 row_ror:8 row_mask:0xf bank_mask:0x3
    v_add_f32_dpp v21, v11, v11 row_ror:8 row_mask:0xf bank_mask:0xc
    v_dot2_f32_bf16 v8, v80, v4, 0
    v_dot2_f32_bf16 v9, v84, v4, 0
    v_dot2_f32_bf16 v10, v88, v4, 0
    v_dot2_f32_bf16 v11, v92, v4, 0
    v_add_f32_dpp v20, v20, v20 row_half_mirror row_mask:0xf bank_mask:0xf
    v_add_f32_dpp v21, v21, v21 row_half_mirror row_mask:0xf bank_mask:0xf
    v_dot2c_f32_bf16 v8, v81, v5
    v_dot2c_f32_bf16 v9, v85, v5
    v_dot2c_f32_bf16 v10, v89, v5
    v_dot2c_f32_bf16 v11, v93, v5
    s_waitcnt vmcnt(2)
    buffer_load_dwordx4 v[252:255], v1, s[40:43], s49 offen offset:3072 nt
    v_add_f32_dpp v20, v20, v20 quad_perm:[1,0,3,2] row_mask:0xf bank_mask:0xf
    v_add_f32_dpp v21, v21, v21 quad_perm:[1,0,3,2] row_mask:0xf bank_mask:0xf
    v_dot2c_f32_bf16 v8, v82, v6
    v_dot2c_f32_bf16 v9, v86, v6
    v_dot2c_f32_bf16 v10, v90, v6
    v_dot2c_f32_bf16 v11, v94, v6
    v_add_f32_dpp v20, v20, v20 quad_perm:[2,3,0,1] row_mask:0xf bank_mask:0xf
    v_add_f32_dpp v21, v21, v21 quad_perm:[2,3,0,1] row_mask:0xf bank_mask:0xf
    v_dot2c_f32_bf16 v8, v83, v7
    v_dot2c_f32_bf16 v9, v87, v7
    v_dot2c_f32_bf16 v10, v91, v7
    v_dot2c_f32_bf16 v11, v95, v7
    v_add_f32_dpp v22, v8, v8 row_ror:8 row_mask:0xf bank_mask:0x3
    v_add_f32_dpp v22, v9, v9 row_ror:8 row_mask:0xf bank_mask:0xc
    v_add_f32_dpp v23, v10, v10 row_ror:8 row_mask:0xf bank_mask:0x3
    v_add_f32_dpp v23, v11, v11 row_ror:8 row_mask:0xf bank_mask:0xc
    v_dot2_f32_bf16 v8, v96, v4, 0
    v_dot2_f32_bf16 v9, v100, v4, 0
    v_dot2_f32_bf16 v10, v104, v4, 0
    v_dot2_f32_bf16 v11, v108, v4, 0
    v_add_f32_dpp v22, v22, v22 row_half_mirror row_mask:0xf bank_mask:0xf
    v_add_f32_dpp v23, v23, v23 row_half_mirror row_mask:0xf bank_mask:0xf
    v_dot2c_f32_bf16 v8, v97, v5
    v_dot2c_f32_bf16 v9, v101, v5
    v_dot2c_f32_bf16 v10, v105, v5
    v_dot2c_f32_bf16 v11, v109, v5
    v_add_f32_dpp v22, v22, v22 quad_perm:[1,0,3,2] row_mask:0xf bank_mask:0xf
    v_add_f32_dpp v23, v23, v23 quad_perm:[1,0,3,2] row_mask:0xf bank_mask:0xf
    v_dot2c_f32_bf16 v8, v98, v6
    v_dot2c_f32_bf16 v9, v102, v6
    v_dot2c_f32_bf16 v10, v106, v6
    v_dot2c_f32_bf16 v11, v110, v6
    v_add_f32_dpp v22, v22, v22 quad_perm:[2,3,0,1] row_mask:0xf bank_mask:0xf
    v_add_f32_dpp v23, v23, v23 quad_perm:[2,3,0,1] row_mask:0xf bank_mask:0xf
    v_dot2c_f32_bf16 v8, v99, v7
    v_dot2c_f32_bf16 v9, v103, v7
    s_waitcnt vmcnt(2)
    s_mov_b32 s49, 172032
    buffer_load_dwordx4 v[32:35], v1, s[40:43], s49 offen offset:0 nt
    v_dot2c_f32_bf16 v10, v107, v7
    v_dot2c_f32_bf16 v11, v111, v7
    v_add_f32_dpp v24, v8, v8 row_ror:8 row_mask:0xf bank_mask:0x3
    v_add_f32_dpp v24, v9, v9 row_ror:8 row_mask:0xf bank_mask:0xc
    v_add_f32_dpp v25, v10, v10 row_ror:8 row_mask:0xf bank_mask:0x3
    v_add_f32_dpp v25, v11, v11 row_ror:8 row_mask:0xf bank_mask:0xc
    v_dot2_f32_bf16 v8, v112, v4, 0
    v_dot2_f32_bf16 v9, v116, v4, 0
    v_dot2_f32_bf16 v10, v120, v4, 0
    v_dot2_f32_bf16 v11, v124, v4, 0
    v_add_f32_dpp v24, v24, v24 row_half_mirror row_mask:0xf bank_mask:0xf
    v_add_f32_dpp v25, v25, v25 row_half_mirror row_mask:0xf bank_mask:0xf
    v_dot2c_f32_bf16 v8, v113, v5
    v_dot2c_f32_bf16 v9, v117, v5
    v_dot2c_f32_bf16 v10, v121, v5
    v_dot2c_f32_bf16 v11, v125, v5
    v_add_f32_dpp v24, v24, v24 quad_perm:[1,0,3,2] row_mask:0xf bank_mask:0xf
    v_add_f32_dpp v25, v25, v25 quad_perm:[1,0,3,2] row_mask:0xf bank_mask:0xf
    v_dot2c_f32_bf16 v8, v114, v6
    v_dot2c_f32_bf16 v9, v118, v6
    v_dot2c_f32_bf16 v10, v122, v6
    v_dot2c_f32_bf16 v11, v126, v6
    v_add_f32_dpp v24, v24, v24 quad_perm:[2,3,0,1] row_mask:0xf bank_mask:0xf
    v_add_f32_dpp v25, v25, v25 quad_perm:[2,3,0,1] row_mask:0xf bank_mask:0xf
    v_dot2c_f32_bf16 v8, v115, v7
    v_dot2c_f32_bf16 v9, v119, v7
    v_dot2c_f32_bf16 v10, v123, v7
    v_dot2c_f32_bf16 v11, v127, v7
    v_add_f32_dpp v26, v8, v8 row_ror:8 row_mask:0xf bank_mask:0x3
    v_add_f32_dpp v26, v9, v9 row_ror:8 row_mask:0xf bank_mask:0xc
    v_add_f32_dpp v27, v10, v10 row_ror:8 row_mask:0xf bank_mask:0x3
    v_add_f32_dpp v27, v11, v11 row_ror:8 row_mask:0xf bank_mask:0xc
    v_dot2_f32_bf16 v8, v128, v4, 0
    v_dot2_f32_bf16 v9, v132, v4, 0
    v_dot2_f32_bf16 v10, v136, v4, 0
    v_dot2_f32_bf16 v11, v140, v4, 0
    s_waitcnt vmcnt(2)
    buffer_load_dwordx4 v[36:39], v1, s[40:43], s49 offen offset:1024 nt
    v_add_f32_dpp v26, v26, v26 row_half_mirror row_mask:0xf bank_mask:0xf
    v_add_f32_dpp v27, v27, v27 row_half_mirror row_mask:0xf bank_mask:0xf
    v_dot2c_f32_bf16 v8, v129, v5
    v_dot2c_f32_bf16 v9, v133, v5
    v_dot2c_f32_bf16 v10, v137, v5
    v_dot2c_f32_bf16 v11, v141, v5
    v_add_f32_dpp v26, v26, v26 quad_perm:[1,0,3,2] row_mask:0xf bank_mask:0xf
    v_add_f32_dpp v27, v27, v27 quad_perm:[1,0,3,2] row_mask:0xf bank_mask:0xf
    v_dot2c_f32_bf16 v8, v130, v6
    v_dot2c_f32_bf16 v9, v134, v6
    v_dot2c_f32_bf16 v10, v138, v6
    v_dot2c_f32_bf16 v11, v142, v6
    v_add_f32_dpp v26, v26, v26 quad_perm:[2,3,0,1] row_mask:0xf bank_mask:0xf
    v_add_f32_dpp v27, v27, v27 quad_perm:[2,3,0,1] row_mask:0xf bank_mask:0xf
    v_dot2c_f32_bf16 v8, v131, v7
    v_dot2c_f32_bf16 v9, v135, v7
    v_dot2c_f32_bf16 v10, v139, v7
    v_dot2c_f32_bf16 v11, v143, v7
    v_add_f32_dpp v28, v8, v8 row_ror:8 row_mask:0xf bank_mask:0x3
    v_add_f32_dpp v28, v9, v9 row_ror:8 row_mask:0xf bank_mask:0xc
    v_add_f32_dpp v29, v10, v10 row_ror:8 row_mask:0xf bank_mask:0x3
    v_add_f32_dpp v29, v11, v11 row_ror:8 row_mask:0xf bank_mask:0xc
    v_dot2_f32_bf16 v8, v144, v4, 0
    v_dot2_f32_bf16 v9, v148, v4, 0
    v_dot2_f32_bf16 v10, v152, v4, 0
    v_dot2_f32_bf16 v11, v156, v4, 0
    v_add_f32_dpp v28, v28, v28 row_half_mirror row_mask:0xf bank_mask:0xf
    v_add_f32_dpp v29, v29, v29 row_half_mirror row_mask:0xf bank_mask:0xf
    v_dot2c_f32_bf16 v8, v145, v5
    v_dot2c_f32_bf16 v9, v149, v5
    v_dot2c_f32_bf16 v10, v153, v5
    v_dot2c_f32_bf16 v11, v157, v5
    v_add_f32_dpp v28, v28, v28 quad_perm:[1,0,3,2] row_mask:0xf bank_mask:0xf
    v_add_f32_dpp v29, v29, v29 quad_perm:[1,0,3,2] row_mask:0xf bank_mask:0xf
    v_dot2c_f32_bf16 v8, v146, v6
    v_dot2c_f32_bf16 v9, v150, v6
    buffer_load_dwordx4 v[40:43], v1, s[40:43], s49 offen offset:2048 nt
    v_dot2c_f32_bf16 v10, v154, v6
    v_dot2c_f32_bf16 v11, v158, v6
    v_add_f32_dpp v28, v28, v28 quad_perm:[2,3,0,1] row_mask:0xf bank_mask:0xf
    v_add_f32_dpp v29, v29, v29 quad_perm:[2,3,0,1] row_mask:0xf bank_mask:0xf
    v_dot2c_f32_bf16 v8, v147, v7
    v_dot2c_f32_bf16 v9, v151, v7
    v_dot2c_f32_bf16 v10, v155, v7
    v_dot2c_f32_bf16 v11, v159, v7
    v_add_f32_dpp v30, v8, v8 row_ror:8 row_mask:0xf bank_mask:0x3
    v_add_f32_dpp v30, v9, v9 row_ror:8 row_mask:0xf bank_mask:0xc
    v_add_f32_dpp v31, v10, v10 row_ror:8 row_mask:0xf bank_mask:0x3
    v_add_f32_dpp v31, v11, v11 row_ror:8 row_mask:0xf bank_mask:0xc
    v_add_f32_dpp v30, v30, v30 row_half_mirror row_mask:0xf bank_mask:0xf
    s_nop 0
    v_add_f32_dpp v31, v31, v31 row_half_mirror row_mask:0xf bank_mask:0xf
    v_add_f32_dpp v30, v30, v30 quad_perm:[1,0,3,2] row_mask:0xf bank_mask:0xf
    s_nop 0
    v_add_f32_dpp v31, v31, v31 quad_perm:[1,0,3,2] row_mask:0xf bank_mask:0xf
    v_add_f32_dpp v30, v30, v30 quad_perm:[2,3,0,1] row_mask:0xf bank_mask:0xf
    s_nop 0
    v_add_f32_dpp v31, v31, v31 quad_perm:[2,3,0,1] row_mask:0xf bank_mask:0xf
    v_max3_f32 v8, v12, v13, v16
    v_max3_f32 v8, v8, v17, v18
    v_max3_f32 v8, v8, v19, v20
    v_max3_f32 v8, v8, v21, v22
    v_max3_f32 v8, v8, v23, v24
    v_max3_f32 v8, v8, v25, v26
    v_max3_f32 v8, v8, v27, v28
    v_max3_f32 v8, v8, v29, v30
    v_max_f32 v8, v8, v31
    s_mov_b32 s34, 0x3e0293ee
    s_nop 0
    v_max_f32_dpp v8, v8, v8 row_ror:8 row_mask:0xf bank_mask:0xf
    v_mov_b32 v9, v8
    s_nop 1
    v_permlane16_swap_b32 v8, v9
    v_max_f32 v8, v8, v9
    v_mov_b32 v9, v8
    s_nop 1
    v_permlane32_swap_b32 v8, v9
    v_max_f32 v8, v8, v9
    v_mul_f32 v8, s34, v8
    s_waitcnt vmcnt(3)
    buffer_load_dwordx4 v[44:47], v1, s[40:43], s49 offen offset:3072 nt
    v_fma_f32 v12, v12, s34, -v8
    v_fma_f32 v13, v13, s34, -v8
    v_fma_f32 v16, v16, s34, -v8
    v_fma_f32 v17, v17, s34, -v8
    v_fma_f32 v18, v18, s34, -v8
    v_fma_f32 v19, v19, s34, -v8
    v_fma_f32 v20, v20, s34, -v8
    v_fma_f32 v21, v21, s34, -v8
    v_fma_f32 v22, v22, s34, -v8
    v_fma_f32 v23, v23, s34, -v8
    v_fma_f32 v24, v24, s34, -v8
    v_fma_f32 v25, v25, s34, -v8
    v_fma_f32 v26, v26, s34, -v8
    v_fma_f32 v27, v27, s34, -v8
    v_fma_f32 v28, v28, s34, -v8
    v_fma_f32 v29, v29, s34, -v8
    v_fma_f32 v30, v30, s34, -v8
    v_fma_f32 v31, v31, s34, -v8
    v_exp_f32 v12, v12
    v_exp_f32 v13, v13
    v_exp_f32 v16, v16
    v_exp_f32 v17, v17
    v_exp_f32 v18, v18
    v_exp_f32 v19, v19
    v_exp_f32 v20, v20
    v_exp_f32 v21, v21
    v_exp_f32 v22, v22
    v_exp_f32 v23, v23
    v_exp_f32 v24, v24
    v_exp_f32 v25, v25
    v_exp_f32 v26, v26
    v_exp_f32 v27, v27
    v_exp_f32 v28, v28
    v_exp_f32 v29, v29
    v_exp_f32 v30, v30
    v_exp_f32 v31, v31
    s_waitcnt vmcnt(3)
    s_mov_b32 s49, 200704
    buffer_load_dwordx4 v[48:51], v1, s[40:43], s49 offen offset:0 nt
    v_add_f32 v9, v12, v13
    v_add_f32 v9, v9, v16
    v_add_f32 v9, v9, v17
    v_add_f32 v9, v9, v18
    v_add_f32 v9, v9, v19
    v_add_f32 v9, v9, v20
    v_add_f32 v9, v9, v21
    v_add_f32 v9, v9, v22
    v_add_f32 v9, v9, v23
    v_add_f32 v9, v9, v24
    v_add_f32 v9, v9, v25
    v_add_f32 v9, v9, v26
    v_add_f32 v9, v9, v27
    v_add_f32 v9, v9, v28
    v_add_f32 v9, v9, v29
    v_add_f32 v9, v9, v30
    v_add_f32 v9, v9, v31
    v_and_b32 v10, 1, v0
    v_lshlrev_b32 v10, 4, v10
    v_mov_b32 v11, 0xffff
    v_lshlrev_b32 v10, v10, v11
    v_bfe_u32 v11, v0, 1, 2
    v_cmp_eq_u32 vcc, 0, v11
    s_nop 1
    v_cndmask_b32 v144, 0, v10, vcc
    v_cmp_eq_u32 vcc, 1, v11
    s_nop 1
    v_cndmask_b32 v145, 0, v10, vcc
    v_cmp_eq_u32 vcc, 2, v11
    s_nop 1
    v_cndmask_b32 v146, 0, v10, vcc
    v_cmp_eq_u32 vcc, 3, v11
    s_nop 1
    v_cndmask_b32 v147, 0, v10, vcc
    v_add_f32_dpp v9, v9, v9 row_ror:8 row_mask:0xf bank_mask:0xf
    v_mov_b32 v10, v9
    s_nop 1
    v_permlane16_swap_b32 v9, v10
    v_add_f32 v9, v9, v10
    v_mov_b32 v10, v9
    s_nop 1
    v_permlane32_swap_b32 v9, v10
    s_waitcnt vmcnt(3)
    buffer_load_dwordx4 v[52:55], v1, s[40:43], s49 offen offset:1024 nt
    v_add_f32 v9, v9, v10
    s_lshl_b32 s34, s3, 3
    s_add_u32 s34, s34, 98552
    v_mov_b32 v10, s34
    s_mov_b64 exec, 1
    ds_write_b64 v10, v[8:9]
    s_mov_b64 exec, -1
    s_lshl_b32 s34, s3, 10
    s_add_u32 s34, s34, 98304
    v_lshl_add_u32 v2, v0, 4, s34
    v_cvt_pk_bf16_f32 v10, v12, v12
    v_and_b32 v128, v10, v144
    v_and_b32 v129, v10, v145
    v_and_b32 v130, v10, v146
    v_and_b32 v131, v10, v147
    s_nop 1
    v_mfma_f32_16x16x32_bf16 v[148:151], v[160:163], v[128:131], 0
    v_mfma_f32_16x16x32_bf16 v[152:155], v[164:167], v[128:131], 0
    v_cvt_pk_bf16_f32 v10, v13, v13
    v_and_b32 v132, v10, v144
    v_and_b32 v133, v10, v145
    v_and_b32 v134, v10, v146
    v_and_b32 v135, v10, v147
    s_nop 1
    v_mfma_f32_16x16x32_bf16 v[148:151], v[168:171], v[132:135], v[148:151]
    v_mfma_f32_16x16x32_bf16 v[152:155], v[172:175], v[132:135], v[152:155]
    v_cvt_pk_bf16_f32 v10, v16, v16
    v_and_b32 v128, v10, v144
    v_and_b32 v129, v10, v145
    v_and_b32 v130, v10, v146
    v_and_b32 v131, v10, v147
    s_nop 1
    v_mfma_f32_16x16x32_bf16 v[148:151], v[176:179], v[128:131], v[148:151]
    v_mfma_f32_16x16x32_bf16 v[152:155], v[180:183], v[128:131], v[152:155]
    v_cvt_pk_bf16_f32 v10, v17, v17
    v_and_b32 v132, v10, v144
    v_and_b32 v133, v10, v145
    v_and_b32 v134, v10, v146
    v_and_b32 v135, v10, v147
    s_nop 1
    v_mfma_f32_16x16x32_bf16 v[148:151], v[184:187], v[132:135], v[148:151]
    v_mfma_f32_16x16x32_bf16 v[152:155], v[188:191], v[132:135], v[152:155]
    s_waitcnt vmcnt(3)
    buffer_load_dwordx4 v[56:59], v1, s[40:43], s49 offen offset:2048 nt
    v_cvt_pk_bf16_f32 v10, v18, v18
    v_and_b32 v128, v10, v144
    v_and_b32 v129, v10, v145
    v_and_b32 v130, v10, v146
    v_and_b32 v131, v10, v147
    s_nop 1
    v_mfma_f32_16x16x32_bf16 v[148:151], v[192:195], v[128:131], v[148:151]
    v_mfma_f32_16x16x32_bf16 v[152:155], v[196:199], v[128:131], v[152:155]
    v_cvt_pk_bf16_f32 v10, v19, v19
    v_and_b32 v132, v10, v144
    v_and_b32 v133, v10, v145
    v_and_b32 v134, v10, v146
    v_and_b32 v135, v10, v147
    s_nop 1
    v_mfma_f32_16x16x32_bf16 v[148:151], v[200:203], v[132:135], v[148:151]
    v_mfma_f32_16x16x32_bf16 v[152:155], v[204:207], v[132:135], v[152:155]
    v_cvt_pk_bf16_f32 v10, v20, v20
    v_and_b32 v128, v10, v144
    v_and_b32 v129, v10, v145
    v_and_b32 v130, v10, v146
    v_and_b32 v131, v10, v147
    s_nop 1
    v_mfma_f32_16x16x32_bf16 v[148:151], v[208:211], v[128:131], v[148:151]
    v_mfma_f32_16x16x32_bf16 v[152:155], v[212:215], v[128:131], v[152:155]
    v_cvt_pk_bf16_f32 v10, v21, v21
    v_and_b32 v132, v10, v144
    v_and_b32 v133, v10, v145
    v_and_b32 v134, v10, v146
    v_and_b32 v135, v10, v147
    s_nop 1
    v_mfma_f32_16x16x32_bf16 v[148:151], v[216:219], v[132:135], v[148:151]
    v_mfma_f32_16x16x32_bf16 v[152:155], v[220:223], v[132:135], v[152:155]
    v_cvt_pk_bf16_f32 v10, v22, v22
    v_and_b32 v128, v10, v144
    v_and_b32 v129, v10, v145
    v_and_b32 v130, v10, v146
    v_and_b32 v131, v10, v147
    s_nop 1
    v_mfma_f32_16x16x32_bf16 v[148:151], v[224:227], v[128:131], v[148:151]
    v_mfma_f32_16x16x32_bf16 v[152:155], v[228:231], v[128:131], v[152:155]
    v_cvt_pk_bf16_f32 v10, v23, v23
    s_waitcnt vmcnt(3)
    buffer_load_dwordx4 v[60:63], v1, s[40:43], s49 offen offset:3072 nt
    v_and_b32 v132, v10, v144
    v_and_b32 v133, v10, v145
    v_and_b32 v134, v10, v146
    v_and_b32 v135, v10, v147
    s_nop 1
    v_mfma_f32_16x16x32_bf16 v[148:151], v[232:235], v[132:135], v[148:151]
    v_mfma_f32_16x16x32_bf16 v[152:155], v[236:239], v[132:135], v[152:155]
    v_cvt_pk_bf16_f32 v10, v24, v24
    v_and_b32 v128, v10, v144
    v_and_b32 v129, v10, v145
    v_and_b32 v130, v10, v146
    v_and_b32 v131, v10, v147
    s_nop 1
    v_mfma_f32_16x16x32_bf16 v[148:151], v[240:243], v[128:131], v[148:151]
    v_mfma_f32_16x16x32_bf16 v[152:155], v[244:247], v[128:131], v[152:155]
    v_cvt_pk_bf16_f32 v10, v25, v25
    v_and_b32 v132, v10, v144
    v_and_b32 v133, v10, v145
    v_and_b32 v134, v10, v146
    v_and_b32 v135, v10, v147
    s_nop 1
    v_mfma_f32_16x16x32_bf16 v[148:151], v[248:251], v[132:135], v[148:151]
    v_mfma_f32_16x16x32_bf16 v[152:155], v[252:255], v[132:135], v[152:155]
    v_cvt_pk_bf16_f32 v10, v26, v26
    v_and_b32 v128, v10, v144
    v_and_b32 v129, v10, v145
    v_and_b32 v130, v10, v146
    v_and_b32 v131, v10, v147
    s_nop 1
    v_mfma_f32_16x16x32_bf16 v[148:151], v[32:35], v[128:131], v[148:151]
    v_mfma_f32_16x16x32_bf16 v[152:155], v[36:39], v[128:131], v[152:155]
    v_cvt_pk_bf16_f32 v10, v27, v27
    v_and_b32 v132, v10, v144
    v_and_b32 v133, v10, v145
    v_and_b32 v134, v10, v146
    v_and_b32 v135, v10, v147
    s_nop 1
    v_mfma_f32_16x16x32_bf16 v[148:151], v[40:43], v[132:135], v[148:151]
    v_mfma_f32_16x16x32_bf16 v[152:155], v[44:47], v[132:135], v[152:155]
    v_cvt_pk_bf16_f32 v10, v28, v28
    v_and_b32 v128, v10, v144
    s_waitcnt vmcnt(3)
    s_mov_b32 s49, 229376
    buffer_load_dwordx4 v[64:67], v1, s[40:43], s49 offen offset:0 nt
    v_and_b32 v129, v10, v145
    v_and_b32 v130, v10, v146
    v_and_b32 v131, v10, v147
    s_waitcnt vmcnt(3)
    buffer_load_dwordx4 v[68:71], v1, s[40:43], s49 offen offset:1024 nt
    v_mfma_f32_16x16x32_bf16 v[148:151], v[48:51], v[128:131], v[148:151]
    v_mfma_f32_16x16x32_bf16 v[152:155], v[52:55], v[128:131], v[152:155]
    v_cvt_pk_bf16_f32 v10, v29, v29
    v_and_b32 v132, v10, v144
    v_and_b32 v133, v10, v145
    v_and_b32 v134, v10, v146
    v_and_b32 v135, v10, v147
    s_waitcnt vmcnt(3)
    buffer_load_dwordx4 v[72:75], v1, s[40:43], s49 offen offset:2048 nt
    s_waitcnt vmcnt(3)
    buffer_load_dwordx4 v[76:79], v1, s[40:43], s49 offen offset:3072 nt
    s_barrier
    v_mfma_f32_16x16x32_bf16 v[148:151], v[56:59], v[132:135], v[148:151]
    v_mfma_f32_16x16x32_bf16 v[152:155], v[60:63], v[132:135], v[152:155]
    v_cvt_pk_bf16_f32 v10, v30, v30
    v_and_b32 v128, v10, v144
    v_and_b32 v129, v10, v145
    v_and_b32 v130, v10, v146
    v_and_b32 v131, v10, v147
    s_waitcnt vmcnt(2)
    s_nop 0
    v_mfma_f32_16x16x32_bf16 v[148:151], v[64:67], v[128:131], v[148:151]
    v_mfma_f32_16x16x32_bf16 v[152:155], v[68:71], v[128:131], v[152:155]
    v_cvt_pk_bf16_f32 v10, v31, v31
    v_and_b32 v132, v10, v144
    v_and_b32 v133, v10, v145
    v_and_b32 v134, v10, v146
    v_and_b32 v135, v10, v147
    s_waitcnt vmcnt(0)
    s_nop 0
    v_mfma_f32_16x16x32_bf16 v[148:151], v[72:75], v[132:135], v[148:151]
    v_mfma_f32_16x16x32_bf16 v[152:155], v[76:79], v[132:135], v[152:155]
    s_nop 7
    v_mov_b32_dpp v148, v152 quad_perm:[0,1,2,3] row_mask:0xf bank_mask:0xc
    v_mov_b32_dpp v149, v153 quad_perm:[0,1,2,3] row_mask:0xf bank_mask:0xc
    v_mov_b32_dpp v150, v154 quad_perm:[0,1,2,3] row_mask:0xf bank_mask:0xc
    v_mov_b32_dpp v151, v155 quad_perm:[0,1,2,3] row_mask:0xf bank_mask:0xc
    ds_write_b128 v2, v[148:151]
    s_waitcnt lgkmcnt(0)
    s_barrier
    v_and_b32 v200, 3, v0
    v_bfe_u32 v201, v0, 2, 2
    v_lshrrev_b32 v202, 4, v0
    s_lshl_b32 s34, s3, 10
    s_add_u32 s34, s34, 122112
    v_lshl_add_u32 v203, v0, 4, s34
    s_movk_i32 s48, 5120
    s_cmp_eq_u32 s63, 0
    s_cbranch_scc1 L_t_wo
    s_cmp_eq_u32 s63, 2
    s_cbranch_scc1 L_t_w2
    s_cmp_eq_u32 s63, 3
    s_cbranch_scc1 L_fin
    v_and_b32 v205, 15, v0
    v_lshlrev_b32 v205, 4, v205
    s_and_b32 s49, s3, 3
    s_mul_i32 s34, s49, 1280
    s_add_u32 s34, s34, 70656
    v_lshl_add_u32 v206, v202, 17, v205
    v_add_u32 v206, s34, v206
    s_mul_i32 s34, s49, 3840
    v_add_u32 v205, s34, v205
    s_barrier
L_r_w1:
    s_cmp_lt_u32 s3, 4
    s_cbranch_scc1 L_w1_ln
    s_and_b32 s49, s3, 3
    s_lshl_b32 s42, s49, 11
    s_add_u32 s42, s42, 40960
    s_bitcmp1_b32 s62, 0
    s_cbranch_scc1 L_rot1
    s_add_u32 m0, s42, 0
    s_add_u32 s34, s50, 0
    buffer_load_dwordx4 v15, s[52:55], s34 offen  lds
    s_add_u32 m0, s42, 1024
    s_add_u32 s34, s50, 884736
    buffer_load_dwordx4 v15, s[52:55], s34 offen  lds
    s_add_u32 m0, s42, 8192
    s_add_u32 s34, s50, 110592
    buffer_load_dwordx4 v15, s[52:55], s34 offen  lds
    s_add_u32 m0, s42, 9216
    s_add_u32 s34, s50, 995328
    buffer_load_dwordx4 v15, s[52:55], s34 offen  lds
    s_add_u32 m0, s42, 32768
    s_add_u32 s34, s51, 0
    buffer_load_dwordx4 v15, s[52:55], s34 offen  lds
    s_add_u32 m0, s42, 33792
    s_add_u32 s34, s51, 13824
    buffer_load_dwordx4 v15, s[52:55], s34 offen  lds
    s_add_u32 m0, s42, 16384
    s_add_u32 s34, s50, 221184
    buffer_load_dwordx4 v15, s[52:55], s34 offen  lds
    s_add_u32 m0, s42, 17408
    s_add_u32 s34, s50, 1105920
    buffer_load_dwordx4 v15, s[52:55], s34 offen  lds
    s_add_u32 m0, s42, 24576
    s_add_u32 s34, s50, 331776
    buffer_load_dwordx4 v15, s[52:55], s34 offen  lds
    s_add_u32 m0, s42, 25600
    s_add_u32 s34, s50, 1216512
    buffer_load_dwordx4 v15, s[52:55], s34 offen  lds
    s_branch L_rot2
L_rot1:
    s_add_u32 m0, s42, 16384
    s_add_u32 s34, s50, 221184
    buffer_load_dwordx4 v15, s[52:55], s34 offen  lds
    s_add_u32 m0, s42, 17408
    s_add_u32 s34, s50, 1105920
    buffer_load_dwordx4 v15, s[52:55], s34 offen  lds
    s_add_u32 m0, s42, 24576
    s_add_u32 s34, s50, 331776
    buffer_load_dwordx4 v15, s[52:55], s34 offen  lds
    s_add_u32 m0, s42, 25600
    s_add_u32 s34, s50, 1216512
    buffer_load_dwordx4 v15, s[52:55], s34 offen  lds
    s_add_u32 m0, s42, 32768
    s_add_u32 s34, s51, 0
    buffer_load_dwordx4 v15, s[52:55], s34 offen  lds
    s_add_u32 m0, s42, 33792
    s_add_u32 s34, s51, 13824
    buffer_load_dwordx4 v15, s[52:55], s34 offen  lds
    s_add_u32 m0, s42, 0
    s_add_u32 s34, s50, 0
    buffer_load_dwordx4 v15, s[52:55], s34 offen  lds
    s_add_u32 m0, s42, 1024
    s_add_u32 s34, s50, 884736
    buffer_load_dwordx4 v15, s[52:55], s34 offen  lds
    s_add_u32 m0, s42, 8192
    s_add_u32 s34, s50, 110592
    buffer_load_dwordx4 v15, s[52:55], s34 offen  lds
    s_add_u32 m0, s42, 9216
    s_add_u32 s34, s50, 995328
    buffer_load_dwordx4 v15, s[52:55], s34 offen  lds
L_rot2:
    v_lshrrev_b32 v3, 2, v0
    v_lshlrev_b32 v3, 6, v3
    v_lshl_add_u32 v3, v200, 3, v3
    v_add_u32 v3, s42, v3
    s_lshl_b32 s35, s49, 6
    s_add_u32 s35, s35, 116736
    v_mul_u32_u24 v4, 1344, v200
    v_lshl_add_u32 v4, v202, 4, v4
    v_add_u32 v4, s35, v4
    s_lshl_b32 s35, s49, 11
    s_add_u32 s35, s35, 122112
    v_lshl_add_u32 v5, v0, 4, s35
    s_waitcnt vmcnt(0)
    s_barrier
    ds_read_b64_tr_b16 v[32:33], v3 offset:0
    ds_read_b64_tr_b16 v[34:35], v3 offset:1024
    ds_read_b64_tr_b16 v[36:37], v3 offset:32
    ds_read_b64_tr_b16 v[38:39], v3 offset:1056
    ds_read_b64_tr_b16 v[40:41], v3 offset:8192
    ds_read_b64_tr_b16 v[42:43], v3 offset:9216
    ds_read_b64_tr_b16 v[44:45], v3 offset:8224
    ds_read_b64_tr_b16 v[46:47], v3 offset:9248
    ds_read_b64_tr_b16 v[48:49], v3 offset:16384
    ds_read_b64_tr_b16 v[50:51], v3 offset:17408
    ds_read_b64_tr_b16 v[52:53], v3 offset:16416
    ds_read_b64_tr_b16 v[54:55], v3 offset:17440
    s_waitcnt lgkmcnt(4)
    ds_read_b64_tr_b16 v[56:57], v3 offset:24576
    ds_read_b64_tr_b16 v[58:59], v3 offset:25600
    ds_read_b64_tr_b16 v[60:61], v3 offset:24608
    ds_read_b64_tr_b16 v[62:63], v3 offset:25632
    ds_read_b64_tr_b16 v[64:65], v3 offset:32768
    ds_read_b64_tr_b16 v[66:67], v3 offset:33792
    ds_read_b64_tr_b16 v[68:69], v3 offset:32800
    ds_read_b64_tr_b16 v[70:71], v3 offset:33824
    s_waitcnt lgkmcnt(0)
    s_barrier
    ds_read_b128 v[140:143], v4 offset:0
    ds_read_b128 v[144:147], v4 offset:256
    ds_read_b128 v[148:151], v4 offset:512
    ds_read_b128 v[152:155], v4 offset:768
    ds_read_b128 v[156:159], v4 offset:1024
    s_waitcnt lgkmcnt(4)
    v_mfma_f32_16x16x32_bf16 v[20:23], v[32:35], v[140:143], 0
    v_mfma_f32_16x16x32_bf16 v[24:27], v[36:39], v[140:143], 0
    s_waitcnt lgkmcnt(3)
    v_mfma_f32_16x16x32_bf16 v[20:23], v[40:43], v[144:147], v[20:23]
    v_mfma_f32_16x16x32_bf16 v[24:27], v[44:47], v[144:147], v[24:27]
    s_waitcnt lgkmcnt(2)
    v_mfma_f32_16x16x32_bf16 v[20:23], v[48:51], v[148:151], v[20:23]
    v_mfma_f32_16x16x32_bf16 v[24:27], v[52:55], v[148:151], v[24:27]
    s_waitcnt lgkmcnt(1)
    v_mfma_f32_16x16x32_bf16 v[20:23], v[56:59], v[152:155], v[20:23]
    v_mfma_f32_16x16x32_bf16 v[24:27], v[60:63], v[152:155], v[24:27]
    s_waitcnt lgkmcnt(0)
    v_mfma_f32_16x16x32_bf16 v[20:23], v[64:67], v[156:159], v[20:23]
    v_mfma_f32_16x16x32_bf16 v[24:27], v[68:71], v[156:159], v[24:27]
    s_nop 6
    ds_write_b128 v5, v[20:23]
    ds_write_b128 v5, v[24:27] offset:1024
    s_waitcnt lgkmcnt(0)
    s_barrier
    s_branch L_fin
L_w1_ln:
    ds_read_b128 v[140:143], v205 offset:0
    ds_read_b128 v[144:147], v205 offset:256
    ds_read_b128 v[148:151], v205 offset:512
    ds_read_b128 v[152:155], v205 offset:768
    ds_read_b128 v[156:159], v205 offset:1024
    ds_read_b128 v[160:163], v205 offset:1280
    ds_read_b128 v[164:167], v205 offset:1536
    ds_read_b128 v[168:171], v205 offset:1792
    ds_read_b128 v[172:175], v205 offset:2048
    ds_read_b128 v[176:179], v205 offset:2304
    ds_read_b128 v[180:183], v205 offset:2560
    ds_read_b128 v[184:187], v205 offset:2816
    ds_read_b128 v[188:191], v205 offset:3072
    ds_read_b128 v[192:195], v205 offset:3328
    ds_read_b128 v[196:199], v205 offset:3584
    v_and_b32 v8, 1, v0
    v_lshlrev_b32 v8, 4, v8
    v_mov_b32 v9, 0xffff
    v_lshlrev_b32 v8, v8, v9
    v_bfe_u32 v9, v0, 1, 2
    v_cmp_eq_u32 vcc, 0, v9
    s_nop 1
    v_cndmask_b32 v16, 0, v8, vcc
    v_cmp_eq_u32 vcc, 1, v9
    s_nop 1
    v_cndmask_b32 v17, 0, v8, vcc
    v_cmp_eq_u32 vcc, 2, v9
    s_nop 1
    v_cndmask_b32 v18, 0, v8, vcc
    v_cmp_eq_u32 vcc, 3, v9
    s_nop 1
    v_cndmask_b32 v19, 0, v8, vcc
    v_bfe_u32 v8, v0, 3, 1
    v_cmp_eq_u32 vcc, 0, v8
    s_nop 1
    v_cndmask_b32 v20, 0, v16, vcc
    v_xor_b32 v24, v20, v16
    v_cndmask_b32 v21, 0, v17, vcc
    v_xor_b32 v25, v21, v17
    v_cndmask_b32 v22, 0, v18, vcc
    v_xor_b32 v26, v22, v18
    v_cndmask_b32 v23, 0, v19, vcc
    v_xor_b32 v27, v23, v19
    v_and_b32 v52, 0x3f803f80, v20
    v_and_b32 v60, 0x3e803e80, v20
    v_and_b32 v53, 0x3f803f80, v21
    v_and_b32 v61, 0x3e803e80, v21
    v_and_b32 v54, 0x3f803f80, v22
    v_and_b32 v62, 0x3e803e80, v22
    v_and_b32 v55, 0x3f803f80, v23
    v_and_b32 v63, 0x3e803e80, v23
    v_and_b32 v56, 0x3f803f80, v24
    v_and_b32 v64, 0x3e803e80, v24
    v_and_b32 v57, 0x3f803f80, v25
    v_and_b32 v65, 0x3e803e80, v25
    v_and_b32 v58, 0x3f803f80, v26
    v_and_b32 v66, 0x3e803e80, v26
    v_and_b32 v59, 0x3f803f80, v27
    v_and_b32 v67, 0x3e803e80, v27
    s_waitcnt lgkmcnt(0)
    v_mfma_f32_16x16x32_bf16 v[68:71], v[140:143], v[60:63], 0
    v_mfma_f32_16x16x32_bf16 v[68:71], v[144:147], v[64:67], v[68:71]
    v_mfma_f32_16x16x32_bf16 v[72:75], v[148:151], v[60:63], 0
    v_mfma_f32_16x16x32_bf16 v[72:75], v[152:155], v[64:67], v[72:75]
    v_mfma_f32_16x16x32_bf16 v[76:79], v[156:159], v[60:63], 0
    v_mfma_f32_16x16x32_bf16 v[116:119], v[160:163], v[60:63], 0
    v_mfma_f32_16x16x32_bf16 v[116:119], v[164:167], v[64:67], v[116:119]
    v_mfma_f32_16x16x32_bf16 v[120:123], v[168:171], v[60:63], 0
    v_mfma_f32_16x16x32_bf16 v[120:123], v[172:175], v[64:67], v[120:123]
    v_mfma_f32_16x16x32_bf16 v[124:127], v[176:179], v[60:63], 0
    v_mfma_f32_16x16x32_bf16 v[80:83], v[180:183], v[60:63], 1.0
    v_mfma_f32_16x16x32_bf16 v[80:83], v[184:187], v[64:67], v[80:83]
    v_mfma_f32_16x16x32_bf16 v[84:87], v[188:191], v[60:63], 1.0
    v_mfma_f32_16x16x32_bf16 v[84:87], v[192:195], v[64:67], v[84:87]
    v_mfma_f32_16x16x32_bf16 v[88:91], v[196:199], v[60:63], 1.0
    s_mul_i32 s34, s3, 1344
    s_add_u32 s34, s34, 116736
    v_lshl_add_u32 v7, v0, 4, s34
    v_lshlrev_b32 v8, 6, v202
    v_lshl_add_u32 v8, v200, 4, v8
    v_and_b32 v9, 1, v201
    v_lshl_add_u32 v8, v9, 3, v8
    v_add_u32 v8, s34, v8
    v_lshrrev_b32 v9, 5, v0
    v_lshlrev_b32 v9, 10, v9
    v_and_b32 v6, 1, v202
    v_lshl_add_u32 v9, v6, 9, v9
    v_bfe_u32 v6, v0, 1, 1
    v_lshl_add_u32 v9, v6, 8, v9
    v_lshl_add_u32 v9, v201, 4, v9
    v_and_b32 v6, 1, v0
    v_lshl_add_u32 v9, v6, 3, v9
    v_add_u32 v9, 122112, v9
    s_lshr_b32 s34, s62, 2
    s_lshl_b32 s34, s34, 8
    s_and_b32 s49, s62, 3
    s_lshl_b32 s49, s49, 17
    s_add_u32 s34, s34, s49
    s_add_u32 s34, s34, 80896
    v_lshl_add_u32 v5, v0, 2, s34
    s_barrier
    s_mov_b32 s35, 0
    s_mov_b64 s[40:41], -1
    s_mov_b64 s[42:43], -1
L_pb:
    s_mov_b64 exec, s[40:41]
    s_cbranch_execz L_pbs0
    buffer_load_dwordx4 v[140:143], v206, s[44:47], 0 offen offset:0 sc1
    buffer_load_dwordx4 v[148:151], v206, s[44:47], 0 offen offset:256 sc1
    buffer_load_dwordx4 v[156:159], v206, s[44:47], 0 offen offset:512 sc1
    buffer_load_dwordx4 v[164:167], v206, s[44:47], 0 offen offset:768 sc1
    buffer_load_dwordx4 v[172:175], v206, s[44:47], 0 offen offset:1024 sc1
L_pbs0:
    s_mov_b64 exec, s[42:43]
    s_cbranch_execz L_pbs1
    buffer_load_dwordx4 v[144:147], v206, s[44:47], s48 offen offset:0 sc1
    buffer_load_dwordx4 v[152:155], v206, s[44:47], s48 offen offset:256 sc1
    buffer_load_dwordx4 v[160:163], v206, s[44:47], s48 offen offset:512 sc1
    buffer_load_dwordx4 v[168:171], v206, s[44:47], s48 offen offset:768 sc1
    buffer_load_dwordx4 v[176:179], v206, s[44:47], s48 offen offset:1024 sc1
L_pbs1:
    s_mov_b64 exec, -1
    s_add_u32 s35, s35, 1
    s_waitcnt vmcnt(0)
    v_max3_u32 v28, v140, v141, v142
    v_max3_u32 v29, v144, v145, v146
    v_max3_u32 v28, v28, v143, v148
    v_max3_u32 v29, v29, v147, v152
    v_max3_u32 v28, v28, v149, v150
    v_max3_u32 v29, v29, v153, v154
    v_max3_u32 v28, v28, v151, v156
    v_max3_u32 v29, v29, v155, v160
    v_max3_u32 v28, v28, v157, v158
    v_max3_u32 v29, v29, v161, v162
    v_max3_u32 v28, v28, v159, v164
    v_max3_u32 v29, v29, v163, v168
    v_max3_u32 v28, v28, v165, v166
    v_max3_u32 v29, v29, v169, v170
    v_max3_u32 v28, v28, v167, v172
    v_max3_u32 v29, v29, v171, v176
    v_max3_u32 v28, v28, v173, v174
    v_max3_u32 v29, v29, v177, v178
    v_max_u32 v28, v28, v175
    v_max_u32 v29, v29, v179
    v_cmp_eq_u32 s[40:41], -1, v28
    v_cmp_eq_u32 s[42:43], -1, v29
    v_mfma_f32_16x16x32_bf16 v[128:131], v[140:143], v[52:55], v[68:71]
    s_or_b64 vcc, s[40:41], s[42:43]
    s_cbranch_scc0 L_pbd
    s_cmp_lt_u32 s35, 60000
    s_cbranch_scc1 L_pb
L_pbd:
    v_mfma_f32_16x16x32_bf16 v[128:131], v[144:147], v[52:55], v[128:131]
    v_mfma_f32_16x16x32_bf16 v[128:131], v[148:151], v[56:59], v[128:131]
    v_mfma_f32_16x16x32_bf16 v[128:131], v[152:155], v[56:59], v[128:131]
    v_mfma_f32_16x16x32_bf16 v[132:135], v[156:159], v[52:55], v[72:75]
    v_mfma_f32_16x16x32_bf16 v[132:135], v[160:163], v[52:55], v[132:135]
    v_mfma_f32_16x16x32_bf16 v[132:135], v[164:167], v[56:59], v[132:135]
    v_mfma_f32_16x16x32_bf16 v[132:135], v[168:171], v[56:59], v[132:135]
    v_mfma_f32_16x16x32_bf16 v[136:139], v[172:175], v[52:55], v[76:79]
    v_mfma_f32_16x16x32_bf16 v[136:139], v[176:179], v[52:55], v[136:139]
    s_nop 1
    v_pk_add_f32 v[20:21], v[128:129], v[130:131]
    v_pk_mul_f32 v[22:23], v[128:129], v[128:129]
    v_pk_fma_f32 v[22:23], v[130:131], v[130:131], v[22:23]
    s_nop 0
    v_pk_add_f32 v[20:21], v[20:21], v[132:133]
    v_pk_fma_f32 v[22:23], v[132:133], v[132:133], v[22:23]
    v_pk_add_f32 v[20:21], v[20:21], v[134:135]
    v_pk_fma_f32 v[22:23], v[134:135], v[134:135], v[22:23]
    v_pk_add_f32 v[20:21], v[20:21], v[136:137]
    v_pk_fma_f32 v[22:23], v[136:137], v[136:137], v[22:23]
    v_pk_add_f32 v[20:21], v[20:21], v[138:139]
    v_pk_fma_f32 v[22:23], v[138:139], v[138:139], v[22:23]
    v_add_f32 v20, v20, v21
    v_add_f32 v21, v22, v23
    s_nop 0
    v_add_f32_dpp v20, v20, v20 row_ror:8 row_mask:0xf bank_mask:0xf
    v_add_f32_dpp v21, v21, v21 row_ror:8 row_mask:0xf bank_mask:0xf
    s_nop 0
    v_add_f32_dpp v20, v20, v20 row_ror:4 row_mask:0xf bank_mask:0xf
    v_add_f32_dpp v21, v21, v21 row_ror:4 row_mask:0xf bank_mask:0xf
    s_nop 0
    v_add_f32_dpp v20, v20, v20 row_ror:2 row_mask:0xf bank_mask:0xf
    v_add_f32_dpp v21, v21, v21 row_ror:2 row_mask:0xf bank_mask:0xf
    s_nop 0
    v_add_f32_dpp v20, v20, v20 row_ror:1 row_mask:0xf bank_mask:0xf
    v_add_f32_dpp v21, v21, v21 row_ror:1 row_mask:0xf bank_mask:0xf
    v_mov_b32 v22, v20
    v_mov_b32 v23, v21
    s_nop 0
    v_permlane16_swap_b32 v20, v22
    v_permlane16_swap_b32 v21, v23
    v_add_f32 v20, v20, v22
    v_add_f32 v21, v21, v23
    v_mov_b32 v22, v20
    v_mov_b32 v23, v21
    s_nop 0
    v_permlane32_swap_b32 v20, v22
    v_permlane32_swap_b32 v21, v23
    v_add_f32 v20, v20, v22
    v_add_f32 v21, v21, v23
    v_mul_f32 v22, 0x3acccccd, v20
    v_mul_f32 v21, 0x3acccccd, v21
    v_fma_f32 v21, -v22, v22, v21
    v_max_f32 v21, 0, v21
    v_add_f32 v21, 0x3727c5ac, v21
    v_rsq_f32 v20, v21
    s_nop 0
    v_mul_f32_e64 v21, -v22, v20
    v_pk_fma_f32 v[128:129], v[128:129], v[20:21], v[20:21] op_sel:[0,0,1] op_sel_hi:[1,0,1]
    v_pk_fma_f32 v[130:131], v[130:131], v[20:21], v[20:21] op_sel:[0,0,1] op_sel_hi:[1,0,1]
    v_pk_fma_f32 v[132:133], v[132:133], v[20:21], v[20:21] op_sel:[0,0,1] op_sel_hi:[1,0,1]
    v_pk_fma_f32 v[134:135], v[134:135], v[20:21], v[20:21] op_sel:[0,0,1] op_sel_hi:[1,0,1]
    v_pk_fma_f32 v[136:137], v[136:137], v[20:21], v[20:21] op_sel:[0,0,1] op_sel_hi:[1,0,1]
    v_pk_fma_f32 v[138:139], v[138:139], v[20:21], v[20:21] op_sel:[0,0,1] op_sel_hi:[1,0,1]
    v_pk_fma_f32 v[128:129], v[128:129], v[80:81], v[116:117]
    v_pk_fma_f32 v[130:131], v[130:131], v[82:83], v[118:119]
    v_pk_fma_f32 v[132:133], v[132:133], v[84:85], v[120:121]
    v_pk_fma_f32 v[134:135], v[134:135], v[86:87], v[122:123]
    v_pk_fma_f32 v[136:137], v[136:137], v[88:89], v[124:125]
    v_pk_fma_f32 v[138:139], v[138:139], v[90:91], v[126:127]
    v_cvt_pk_bf16_f32 v20, v128, v129
    v_cvt_pk_bf16_f32 v21, v130, v131
    v_cvt_pk_bf16_f32 v22, v132, v133
    v_cvt_pk_bf16_f32 v23, v134, v135
    v_cvt_pk_bf16_f32 v24, v136, v137
    v_cvt_pk_bf16_f32 v25, v138, v139
    ds_write_b128 v7, v[20:23]
    s_mov_b32 exec_lo, 0x00ff00ff
    s_mov_b32 exec_hi, 0x00ff00ff
    ds_write_b64 v8, v[24:25] offset:1024
    s_mov_b64 exec, -1
    s_waitcnt lgkmcnt(0)
    s_barrier
    s_barrier
    s_cmp_lg_u32 s3, 0
    s_cbranch_scc1 L_fin
    ds_read_b64 v[20:21], v9 offset:0
    ds_read_b64 v[22:23], v9 offset:2048
    ds_read_b64 v[24:25], v9 offset:4096
    ds_read_b64 v[26:27], v9 offset:6144
    s_mov_b32 s34, 0xbdd2d3e8
    v_mov_b32 v10, 0xc0135761
    s_waitcnt lgkmcnt(3)
    v_pk_add_f32 v[100:101], v[100:101], v[20:21]
    s_waitcnt lgkmcnt(2)
    v_pk_add_f32 v[100:101], v[100:101], v[22:23]
    s_waitcnt lgkmcnt(1)
    v_pk_add_f32 v[100:101], v[100:101], v[24:25]
    s_waitcnt lgkmcnt(0)
    v_pk_add_f32 v[100:101], v[100:101], v[26:27]
    v_pk_mul_f32 v[20:21], v[100:101], v[100:101]
    v_fma_f32 v20, v20, s34, v10
    v_fma_f32 v21, v21, s34, v10
    v_pk_mul_f32 v[20:21], v[20:21], v[100:101]
    v_exp_f32 v20, v20
    v_exp_f32 v21, v21
    v_add_f32 v20, 1.0, v20
    v_add_f32 v21, 1.0, v21
    v_rcp_f32 v20, v20
    v_rcp_f32 v21, v21
    s_nop 0
    v_pk_mul_f32 v[20:21], v[20:21], v[100:101]
    v_cvt_pk_bf16_f32 v20, v20, v21
    v_min_u32 v20, -2, v20
    buffer_store_dword v20, v5, s[44:47], 0 offen sc1
    s_branch L_fin
L_t_w2:
    v_bfe_u32 v205, v0, 3, 2
    v_lshlrev_b32 v204, 3, v205
    v_lshrrev_b32 v205, 5, v0
    v_lshl_add_u32 v204, v205, 2, v204
    v_bfe_u32 v205, v0, 1, 2
    v_add_u32 v204, v204, v205
    v_and_b32 v205, 1, v0
    s_sub_u32 s49, s3, 1
    v_mul_u32_u24 v204, 1280, v204
    v_lshl_add_u32 v204, v205, 4, v204
    s_lshl_b32 s34, s62, 5
    s_mul_i32 s35, s49, 327680
    s_add_u32 s34, s34, s35
    v_add_u32 v204, s34, v204
    s_lshl_b32 s50, s49, 13
    s_add_u32 s50, s50, 40960
    v_lshl_add_u32 v205, v0, 3, s50
    s_lshl_b32 s40, s62, 1
    s_add_u32 s41, s40, 8
    s_add_u32 s42, s40, 2
    s_barrier
L_w2_dma:
    s_and_b32 s34, s40, 7
    s_lshl_b32 s35, s34, 10
    s_add_u32 m0, s50, s35
    s_mul_i32 s34, s34, 40960
    buffer_load_dwordx4 v204, s[52:55], s34 offen  lds
    s_add_u32 s40, s40, 1
    s_cmp_lg_u32 s40, s42
    s_cbranch_scc1 L_w2_nw
L_w2_nw:
    s_cmp_lt_u32 s40, s41
    s_cbranch_scc1 L_w2_dma
    s_lshl_b32 s34, s49, 9
    s_add_u32 s34, s34, 80896
    s_cmp_eq_u32 s49, 6
    s_cselect_b32 s35, 1, 3
    v_lshlrev_b32 v6, 6, v202
    v_lshl_add_u32 v6, v200, 4, v6
    v_add_u32 v6, s34, v6
    v_lshl_add_u32 v4, v201, 17, v6
    v_min_u32 v5, s35, v201
    v_lshl_add_u32 v5, v5, 17, v6
    s_waitcnt vmcnt(0)
    ds_read_b64_tr_b16 v[32:33], v205 offset:0
    ds_read_b64_tr_b16 v[34:35], v205 offset:512
    ds_read_b64_tr_b16 v[36:37], v205 offset:1024
    ds_read_b64_tr_b16 v[38:39], v205 offset:1536
    ds_read_b64_tr_b16 v[40:41], v205 offset:2048
    ds_read_b64_tr_b16 v[42:43], v205 offset:2560
    ds_read_b64_tr_b16 v[44:45], v205 offset:3072
    ds_read_b64_tr_b16 v[46:47], v205 offset:3584
    s_waitcnt lgkmcnt(0)
    ds_read_b64_tr_b16 v[48:49], v205 offset:4096
    ds_read_b64_tr_b16 v[50:51], v205 offset:4608
    ds_read_b64_tr_b16 v[52:53], v205 offset:5120
    ds_read_b64_tr_b16 v[54:55], v205 offset:5632
    ds_read_b64_tr_b16 v[56:57], v205 offset:6144
    ds_read_b64_tr_b16 v[58:59], v205 offset:6656
    ds_read_b64_tr_b16 v[60:61], v205 offset:7168
    ds_read_b64_tr_b16 v[62:63], v205 offset:7680
    s_waitcnt lgkmcnt(0)
    s_barrier
    s_sleep 1
    s_mov_b32 s35, 0
L_poll52:
    buffer_load_dwordx4 v[64:67], v4, s[44:47], 0 offen sc1
    buffer_load_dwordx4 v[68:71], v5, s[44:47], 0 offen offset:256 sc1
    s_add_u32 s35, s35, 1
    s_waitcnt vmcnt(0)
    v_max3_u32 v28, v64, v65, v66
    v_max3_u32 v28, v28, v67, v68
    v_max3_u32 v28, v28, v69, v70
    v_max_u32 v28, v28, v71
    v_cmp_eq_u32 vcc, -1, v28
    s_cbranch_vccz L_done53
    s_cmp_lt_u32 s35, 60000
    s_cbranch_scc1 L_poll52
L_done53:
    v_mfma_f32_16x16x32_bf16 v[80:83], v[32:35], v[64:67], 0
    v_mfma_f32_16x16x32_bf16 v[84:87], v[36:39], v[64:67], 0
    v_mfma_f32_16x16x32_bf16 v[88:91], v[40:43], v[64:67], 0
    v_mfma_f32_16x16x32_bf16 v[92:95], v[44:47], v[64:67], 0
    v_mfma_f32_16x16x32_bf16 v[80:83], v[48:51], v[68:71], v[80:83]
    v_mfma_f32_16x16x32_bf16 v[84:87], v[52:55], v[68:71], v[84:87]
    v_mfma_f32_16x16x32_bf16 v[88:91], v[56:59], v[68:71], v[88:91]
    v_mfma_f32_16x16x32_bf16 v[92:95], v[60:63], v[68:71], v[92:95]
    s_nop 5
    v_mov_b32_dpp v80, v84 quad_perm:[0,1,2,3] row_mask:0xf bank_mask:0x2
    v_mov_b32_dpp v81, v85 quad_perm:[0,1,2,3] row_mask:0xf bank_mask:0x2
    v_mov_b32_dpp v82, v86 quad_perm:[0,1,2,3] row_mask:0xf bank_mask:0x2
    v_mov_b32_dpp v83, v87 quad_perm:[0,1,2,3] row_mask:0xf bank_mask:0x2
    v_mov_b32_dpp v80, v88 quad_perm:[0,1,2,3] row_mask:0xf bank_mask:0x4
    v_mov_b32_dpp v81, v89 quad_perm:[0,1,2,3] row_mask:0xf bank_mask:0x4
    v_mov_b32_dpp v82, v90 quad_perm:[0,1,2,3] row_mask:0xf bank_mask:0x4
    v_mov_b32_dpp v83, v91 quad_perm:[0,1,2,3] row_mask:0xf bank_mask:0x4
    v_mov_b32_dpp v80, v92 quad_perm:[0,1,2,3] row_mask:0xf bank_mask:0x8
    v_mov_b32_dpp v81, v93 quad_perm:[0,1,2,3] row_mask:0xf bank_mask:0x8
    v_mov_b32_dpp v82, v94 quad_perm:[0,1,2,3] row_mask:0xf bank_mask:0x8
    v_mov_b32_dpp v83, v95 quad_perm:[0,1,2,3] row_mask:0xf bank_mask:0x8
    ds_write_b128 v203, v[80:83]
    s_waitcnt lgkmcnt(0)
    s_barrier
    s_branch L_fin
L_w2_red:
    s_mov_b32 s35, 0
L_poll55:
    buffer_load_dwordx2 v[20:21], v204, s[44:47], 0 offen sc1
    buffer_load_dwordx2 v[22:23], v204, s[44:47], s48 offen sc1
    s_add_u32 s35, s35, 1
    s_waitcnt vmcnt(0)
    v_max3_u32 v28, v20, v21, v22
    v_max_u32 v28, v28, v23
    v_cmp_eq_u32 vcc, -1, v28
    s_cbranch_vccz L_done56
    s_sleep 12
    s_cmp_lt_u32 s35, 60000
    s_cbranch_scc1 L_poll55
L_done56:
    s_barrier
    v_lshlrev_b32 v44, 16, v20
    v_and_b32 v45, 0xffff0000, v20
    v_lshlrev_b32 v46, 16, v21
    v_and_b32 v47, 0xffff0000, v21
    v_lshlrev_b32 v48, 16, v22
    v_and_b32 v49, 0xffff0000, v22
    v_lshlrev_b32 v50, 16, v23
    v_and_b32 v51, 0xffff0000, v23
    v_add_f32 v108, v108, v44
    v_add_f32 v109, v109, v45
    v_add_f32 v110, v110, v46
    v_add_f32 v111, v111, v47
    v_add_f32 v108, v108, v48
    v_add_f32 v109, v109, v49
    v_add_f32 v110, v110, v50
    v_add_f32 v111, v111, v51
    s_barrier
    ds_read_b128 v[64:67], v203 offset:1024
    ds_read_b128 v[68:71], v203 offset:2048
    ds_read_b128 v[72:75], v203 offset:3072
    ds_read_b128 v[76:79], v203 offset:4096
    ds_read_b128 v[80:83], v203 offset:5120
    ds_read_b128 v[84:87], v203 offset:6144
    ds_read_b128 v[88:91], v203 offset:7168
    s_waitcnt lgkmcnt(5)
    v_pk_add_f32 v[64:65], v[64:65], v[68:69]
    v_pk_add_f32 v[66:67], v[66:67], v[70:71]
    s_waitcnt lgkmcnt(4)
    v_pk_add_f32 v[64:65], v[64:65], v[72:73]
    v_pk_add_f32 v[66:67], v[66:67], v[74:75]
    s_waitcnt lgkmcnt(3)
    v_pk_add_f32 v[64:65], v[64:65], v[76:77]
    v_pk_add_f32 v[66:67], v[66:67], v[78:79]
    s_waitcnt lgkmcnt(2)
    v_pk_add_f32 v[64:65], v[64:65], v[80:81]
    v_pk_add_f32 v[66:67], v[66:67], v[82:83]
    s_waitcnt lgkmcnt(1)
    v_pk_add_f32 v[64:65], v[64:65], v[84:85]
    v_pk_add_f32 v[66:67], v[66:67], v[86:87]
    s_waitcnt lgkmcnt(0)
    v_pk_add_f32 v[64:65], v[64:65], v[88:89]
    v_pk_add_f32 v[66:67], v[66:67], v[90:91]
    v_pk_fma_f32 v[64:65], v[64:65], v[104:105], v[108:109]
    v_pk_fma_f32 v[66:67], v[66:67], v[106:107], v[110:111]
    s_nop 0
    v_add_f32_dpp v64, v64, v64 row_ror:4 row_mask:0xf bank_mask:0xf
    v_add_f32_dpp v65, v65, v65 row_ror:4 row_mask:0xf bank_mask:0xf
    v_add_f32_dpp v66, v66, v66 row_ror:4 row_mask:0xf bank_mask:0xf
    v_add_f32_dpp v67, v67, v67 row_ror:4 row_mask:0xf bank_mask:0xf
    v_add_f32_dpp v64, v64, v64 row_ror:8 row_mask:0xf bank_mask:0xf
    v_add_f32_dpp v65, v65, v65 row_ror:8 row_mask:0xf bank_mask:0xf
    v_add_f32_dpp v66, v66, v66 row_ror:8 row_mask:0xf bank_mask:0xf
    v_add_f32_dpp v67, v67, v67 row_ror:8 row_mask:0xf bank_mask:0xf
    v_cvt_pk_bf16_f32 v20, v64, v65
    v_cvt_pk_bf16_f32 v21, v66, v67
    s_mov_b32 exec_lo, 0x000f000f
    s_mov_b32 exec_hi, 0x000f000f
    global_store_dwordx2 v112, v[20:21], s[28:29]
    s_mov_b64 exec, -1
    s_branch L_fin
L_t_wo:
    s_lshr_b32 s49, s3, 1
    s_lshl_b32 s49, s49, 17
    v_and_b32 v210, 7, v0
    s_lshl_b32 s34, s60, 12
    s_add_u32 s34, s34, s49
    s_add_u32 s34, s34, 98560
    v_lshrrev_b32 v211, 3, v0
    v_lshl_add_u32 v204, v211, 9, s34
    s_lshl_b32 s35, s51, 7
    s_add_u32 s34, s34, s35
    s_sub_u32 s34, s34, 256
    v_lshrrev_b32 v211, 3, v0
    v_lshlrev_b32 v205, 9, v211
    v_lshl_add_u32 v205, v210, 4, v205
    v_add_u32 v205, s34, v205
    s_lshl_b32 s34, s3, 12
    s_add_u32 s34, s34, 40960
    v_lshrrev_b32 v206, 2, v0
    v_lshlrev_b32 v206, 6, v206
    v_lshl_add_u32 v206, v200, 3, v206
    v_add_u32 v206, s34, v206
    s_mul_i32 s34, s3, 1152
    s_add_u32 s34, s34, 107520
    v_mul_u32_u24 v207, 144, v211
    v_lshl_add_u32 v207, v210, 4, v207
    v_add_u32 v207, s34, v207
    v_mul_u32_u24 v208, 144, v210
    v_lshl_add_u32 v208, v202, 4, v208
    v_add_u32 v208, s34, v208
    v_mul_u32_u24 v212, 144, v211
    v_add_u32 v212, s34, v212
    v_mul_u32_u24 v213, 144, v210
    v_add_u32 v213, s34, v213
    v_and_b32 v211, 1, v211
    v_lshl_add_u32 v203, v211, 6, v208
    v_add_u32 v203, 14592, v203
    v_mov_b32 v210, 98816
    v_cmp_eq_u32 vcc, 0, v211
    s_nop 1
    v_cndmask_b32 v209, v208, v210, vcc
    v_cndmask_b32 v208, v210, v208, vcc
    s_barrier
L_r_wo2:
    s_mov_b32 m0, s56
    s_nop 0
    buffer_load_dwordx4 v15, s[52:55], s57 offen  lds
    s_mov_b32 m0, s58
    s_nop 0
    buffer_load_dwordx4 v15, s[52:55], s59 offen  lds
    s_xor_b32 m0, s56, 2048
    s_sub_u32 s34, 40960, s57
    buffer_load_dwordx4 v15, s[52:55], s34 offen  lds
    s_xor_b32 m0, s58, 2048
    s_sub_u32 s34, 42240, s57
    buffer_load_dwordx4 v15, s[52:55], s34 offen  lds
L_r_wo3:
    s_mov_b32 s35, 0
    buffer_load_dwordx4 v[64:67], v205, s[44:47], 0 offen sc1
    buffer_load_dword v26, v204, s[44:47], 0 offen sc1
    s_waitcnt vmcnt(2)
    ds_read_b64_tr_b16 v[32:33], v206 offset:0
    ds_read_b64_tr_b16 v[34:35], v206 offset:1024
    ds_read_b64_tr_b16 v[36:37], v206 offset:32
    ds_read_b64_tr_b16 v[38:39], v206 offset:1056
    ds_read_b64_tr_b16 v[40:41], v206 offset:2048
    ds_read_b64_tr_b16 v[42:43], v206 offset:3072
    ds_read_b64_tr_b16 v[44:45], v206 offset:2080
    ds_read_b64_tr_b16 v[46:47], v206 offset:3104
    s_branch L_pam
L_pa:
    buffer_load_dwordx4 v[64:67], v205, s[44:47], 0 offen sc1
    buffer_load_dword v26, v204, s[44:47], 0 offen sc1
L_pam:
    s_add_u32 s35, s35, 1
    s_waitcnt vmcnt(0)
    ds_write_b128 v207, v[64:67]
    ds_write_b32 v212, v26 offset:128
    v_max3_u32 v28, v64, v65, v66
    v_max3_u32 v28, v28, v67, v26
    v_cmp_eq_u32 vcc, -1, v28
    s_cbranch_vccz L_pad
    s_mov_b64 exec, vcc
    s_cmp_lt_u32 s35, 60000
    s_cbranch_scc1 L_pa
L_pad:
    s_mov_b64 exec, -1
    ds_read_b32 v26, v213 offset:128
    ds_read_b128 v[68:71], v208 offset:0
    ds_read_b128 v[72:75], v209 offset:0
    ds_read_b128 v[76:79], v208 offset:64
    ds_read_b128 v[80:83], v209 offset:64
    s_waitcnt lgkmcnt(3)
    v_mfma_f32_16x16x32_bf16 v[20:23], v[32:35], v[68:71], 0
    s_waitcnt lgkmcnt(2)
    v_mfma_f32_16x16x32_bf16 v[20:23], v[36:39], v[72:75], v[20:23]
    s_waitcnt lgkmcnt(1)
    v_mfma_f32_16x16x32_bf16 v[20:23], v[40:43], v[76:79], v[20:23]
    s_waitcnt lgkmcnt(0)
    v_mfma_f32_16x16x32_bf16 v[20:23], v[44:47], v[80:83], v[20:23]
    v_sub_f32_dpp v26, v26, v26 quad_perm:[1,0,3,2] row_mask:0xf bank_mask:0xf
    v_exp_f32 v26, v26
    s_nop 0
    v_add_f32 v26, 1.0, v26
    v_rcp_f32 v26, v26
    s_nop 2
    v_pk_mul_f32 v[20:21], v[20:21], v[26:27] op_sel_hi:[1,0]
    v_pk_mul_f32 v[22:23], v[22:23], v[26:27] op_sel_hi:[1,0]
    ds_write_b128 v203, v[20:23]
    s_waitcnt lgkmcnt(0)
    s_barrier
    s_cmp_lg_u32 s3, 0
    s_cbranch_scc1 L_fin
    ds_read_b128 v[64:67], v207 offset:14592
    ds_read_b128 v[68:71], v207 offset:15744
    ds_read_b128 v[72:75], v207 offset:16896
    ds_read_b128 v[76:79], v207 offset:18048
    ds_read_b128 v[80:83], v207 offset:19200
    ds_read_b128 v[84:87], v207 offset:20352
    ds_read_b128 v[88:91], v207 offset:21504
    ds_read_b128 v[92:95], v207 offset:22656
    s_waitcnt lgkmcnt(6)
    v_pk_add_f32 v[64:65], v[64:65], v[68:69]
    v_pk_add_f32 v[66:67], v[66:67], v[70:71]
    s_waitcnt lgkmcnt(5)
    v_pk_add_f32 v[64:65], v[64:65], v[72:73]
    v_pk_add_f32 v[66:67], v[66:67], v[74:75]
    s_waitcnt lgkmcnt(4)
    v_pk_add_f32 v[64:65], v[64:65], v[76:77]
    v_pk_add_f32 v[66:67], v[66:67], v[78:79]
    s_waitcnt lgkmcnt(3)
    v_pk_add_f32 v[64:65], v[64:65], v[80:81]
    v_pk_add_f32 v[66:67], v[66:67], v[82:83]
    s_waitcnt lgkmcnt(2)
    v_pk_add_f32 v[64:65], v[64:65], v[84:85]
    v_pk_add_f32 v[66:67], v[66:67], v[86:87]
    s_waitcnt lgkmcnt(1)
    v_pk_add_f32 v[64:65], v[64:65], v[88:89]
    v_pk_add_f32 v[66:67], v[66:67], v[90:91]
    s_waitcnt lgkmcnt(0)
    v_pk_add_f32 v[64:65], v[64:65], v[92:93]
    v_pk_add_f32 v[66:67], v[66:67], v[94:95]
    v_pk_mul_f32 v[20:21], v[64:65], v[100:101]
    v_pk_mul_f32 v[22:23], v[66:67], v[102:103]
    s_nop 0
    v_add_f32_dpp v20, v20, v20 row_ror:8 row_mask:0xf bank_mask:0xf
    v_add_f32_dpp v21, v21, v21 row_ror:8 row_mask:0xf bank_mask:0xf
    v_add_f32_dpp v22, v22, v22 row_ror:8 row_mask:0xf bank_mask:0xf
    v_add_f32_dpp v23, v23, v23 row_ror:8 row_mask:0xf bank_mask:0xf
    v_cvt_pk_bf16_f32 v24, v20, v21
    v_cvt_pk_bf16_f32 v25, v22, v23
    v_min_u32 v24, -2, v24
    v_min_u32 v25, -2, v25
    s_mov_b32 exec_lo, 0x00ff00ff
    s_mov_b32 exec_hi, 0x00ff00ff
    buffer_store_dwordx2 v[24:25], v112, s[44:47], 0 offen sc1
    s_mov_b64 exec, -1
L_fin:
L_exit:
    s_endpgm
L_codeend:
.section .rodata,"a"
.p2align 6
.amdhsa_kernel adaLN_cond__sliding_block_cached__dense_activation_gelu__decode_kernel
  .amdhsa_next_free_vgpr 256
  .amdhsa_next_free_sgpr 102
  .amdhsa_accum_offset 256
  .amdhsa_group_segment_fixed_size 0
  .amdhsa_kernarg_size 120
  .amdhsa_user_sgpr_count 2
  .amdhsa_user_sgpr_kernarg_segment_ptr 1
  .amdhsa_system_sgpr_workgroup_id_x 1
  .amdhsa_float_denorm_mode_32 3
.end_amdhsa_kernel
```

```asm
; @launch grid=(256,1,1) block=(512,1,1) lds=132352
.amdgcn_target "amdgcn-amd-amdhsa--gfx950"
.text
.globl adaLN_cond__sliding_block_cached__dense_activation_gelu__decode_kernel
.p2align 8
.type adaLN_cond__sliding_block_cached__dense_activation_gelu__decode_kernel,@function
adaLN_cond__sliding_block_cached__dense_activation_gelu__decode_kernel:
    s_cmp_ge_u32 s2, 256
    s_cbranch_scc1 L_exit
    s_load_dwordx16 s[4:19], s[0:1], 0
    s_load_dwordx8 s[20:27], s[0:1], 64
    s_load_dwordx4 s[28:31], s[0:1], 96
    s_load_dwordx2 s[32:33], s[0:1], 112
    v_lshrrev_b32 v1, 6, v0
    v_and_b32 v0, 63, v0
    v_readfirstlane_b32 s3, v1
    s_and_b32 s60, s2, 7
    s_lshr_b32 s61, s2, 3
    s_mov_b32 s39, 0x20000
    s_mov_b32 s43, 0x20000
    s_mov_b32 s46, 524288
    s_mov_b32 s47, 0x20000
    s_cmp_lg_u32 s3, 0
    s_cbranch_scc1 L_stream
    s_setprio 3
    v_and_b32 v12, 3, v0
    v_bfe_u32 v13, v0, 2, 2
    v_lshrrev_b32 v14, 4, v0
    v_lshrrev_b32 v10, 3, v0
    v_and_b32 v11, 7, v0
    v_lshlrev_b32 v11, 4, v11
    s_lshr_b32 s50, s2, 2
    s_and_b32 s51, s2, 3
    s_mul_i32 s34, s51, 1228800
    s_lshl_b32 s35, s50, 7
    s_add_u32 s34, s34, s35
    v_mul_u32_u24 v17, 7680, v10
    v_add3_u32 v17, v17, v11, s34
    v_mul_u32_u24 v16, 1280, v12
    v_lshl_add_u32 v18, v14, 4, v16
    s_mul_i32 s34, s51, 320
    v_add_u32 v19, s34, v18
    s_mov_b32 s38, 4915200
    s_sub_u32 s52, s50, 10
    s_waitcnt lgkmcnt(0)
    s_add_u32 s44, s32, 0
    s_addc_u32 s45, s33, 0
    s_cmp_ge_u32 s2, 240
    s_cbranch_scc1 L_clear
    s_cmp_ge_u32 s52, 10
    s_cbranch_scc1 L_nox
    v_lshl_add_u32 v18, v13, 6, v18
    global_load_dwordx4 v[52:55], v18, s[4:5] offset:0
    global_load_dwordx4 v[56:59], v18, s[4:5] offset:256
    global_load_dwordx4 v[60:63], v18, s[4:5] offset:512
    global_load_dwordx4 v[64:67], v18, s[4:5] offset:768
    global_load_dwordx4 v[68:71], v18, s[4:5] offset:1024
    s_lshl_b32 s34, s52, 7
    v_lshl_add_u32 v16, v13, 5, v16
    v_lshl_add_u32 v16, v14, 3, v16
    v_add_u32 v16, s34, v16
    global_load_dwordx2 v[72:73], v16, s[4:5]
L_nox:
    global_load_dwordx4 v[32:35], v19, s[24:25] offset:0
    global_load_dwordx4 v[36:39], v19, s[24:25] offset:64
    global_load_dwordx4 v[40:43], v19, s[24:25] offset:128
    global_load_dwordx4 v[44:47], v19, s[24:25] offset:192
    global_load_dwordx4 v[48:51], v19, s[24:25] offset:256
    s_mov_b32 s36, s26
    s_mov_b32 s37, s27
    s_mov_b32 m0, 0
    s_mov_b32 s34, 0
L_dma1:
    buffer_load_dwordx4 v17, s[36:39], s34 offen  lds
    s_add_u32 m0, m0, 1024
    s_add_u32 s34, s34, 61440
    buffer_load_dwordx4 v17, s[36:39], s34 offen  lds
    s_add_u32 m0, m0, 1024
    s_add_u32 s34, s34, 61440
    buffer_load_dwordx4 v17, s[36:39], s34 offen  lds
    s_add_u32 m0, m0, 1024
    s_add_u32 s34, s34, 61440
    buffer_load_dwordx4 v17, s[36:39], s34 offen  lds
    s_add_u32 m0, m0, 1024
    s_add_u32 s34, s34, 61440
    s_cmp_lt_u32 s34, 1228800
    s_cbranch_scc1 L_dma1
    v_lshlrev_b32 v1, 2, v0
    v_add_u32 v1, 98304, v1
    v_mov_b32 v2, -1
    v_mov_b32 v3, 0
    ds_write_b32 v1, v2
    ds_write_b32 v1, v2 offset:256
    ds_write_b32 v1, v3 offset:512
    ds_write_b32 v1, v3 offset:768
    s_waitcnt lgkmcnt(0)
    s_barrier
    s_getpc_b64 s[56:57]
L_pc2:
    s_sub_u32 s56, s56, L_pc2-adaLN_cond__sliding_block_cached__dense_activation_gelu__decode_kernel
    s_subb_u32 s57, s57, 0
    s_lshl_b32 s34, s61, 10
    v_lshl_add_u32 v9, v0, 4, s34
    v_min_u32 v9, L_codeend-adaLN_cond__sliding_block_cached__dense_activation_gelu__decode_kernel-16, v9
    global_load_dwordx4 v[76:79], v9, s[56:57]
    s_and_b32 s34, s2, 31
    s_lshl_b32 s34, s34, 8
    s_lshr_b32 s35, s2, 7
    s_lshl_b32 s35, s35, 7
    s_add_u32 s49, s34, s35
    s_bfe_u32 s53, s2, 0x20005
    s_mul_i32 s34, s53, 1310720
    s_add_u32 s34, s34, s49
    v_lshl_add_u32 v16, v10, 13, v11
    v_add_u32 v16, s34, v16
    s_mov_b32 s36, s10
    s_mov_b32 s37, s11
    s_mov_b32 s38, 5242880
    s_mov_b32 m0, 20480
    s_mov_b32 s34, 0
L_dma3:
    buffer_load_dwordx4 v16, s[36:39], s34 offen  lds
    s_add_u32 m0, m0, 1024
    s_add_u32 s34, s34, 65536
    buffer_load_dwordx4 v16, s[36:39], s34 offen  lds
    s_add_u32 m0, m0, 1024
    s_add_u32 s34, s34, 65536
    buffer_load_dwordx4 v16, s[36:39], s34 offen  lds
    s_add_u32 m0, m0, 1024
    s_add_u32 s34, s34, 65536
    buffer_load_dwordx4 v16, s[36:39], s34 offen  lds
    s_add_u32 m0, m0, 1024
    s_add_u32 s34, s34, 65536
    s_cmp_lt_u32 s34, 1310720
    s_cbranch_scc1 L_dma3
    v_lshl_add_u32 v15, v14, 3, v13
    v_lshlrev_b32 v15, 7, v15
    v_lshl_add_u32 v15, v12, 3, v15
    s_waitcnt vmcnt(41)
    s_mov_b32 s34, 0xbfb8aa3b
    v_lshlrev_b32 v20, 16, v32
    v_and_b32 v21, 0xffff0000, v32
    v_lshlrev_b32 v22, 16, v33
    v_and_b32 v23, 0xffff0000, v33
    v_mul_f32 v24, s34, v20
    v_mul_f32 v25, s34, v21
    v_mul_f32 v26, s34, v22
    v_mul_f32 v27, s34, v23
    v_exp_f32 v24, v24
    v_exp_f32 v25, v25
    v_exp_f32 v26, v26
    v_exp_f32 v27, v27
    v_add_f32 v24, 1.0, v24
    v_add_f32 v25, 1.0, v25
    v_add_f32 v26, 1.0, v26
    v_add_f32 v27, 1.0, v27
    v_rcp_f32 v24, v24
    v_rcp_f32 v25, v25
    v_rcp_f32 v26, v26
    v_rcp_f32 v27, v27
    v_mul_f32 v24, v20, v24
    v_mul_f32 v25, v21, v25
    v_mul_f32 v26, v22, v26
    v_mul_f32 v27, v23, v27
    v_cvt_pk_bf16_f32 v32, v24, v25
    v_cvt_pk_bf16_f32 v33, v26, v27
    v_lshlrev_b32 v20, 16, v34
    v_and_b32 v21, 0xffff0000, v34
    v_lshlrev_b32 v22, 16, v35
    v_and_b32 v23, 0xffff0000, v35
    v_mul_f32 v24, s34, v20
    v_mul_f32 v25, s34, v21
    v_mul_f32 v26, s34, v22
    v_mul_f32 v27, s34, v23
    v_exp_f32 v24, v24
    v_exp_f32 v25, v25
    v_exp_f32 v26, v26
    v_exp_f32 v27, v27
    v_add_f32 v24, 1.0, v24
    v_add_f32 v25, 1.0, v25
    v_add_f32 v26, 1.0, v26
    v_add_f32 v27, 1.0, v27
    v_rcp_f32 v24, v24
    v_rcp_f32 v25, v25
    v_rcp_f32 v26, v26
    v_rcp_f32 v27, v27
    v_mul_f32 v24, v20, v24
    v_mul_f32 v25, v21, v25
    v_mul_f32 v26, v22, v26
    v_mul_f32 v27, v23, v27
    v_cvt_pk_bf16_f32 v34, v24, v25
    v_cvt_pk_bf16_f32 v35, v26, v27
    v_lshlrev_b32 v20, 16, v36
    v_and_b32 v21, 0xffff0000, v36
    v_lshlrev_b32 v22, 16, v37
    v_and_b32 v23, 0xffff0000, v37
    v_mul_f32 v24, s34, v20
    v_mul_f32 v25, s34, v21
    v_mul_f32 v26, s34, v22
    v_mul_f32 v27, s34, v23
    v_exp_f32 v24, v24
    v_exp_f32 v25, v25
    v_exp_f32 v26, v26
    v_exp_f32 v27, v27
    v_add_f32 v24, 1.0, v24
    v_add_f32 v25, 1.0, v25
    v_add_f32 v26, 1.0, v26
    v_add_f32 v27, 1.0, v27
    v_rcp_f32 v24, v24
    v_rcp_f32 v25, v25
    v_rcp_f32 v26, v26
    v_rcp_f32 v27, v27
    v_mul_f32 v24, v20, v24
    v_mul_f32 v25, v21, v25
    v_mul_f32 v26, v22, v26
    v_mul_f32 v27, v23, v27
    v_cvt_pk_bf16_f32 v36, v24, v25
    v_cvt_pk_bf16_f32 v37, v26, v27
    v_lshlrev_b32 v20, 16, v38
    v_and_b32 v21, 0xffff0000, v38
    v_lshlrev_b32 v22, 16, v39
    v_and_b32 v23, 0xffff0000, v39
    v_mul_f32 v24, s34, v20
    v_mul_f32 v25, s34, v21
    v_mul_f32 v26, s34, v22
    v_mul_f32 v27, s34, v23
    v_exp_f32 v24, v24
    v_exp_f32 v25, v25
    v_exp_f32 v26, v26
    v_exp_f32 v27, v27
    v_add_f32 v24, 1.0, v24
    v_add_f32 v25, 1.0, v25
    v_add_f32 v26, 1.0, v26
    v_add_f32 v27, 1.0, v27
    v_rcp_f32 v24, v24
    v_rcp_f32 v25, v25
    v_rcp_f32 v26, v26
    v_rcp_f32 v27, v27
    v_mul_f32 v24, v20, v24
    v_mul_f32 v25, v21, v25
    v_mul_f32 v26, v22, v26
    v_mul_f32 v27, v23, v27
    v_cvt_pk_bf16_f32 v38, v24, v25
    v_cvt_pk_bf16_f32 v39, v26, v27
    v_lshlrev_b32 v20, 16, v40
    v_and_b32 v21, 0xffff0000, v40
    v_lshlrev_b32 v22, 16, v41
    v_and_b32 v23, 0xffff0000, v41
    v_mul_f32 v24, s34, v20
    v_mul_f32 v25, s34, v21
    v_mul_f32 v26, s34, v22
    v_mul_f32 v27, s34, v23
    v_exp_f32 v24, v24
    v_exp_f32 v25, v25
    v_exp_f32 v26, v26
    v_exp_f32 v27, v27
    v_add_f32 v24, 1.0, v24
    v_add_f32 v25, 1.0, v25
    v_add_f32 v26, 1.0, v26
    v_add_f32 v27, 1.0, v27
    v_rcp_f32 v24, v24
    v_rcp_f32 v25, v25
    v_rcp_f32 v26, v26
    v_rcp_f32 v27, v27
    v_mul_f32 v24, v20, v24
    v_mul_f32 v25, v21, v25
    v_mul_f32 v26, v22, v26
    v_mul_f32 v27, v23, v27
    v_cvt_pk_bf16_f32 v40, v24, v25
    v_cvt_pk_bf16_f32 v41, v26, v27
    v_lshlrev_b32 v20, 16, v42
    v_and_b32 v21, 0xffff0000, v42
    v_lshlrev_b32 v22, 16, v43
    v_and_b32 v23, 0xffff0000, v43
    v_mul_f32 v24, s34, v20
    v_mul_f32 v25, s34, v21
    v_mul_f32 v26, s34, v22
    v_mul_f32 v27, s34, v23
    v_exp_f32 v24, v24
    v_exp_f32 v25, v25
    v_exp_f32 v26, v26
    v_exp_f32 v27, v27
    v_add_f32 v24, 1.0, v24
    v_add_f32 v25, 1.0, v25
    v_add_f32 v26, 1.0, v26
    v_add_f32 v27, 1.0, v27
    v_rcp_f32 v24, v24
    v_rcp_f32 v25, v25
    v_rcp_f32 v26, v26
    v_rcp_f32 v27, v27
    v_mul_f32 v24, v20, v24
    v_mul_f32 v25, v21, v25
    v_mul_f32 v26, v22, v26
    v_mul_f32 v27, v23, v27
    v_cvt_pk_bf16_f32 v42, v24, v25
    v_cvt_pk_bf16_f32 v43, v26, v27
    v_lshlrev_b32 v20, 16, v44
    v_and_b32 v21, 0xffff0000, v44
    v_lshlrev_b32 v22, 16, v45
    v_and_b32 v23, 0xffff0000, v45
    v_mul_f32 v24, s34, v20
    v_mul_f32 v25, s34, v21
    v_mul_f32 v26, s34, v22
    v_mul_f32 v27, s34, v23
    v_exp_f32 v24, v24
    v_exp_f32 v25, v25
    v_exp_f32 v26, v26
    v_exp_f32 v27, v27
    v_add_f32 v24, 1.0, v24
    v_add_f32 v25, 1.0, v25
    v_add_f32 v26, 1.0, v26
    v_add_f32 v27, 1.0, v27
    v_rcp_f32 v24, v24
    v_rcp_f32 v25, v25
    v_rcp_f32 v26, v26
    v_rcp_f32 v27, v27
    v_mul_f32 v24, v20, v24
    v_mul_f32 v25, v21, v25
    v_mul_f32 v26, v22, v26
    v_mul_f32 v27, v23, v27
    v_cvt_pk_bf16_f32 v44, v24, v25
    v_cvt_pk_bf16_f32 v45, v26, v27
    v_lshlrev_b32 v20, 16, v46
    v_and_b32 v21, 0xffff0000, v46
    v_lshlrev_b32 v22, 16, v47
    v_and_b32 v23, 0xffff0000, v47
    v_mul_f32 v24, s34, v20
    v_mul_f32 v25, s34, v21
    v_mul_f32 v26, s34, v22
    v_mul_f32 v27, s34, v23
    v_exp_f32 v24, v24
    v_exp_f32 v25, v25
    v_exp_f32 v26, v26
    v_exp_f32 v27, v27
    v_add_f32 v24, 1.0, v24
    v_add_f32 v25, 1.0, v25
    v_add_f32 v26, 1.0, v26
    v_add_f32 v27, 1.0, v27
    v_rcp_f32 v24, v24
    v_rcp_f32 v25, v25
    v_rcp_f32 v26, v26
    v_rcp_f32 v27, v27
    v_mul_f32 v24, v20, v24
    v_mul_f32 v25, v21, v25
    v_mul_f32 v26, v22, v26
    v_mul_f32 v27, v23, v27
    v_cvt_pk_bf16_f32 v46, v24, v25
    v_cvt_pk_bf16_f32 v47, v26, v27
    v_lshlrev_b32 v20, 16, v48
    v_and_b32 v21, 0xffff0000, v48
    v_lshlrev_b32 v22, 16, v49
    v_and_b32 v23, 0xffff0000, v49
    v_mul_f32 v24, s34, v20
    v_mul_f32 v25, s34, v21
    v_mul_f32 v26, s34, v22
    v_mul_f32 v27, s34, v23
    v_exp_f32 v24, v24
    v_exp_f32 v25, v25
    v_exp_f32 v26, v26
    v_exp_f32 v27, v27
    v_add_f32 v24, 1.0, v24
    v_add_f32 v25, 1.0, v25
    v_add_f32 v26, 1.0, v26
    v_add_f32 v27, 1.0, v27
    v_rcp_f32 v24, v24
    v_rcp_f32 v25, v25
    v_rcp_f32 v26, v26
    v_rcp_f32 v27, v27
    v_mul_f32 v24, v20, v24
    v_mul_f32 v25, v21, v25
    v_mul_f32 v26, v22, v26
    v_mul_f32 v27, v23, v27
    v_cvt_pk_bf16_f32 v48, v24, v25
    v_cvt_pk_bf16_f32 v49, v26, v27
    v_lshlrev_b32 v20, 16, v50
    v_and_b32 v21, 0xffff0000, v50
    v_lshlrev_b32 v22, 16, v51
    v_and_b32 v23, 0xffff0000, v51
    v_mul_f32 v24, s34, v20
    v_mul_f32 v25, s34, v21
    v_mul_f32 v26, s34, v22
    v_mul_f32 v27, s34, v23
    v_exp_f32 v24, v24
    v_exp_f32 v25, v25
    v_exp_f32 v26, v26
    v_exp_f32 v27, v27
    v_add_f32 v24, 1.0, v24
    v_add_f32 v25, 1.0, v25
    v_add_f32 v26, 1.0, v26
    v_add_f32 v27, 1.0, v27
    v_rcp_f32 v24, v24
    v_rcp_f32 v25, v25
    v_rcp_f32 v26, v26
    v_rcp_f32 v27, v27
    v_mul_f32 v24, v20, v24
    v_mul_f32 v25, v21, v25
    v_mul_f32 v26, v22, v26
    v_mul_f32 v27, v23, v27
    v_cvt_pk_bf16_f32 v50, v24, v25
    v_cvt_pk_bf16_f32 v51, v26, v27
    s_cmp_ge_u32 s52, 10
    s_cbranch_scc1 L_nostats
    v_mov_b32 v20, 0
    v_mov_b32 v21, 0
    v_mov_b32 v22, 0x3f803f80
    v_dot2c_f32_bf16 v20, v52, v22
    v_dot2c_f32_bf16 v21, v52, v52
    v_dot2c_f32_bf16 v20, v53, v22
    v_dot2c_f32_bf16 v21, v53, v53
    v_dot2c_f32_bf16 v20, v54, v22
    v_dot2c_f32_bf16 v21, v54, v54
    v_dot2c_f32_bf16 v20, v55, v22
    v_dot2c_f32_bf16 v21, v55, v55
    v_dot2c_f32_bf16 v20, v56, v22
    v_dot2c_f32_bf16 v21, v56, v56
    v_dot2c_f32_bf16 v20, v57, v22
    v_dot2c_f32_bf16 v21, v57, v57
    v_dot2c_f32_bf16 v20, v58, v22
    v_dot2c_f32_bf16 v21, v58, v58
    v_dot2c_f32_bf16 v20, v59, v22
    v_dot2c_f32_bf16 v21, v59, v59
    v_dot2c_f32_bf16 v20, v60, v22
    v_dot2c_f32_bf16 v21, v60, v60
    v_dot2c_f32_bf16 v20, v61, v22
    v_dot2c_f32_bf16 v21, v61, v61
    v_dot2c_f32_bf16 v20, v62, v22
    v_dot2c_f32_bf16 v21, v62, v62
    v_dot2c_f32_bf16 v20, v63, v22
    v_dot2c_f32_bf16 v21, v63, v63
    v_dot2c_f32_bf16 v20, v64, v22
    v_dot2c_f32_bf16 v21, v64, v64
    v_dot2c_f32_bf16 v20, v65, v22
    v_dot2c_f32_bf16 v21, v65, v65
    v_dot2c_f32_bf16 v20, v66, v22
    v_dot2c_f32_bf16 v21, v66, v66
    v_dot2c_f32_bf16 v20, v67, v22
    v_dot2c_f32_bf16 v21, v67, v67
    v_dot2c_f32_bf16 v20, v68, v22
    v_dot2c_f32_bf16 v21, v68, v68
    v_dot2c_f32_bf16 v20, v69, v22
    v_dot2c_f32_bf16 v21, v69, v69
    v_dot2c_f32_bf16 v20, v70, v22
    v_dot2c_f32_bf16 v21, v70, v70
    v_dot2c_f32_bf16 v20, v71, v22
    v_dot2c_f32_bf16 v21, v71, v71
    s_nop 1
    v_add_f32_dpp v20, v20, v20 row_ror:4 row_mask:0xf bank_mask:0xf
    v_add_f32_dpp v21, v21, v21 row_ror:4 row_mask:0xf bank_mask:0xf
    s_nop 0
    v_add_f32_dpp v20, v20, v20 row_ror:8 row_mask:0xf bank_mask:0xf
    v_add_f32_dpp v21, v21, v21 row_ror:8 row_mask:0xf bank_mask:0xf
    v_mov_b32 v22, v20
    v_mov_b32 v23, v21
    s_nop 0
    v_permlane16_swap_b32 v20, v22
    v_permlane16_swap_b32 v21, v23
    v_add_f32 v20, v20, v22
    v_add_f32 v21, v21, v23
    v_mov_b32 v22, v20
    v_mov_b32 v23, v21
    s_nop 0
    v_permlane32_swap_b32 v20, v22
    v_permlane32_swap_b32 v21, v23
    v_add_f32 v20, v20, v22
    v_add_f32 v21, v21, v23
    v_mul_f32 v22, 0x3acccccd, v20
    v_mul_f32 v21, 0x3acccccd, v21
    v_fma_f32 v21, -v22, v22, v21
    v_max_f32 v21, 0, v21
    v_add_f32 v21, 0x3727c5ac, v21
    v_rsq_f32 v20, v21
    s_nop 0
    v_mul_f32_e64 v21, -v22, v20
    v_lshlrev_b32 v24, 16, v72
    v_and_b32 v25, 0xffff0000, v72
    v_lshlrev_b32 v26, 16, v73
    v_and_b32 v27, 0xffff0000, v73
    v_fma_f32 v24, v24, v20, v21
    v_fma_f32 v25, v25, v20, v21
    v_fma_f32 v26, v26, v20, v21
    v_fma_f32 v27, v27, v20, v21
L_nostats:
    s_waitcnt vmcnt(21)
    ds_read_b64_tr_b16 v[96:97], v15 offset:0
    ds_read_b64_tr_b16 v[98:99], v15 offset:512
    ds_read_b64_tr_b16 v[100:101], v15 offset:32
    ds_read_b64_tr_b16 v[102:103], v15 offset:544
    ds_read_b64_tr_b16 v[104:105], v15 offset:64
    ds_read_b64_tr_b16 v[106:107], v15 offset:576
    ds_read_b64_tr_b16 v[108:109], v15 offset:96
    ds_read_b64_tr_b16 v[110:111], v15 offset:608
    s_waitcnt lgkmcnt(7)
    ds_read_b64_tr_b16 v[112:113], v15 offset:4096
    ds_read_b64_tr_b16 v[114:115], v15 offset:4608
    ds_read_b64_tr_b16 v[116:117], v15 offset:4128
    ds_read_b64_tr_b16 v[118:119], v15 offset:4640
    ds_read_b64_tr_b16 v[120:121], v15 offset:4160
    ds_read_b64_tr_b16 v[122:123], v15 offset:4672
    ds_read_b64_tr_b16 v[124:125], v15 offset:4192
    ds_read_b64_tr_b16 v[126:127], v15 offset:4704
    s_waitcnt lgkmcnt(7)
    ds_read_b64_tr_b16 v[128:129], v15 offset:8192
    ds_read_b64_tr_b16 v[130:131], v15 offset:8704
    ds_read_b64_tr_b16 v[132:133], v15 offset:8224
    ds_read_b64_tr_b16 v[134:135], v15 offset:8736
    ds_read_b64_tr_b16 v[136:137], v15 offset:8256
    ds_read_b64_tr_b16 v[138:139], v15 offset:8768
    ds_read_b64_tr_b16 v[140:141], v15 offset:8288
    ds_read_b64_tr_b16 v[142:143], v15 offset:8800
    s_waitcnt lgkmcnt(7)
    ds_read_b64_tr_b16 v[144:145], v15 offset:12288
    ds_read_b64_tr_b16 v[146:147], v15 offset:12800
    ds_read_b64_tr_b16 v[148:149], v15 offset:12320
    ds_read_b64_tr_b16 v[150:151], v15 offset:12832
    ds_read_b64_tr_b16 v[152:153], v15 offset:12352
    ds_read_b64_tr_b16 v[154:155], v15 offset:12864
    ds_read_b64_tr_b16 v[156:157], v15 offset:12384
    ds_read_b64_tr_b16 v[158:159], v15 offset:12896
    s_waitcnt lgkmcnt(7)
    ds_read_b64_tr_b16 v[160:161], v15 offset:16384
    ds_read_b64_tr_b16 v[162:163], v15 offset:16896
    ds_read_b64_tr_b16 v[164:165], v15 offset:16416
    ds_read_b64_tr_b16 v[166:167], v15 offset:16928
    ds_read_b64_tr_b16 v[168:169], v15 offset:16448
    ds_read_b64_tr_b16 v[170:171], v15 offset:16960
    ds_read_b64_tr_b16 v[172:173], v15 offset:16480
    ds_read_b64_tr_b16 v[174:175], v15 offset:16992
    s_waitcnt lgkmcnt(0)
    v_mfma_f32_16x16x32_bf16 v[80:83], v[96:99], v[32:35], 0
    v_mfma_f32_16x16x32_bf16 v[84:87], v[100:103], v[32:35], 0
    v_mfma_f32_16x16x32_bf16 v[88:91], v[104:107], v[32:35], 0
    v_mfma_f32_16x16x32_bf16 v[92:95], v[108:111], v[32:35], 0
    v_mfma_f32_16x16x32_bf16 v[80:83], v[112:115], v[36:39], v[80:83]
    v_mfma_f32_16x16x32_bf16 v[84:87], v[116:119], v[36:39], v[84:87]
    v_mfma_f32_16x16x32_bf16 v[88:91], v[120:123], v[36:39], v[88:91]
    v_mfma_f32_16x16x32_bf16 v[92:95], v[124:127], v[36:39], v[92:95]
    v_mfma_f32_16x16x32_bf16 v[80:83], v[128:131], v[40:43], v[80:83]
    v_mfma_f32_16x16x32_bf16 v[84:87], v[132:135], v[40:43], v[84:87]
    v_mfma_f32_16x16x32_bf16 v[88:91], v[136:139], v[40:43], v[88:91]
    v_mfma_f32_16x16x32_bf16 v[92:95], v[140:143], v[40:43], v[92:95]
    v_mfma_f32_16x16x32_bf16 v[80:83], v[144:147], v[44:47], v[80:83]
    v_mfma_f32_16x16x32_bf16 v[84:87], v[148:151], v[44:47], v[84:87]
    v_mfma_f32_16x16x32_bf16 v[88:91], v[152:155], v[44:47], v[88:91]
    v_mfma_f32_16x16x32_bf16 v[92:95], v[156:159], v[44:47], v[92:95]
    v_mfma_f32_16x16x32_bf16 v[80:83], v[160:163], v[48:51], v[80:83]
    v_mfma_f32_16x16x32_bf16 v[84:87], v[164:167], v[48:51], v[84:87]
    v_mfma_f32_16x16x32_bf16 v[88:91], v[168:171], v[48:51], v[88:91]
    v_mfma_f32_16x16x32_bf16 v[92:95], v[172:175], v[48:51], v[92:95]
    s_cmp_ge_u32 s50, 20
    s_cbranch_scc1 L_adr_rest
    s_cmp_lt_u32 s50, 10
    s_cselect_b32 s34, 5120, 0
    s_cselect_b32 s35, s50, s52
    s_lshl_b32 s35, s35, 9
    s_add_u32 s34, s34, s35
    s_lshl_b32 s35, s51, 17
    s_add_u32 s34, s34, s35
    v_lshrrev_b32 v19, 1, v14
    v_lshl_add_u32 v19, v13, 1, v19
    v_lshlrev_b32 v19, 6, v19
    v_lshl_add_u32 v19, v12, 4, v19
    v_and_b32 v20, 1, v14
    v_lshl_add_u32 v19, v20, 3, v19
    s_branch L_adr_done
L_adr_rest:
    s_lshl_b32 s34, s51, 17
    s_lshl_b32 s35, s50, 9
    s_add_u32 s34, s34, s35
    s_add_u32 s34, s34, 0
    v_lshlrev_b32 v19, 7, v12
    v_lshl_add_u32 v19, v13, 5, v19
    v_lshl_add_u32 v19, v14, 3, v19
    s_nop 3
L_adr_done:
    v_add_u32 v19, s34, v19
    v_mov_b32_dpp v80, v84 quad_perm:[0,1,2,3] row_mask:0xf bank_mask:0x2
    v_mov_b32_dpp v81, v85 quad_perm:[0,1,2,3] row_mask:0xf bank_mask:0x2
    v_mov_b32_dpp v82, v86 quad_perm:[0,1,2,3] row_mask:0xf bank_mask:0x2
    v_mov_b32_dpp v83, v87 quad_perm:[0,1,2,3] row_mask:0xf bank_mask:0x2
    v_mov_b32_dpp v80, v88 quad_perm:[0,1,2,3] row_mask:0xf bank_mask:0x4
    v_mov_b32_dpp v81, v89 quad_perm:[0,1,2,3] row_mask:0xf bank_mask:0x4
    v_mov_b32_dpp v82, v90 quad_perm:[0,1,2,3] row_mask:0xf bank_mask:0x4
    v_mov_b32_dpp v83, v91 quad_perm:[0,1,2,3] row_mask:0xf bank_mask:0x4
    v_mov_b32_dpp v80, v92 quad_perm:[0,1,2,3] row_mask:0xf bank_mask:0x8
    v_mov_b32_dpp v81, v93 quad_perm:[0,1,2,3] row_mask:0xf bank_mask:0x8
    v_mov_b32_dpp v82, v94 quad_perm:[0,1,2,3] row_mask:0xf bank_mask:0x8
    v_mov_b32_dpp v83, v95 quad_perm:[0,1,2,3] row_mask:0xf bank_mask:0x8
    s_cmp_ge_u32 s52, 10
    s_cbranch_scc1 L_noz
    v_add_f32 v80, 0x3e800000, v80
    v_add_f32 v81, 0x3e800000, v81
    v_add_f32 v82, 0x3e800000, v82
    v_add_f32 v83, 0x3e800000, v83
    v_mul_f32 v80, v80, v24
    v_mul_f32 v81, v81, v25
    v_mul_f32 v82, v82, v26
    v_mul_f32 v83, v83, v27
L_noz:
    v_cvt_pk_bf16_f32 v20, v80, v81
    v_cvt_pk_bf16_f32 v21, v82, v83
    v_min_u32 v20, -2, v20
    v_min_u32 v21, -2, v21
    v_and_b32 v22, 15, v0
    v_lshlrev_b32 v22, 2, v22
    s_mov_b32 s35, 0
L_poll4:
    global_load_dword v23, v22, s[30:31] offset:128 sc1
    s_add_u32 s35, s35, 1
    s_waitcnt vmcnt(0)
    v_cmp_eq_u32 vcc, 0, v23
    s_cbranch_vccz L_done5
    s_sleep 8
    s_cmp_lt_u32 s35, 60000
    s_cbranch_scc1 L_poll4
L_done5:
    s_getreg_b32 s97, hwreg(HW_REG_XCC_ID, 0, 4)
    s_sub_u32 s97, s97, s2
    s_and_b32 s97, s97, 7
    s_add_u32 s97, s97, 1
    v_cmp_ne_u32 vcc, s97, v23
    s_nop 0
    s_mov_b32 s97, vcc_lo
    buffer_store_dwordx2 v[20:21], v19, s[44:47], 0 offen sc1
    s_branch L_p2
L_clear:
    s_sub_u32 s55, s2, 240
    s_lshr_b32 s34, s55, 2
    s_lshl_b32 s35, s34, 3
    s_lshr_b32 s54, 538124318, s35
    s_and_b32 s54, s54, 0xff
    s_lshl_b32 s54, s54, 10
    s_mul_i32 s34, s34, 32768
    s_lshl_b32 s35, s51, 17
    s_add_u32 s34, s34, s35
    v_lshl_add_u32 v19, v0, 4, s34
    v_mov_b32 v20, -1
    v_mov_b32 v21, -1
    v_mov_b32 v22, -1
    v_mov_b32 v23, -1
    s_mov_b32 s34, 0
L_clrloop:
    buffer_store_dwordx4 v[20:23], v19, s[44:47], s34 offen sc1
    s_add_u32 s34, s34, 1024
    s_cmp_lt_u32 s34, s54
    s_cbranch_scc1 L_clrloop
    v_lshlrev_b32 v1, 2, v0
    v_add_u32 v1, 98304, v1
    v_mov_b32 v2, -1
    v_mov_b32 v3, 0
    ds_write_b32 v1, v2
    ds_write_b32 v1, v2 offset:256
    ds_write_b32 v1, v3 offset:512
    ds_write_b32 v1, v3 offset:768
    s_waitcnt lgkmcnt(0)
    s_barrier
    s_lshl_b32 s34, s55, 2
    v_mov_b32 v24, s34
    s_getreg_b32 s97, hwreg(HW_REG_XCC_ID, 0, 4)
    s_sub_u32 s97, s97, s2
    s_and_b32 s97, s97, 7
    s_add_u32 s97, s97, 1
    v_mov_b32 v25, s97
    s_waitcnt vmcnt(0)
    s_mov_b64 exec, 1
    global_store_dword v24, v25, s[30:31] offset:128 sc1
    s_mov_b64 exec, -1
    s_getpc_b64 s[56:57]
L_pc7:
    s_sub_u32 s56, s56, L_pc7-adaLN_cond__sliding_block_cached__dense_activation_gelu__decode_kernel
    s_subb_u32 s57, s57, 0
    s_lshl_b32 s34, s61, 10
    v_lshl_add_u32 v9, v0, 4, s34
    v_min_u32 v9, L_codeend-adaLN_cond__sliding_block_cached__dense_activation_gelu__decode_kernel-16, v9
    global_load_dwordx4 v[76:79], v9, s[56:57]
    s_and_b32 s34, s2, 31
    s_lshl_b32 s34, s34, 8
    s_lshr_b32 s35, s2, 7
    s_lshl_b32 s35, s35, 7
    s_add_u32 s49, s34, s35
    s_bfe_u32 s53, s2, 0x20005
    s_mul_i32 s34, s53, 1310720
    s_add_u32 s34, s34, s49
    v_lshl_add_u32 v16, v10, 13, v11
    v_add_u32 v16, s34, v16
    s_mov_b32 s36, s10
    s_mov_b32 s37, s11
    s_mov_b32 s38, 5242880
    s_mov_b32 m0, 20480
    s_mov_b32 s34, 0
L_dma8:
    buffer_load_dwordx4 v16, s[36:39], s34 offen  lds
    s_add_u32 m0, m0, 1024
    s_add_u32 s34, s34, 65536
    buffer_load_dwordx4 v16, s[36:39], s34 offen  lds
    s_add_u32 m0, m0, 1024
    s_add_u32 s34, s34, 65536
    buffer_load_dwordx4 v16, s[36:39], s34 offen  lds
    s_add_u32 m0, m0, 1024
    s_add_u32 s34, s34, 65536
    buffer_load_dwordx4 v16, s[36:39], s34 offen  lds
    s_add_u32 m0, m0, 1024
    s_add_u32 s34, s34, 65536
    s_cmp_lt_u32 s34, 1310720
    s_cbranch_scc1 L_dma8
    v_lshl_add_u32 v15, v14, 3, v13
    v_lshlrev_b32 v15, 7, v15
    v_lshl_add_u32 v15, v12, 3, v15
    v_and_b32 v22, 15, v0
    v_lshlrev_b32 v22, 2, v22
    s_mov_b32 s35, 0
L_poll9:
    global_load_dword v23, v22, s[30:31] offset:128 sc1
    s_add_u32 s35, s35, 1
    s_waitcnt vmcnt(0)
    v_cmp_eq_u32 vcc, 0, v23
    s_cbranch_vccz L_done10
    s_sleep 8
    s_cmp_lt_u32 s35, 60000
    s_cbranch_scc1 L_poll9
L_done10:
    s_getreg_b32 s97, hwreg(HW_REG_XCC_ID, 0, 4)
    s_sub_u32 s97, s97, s2
    s_and_b32 s97, s97, 7
    s_add_u32 s97, s97, 1
    v_cmp_ne_u32 vcc, s97, v23
    s_nop 0
    s_mov_b32 s97, vcc_lo
L_p2:
    v_mov_b32 v199, v19
    ds_read_b64_tr_b16 v[96:97], v15 offset:20480
    ds_read_b64_tr_b16 v[98:99], v15 offset:20992
    ds_read_b64_tr_b16 v[100:101], v15 offset:20512
    ds_read_b64_tr_b16 v[102:103], v15 offset:21024
    ds_read_b64_tr_b16 v[104:105], v15 offset:20544
    ds_read_b64_tr_b16 v[106:107], v15 offset:21056
    ds_read_b64_tr_b16 v[108:109], v15 offset:20576
    ds_read_b64_tr_b16 v[110:111], v15 offset:21088
    s_waitcnt lgkmcnt(7)
    ds_read_b64_tr_b16 v[112:113], v15 offset:24576
    ds_read_b64_tr_b16 v[114:115], v15 offset:25088
    ds_read_b64_tr_b16 v[116:117], v15 offset:24608
    ds_read_b64_tr_b16 v[118:119], v15 offset:25120
    ds_read_b64_tr_b16 v[120:121], v15 offset:24640
    ds_read_b64_tr_b16 v[122:123], v15 offset:25152
    ds_read_b64_tr_b16 v[124:125], v15 offset:24672
    ds_read_b64_tr_b16 v[126:127], v15 offset:25184
    s_waitcnt lgkmcnt(7)
    ds_read_b64_tr_b16 v[128:129], v15 offset:28672
    ds_read_b64_tr_b16 v[130:131], v15 offset:29184
    ds_read_b64_tr_b16 v[132:133], v15 offset:28704
    ds_read_b64_tr_b16 v[134:135], v15 offset:29216
    ds_read_b64_tr_b16 v[136:137], v15 offset:28736
    ds_read_b64_tr_b16 v[138:139], v15 offset:29248
    ds_read_b64_tr_b16 v[140:141], v15 offset:28768
    ds_read_b64_tr_b16 v[142:143], v15 offset:29280
    s_waitcnt lgkmcnt(7)
    ds_read_b64_tr_b16 v[144:145], v15 offset:32768
    ds_read_b64_tr_b16 v[146:147], v15 offset:33280
    ds_read_b64_tr_b16 v[148:149], v15 offset:32800
    ds_read_b64_tr_b16 v[150:151], v15 offset:33312
    ds_read_b64_tr_b16 v[152:153], v15 offset:32832
    ds_read_b64_tr_b16 v[154:155], v15 offset:33344
    ds_read_b64_tr_b16 v[156:157], v15 offset:32864
    ds_read_b64_tr_b16 v[158:159], v15 offset:33376
    s_waitcnt lgkmcnt(7)
    ds_read_b64_tr_b16 v[160:161], v15 offset:36864
    ds_read_b64_tr_b16 v[162:163], v15 offset:37376
    ds_read_b64_tr_b16 v[164:165], v15 offset:36896
    ds_read_b64_tr_b16 v[166:167], v15 offset:37408
    ds_read_b64_tr_b16 v[168:169], v15 offset:36928
    ds_read_b64_tr_b16 v[170:171], v15 offset:37440
    ds_read_b64_tr_b16 v[172:173], v15 offset:36960
    ds_read_b64_tr_b16 v[174:175], v15 offset:37472
    s_waitcnt lgkmcnt(0)
    s_mul_i32 s34, s53, 1280
    v_lshlrev_b32 v19, 17, v13
    v_lshl_add_u32 v19, v14, 6, v19
    v_lshl_add_u32 v19, v12, 4, v19
    v_add_u32 v19, s34, v19
    s_movk_i32 s48, 5120
    s_mov_b32 s56, 131072
    s_mov_b32 s57, 262144
    s_mov_b32 s58, 393216
    s_sub_u32 s34, s2, 80
    s_cmp_lt_u32 s34, 160
    s_cselect_b32 s54, 1, 0
    s_and_b32 s34, s2, 3
    s_cselect_b32 s54, 0, s54
    v_mov_b32 v180, 0
    v_mov_b32 v181, 0
    v_mov_b32 v182, 0
    v_mov_b32 v183, 0
    v_mov_b32 v184, 0
    v_mov_b32 v185, 0
    v_mov_b32 v186, 0
    v_mov_b32 v187, 0
    v_mov_b32 v22, 99072
    s_mov_b32 s35, 0
L_poll12:
    ds_read_b32 v23, v22
    s_add_u32 s35, s35, 1
    s_waitcnt lgkmcnt(0)
    v_cmp_gt_u32 vcc, 19, v23
    s_cbranch_vccz L_done13
    s_sleep 2
    s_cmp_lt_u32 s35, 60000
    s_cbranch_scc1 L_poll12
L_done13:
    s_mov_b32 s35, 0
L_poll15:
    buffer_load_dwordx4 v[32:35], v19, s[44:47], 0 offen offset:0 sc1
    buffer_load_dwordx4 v[36:39], v19, s[44:47], s48 offen offset:0 sc1
    buffer_load_dwordx4 v[40:43], v19, s[44:47], 0 offen offset:256 sc1
    buffer_load_dwordx4 v[44:47], v19, s[44:47], s48 offen offset:256 sc1
    buffer_load_dwordx4 v[48:51], v19, s[44:47], 0 offen offset:512 sc1
    buffer_load_dwordx4 v[52:55], v19, s[44:47], s48 offen offset:512 sc1
    buffer_load_dwordx4 v[56:59], v19, s[44:47], 0 offen offset:768 sc1
    buffer_load_dwordx4 v[60:63], v19, s[44:47], s48 offen offset:768 sc1
    buffer_load_dwordx4 v[64:67], v19, s[44:47], 0 offen offset:1024 sc1
    buffer_load_dwordx4 v[68:71], v19, s[44:47], s48 offen offset:1024 sc1
    s_cmp_eq_u32 s54, 0
    s_cbranch_scc1 L_hskip
    buffer_load_dwordx2 v[180:181], v199, s[44:47], 0 offen sc1
    buffer_load_dwordx2 v[182:183], v199, s[44:47], s56 offen sc1
    buffer_load_dwordx2 v[184:185], v199, s[44:47], s57 offen sc1
    buffer_load_dwordx2 v[186:187], v199, s[44:47], s58 offen sc1
L_hskip:
    s_add_u32 s35, s35, 1
    s_waitcnt vmcnt(0)
    v_max3_u32 v20, v32, v33, v34
    v_max3_u32 v20, v20, v35, v36
    v_max3_u32 v20, v20, v37, v38
    v_max3_u32 v20, v20, v39, v40
    v_max3_u32 v20, v20, v41, v42
    v_max3_u32 v20, v20, v43, v44
    v_max3_u32 v20, v20, v45, v46
    v_max3_u32 v20, v20, v47, v48
    v_max3_u32 v20, v20, v49, v50
    v_max3_u32 v20, v20, v51, v52
    v_max3_u32 v20, v20, v53, v54
    v_max3_u32 v20, v20, v55, v56
    v_max3_u32 v20, v20, v57, v58
    v_max3_u32 v20, v20, v59, v60
    v_max3_u32 v20, v20, v61, v62
    v_max3_u32 v20, v20, v63, v64
    v_max3_u32 v20, v20, v65, v66
    v_max3_u32 v20, v20, v67, v68
    v_max3_u32 v20, v20, v69, v70
    v_max3_u32 v20, v20, v71, v180
    v_max3_u32 v20, v20, v181, v182
    v_max3_u32 v20, v20, v183, v184
    v_max3_u32 v20, v20, v185, v186
    v_max_u32 v20, v20, v187
    v_cmp_eq_u32 vcc, -1, v20
    s_cbranch_vccz L_done16
    s_sleep 16
    s_cmp_lt_u32 s35, 60000
    s_cbranch_scc1 L_poll15
L_done16:
    v_mfma_f32_16x16x32_bf16 v[80:83], v[96:99], v[32:35], 0
    v_mfma_f32_16x16x32_bf16 v[84:87], v[100:103], v[32:35], 0
    v_mfma_f32_16x16x32_bf16 v[88:91], v[104:107], v[32:35], 0
    v_mfma_f32_16x16x32_bf16 v[92:95], v[108:111], v[32:35], 0
    v_mfma_f32_16x16x32_bf16 v[80:83], v[96:99], v[36:39], v[80:83]
    v_mfma_f32_16x16x32_bf16 v[84:87], v[100:103], v[36:39], v[84:87]
    v_mfma_f32_16x16x32_bf16 v[88:91], v[104:107], v[36:39], v[88:91]
    v_mfma_f32_16x16x32_bf16 v[92:95], v[108:111], v[36:39], v[92:95]
    v_mfma_f32_16x16x32_bf16 v[80:83], v[112:115], v[40:43], v[80:83]
    v_mfma_f32_16x16x32_bf16 v[84:87], v[116:119], v[40:43], v[84:87]
    v_mfma_f32_16x16x32_bf16 v[88:91], v[120:123], v[40:43], v[88:91]
    v_mfma_f32_16x16x32_bf16 v[92:95], v[124:127], v[40:43], v[92:95]
    v_mfma_f32_16x16x32_bf16 v[80:83], v[112:115], v[44:47], v[80:83]
    v_mfma_f32_16x16x32_bf16 v[84:87], v[116:119], v[44:47], v[84:87]
    v_mfma_f32_16x16x32_bf16 v[88:91], v[120:123], v[44:47], v[88:91]
    v_mfma_f32_16x16x32_bf16 v[92:95], v[124:127], v[44:47], v[92:95]
    v_mfma_f32_16x16x32_bf16 v[80:83], v[128:131], v[48:51], v[80:83]
    v_mfma_f32_16x16x32_bf16 v[84:87], v[132:135], v[48:51], v[84:87]
    v_mfma_f32_16x16x32_bf16 v[88:91], v[136:139], v[48:51], v[88:91]
    v_mfma_f32_16x16x32_bf16 v[92:95], v[140:143], v[48:51], v[92:95]
    v_mfma_f32_16x16x32_bf16 v[80:83], v[128:131], v[52:55], v[80:83]
    v_mfma_f32_16x16x32_bf16 v[84:87], v[132:135], v[52:55], v[84:87]
    v_mfma_f32_16x16x32_bf16 v[88:91], v[136:139], v[52:55], v[88:91]
    v_mfma_f32_16x16x32_bf16 v[92:95], v[140:143], v[52:55], v[92:95]
    v_mfma_f32_16x16x32_bf16 v[80:83], v[144:147], v[56:59], v[80:83]
    v_mfma_f32_16x16x32_bf16 v[84:87], v[148:151], v[56:59], v[84:87]
    v_mfma_f32_16x16x32_bf16 v[88:91], v[152:155], v[56:59], v[88:91]
    v_mfma_f32_16x16x32_bf16 v[92:95], v[156:159], v[56:59], v[92:95]
    v_mfma_f32_16x16x32_bf16 v[80:83], v[144:147], v[60:63], v[80:83]
    v_mfma_f32_16x16x32_bf16 v[84:87], v[148:151], v[60:63], v[84:87]
    v_mfma_f32_16x16x32_bf16 v[88:91], v[152:155], v[60:63], v[88:91]
    v_mfma_f32_16x16x32_bf16 v[92:95], v[156:159], v[60:63], v[92:95]
    v_mfma_f32_16x16x32_bf16 v[80:83], v[160:163], v[64:67], v[80:83]
    v_mfma_f32_16x16x32_bf16 v[84:87], v[164:167], v[64:67], v[84:87]
    v_mfma_f32_16x16x32_bf16 v[88:91], v[168:171], v[64:67], v[88:91]
    v_mfma_f32_16x16x32_bf16 v[92:95], v[172:175], v[64:67], v[92:95]
    v_mfma_f32_16x16x32_bf16 v[80:83], v[160:163], v[68:71], v[80:83]
    v_mfma_f32_16x16x32_bf16 v[84:87], v[164:167], v[68:71], v[84:87]
    v_mfma_f32_16x16x32_bf16 v[88:91], v[168:171], v[68:71], v[88:91]
    v_mfma_f32_16x16x32_bf16 v[92:95], v[172:175], v[68:71], v[92:95]
    s_lshl_b32 s34, s53, 17
    s_lshl_b32 s35, s49, 2
    s_add_u32 s34, s34, s35
    s_add_u32 s34, s34, 32768
    v_lshlrev_b32 v19, 7, v12
    v_lshl_add_u32 v19, v13, 5, v19
    v_lshl_add_u32 v19, v14, 3, v19
    v_add_u32 v19, s34, v19
    v_add_f32_dpp v20, v80, v80 row_ror:8 row_mask:0xf bank_mask:0x3
    v_add_f32_dpp v24, v84, v84 row_ror:8 row_mask:0xf bank_mask:0x3
    v_add_f32_dpp v21, v81, v81 row_ror:8 row_mask:0xf bank_mask:0x3
    v_add_f32_dpp v25, v85, v85 row_ror:8 row_mask:0xf bank_mask:0x3
    v_add_f32_dpp v22, v82, v82 row_ror:8 row_mask:0xf bank_mask:0x3
    v_add_f32_dpp v26, v86, v86 row_ror:8 row_mask:0xf bank_mask:0x3
    v_add_f32_dpp v23, v83, v83 row_ror:8 row_mask:0xf bank_mask:0x3
    v_add_f32_dpp v27, v87, v87 row_ror:8 row_mask:0xf bank_mask:0x3
    v_add_f32_dpp v20, v88, v88 row_ror:8 row_mask:0xf bank_mask:0xc
    v_add_f32_dpp v24, v92, v92 row_ror:8 row_mask:0xf bank_mask:0xc
    v_add_f32_dpp v21, v89, v89 row_ror:8 row_mask:0xf bank_mask:0xc
    v_add_f32_dpp v25, v93, v93 row_ror:8 row_mask:0xf bank_mask:0xc
    v_add_f32_dpp v22, v90, v90 row_ror:8 row_mask:0xf bank_mask:0xc
    v_add_f32_dpp v26, v94, v94 row_ror:8 row_mask:0xf bank_mask:0xc
    v_add_f32_dpp v23, v91, v91 row_ror:8 row_mask:0xf bank_mask:0xc
    v_add_f32_dpp v27, v95, v95 row_ror:8 row_mask:0xf bank_mask:0xc
    v_add_f32_dpp v28, v20, v20 row_shl:4 row_mask:0xf bank_mask:0x5
    v_add_f32_dpp v29, v21, v21 row_shl:4 row_mask:0xf bank_mask:0x5
    v_add_f32_dpp v30, v22, v22 row_shl:4 row_mask:0xf bank_mask:0x5
    v_add_f32_dpp v31, v23, v23 row_shl:4 row_mask:0xf bank_mask:0x5
    v_add_f32_dpp v28, v24, v24 row_shr:4 row_mask:0xf bank_mask:0xa
    v_add_f32_dpp v29, v25, v25 row_shr:4 row_mask:0xf bank_mask:0xa
    v_add_f32_dpp v30, v26, v26 row_shr:4 row_mask:0xf bank_mask:0xa
    v_add_f32_dpp v31, v27, v27 row_shr:4 row_mask:0xf bank_mask:0xa
    v_cvt_pk_bf16_f32 v20, v28, v29
    v_cvt_pk_bf16_f32 v21, v30, v31
    v_min_u32 v20, -2, v20
    v_min_u32 v21, -2, v21
    buffer_store_dwordx2 v[20:21], v19, s[44:47], 0 offen sc1
    s_cmp_eq_u32 s54, 0
    s_cbranch_scc1 L_nomf
    v_lshlrev_b32 v24, 16, v180
    v_and_b32 v25, 0xffff0000, v180
    v_lshlrev_b32 v26, 16, v181
    v_and_b32 v27, 0xffff0000, v181
    v_lshlrev_b32 v28, 16, v182
    v_and_b32 v29, 0xffff0000, v182
    v_lshlrev_b32 v30, 16, v183
    v_and_b32 v31, 0xffff0000, v183
    v_add_f32 v24, v24, v28
    v_add_f32 v25, v25, v29
    v_add_f32 v26, v26, v30
    v_add_f32 v27, v27, v31
    v_lshlrev_b32 v28, 16, v184
    v_and_b32 v29, 0xffff0000, v184
    v_lshlrev_b32 v30, 16, v185
    v_and_b32 v31, 0xffff0000, v185
    v_add_f32 v24, v24, v28
    v_add_f32 v25, v25, v29
    v_add_f32 v26, v26, v30
    v_add_f32 v27, v27, v31
    v_lshlrev_b32 v28, 16, v186
    v_and_b32 v29, 0xffff0000, v186
    v_lshlrev_b32 v30, 16, v187
    v_and_b32 v31, 0xffff0000, v187
    v_add_f32 v24, v24, v28
    v_add_f32 v25, v25, v29
    v_add_f32 v26, v26, v30
    v_add_f32 v27, v27, v31
    v_cvt_pk_bf16_f32 v22, v24, v25
    v_cvt_pk_bf16_f32 v23, v26, v27
    v_min_u32 v22, -2, v22
    v_min_u32 v23, -2, v23
    s_sub_u32 s34, s50, 20
    s_lshl_b32 s35, s34, 9
    v_subrev_u32 v199, s35, v199
    s_lshr_b32 s35, s34, 2
    s_lshl_b32 s35, s35, 9
    s_and_b32 s34, s34, 3
    s_lshl_b32 s34, s34, 17
    s_add_u32 s34, s34, s35
    s_add_u32 s34, s34, 55296
    v_add_u32 v199, s34, v199
    buffer_store_dwordx2 v[22:23], v199, s[44:47], 0 offen sc1
L_nomf:
    s_and_b32 s34, s2, 127
    s_lshl_b32 s34, s34, 21
    s_lshr_b32 s35, s2, 7
    s_lshl_b32 s35, s35, 18
    s_add_u32 s34, s34, s35
    s_add_u32 s34, s34, 1572864
    s_mov_b32 s38, 0x40000
    s_mov_b32 s42, 0x40000
    s_waitcnt lgkmcnt(0)
    s_add_u32 s36, s6, s34
    s_addc_u32 s37, s7, 0
    s_add_u32 s40, s8, s34
    s_addc_u32 s41, s9, 0
    v_lshlrev_b32 v18, 4, v0
    s_mov_b32 s34, 258048
    buffer_load_dwordx4 v[128:131], v18, s[36:39], s34 offen offset:0 nt
    buffer_load_dwordx4 v[132:135], v18, s[36:39], s34 offen offset:1024 nt
    buffer_load_dwordx4 v[136:139], v18, s[36:39], s34 offen offset:2048 nt
    buffer_load_dwordx4 v[140:143], v18, s[36:39], s34 offen offset:3072 nt
    buffer_load_dwordx4 v[144:147], v18, s[40:43], s34 offen offset:0 nt
    buffer_load_dwordx4 v[148:151], v18, s[40:43], s34 offen offset:1024 nt
    buffer_load_dwordx4 v[152:155], v18, s[40:43], s34 offen offset:2048 nt
    buffer_load_dwordx4 v[156:159], v18, s[40:43], s34 offen offset:3072 nt
    s_and_b32 s34, s2, 31
    s_lshl_b32 s34, s34, 10
    s_lshl_b32 s35, s53, 7
    s_add_u32 s34, s34, s35
    s_add_u32 s34, s34, 32768
    v_lshrrev_b32 v19, 5, v0
    v_mul_u32_u24 v19, 384, v19
    v_lshl_add_u32 v19, v0, 2, v19
    v_add_u32 v19, s34, v19
    v_mov_b32 v22, 99072
    s_mov_b32 s35, 0
L_poll18:
    ds_read_b32 v23, v22
    s_add_u32 s35, s35, 1
    s_waitcnt lgkmcnt(0)
    v_cmp_gt_u32 vcc, 31, v23
    s_cbranch_vccz L_done19
    s_sleep 2
    s_cmp_lt_u32 s35, 60000
    s_cbranch_scc1 L_poll18
L_done19:
    s_mov_b32 s35, 0
L_poll21:
    buffer_load_dword v32, v19, s[44:47], 0 offen sc1
    buffer_load_dword v33, v19, s[44:47], s56 offen sc1
    buffer_load_dword v34, v19, s[44:47], s57 offen sc1
    buffer_load_dword v35, v19, s[44:47], s58 offen sc1
    s_add_u32 s35, s35, 1
    s_waitcnt vmcnt(0)
    v_max3_u32 v22, v32, v33, v34
    v_max_u32 v22, v22, v35
    v_cmp_eq_u32 vcc, -1, v22
    s_cbranch_vccz L_done22
    s_sleep 16
    s_cmp_lt_u32 s35, 60000
    s_cbranch_scc1 L_poll21
L_done22:
    v_lshlrev_b32 v36, 16, v32
    v_and_b32 v37, 0xffff0000, v32
    v_lshlrev_b32 v38, 16, v33
    v_and_b32 v39, 0xffff0000, v33
    v_lshlrev_b32 v40, 16, v34
    v_and_b32 v41, 0xffff0000, v34
    v_lshlrev_b32 v42, 16, v35
    v_and_b32 v43, 0xffff0000, v35
    v_pk_add_f32 v[36:37], v[36:37], v[38:39]
    v_pk_add_f32 v[40:41], v[40:41], v[42:43]
    v_pk_add_f32 v[36:37], v[36:37], v[40:41]
    v_cvt_pk_bf16_f32 v32, v36, v37
    v_min_u32 v32, -2, v32
    ds_write_b32 v1, v32
    v_and_b32 v2, 15, v0
    v_lshlrev_b32 v2, 4, v2
    v_add_u32 v2, 98304, v2
    ds_read_b128 v[4:7], v2
    s_waitcnt lgkmcnt(0)
    v_dot2_f32_bf16 v8, v128, v4, 0
    v_dot2_f32_bf16 v9, v132, v4, 0
    v_dot2_f32_bf16 v10, v136, v4, 0
    v_dot2_f32_bf16 v11, v140, v4, 0
    v_dot2c_f32_bf16 v8, v129, v5
    v_dot2c_f32_bf16 v9, v133, v5
    v_dot2c_f32_bf16 v10, v137, v5
    v_dot2c_f32_bf16 v11, v141, v5
    v_dot2c_f32_bf16 v8, v130, v6
    v_dot2c_f32_bf16 v9, v134, v6
    v_dot2c_f32_bf16 v10, v138, v6
    v_dot2c_f32_bf16 v11, v142, v6
    v_dot2c_f32_bf16 v8, v131, v7
    v_dot2c_f32_bf16 v9, v135, v7
    v_dot2c_f32_bf16 v10, v139, v7
    v_dot2c_f32_bf16 v11, v143, v7
    v_add_f32_dpp v16, v8, v8 row_ror:8 row_mask:0xf bank_mask:0x3
    v_add_f32_dpp v16, v9, v9 row_ror:8 row_mask:0xf bank_mask:0xc
    v_add_f32_dpp v17, v10, v10 row_ror:8 row_mask:0xf bank_mask:0x3
    v_add_f32_dpp v17, v11, v11 row_ror:8 row_mask:0xf bank_mask:0xc
    v_add_f32_dpp v16, v16, v16 row_half_mirror row_mask:0xf bank_mask:0xf
    s_nop 0
    v_add_f32_dpp v17, v17, v17 row_half_mirror row_mask:0xf bank_mask:0xf
    v_add_f32_dpp v16, v16, v16 quad_perm:[1,0,3,2] row_mask:0xf bank_mask:0xf
    s_nop 0
    v_add_f32_dpp v17, v17, v17 quad_perm:[1,0,3,2] row_mask:0xf bank_mask:0xf
    v_add_f32_dpp v16, v16, v16 quad_perm:[2,3,0,1] row_mask:0xf bank_mask:0xf
    s_nop 0
    v_add_f32_dpp v17, v17, v17 quad_perm:[2,3,0,1] row_mask:0xf bank_mask:0xf
    v_max_f32 v8, v16, v17
    s_mov_b32 s34, 0x3e0293ee
    s_nop 0
    v_max_f32_dpp v8, v8, v8 row_ror:8 row_mask:0xf bank_mask:0xf
    v_mov_b32 v9, v8
    s_nop 1
    v_permlane16_swap_b32 v8, v9
    v_max_f32 v8, v8, v9
    v_mov_b32 v9, v8
    s_nop 1
    v_permlane32_swap_b32 v8, v9
    v_max_f32 v8, v8, v9
    v_mul_f32 v8, s34, v8
    v_fma_f32 v16, v16, s34, -v8
    v_fma_f32 v17, v17, s34, -v8
    v_exp_f32 v16, v16
    v_exp_f32 v17, v17
    s_nop 0
    v_add_f32 v9, v16, v17
    v_and_b32 v10, 1, v0
    v_lshlrev_b32 v10, 4, v10
    v_mov_b32 v11, 0xffff
    v_lshlrev_b32 v10, v10, v11
    v_bfe_u32 v11, v0, 1, 2
    v_cmp_eq_u32 vcc, 0, v11
    s_nop 1
    v_cndmask_b32 v20, 0, v10, vcc
    v_cmp_eq_u32 vcc, 1, v11
    s_nop 1
    v_cndmask_b32 v21, 0, v10, vcc
    v_cmp_eq_u32 vcc, 2, v11
    s_nop 1
    v_cndmask_b32 v22, 0, v10, vcc
    v_cmp_eq_u32 vcc, 3, v11
    s_nop 1
    v_cndmask_b32 v23, 0, v10, vcc
    v_add_f32_dpp v9, v9, v9 row_ror:8 row_mask:0xf bank_mask:0xf
    v_mov_b32 v10, v9
    s_nop 1
    v_permlane16_swap_b32 v9, v10
    v_add_f32 v9, v9, v10
    v_mov_b32 v10, v9
    s_nop 1
    v_permlane32_swap_b32 v9, v10
    v_add_f32 v9, v9, v10
    v_mov_b32 v10, 98616
    s_mov_b64 exec, 1
    ds_write_b64 v10, v[8:9]
    s_mov_b64 exec, -1
    v_cvt_pk_bf16_f32 v10, v16, v16
    v_and_b32 v24, v10, v20
    v_and_b32 v25, v10, v21
    v_and_b32 v26, v10, v22
    v_and_b32 v27, v10, v23
    s_nop 1
    v_mfma_f32_16x16x32_bf16 v[116:119], v[144:147], v[24:27], 0
    v_mfma_f32_16x16x32_bf16 v[120:123], v[148:151], v[24:27], 0
    v_cvt_pk_bf16_f32 v10, v17, v17
    v_and_b32 v28, v10, v20
    v_and_b32 v29, v10, v21
    v_and_b32 v30, v10, v22
    v_and_b32 v31, v10, v23
    s_nop 1
    v_mfma_f32_16x16x32_bf16 v[116:119], v[152:155], v[28:31], v[116:119]
    v_mfma_f32_16x16x32_bf16 v[120:123], v[156:159], v[28:31], v[120:123]
    s_nop 7
    v_mov_b32_dpp v116, v120 quad_perm:[0,1,2,3] row_mask:0xf bank_mask:0xc
    v_mov_b32_dpp v117, v121 quad_perm:[0,1,2,3] row_mask:0xf bank_mask:0xc
    v_mov_b32_dpp v118, v122 quad_perm:[0,1,2,3] row_mask:0xf bank_mask:0xc
    v_mov_b32_dpp v119, v123 quad_perm:[0,1,2,3] row_mask:0xf bank_mask:0xc
    s_mov_b32 s63, 0
    s_mov_b32 s62, s61
    s_cmp_lt_u32 s61, 20
    s_cbranch_scc1 L_rd24
    s_mul_i32 s62, s60, 12
    s_add_u32 s62, s62, s61
    s_sub_u32 s62, s62, 20
    s_mov_b32 s63, 1
    s_cmp_lt_u32 s62, 54
    s_cbranch_scc1 L_rd24
    s_cmp_lt_u32 s62, 56
    s_cselect_b32 s63, 3, 2
    s_sub_u32 s62, s62, 56
L_rd24:
    v_and_b32 v8, 3, v0
    v_bfe_u32 v9, v0, 2, 2
    v_lshrrev_b32 v10, 4, v0
    s_mov_b32 s55, 0x20000
    s_lshl_b32 s35, s62, 6
    s_and_b32 s49, s62, 1
    s_cmp_eq_u32 s63, 0
    s_cbranch_scc1 L_dp26
    s_cmp_eq_u32 s63, 1
    s_cbranch_scc1 L_dp27
    s_mov_b32 s52, s20
    s_mov_b32 s53, s21
    s_mov_b32 s54, 2211840
    v_mov_b32 v15, 0
    s_branch L_dp28
L_dp27:
    s_mov_b32 s52, s16
    s_mov_b32 s53, s17
    s_mov_b32 s54, 2211840
    v_lshl_add_u32 v15, v9, 3, v10
    v_mul_u32_u24 v15, 3456, v15
    v_lshl_add_u32 v15, v8, 4, v15
    v_add_u32 v15, s35, v15
    s_bfe_u32 s50, s3, 0x10001
    s_lshl_b32 s50, s50, 7
    s_and_b32 s34, s3, 1
    s_lshl_b32 s34, s34, 2
    s_add_u32 s50, s50, s34
    s_and_b32 s51, s3, 3
    s_lshl_b32 s51, s51, 5
    s_add_u32 s51, s51, 512
    s_mul_i32 s50, s50, 3456
    s_mul_i32 s51, s51, 3456
    s_branch L_dp28
L_dp26:
    s_mov_b32 s52, s12
    s_mov_b32 s53, s13
    s_mov_b32 s54, 5242880
    s_lshr_b32 s50, s3, 1
    s_lshl_b32 s50, s50, 3
    s_add_u32 s50, s50, s60
    s_and_b32 s51, s3, 1
    s_lshl_b32 s34, s50, 1
    s_add_u32 s34, s34, s51
    s_mul_i32 s34, s34, 81920
    s_add_u32 s34, s34, s35
    v_lshl_add_u32 v15, v9, 2, v10
    v_mul_u32_u24 v15, 2560, v15
    v_lshl_add_u32 v15, v8, 4, v15
    v_add_u32 v15, s34, v15
    s_lshl_b32 s56, s3, 12
    s_lshl_b32 s34, s49, 11
    s_add_u32 s56, s56, s34
    s_add_u32 s56, s56, 40960
    s_add_u32 s58, s56, 1024
    s_mul_i32 s57, s49, 40960
    s_add_u32 s59, s57, 1280
L_dp28:
    v_and_b32 v200, 3, v0
    v_bfe_u32 v201, v0, 2, 2
    v_lshrrev_b32 v202, 4, v0
    s_lshl_b32 s34, s3, 10
    s_add_u32 s34, s34, 122112
    v_lshl_add_u32 v203, v0, 4, s34
    s_movk_i32 s48, 5120
    v_mov_b32 v197, 0
    s_mov_b32 s40, 0
    s_mov_b32 s41, 0
    s_mov_b32 s42, 0
    s_cmp_eq_u32 s63, 0
    s_cbranch_scc1 L_d_wo
    s_cmp_eq_u32 s63, 2
    s_cbranch_scc1 L_d_w2
    s_cmp_eq_u32 s63, 3
    s_cbranch_scc1 L_d_none
    v_and_b32 v205, 15, v0
    v_lshlrev_b32 v205, 4, v205
    s_and_b32 s49, s3, 3
    s_mul_i32 s34, s49, 1280
    s_add_u32 s34, s34, 70656
    v_lshl_add_u32 v206, v202, 17, v205
    v_add_u32 v206, s34, v206
    s_mul_i32 s34, s49, 3840
    v_add_u32 v205, s34, v205
    s_lshl_b32 s34, s62, 6
    v_lshlrev_b32 v5, 4, v14
    v_lshl_add_u32 v5, v12, 2, v5
    v_add_u32 v5, s34, v5
    global_load_dword v6, v5, s[18:19]
    v_and_b32 v7, 15, v0
    v_lshlrev_b32 v7, 4, v7
    v_mul_u32_u24 v8, 1280, v14
    v_add_u32 v8, v8, v7
    v_bfe_u32 v9, v0, 3, 1
    v_lshlrev_b32 v9, 17, v9
    v_lshl_add_u32 v9, v14, 7, v9
    v_and_b32 v10, 7, v0
    v_lshl_add_u32 v9, v10, 4, v9
    v_add_u32 v9, 65536, v9
    s_mov_b32 s57, 262144
    v_mul_u32_u24 v5, 3840, v14
    v_add_u32 v5, v5, v7
    global_load_dwordx4 v[32:35], v8, s[4:5] offset:0
    global_load_dwordx4 v[36:39], v8, s[4:5] offset:256
    global_load_dwordx4 v[40:43], v8, s[4:5] offset:512
    global_load_dwordx4 v[44:47], v8, s[4:5] offset:768
    global_load_dwordx4 v[48:51], v8, s[4:5] offset:1024
    s_mov_b32 s35, 0
L_poll29:
    buffer_load_dwordx4 v[52:55], v9, s[44:47], s57 offen offset:1024 sc1
    buffer_load_dwordx4 v[56:59], v9, s[44:47], 0 offen offset:1536 sc1
    buffer_load_dwordx4 v[60:63], v9, s[44:47], s57 offen offset:1536 sc1
    buffer_load_dwordx4 v[64:67], v9, s[44:47], 0 offen offset:2048 sc1
    buffer_load_dwordx4 v[68:71], v9, s[44:47], s57 offen offset:2048 sc1
    buffer_load_dwordx4 v[72:75], v9, s[44:47], 0 offen offset:2560 sc1
    buffer_load_dwordx4 v[76:79], v9, s[44:47], s57 offen offset:2560 sc1
    buffer_load_dwordx4 v[80:83], v9, s[44:47], 0 offen offset:3072 sc1
    buffer_load_dwordx4 v[84:87], v9, s[44:47], s57 offen offset:3072 sc1
    buffer_load_dwordx4 v[88:91], v9, s[44:47], 0 offen offset:3584 sc1
    s_add_u32 s35, s35, 1
    s_waitcnt vmcnt(0)
    v_max3_u32 v28, v52, v53, v54
    v_max3_u32 v28, v28, v55, v56
    v_max3_u32 v28, v28, v57, v58
    v_max3_u32 v28, v28, v59, v60
    v_max3_u32 v28, v28, v61, v62
    v_max3_u32 v28, v28, v63, v64
    v_max3_u32 v28, v28, v65, v66
    v_max3_u32 v28, v28, v67, v68
    v_max3_u32 v28, v28, v69, v70
    v_max3_u32 v28, v28, v71, v72
    v_max3_u32 v28, v28, v73, v74
    v_max3_u32 v28, v28, v75, v76
    v_max3_u32 v28, v28, v77, v78
    v_max3_u32 v28, v28, v79, v80
    v_max3_u32 v28, v28, v81, v82
    v_max3_u32 v28, v28, v83, v84
    v_max3_u32 v28, v28, v85, v86
    v_max3_u32 v28, v28, v87, v88
    v_max3_u32 v28, v28, v89, v90
    v_max_u32 v28, v28, v91
    v_cmp_eq_u32 vcc, -1, v28
    s_cbranch_vccz L_done30
    s_sleep 16
    s_cmp_lt_u32 s35, 60000
    s_cbranch_scc1 L_poll29
L_done30:
    ds_write_b128 v5, v[32:35] offset:0
    ds_write_b128 v5, v[36:39] offset:256
    ds_write_b128 v5, v[40:43] offset:512
    ds_write_b128 v5, v[44:47] offset:768
    ds_write_b128 v5, v[48:51] offset:1024
    ds_write_b128 v5, v[52:55] offset:1280
    ds_write_b128 v5, v[56:59] offset:1536
    ds_write_b128 v5, v[60:63] offset:1792
    ds_write_b128 v5, v[64:67] offset:2048
    ds_write_b128 v5, v[68:71] offset:2304
    ds_write_b128 v5, v[72:75] offset:2560
    ds_write_b128 v5, v[76:79] offset:2816
    ds_write_b128 v5, v[80:83] offset:3072
    ds_write_b128 v5, v[84:87] offset:3328
    ds_write_b128 v5, v[88:91] offset:3584
    s_waitcnt lgkmcnt(0)
    v_lshlrev_b32 v100, 16, v6
    v_and_b32 v101, 0xffff0000, v6
    s_cmp_eq_u32 s60, 4
    s_cselect_b32 s40, 6, 12
    s_mov_b32 s41, 5462
    s_cmov_b32 s41, 10923
    s_cselect_b32 s34, 20, 20
    s_mov_b32 s49, 17280
    s_cmov_b32 s49, 34560
    v_min_u32 v196, 59, v0
    v_mul_u32_u24 v197, s41, v196
    v_lshrrev_b32 v197, 16, v197
    v_mul_u32_u24 v194, s40, v197
    v_sub_u32 v196, v196, v194
    v_mul_u32_u24 v197, 3456, v197
    v_lshl_add_u32 v197, v196, 6, v197
    s_mul_i32 s35, s60, 768
    s_add_i32 s35, s35, 0
    s_cmp_eq_u32 s60, 4
    s_cselect_b32 s35, 3072, s35
    s_sub_u32 s34, s61, s34
    s_mul_i32 s34, s34, s49
    s_mul_i32 s34, s34, 11
    s_add_u32 s34, s34, s35
    v_add_u32 v197, s34, v197
    s_mov_b32 s40, s49
    s_mov_b32 s41, s49
    s_branch L_d_none
L_d_w2:
    s_lshl_b32 s34, s62, 5
    v_lshl_add_u32 v3, v14, 3, s34
    global_load_dwordx2 v[20:21], v3, s[22:23]
    v_mul_u32_u24 v112, 1280, v12
    v_add_u32 v112, v112, v3
    global_load_dwordx2 v[22:23], v112, s[4:5]
    s_lshr_b32 s34, s62, 2
    s_add_u32 s34, s34, 30
    s_lshr_b32 s35, s34, 2
    s_lshl_b32 s35, s35, 9
    s_and_b32 s34, s34, 3
    s_lshl_b32 s34, s34, 17
    s_add_u32 s34, s34, s35
    s_and_b32 s35, s62, 3
    s_mul_i32 s35, s35, 32
    s_add_u32 s34, s34, s35
    s_add_u32 s34, s34, 65536
    v_lshlrev_b32 v5, 7, v12
    v_lshl_add_u32 v5, v14, 3, v5
    v_add_u32 v5, s34, v5
    s_waitcnt vmcnt(0)
    v_lshlrev_b32 v32, 16, v20
    v_and_b32 v33, 0xffff0000, v20
    v_lshlrev_b32 v34, 16, v21
    v_and_b32 v35, 0xffff0000, v21
    v_lshlrev_b32 v108, 16, v22
    v_and_b32 v109, 0xffff0000, v22
    v_lshlrev_b32 v110, 16, v23
    v_and_b32 v111, 0xffff0000, v23
    s_mov_b32 s35, 0
L_poll32:
    buffer_load_dwordx2 v[24:25], v5, s[44:47], 0 offen sc1
    s_add_u32 s35, s35, 1
    s_waitcnt vmcnt(0)
    v_max_u32 v28, v24, v25
    v_cmp_eq_u32 vcc, -1, v28
    s_cbranch_vccz L_done33
    s_sleep 16
    s_cmp_lt_u32 s35, 60000
    s_cbranch_scc1 L_poll32
L_done33:
    v_lshlrev_b32 v104, 16, v24
    v_and_b32 v105, 0xffff0000, v24
    v_lshlrev_b32 v106, 16, v25
    v_and_b32 v107, 0xffff0000, v25
    v_fma_f32 v108, v104, v32, v108
    v_fma_f32 v109, v105, v33, v109
    v_fma_f32 v110, v106, v34, v110
    v_fma_f32 v111, v107, v35, v111
    v_mul_f32 v108, 0x3e800000, v108
    v_mul_f32 v109, 0x3e800000, v109
    v_mul_f32 v110, 0x3e800000, v110
    v_mul_f32 v111, 0x3e800000, v111
    v_lshl_add_u32 v204, v13, 17, v112
    v_add_u32 v204, 70656, v204
    s_cmp_eq_u32 s60, 4
    s_cselect_b32 s40, 2, 6
    s_mov_b32 s41, 10923
    s_cmov_b32 s41, 32769
    s_cselect_b32 s34, 28, 20
    s_mov_b32 s49, 12800
    s_cmov_b32 s49, 38400
    v_min_u32 v196, 59, v0
    v_mul_u32_u24 v197, s41, v196
    v_lshrrev_b32 v197, 16, v197
    v_mul_u32_u24 v194, s40, v197
    v_sub_u32 v196, v196, v194
    v_mul_u32_u24 v197, 1280, v197
    v_lshl_add_u32 v197, v196, 6, v197
    s_mul_i32 s35, s60, 384
    s_add_i32 s35, s35, -1792
    s_cmp_eq_u32 s60, 4
    s_cselect_b32 s35, 0, s35
    s_sub_u32 s34, s61, s34
    s_mul_i32 s34, s34, s49
    s_mul_i32 s34, s34, 15
    s_add_u32 s34, s34, s35
    v_add_u32 v197, s34, v197
    s_mov_b32 s40, s49
    s_mov_b32 s41, s49
    s_branch L_d_none
L_d_wo:
    s_lshr_b32 s49, s3, 1
    s_lshl_b32 s49, s49, 17
    v_and_b32 v210, 7, v0
    s_lshl_b32 s34, s60, 12
    s_add_u32 s34, s34, s49
    s_add_u32 s34, s34, 98560
    v_lshrrev_b32 v211, 3, v0
    v_lshl_add_u32 v204, v211, 9, s34
    s_lshl_b32 s35, s51, 7
    s_add_u32 s34, s34, s35
    s_sub_u32 s34, s34, 256
    v_lshrrev_b32 v211, 3, v0
    v_lshlrev_b32 v205, 9, v211
    v_lshl_add_u32 v205, v210, 4, v205
    v_add_u32 v205, s34, v205
    s_lshl_b32 s34, s3, 12
    s_add_u32 s34, s34, 40960
    v_lshrrev_b32 v206, 2, v0
    v_lshlrev_b32 v206, 6, v206
    v_lshl_add_u32 v206, v200, 3, v206
    v_add_u32 v206, s34, v206
    s_mul_i32 s34, s3, 1152
    s_add_u32 s34, s34, 107520
    v_mul_u32_u24 v207, 144, v211
    v_lshl_add_u32 v207, v210, 4, v207
    v_add_u32 v207, s34, v207
    v_mul_u32_u24 v208, 144, v210
    v_lshl_add_u32 v208, v202, 4, v208
    v_add_u32 v208, s34, v208
    v_mul_u32_u24 v212, 144, v211
    v_add_u32 v212, s34, v212
    v_mul_u32_u24 v213, 144, v210
    v_add_u32 v213, s34, v213
    v_and_b32 v211, 1, v211
    v_lshl_add_u32 v203, v211, 6, v208
    v_add_u32 v203, 14592, v203
    v_mov_b32 v210, 98816
    v_cmp_eq_u32 vcc, 0, v211
    s_nop 1
    v_cndmask_b32 v209, v208, v210, vcc
    v_cndmask_b32 v208, v210, v208, vcc
    v_mov_b32 v6, v14
    v_and_b32 v8, 7, v0
    s_lshl_b32 s35, s62, 6
    v_lshl_add_u32 v8, v8, 3, s35
    s_lshr_b32 s34, s62, 1
    s_add_u32 s34, s34, 0
    s_lshr_b32 s35, s34, 2
    s_lshl_b32 s35, s35, 9
    s_and_b32 s34, s34, 3
    s_lshl_b32 s34, s34, 17
    s_add_u32 s34, s34, s35
    s_and_b32 s35, s62, 1
    s_mul_i32 s35, s35, 64
    s_add_u32 s34, s34, s35
    s_add_u32 s34, s34, 65536
    v_and_b32 v9, 7, v0
    v_lshlrev_b32 v9, 3, v9
    v_lshl_add_u32 v9, v6, 7, v9
    v_add_u32 v9, s34, v9
    s_lshr_b32 s34, s60, 2
    s_mul_i32 s34, s34, 5120
    s_and_b32 s35, s60, 3
    s_lshl_b32 s35, s35, 17
    s_add_u32 s34, s34, s35
    s_add_u32 s34, s34, 70656
    v_mul_u32_u24 v112, 1280, v6
    v_add3_u32 v112, v112, v8, s34
    v_bfe_u32 v7, v0, 3, 1
    v_lshl_add_u32 v112, v7, 30, v112
    s_mul_i32 s34, s62, 52
    s_lshr_b32 s34, s34, 8
    s_mul_i32 s35, s34, 5
    s_sub_u32 s35, s62, s35
    s_mul_i32 s34, s34, 1310720
    s_lshl_b32 s35, s35, 15
    s_add_u32 s34, s34, s35
    s_mul_i32 s35, s60, 163840
    s_add_u32 s34, s34, s35
    v_lshl_add_u32 v197, v0, 6, s34
    s_movk_i32 s40, 4096
    s_movk_i32 s41, 4096
    s_mov_b32 s35, 0
L_poll35:
    buffer_load_dwordx2 v[32:33], v9, s[44:47], 0 offen sc1
    s_add_u32 s35, s35, 1
    s_waitcnt vmcnt(0)
    v_max_u32 v22, v32, v33
    v_cmp_eq_u32 vcc, -1, v22
    s_cbranch_vccz L_done36
    s_sleep 16
    s_cmp_lt_u32 s35, 60000
    s_cbranch_scc1 L_poll35
L_done36:
    v_lshlrev_b32 v100, 16, v32
    v_and_b32 v101, 0xffff0000, v32
    v_lshlrev_b32 v102, 16, v33
    v_and_b32 v103, 0xffff0000, v33
L_d_none:
    v_and_b32 v19, 7, v0
    v_lshlrev_b32 v19, 3, v19
    v_add_u32 v19, 98560, v19
    s_mov_b32 s35, 0
L_poll38:
    ds_read_b64 v[20:21], v19
    s_add_u32 s35, s35, 1
    s_waitcnt lgkmcnt(0)
    v_max_u32 v22, v20, v21
    v_cmp_eq_u32 vcc, -1, v22
    s_cbranch_vccz L_done39
    s_sleep 2
    s_cmp_lt_u32 s35, 60000
    s_cbranch_scc1 L_poll38
L_done39:
    v_max_f32_dpp v22, v20, v20 row_half_mirror row_mask:0xf bank_mask:0xf
    s_nop 1
    v_max_f32_dpp v22, v22, v22 quad_perm:[1,0,3,2] row_mask:0xf bank_mask:0xf
    s_nop 1
    v_max_f32_dpp v22, v22, v22 quad_perm:[2,3,0,1] row_mask:0xf bank_mask:0xf
    v_sub_f32 v20, v20, v22
    v_exp_f32 v20, v20
    s_nop 0
    v_mul_f32 v21, v21, v20
    s_nop 1
    v_add_f32_dpp v21, v21, v21 row_half_mirror row_mask:0xf bank_mask:0xf
    s_nop 1
    v_add_f32_dpp v21, v21, v21 quad_perm:[1,0,3,2] row_mask:0xf bank_mask:0xf
    s_nop 1
    v_add_f32_dpp v21, v21, v21 quad_perm:[2,3,0,1] row_mask:0xf bank_mask:0xf
    v_rcp_f32 v23, v21
    v_log_f32 v21, v21
    v_mul_f32 v20, v20, v23
    v_add_f32 v21, v21, v22
    v_min_u32 v21, -2, v21
    v_readlane_b32 s88, v20, 0
    v_readlane_b32 s90, v20, 1
    v_readlane_b32 s92, v20, 2
    v_readlane_b32 s94, v20, 3
    v_readlane_b32 s96, v20, 4
    v_readlane_b32 s98, v20, 5
    v_readlane_b32 s100, v20, 6
    v_readlane_b32 s89, v20, 7
    s_and_b32 s95, s61, 3
    s_lshl_b32 s95, s95, 17
    s_bfe_u32 s35, s2, 0x20005
    s_lshl_b32 s35, s35, 1
    s_lshr_b32 s91, s2, 7
    s_add_u32 s35, s35, s91
    s_getreg_b32 s91, hwreg(HW_REG_XCC_ID, 0, 4)
    v_mov_b32 v24, v21
    v_mov_b32 v25, s91
    v_mul_f32 v20, s89, v116
    v_mul_f32 v21, s89, v117
    v_mul_f32 v22, s89, v118
    v_mul_f32 v23, s89, v119
    s_lshl_b32 s34, s60, 12
    s_lshl_b32 s35, s35, 9
    s_add_u32 s34, s34, s35
    s_add_u32 s34, s34, s95
    s_add_u32 s34, s34, 98304
    v_and_b32 v18, 7, v0
    v_lshl_add_u32 v18, v14, 3, v18
    v_bfe_u32 v19, v0, 3, 1
    v_lshl_add_u32 v18, v19, 5, v18
    v_lshl_add_u32 v26, v18, 3, s34
    v_lshlrev_b32 v19, 4, v0
    v_add_u32 v19, 99328, v19
    s_mov_b32 s36, s12
    s_mov_b32 s37, s13
    s_mov_b32 s38, 5242880
    s_and_b32 s34, s61, 24
    s_add_u32 s34, s34, s60
    s_mul_i32 s34, s34, 163840
    s_and_b32 s35, s61, 7
    s_mul_i32 s35, s35, 20480
    s_add_u32 s34, s34, s35
    v_lshl_add_u32 v195, v0, 6, s34
    s_mov_b32 s34, 0
    s_barrier
    buffer_load_dword v250, v195, s[36:39], s34 offen
    s_add_u32 s34, s34, 4096
    buffer_load_dword v250, v195, s[36:39], s34 offen
    s_add_u32 s34, s34, 4096
    buffer_load_dword v250, v195, s[36:39], s34 offen
    s_add_u32 s34, s34, 4096
    buffer_load_dword v250, v195, s[36:39], s34 offen
    s_add_u32 s34, s34, 4096
    buffer_load_dword v250, v195, s[36:39], s34 offen
    s_add_u32 s34, s34, 4096
L_nopf:
    s_cmp_eq_u32 s97, 0
    v_mov_b32 v27, -2
    s_barrier
    ds_read_b128 v[32:35], v19 offset:0
    ds_read_b128 v[36:39], v19 offset:1024
    ds_read_b128 v[40:43], v19 offset:2048
    ds_read_b128 v[44:47], v19 offset:3072
    ds_read_b128 v[48:51], v19 offset:4096
    ds_read_b128 v[52:55], v19 offset:5120
    ds_read_b128 v[56:59], v19 offset:6144
    s_waitcnt lgkmcnt(6)
    v_pk_fma_f32 v[20:21], v[32:33], s[88:89], v[20:21] op_sel_hi:[1,0,1]
    v_pk_fma_f32 v[22:23], v[34:35], s[88:89], v[22:23] op_sel_hi:[1,0,1]
    s_waitcnt lgkmcnt(5)
    v_pk_fma_f32 v[20:21], v[36:37], s[90:91], v[20:21] op_sel_hi:[1,0,1]
    v_pk_fma_f32 v[22:23], v[38:39], s[90:91], v[22:23] op_sel_hi:[1,0,1]
    s_waitcnt lgkmcnt(4)
    v_pk_fma_f32 v[20:21], v[40:41], s[92:93], v[20:21] op_sel_hi:[1,0,1]
    v_pk_fma_f32 v[22:23], v[42:43], s[92:93], v[22:23] op_sel_hi:[1,0,1]
    s_waitcnt lgkmcnt(3)
    v_pk_fma_f32 v[20:21], v[44:45], s[94:95], v[20:21] op_sel_hi:[1,0,1]
    v_pk_fma_f32 v[22:23], v[46:47], s[94:95], v[22:23] op_sel_hi:[1,0,1]
    s_waitcnt lgkmcnt(2)
    v_pk_fma_f32 v[20:21], v[48:49], s[96:97], v[20:21] op_sel_hi:[1,0,1]
    v_pk_fma_f32 v[22:23], v[50:51], s[96:97], v[22:23] op_sel_hi:[1,0,1]
    s_waitcnt lgkmcnt(1)
    v_pk_fma_f32 v[20:21], v[52:53], s[98:99], v[20:21] op_sel_hi:[1,0,1]
    v_pk_fma_f32 v[22:23], v[54:55], s[98:99], v[22:23] op_sel_hi:[1,0,1]
    s_waitcnt lgkmcnt(0)
    v_pk_fma_f32 v[20:21], v[56:57], s[100:101], v[20:21] op_sel_hi:[1,0,1]
    v_pk_fma_f32 v[22:23], v[58:59], s[100:101], v[22:23] op_sel_hi:[1,0,1]
    s_nop 0
    v_add_f32_dpp v20, v20, v20 row_ror:8 row_mask:0xf bank_mask:0xf
    v_add_f32_dpp v21, v21, v21 row_ror:8 row_mask:0xf bank_mask:0xf
    v_add_f32_dpp v22, v22, v22 row_ror:8 row_mask:0xf bank_mask:0xf
    v_add_f32_dpp v23, v23, v23 row_ror:8 row_mask:0xf bank_mask:0xf
    v_cvt_pk_bf16_f32 v28, v20, v21
    v_cvt_pk_bf16_f32 v29, v22, v23
    s_nop 0
    v_min_u32_dpp v24, v28, v27 quad_perm:[0,1,2,3] row_mask:0xf bank_mask:0x3
    v_min_u32_dpp v25, v29, v27 quad_perm:[0,1,2,3] row_mask:0xf bank_mask:0x3
    buffer_store_dwordx2 v[24:25], v26, s[44:47], 0 offen
    s_cbranch_scc1 L_ostd
    buffer_store_dwordx2 v[24:25], v26, s[44:47], 0 offen sc1
L_ostd:
    ds_write_b96 v19, v[24:26] offset:32000
    s_waitcnt lgkmcnt(0)
    s_cmp_lt_u32 s63, 1
    s_cbranch_scc1 L_nopf2
    buffer_load_dword v250, v197, s[52:55], s42 offen
    s_add_u32 s42, s42, s40
    buffer_load_dword v250, v197, s[52:55], s42 offen
    s_add_u32 s42, s42, s41
    buffer_load_dword v250, v197, s[52:55], s42 offen
    s_add_u32 s42, s42, s40
    buffer_load_dword v250, v197, s[52:55], s42 offen
    s_add_u32 s42, s42, s41
    buffer_load_dword v250, v197, s[52:55], s42 offen
    s_add_u32 s42, s42, s40
    buffer_load_dword v250, v197, s[52:55], s42 offen
    s_add_u32 s42, s42, s41
    buffer_load_dword v250, v197, s[52:55], s42 offen
    s_add_u32 s42, s42, s40
    buffer_load_dword v250, v197, s[52:55], s42 offen
    s_add_u32 s42, s42, s41
L_nopf2:
    s_barrier
    s_cmp_lg_u32 s63, 0
    s_cbranch_scc1 L_r_nwo
    s_mov_b32 m0, s56
    s_nop 0
    buffer_load_dwordx4 v15, s[52:55], s57 offen  lds
    s_branch L_r_wo2
L_r_nwo:
    buffer_load_dword v250, v197, s[52:55], s42 offen
    s_add_u32 s42, s42, s40
    buffer_load_dword v250, v197, s[52:55], s42 offen
    s_add_u32 s42, s42, s41
    buffer_load_dword v250, v197, s[52:55], s42 offen
    s_add_u32 s42, s42, s40
    s_cmp_eq_u32 s63, 1
    s_cbranch_scc1 L_r_w1
    buffer_load_dword v250, v197, s[52:55], s42 offen
    s_add_u32 s42, s42, s40
    buffer_load_dword v250, v197, s[52:55], s42 offen
    s_add_u32 s42, s42, s41
    buffer_load_dword v250, v197, s[52:55], s42 offen
    s_add_u32 s42, s42, s40
    buffer_load_dword v250, v197, s[52:55], s42 offen
    s_add_u32 s42, s42, s41
    s_cmp_eq_u32 s63, 2
    s_cbranch_scc1 L_w2_red
    s_waitcnt vmcnt(0)
    s_mov_b64 exec, -1
    v_lshlrev_b32 v243, 4, v0
    v_add_u32 v243, 131328, v243
    ds_read_b96 v[240:242], v243
    s_waitcnt lgkmcnt(0)
    buffer_store_dwordx2 v[240:241], v242, s[44:47], 0 offen sc1
    s_branch L_fin
L_stream:
    s_sub_u32 s49, s3, 1
    s_lshl_b32 s49, s49, 12
    v_lshl_add_u32 v1, v0, 4, s49
    s_and_b32 s34, s2, 127
    s_lshl_b32 s34, s34, 21
    s_lshr_b32 s35, s2, 7
    s_lshl_b32 s35, s35, 18
    s_add_u32 s34, s34, s35
    s_add_u32 s34, s34, 1572864
    s_mov_b32 s38, 0x40000
    s_mov_b32 s42, 0x40000
    s_waitcnt lgkmcnt(0)
    s_add_u32 s36, s6, s34
    s_addc_u32 s37, s7, 0
    s_add_u32 s40, s8, s34
    s_addc_u32 s41, s9, 0
    s_mov_b32 s49, 0
    buffer_load_dwordx4 v[16:19], v1, s[36:39], s49 offen offset:0 nt
    buffer_load_dwordx4 v[20:23], v1, s[36:39], s49 offen offset:1024 nt
    buffer_load_dwordx4 v[24:27], v1, s[36:39], s49 offen offset:2048 nt
    s_barrier
    s_waitcnt vmcnt(2)
    buffer_load_dwordx4 v[28:31], v1, s[36:39], s49 offen offset:3072 nt
    s_waitcnt vmcnt(2)
    s_mov_b32 s49, 28672
    buffer_load_dwordx4 v[32:35], v1, s[36:39], s49 offen offset:0 nt
    s_waitcnt vmcnt(2)
    buffer_load_dwordx4 v[36:39], v1, s[36:39], s49 offen offset:1024 nt
    s_waitcnt vmcnt(2)
    buffer_load_dwordx4 v[40:43], v1, s[36:39], s49 offen offset:2048 nt
    s_waitcnt vmcnt(2)
    buffer_load_dwordx4 v[44:47], v1, s[36:39], s49 offen offset:3072 nt
    s_add_u32 s44, s32, 0
    s_addc_u32 s45, s33, 0
    s_mov_b32 s63, 0
    s_mov_b32 s62, s61
    s_cmp_lt_u32 s61, 20
    s_cbranch_scc1 L_rd41
    s_mul_i32 s62, s60, 12
    s_add_u32 s62, s62, s61
    s_sub_u32 s62, s62, 20
    s_mov_b32 s63, 1
    s_cmp_lt_u32 s62, 54
    s_cbranch_scc1 L_rd41
    s_cmp_lt_u32 s62, 56
    s_cselect_b32 s63, 3, 2
    s_sub_u32 s62, s62, 56
L_rd41:
    v_and_b32 v8, 3, v0
    v_bfe_u32 v9, v0, 2, 2
    v_lshrrev_b32 v10, 4, v0
    s_mov_b32 s55, 0x20000
    s_lshl_b32 s35, s62, 6
    s_and_b32 s49, s62, 1
    s_cmp_eq_u32 s63, 0
    s_cbranch_scc1 L_dp43
    s_cmp_eq_u32 s63, 1
    s_cbranch_scc1 L_dp44
    s_mov_b32 s52, s20
    s_mov_b32 s53, s21
    s_mov_b32 s54, 2211840
    v_mov_b32 v15, 0
    s_branch L_dp45
L_dp44:
    s_mov_b32 s52, s16
    s_mov_b32 s53, s17
    s_mov_b32 s54, 2211840
    v_lshl_add_u32 v15, v9, 3, v10
    v_mul_u32_u24 v15, 3456, v15
    v_lshl_add_u32 v15, v8, 4, v15
    v_add_u32 v15, s35, v15
    s_bfe_u32 s50, s3, 0x10001
    s_lshl_b32 s50, s50, 7
    s_and_b32 s34, s3, 1
    s_lshl_b32 s34, s34, 2
    s_add_u32 s50, s50, s34
    s_and_b32 s51, s3, 3
    s_lshl_b32 s51, s51, 5
    s_add_u32 s51, s51, 512
    s_mul_i32 s50, s50, 3456
    s_mul_i32 s51, s51, 3456
    s_branch L_dp45
L_dp43:
    s_mov_b32 s52, s12
    s_mov_b32 s53, s13
    s_mov_b32 s54, 5242880
    s_lshr_b32 s50, s3, 1
    s_lshl_b32 s50, s50, 3
    s_add_u32 s50, s50, s60
    s_and_b32 s51, s3, 1
    s_lshl_b32 s34, s50, 1
    s_add_u32 s34, s34, s51
    s_mul_i32 s34, s34, 81920
    s_add_u32 s34, s34, s35
    v_lshl_add_u32 v15, v9, 2, v10
    v_mul_u32_u24 v15, 2560, v15
    v_lshl_add_u32 v15, v8, 4, v15
    v_add_u32 v15, s34, v15
    s_lshl_b32 s56, s3, 12
    s_lshl_b32 s34, s49, 11
    s_add_u32 s56, s56, s34
    s_add_u32 s56, s56, 40960
    s_add_u32 s58, s56, 1024
    s_mul_i32 s57, s49, 40960
    s_add_u32 s59, s57, 1280
L_dp45:
    v_and_b32 v2, 15, v0
    v_lshlrev_b32 v2, 4, v2
    v_add_u32 v2, 98304, v2
    s_waitcnt vmcnt(2)
    s_mov_b32 s49, 57344
    buffer_load_dwordx4 v[48:51], v1, s[36:39], s49 offen offset:0 nt
    s_waitcnt vmcnt(2)
    buffer_load_dwordx4 v[52:55], v1, s[36:39], s49 offen offset:1024 nt
    s_waitcnt vmcnt(2)
    s_cmp_ge_u32 s3, 4
    s_cbranch_scc1 L_sl46
    s_waitcnt vmcnt(1)
L_sl46:
    buffer_load_dwordx4 v[56:59], v1, s[36:39], s49 offen offset:2048 nt
    s_waitcnt vmcnt(2)
    s_cmp_ge_u32 s3, 4
    s_cbranch_scc1 L_sl47
    s_waitcnt vmcnt(1)
L_sl47:
    buffer_load_dwordx4 v[60:63], v1, s[36:39], s49 offen offset:3072 nt
    s_waitcnt vmcnt(2)
    s_cmp_ge_u32 s3, 4
    s_cbranch_scc1 L_sl48
    s_waitcnt vmcnt(1)
L_sl48:
    s_mov_b32 s49, 86016
    buffer_load_dwordx4 v[64:67], v1, s[36:39], s49 offen offset:0 nt
    s_waitcnt vmcnt(2)
    buffer_load_dwordx4 v[68:71], v1, s[36:39], s49 offen offset:1024 nt
    s_waitcnt vmcnt(2)
    buffer_load_dwordx4 v[72:75], v1, s[36:39], s49 offen offset:2048 nt
    s_waitcnt vmcnt(2)
    buffer_load_dwordx4 v[76:79], v1, s[36:39], s49 offen offset:3072 nt
    s_waitcnt vmcnt(2)
    s_mov_b32 s49, 114688
    buffer_load_dwordx4 v[80:83], v1, s[36:39], s49 offen offset:0 nt
    s_waitcnt vmcnt(2)
    buffer_load_dwordx4 v[84:87], v1, s[36:39], s49 offen offset:1024 nt
    s_waitcnt vmcnt(2)
    buffer_load_dwordx4 v[88:91], v1, s[36:39], s49 offen offset:2048 nt
    v_mov_b32 v3, 19
    ds_write_b32 v2, v3 offset:768
    s_waitcnt vmcnt(2)
    buffer_load_dwordx4 v[92:95], v1, s[36:39], s49 offen offset:3072 nt
    s_waitcnt vmcnt(2)
    s_mov_b32 s49, 143360
    buffer_load_dwordx4 v[96:99], v1, s[36:39], s49 offen offset:0 nt
    s_waitcnt vmcnt(2)
    buffer_load_dwordx4 v[100:103], v1, s[36:39], s49 offen offset:1024 nt
    s_waitcnt vmcnt(2)
    buffer_load_dwordx4 v[104:107], v1, s[36:39], s49 offen offset:2048 nt
    s_waitcnt vmcnt(2)
    buffer_load_dwordx4 v[108:111], v1, s[36:39], s49 offen offset:3072 nt
    s_waitcnt vmcnt(2)
    s_mov_b32 s49, 172032
    buffer_load_dwordx4 v[112:115], v1, s[36:39], s49 offen offset:0 nt
    s_waitcnt vmcnt(2)
    buffer_load_dwordx4 v[116:119], v1, s[36:39], s49 offen offset:1024 nt
    s_waitcnt vmcnt(2)
    buffer_load_dwordx4 v[120:123], v1, s[36:39], s49 offen offset:2048 nt
    s_waitcnt vmcnt(2)
    buffer_load_dwordx4 v[124:127], v1, s[36:39], s49 offen offset:3072 nt
    s_waitcnt vmcnt(2)
    s_mov_b32 s49, 200704
    buffer_load_dwordx4 v[128:131], v1, s[36:39], s49 offen offset:0 nt
    s_waitcnt vmcnt(2)
    buffer_load_dwordx4 v[132:135], v1, s[36:39], s49 offen offset:1024 nt
    s_waitcnt vmcnt(2)
    buffer_load_dwordx4 v[136:139], v1, s[36:39], s49 offen offset:2048 nt
    v_mov_b32 v3, 31
    ds_write_b32 v2, v3 offset:768
    s_waitcnt vmcnt(2)
    buffer_load_dwordx4 v[140:143], v1, s[36:39], s49 offen offset:3072 nt
    s_waitcnt vmcnt(2)
    s_mov_b32 s49, 229376
    buffer_load_dwordx4 v[144:147], v1, s[36:39], s49 offen offset:0 nt
    s_waitcnt vmcnt(2)
    buffer_load_dwordx4 v[148:151], v1, s[36:39], s49 offen offset:1024 nt
    s_waitcnt vmcnt(2)
    buffer_load_dwordx4 v[152:155], v1, s[36:39], s49 offen offset:2048 nt
    s_waitcnt vmcnt(2)
    buffer_load_dwordx4 v[156:159], v1, s[36:39], s49 offen offset:3072 nt
    s_waitcnt vmcnt(2)
    s_mov_b32 s49, 0
    buffer_load_dwordx4 v[160:163], v1, s[40:43], s49 offen offset:0 nt
    s_waitcnt vmcnt(2)
    buffer_load_dwordx4 v[164:167], v1, s[40:43], s49 offen offset:1024 nt
    s_waitcnt vmcnt(2)
    buffer_load_dwordx4 v[168:171], v1, s[40:43], s49 offen offset:2048 nt
    s_waitcnt vmcnt(2)
    buffer_load_dwordx4 v[172:175], v1, s[40:43], s49 offen offset:3072 nt
    s_waitcnt vmcnt(2)
    s_mov_b32 s49, 28672
    buffer_load_dwordx4 v[176:179], v1, s[40:43], s49 offen offset:0 nt
    s_waitcnt vmcnt(2)
    buffer_load_dwordx4 v[180:183], v1, s[40:43], s49 offen offset:1024 nt
    s_waitcnt vmcnt(2)
    buffer_load_dwordx4 v[184:187], v1, s[40:43], s49 offen offset:2048 nt
    s_waitcnt vmcnt(2)
    buffer_load_dwordx4 v[188:191], v1, s[40:43], s49 offen offset:3072 nt
    s_waitcnt vmcnt(2)
    s_mov_b32 s49, 57344
    buffer_load_dwordx4 v[192:195], v1, s[40:43], s49 offen offset:0 nt
    s_waitcnt vmcnt(2)
    buffer_load_dwordx4 v[196:199], v1, s[40:43], s49 offen offset:1024 nt
    s_waitcnt vmcnt(2)
    buffer_load_dwordx4 v[200:203], v1, s[40:43], s49 offen offset:2048 nt
    s_waitcnt vmcnt(2)
    buffer_load_dwordx4 v[204:207], v1, s[40:43], s49 offen offset:3072 nt
    s_waitcnt vmcnt(2)
    s_mov_b32 s49, 86016
    buffer_load_dwordx4 v[208:211], v1, s[40:43], s49 offen offset:0 nt
    s_waitcnt vmcnt(2)
    buffer_load_dwordx4 v[212:215], v1, s[40:43], s49 offen offset:1024 nt
    s_waitcnt vmcnt(2)
    buffer_load_dwordx4 v[216:219], v1, s[40:43], s49 offen offset:2048 nt
    s_waitcnt vmcnt(2)
    buffer_load_dwordx4 v[220:223], v1, s[40:43], s49 offen offset:3072 nt
    s_waitcnt vmcnt(2)
    s_mov_b32 s49, 114688
    buffer_load_dwordx4 v[224:227], v1, s[40:43], s49 offen offset:0 nt
    s_waitcnt vmcnt(2)
    buffer_load_dwordx4 v[228:231], v1, s[40:43], s49 offen offset:1024 nt
    s_waitcnt vmcnt(2)
    buffer_load_dwordx4 v[232:235], v1, s[40:43], s49 offen offset:2048 nt
    s_waitcnt vmcnt(2)
    buffer_load_dwordx4 v[236:239], v1, s[40:43], s49 offen offset:3072 nt
    s_mov_b32 s35, 0
L_poll49:
    ds_read_b128 v[4:7], v2
    s_add_u32 s35, s35, 1
    s_waitcnt lgkmcnt(0)
    v_max3_u32 v3, v4, v5, v6
    v_max_u32 v3, v3, v7
    v_cmp_eq_u32 vcc, -1, v3
    s_cbranch_vccz L_done50
    s_sleep 2
    s_cmp_lt_u32 s35, 60000
    s_cbranch_scc1 L_poll49
L_done50:
    s_waitcnt vmcnt(2)
    s_mov_b32 s49, 143360
    buffer_load_dwordx4 v[240:243], v1, s[40:43], s49 offen offset:0 nt
    v_dot2_f32_bf16 v8, v16, v4, 0
    v_dot2_f32_bf16 v9, v20, v4, 0
    v_dot2_f32_bf16 v10, v24, v4, 0
    v_dot2_f32_bf16 v11, v28, v4, 0
    v_dot2c_f32_bf16 v8, v17, v5
    v_dot2c_f32_bf16 v9, v21, v5
    v_dot2c_f32_bf16 v10, v25, v5
    v_dot2c_f32_bf16 v11, v29, v5
    v_dot2c_f32_bf16 v8, v18, v6
    v_dot2c_f32_bf16 v9, v22, v6
    v_dot2c_f32_bf16 v10, v26, v6
    v_dot2c_f32_bf16 v11, v30, v6
    v_dot2c_f32_bf16 v8, v19, v7
    v_dot2c_f32_bf16 v9, v23, v7
    v_dot2c_f32_bf16 v10, v27, v7
    v_dot2c_f32_bf16 v11, v31, v7
    v_add_f32_dpp v12, v8, v8 row_ror:8 row_mask:0xf bank_mask:0x3
    v_add_f32_dpp v12, v9, v9 row_ror:8 row_mask:0xf bank_mask:0xc
    v_add_f32_dpp v13, v10, v10 row_ror:8 row_mask:0xf bank_mask:0x3
    v_add_f32_dpp v13, v11, v11 row_ror:8 row_mask:0xf bank_mask:0xc
    v_dot2_f32_bf16 v8, v32, v4, 0
    v_dot2_f32_bf16 v9, v36, v4, 0
    v_dot2_f32_bf16 v10, v40, v4, 0
    v_dot2_f32_bf16 v11, v44, v4, 0
    v_add_f32_dpp v12, v12, v12 row_half_mirror row_mask:0xf bank_mask:0xf
    v_add_f32_dpp v13, v13, v13 row_half_mirror row_mask:0xf bank_mask:0xf
    v_dot2c_f32_bf16 v8, v33, v5
    v_dot2c_f32_bf16 v9, v37, v5
    v_dot2c_f32_bf16 v10, v41, v5
    v_dot2c_f32_bf16 v11, v45, v5
    v_add_f32_dpp v12, v12, v12 quad_perm:[1,0,3,2] row_mask:0xf bank_mask:0xf
    v_add_f32_dpp v13, v13, v13 quad_perm:[1,0,3,2] row_mask:0xf bank_mask:0xf
    v_dot2c_f32_bf16 v8, v34, v6
    v_dot2c_f32_bf16 v9, v38, v6
    v_dot2c_f32_bf16 v10, v42, v6
    v_dot2c_f32_bf16 v11, v46, v6
    s_waitcnt vmcnt(2)
    buffer_load_dwordx4 v[244:247], v1, s[40:43], s49 offen offset:1024 nt
    v_add_f32_dpp v12, v12, v12 quad_perm:[2,3,0,1] row_mask:0xf bank_mask:0xf
    v_add_f32_dpp v13, v13, v13 quad_perm:[2,3,0,1] row_mask:0xf bank_mask:0xf
    v_dot2c_f32_bf16 v8, v35, v7
    v_dot2c_f32_bf16 v9, v39, v7
    v_dot2c_f32_bf16 v10, v43, v7
    v_dot2c_f32_bf16 v11, v47, v7
    v_add_f32_dpp v16, v8, v8 row_ror:8 row_mask:0xf bank_mask:0x3
    v_add_f32_dpp v16, v9, v9 row_ror:8 row_mask:0xf bank_mask:0xc
    v_add_f32_dpp v17, v10, v10 row_ror:8 row_mask:0xf bank_mask:0x3
    v_add_f32_dpp v17, v11, v11 row_ror:8 row_mask:0xf bank_mask:0xc
    v_dot2_f32_bf16 v8, v48, v4, 0
    v_dot2_f32_bf16 v9, v52, v4, 0
    v_dot2_f32_bf16 v10, v56, v4, 0
    v_dot2_f32_bf16 v11, v60, v4, 0
    v_add_f32_dpp v16, v16, v16 row_half_mirror row_mask:0xf bank_mask:0xf
    v_add_f32_dpp v17, v17, v17 row_half_mirror row_mask:0xf bank_mask:0xf
    v_dot2c_f32_bf16 v8, v49, v5
    v_dot2c_f32_bf16 v9, v53, v5
    v_dot2c_f32_bf16 v10, v57, v5
    v_dot2c_f32_bf16 v11, v61, v5
    v_add_f32_dpp v16, v16, v16 quad_perm:[1,0,3,2] row_mask:0xf bank_mask:0xf
    v_add_f32_dpp v17, v17, v17 quad_perm:[1,0,3,2] row_mask:0xf bank_mask:0xf
    v_dot2c_f32_bf16 v8, v50, v6
    v_dot2c_f32_bf16 v9, v54, v6
    v_dot2c_f32_bf16 v10, v58, v6
    v_dot2c_f32_bf16 v11, v62, v6
    v_add_f32_dpp v16, v16, v16 quad_perm:[2,3,0,1] row_mask:0xf bank_mask:0xf
    v_add_f32_dpp v17, v17, v17 quad_perm:[2,3,0,1] row_mask:0xf bank_mask:0xf
    v_dot2c_f32_bf16 v8, v51, v7
    v_dot2c_f32_bf16 v9, v55, v7
    v_dot2c_f32_bf16 v10, v59, v7
    v_dot2c_f32_bf16 v11, v63, v7
    v_add_f32_dpp v18, v8, v8 row_ror:8 row_mask:0xf bank_mask:0x3
    v_add_f32_dpp v18, v9, v9 row_ror:8 row_mask:0xf bank_mask:0xc
    v_add_f32_dpp v19, v10, v10 row_ror:8 row_mask:0xf bank_mask:0x3
    v_add_f32_dpp v19, v11, v11 row_ror:8 row_mask:0xf bank_mask:0xc
    s_waitcnt vmcnt(2)
    buffer_load_dwordx4 v[248:251], v1, s[40:43], s49 offen offset:2048 nt
    v_dot2_f32_bf16 v8, v64, v4, 0
    v_dot2_f32_bf16 v9, v68, v4, 0
    v_dot2_f32_bf16 v10, v72, v4, 0
    v_dot2_f32_bf16 v11, v76, v4, 0
    v_add_f32_dpp v18, v18, v18 row_half_mirror row_mask:0xf bank_mask:0xf
    v_add_f32_dpp v19, v19, v19 row_half_mirror row_mask:0xf bank_mask:0xf
    v_dot2c_f32_bf16 v8, v65, v5
    v_dot2c_f32_bf16 v9, v69, v5
    v_dot2c_f32_bf16 v10, v73, v5
    v_dot2c_f32_bf16 v11, v77, v5
    v_add_f32_dpp v18, v18, v18 quad_perm:[1,0,3,2] row_mask:0xf bank_mask:0xf
    v_add_f32_dpp v19, v19, v19 quad_perm:[1,0,3,2] row_mask:0xf bank_mask:0xf
    v_dot2c_f32_bf16 v8, v66, v6
    v_dot2c_f32_bf16 v9, v70, v6
    v_dot2c_f32_bf16 v10, v74, v6
    v_dot2c_f32_bf16 v11, v78, v6
    v_add_f32_dpp v18, v18, v18 quad_perm:[2,3,0,1] row_mask:0xf bank_mask:0xf
    v_add_f32_dpp v19, v19, v19 quad_perm:[2,3,0,1] row_mask:0xf bank_mask:0xf
    v_dot2c_f32_bf16 v8, v67, v7
    v_dot2c_f32_bf16 v9, v71, v7
    v_dot2c_f32_bf16 v10, v75, v7
    v_dot2c_f32_bf16 v11, v79, v7
    v_add_f32_dpp v20, v8, v8 row_ror:8 row_mask:0xf bank_mask:0x3
    v_add_f32_dpp v20, v9, v9 row_ror:8 row_mask:0xf bank_mask:0xc
    v_add_f32_dpp v21, v10, v10 row_ror:8 row_mask:0xf bank_mask:0x3
    v_add_f32_dpp v21, v11, v11 row_ror:8 row_mask:0xf bank_mask:0xc
    v_dot2_f32_bf16 v8, v80, v4, 0
    v_dot2_f32_bf16 v9, v84, v4, 0
    v_dot2_f32_bf16 v10, v88, v4, 0
    v_dot2_f32_bf16 v11, v92, v4, 0
    v_add_f32_dpp v20, v20, v20 row_half_mirror row_mask:0xf bank_mask:0xf
    v_add_f32_dpp v21, v21, v21 row_half_mirror row_mask:0xf bank_mask:0xf
    v_dot2c_f32_bf16 v8, v81, v5
    v_dot2c_f32_bf16 v9, v85, v5
    v_dot2c_f32_bf16 v10, v89, v5
    v_dot2c_f32_bf16 v11, v93, v5
    s_waitcnt vmcnt(2)
    buffer_load_dwordx4 v[252:255], v1, s[40:43], s49 offen offset:3072 nt
    v_add_f32_dpp v20, v20, v20 quad_perm:[1,0,3,2] row_mask:0xf bank_mask:0xf
    v_add_f32_dpp v21, v21, v21 quad_perm:[1,0,3,2] row_mask:0xf bank_mask:0xf
    v_dot2c_f32_bf16 v8, v82, v6
    v_dot2c_f32_bf16 v9, v86, v6
    v_dot2c_f32_bf16 v10, v90, v6
    v_dot2c_f32_bf16 v11, v94, v6
    v_add_f32_dpp v20, v20, v20 quad_perm:[2,3,0,1] row_mask:0xf bank_mask:0xf
    v_add_f32_dpp v21, v21, v21 quad_perm:[2,3,0,1] row_mask:0xf bank_mask:0xf
    v_dot2c_f32_bf16 v8, v83, v7
    v_dot2c_f32_bf16 v9, v87, v7
    v_dot2c_f32_bf16 v10, v91, v7
    v_dot2c_f32_bf16 v11, v95, v7
    v_add_f32_dpp v22, v8, v8 row_ror:8 row_mask:0xf bank_mask:0x3
    v_add_f32_dpp v22, v9, v9 row_ror:8 row_mask:0xf bank_mask:0xc
    v_add_f32_dpp v23, v10, v10 row_ror:8 row_mask:0xf bank_mask:0x3
    v_add_f32_dpp v23, v11, v11 row_ror:8 row_mask:0xf bank_mask:0xc
    v_dot2_f32_bf16 v8, v96, v4, 0
    v_dot2_f32_bf16 v9, v100, v4, 0
    v_dot2_f32_bf16 v10, v104, v4, 0
    v_dot2_f32_bf16 v11, v108, v4, 0
    v_add_f32_dpp v22, v22, v22 row_half_mirror row_mask:0xf bank_mask:0xf
    v_add_f32_dpp v23, v23, v23 row_half_mirror row_mask:0xf bank_mask:0xf
    v_dot2c_f32_bf16 v8, v97, v5
    v_dot2c_f32_bf16 v9, v101, v5
    v_dot2c_f32_bf16 v10, v105, v5
    v_dot2c_f32_bf16 v11, v109, v5
    v_add_f32_dpp v22, v22, v22 quad_perm:[1,0,3,2] row_mask:0xf bank_mask:0xf
    v_add_f32_dpp v23, v23, v23 quad_perm:[1,0,3,2] row_mask:0xf bank_mask:0xf
    v_dot2c_f32_bf16 v8, v98, v6
    v_dot2c_f32_bf16 v9, v102, v6
    v_dot2c_f32_bf16 v10, v106, v6
    v_dot2c_f32_bf16 v11, v110, v6
    v_add_f32_dpp v22, v22, v22 quad_perm:[2,3,0,1] row_mask:0xf bank_mask:0xf
    v_add_f32_dpp v23, v23, v23 quad_perm:[2,3,0,1] row_mask:0xf bank_mask:0xf
    v_dot2c_f32_bf16 v8, v99, v7
    v_dot2c_f32_bf16 v9, v103, v7
    s_waitcnt vmcnt(2)
    s_mov_b32 s49, 172032
    buffer_load_dwordx4 v[32:35], v1, s[40:43], s49 offen offset:0 nt
    v_dot2c_f32_bf16 v10, v107, v7
    v_dot2c_f32_bf16 v11, v111, v7
    v_add_f32_dpp v24, v8, v8 row_ror:8 row_mask:0xf bank_mask:0x3
    v_add_f32_dpp v24, v9, v9 row_ror:8 row_mask:0xf bank_mask:0xc
    v_add_f32_dpp v25, v10, v10 row_ror:8 row_mask:0xf bank_mask:0x3
    v_add_f32_dpp v25, v11, v11 row_ror:8 row_mask:0xf bank_mask:0xc
    v_dot2_f32_bf16 v8, v112, v4, 0
    v_dot2_f32_bf16 v9, v116, v4, 0
    v_dot2_f32_bf16 v10, v120, v4, 0
    v_dot2_f32_bf16 v11, v124, v4, 0
    v_add_f32_dpp v24, v24, v24 row_half_mirror row_mask:0xf bank_mask:0xf
    v_add_f32_dpp v25, v25, v25 row_half_mirror row_mask:0xf bank_mask:0xf
    v_dot2c_f32_bf16 v8, v113, v5
    v_dot2c_f32_bf16 v9, v117, v5
    v_dot2c_f32_bf16 v10, v121, v5
    v_dot2c_f32_bf16 v11, v125, v5
    v_add_f32_dpp v24, v24, v24 quad_perm:[1,0,3,2] row_mask:0xf bank_mask:0xf
    v_add_f32_dpp v25, v25, v25 quad_perm:[1,0,3,2] row_mask:0xf bank_mask:0xf
    v_dot2c_f32_bf16 v8, v114, v6
    v_dot2c_f32_bf16 v9, v118, v6
    v_dot2c_f32_bf16 v10, v122, v6
    v_dot2c_f32_bf16 v11, v126, v6
    v_add_f32_dpp v24, v24, v24 quad_perm:[2,3,0,1] row_mask:0xf bank_mask:0xf
    v_add_f32_dpp v25, v25, v25 quad_perm:[2,3,0,1] row_mask:0xf bank_mask:0xf
    v_dot2c_f32_bf16 v8, v115, v7
    v_dot2c_f32_bf16 v9, v119, v7
    v_dot2c_f32_bf16 v10, v123, v7
    v_dot2c_f32_bf16 v11, v127, v7
    v_add_f32_dpp v26, v8, v8 row_ror:8 row_mask:0xf bank_mask:0x3
    v_add_f32_dpp v26, v9, v9 row_ror:8 row_mask:0xf bank_mask:0xc
    v_add_f32_dpp v27, v10, v10 row_ror:8 row_mask:0xf bank_mask:0x3
    v_add_f32_dpp v27, v11, v11 row_ror:8 row_mask:0xf bank_mask:0xc
    v_dot2_f32_bf16 v8, v128, v4, 0
    v_dot2_f32_bf16 v9, v132, v4, 0
    v_dot2_f32_bf16 v10, v136, v4, 0
    v_dot2_f32_bf16 v11, v140, v4, 0
    s_waitcnt vmcnt(2)
    buffer_load_dwordx4 v[36:39], v1, s[40:43], s49 offen offset:1024 nt
    v_add_f32_dpp v26, v26, v26 row_half_mirror row_mask:0xf bank_mask:0xf
    v_add_f32_dpp v27, v27, v27 row_half_mirror row_mask:0xf bank_mask:0xf
    v_dot2c_f32_bf16 v8, v129, v5
    v_dot2c_f32_bf16 v9, v133, v5
    v_dot2c_f32_bf16 v10, v137, v5
    v_dot2c_f32_bf16 v11, v141, v5
    v_add_f32_dpp v26, v26, v26 quad_perm:[1,0,3,2] row_mask:0xf bank_mask:0xf
    v_add_f32_dpp v27, v27, v27 quad_perm:[1,0,3,2] row_mask:0xf bank_mask:0xf
    v_dot2c_f32_bf16 v8, v130, v6
    v_dot2c_f32_bf16 v9, v134, v6
    v_dot2c_f32_bf16 v10, v138, v6
    v_dot2c_f32_bf16 v11, v142, v6
    v_add_f32_dpp v26, v26, v26 quad_perm:[2,3,0,1] row_mask:0xf bank_mask:0xf
    v_add_f32_dpp v27, v27, v27 quad_perm:[2,3,0,1] row_mask:0xf bank_mask:0xf
    v_dot2c_f32_bf16 v8, v131, v7
    v_dot2c_f32_bf16 v9, v135, v7
    v_dot2c_f32_bf16 v10, v139, v7
    v_dot2c_f32_bf16 v11, v143, v7
    v_add_f32_dpp v28, v8, v8 row_ror:8 row_mask:0xf bank_mask:0x3
    v_add_f32_dpp v28, v9, v9 row_ror:8 row_mask:0xf bank_mask:0xc
    v_add_f32_dpp v29, v10, v10 row_ror:8 row_mask:0xf bank_mask:0x3
    v_add_f32_dpp v29, v11, v11 row_ror:8 row_mask:0xf bank_mask:0xc
    v_dot2_f32_bf16 v8, v144, v4, 0
    v_dot2_f32_bf16 v9, v148, v4, 0
    v_dot2_f32_bf16 v10, v152, v4, 0
    v_dot2_f32_bf16 v11, v156, v4, 0
    v_add_f32_dpp v28, v28, v28 row_half_mirror row_mask:0xf bank_mask:0xf
    v_add_f32_dpp v29, v29, v29 row_half_mirror row_mask:0xf bank_mask:0xf
    v_dot2c_f32_bf16 v8, v145, v5
    v_dot2c_f32_bf16 v9, v149, v5
    v_dot2c_f32_bf16 v10, v153, v5
    v_dot2c_f32_bf16 v11, v157, v5
    v_add_f32_dpp v28, v28, v28 quad_perm:[1,0,3,2] row_mask:0xf bank_mask:0xf
    v_add_f32_dpp v29, v29, v29 quad_perm:[1,0,3,2] row_mask:0xf bank_mask:0xf
    v_dot2c_f32_bf16 v8, v146, v6
    v_dot2c_f32_bf16 v9, v150, v6
    buffer_load_dwordx4 v[40:43], v1, s[40:43], s49 offen offset:2048 nt
    v_dot2c_f32_bf16 v10, v154, v6
    v_dot2c_f32_bf16 v11, v158, v6
    v_add_f32_dpp v28, v28, v28 quad_perm:[2,3,0,1] row_mask:0xf bank_mask:0xf
    v_add_f32_dpp v29, v29, v29 quad_perm:[2,3,0,1] row_mask:0xf bank_mask:0xf
    v_dot2c_f32_bf16 v8, v147, v7
    v_dot2c_f32_bf16 v9, v151, v7
    v_dot2c_f32_bf16 v10, v155, v7
    v_dot2c_f32_bf16 v11, v159, v7
    v_add_f32_dpp v30, v8, v8 row_ror:8 row_mask:0xf bank_mask:0x3
    v_add_f32_dpp v30, v9, v9 row_ror:8 row_mask:0xf bank_mask:0xc
    v_add_f32_dpp v31, v10, v10 row_ror:8 row_mask:0xf bank_mask:0x3
    v_add_f32_dpp v31, v11, v11 row_ror:8 row_mask:0xf bank_mask:0xc
    v_add_f32_dpp v30, v30, v30 row_half_mirror row_mask:0xf bank_mask:0xf
    s_nop 0
    v_add_f32_dpp v31, v31, v31 row_half_mirror row_mask:0xf bank_mask:0xf
    v_add_f32_dpp v30, v30, v30 quad_perm:[1,0,3,2] row_mask:0xf bank_mask:0xf
    s_nop 0
    v_add_f32_dpp v31, v31, v31 quad_perm:[1,0,3,2] row_mask:0xf bank_mask:0xf
    v_add_f32_dpp v30, v30, v30 quad_perm:[2,3,0,1] row_mask:0xf bank_mask:0xf
    s_nop 0
    v_add_f32_dpp v31, v31, v31 quad_perm:[2,3,0,1] row_mask:0xf bank_mask:0xf
    v_max3_f32 v8, v12, v13, v16
    v_max3_f32 v8, v8, v17, v18
    v_max3_f32 v8, v8, v19, v20
    v_max3_f32 v8, v8, v21, v22
    v_max3_f32 v8, v8, v23, v24
    v_max3_f32 v8, v8, v25, v26
    v_max3_f32 v8, v8, v27, v28
    v_max3_f32 v8, v8, v29, v30
    v_max_f32 v8, v8, v31
    s_mov_b32 s34, 0x3e0293ee
    s_nop 0
    v_max_f32_dpp v8, v8, v8 row_ror:8 row_mask:0xf bank_mask:0xf
    v_mov_b32 v9, v8
    s_nop 1
    v_permlane16_swap_b32 v8, v9
    v_max_f32 v8, v8, v9
    v_mov_b32 v9, v8
    s_nop 1
    v_permlane32_swap_b32 v8, v9
    v_max_f32 v8, v8, v9
    v_mul_f32 v8, s34, v8
    s_waitcnt vmcnt(3)
    buffer_load_dwordx4 v[44:47], v1, s[40:43], s49 offen offset:3072 nt
    v_fma_f32 v12, v12, s34, -v8
    v_fma_f32 v13, v13, s34, -v8
    v_fma_f32 v16, v16, s34, -v8
    v_fma_f32 v17, v17, s34, -v8
    v_fma_f32 v18, v18, s34, -v8
    v_fma_f32 v19, v19, s34, -v8
    v_fma_f32 v20, v20, s34, -v8
    v_fma_f32 v21, v21, s34, -v8
    v_fma_f32 v22, v22, s34, -v8
    v_fma_f32 v23, v23, s34, -v8
    v_fma_f32 v24, v24, s34, -v8
    v_fma_f32 v25, v25, s34, -v8
    v_fma_f32 v26, v26, s34, -v8
    v_fma_f32 v27, v27, s34, -v8
    v_fma_f32 v28, v28, s34, -v8
    v_fma_f32 v29, v29, s34, -v8
    v_fma_f32 v30, v30, s34, -v8
    v_fma_f32 v31, v31, s34, -v8
    v_exp_f32 v12, v12
    v_exp_f32 v13, v13
    v_exp_f32 v16, v16
    v_exp_f32 v17, v17
    v_exp_f32 v18, v18
    v_exp_f32 v19, v19
    v_exp_f32 v20, v20
    v_exp_f32 v21, v21
    v_exp_f32 v22, v22
    v_exp_f32 v23, v23
    v_exp_f32 v24, v24
    v_exp_f32 v25, v25
    v_exp_f32 v26, v26
    v_exp_f32 v27, v27
    v_exp_f32 v28, v28
    v_exp_f32 v29, v29
    v_exp_f32 v30, v30
    v_exp_f32 v31, v31
    s_waitcnt vmcnt(3)
    s_mov_b32 s49, 200704
    buffer_load_dwordx4 v[48:51], v1, s[40:43], s49 offen offset:0 nt
    v_add_f32 v9, v12, v13
    v_add_f32 v9, v9, v16
    v_add_f32 v9, v9, v17
    v_add_f32 v9, v9, v18
    v_add_f32 v9, v9, v19
    v_add_f32 v9, v9, v20
    v_add_f32 v9, v9, v21
    v_add_f32 v9, v9, v22
    v_add_f32 v9, v9, v23
    v_add_f32 v9, v9, v24
    v_add_f32 v9, v9, v25
    v_add_f32 v9, v9, v26
    v_add_f32 v9, v9, v27
    v_add_f32 v9, v9, v28
    v_add_f32 v9, v9, v29
    v_add_f32 v9, v9, v30
    v_add_f32 v9, v9, v31
    v_and_b32 v10, 1, v0
    v_lshlrev_b32 v10, 4, v10
    v_mov_b32 v11, 0xffff
    v_lshlrev_b32 v10, v10, v11
    v_bfe_u32 v11, v0, 1, 2
    v_cmp_eq_u32 vcc, 0, v11
    s_nop 1
    v_cndmask_b32 v144, 0, v10, vcc
    v_cmp_eq_u32 vcc, 1, v11
    s_nop 1
    v_cndmask_b32 v145, 0, v10, vcc
    v_cmp_eq_u32 vcc, 2, v11
    s_nop 1
    v_cndmask_b32 v146, 0, v10, vcc
    v_cmp_eq_u32 vcc, 3, v11
    s_nop 1
    v_cndmask_b32 v147, 0, v10, vcc
    v_add_f32_dpp v9, v9, v9 row_ror:8 row_mask:0xf bank_mask:0xf
    v_mov_b32 v10, v9
    s_nop 1
    v_permlane16_swap_b32 v9, v10
    v_add_f32 v9, v9, v10
    v_mov_b32 v10, v9
    s_nop 1
    v_permlane32_swap_b32 v9, v10
    s_waitcnt vmcnt(3)
    buffer_load_dwordx4 v[52:55], v1, s[40:43], s49 offen offset:1024 nt
    v_add_f32 v9, v9, v10
    s_lshl_b32 s34, s3, 3
    s_add_u32 s34, s34, 98552
    v_mov_b32 v10, s34
    s_mov_b64 exec, 1
    ds_write_b64 v10, v[8:9]
    s_mov_b64 exec, -1
    s_lshl_b32 s34, s3, 10
    s_add_u32 s34, s34, 98304
    v_lshl_add_u32 v2, v0, 4, s34
    v_cvt_pk_bf16_f32 v10, v12, v12
    v_and_b32 v128, v10, v144
    v_and_b32 v129, v10, v145
    v_and_b32 v130, v10, v146
    v_and_b32 v131, v10, v147
    s_nop 1
    v_mfma_f32_16x16x32_bf16 v[148:151], v[160:163], v[128:131], 0
    v_mfma_f32_16x16x32_bf16 v[152:155], v[164:167], v[128:131], 0
    v_cvt_pk_bf16_f32 v10, v13, v13
    v_and_b32 v132, v10, v144
    v_and_b32 v133, v10, v145
    v_and_b32 v134, v10, v146
    v_and_b32 v135, v10, v147
    s_nop 1
    v_mfma_f32_16x16x32_bf16 v[148:151], v[168:171], v[132:135], v[148:151]
    v_mfma_f32_16x16x32_bf16 v[152:155], v[172:175], v[132:135], v[152:155]
    v_cvt_pk_bf16_f32 v10, v16, v16
    v_and_b32 v128, v10, v144
    v_and_b32 v129, v10, v145
    v_and_b32 v130, v10, v146
    v_and_b32 v131, v10, v147
    s_nop 1
    v_mfma_f32_16x16x32_bf16 v[148:151], v[176:179], v[128:131], v[148:151]
    v_mfma_f32_16x16x32_bf16 v[152:155], v[180:183], v[128:131], v[152:155]
    v_cvt_pk_bf16_f32 v10, v17, v17
    v_and_b32 v132, v10, v144
    v_and_b32 v133, v10, v145
    v_and_b32 v134, v10, v146
    v_and_b32 v135, v10, v147
    s_nop 1
    v_mfma_f32_16x16x32_bf16 v[148:151], v[184:187], v[132:135], v[148:151]
    v_mfma_f32_16x16x32_bf16 v[152:155], v[188:191], v[132:135], v[152:155]
    s_waitcnt vmcnt(3)
    buffer_load_dwordx4 v[56:59], v1, s[40:43], s49 offen offset:2048 nt
    v_cvt_pk_bf16_f32 v10, v18, v18
    v_and_b32 v128, v10, v144
    v_and_b32 v129, v10, v145
    v_and_b32 v130, v10, v146
    v_and_b32 v131, v10, v147
    s_nop 1
    v_mfma_f32_16x16x32_bf16 v[148:151], v[192:195], v[128:131], v[148:151]
    v_mfma_f32_16x16x32_bf16 v[152:155], v[196:199], v[128:131], v[152:155]
    v_cvt_pk_bf16_f32 v10, v19, v19
    v_and_b32 v132, v10, v144
    v_and_b32 v133, v10, v145
    v_and_b32 v134, v10, v146
    v_and_b32 v135, v10, v147
    s_nop 1
    v_mfma_f32_16x16x32_bf16 v[148:151], v[200:203], v[132:135], v[148:151]
    v_mfma_f32_16x16x32_bf16 v[152:155], v[204:207], v[132:135], v[152:155]
    v_cvt_pk_bf16_f32 v10, v20, v20
    v_and_b32 v128, v10, v144
    v_and_b32 v129, v10, v145
    v_and_b32 v130, v10, v146
    v_and_b32 v131, v10, v147
    s_nop 1
    v_mfma_f32_16x16x32_bf16 v[148:151], v[208:211], v[128:131], v[148:151]
    v_mfma_f32_16x16x32_bf16 v[152:155], v[212:215], v[128:131], v[152:155]
    v_cvt_pk_bf16_f32 v10, v21, v21
    v_and_b32 v132, v10, v144
    v_and_b32 v133, v10, v145
    v_and_b32 v134, v10, v146
    v_and_b32 v135, v10, v147
    s_nop 1
    v_mfma_f32_16x16x32_bf16 v[148:151], v[216:219], v[132:135], v[148:151]
    v_mfma_f32_16x16x32_bf16 v[152:155], v[220:223], v[132:135], v[152:155]
    v_cvt_pk_bf16_f32 v10, v22, v22
    v_and_b32 v128, v10, v144
    v_and_b32 v129, v10, v145
    v_and_b32 v130, v10, v146
    v_and_b32 v131, v10, v147
    s_nop 1
    v_mfma_f32_16x16x32_bf16 v[148:151], v[224:227], v[128:131], v[148:151]
    v_mfma_f32_16x16x32_bf16 v[152:155], v[228:231], v[128:131], v[152:155]
    v_cvt_pk_bf16_f32 v10, v23, v23
    s_waitcnt vmcnt(3)
    buffer_load_dwordx4 v[60:63], v1, s[40:43], s49 offen offset:3072 nt
    v_and_b32 v132, v10, v144
    v_and_b32 v133, v10, v145
    v_and_b32 v134, v10, v146
    v_and_b32 v135, v10, v147
    s_nop 1
    v_mfma_f32_16x16x32_bf16 v[148:151], v[232:235], v[132:135], v[148:151]
    v_mfma_f32_16x16x32_bf16 v[152:155], v[236:239], v[132:135], v[152:155]
    v_cvt_pk_bf16_f32 v10, v24, v24
    v_and_b32 v128, v10, v144
    v_and_b32 v129, v10, v145
    v_and_b32 v130, v10, v146
    v_and_b32 v131, v10, v147
    s_nop 1
    v_mfma_f32_16x16x32_bf16 v[148:151], v[240:243], v[128:131], v[148:151]
    v_mfma_f32_16x16x32_bf16 v[152:155], v[244:247], v[128:131], v[152:155]
    v_cvt_pk_bf16_f32 v10, v25, v25
    v_and_b32 v132, v10, v144
    v_and_b32 v133, v10, v145
    v_and_b32 v134, v10, v146
    v_and_b32 v135, v10, v147
    s_nop 1
    v_mfma_f32_16x16x32_bf16 v[148:151], v[248:251], v[132:135], v[148:151]
    v_mfma_f32_16x16x32_bf16 v[152:155], v[252:255], v[132:135], v[152:155]
    v_cvt_pk_bf16_f32 v10, v26, v26
    v_and_b32 v128, v10, v144
    v_and_b32 v129, v10, v145
    v_and_b32 v130, v10, v146
    v_and_b32 v131, v10, v147
    s_nop 1
    v_mfma_f32_16x16x32_bf16 v[148:151], v[32:35], v[128:131], v[148:151]
    v_mfma_f32_16x16x32_bf16 v[152:155], v[36:39], v[128:131], v[152:155]
    v_cvt_pk_bf16_f32 v10, v27, v27
    v_and_b32 v132, v10, v144
    v_and_b32 v133, v10, v145
    v_and_b32 v134, v10, v146
    v_and_b32 v135, v10, v147
    s_nop 1
    v_mfma_f32_16x16x32_bf16 v[148:151], v[40:43], v[132:135], v[148:151]
    v_mfma_f32_16x16x32_bf16 v[152:155], v[44:47], v[132:135], v[152:155]
    v_cvt_pk_bf16_f32 v10, v28, v28
    v_and_b32 v128, v10, v144
    s_waitcnt vmcnt(3)
    s_mov_b32 s49, 229376
    buffer_load_dwordx4 v[64:67], v1, s[40:43], s49 offen offset:0 nt
    v_and_b32 v129, v10, v145
    v_and_b32 v130, v10, v146
    v_and_b32 v131, v10, v147
    s_waitcnt vmcnt(3)
    buffer_load_dwordx4 v[68:71], v1, s[40:43], s49 offen offset:1024 nt
    v_mfma_f32_16x16x32_bf16 v[148:151], v[48:51], v[128:131], v[148:151]
    v_mfma_f32_16x16x32_bf16 v[152:155], v[52:55], v[128:131], v[152:155]
    v_cvt_pk_bf16_f32 v10, v29, v29
    v_and_b32 v132, v10, v144
    v_and_b32 v133, v10, v145
    v_and_b32 v134, v10, v146
    v_and_b32 v135, v10, v147
    s_waitcnt vmcnt(3)
    buffer_load_dwordx4 v[72:75], v1, s[40:43], s49 offen offset:2048 nt
    s_waitcnt vmcnt(3)
    buffer_load_dwordx4 v[76:79], v1, s[40:43], s49 offen offset:3072 nt
    s_barrier
    v_mfma_f32_16x16x32_bf16 v[148:151], v[56:59], v[132:135], v[148:151]
    v_mfma_f32_16x16x32_bf16 v[152:155], v[60:63], v[132:135], v[152:155]
    v_cvt_pk_bf16_f32 v10, v30, v30
    v_and_b32 v128, v10, v144
    v_and_b32 v129, v10, v145
    v_and_b32 v130, v10, v146
    v_and_b32 v131, v10, v147
    s_waitcnt vmcnt(2)
    s_nop 0
    v_mfma_f32_16x16x32_bf16 v[148:151], v[64:67], v[128:131], v[148:151]
    v_mfma_f32_16x16x32_bf16 v[152:155], v[68:71], v[128:131], v[152:155]
    v_cvt_pk_bf16_f32 v10, v31, v31
    v_and_b32 v132, v10, v144
    v_and_b32 v133, v10, v145
    v_and_b32 v134, v10, v146
    v_and_b32 v135, v10, v147
    s_waitcnt vmcnt(0)
    s_nop 0
    v_mfma_f32_16x16x32_bf16 v[148:151], v[72:75], v[132:135], v[148:151]
    v_mfma_f32_16x16x32_bf16 v[152:155], v[76:79], v[132:135], v[152:155]
    s_nop 7
    v_mov_b32_dpp v148, v152 quad_perm:[0,1,2,3] row_mask:0xf bank_mask:0xc
    v_mov_b32_dpp v149, v153 quad_perm:[0,1,2,3] row_mask:0xf bank_mask:0xc
    v_mov_b32_dpp v150, v154 quad_perm:[0,1,2,3] row_mask:0xf bank_mask:0xc
    v_mov_b32_dpp v151, v155 quad_perm:[0,1,2,3] row_mask:0xf bank_mask:0xc
    ds_write_b128 v2, v[148:151]
    s_waitcnt lgkmcnt(0)
    s_barrier
    v_and_b32 v200, 3, v0
    v_bfe_u32 v201, v0, 2, 2
    v_lshrrev_b32 v202, 4, v0
    s_lshl_b32 s34, s3, 10
    s_add_u32 s34, s34, 122112
    v_lshl_add_u32 v203, v0, 4, s34
    s_movk_i32 s48, 5120
    s_cmp_eq_u32 s63, 0
    s_cbranch_scc1 L_t_wo
    s_cmp_eq_u32 s63, 2
    s_cbranch_scc1 L_t_w2
    s_cmp_eq_u32 s63, 3
    s_cbranch_scc1 L_fin
    v_and_b32 v205, 15, v0
    v_lshlrev_b32 v205, 4, v205
    s_and_b32 s49, s3, 3
    s_mul_i32 s34, s49, 1280
    s_add_u32 s34, s34, 70656
    v_lshl_add_u32 v206, v202, 17, v205
    v_add_u32 v206, s34, v206
    s_mul_i32 s34, s49, 3840
    v_add_u32 v205, s34, v205
    s_barrier
L_r_w1:
    s_cmp_lt_u32 s3, 4
    s_cbranch_scc1 L_w1_ln
    s_and_b32 s49, s3, 3
    s_lshl_b32 s42, s49, 11
    s_add_u32 s42, s42, 40960
    s_bitcmp1_b32 s62, 0
    s_cbranch_scc1 L_rot1
    s_add_u32 m0, s42, 0
    s_add_u32 s34, s50, 0
    buffer_load_dwordx4 v15, s[52:55], s34 offen  lds
    s_add_u32 m0, s42, 1024
    s_add_u32 s34, s50, 884736
    buffer_load_dwordx4 v15, s[52:55], s34 offen  lds
    s_add_u32 m0, s42, 8192
    s_add_u32 s34, s50, 110592
    buffer_load_dwordx4 v15, s[52:55], s34 offen  lds
    s_add_u32 m0, s42, 9216
    s_add_u32 s34, s50, 995328
    buffer_load_dwordx4 v15, s[52:55], s34 offen  lds
    s_add_u32 m0, s42, 32768
    s_add_u32 s34, s51, 0
    buffer_load_dwordx4 v15, s[52:55], s34 offen  lds
    s_add_u32 m0, s42, 33792
    s_add_u32 s34, s51, 13824
    buffer_load_dwordx4 v15, s[52:55], s34 offen  lds
    s_add_u32 m0, s42, 16384
    s_add_u32 s34, s50, 221184
    buffer_load_dwordx4 v15, s[52:55], s34 offen  lds
    s_add_u32 m0, s42, 17408
    s_add_u32 s34, s50, 1105920
    buffer_load_dwordx4 v15, s[52:55], s34 offen  lds
    s_add_u32 m0, s42, 24576
    s_add_u32 s34, s50, 331776
    buffer_load_dwordx4 v15, s[52:55], s34 offen  lds
    s_add_u32 m0, s42, 25600
    s_add_u32 s34, s50, 1216512
    buffer_load_dwordx4 v15, s[52:55], s34 offen  lds
    s_branch L_rot2
L_rot1:
    s_add_u32 m0, s42, 16384
    s_add_u32 s34, s50, 221184
    buffer_load_dwordx4 v15, s[52:55], s34 offen  lds
    s_add_u32 m0, s42, 17408
    s_add_u32 s34, s50, 1105920
    buffer_load_dwordx4 v15, s[52:55], s34 offen  lds
    s_add_u32 m0, s42, 24576
    s_add_u32 s34, s50, 331776
    buffer_load_dwordx4 v15, s[52:55], s34 offen  lds
    s_add_u32 m0, s42, 25600
    s_add_u32 s34, s50, 1216512
    buffer_load_dwordx4 v15, s[52:55], s34 offen  lds
    s_add_u32 m0, s42, 32768
    s_add_u32 s34, s51, 0
    buffer_load_dwordx4 v15, s[52:55], s34 offen  lds
    s_add_u32 m0, s42, 33792
    s_add_u32 s34, s51, 13824
    buffer_load_dwordx4 v15, s[52:55], s34 offen  lds
    s_add_u32 m0, s42, 0
    s_add_u32 s34, s50, 0
    buffer_load_dwordx4 v15, s[52:55], s34 offen  lds
    s_add_u32 m0, s42, 1024
    s_add_u32 s34, s50, 884736
    buffer_load_dwordx4 v15, s[52:55], s34 offen  lds
    s_add_u32 m0, s42, 8192
    s_add_u32 s34, s50, 110592
    buffer_load_dwordx4 v15, s[52:55], s34 offen  lds
    s_add_u32 m0, s42, 9216
    s_add_u32 s34, s50, 995328
    buffer_load_dwordx4 v15, s[52:55], s34 offen  lds
L_rot2:
    v_lshrrev_b32 v3, 2, v0
    v_lshlrev_b32 v3, 6, v3
    v_lshl_add_u32 v3, v200, 3, v3
    v_add_u32 v3, s42, v3
    s_lshl_b32 s35, s49, 6
    s_add_u32 s35, s35, 116736
    v_mul_u32_u24 v4, 1344, v200
    v_lshl_add_u32 v4, v202, 4, v4
    v_add_u32 v4, s35, v4
    s_lshl_b32 s35, s49, 11
    s_add_u32 s35, s35, 122112
    v_lshl_add_u32 v5, v0, 4, s35
    s_waitcnt vmcnt(0)
    s_barrier
    ds_read_b64_tr_b16 v[32:33], v3 offset:0
    ds_read_b64_tr_b16 v[34:35], v3 offset:1024
    ds_read_b64_tr_b16 v[36:37], v3 offset:32
    ds_read_b64_tr_b16 v[38:39], v3 offset:1056
    ds_read_b64_tr_b16 v[40:41], v3 offset:8192
    ds_read_b64_tr_b16 v[42:43], v3 offset:9216
    ds_read_b64_tr_b16 v[44:45], v3 offset:8224
    ds_read_b64_tr_b16 v[46:47], v3 offset:9248
    ds_read_b64_tr_b16 v[48:49], v3 offset:16384
    ds_read_b64_tr_b16 v[50:51], v3 offset:17408
    ds_read_b64_tr_b16 v[52:53], v3 offset:16416
    ds_read_b64_tr_b16 v[54:55], v3 offset:17440
    s_waitcnt lgkmcnt(4)
    ds_read_b64_tr_b16 v[56:57], v3 offset:24576
    ds_read_b64_tr_b16 v[58:59], v3 offset:25600
    ds_read_b64_tr_b16 v[60:61], v3 offset:24608
    ds_read_b64_tr_b16 v[62:63], v3 offset:25632
    ds_read_b64_tr_b16 v[64:65], v3 offset:32768
    ds_read_b64_tr_b16 v[66:67], v3 offset:33792
    ds_read_b64_tr_b16 v[68:69], v3 offset:32800
    ds_read_b64_tr_b16 v[70:71], v3 offset:33824
    s_waitcnt lgkmcnt(0)
    s_barrier
    ds_read_b128 v[140:143], v4 offset:0
    ds_read_b128 v[144:147], v4 offset:256
    ds_read_b128 v[148:151], v4 offset:512
    ds_read_b128 v[152:155], v4 offset:768
    ds_read_b128 v[156:159], v4 offset:1024
    s_waitcnt lgkmcnt(4)
    v_mfma_f32_16x16x32_bf16 v[20:23], v[32:35], v[140:143], 0
    v_mfma_f32_16x16x32_bf16 v[24:27], v[36:39], v[140:143], 0
    s_waitcnt lgkmcnt(3)
    v_mfma_f32_16x16x32_bf16 v[20:23], v[40:43], v[144:147], v[20:23]
    v_mfma_f32_16x16x32_bf16 v[24:27], v[44:47], v[144:147], v[24:27]
    s_waitcnt lgkmcnt(2)
    v_mfma_f32_16x16x32_bf16 v[20:23], v[48:51], v[148:151], v[20:23]
    v_mfma_f32_16x16x32_bf16 v[24:27], v[52:55], v[148:151], v[24:27]
    s_waitcnt lgkmcnt(1)
    v_mfma_f32_16x16x32_bf16 v[20:23], v[56:59], v[152:155], v[20:23]
    v_mfma_f32_16x16x32_bf16 v[24:27], v[60:63], v[152:155], v[24:27]
    s_waitcnt lgkmcnt(0)
    v_mfma_f32_16x16x32_bf16 v[20:23], v[64:67], v[156:159], v[20:23]
    v_mfma_f32_16x16x32_bf16 v[24:27], v[68:71], v[156:159], v[24:27]
    s_nop 6
    ds_write_b128 v5, v[20:23]
    ds_write_b128 v5, v[24:27] offset:1024
    s_waitcnt lgkmcnt(0)
    s_barrier
    s_branch L_fin
L_w1_ln:
    ds_read_b128 v[140:143], v205 offset:0
    ds_read_b128 v[144:147], v205 offset:256
    ds_read_b128 v[148:151], v205 offset:512
    ds_read_b128 v[152:155], v205 offset:768
    ds_read_b128 v[156:159], v205 offset:1024
    ds_read_b128 v[160:163], v205 offset:1280
    ds_read_b128 v[164:167], v205 offset:1536
    ds_read_b128 v[168:171], v205 offset:1792
    ds_read_b128 v[172:175], v205 offset:2048
    ds_read_b128 v[176:179], v205 offset:2304
    ds_read_b128 v[180:183], v205 offset:2560
    ds_read_b128 v[184:187], v205 offset:2816
    ds_read_b128 v[188:191], v205 offset:3072
    ds_read_b128 v[192:195], v205 offset:3328
    ds_read_b128 v[196:199], v205 offset:3584
    v_and_b32 v8, 1, v0
    v_lshlrev_b32 v8, 4, v8
    v_mov_b32 v9, 0xffff
    v_lshlrev_b32 v8, v8, v9
    v_bfe_u32 v9, v0, 1, 2
    v_cmp_eq_u32 vcc, 0, v9
    s_nop 1
    v_cndmask_b32 v16, 0, v8, vcc
    v_cmp_eq_u32 vcc, 1, v9
    s_nop 1
    v_cndmask_b32 v17, 0, v8, vcc
    v_cmp_eq_u32 vcc, 2, v9
    s_nop 1
    v_cndmask_b32 v18, 0, v8, vcc
    v_cmp_eq_u32 vcc, 3, v9
    s_nop 1
    v_cndmask_b32 v19, 0, v8, vcc
    v_bfe_u32 v8, v0, 3, 1
    v_cmp_eq_u32 vcc, 0, v8
    s_nop 1
    v_cndmask_b32 v20, 0, v16, vcc
    v_xor_b32 v24, v20, v16
    v_cndmask_b32 v21, 0, v17, vcc
    v_xor_b32 v25, v21, v17
    v_cndmask_b32 v22, 0, v18, vcc
    v_xor_b32 v26, v22, v18
    v_cndmask_b32 v23, 0, v19, vcc
    v_xor_b32 v27, v23, v19
    v_and_b32 v52, 0x3f803f80, v20
    v_and_b32 v60, 0x3e803e80, v20
    v_and_b32 v53, 0x3f803f80, v21
    v_and_b32 v61, 0x3e803e80, v21
    v_and_b32 v54, 0x3f803f80, v22
    v_and_b32 v62, 0x3e803e80, v22
    v_and_b32 v55, 0x3f803f80, v23
    v_and_b32 v63, 0x3e803e80, v23
    v_and_b32 v56, 0x3f803f80, v24
    v_and_b32 v64, 0x3e803e80, v24
    v_and_b32 v57, 0x3f803f80, v25
    v_and_b32 v65, 0x3e803e80, v25
    v_and_b32 v58, 0x3f803f80, v26
    v_and_b32 v66, 0x3e803e80, v26
    v_and_b32 v59, 0x3f803f80, v27
    v_and_b32 v67, 0x3e803e80, v27
    s_waitcnt lgkmcnt(0)
    v_mfma_f32_16x16x32_bf16 v[68:71], v[140:143], v[60:63], 0
    v_mfma_f32_16x16x32_bf16 v[68:71], v[144:147], v[64:67], v[68:71]
    v_mfma_f32_16x16x32_bf16 v[72:75], v[148:151], v[60:63], 0
    v_mfma_f32_16x16x32_bf16 v[72:75], v[152:155], v[64:67], v[72:75]
    v_mfma_f32_16x16x32_bf16 v[76:79], v[156:159], v[60:63], 0
    v_mfma_f32_16x16x32_bf16 v[116:119], v[160:163], v[60:63], 0
    v_mfma_f32_16x16x32_bf16 v[116:119], v[164:167], v[64:67], v[116:119]
    v_mfma_f32_16x16x32_bf16 v[120:123], v[168:171], v[60:63], 0
    v_mfma_f32_16x16x32_bf16 v[120:123], v[172:175], v[64:67], v[120:123]
    v_mfma_f32_16x16x32_bf16 v[124:127], v[176:179], v[60:63], 0
    v_mfma_f32_16x16x32_bf16 v[80:83], v[180:183], v[60:63], 1.0
    v_mfma_f32_16x16x32_bf16 v[80:83], v[184:187], v[64:67], v[80:83]
    v_mfma_f32_16x16x32_bf16 v[84:87], v[188:191], v[60:63], 1.0
    v_mfma_f32_16x16x32_bf16 v[84:87], v[192:195], v[64:67], v[84:87]
    v_mfma_f32_16x16x32_bf16 v[88:91], v[196:199], v[60:63], 1.0
    s_mul_i32 s34, s3, 1344
    s_add_u32 s34, s34, 116736
    v_lshl_add_u32 v7, v0, 4, s34
    v_lshlrev_b32 v8, 6, v202
    v_lshl_add_u32 v8, v200, 4, v8
    v_and_b32 v9, 1, v201
    v_lshl_add_u32 v8, v9, 3, v8
    v_add_u32 v8, s34, v8
    v_bfe_u32 v9, v0, 3, 1
    v_mul_u32_u24 v9, 9216, v9
    v_sub_u32 v8, v8, v9
    v_lshrrev_b32 v9, 5, v0
    v_lshlrev_b32 v9, 10, v9
    v_and_b32 v6, 1, v202
    v_lshl_add_u32 v9, v6, 9, v9
    v_bfe_u32 v6, v0, 1, 1
    v_lshl_add_u32 v9, v6, 8, v9
    v_lshl_add_u32 v9, v201, 4, v9
    v_and_b32 v6, 1, v0
    v_lshl_add_u32 v9, v6, 3, v9
    v_add_u32 v9, 122112, v9
    s_lshr_b32 s34, s62, 2
    s_lshl_b32 s34, s34, 8
    s_and_b32 s49, s62, 3
    s_lshl_b32 s49, s49, 17
    s_add_u32 s34, s34, s49
    s_add_u32 s34, s34, 80896
    v_lshl_add_u32 v5, v0, 2, s34
    s_barrier
    s_mov_b32 s35, 0
    s_mov_b64 s[40:41], -1
    s_mov_b64 s[42:43], -1
L_pb:
    s_mov_b64 exec, s[40:41]
    s_cbranch_execz L_pbs0
    buffer_load_dwordx4 v[140:143], v206, s[44:47], 0 offen offset:0 sc1
    buffer_load_dwordx4 v[148:151], v206, s[44:47], 0 offen offset:256 sc1
    buffer_load_dwordx4 v[156:159], v206, s[44:47], 0 offen offset:512 sc1
    buffer_load_dwordx4 v[164:167], v206, s[44:47], 0 offen offset:768 sc1
    buffer_load_dwordx4 v[172:175], v206, s[44:47], 0 offen offset:1024 sc1
L_pbs0:
    s_mov_b64 exec, s[42:43]
    s_cbranch_execz L_pbs1
    buffer_load_dwordx4 v[144:147], v206, s[44:47], s48 offen offset:0 sc1
    buffer_load_dwordx4 v[152:155], v206, s[44:47], s48 offen offset:256 sc1
    buffer_load_dwordx4 v[160:163], v206, s[44:47], s48 offen offset:512 sc1
    buffer_load_dwordx4 v[168:171], v206, s[44:47], s48 offen offset:768 sc1
    buffer_load_dwordx4 v[176:179], v206, s[44:47], s48 offen offset:1024 sc1
L_pbs1:
    s_mov_b64 exec, -1
    s_add_u32 s35, s35, 1
    s_waitcnt vmcnt(0)
    v_max3_u32 v28, v140, v141, v142
    v_max3_u32 v29, v144, v145, v146
    v_max3_u32 v28, v28, v143, v148
    v_max3_u32 v29, v29, v147, v152
    v_max3_u32 v28, v28, v149, v150
    v_max3_u32 v29, v29, v153, v154
    v_max3_u32 v28, v28, v151, v156
    v_max3_u32 v29, v29, v155, v160
    v_max3_u32 v28, v28, v157, v158
    v_max3_u32 v29, v29, v161, v162
    v_max3_u32 v28, v28, v159, v164
    v_max3_u32 v29, v29, v163, v168
    v_max3_u32 v28, v28, v165, v166
    v_max3_u32 v29, v29, v169, v170
    v_max3_u32 v28, v28, v167, v172
    v_max3_u32 v29, v29, v171, v176
    v_max3_u32 v28, v28, v173, v174
    v_max3_u32 v29, v29, v177, v178
    v_max_u32 v28, v28, v175
    v_max_u32 v29, v29, v179
    v_cmp_eq_u32 s[40:41], -1, v28
    v_cmp_eq_u32 s[42:43], -1, v29
    v_mfma_f32_16x16x32_bf16 v[128:131], v[140:143], v[52:55], v[68:71]
    s_or_b64 vcc, s[40:41], s[42:43]
    s_cbranch_scc0 L_pbd
    s_cmp_lg_u32 s35, 64
    s_cbranch_scc1 L_tmo52
    s_mov_b64 exec, -1
    v_lshlrev_b32 v243, 4, v0
    v_add_u32 v243, 131328, v243
    ds_read_b96 v[240:242], v243
    s_waitcnt lgkmcnt(0)
    buffer_store_dwordx2 v[240:241], v242, s[44:47], 0 offen sc1
L_tmo52:
    s_cmp_lt_u32 s35, 60000
    s_cbranch_scc1 L_pb
L_pbd:
    v_mfma_f32_16x16x32_bf16 v[128:131], v[144:147], v[52:55], v[128:131]
    v_mfma_f32_16x16x32_bf16 v[128:131], v[148:151], v[56:59], v[128:131]
    v_mfma_f32_16x16x32_bf16 v[128:131], v[152:155], v[56:59], v[128:131]
    v_mfma_f32_16x16x32_bf16 v[132:135], v[156:159], v[52:55], v[72:75]
    v_mfma_f32_16x16x32_bf16 v[132:135], v[160:163], v[52:55], v[132:135]
    v_mfma_f32_16x16x32_bf16 v[132:135], v[164:167], v[56:59], v[132:135]
    v_mfma_f32_16x16x32_bf16 v[132:135], v[168:171], v[56:59], v[132:135]
    v_mfma_f32_16x16x32_bf16 v[136:139], v[172:175], v[52:55], v[76:79]
    v_mfma_f32_16x16x32_bf16 v[136:139], v[176:179], v[52:55], v[136:139]
    s_nop 1
    v_pk_add_f32 v[20:21], v[128:129], v[130:131]
    v_pk_mul_f32 v[22:23], v[128:129], v[128:129]
    v_pk_fma_f32 v[22:23], v[130:131], v[130:131], v[22:23]
    s_nop 0
    v_pk_add_f32 v[20:21], v[20:21], v[132:133]
    v_pk_fma_f32 v[22:23], v[132:133], v[132:133], v[22:23]
    v_pk_add_f32 v[20:21], v[20:21], v[134:135]
    v_pk_fma_f32 v[22:23], v[134:135], v[134:135], v[22:23]
    v_pk_add_f32 v[20:21], v[20:21], v[136:137]
    v_pk_fma_f32 v[22:23], v[136:137], v[136:137], v[22:23]
    v_pk_add_f32 v[20:21], v[20:21], v[138:139]
    v_pk_fma_f32 v[22:23], v[138:139], v[138:139], v[22:23]
    v_add_f32 v20, v20, v21
    v_add_f32 v21, v22, v23
    s_nop 0
    v_add_f32_dpp v20, v20, v20 row_ror:8 row_mask:0xf bank_mask:0xf
    v_add_f32_dpp v21, v21, v21 row_ror:8 row_mask:0xf bank_mask:0xf
    s_nop 0
    v_add_f32_dpp v20, v20, v20 row_ror:4 row_mask:0xf bank_mask:0xf
    v_add_f32_dpp v21, v21, v21 row_ror:4 row_mask:0xf bank_mask:0xf
    s_nop 0
    v_add_f32_dpp v20, v20, v20 row_ror:2 row_mask:0xf bank_mask:0xf
    v_add_f32_dpp v21, v21, v21 row_ror:2 row_mask:0xf bank_mask:0xf
    s_nop 0
    v_add_f32_dpp v20, v20, v20 row_ror:1 row_mask:0xf bank_mask:0xf
    v_add_f32_dpp v21, v21, v21 row_ror:1 row_mask:0xf bank_mask:0xf
    v_mov_b32 v22, v20
    v_mov_b32 v23, v21
    s_nop 0
    v_permlane16_swap_b32 v20, v22
    v_permlane16_swap_b32 v21, v23
    v_add_f32 v20, v20, v22
    v_add_f32 v21, v21, v23
    v_mov_b32 v22, v20
    v_mov_b32 v23, v21
    s_nop 0
    v_permlane32_swap_b32 v20, v22
    v_permlane32_swap_b32 v21, v23
    v_add_f32 v20, v20, v22
    v_add_f32 v21, v21, v23
    v_mul_f32 v22, 0x3acccccd, v20
    v_mul_f32 v21, 0x3acccccd, v21
    v_fma_f32 v21, -v22, v22, v21
    v_max_f32 v21, 0, v21
    v_add_f32 v21, 0x3727c5ac, v21
    v_rsq_f32 v20, v21
    s_nop 0
    v_mul_f32_e64 v21, -v22, v20
    v_pk_fma_f32 v[128:129], v[128:129], v[20:21], v[20:21] op_sel:[0,0,1] op_sel_hi:[1,0,1]
    v_pk_fma_f32 v[130:131], v[130:131], v[20:21], v[20:21] op_sel:[0,0,1] op_sel_hi:[1,0,1]
    v_pk_fma_f32 v[132:133], v[132:133], v[20:21], v[20:21] op_sel:[0,0,1] op_sel_hi:[1,0,1]
    v_pk_fma_f32 v[134:135], v[134:135], v[20:21], v[20:21] op_sel:[0,0,1] op_sel_hi:[1,0,1]
    v_pk_fma_f32 v[136:137], v[136:137], v[20:21], v[20:21] op_sel:[0,0,1] op_sel_hi:[1,0,1]
    v_pk_fma_f32 v[138:139], v[138:139], v[20:21], v[20:21] op_sel:[0,0,1] op_sel_hi:[1,0,1]
    v_pk_fma_f32 v[128:129], v[128:129], v[80:81], v[116:117]
    v_pk_fma_f32 v[130:131], v[130:131], v[82:83], v[118:119]
    v_pk_fma_f32 v[132:133], v[132:133], v[84:85], v[120:121]
    v_pk_fma_f32 v[134:135], v[134:135], v[86:87], v[122:123]
    v_pk_fma_f32 v[136:137], v[136:137], v[88:89], v[124:125]
    v_pk_fma_f32 v[138:139], v[138:139], v[90:91], v[126:127]
    v_cvt_pk_bf16_f32 v20, v128, v129
    v_cvt_pk_bf16_f32 v21, v130, v131
    v_cvt_pk_bf16_f32 v22, v132, v133
    v_cvt_pk_bf16_f32 v23, v134, v135
    v_cvt_pk_bf16_f32 v24, v136, v137
    v_cvt_pk_bf16_f32 v25, v138, v139
    ds_write_b128 v7, v[20:23]
    ds_write_b64 v8, v[24:25] offset:1024
    s_waitcnt lgkmcnt(0)
    s_barrier
    s_barrier
    s_cmp_lg_u32 s3, 0
    s_cbranch_scc1 L_fin
    ds_read_b64 v[20:21], v9 offset:0
    ds_read_b64 v[22:23], v9 offset:2048
    ds_read_b64 v[24:25], v9 offset:4096
    ds_read_b64 v[26:27], v9 offset:6144
    s_mov_b32 s34, 0xbdd2d3e8
    v_mov_b32 v10, 0xc0135761
    s_waitcnt lgkmcnt(3)
    v_pk_add_f32 v[100:101], v[100:101], v[20:21]
    s_waitcnt lgkmcnt(2)
    v_pk_add_f32 v[100:101], v[100:101], v[22:23]
    s_waitcnt lgkmcnt(1)
    v_pk_add_f32 v[100:101], v[100:101], v[24:25]
    s_waitcnt lgkmcnt(0)
    v_pk_add_f32 v[100:101], v[100:101], v[26:27]
    v_pk_mul_f32 v[20:21], v[100:101], v[100:101]
    v_fma_f32 v20, v20, s34, v10
    v_fma_f32 v21, v21, s34, v10
    v_pk_mul_f32 v[20:21], v[20:21], v[100:101]
    v_exp_f32 v20, v20
    v_exp_f32 v21, v21
    v_add_f32 v20, 1.0, v20
    v_add_f32 v21, 1.0, v21
    v_rcp_f32 v20, v20
    v_rcp_f32 v21, v21
    s_nop 0
    v_pk_mul_f32 v[20:21], v[20:21], v[100:101]
    v_cvt_pk_bf16_f32 v20, v20, v21
    v_min_u32 v20, -2, v20
    buffer_store_dword v20, v5, s[44:47], 0 offen sc1
    s_branch L_fin
L_t_w2:
    v_bfe_u32 v205, v0, 3, 2
    v_lshlrev_b32 v204, 3, v205
    v_lshrrev_b32 v205, 5, v0
    v_lshl_add_u32 v204, v205, 2, v204
    v_bfe_u32 v205, v0, 1, 2
    v_add_u32 v204, v204, v205
    v_and_b32 v205, 1, v0
    s_sub_u32 s49, s3, 1
    v_mul_u32_u24 v204, 1280, v204
    v_lshl_add_u32 v204, v205, 4, v204
    s_lshl_b32 s34, s62, 5
    s_mul_i32 s35, s49, 327680
    s_add_u32 s34, s34, s35
    v_add_u32 v204, s34, v204
    s_lshl_b32 s50, s49, 13
    s_add_u32 s50, s50, 40960
    v_lshl_add_u32 v205, v0, 3, s50
    s_lshl_b32 s40, s62, 1
    s_add_u32 s41, s40, 8
    s_add_u32 s42, s40, 2
    s_barrier
L_w2_dma:
    s_and_b32 s34, s40, 7
    s_lshl_b32 s35, s34, 10
    s_add_u32 m0, s50, s35
    s_mul_i32 s34, s34, 40960
    buffer_load_dwordx4 v204, s[52:55], s34 offen  lds
    s_add_u32 s40, s40, 1
    s_cmp_lg_u32 s40, s42
    s_cbranch_scc1 L_w2_nw
L_w2_nw:
    s_cmp_lt_u32 s40, s41
    s_cbranch_scc1 L_w2_dma
    s_lshl_b32 s34, s49, 9
    s_add_u32 s34, s34, 80896
    s_cmp_eq_u32 s49, 6
    s_cselect_b32 s35, 1, 3
    v_lshlrev_b32 v6, 6, v202
    v_lshl_add_u32 v6, v200, 4, v6
    v_add_u32 v6, s34, v6
    v_lshl_add_u32 v4, v201, 17, v6
    v_min_u32 v5, s35, v201
    v_lshl_add_u32 v5, v5, 17, v6
    s_waitcnt vmcnt(0)
    ds_read_b64_tr_b16 v[32:33], v205 offset:0
    ds_read_b64_tr_b16 v[34:35], v205 offset:512
    ds_read_b64_tr_b16 v[36:37], v205 offset:1024
    ds_read_b64_tr_b16 v[38:39], v205 offset:1536
    ds_read_b64_tr_b16 v[40:41], v205 offset:2048
    ds_read_b64_tr_b16 v[42:43], v205 offset:2560
    ds_read_b64_tr_b16 v[44:45], v205 offset:3072
    ds_read_b64_tr_b16 v[46:47], v205 offset:3584
    s_waitcnt lgkmcnt(0)
    ds_read_b64_tr_b16 v[48:49], v205 offset:4096
    ds_read_b64_tr_b16 v[50:51], v205 offset:4608
    ds_read_b64_tr_b16 v[52:53], v205 offset:5120
    ds_read_b64_tr_b16 v[54:55], v205 offset:5632
    ds_read_b64_tr_b16 v[56:57], v205 offset:6144
    ds_read_b64_tr_b16 v[58:59], v205 offset:6656
    ds_read_b64_tr_b16 v[60:61], v205 offset:7168
    ds_read_b64_tr_b16 v[62:63], v205 offset:7680
    s_waitcnt lgkmcnt(0)
    s_barrier
    s_sleep 1
    s_mov_b32 s35, 0
L_poll53:
    buffer_load_dwordx4 v[64:67], v4, s[44:47], 0 offen sc1
    buffer_load_dwordx4 v[68:71], v5, s[44:47], 0 offen offset:256 sc1
    s_add_u32 s35, s35, 1
    s_waitcnt vmcnt(0)
    v_max3_u32 v28, v64, v65, v66
    v_max3_u32 v28, v28, v67, v68
    v_max3_u32 v28, v28, v69, v70
    v_max_u32 v28, v28, v71
    v_cmp_eq_u32 vcc, -1, v28
    s_cbranch_vccz L_done54
    s_cmp_lg_u32 s35, 64
    s_cbranch_scc1 L_tmo56
    s_mov_b64 exec, -1
    v_lshlrev_b32 v243, 4, v0
    v_add_u32 v243, 131328, v243
    ds_read_b96 v[240:242], v243
    s_waitcnt lgkmcnt(0)
    buffer_store_dwordx2 v[240:241], v242, s[44:47], 0 offen sc1
L_tmo56:
    s_cmp_lt_u32 s35, 60000
    s_cbranch_scc1 L_poll53
L_done54:
    v_mfma_f32_16x16x32_bf16 v[80:83], v[32:35], v[64:67], 0
    v_mfma_f32_16x16x32_bf16 v[84:87], v[36:39], v[64:67], 0
    v_mfma_f32_16x16x32_bf16 v[88:91], v[40:43], v[64:67], 0
    v_mfma_f32_16x16x32_bf16 v[92:95], v[44:47], v[64:67], 0
    v_mfma_f32_16x16x32_bf16 v[80:83], v[48:51], v[68:71], v[80:83]
    v_mfma_f32_16x16x32_bf16 v[84:87], v[52:55], v[68:71], v[84:87]
    v_mfma_f32_16x16x32_bf16 v[88:91], v[56:59], v[68:71], v[88:91]
    v_mfma_f32_16x16x32_bf16 v[92:95], v[60:63], v[68:71], v[92:95]
    s_nop 5
    v_mov_b32_dpp v80, v84 quad_perm:[0,1,2,3] row_mask:0xf bank_mask:0x2
    v_mov_b32_dpp v81, v85 quad_perm:[0,1,2,3] row_mask:0xf bank_mask:0x2
    v_mov_b32_dpp v82, v86 quad_perm:[0,1,2,3] row_mask:0xf bank_mask:0x2
    v_mov_b32_dpp v83, v87 quad_perm:[0,1,2,3] row_mask:0xf bank_mask:0x2
    v_mov_b32_dpp v80, v88 quad_perm:[0,1,2,3] row_mask:0xf bank_mask:0x4
    v_mov_b32_dpp v81, v89 quad_perm:[0,1,2,3] row_mask:0xf bank_mask:0x4
    v_mov_b32_dpp v82, v90 quad_perm:[0,1,2,3] row_mask:0xf bank_mask:0x4
    v_mov_b32_dpp v83, v91 quad_perm:[0,1,2,3] row_mask:0xf bank_mask:0x4
    v_mov_b32_dpp v80, v92 quad_perm:[0,1,2,3] row_mask:0xf bank_mask:0x8
    v_mov_b32_dpp v81, v93 quad_perm:[0,1,2,3] row_mask:0xf bank_mask:0x8
    v_mov_b32_dpp v82, v94 quad_perm:[0,1,2,3] row_mask:0xf bank_mask:0x8
    v_mov_b32_dpp v83, v95 quad_perm:[0,1,2,3] row_mask:0xf bank_mask:0x8
    ds_write_b128 v203, v[80:83]
    s_waitcnt lgkmcnt(0)
    s_barrier
    s_branch L_fin
L_w2_red:
    s_mov_b32 s35, 0
L_poll57:
    buffer_load_dwordx2 v[20:21], v204, s[44:47], 0 offen sc1
    buffer_load_dwordx2 v[22:23], v204, s[44:47], s48 offen sc1
    s_add_u32 s35, s35, 1
    s_waitcnt vmcnt(0)
    v_max3_u32 v28, v20, v21, v22
    v_max_u32 v28, v28, v23
    v_cmp_eq_u32 vcc, -1, v28
    s_cbranch_vccz L_done58
    s_cmp_lg_u32 s35, 21
    s_cbranch_scc1 L_tmo60
    s_mov_b64 exec, -1
    v_lshlrev_b32 v243, 4, v0
    v_add_u32 v243, 131328, v243
    ds_read_b96 v[240:242], v243
    s_waitcnt lgkmcnt(0)
    buffer_store_dwordx2 v[240:241], v242, s[44:47], 0 offen sc1
L_tmo60:
    s_sleep 12
    s_cmp_lt_u32 s35, 60000
    s_cbranch_scc1 L_poll57
L_done58:
    s_barrier
    v_lshlrev_b32 v44, 16, v20
    v_and_b32 v45, 0xffff0000, v20
    v_lshlrev_b32 v46, 16, v21
    v_and_b32 v47, 0xffff0000, v21
    v_lshlrev_b32 v48, 16, v22
    v_and_b32 v49, 0xffff0000, v22
    v_lshlrev_b32 v50, 16, v23
    v_and_b32 v51, 0xffff0000, v23
    v_add_f32 v108, v108, v44
    v_add_f32 v109, v109, v45
    v_add_f32 v110, v110, v46
    v_add_f32 v111, v111, v47
    v_add_f32 v108, v108, v48
    v_add_f32 v109, v109, v49
    v_add_f32 v110, v110, v50
    v_add_f32 v111, v111, v51
    s_mov_b32 s36, s28
    s_mov_b32 s37, s29
    s_movk_i32 s38, 5120
    v_lshl_add_u32 v112, v13, 28, v112
    s_barrier
    ds_read_b128 v[64:67], v203 offset:1024
    ds_read_b128 v[68:71], v203 offset:2048
    ds_read_b128 v[72:75], v203 offset:3072
    ds_read_b128 v[76:79], v203 offset:4096
    ds_read_b128 v[80:83], v203 offset:5120
    ds_read_b128 v[84:87], v203 offset:6144
    ds_read_b128 v[88:91], v203 offset:7168
    s_waitcnt lgkmcnt(5)
    v_pk_add_f32 v[64:65], v[64:65], v[68:69]
    v_pk_add_f32 v[66:67], v[66:67], v[70:71]
    s_waitcnt lgkmcnt(4)
    v_pk_add_f32 v[64:65], v[64:65], v[72:73]
    v_pk_add_f32 v[66:67], v[66:67], v[74:75]
    s_waitcnt lgkmcnt(3)
    v_pk_add_f32 v[64:65], v[64:65], v[76:77]
    v_pk_add_f32 v[66:67], v[66:67], v[78:79]
    s_waitcnt lgkmcnt(2)
    v_pk_add_f32 v[64:65], v[64:65], v[80:81]
    v_pk_add_f32 v[66:67], v[66:67], v[82:83]
    s_waitcnt lgkmcnt(1)
    v_pk_add_f32 v[64:65], v[64:65], v[84:85]
    v_pk_add_f32 v[66:67], v[66:67], v[86:87]
    s_waitcnt lgkmcnt(0)
    v_pk_add_f32 v[64:65], v[64:65], v[88:89]
    v_pk_add_f32 v[66:67], v[66:67], v[90:91]
    v_pk_fma_f32 v[64:65], v[64:65], v[104:105], v[108:109]
    v_pk_fma_f32 v[66:67], v[66:67], v[106:107], v[110:111]
    s_nop 0
    v_add_f32_dpp v64, v64, v64 row_ror:4 row_mask:0xf bank_mask:0xf
    v_add_f32_dpp v65, v65, v65 row_ror:4 row_mask:0xf bank_mask:0xf
    v_add_f32_dpp v66, v66, v66 row_ror:4 row_mask:0xf bank_mask:0xf
    v_add_f32_dpp v67, v67, v67 row_ror:4 row_mask:0xf bank_mask:0xf
    v_add_f32_dpp v64, v64, v64 row_ror:8 row_mask:0xf bank_mask:0xf
    v_add_f32_dpp v65, v65, v65 row_ror:8 row_mask:0xf bank_mask:0xf
    v_add_f32_dpp v66, v66, v66 row_ror:8 row_mask:0xf bank_mask:0xf
    v_add_f32_dpp v67, v67, v67 row_ror:8 row_mask:0xf bank_mask:0xf
    v_cvt_pk_bf16_f32 v20, v64, v65
    v_cvt_pk_bf16_f32 v21, v66, v67
    buffer_store_dwordx2 v[20:21], v112, s[36:39], 0 offen
    s_branch L_fin
L_t_wo:
    s_mov_b32 m0, s56
    s_nop 0
    buffer_load_dwordx4 v15, s[52:55], s57 offen  lds
    s_lshr_b32 s49, s3, 1
    s_lshl_b32 s49, s49, 17
    v_and_b32 v210, 7, v0
    s_lshl_b32 s34, s60, 12
    s_add_u32 s34, s34, s49
    s_add_u32 s34, s34, 98560
    v_lshrrev_b32 v211, 3, v0
    v_lshl_add_u32 v204, v211, 9, s34
    s_lshl_b32 s35, s51, 7
    s_add_u32 s34, s34, s35
    s_sub_u32 s34, s34, 256
    v_lshrrev_b32 v211, 3, v0
    v_lshlrev_b32 v205, 9, v211
    v_lshl_add_u32 v205, v210, 4, v205
    v_add_u32 v205, s34, v205
    s_lshl_b32 s34, s3, 12
    s_add_u32 s34, s34, 40960
    v_lshrrev_b32 v206, 2, v0
    v_lshlrev_b32 v206, 6, v206
    v_lshl_add_u32 v206, v200, 3, v206
    v_add_u32 v206, s34, v206
    s_mul_i32 s34, s3, 1152
    s_add_u32 s34, s34, 107520
    v_mul_u32_u24 v207, 144, v211
    v_lshl_add_u32 v207, v210, 4, v207
    v_add_u32 v207, s34, v207
    v_mul_u32_u24 v208, 144, v210
    v_lshl_add_u32 v208, v202, 4, v208
    v_add_u32 v208, s34, v208
    v_mul_u32_u24 v212, 144, v211
    v_add_u32 v212, s34, v212
    v_mul_u32_u24 v213, 144, v210
    v_add_u32 v213, s34, v213
    v_and_b32 v211, 1, v211
    v_lshl_add_u32 v203, v211, 6, v208
    v_add_u32 v203, 14592, v203
    v_mov_b32 v210, 98816
    v_cmp_eq_u32 vcc, 0, v211
    s_nop 1
    v_cndmask_b32 v209, v208, v210, vcc
    v_cndmask_b32 v208, v210, v208, vcc
    s_barrier
L_r_wo2:
    s_mov_b32 m0, s58
    s_nop 0
    buffer_load_dwordx4 v15, s[52:55], s59 offen  lds
    s_xor_b32 m0, s56, 2048
    s_sub_u32 s34, 40960, s57
    buffer_load_dwordx4 v15, s[52:55], s34 offen  lds
    s_xor_b32 m0, s58, 2048
    s_sub_u32 s34, 42240, s57
    buffer_load_dwordx4 v15, s[52:55], s34 offen  lds
L_r_wo3:
    s_mov_b32 s35, 0
    s_mov_b32 s48, 0
    buffer_load_dwordx4 v[64:67], v205, s[44:47], 0 offen sc1
    buffer_load_dwordx2 v[26:27], v204, s[44:47], 0 offen sc1
    s_waitcnt vmcnt(2)
    ds_read_b64_tr_b16 v[32:33], v206 offset:0
    ds_read_b64_tr_b16 v[34:35], v206 offset:1024
    ds_read_b64_tr_b16 v[36:37], v206 offset:32
    ds_read_b64_tr_b16 v[38:39], v206 offset:1056
    ds_read_b64_tr_b16 v[40:41], v206 offset:2048
    ds_read_b64_tr_b16 v[42:43], v206 offset:3072
    ds_read_b64_tr_b16 v[44:45], v206 offset:2080
    ds_read_b64_tr_b16 v[46:47], v206 offset:3104
    s_branch L_pam
L_pa:
    buffer_load_dwordx4 v[64:67], v205, s[44:47], 0 offen sc1
    buffer_load_dwordx2 v[26:27], v204, s[44:47], 0 offen sc1
L_pam:
    s_add_u32 s35, s35, 1
    s_waitcnt vmcnt(0)
    ds_write_b128 v207, v[64:67]
    ds_write_b32 v212, v26 offset:128
    v_max3_u32 v28, v64, v65, v66
    v_max3_u32 v28, v28, v67, v26
    v_cmp_eq_u32 vcc, -1, v28
    s_cbranch_vccz L_pad
    s_cmp_lg_u32 s35, 64
    s_cbranch_scc1 L_tmo61
    s_mov_b64 exec, -1
    v_lshlrev_b32 v243, 4, v0
    v_add_u32 v243, 131328, v243
    ds_read_b96 v[240:242], v243
    s_waitcnt lgkmcnt(0)
    buffer_store_dwordx2 v[240:241], v242, s[44:47], 0 offen sc1
L_tmo61:
    s_mov_b64 exec, vcc
    s_cmp_lt_u32 s35, 60000
    s_cbranch_scc1 L_pa
L_pad:
    s_mov_b64 exec, -1
    ds_read_b32 v26, v213 offset:128
    ds_read_b128 v[68:71], v208 offset:0
    ds_read_b128 v[72:75], v209 offset:0
    ds_read_b128 v[76:79], v208 offset:64
    ds_read_b128 v[80:83], v209 offset:64
    s_waitcnt lgkmcnt(3)
    v_mfma_f32_16x16x32_bf16 v[20:23], v[32:35], v[68:71], 0
    s_waitcnt lgkmcnt(2)
    v_mfma_f32_16x16x32_bf16 v[20:23], v[36:39], v[72:75], v[20:23]
    s_waitcnt lgkmcnt(1)
    v_mfma_f32_16x16x32_bf16 v[20:23], v[40:43], v[76:79], v[20:23]
    s_waitcnt lgkmcnt(0)
    v_mfma_f32_16x16x32_bf16 v[20:23], v[44:47], v[80:83], v[20:23]
    v_sub_f32_dpp v26, v26, v26 quad_perm:[1,0,3,2] row_mask:0xf bank_mask:0xf
    v_exp_f32 v26, v26
    s_nop 0
    v_add_f32 v26, 1.0, v26
    v_rcp_f32 v26, v26
    s_nop 2
    v_pk_mul_f32 v[20:21], v[20:21], v[26:27] op_sel_hi:[1,0]
    v_pk_mul_f32 v[22:23], v[22:23], v[26:27] op_sel_hi:[1,0]
    ds_write_b128 v203, v[20:23]
    s_waitcnt lgkmcnt(0)
    s_barrier
    s_cmp_lg_u32 s3, 0
    s_cbranch_scc1 L_wo_x
    ds_read_b128 v[64:67], v207 offset:14592
    ds_read_b128 v[68:71], v207 offset:15744
    ds_read_b128 v[72:75], v207 offset:16896
    ds_read_b128 v[76:79], v207 offset:18048
    ds_read_b128 v[80:83], v207 offset:19200
    ds_read_b128 v[84:87], v207 offset:20352
    ds_read_b128 v[88:91], v207 offset:21504
    ds_read_b128 v[92:95], v207 offset:22656
    s_waitcnt lgkmcnt(6)
    v_pk_add_f32 v[64:65], v[64:65], v[68:69]
    v_pk_add_f32 v[66:67], v[66:67], v[70:71]
    s_waitcnt lgkmcnt(5)
    v_pk_add_f32 v[64:65], v[64:65], v[72:73]
    v_pk_add_f32 v[66:67], v[66:67], v[74:75]
    s_waitcnt lgkmcnt(4)
    v_pk_add_f32 v[64:65], v[64:65], v[76:77]
    v_pk_add_f32 v[66:67], v[66:67], v[78:79]
    s_waitcnt lgkmcnt(3)
    v_pk_add_f32 v[64:65], v[64:65], v[80:81]
    v_pk_add_f32 v[66:67], v[66:67], v[82:83]
    s_waitcnt lgkmcnt(2)
    v_pk_add_f32 v[64:65], v[64:65], v[84:85]
    v_pk_add_f32 v[66:67], v[66:67], v[86:87]
    s_waitcnt lgkmcnt(1)
    v_pk_add_f32 v[64:65], v[64:65], v[88:89]
    v_pk_add_f32 v[66:67], v[66:67], v[90:91]
    s_waitcnt lgkmcnt(0)
    v_pk_add_f32 v[64:65], v[64:65], v[92:93]
    v_pk_add_f32 v[66:67], v[66:67], v[94:95]
    v_pk_mul_f32 v[20:21], v[64:65], v[100:101]
    v_pk_mul_f32 v[22:23], v[66:67], v[102:103]
    s_nop 0
    v_add_f32_dpp v20, v20, v20 row_ror:8 row_mask:0xf bank_mask:0xf
    v_add_f32_dpp v21, v21, v21 row_ror:8 row_mask:0xf bank_mask:0xf
    v_add_f32_dpp v22, v22, v22 row_ror:8 row_mask:0xf bank_mask:0xf
    v_add_f32_dpp v23, v23, v23 row_ror:8 row_mask:0xf bank_mask:0xf
    v_cvt_pk_bf16_f32 v28, v20, v21
    v_cvt_pk_bf16_f32 v29, v22, v23
    v_min_u32 v28, -2, v28
    v_min_u32 v29, -2, v29
    buffer_store_dwordx2 v[28:29], v112, s[44:47], 0 offen sc1
L_wo_x:
    s_getreg_b32 s34, hwreg(HW_REG_XCC_ID, 0, 4)
    v_cmp_ne_u32 vcc, s34, v27
    s_cbranch_vccz L_fin
    s_mov_b64 exec, -1
    v_lshlrev_b32 v243, 4, v0
    v_add_u32 v243, 131328, v243
    ds_read_b96 v[240:242], v243
    s_waitcnt lgkmcnt(0)
    buffer_store_dwordx2 v[240:241], v242, s[44:47], 0 offen sc1
L_fin:
L_exit:
    s_endpgm
L_codeend:
.section .rodata,"a"
.p2align 6
.amdhsa_kernel adaLN_cond__sliding_block_cached__dense_activation_gelu__decode_kernel
  .amdhsa_next_free_vgpr 256
  .amdhsa_next_free_sgpr 102
  .amdhsa_accum_offset 256
  .amdhsa_group_segment_fixed_size 0
  .amdhsa_kernarg_size 120
  .amdhsa_user_sgpr_count 2
  .amdhsa_user_sgpr_kernarg_segment_ptr 1
  .amdhsa_system_sgpr_workgroup_id_x 1
  .amdhsa_float_denorm_mode_32 3
.end_amdhsa_kernel
```

```asm
; @launch grid=(256,1,1) block=(512,1,1) lds=132352
.amdgcn_target "amdgcn-amd-amdhsa--gfx950"
.text
.globl adaLN_cond__sliding_block_cached__dense_activation_gelu__decode_kernel
.p2align 8
.type adaLN_cond__sliding_block_cached__dense_activation_gelu__decode_kernel,@function
adaLN_cond__sliding_block_cached__dense_activation_gelu__decode_kernel:
    s_cmp_ge_u32 s2, 256
    s_cbranch_scc1 L_exit
    s_load_dwordx4 s[4:7], s[0:1], 0
    v_lshrrev_b32 v1, 6, v0
    v_and_b32 v0, 63, v0
    v_readfirstlane_b32 s3, v1
    s_and_b32 s34, s2, 127
    s_lshl_b32 s34, s34, 21
    s_lshr_b32 s35, s2, 7
    s_lshl_b32 s35, s35, 18
    s_add_u32 s34, s34, s35
    s_add_u32 s34, s34, 1572864
    s_mov_b32 s38, 0x40000
    s_mov_b32 s39, 0x20000
    s_sub_u32 s49, s3, 1
    s_cbranch_scc1 L_nohead
    s_lshl_b32 s49, s49, 12
    v_lshl_add_u32 v1, v0, 4, s49
    s_waitcnt lgkmcnt(0)
    s_add_u32 s36, s6, s34
    s_addc_u32 s37, s7, 0
    buffer_load_dwordx4 v[16:19], v1, s[36:39], 0 offen offset:0 nt
    buffer_load_dwordx4 v[20:23], v1, s[36:39], 0 offen offset:1024 nt
    buffer_load_dwordx4 v[24:27], v1, s[36:39], 0 offen offset:2048 nt
L_nohead:
    s_load_dwordx8 s[8:15], s[0:1], 16
    s_load_dwordx4 s[16:19], s[0:1], 48
    s_load_dwordx8 s[20:27], s[0:1], 64
    s_load_dwordx4 s[28:31], s[0:1], 96
    s_load_dwordx2 s[32:33], s[0:1], 112
    s_and_b32 s60, s2, 7
    s_lshr_b32 s61, s2, 3
    s_mov_b32 s39, 0x20000
    s_mov_b32 s43, 0x20000
    s_mov_b32 s46, 966656
    s_mov_b32 s47, 0x20000
    s_cmp_lg_u32 s3, 0
    s_cbranch_scc1 L_stream
    s_setprio 3
    v_and_b32 v12, 3, v0
    v_bfe_u32 v13, v0, 2, 2
    v_lshrrev_b32 v14, 4, v0
    v_lshrrev_b32 v10, 3, v0
    v_and_b32 v11, 7, v0
    v_lshlrev_b32 v11, 4, v11
    s_lshr_b32 s50, s2, 2
    s_and_b32 s51, s2, 3
    s_mul_i32 s34, s51, 1228800
    s_lshl_b32 s35, s50, 7
    s_add_u32 s34, s34, s35
    v_mul_u32_u24 v17, 7680, v10
    v_add3_u32 v17, v17, v11, s34
    v_mul_u32_u24 v16, 1280, v12
    v_lshl_add_u32 v18, v14, 4, v16
    s_mul_i32 s34, s51, 320
    v_add_u32 v19, s34, v18
    s_mov_b32 s38, 4915200
    s_sub_u32 s52, s50, 10
    s_waitcnt lgkmcnt(0)
    s_add_u32 s44, s32, 0
    s_addc_u32 s45, s33, 0
    s_cmp_ge_u32 s2, 240
    s_cbranch_scc1 L_clear
    s_cmp_ge_u32 s52, 10
    s_cbranch_scc1 L_nox
    v_lshl_add_u32 v18, v13, 6, v18
    global_load_dwordx4 v[52:55], v18, s[4:5] offset:0
    global_load_dwordx4 v[56:59], v18, s[4:5] offset:256
    global_load_dwordx4 v[60:63], v18, s[4:5] offset:512
    global_load_dwordx4 v[64:67], v18, s[4:5] offset:768
    global_load_dwordx4 v[68:71], v18, s[4:5] offset:1024
    s_lshl_b32 s34, s52, 7
    v_lshl_add_u32 v16, v13, 5, v16
    v_lshl_add_u32 v16, v14, 3, v16
    v_add_u32 v16, s34, v16
    global_load_dwordx2 v[72:73], v16, s[4:5]
L_nox:
    global_load_dwordx4 v[32:35], v19, s[24:25] offset:0
    global_load_dwordx4 v[36:39], v19, s[24:25] offset:64
    global_load_dwordx4 v[40:43], v19, s[24:25] offset:128
    global_load_dwordx4 v[44:47], v19, s[24:25] offset:192
    global_load_dwordx4 v[48:51], v19, s[24:25] offset:256
    s_mov_b32 s36, s26
    s_mov_b32 s37, s27
    s_mov_b32 m0, 0
    s_mov_b32 s34, 0
L_dma1:
    buffer_load_dwordx4 v17, s[36:39], s34 offen  lds
    s_add_u32 m0, m0, 1024
    s_add_u32 s34, s34, 61440
    buffer_load_dwordx4 v17, s[36:39], s34 offen  lds
    s_add_u32 m0, m0, 1024
    s_add_u32 s34, s34, 61440
    buffer_load_dwordx4 v17, s[36:39], s34 offen  lds
    s_add_u32 m0, m0, 1024
    s_add_u32 s34, s34, 61440
    buffer_load_dwordx4 v17, s[36:39], s34 offen  lds
    s_add_u32 m0, m0, 1024
    s_add_u32 s34, s34, 61440
    s_cmp_lt_u32 s34, 1228800
    s_cbranch_scc1 L_dma1
    v_lshlrev_b32 v1, 2, v0
    v_add_u32 v1, 98304, v1
    v_mov_b32 v2, -1
    v_mov_b32 v3, 0
    ds_write_b32 v1, v2
    ds_write_b32 v1, v2 offset:256
    ds_write_b32 v1, v3 offset:512
    ds_write_b32 v1, v3 offset:768
    s_waitcnt lgkmcnt(0)
    s_barrier
    s_getpc_b64 s[56:57]
L_pc2:
    s_sub_u32 s56, s56, L_pc2-adaLN_cond__sliding_block_cached__dense_activation_gelu__decode_kernel
    s_subb_u32 s57, s57, 0
    s_lshl_b32 s34, s61, 10
    v_lshl_add_u32 v9, v0, 4, s34
    v_min_u32 v9, L_codeend-adaLN_cond__sliding_block_cached__dense_activation_gelu__decode_kernel-16, v9
    global_load_dwordx4 v[76:79], v9, s[56:57]
    s_and_b32 s34, s2, 31
    s_lshl_b32 s34, s34, 8
    s_lshr_b32 s35, s2, 7
    s_lshl_b32 s35, s35, 7
    s_add_u32 s49, s34, s35
    s_bfe_u32 s53, s2, 0x20005
    s_mul_i32 s34, s53, 1310720
    s_add_u32 s34, s34, s49
    v_lshl_add_u32 v16, v10, 13, v11
    v_add_u32 v16, s34, v16
    s_mov_b32 s36, s10
    s_mov_b32 s37, s11
    s_mov_b32 s38, 5242880
    s_mov_b32 m0, 20480
    s_mov_b32 s34, 0
L_dma3:
    buffer_load_dwordx4 v16, s[36:39], s34 offen  lds
    s_add_u32 m0, m0, 1024
    s_add_u32 s34, s34, 65536
    buffer_load_dwordx4 v16, s[36:39], s34 offen  lds
    s_add_u32 m0, m0, 1024
    s_add_u32 s34, s34, 65536
    buffer_load_dwordx4 v16, s[36:39], s34 offen  lds
    s_add_u32 m0, m0, 1024
    s_add_u32 s34, s34, 65536
    buffer_load_dwordx4 v16, s[36:39], s34 offen  lds
    s_add_u32 m0, m0, 1024
    s_add_u32 s34, s34, 65536
    s_cmp_lt_u32 s34, 1310720
    s_cbranch_scc1 L_dma3
    v_lshl_add_u32 v15, v14, 3, v13
    v_lshlrev_b32 v15, 7, v15
    v_lshl_add_u32 v15, v12, 3, v15
    s_waitcnt vmcnt(41)
    s_mov_b32 s34, 0xbfb8aa3b
    v_lshlrev_b32 v20, 16, v32
    v_and_b32 v21, 0xffff0000, v32
    v_lshlrev_b32 v22, 16, v33
    v_and_b32 v23, 0xffff0000, v33
    v_mul_f32 v24, s34, v20
    v_mul_f32 v25, s34, v21
    v_mul_f32 v26, s34, v22
    v_mul_f32 v27, s34, v23
    v_exp_f32 v24, v24
    v_exp_f32 v25, v25
    v_exp_f32 v26, v26
    v_exp_f32 v27, v27
    v_add_f32 v24, 1.0, v24
    v_add_f32 v25, 1.0, v25
    v_add_f32 v26, 1.0, v26
    v_add_f32 v27, 1.0, v27
    v_rcp_f32 v24, v24
    v_rcp_f32 v25, v25
    v_rcp_f32 v26, v26
    v_rcp_f32 v27, v27
    v_mul_f32 v24, v20, v24
    v_mul_f32 v25, v21, v25
    v_mul_f32 v26, v22, v26
    v_mul_f32 v27, v23, v27
    v_cvt_pk_bf16_f32 v32, v24, v25
    v_cvt_pk_bf16_f32 v33, v26, v27
    v_lshlrev_b32 v20, 16, v34
    v_and_b32 v21, 0xffff0000, v34
    v_lshlrev_b32 v22, 16, v35
    v_and_b32 v23, 0xffff0000, v35
    v_mul_f32 v24, s34, v20
    v_mul_f32 v25, s34, v21
    v_mul_f32 v26, s34, v22
    v_mul_f32 v27, s34, v23
    v_exp_f32 v24, v24
    v_exp_f32 v25, v25
    v_exp_f32 v26, v26
    v_exp_f32 v27, v27
    v_add_f32 v24, 1.0, v24
    v_add_f32 v25, 1.0, v25
    v_add_f32 v26, 1.0, v26
    v_add_f32 v27, 1.0, v27
    v_rcp_f32 v24, v24
    v_rcp_f32 v25, v25
    v_rcp_f32 v26, v26
    v_rcp_f32 v27, v27
    v_mul_f32 v24, v20, v24
    v_mul_f32 v25, v21, v25
    v_mul_f32 v26, v22, v26
    v_mul_f32 v27, v23, v27
    v_cvt_pk_bf16_f32 v34, v24, v25
    v_cvt_pk_bf16_f32 v35, v26, v27
    v_lshlrev_b32 v20, 16, v36
    v_and_b32 v21, 0xffff0000, v36
    v_lshlrev_b32 v22, 16, v37
    v_and_b32 v23, 0xffff0000, v37
    v_mul_f32 v24, s34, v20
    v_mul_f32 v25, s34, v21
    v_mul_f32 v26, s34, v22
    v_mul_f32 v27, s34, v23
    v_exp_f32 v24, v24
    v_exp_f32 v25, v25
    v_exp_f32 v26, v26
    v_exp_f32 v27, v27
    v_add_f32 v24, 1.0, v24
    v_add_f32 v25, 1.0, v25
    v_add_f32 v26, 1.0, v26
    v_add_f32 v27, 1.0, v27
    v_rcp_f32 v24, v24
    v_rcp_f32 v25, v25
    v_rcp_f32 v26, v26
    v_rcp_f32 v27, v27
    v_mul_f32 v24, v20, v24
    v_mul_f32 v25, v21, v25
    v_mul_f32 v26, v22, v26
    v_mul_f32 v27, v23, v27
    v_cvt_pk_bf16_f32 v36, v24, v25
    v_cvt_pk_bf16_f32 v37, v26, v27
    v_lshlrev_b32 v20, 16, v38
    v_and_b32 v21, 0xffff0000, v38
    v_lshlrev_b32 v22, 16, v39
    v_and_b32 v23, 0xffff0000, v39
    v_mul_f32 v24, s34, v20
    v_mul_f32 v25, s34, v21
    v_mul_f32 v26, s34, v22
    v_mul_f32 v27, s34, v23
    v_exp_f32 v24, v24
    v_exp_f32 v25, v25
    v_exp_f32 v26, v26
    v_exp_f32 v27, v27
    v_add_f32 v24, 1.0, v24
    v_add_f32 v25, 1.0, v25
    v_add_f32 v26, 1.0, v26
    v_add_f32 v27, 1.0, v27
    v_rcp_f32 v24, v24
    v_rcp_f32 v25, v25
    v_rcp_f32 v26, v26
    v_rcp_f32 v27, v27
    v_mul_f32 v24, v20, v24
    v_mul_f32 v25, v21, v25
    v_mul_f32 v26, v22, v26
    v_mul_f32 v27, v23, v27
    v_cvt_pk_bf16_f32 v38, v24, v25
    v_cvt_pk_bf16_f32 v39, v26, v27
    v_lshlrev_b32 v20, 16, v40
    v_and_b32 v21, 0xffff0000, v40
    v_lshlrev_b32 v22, 16, v41
    v_and_b32 v23, 0xffff0000, v41
    v_mul_f32 v24, s34, v20
    v_mul_f32 v25, s34, v21
    v_mul_f32 v26, s34, v22
    v_mul_f32 v27, s34, v23
    v_exp_f32 v24, v24
    v_exp_f32 v25, v25
    v_exp_f32 v26, v26
    v_exp_f32 v27, v27
    v_add_f32 v24, 1.0, v24
    v_add_f32 v25, 1.0, v25
    v_add_f32 v26, 1.0, v26
    v_add_f32 v27, 1.0, v27
    v_rcp_f32 v24, v24
    v_rcp_f32 v25, v25
    v_rcp_f32 v26, v26
    v_rcp_f32 v27, v27
    v_mul_f32 v24, v20, v24
    v_mul_f32 v25, v21, v25
    v_mul_f32 v26, v22, v26
    v_mul_f32 v27, v23, v27
    v_cvt_pk_bf16_f32 v40, v24, v25
    v_cvt_pk_bf16_f32 v41, v26, v27
    v_lshlrev_b32 v20, 16, v42
    v_and_b32 v21, 0xffff0000, v42
    v_lshlrev_b32 v22, 16, v43
    v_and_b32 v23, 0xffff0000, v43
    v_mul_f32 v24, s34, v20
    v_mul_f32 v25, s34, v21
    v_mul_f32 v26, s34, v22
    v_mul_f32 v27, s34, v23
    v_exp_f32 v24, v24
    v_exp_f32 v25, v25
    v_exp_f32 v26, v26
    v_exp_f32 v27, v27
    v_add_f32 v24, 1.0, v24
    v_add_f32 v25, 1.0, v25
    v_add_f32 v26, 1.0, v26
    v_add_f32 v27, 1.0, v27
    v_rcp_f32 v24, v24
    v_rcp_f32 v25, v25
    v_rcp_f32 v26, v26
    v_rcp_f32 v27, v27
    v_mul_f32 v24, v20, v24
    v_mul_f32 v25, v21, v25
    v_mul_f32 v26, v22, v26
    v_mul_f32 v27, v23, v27
    v_cvt_pk_bf16_f32 v42, v24, v25
    v_cvt_pk_bf16_f32 v43, v26, v27
    v_lshlrev_b32 v20, 16, v44
    v_and_b32 v21, 0xffff0000, v44
    v_lshlrev_b32 v22, 16, v45
    v_and_b32 v23, 0xffff0000, v45
    v_mul_f32 v24, s34, v20
    v_mul_f32 v25, s34, v21
    v_mul_f32 v26, s34, v22
    v_mul_f32 v27, s34, v23
    v_exp_f32 v24, v24
    v_exp_f32 v25, v25
    v_exp_f32 v26, v26
    v_exp_f32 v27, v27
    v_add_f32 v24, 1.0, v24
    v_add_f32 v25, 1.0, v25
    v_add_f32 v26, 1.0, v26
    v_add_f32 v27, 1.0, v27
    v_rcp_f32 v24, v24
    v_rcp_f32 v25, v25
    v_rcp_f32 v26, v26
    v_rcp_f32 v27, v27
    v_mul_f32 v24, v20, v24
    v_mul_f32 v25, v21, v25
    v_mul_f32 v26, v22, v26
    v_mul_f32 v27, v23, v27
    v_cvt_pk_bf16_f32 v44, v24, v25
    v_cvt_pk_bf16_f32 v45, v26, v27
    v_lshlrev_b32 v20, 16, v46
    v_and_b32 v21, 0xffff0000, v46
    v_lshlrev_b32 v22, 16, v47
    v_and_b32 v23, 0xffff0000, v47
    v_mul_f32 v24, s34, v20
    v_mul_f32 v25, s34, v21
    v_mul_f32 v26, s34, v22
    v_mul_f32 v27, s34, v23
    v_exp_f32 v24, v24
    v_exp_f32 v25, v25
    v_exp_f32 v26, v26
    v_exp_f32 v27, v27
    v_add_f32 v24, 1.0, v24
    v_add_f32 v25, 1.0, v25
    v_add_f32 v26, 1.0, v26
    v_add_f32 v27, 1.0, v27
    v_rcp_f32 v24, v24
    v_rcp_f32 v25, v25
    v_rcp_f32 v26, v26
    v_rcp_f32 v27, v27
    v_mul_f32 v24, v20, v24
    v_mul_f32 v25, v21, v25
    v_mul_f32 v26, v22, v26
    v_mul_f32 v27, v23, v27
    v_cvt_pk_bf16_f32 v46, v24, v25
    v_cvt_pk_bf16_f32 v47, v26, v27
    v_lshlrev_b32 v20, 16, v48
    v_and_b32 v21, 0xffff0000, v48
    v_lshlrev_b32 v22, 16, v49
    v_and_b32 v23, 0xffff0000, v49
    v_mul_f32 v24, s34, v20
    v_mul_f32 v25, s34, v21
    v_mul_f32 v26, s34, v22
    v_mul_f32 v27, s34, v23
    v_exp_f32 v24, v24
    v_exp_f32 v25, v25
    v_exp_f32 v26, v26
    v_exp_f32 v27, v27
    v_add_f32 v24, 1.0, v24
    v_add_f32 v25, 1.0, v25
    v_add_f32 v26, 1.0, v26
    v_add_f32 v27, 1.0, v27
    v_rcp_f32 v24, v24
    v_rcp_f32 v25, v25
    v_rcp_f32 v26, v26
    v_rcp_f32 v27, v27
    v_mul_f32 v24, v20, v24
    v_mul_f32 v25, v21, v25
    v_mul_f32 v26, v22, v26
    v_mul_f32 v27, v23, v27
    v_cvt_pk_bf16_f32 v48, v24, v25
    v_cvt_pk_bf16_f32 v49, v26, v27
    v_lshlrev_b32 v20, 16, v50
    v_and_b32 v21, 0xffff0000, v50
    v_lshlrev_b32 v22, 16, v51
    v_and_b32 v23, 0xffff0000, v51
    v_mul_f32 v24, s34, v20
    v_mul_f32 v25, s34, v21
    v_mul_f32 v26, s34, v22
    v_mul_f32 v27, s34, v23
    v_exp_f32 v24, v24
    v_exp_f32 v25, v25
    v_exp_f32 v26, v26
    v_exp_f32 v27, v27
    v_add_f32 v24, 1.0, v24
    v_add_f32 v25, 1.0, v25
    v_add_f32 v26, 1.0, v26
    v_add_f32 v27, 1.0, v27
    v_rcp_f32 v24, v24
    v_rcp_f32 v25, v25
    v_rcp_f32 v26, v26
    v_rcp_f32 v27, v27
    v_mul_f32 v24, v20, v24
    v_mul_f32 v25, v21, v25
    v_mul_f32 v26, v22, v26
    v_mul_f32 v27, v23, v27
    v_cvt_pk_bf16_f32 v50, v24, v25
    v_cvt_pk_bf16_f32 v51, v26, v27
    s_cmp_ge_u32 s52, 10
    s_cbranch_scc1 L_nostats
    v_mov_b32 v20, 0
    v_mov_b32 v21, 0
    v_mov_b32 v22, 0x3f803f80
    v_dot2c_f32_bf16 v20, v52, v22
    v_dot2c_f32_bf16 v21, v52, v52
    v_dot2c_f32_bf16 v20, v53, v22
    v_dot2c_f32_bf16 v21, v53, v53
    v_dot2c_f32_bf16 v20, v54, v22
    v_dot2c_f32_bf16 v21, v54, v54
    v_dot2c_f32_bf16 v20, v55, v22
    v_dot2c_f32_bf16 v21, v55, v55
    v_dot2c_f32_bf16 v20, v56, v22
    v_dot2c_f32_bf16 v21, v56, v56
    v_dot2c_f32_bf16 v20, v57, v22
    v_dot2c_f32_bf16 v21, v57, v57
    v_dot2c_f32_bf16 v20, v58, v22
    v_dot2c_f32_bf16 v21, v58, v58
    v_dot2c_f32_bf16 v20, v59, v22
    v_dot2c_f32_bf16 v21, v59, v59
    v_dot2c_f32_bf16 v20, v60, v22
    v_dot2c_f32_bf16 v21, v60, v60
    v_dot2c_f32_bf16 v20, v61, v22
    v_dot2c_f32_bf16 v21, v61, v61
    v_dot2c_f32_bf16 v20, v62, v22
    v_dot2c_f32_bf16 v21, v62, v62
    v_dot2c_f32_bf16 v20, v63, v22
    v_dot2c_f32_bf16 v21, v63, v63
    v_dot2c_f32_bf16 v20, v64, v22
    v_dot2c_f32_bf16 v21, v64, v64
    v_dot2c_f32_bf16 v20, v65, v22
    v_dot2c_f32_bf16 v21, v65, v65
    v_dot2c_f32_bf16 v20, v66, v22
    v_dot2c_f32_bf16 v21, v66, v66
    v_dot2c_f32_bf16 v20, v67, v22
    v_dot2c_f32_bf16 v21, v67, v67
    v_dot2c_f32_bf16 v20, v68, v22
    v_dot2c_f32_bf16 v21, v68, v68
    v_dot2c_f32_bf16 v20, v69, v22
    v_dot2c_f32_bf16 v21, v69, v69
    v_dot2c_f32_bf16 v20, v70, v22
    v_dot2c_f32_bf16 v21, v70, v70
    v_dot2c_f32_bf16 v20, v71, v22
    v_dot2c_f32_bf16 v21, v71, v71
    s_nop 1
    v_add_f32_dpp v20, v20, v20 row_ror:4 row_mask:0xf bank_mask:0xf
    v_add_f32_dpp v21, v21, v21 row_ror:4 row_mask:0xf bank_mask:0xf
    s_nop 0
    v_add_f32_dpp v20, v20, v20 row_ror:8 row_mask:0xf bank_mask:0xf
    v_add_f32_dpp v21, v21, v21 row_ror:8 row_mask:0xf bank_mask:0xf
    v_mov_b32 v22, v20
    v_mov_b32 v23, v21
    s_nop 0
    v_permlane16_swap_b32 v20, v22
    v_permlane16_swap_b32 v21, v23
    v_add_f32 v20, v20, v22
    v_add_f32 v21, v21, v23
    v_mov_b32 v22, v20
    v_mov_b32 v23, v21
    s_nop 0
    v_permlane32_swap_b32 v20, v22
    v_permlane32_swap_b32 v21, v23
    v_add_f32 v20, v20, v22
    v_add_f32 v21, v21, v23
    v_mul_f32 v22, 0x3acccccd, v20
    v_mul_f32 v21, 0x3acccccd, v21
    v_fma_f32 v21, -v22, v22, v21
    v_max_f32 v21, 0, v21
    v_add_f32 v21, 0x3727c5ac, v21
    v_rsq_f32 v20, v21
    s_nop 0
    v_mul_f32_e64 v21, -v22, v20
    v_lshlrev_b32 v24, 16, v72
    v_and_b32 v25, 0xffff0000, v72
    v_lshlrev_b32 v26, 16, v73
    v_and_b32 v27, 0xffff0000, v73
    v_fma_f32 v24, v24, v20, v21
    v_fma_f32 v25, v25, v20, v21
    v_fma_f32 v26, v26, v20, v21
    v_fma_f32 v27, v27, v20, v21
L_nostats:
    s_waitcnt vmcnt(21)
    ds_read_b64_tr_b16 v[96:97], v15 offset:0
    ds_read_b64_tr_b16 v[98:99], v15 offset:512
    ds_read_b64_tr_b16 v[100:101], v15 offset:32
    ds_read_b64_tr_b16 v[102:103], v15 offset:544
    ds_read_b64_tr_b16 v[104:105], v15 offset:64
    ds_read_b64_tr_b16 v[106:107], v15 offset:576
    ds_read_b64_tr_b16 v[108:109], v15 offset:96
    ds_read_b64_tr_b16 v[110:111], v15 offset:608
    s_waitcnt lgkmcnt(7)
    ds_read_b64_tr_b16 v[112:113], v15 offset:4096
    ds_read_b64_tr_b16 v[114:115], v15 offset:4608
    ds_read_b64_tr_b16 v[116:117], v15 offset:4128
    ds_read_b64_tr_b16 v[118:119], v15 offset:4640
    ds_read_b64_tr_b16 v[120:121], v15 offset:4160
    ds_read_b64_tr_b16 v[122:123], v15 offset:4672
    ds_read_b64_tr_b16 v[124:125], v15 offset:4192
    ds_read_b64_tr_b16 v[126:127], v15 offset:4704
    s_waitcnt lgkmcnt(7)
    ds_read_b64_tr_b16 v[128:129], v15 offset:8192
    ds_read_b64_tr_b16 v[130:131], v15 offset:8704
    ds_read_b64_tr_b16 v[132:133], v15 offset:8224
    ds_read_b64_tr_b16 v[134:135], v15 offset:8736
    ds_read_b64_tr_b16 v[136:137], v15 offset:8256
    ds_read_b64_tr_b16 v[138:139], v15 offset:8768
    ds_read_b64_tr_b16 v[140:141], v15 offset:8288
    ds_read_b64_tr_b16 v[142:143], v15 offset:8800
    s_waitcnt lgkmcnt(7)
    ds_read_b64_tr_b16 v[144:145], v15 offset:12288
    ds_read_b64_tr_b16 v[146:147], v15 offset:12800
    ds_read_b64_tr_b16 v[148:149], v15 offset:12320
    ds_read_b64_tr_b16 v[150:151], v15 offset:12832
    ds_read_b64_tr_b16 v[152:153], v15 offset:12352
    ds_read_b64_tr_b16 v[154:155], v15 offset:12864
    ds_read_b64_tr_b16 v[156:157], v15 offset:12384
    ds_read_b64_tr_b16 v[158:159], v15 offset:12896
    s_waitcnt lgkmcnt(7)
    ds_read_b64_tr_b16 v[160:161], v15 offset:16384
    ds_read_b64_tr_b16 v[162:163], v15 offset:16896
    ds_read_b64_tr_b16 v[164:165], v15 offset:16416
    ds_read_b64_tr_b16 v[166:167], v15 offset:16928
    ds_read_b64_tr_b16 v[168:169], v15 offset:16448
    ds_read_b64_tr_b16 v[170:171], v15 offset:16960
    ds_read_b64_tr_b16 v[172:173], v15 offset:16480
    ds_read_b64_tr_b16 v[174:175], v15 offset:16992
    s_waitcnt lgkmcnt(0)
    v_mfma_f32_16x16x32_bf16 v[80:83], v[96:99], v[32:35], 0
    v_mfma_f32_16x16x32_bf16 v[84:87], v[100:103], v[32:35], 0
    v_mfma_f32_16x16x32_bf16 v[88:91], v[104:107], v[32:35], 0
    v_mfma_f32_16x16x32_bf16 v[92:95], v[108:111], v[32:35], 0
    v_mfma_f32_16x16x32_bf16 v[80:83], v[112:115], v[36:39], v[80:83]
    v_mfma_f32_16x16x32_bf16 v[84:87], v[116:119], v[36:39], v[84:87]
    v_mfma_f32_16x16x32_bf16 v[88:91], v[120:123], v[36:39], v[88:91]
    v_mfma_f32_16x16x32_bf16 v[92:95], v[124:127], v[36:39], v[92:95]
    v_mfma_f32_16x16x32_bf16 v[80:83], v[128:131], v[40:43], v[80:83]
    v_mfma_f32_16x16x32_bf16 v[84:87], v[132:135], v[40:43], v[84:87]
    v_mfma_f32_16x16x32_bf16 v[88:91], v[136:139], v[40:43], v[88:91]
    v_mfma_f32_16x16x32_bf16 v[92:95], v[140:143], v[40:43], v[92:95]
    v_mfma_f32_16x16x32_bf16 v[80:83], v[144:147], v[44:47], v[80:83]
    v_mfma_f32_16x16x32_bf16 v[84:87], v[148:151], v[44:47], v[84:87]
    v_mfma_f32_16x16x32_bf16 v[88:91], v[152:155], v[44:47], v[88:91]
    v_mfma_f32_16x16x32_bf16 v[92:95], v[156:159], v[44:47], v[92:95]
    v_mfma_f32_16x16x32_bf16 v[80:83], v[160:163], v[48:51], v[80:83]
    v_mfma_f32_16x16x32_bf16 v[84:87], v[164:167], v[48:51], v[84:87]
    v_mfma_f32_16x16x32_bf16 v[88:91], v[168:171], v[48:51], v[88:91]
    v_mfma_f32_16x16x32_bf16 v[92:95], v[172:175], v[48:51], v[92:95]
    s_cmp_ge_u32 s50, 20
    s_cbranch_scc1 L_adr_rest
    s_cmp_lt_u32 s50, 10
    s_cselect_b32 s34, 5120, 0
    s_cselect_b32 s35, s50, s52
    s_lshl_b32 s35, s35, 9
    s_add_u32 s34, s34, s35
    s_lshl_b32 s35, s51, 18
    s_add_u32 s34, s34, s35
    v_lshrrev_b32 v19, 1, v14
    v_lshl_add_u32 v19, v13, 1, v19
    v_lshlrev_b32 v19, 6, v19
    v_lshl_add_u32 v19, v12, 4, v19
    v_and_b32 v20, 1, v14
    v_lshl_add_u32 v19, v20, 3, v19
    s_branch L_adr_done
L_adr_rest:
    s_lshl_b32 s34, s51, 18
    s_lshl_b32 s35, s50, 9
    s_add_u32 s34, s34, s35
    s_add_u32 s34, s34, 0
    v_lshlrev_b32 v19, 7, v12
    v_lshl_add_u32 v19, v13, 5, v19
    v_lshl_add_u32 v19, v14, 3, v19
    s_nop 3
L_adr_done:
    v_add_u32 v19, s34, v19
    v_mov_b32_dpp v80, v84 quad_perm:[0,1,2,3] row_mask:0xf bank_mask:0x2
    v_mov_b32_dpp v81, v85 quad_perm:[0,1,2,3] row_mask:0xf bank_mask:0x2
    v_mov_b32_dpp v82, v86 quad_perm:[0,1,2,3] row_mask:0xf bank_mask:0x2
    v_mov_b32_dpp v83, v87 quad_perm:[0,1,2,3] row_mask:0xf bank_mask:0x2
    v_mov_b32_dpp v80, v88 quad_perm:[0,1,2,3] row_mask:0xf bank_mask:0x4
    v_mov_b32_dpp v81, v89 quad_perm:[0,1,2,3] row_mask:0xf bank_mask:0x4
    v_mov_b32_dpp v82, v90 quad_perm:[0,1,2,3] row_mask:0xf bank_mask:0x4
    v_mov_b32_dpp v83, v91 quad_perm:[0,1,2,3] row_mask:0xf bank_mask:0x4
    v_mov_b32_dpp v80, v92 quad_perm:[0,1,2,3] row_mask:0xf bank_mask:0x8
    v_mov_b32_dpp v81, v93 quad_perm:[0,1,2,3] row_mask:0xf bank_mask:0x8
    v_mov_b32_dpp v82, v94 quad_perm:[0,1,2,3] row_mask:0xf bank_mask:0x8
    v_mov_b32_dpp v83, v95 quad_perm:[0,1,2,3] row_mask:0xf bank_mask:0x8
    s_cmp_ge_u32 s52, 10
    s_cbranch_scc1 L_noz
    v_add_f32 v80, 0x3e800000, v80
    v_add_f32 v81, 0x3e800000, v81
    v_add_f32 v82, 0x3e800000, v82
    v_add_f32 v83, 0x3e800000, v83
    v_mul_f32 v80, v80, v24
    v_mul_f32 v81, v81, v25
    v_mul_f32 v82, v82, v26
    v_mul_f32 v83, v83, v27
L_noz:
    v_cvt_pk_bf16_f32 v20, v80, v81
    v_cvt_pk_bf16_f32 v21, v82, v83
    v_min_u32 v20, -2, v20
    v_min_u32 v21, -2, v21
    v_and_b32 v22, 15, v0
    v_lshlrev_b32 v22, 2, v22
    s_mov_b32 s35, 0
L_poll4:
    global_load_dword v23, v22, s[30:31] offset:128 sc1
    s_add_u32 s35, s35, 1
    s_waitcnt vmcnt(0)
    v_cmp_eq_u32 vcc, 0, v23
    s_cbranch_vccz L_done5
    s_sleep 8
    s_cmp_lt_u32 s35, 60000
    s_cbranch_scc1 L_poll4
L_done5:
    s_getreg_b32 s97, hwreg(HW_REG_XCC_ID, 0, 4)
    s_sub_u32 s97, s97, s2
    s_and_b32 s97, s97, 7
    s_add_u32 s97, s97, 1
    v_cmp_ne_u32 vcc, s97, v23
    s_nop 0
    s_mov_b32 s97, vcc_lo
    buffer_store_dwordx2 v[20:21], v19, s[44:47], 0 offen sc1
    s_branch L_p2
L_clear:
    s_sub_u32 s55, s2, 240
    s_lshr_b32 s34, s55, 2
    s_lshl_b32 s35, s34, 3
    s_lshr_b32 s54, 538910755, s35
    s_and_b32 s54, s54, 0xff
    s_lshl_b32 s54, s54, 10
    s_mul_i32 s34, s34, 49152
    s_lshl_b32 s35, s51, 18
    s_add_u32 s34, s34, s35
    v_lshl_add_u32 v19, v0, 4, s34
    v_mov_b32 v20, -1
    v_mov_b32 v21, -1
    v_mov_b32 v22, -1
    v_mov_b32 v23, -1
    s_mov_b32 s34, 0
L_clrloop:
    buffer_store_dwordx4 v[20:23], v19, s[44:47], s34 offen offset:0 sc1
    s_add_u32 s34, s34, 1024
    s_cmp_lt_u32 s34, s54
    s_cbranch_scc1 L_clrloop
    v_lshlrev_b32 v1, 2, v0
    v_add_u32 v1, 98304, v1
    v_mov_b32 v2, -1
    v_mov_b32 v3, 0
    ds_write_b32 v1, v2
    ds_write_b32 v1, v2 offset:256
    ds_write_b32 v1, v3 offset:512
    ds_write_b32 v1, v3 offset:768
    s_waitcnt lgkmcnt(0)
    s_barrier
    s_lshl_b32 s34, s55, 2
    v_mov_b32 v24, s34
    s_getreg_b32 s97, hwreg(HW_REG_XCC_ID, 0, 4)
    s_sub_u32 s97, s97, s2
    s_and_b32 s97, s97, 7
    s_add_u32 s97, s97, 1
    v_mov_b32 v25, s97
    v_readfirstlane_b32 s90, v19
    s_mov_b32 s91, 0
    s_waitcnt vmcnt(0)
    s_mov_b64 exec, 1
    global_store_dword v24, v25, s[30:31] offset:128 sc1
    s_mov_b64 exec, -1
    s_getpc_b64 s[56:57]
L_pc7:
    s_sub_u32 s56, s56, L_pc7-adaLN_cond__sliding_block_cached__dense_activation_gelu__decode_kernel
    s_subb_u32 s57, s57, 0
    s_lshl_b32 s34, s61, 10
    v_lshl_add_u32 v9, v0, 4, s34
    v_min_u32 v9, L_codeend-adaLN_cond__sliding_block_cached__dense_activation_gelu__decode_kernel-16, v9
    global_load_dwordx4 v[76:79], v9, s[56:57]
    s_and_b32 s34, s2, 31
    s_lshl_b32 s34, s34, 8
    s_lshr_b32 s35, s2, 7
    s_lshl_b32 s35, s35, 7
    s_add_u32 s49, s34, s35
    s_bfe_u32 s53, s2, 0x20005
    s_mul_i32 s34, s53, 1310720
    s_add_u32 s34, s34, s49
    v_lshl_add_u32 v16, v10, 13, v11
    v_add_u32 v16, s34, v16
    s_mov_b32 s36, s10
    s_mov_b32 s37, s11
    s_mov_b32 s38, 5242880
    s_mov_b32 m0, 20480
    s_mov_b32 s34, 0
L_dma8:
    buffer_load_dwordx4 v16, s[36:39], s34 offen  lds
    s_add_u32 m0, m0, 1024
    s_add_u32 s34, s34, 65536
    buffer_load_dwordx4 v16, s[36:39], s34 offen  lds
    s_add_u32 m0, m0, 1024
    s_add_u32 s34, s34, 65536
    buffer_load_dwordx4 v16, s[36:39], s34 offen  lds
    s_add_u32 m0, m0, 1024
    s_add_u32 s34, s34, 65536
    buffer_load_dwordx4 v16, s[36:39], s34 offen  lds
    s_add_u32 m0, m0, 1024
    s_add_u32 s34, s34, 65536
    s_cmp_lt_u32 s34, 1310720
    s_cbranch_scc1 L_dma8
    v_lshl_add_u32 v15, v14, 3, v13
    v_lshlrev_b32 v15, 7, v15
    v_lshl_add_u32 v15, v12, 3, v15
    s_add_u32 s34, s90, 0
    s_add_u32 s35, s90, 8192
    s_mov_b64 s[88:89], 0
    s_load_dword s88, s[44:45], s34
    s_load_dword s89, s[44:45], s35
    s_waitcnt lgkmcnt(1)
    s_cmp_lg_u32 s89, 0
    s_addc_u32 s91, s91, 0
    s_waitcnt lgkmcnt(0)
    s_add_u32 s34, s90, 1024
    s_add_u32 s35, s90, 9216
    s_mov_b64 s[88:89], 0
    s_load_dword s89, s[44:45], s35
    s_load_dword s88, s[44:45], s34
    s_waitcnt lgkmcnt(1)
    s_cmp_eq_u32 s88, 0
    s_addc_u32 s91, s91, 0
    s_waitcnt lgkmcnt(0)
    s_add_u32 s34, s90, 2048
    s_add_u32 s35, s90, 10240
    s_mov_b64 s[88:89], 0
    s_load_dword s88, s[44:45], s34
    s_load_dword s89, s[44:45], s35
    s_waitcnt lgkmcnt(1)
    s_cmp_lg_u32 s89, 0
    s_addc_u32 s91, s91, 0
    s_waitcnt lgkmcnt(0)
    s_add_u32 s34, s90, 3072
    s_add_u32 s35, s90, 11264
    s_mov_b64 s[88:89], 0
    s_load_dword s89, s[44:45], s35
    s_load_dword s88, s[44:45], s34
    s_waitcnt lgkmcnt(1)
    s_cmp_eq_u32 s88, 0
    s_addc_u32 s91, s91, 0
    s_waitcnt lgkmcnt(0)
    s_getreg_b32 s34, hwreg(HW_REG_XCC_ID, 2, 1)
    s_sub_u32 s35, 2, s91
    s_sub_u32 s91, s91, 2
    s_cmp_eq_u32 s34, 0
    s_cselect_b32 s91, s91, s35
    v_mov_b32 v25, s91
    s_mov_b64 exec, 1
    global_store_dword v24, v25, s[30:31] sc1
    s_mov_b64 exec, -1
    v_and_b32 v22, 15, v0
    v_lshlrev_b32 v22, 2, v22
    s_mov_b32 s35, 0
L_poll9:
    global_load_dword v23, v22, s[30:31] offset:128 sc1
    s_add_u32 s35, s35, 1
    s_waitcnt vmcnt(0)
    v_cmp_eq_u32 vcc, 0, v23
    s_cbranch_vccz L_done10
    s_sleep 8
    s_cmp_lt_u32 s35, 60000
    s_cbranch_scc1 L_poll9
L_done10:
    s_getreg_b32 s97, hwreg(HW_REG_XCC_ID, 0, 4)
    s_sub_u32 s97, s97, s2
    s_and_b32 s97, s97, 7
    s_add_u32 s97, s97, 1
    v_cmp_ne_u32 vcc, s97, v23
    s_nop 0
    s_mov_b32 s97, vcc_lo
L_p2:
    v_mov_b32 v199, v19
    ds_read_b64_tr_b16 v[96:97], v15 offset:20480
    ds_read_b64_tr_b16 v[98:99], v15 offset:20992
    ds_read_b64_tr_b16 v[100:101], v15 offset:20512
    ds_read_b64_tr_b16 v[102:103], v15 offset:21024
    ds_read_b64_tr_b16 v[104:105], v15 offset:20544
    ds_read_b64_tr_b16 v[106:107], v15 offset:21056
    ds_read_b64_tr_b16 v[108:109], v15 offset:20576
    ds_read_b64_tr_b16 v[110:111], v15 offset:21088
    s_waitcnt lgkmcnt(7)
    ds_read_b64_tr_b16 v[112:113], v15 offset:24576
    ds_read_b64_tr_b16 v[114:115], v15 offset:25088
    ds_read_b64_tr_b16 v[116:117], v15 offset:24608
    ds_read_b64_tr_b16 v[118:119], v15 offset:25120
    ds_read_b64_tr_b16 v[120:121], v15 offset:24640
    ds_read_b64_tr_b16 v[122:123], v15 offset:25152
    ds_read_b64_tr_b16 v[124:125], v15 offset:24672
    ds_read_b64_tr_b16 v[126:127], v15 offset:25184
    s_waitcnt lgkmcnt(7)
    ds_read_b64_tr_b16 v[128:129], v15 offset:28672
    ds_read_b64_tr_b16 v[130:131], v15 offset:29184
    ds_read_b64_tr_b16 v[132:133], v15 offset:28704
    ds_read_b64_tr_b16 v[134:135], v15 offset:29216
    ds_read_b64_tr_b16 v[136:137], v15 offset:28736
    ds_read_b64_tr_b16 v[138:139], v15 offset:29248
    ds_read_b64_tr_b16 v[140:141], v15 offset:28768
    ds_read_b64_tr_b16 v[142:143], v15 offset:29280
    s_waitcnt lgkmcnt(7)
    ds_read_b64_tr_b16 v[144:145], v15 offset:32768
    ds_read_b64_tr_b16 v[146:147], v15 offset:33280
    ds_read_b64_tr_b16 v[148:149], v15 offset:32800
    ds_read_b64_tr_b16 v[150:151], v15 offset:33312
    ds_read_b64_tr_b16 v[152:153], v15 offset:32832
    ds_read_b64_tr_b16 v[154:155], v15 offset:33344
    ds_read_b64_tr_b16 v[156:157], v15 offset:32864
    ds_read_b64_tr_b16 v[158:159], v15 offset:33376
    s_waitcnt lgkmcnt(7)
    ds_read_b64_tr_b16 v[160:161], v15 offset:36864
    ds_read_b64_tr_b16 v[162:163], v15 offset:37376
    ds_read_b64_tr_b16 v[164:165], v15 offset:36896
    ds_read_b64_tr_b16 v[166:167], v15 offset:37408
    ds_read_b64_tr_b16 v[168:169], v15 offset:36928
    ds_read_b64_tr_b16 v[170:171], v15 offset:37440
    ds_read_b64_tr_b16 v[172:173], v15 offset:36960
    ds_read_b64_tr_b16 v[174:175], v15 offset:37472
    s_waitcnt lgkmcnt(0)
    s_mul_i32 s34, s53, 1280
    v_lshlrev_b32 v19, 18, v13
    v_lshl_add_u32 v19, v14, 6, v19
    v_lshl_add_u32 v19, v12, 4, v19
    v_add_u32 v19, s34, v19
    s_movk_i32 s48, 5120
    s_mov_b32 s56, 262144
    s_mov_b32 s57, 524288
    s_mov_b32 s58, 786432
    s_sub_u32 s34, s2, 80
    s_cmp_lt_u32 s34, 160
    s_cselect_b32 s54, 1, 0
    s_and_b32 s34, s2, 3
    s_cselect_b32 s54, 0, s54
    v_mov_b32 v180, 0
    v_mov_b32 v181, 0
    v_mov_b32 v182, 0
    v_mov_b32 v183, 0
    v_mov_b32 v184, 0
    v_mov_b32 v185, 0
    v_mov_b32 v186, 0
    v_mov_b32 v187, 0
    v_mov_b32 v22, 99072
    s_mov_b32 s35, 0
L_poll12:
    ds_read_b32 v23, v22
    s_add_u32 s35, s35, 1
    s_waitcnt lgkmcnt(0)
    v_cmp_gt_u32 vcc, 19, v23
    s_cbranch_vccz L_done13
    s_sleep 2
    s_cmp_lt_u32 s35, 60000
    s_cbranch_scc1 L_poll12
L_done13:
    s_mov_b32 s35, 0
L_poll15:
    buffer_load_dwordx4 v[32:35], v19, s[44:47], 0 offen offset:0 sc1
    buffer_load_dwordx4 v[36:39], v19, s[44:47], s48 offen offset:0 sc1
    buffer_load_dwordx4 v[40:43], v19, s[44:47], 0 offen offset:256 sc1
    buffer_load_dwordx4 v[44:47], v19, s[44:47], s48 offen offset:256 sc1
    buffer_load_dwordx4 v[48:51], v19, s[44:47], 0 offen offset:512 sc1
    buffer_load_dwordx4 v[52:55], v19, s[44:47], s48 offen offset:512 sc1
    buffer_load_dwordx4 v[56:59], v19, s[44:47], 0 offen offset:768 sc1
    buffer_load_dwordx4 v[60:63], v19, s[44:47], s48 offen offset:768 sc1
    buffer_load_dwordx4 v[64:67], v19, s[44:47], 0 offen offset:1024 sc1
    buffer_load_dwordx4 v[68:71], v19, s[44:47], s48 offen offset:1024 sc1
    s_cmp_eq_u32 s54, 0
    s_cbranch_scc1 L_hskip
    buffer_load_dwordx2 v[180:181], v199, s[44:47], 0 offen sc1
    buffer_load_dwordx2 v[182:183], v199, s[44:47], s56 offen sc1
    buffer_load_dwordx2 v[184:185], v199, s[44:47], s57 offen sc1
    buffer_load_dwordx2 v[186:187], v199, s[44:47], s58 offen sc1
L_hskip:
    s_add_u32 s35, s35, 1
    s_waitcnt vmcnt(0)
    v_max3_u32 v20, v32, v33, v34
    v_max3_u32 v20, v20, v35, v36
    v_max3_u32 v20, v20, v37, v38
    v_max3_u32 v20, v20, v39, v40
    v_max3_u32 v20, v20, v41, v42
    v_max3_u32 v20, v20, v43, v44
    v_max3_u32 v20, v20, v45, v46
    v_max3_u32 v20, v20, v47, v48
    v_max3_u32 v20, v20, v49, v50
    v_max3_u32 v20, v20, v51, v52
    v_max3_u32 v20, v20, v53, v54
    v_max3_u32 v20, v20, v55, v56
    v_max3_u32 v20, v20, v57, v58
    v_max3_u32 v20, v20, v59, v60
    v_max3_u32 v20, v20, v61, v62
    v_max3_u32 v20, v20, v63, v64
    v_max3_u32 v20, v20, v65, v66
    v_max3_u32 v20, v20, v67, v68
    v_max3_u32 v20, v20, v69, v70
    v_max3_u32 v20, v20, v71, v180
    v_max3_u32 v20, v20, v181, v182
    v_max3_u32 v20, v20, v183, v184
    v_max3_u32 v20, v20, v185, v186
    v_max_u32 v20, v20, v187
    v_cmp_eq_u32 vcc, -1, v20
    s_cbranch_vccz L_done16
    s_sleep 16
    s_cmp_lt_u32 s35, 60000
    s_cbranch_scc1 L_poll15
L_done16:
    v_mfma_f32_16x16x32_bf16 v[80:83], v[96:99], v[32:35], 0
    v_mfma_f32_16x16x32_bf16 v[84:87], v[100:103], v[32:35], 0
    v_mfma_f32_16x16x32_bf16 v[88:91], v[104:107], v[32:35], 0
    v_mfma_f32_16x16x32_bf16 v[92:95], v[108:111], v[32:35], 0
    v_mfma_f32_16x16x32_bf16 v[80:83], v[96:99], v[36:39], v[80:83]
    v_mfma_f32_16x16x32_bf16 v[84:87], v[100:103], v[36:39], v[84:87]
    v_mfma_f32_16x16x32_bf16 v[88:91], v[104:107], v[36:39], v[88:91]
    v_mfma_f32_16x16x32_bf16 v[92:95], v[108:111], v[36:39], v[92:95]
    v_mfma_f32_16x16x32_bf16 v[80:83], v[112:115], v[40:43], v[80:83]
    v_mfma_f32_16x16x32_bf16 v[84:87], v[116:119], v[40:43], v[84:87]
    v_mfma_f32_16x16x32_bf16 v[88:91], v[120:123], v[40:43], v[88:91]
    v_mfma_f32_16x16x32_bf16 v[92:95], v[124:127], v[40:43], v[92:95]
    v_mfma_f32_16x16x32_bf16 v[80:83], v[112:115], v[44:47], v[80:83]
    v_mfma_f32_16x16x32_bf16 v[84:87], v[116:119], v[44:47], v[84:87]
    v_mfma_f32_16x16x32_bf16 v[88:91], v[120:123], v[44:47], v[88:91]
    v_mfma_f32_16x16x32_bf16 v[92:95], v[124:127], v[44:47], v[92:95]
    v_mfma_f32_16x16x32_bf16 v[80:83], v[128:131], v[48:51], v[80:83]
    v_mfma_f32_16x16x32_bf16 v[84:87], v[132:135], v[48:51], v[84:87]
    v_mfma_f32_16x16x32_bf16 v[88:91], v[136:139], v[48:51], v[88:91]
    v_mfma_f32_16x16x32_bf16 v[92:95], v[140:143], v[48:51], v[92:95]
    v_mfma_f32_16x16x32_bf16 v[80:83], v[128:131], v[52:55], v[80:83]
    v_mfma_f32_16x16x32_bf16 v[84:87], v[132:135], v[52:55], v[84:87]
    v_mfma_f32_16x16x32_bf16 v[88:91], v[136:139], v[52:55], v[88:91]
    v_mfma_f32_16x16x32_bf16 v[92:95], v[140:143], v[52:55], v[92:95]
    v_mfma_f32_16x16x32_bf16 v[80:83], v[144:147], v[56:59], v[80:83]
    v_mfma_f32_16x16x32_bf16 v[84:87], v[148:151], v[56:59], v[84:87]
    v_mfma_f32_16x16x32_bf16 v[88:91], v[152:155], v[56:59], v[88:91]
    v_mfma_f32_16x16x32_bf16 v[92:95], v[156:159], v[56:59], v[92:95]
    v_mfma_f32_16x16x32_bf16 v[80:83], v[144:147], v[60:63], v[80:83]
    v_mfma_f32_16x16x32_bf16 v[84:87], v[148:151], v[60:63], v[84:87]
    v_mfma_f32_16x16x32_bf16 v[88:91], v[152:155], v[60:63], v[88:91]
    v_mfma_f32_16x16x32_bf16 v[92:95], v[156:159], v[60:63], v[92:95]
    v_mfma_f32_16x16x32_bf16 v[80:83], v[160:163], v[64:67], v[80:83]
    v_mfma_f32_16x16x32_bf16 v[84:87], v[164:167], v[64:67], v[84:87]
    v_mfma_f32_16x16x32_bf16 v[88:91], v[168:171], v[64:67], v[88:91]
    v_mfma_f32_16x16x32_bf16 v[92:95], v[172:175], v[64:67], v[92:95]
    v_mfma_f32_16x16x32_bf16 v[80:83], v[160:163], v[68:71], v[80:83]
    v_mfma_f32_16x16x32_bf16 v[84:87], v[164:167], v[68:71], v[84:87]
    v_mfma_f32_16x16x32_bf16 v[88:91], v[168:171], v[68:71], v[88:91]
    v_mfma_f32_16x16x32_bf16 v[92:95], v[172:175], v[68:71], v[92:95]
    s_lshl_b32 s34, s53, 18
    s_lshl_b32 s35, s49, 2
    s_add_u32 s34, s34, s35
    s_add_u32 s34, s34, 49152
    v_lshlrev_b32 v19, 7, v12
    v_lshl_add_u32 v19, v13, 5, v19
    v_lshl_add_u32 v19, v14, 3, v19
    v_add_u32 v19, s34, v19
    v_add_f32_dpp v20, v80, v80 row_ror:8 row_mask:0xf bank_mask:0x3
    v_add_f32_dpp v24, v84, v84 row_ror:8 row_mask:0xf bank_mask:0x3
    v_add_f32_dpp v21, v81, v81 row_ror:8 row_mask:0xf bank_mask:0x3
    v_add_f32_dpp v25, v85, v85 row_ror:8 row_mask:0xf bank_mask:0x3
    v_add_f32_dpp v22, v82, v82 row_ror:8 row_mask:0xf bank_mask:0x3
    v_add_f32_dpp v26, v86, v86 row_ror:8 row_mask:0xf bank_mask:0x3
    v_add_f32_dpp v23, v83, v83 row_ror:8 row_mask:0xf bank_mask:0x3
    v_add_f32_dpp v27, v87, v87 row_ror:8 row_mask:0xf bank_mask:0x3
    v_add_f32_dpp v20, v88, v88 row_ror:8 row_mask:0xf bank_mask:0xc
    v_add_f32_dpp v24, v92, v92 row_ror:8 row_mask:0xf bank_mask:0xc
    v_add_f32_dpp v21, v89, v89 row_ror:8 row_mask:0xf bank_mask:0xc
    v_add_f32_dpp v25, v93, v93 row_ror:8 row_mask:0xf bank_mask:0xc
    v_add_f32_dpp v22, v90, v90 row_ror:8 row_mask:0xf bank_mask:0xc
    v_add_f32_dpp v26, v94, v94 row_ror:8 row_mask:0xf bank_mask:0xc
    v_add_f32_dpp v23, v91, v91 row_ror:8 row_mask:0xf bank_mask:0xc
    v_add_f32_dpp v27, v95, v95 row_ror:8 row_mask:0xf bank_mask:0xc
    v_add_f32_dpp v28, v20, v20 row_shl:4 row_mask:0xf bank_mask:0x5
    v_add_f32_dpp v29, v21, v21 row_shl:4 row_mask:0xf bank_mask:0x5
    v_add_f32_dpp v30, v22, v22 row_shl:4 row_mask:0xf bank_mask:0x5
    v_add_f32_dpp v31, v23, v23 row_shl:4 row_mask:0xf bank_mask:0x5
    v_add_f32_dpp v28, v24, v24 row_shr:4 row_mask:0xf bank_mask:0xa
    v_add_f32_dpp v29, v25, v25 row_shr:4 row_mask:0xf bank_mask:0xa
    v_add_f32_dpp v30, v26, v26 row_shr:4 row_mask:0xf bank_mask:0xa
    v_add_f32_dpp v31, v27, v27 row_shr:4 row_mask:0xf bank_mask:0xa
    v_cvt_pk_bf16_f32 v20, v28, v29
    v_cvt_pk_bf16_f32 v21, v30, v31
    v_min_u32 v20, -2, v20
    v_min_u32 v21, -2, v21
    buffer_store_dwordx2 v[20:21], v19, s[44:47], 0 offen sc1
    s_cmp_eq_u32 s54, 0
    s_cbranch_scc1 L_nomf
    v_lshlrev_b32 v24, 16, v180
    v_and_b32 v25, 0xffff0000, v180
    v_lshlrev_b32 v26, 16, v181
    v_and_b32 v27, 0xffff0000, v181
    v_lshlrev_b32 v28, 16, v182
    v_and_b32 v29, 0xffff0000, v182
    v_lshlrev_b32 v30, 16, v183
    v_and_b32 v31, 0xffff0000, v183
    v_add_f32 v24, v24, v28
    v_add_f32 v25, v25, v29
    v_add_f32 v26, v26, v30
    v_add_f32 v27, v27, v31
    v_lshlrev_b32 v28, 16, v184
    v_and_b32 v29, 0xffff0000, v184
    v_lshlrev_b32 v30, 16, v185
    v_and_b32 v31, 0xffff0000, v185
    v_add_f32 v24, v24, v28
    v_add_f32 v25, v25, v29
    v_add_f32 v26, v26, v30
    v_add_f32 v27, v27, v31
    v_lshlrev_b32 v28, 16, v186
    v_and_b32 v29, 0xffff0000, v186
    v_lshlrev_b32 v30, 16, v187
    v_and_b32 v31, 0xffff0000, v187
    v_add_f32 v24, v24, v28
    v_add_f32 v25, v25, v29
    v_add_f32 v26, v26, v30
    v_add_f32 v27, v27, v31
    v_cvt_pk_bf16_f32 v22, v24, v25
    v_cvt_pk_bf16_f32 v23, v26, v27
    v_min_u32 v22, -2, v22
    v_min_u32 v23, -2, v23
    s_sub_u32 s34, s50, 20
    s_lshl_b32 s35, s34, 9
    v_subrev_u32 v199, s35, v199
    s_lshr_b32 s35, s34, 2
    s_lshl_b32 s35, s35, 9
    s_and_b32 s34, s34, 3
    s_lshl_b32 s34, s34, 18
    s_add_u32 s34, s34, s35
    s_add_u32 s34, s34, 20480
    v_add_u32 v199, s34, v199
    buffer_store_dwordx2 v[22:23], v199, s[44:47], 0 offen sc1
L_nomf:
    s_and_b32 s34, s2, 127
    s_lshl_b32 s34, s34, 21
    s_lshr_b32 s35, s2, 7
    s_lshl_b32 s35, s35, 18
    s_add_u32 s34, s34, s35
    s_add_u32 s34, s34, 1572864
    s_mov_b32 s38, 0x40000
    s_mov_b32 s42, 0x40000
    s_waitcnt lgkmcnt(0)
    s_add_u32 s36, s6, s34
    s_addc_u32 s37, s7, 0
    s_add_u32 s40, s8, s34
    s_addc_u32 s41, s9, 0
    v_lshlrev_b32 v18, 4, v0
    s_mov_b32 s34, 258048
    buffer_load_dwordx4 v[128:131], v18, s[36:39], s34 offen offset:0 nt
    buffer_load_dwordx4 v[132:135], v18, s[36:39], s34 offen offset:1024 nt
    buffer_load_dwordx4 v[136:139], v18, s[36:39], s34 offen offset:2048 nt
    buffer_load_dwordx4 v[140:143], v18, s[36:39], s34 offen offset:3072 nt
    s_and_b32 s34, s2, 31
    s_lshl_b32 s34, s34, 10
    s_lshl_b32 s35, s53, 7
    s_add_u32 s34, s34, s35
    s_add_u32 s34, s34, 49152
    v_lshrrev_b32 v19, 5, v0
    v_mul_u32_u24 v19, 384, v19
    v_lshl_add_u32 v19, v0, 2, v19
    v_add_u32 v19, s34, v19
    v_mov_b32 v22, 99072
    s_mov_b32 s35, 0
L_poll18:
    ds_read_b32 v23, v22
    s_add_u32 s35, s35, 1
    s_waitcnt lgkmcnt(0)
    v_cmp_gt_u32 vcc, 31, v23
    s_cbranch_vccz L_done19
    s_sleep 2
    s_cmp_lt_u32 s35, 60000
    s_cbranch_scc1 L_poll18
L_done19:
    v_and_b32 v44, 15, v0
    v_lshlrev_b32 v44, 2, v44
    global_load_dword v44, v44, s[30:31] sc1
    s_mov_b32 s35, 0
L_poll21:
    buffer_load_dword v32, v19, s[44:47], 0 offen sc1
    buffer_load_dword v33, v19, s[44:47], s56 offen sc1
    buffer_load_dword v34, v19, s[44:47], s57 offen sc1
    buffer_load_dword v35, v19, s[44:47], s58 offen sc1
    s_add_u32 s35, s35, 1
    s_waitcnt vmcnt(0)
    v_max3_u32 v22, v32, v33, v34
    v_max_u32 v22, v22, v35
    v_cmp_eq_u32 vcc, -1, v22
    s_cbranch_vccz L_done22
    s_sleep 16
    s_cmp_lt_u32 s35, 60000
    s_cbranch_scc1 L_poll21
L_done22:
    v_add_u32_dpp v44, v44, v44 row_ror:8 row_mask:0xf bank_mask:0xf
    s_nop 1
    v_add_u32_dpp v44, v44, v44 row_ror:4 row_mask:0xf bank_mask:0xf
    s_nop 1
    v_add_u32_dpp v44, v44, v44 row_ror:2 row_mask:0xf bank_mask:0xf
    s_nop 1
    v_add_u32_dpp v44, v44, v44 row_ror:1 row_mask:0xf bank_mask:0xf
    s_nop 0
    v_readfirstlane_b32 s99, v44
    s_nop 0
    s_cmp_gt_i32 s99, 0
    s_cselect_b32 s99, 1, 0
    s_getreg_b32 s34, hwreg(HW_REG_XCC_ID, 2, 1)
    s_xor_b32 s99, s99, s34
    s_lshl_b32 s99, s99, 13
    v_mov_b32 v45, 99080
    v_mov_b32 v44, s99
    ds_write_b32 v45, v44
    v_lshlrev_b32 v36, 16, v32
    v_and_b32 v37, 0xffff0000, v32
    v_lshlrev_b32 v38, 16, v33
    v_and_b32 v39, 0xffff0000, v33
    v_lshlrev_b32 v40, 16, v34
    v_and_b32 v41, 0xffff0000, v34
    v_lshlrev_b32 v42, 16, v35
    v_and_b32 v43, 0xffff0000, v35
    v_pk_add_f32 v[36:37], v[36:37], v[38:39]
    v_pk_add_f32 v[40:41], v[40:41], v[42:43]
    v_pk_add_f32 v[36:37], v[36:37], v[40:41]
    v_cvt_pk_bf16_f32 v32, v36, v37
    v_min_u32 v32, -2, v32
    ds_write_b32 v1, v32
    s_mov_b32 s34, 258048
    buffer_load_dwordx4 v[144:147], v18, s[40:43], s34 offen offset:0 nt
    buffer_load_dwordx4 v[148:151], v18, s[40:43], s34 offen offset:1024 nt
    buffer_load_dwordx4 v[152:155], v18, s[40:43], s34 offen offset:2048 nt
    buffer_load_dwordx4 v[156:159], v18, s[40:43], s34 offen offset:3072 nt
    v_and_b32 v2, 15, v0
    v_lshlrev_b32 v2, 4, v2
    v_add_u32 v2, 98304, v2
    ds_read_b128 v[4:7], v2
    s_waitcnt lgkmcnt(0)
    v_dot2_f32_bf16 v8, v128, v4, 0
    v_dot2_f32_bf16 v9, v132, v4, 0
    v_dot2_f32_bf16 v10, v136, v4, 0
    v_dot2_f32_bf16 v11, v140, v4, 0
    v_dot2c_f32_bf16 v8, v129, v5
    v_dot2c_f32_bf16 v9, v133, v5
    v_dot2c_f32_bf16 v10, v137, v5
    v_dot2c_f32_bf16 v11, v141, v5
    v_dot2c_f32_bf16 v8, v130, v6
    v_dot2c_f32_bf16 v9, v134, v6
    v_dot2c_f32_bf16 v10, v138, v6
    v_dot2c_f32_bf16 v11, v142, v6
    v_dot2c_f32_bf16 v8, v131, v7
    v_dot2c_f32_bf16 v9, v135, v7
    v_dot2c_f32_bf16 v10, v139, v7
    v_dot2c_f32_bf16 v11, v143, v7
    v_add_f32_dpp v16, v8, v8 row_ror:8 row_mask:0xf bank_mask:0x3
    v_add_f32_dpp v16, v9, v9 row_ror:8 row_mask:0xf bank_mask:0xc
    v_add_f32_dpp v17, v10, v10 row_ror:8 row_mask:0xf bank_mask:0x3
    v_add_f32_dpp v17, v11, v11 row_ror:8 row_mask:0xf bank_mask:0xc
    v_add_f32_dpp v16, v16, v16 row_half_mirror row_mask:0xf bank_mask:0xf
    s_nop 0
    v_add_f32_dpp v17, v17, v17 row_half_mirror row_mask:0xf bank_mask:0xf
    v_add_f32_dpp v16, v16, v16 quad_perm:[1,0,3,2] row_mask:0xf bank_mask:0xf
    s_nop 0
    v_add_f32_dpp v17, v17, v17 quad_perm:[1,0,3,2] row_mask:0xf bank_mask:0xf
    v_add_f32_dpp v16, v16, v16 quad_perm:[2,3,0,1] row_mask:0xf bank_mask:0xf
    s_nop 0
    v_add_f32_dpp v17, v17, v17 quad_perm:[2,3,0,1] row_mask:0xf bank_mask:0xf
    v_max_f32 v8, v16, v17
    s_mov_b32 s34, 0x3e0293ee
    s_nop 0
    v_max_f32_dpp v8, v8, v8 row_ror:8 row_mask:0xf bank_mask:0xf
    v_mov_b32 v9, v8
    s_nop 1
    v_permlane16_swap_b32 v8, v9
    v_max_f32 v8, v8, v9
    v_mov_b32 v9, v8
    s_nop 1
    v_permlane32_swap_b32 v8, v9
    v_max_f32 v8, v8, v9
    v_mul_f32 v8, s34, v8
    v_fma_f32 v16, v16, s34, -v8
    v_fma_f32 v17, v17, s34, -v8
    v_exp_f32 v16, v16
    v_exp_f32 v17, v17
    s_nop 0
    v_add_f32 v9, v16, v17
    v_and_b32 v10, 1, v0
    v_lshlrev_b32 v10, 4, v10
    v_mov_b32 v11, 0xffff
    v_lshlrev_b32 v10, v10, v11
    v_bfe_u32 v11, v0, 1, 2
    v_cmp_eq_u32 vcc, 0, v11
    s_nop 1
    v_cndmask_b32 v20, 0, v10, vcc
    v_cmp_eq_u32 vcc, 1, v11
    s_nop 1
    v_cndmask_b32 v21, 0, v10, vcc
    v_cmp_eq_u32 vcc, 2, v11
    s_nop 1
    v_cndmask_b32 v22, 0, v10, vcc
    v_cmp_eq_u32 vcc, 3, v11
    s_nop 1
    v_cndmask_b32 v23, 0, v10, vcc
    v_add_f32_dpp v9, v9, v9 row_ror:8 row_mask:0xf bank_mask:0xf
    v_mov_b32 v10, v9
    s_nop 1
    v_permlane16_swap_b32 v9, v10
    v_add_f32 v9, v9, v10
    v_mov_b32 v10, v9
    s_nop 1
    v_permlane32_swap_b32 v9, v10
    v_add_f32 v9, v9, v10
    v_mov_b32 v10, 98616
    s_mov_b64 exec, 1
    ds_write_b64 v10, v[8:9]
    s_mov_b64 exec, -1
    s_waitcnt vmcnt(0)
    v_cvt_pk_bf16_f32 v10, v16, v16
    v_and_b32 v24, v10, v20
    v_and_b32 v25, v10, v21
    v_and_b32 v26, v10, v22
    v_and_b32 v27, v10, v23
    s_nop 1
    v_mfma_f32_16x16x32_bf16 v[116:119], v[144:147], v[24:27], 0
    v_mfma_f32_16x16x32_bf16 v[120:123], v[148:151], v[24:27], 0
    v_cvt_pk_bf16_f32 v10, v17, v17
    v_and_b32 v28, v10, v20
    v_and_b32 v29, v10, v21
    v_and_b32 v30, v10, v22
    v_and_b32 v31, v10, v23
    s_nop 1
    v_mfma_f32_16x16x32_bf16 v[116:119], v[152:155], v[28:31], v[116:119]
    v_mfma_f32_16x16x32_bf16 v[120:123], v[156:159], v[28:31], v[120:123]
    s_nop 7
    v_mov_b32_dpp v116, v120 quad_perm:[0,1,2,3] row_mask:0xf bank_mask:0xc
    v_mov_b32_dpp v117, v121 quad_perm:[0,1,2,3] row_mask:0xf bank_mask:0xc
    v_mov_b32_dpp v118, v122 quad_perm:[0,1,2,3] row_mask:0xf bank_mask:0xc
    v_mov_b32_dpp v119, v123 quad_perm:[0,1,2,3] row_mask:0xf bank_mask:0xc
    s_mov_b32 s63, 0
    s_mov_b32 s62, s61
    s_cmp_lt_u32 s61, 20
    s_cbranch_scc1 L_rd24
    s_mul_i32 s62, s60, 12
    s_add_u32 s62, s62, s61
    s_sub_u32 s62, s62, 20
    s_mov_b32 s63, 1
    s_cmp_lt_u32 s62, 54
    s_cbranch_scc1 L_rd24
    s_cmp_lt_u32 s62, 56
    s_cselect_b32 s63, 3, 2
    s_sub_u32 s62, s62, 56
L_rd24:
    v_and_b32 v8, 3, v0
    v_bfe_u32 v9, v0, 2, 2
    v_lshrrev_b32 v10, 4, v0
    s_mov_b32 s55, 0x20000
    s_lshl_b32 s35, s62, 6
    s_and_b32 s49, s62, 1
    s_cmp_eq_u32 s63, 0
    s_cbranch_scc1 L_dp26
    s_cmp_eq_u32 s63, 1
    s_cbranch_scc1 L_dp27
    s_mov_b32 s52, s20
    s_mov_b32 s53, s21
    s_mov_b32 s54, 2211840
    v_mov_b32 v15, 0
    s_branch L_dp28
L_dp27:
    s_mov_b32 s52, s16
    s_mov_b32 s53, s17
    s_mov_b32 s54, 2211840
    v_lshl_add_u32 v15, v9, 3, v10
    v_mul_u32_u24 v15, 3456, v15
    v_lshl_add_u32 v15, v8, 4, v15
    v_add_u32 v15, s35, v15
    s_bfe_u32 s50, s3, 0x10001
    s_lshl_b32 s50, s50, 7
    s_and_b32 s34, s3, 1
    s_lshl_b32 s34, s34, 2
    s_add_u32 s50, s50, s34
    s_and_b32 s51, s3, 3
    s_lshl_b32 s51, s51, 5
    s_add_u32 s51, s51, 512
    s_mul_i32 s50, s50, 3456
    s_mul_i32 s51, s51, 3456
    s_branch L_dp28
L_dp26:
    s_mov_b32 s52, s12
    s_mov_b32 s53, s13
    s_mov_b32 s54, 5242880
    s_lshr_b32 s50, s3, 1
    s_lshl_b32 s50, s50, 3
    s_add_u32 s50, s50, s60
    s_and_b32 s51, s3, 1
    s_lshl_b32 s34, s50, 1
    s_add_u32 s34, s34, s51
    s_mul_i32 s34, s34, 81920
    s_add_u32 s34, s34, s35
    v_lshl_add_u32 v15, v9, 2, v10
    v_mul_u32_u24 v15, 2560, v15
    v_lshl_add_u32 v15, v8, 4, v15
    v_add_u32 v15, s34, v15
    s_lshl_b32 s56, s3, 12
    s_lshl_b32 s34, s49, 11
    s_add_u32 s56, s56, s34
    s_add_u32 s56, s56, 40960
    s_add_u32 s58, s56, 1024
    s_mul_i32 s57, s49, 40960
    s_add_u32 s59, s57, 1280
L_dp28:
    v_and_b32 v200, 3, v0
    v_bfe_u32 v201, v0, 2, 2
    v_lshrrev_b32 v202, 4, v0
    s_lshl_b32 s34, s3, 10
    s_add_u32 s34, s34, 122112
    v_lshl_add_u32 v203, v0, 4, s34
    s_movk_i32 s48, 16384
    v_mov_b32 v197, 0
    s_mov_b32 s40, 0
    s_mov_b32 s41, 0
    s_mov_b32 s42, 0
    s_cmp_eq_u32 s63, 0
    s_cbranch_scc1 L_d_wo
    s_cmp_eq_u32 s63, 2
    s_cbranch_scc1 L_d_w2
    s_cmp_eq_u32 s63, 3
    s_cbranch_scc1 L_d_none
    v_and_b32 v205, 15, v0
    v_lshlrev_b32 v205, 4, v205
    s_and_b32 s49, s3, 3
    s_mul_i32 s34, s49, 1280
    s_add_u32 s34, s34, s99
    s_add_u32 s34, s34, 98304
    v_lshl_add_u32 v206, v202, 18, v205
    v_add_u32 v206, s34, v206
    s_mul_i32 s34, s49, 3840
    v_add_u32 v205, s34, v205
    s_lshl_b32 s34, s62, 6
    v_lshlrev_b32 v5, 4, v14
    v_lshl_add_u32 v5, v12, 2, v5
    v_add_u32 v5, s34, v5
    global_load_dword v6, v5, s[18:19]
    v_and_b32 v7, 15, v0
    v_lshlrev_b32 v7, 4, v7
    v_mul_u32_u24 v8, 1280, v14
    v_add_u32 v8, v8, v7
    v_bfe_u32 v9, v0, 3, 1
    v_lshlrev_b32 v9, 18, v9
    v_lshl_add_u32 v9, v14, 7, v9
    v_and_b32 v10, 7, v0
    v_lshl_add_u32 v9, v10, 4, v9
    v_add_u32 v9, 30720, v9
    s_mov_b32 s57, 524288
    v_mul_u32_u24 v5, 3840, v14
    v_add_u32 v5, v5, v7
    global_load_dwordx4 v[32:35], v8, s[4:5] offset:0
    global_load_dwordx4 v[36:39], v8, s[4:5] offset:256
    global_load_dwordx4 v[40:43], v8, s[4:5] offset:512
    global_load_dwordx4 v[44:47], v8, s[4:5] offset:768
    global_load_dwordx4 v[48:51], v8, s[4:5] offset:1024
    s_mov_b32 s35, 0
L_poll29:
    buffer_load_dwordx4 v[52:55], v9, s[44:47], s57 offen offset:1024 sc1
    buffer_load_dwordx4 v[56:59], v9, s[44:47], 0 offen offset:1536 sc1
    buffer_load_dwordx4 v[60:63], v9, s[44:47], s57 offen offset:1536 sc1
    buffer_load_dwordx4 v[64:67], v9, s[44:47], 0 offen offset:2048 sc1
    buffer_load_dwordx4 v[68:71], v9, s[44:47], s57 offen offset:2048 sc1
    buffer_load_dwordx4 v[72:75], v9, s[44:47], 0 offen offset:2560 sc1
    buffer_load_dwordx4 v[76:79], v9, s[44:47], s57 offen offset:2560 sc1
    buffer_load_dwordx4 v[80:83], v9, s[44:47], 0 offen offset:3072 sc1
    buffer_load_dwordx4 v[84:87], v9, s[44:47], s57 offen offset:3072 sc1
    buffer_load_dwordx4 v[88:91], v9, s[44:47], 0 offen offset:3584 sc1
    s_add_u32 s35, s35, 1
    s_waitcnt vmcnt(0)
    v_max3_u32 v28, v52, v53, v54
    v_max3_u32 v28, v28, v55, v56
    v_max3_u32 v28, v28, v57, v58
    v_max3_u32 v28, v28, v59, v60
    v_max3_u32 v28, v28, v61, v62
    v_max3_u32 v28, v28, v63, v64
    v_max3_u32 v28, v28, v65, v66
    v_max3_u32 v28, v28, v67, v68
    v_max3_u32 v28, v28, v69, v70
    v_max3_u32 v28, v28, v71, v72
    v_max3_u32 v28, v28, v73, v74
    v_max3_u32 v28, v28, v75, v76
    v_max3_u32 v28, v28, v77, v78
    v_max3_u32 v28, v28, v79, v80
    v_max3_u32 v28, v28, v81, v82
    v_max3_u32 v28, v28, v83, v84
    v_max3_u32 v28, v28, v85, v86
    v_max3_u32 v28, v28, v87, v88
    v_max3_u32 v28, v28, v89, v90
    v_max_u32 v28, v28, v91
    v_cmp_eq_u32 vcc, -1, v28
    s_cbranch_vccz L_done30
    s_sleep 16
    s_cmp_lt_u32 s35, 60000
    s_cbranch_scc1 L_poll29
L_done30:
    ds_write_b128 v5, v[32:35] offset:0
    ds_write_b128 v5, v[36:39] offset:256
    ds_write_b128 v5, v[40:43] offset:512
    ds_write_b128 v5, v[44:47] offset:768
    ds_write_b128 v5, v[48:51] offset:1024
    ds_write_b128 v5, v[52:55] offset:1280
    ds_write_b128 v5, v[56:59] offset:1536
    ds_write_b128 v5, v[60:63] offset:1792
    ds_write_b128 v5, v[64:67] offset:2048
    ds_write_b128 v5, v[68:71] offset:2304
    ds_write_b128 v5, v[72:75] offset:2560
    ds_write_b128 v5, v[76:79] offset:2816
    ds_write_b128 v5, v[80:83] offset:3072
    ds_write_b128 v5, v[84:87] offset:3328
    ds_write_b128 v5, v[88:91] offset:3584
    s_waitcnt lgkmcnt(0)
    v_lshlrev_b32 v100, 16, v6
    v_and_b32 v101, 0xffff0000, v6
    s_cmp_eq_u32 s60, 4
    s_cselect_b32 s40, 6, 12
    s_mov_b32 s41, 5462
    s_cmov_b32 s41, 10923
    s_cselect_b32 s34, 20, 20
    s_mov_b32 s49, 17280
    s_cmov_b32 s49, 34560
    v_min_u32 v196, 59, v0
    v_mul_u32_u24 v197, s41, v196
    v_lshrrev_b32 v197, 16, v197
    v_mul_u32_u24 v194, s40, v197
    v_sub_u32 v196, v196, v194
    v_mul_u32_u24 v197, 3456, v197
    v_lshl_add_u32 v197, v196, 6, v197
    s_mul_i32 s35, s60, 768
    s_add_i32 s35, s35, 0
    s_cmp_eq_u32 s60, 4
    s_cselect_b32 s35, 3072, s35
    s_sub_u32 s34, s61, s34
    s_mul_i32 s34, s34, s49
    s_mul_i32 s34, s34, 11
    s_add_u32 s34, s34, s35
    v_add_u32 v197, s34, v197
    s_mov_b32 s40, s49
    s_mov_b32 s41, s49
    s_branch L_d_none
L_d_w2:
    s_lshl_b32 s34, s62, 5
    v_lshl_add_u32 v3, v14, 3, s34
    global_load_dwordx2 v[20:21], v3, s[22:23]
    v_mul_u32_u24 v112, 1280, v12
    v_add_u32 v112, v112, v3
    global_load_dwordx2 v[22:23], v112, s[4:5]
    s_lshr_b32 s34, s62, 2
    s_add_u32 s34, s34, 30
    s_lshr_b32 s35, s34, 2
    s_lshl_b32 s35, s35, 9
    s_and_b32 s34, s34, 3
    s_lshl_b32 s34, s34, 18
    s_add_u32 s34, s34, s35
    s_and_b32 s35, s62, 3
    s_mul_i32 s35, s35, 32
    s_add_u32 s34, s34, s35
    s_add_u32 s34, s34, 30720
    v_lshlrev_b32 v5, 7, v12
    v_lshl_add_u32 v5, v14, 3, v5
    v_add_u32 v5, s34, v5
    s_waitcnt vmcnt(0)
    v_lshlrev_b32 v32, 16, v20
    v_and_b32 v33, 0xffff0000, v20
    v_lshlrev_b32 v34, 16, v21
    v_and_b32 v35, 0xffff0000, v21
    v_lshlrev_b32 v108, 16, v22
    v_and_b32 v109, 0xffff0000, v22
    v_lshlrev_b32 v110, 16, v23
    v_and_b32 v111, 0xffff0000, v23
    s_mov_b32 s35, 0
L_poll32:
    buffer_load_dwordx2 v[24:25], v5, s[44:47], 0 offen sc1
    s_add_u32 s35, s35, 1
    s_waitcnt vmcnt(0)
    v_max_u32 v28, v24, v25
    v_cmp_eq_u32 vcc, -1, v28
    s_cbranch_vccz L_done33
    s_sleep 16
    s_cmp_lt_u32 s35, 60000
    s_cbranch_scc1 L_poll32
L_done33:
    v_lshlrev_b32 v104, 16, v24
    v_and_b32 v105, 0xffff0000, v24
    v_lshlrev_b32 v106, 16, v25
    v_and_b32 v107, 0xffff0000, v25
    v_fma_f32 v108, v104, v32, v108
    v_fma_f32 v109, v105, v33, v109
    v_fma_f32 v110, v106, v34, v110
    v_fma_f32 v111, v107, v35, v111
    v_mul_f32 v108, 0x3e800000, v108
    v_mul_f32 v109, 0x3e800000, v109
    v_mul_f32 v110, 0x3e800000, v110
    v_mul_f32 v111, 0x3e800000, v111
    v_lshl_add_u32 v204, v13, 18, v112
    s_add_u32 s34, s99, 98304
    v_add_u32 v204, s34, v204
    s_cmp_eq_u32 s60, 4
    s_cselect_b32 s40, 2, 6
    s_mov_b32 s41, 10923
    s_cmov_b32 s41, 32769
    s_cselect_b32 s34, 28, 20
    s_mov_b32 s49, 12800
    s_cmov_b32 s49, 38400
    v_min_u32 v196, 59, v0
    v_mul_u32_u24 v197, s41, v196
    v_lshrrev_b32 v197, 16, v197
    v_mul_u32_u24 v194, s40, v197
    v_sub_u32 v196, v196, v194
    v_mul_u32_u24 v197, 1280, v197
    v_lshl_add_u32 v197, v196, 6, v197
    s_mul_i32 s35, s60, 384
    s_add_i32 s35, s35, -1792
    s_cmp_eq_u32 s60, 4
    s_cselect_b32 s35, 0, s35
    s_sub_u32 s34, s61, s34
    s_mul_i32 s34, s34, s49
    s_mul_i32 s34, s34, 15
    s_add_u32 s34, s34, s35
    v_add_u32 v197, s34, v197
    s_mov_b32 s40, s49
    s_mov_b32 s41, s49
    s_branch L_d_none
L_d_wo:
    s_lshr_b32 s49, s3, 1
    s_lshl_b32 s49, s49, 18
    v_and_b32 v210, 7, v0
    s_mul_i32 s34, s60, 4096
    s_add_u32 s34, s34, s49
    s_add_u32 s34, s34, 147712
    v_lshrrev_b32 v211, 3, v0
    v_mul_u32_u24 v205, 512, v211
    v_add_u32 v204, s34, v205
    s_lshl_b32 s35, s51, 7
    s_add_u32 s34, s34, s35
    s_sub_u32 s34, s34, 256
    v_lshl_add_u32 v205, v210, 4, v205
    v_add_u32 v205, s34, v205
    s_lshl_b32 s34, s3, 12
    s_add_u32 s34, s34, 40960
    v_lshrrev_b32 v206, 2, v0
    v_lshlrev_b32 v206, 6, v206
    v_lshl_add_u32 v206, v200, 3, v206
    v_add_u32 v206, s34, v206
    s_mul_i32 s34, s3, 1152
    s_add_u32 s34, s34, 107520
    v_mul_u32_u24 v207, 144, v211
    v_lshl_add_u32 v207, v210, 4, v207
    v_add_u32 v207, s34, v207
    v_mul_u32_u24 v208, 144, v210
    v_lshl_add_u32 v208, v202, 4, v208
    v_add_u32 v208, s34, v208
    v_mul_u32_u24 v212, 144, v211
    v_add_u32 v212, s34, v212
    v_mul_u32_u24 v213, 144, v210
    v_add_u32 v213, s34, v213
    v_and_b32 v211, 1, v211
    v_lshl_add_u32 v203, v211, 6, v208
    v_add_u32 v203, 14592, v203
    v_mov_b32 v210, 98816
    v_cmp_eq_u32 vcc, 0, v211
    s_nop 1
    v_cndmask_b32 v209, v208, v210, vcc
    v_cndmask_b32 v208, v210, v208, vcc
    v_mov_b32 v6, v14
    v_and_b32 v8, 7, v0
    s_lshl_b32 s35, s62, 6
    v_lshl_add_u32 v8, v8, 3, s35
    s_lshr_b32 s34, s62, 1
    s_add_u32 s34, s34, 0
    s_lshr_b32 s35, s34, 2
    s_lshl_b32 s35, s35, 9
    s_and_b32 s34, s34, 3
    s_lshl_b32 s34, s34, 18
    s_add_u32 s34, s34, s35
    s_and_b32 s35, s62, 1
    s_mul_i32 s35, s35, 64
    s_add_u32 s34, s34, s35
    s_add_u32 s34, s34, 30720
    v_and_b32 v9, 7, v0
    v_lshlrev_b32 v9, 3, v9
    v_lshl_add_u32 v9, v6, 7, v9
    v_add_u32 v9, s34, v9
    s_lshr_b32 s34, s60, 2
    s_lshl_b32 s34, s34, 14
    s_and_b32 s35, s60, 3
    s_lshl_b32 s35, s35, 18
    s_add_u32 s34, s34, s35
    s_add_u32 s34, s34, 98304
    v_mul_u32_u24 v112, 1280, v6
    v_add3_u32 v112, v112, v8, s34
    v_bfe_u32 v7, v0, 3, 1
    v_lshl_add_u32 v112, v7, 13, v112
    s_mul_i32 s34, s62, 52
    s_lshr_b32 s34, s34, 8
    s_mul_i32 s35, s34, 5
    s_sub_u32 s35, s62, s35
    s_mul_i32 s34, s34, 1310720
    s_lshl_b32 s35, s35, 15
    s_add_u32 s34, s34, s35
    s_mul_i32 s35, s60, 163840
    s_add_u32 s34, s34, s35
    v_lshl_add_u32 v197, v0, 6, s34
    s_movk_i32 s40, 4096
    s_movk_i32 s41, 4096
    s_mov_b32 s35, 0
L_poll35:
    buffer_load_dwordx2 v[32:33], v9, s[44:47], 0 offen sc1
    s_add_u32 s35, s35, 1
    s_waitcnt vmcnt(0)
    v_max_u32 v22, v32, v33
    v_cmp_eq_u32 vcc, -1, v22
    s_cbranch_vccz L_done36
    s_sleep 16
    s_cmp_lt_u32 s35, 60000
    s_cbranch_scc1 L_poll35
L_done36:
    v_lshlrev_b32 v100, 16, v32
    v_and_b32 v101, 0xffff0000, v32
    v_lshlrev_b32 v102, 16, v33
    v_and_b32 v103, 0xffff0000, v33
L_d_none:
    v_and_b32 v19, 7, v0
    v_lshlrev_b32 v19, 3, v19
    v_add_u32 v19, 98560, v19
    s_mov_b32 s35, 0
L_poll38:
    ds_read_b64 v[20:21], v19
    s_add_u32 s35, s35, 1
    s_waitcnt lgkmcnt(0)
    v_max_u32 v22, v20, v21
    v_cmp_eq_u32 vcc, -1, v22
    s_cbranch_vccz L_done39
    s_sleep 2
    s_cmp_lt_u32 s35, 60000
    s_cbranch_scc1 L_poll38
L_done39:
    v_max_f32_dpp v22, v20, v20 row_half_mirror row_mask:0xf bank_mask:0xf
    s_nop 1
    v_max_f32_dpp v22, v22, v22 quad_perm:[1,0,3,2] row_mask:0xf bank_mask:0xf
    s_nop 1
    v_max_f32_dpp v22, v22, v22 quad_perm:[2,3,0,1] row_mask:0xf bank_mask:0xf
    v_sub_f32 v20, v20, v22
    v_exp_f32 v20, v20
    s_nop 0
    v_mul_f32 v21, v21, v20
    s_nop 1
    v_add_f32_dpp v21, v21, v21 row_half_mirror row_mask:0xf bank_mask:0xf
    s_nop 1
    v_add_f32_dpp v21, v21, v21 quad_perm:[1,0,3,2] row_mask:0xf bank_mask:0xf
    s_nop 1
    v_add_f32_dpp v21, v21, v21 quad_perm:[2,3,0,1] row_mask:0xf bank_mask:0xf
    v_rcp_f32 v23, v21
    v_log_f32 v21, v21
    v_mul_f32 v20, v20, v23
    v_add_f32 v21, v21, v22
    v_min_u32 v21, -2, v21
    v_readlane_b32 s88, v20, 0
    v_readlane_b32 s90, v20, 1
    v_readlane_b32 s92, v20, 2
    v_readlane_b32 s94, v20, 3
    v_readlane_b32 s96, v20, 4
    v_readlane_b32 s98, v20, 5
    v_readlane_b32 s100, v20, 6
    v_readlane_b32 s89, v20, 7
    s_and_b32 s95, s61, 3
    s_lshl_b32 s95, s95, 18
    s_bfe_u32 s35, s2, 0x20005
    s_lshl_b32 s35, s35, 1
    s_lshr_b32 s91, s2, 7
    s_add_u32 s35, s35, s91
    s_getreg_b32 s91, hwreg(HW_REG_XCC_ID, 0, 4)
    v_mov_b32 v24, v21
    v_mov_b32 v25, s91
    v_mul_f32 v20, s89, v116
    v_mul_f32 v21, s89, v117
    v_mul_f32 v22, s89, v118
    v_mul_f32 v23, s89, v119
    s_mul_i32 s34, s60, 4096
    s_mul_i32 s35, s35, 512
    s_add_u32 s34, s34, s35
    s_add_u32 s34, s34, s95
    s_add_u32 s34, s34, 147456
    v_and_b32 v18, 7, v0
    v_lshl_add_u32 v18, v14, 3, v18
    v_bfe_u32 v19, v0, 3, 1
    v_lshl_add_u32 v18, v19, 5, v18
    v_lshl_add_u32 v26, v18, 3, s34
    v_lshlrev_b32 v19, 4, v0
    v_add_u32 v19, 99328, v19
    s_mov_b32 s36, s12
    s_mov_b32 s37, s13
    s_mov_b32 s38, 5242880
    s_and_b32 s34, s61, 24
    s_add_u32 s34, s34, s60
    s_mul_i32 s34, s34, 163840
    s_and_b32 s35, s61, 7
    s_mul_i32 s35, s35, 20480
    s_add_u32 s34, s34, s35
    v_lshl_add_u32 v195, v0, 6, s34
    s_mov_b32 s34, 0
    s_barrier
    buffer_load_dword v250, v195, s[36:39], s34 offen
    s_add_u32 s34, s34, 4096
    buffer_load_dword v250, v195, s[36:39], s34 offen
    s_add_u32 s34, s34, 4096
    buffer_load_dword v250, v195, s[36:39], s34 offen
    s_add_u32 s34, s34, 4096
    buffer_load_dword v250, v195, s[36:39], s34 offen
    s_add_u32 s34, s34, 4096
    buffer_load_dword v250, v195, s[36:39], s34 offen
    s_add_u32 s34, s34, 4096
    s_cmp_lt_u32 s63, 1
    s_cbranch_scc1 L_nopf
    buffer_load_dword v250, v197, s[52:55], s42 offen
    s_add_u32 s42, s42, s40
    buffer_load_dword v250, v197, s[52:55], s42 offen
    s_add_u32 s42, s42, s41
L_nopf:
    s_cmp_eq_u32 s97, 0
    v_mov_b32 v27, -2
    s_barrier
    ds_read_b128 v[32:35], v19 offset:0
    ds_read_b128 v[36:39], v19 offset:1024
    ds_read_b128 v[40:43], v19 offset:2048
    ds_read_b128 v[44:47], v19 offset:3072
    ds_read_b128 v[48:51], v19 offset:4096
    ds_read_b128 v[52:55], v19 offset:5120
    ds_read_b128 v[56:59], v19 offset:6144
    s_waitcnt lgkmcnt(6)
    v_pk_fma_f32 v[20:21], v[32:33], s[88:89], v[20:21] op_sel_hi:[1,0,1]
    v_pk_fma_f32 v[22:23], v[34:35], s[88:89], v[22:23] op_sel_hi:[1,0,1]
    s_waitcnt lgkmcnt(5)
    v_pk_fma_f32 v[20:21], v[36:37], s[90:91], v[20:21] op_sel_hi:[1,0,1]
    v_pk_fma_f32 v[22:23], v[38:39], s[90:91], v[22:23] op_sel_hi:[1,0,1]
    s_waitcnt lgkmcnt(4)
    v_pk_fma_f32 v[20:21], v[40:41], s[92:93], v[20:21] op_sel_hi:[1,0,1]
    v_pk_fma_f32 v[22:23], v[42:43], s[92:93], v[22:23] op_sel_hi:[1,0,1]
    s_waitcnt lgkmcnt(3)
    v_pk_fma_f32 v[20:21], v[44:45], s[94:95], v[20:21] op_sel_hi:[1,0,1]
    v_pk_fma_f32 v[22:23], v[46:47], s[94:95], v[22:23] op_sel_hi:[1,0,1]
    s_waitcnt lgkmcnt(2)
    v_pk_fma_f32 v[20:21], v[48:49], s[96:97], v[20:21] op_sel_hi:[1,0,1]
    v_pk_fma_f32 v[22:23], v[50:51], s[96:97], v[22:23] op_sel_hi:[1,0,1]
    s_waitcnt lgkmcnt(1)
    v_pk_fma_f32 v[20:21], v[52:53], s[98:99], v[20:21] op_sel_hi:[1,0,1]
    v_pk_fma_f32 v[22:23], v[54:55], s[98:99], v[22:23] op_sel_hi:[1,0,1]
    s_waitcnt lgkmcnt(0)
    v_pk_fma_f32 v[20:21], v[56:57], s[100:101], v[20:21] op_sel_hi:[1,0,1]
    v_pk_fma_f32 v[22:23], v[58:59], s[100:101], v[22:23] op_sel_hi:[1,0,1]
    s_nop 0
    v_add_f32_dpp v20, v20, v20 row_ror:8 row_mask:0xf bank_mask:0xf
    v_add_f32_dpp v21, v21, v21 row_ror:8 row_mask:0xf bank_mask:0xf
    v_add_f32_dpp v22, v22, v22 row_ror:8 row_mask:0xf bank_mask:0xf
    v_add_f32_dpp v23, v23, v23 row_ror:8 row_mask:0xf bank_mask:0xf
    v_cvt_pk_bf16_f32 v28, v20, v21
    v_cvt_pk_bf16_f32 v29, v22, v23
    s_nop 0
    v_min_u32_dpp v24, v28, v27 quad_perm:[0,1,2,3] row_mask:0xf bank_mask:0x3
    v_min_u32_dpp v25, v29, v27 quad_perm:[0,1,2,3] row_mask:0xf bank_mask:0x3
    buffer_store_dwordx2 v[24:25], v26, s[44:47], 0 offen
    s_cbranch_scc1 L_ostd
    buffer_store_dwordx2 v[24:25], v26, s[44:47], 0 offen sc1
L_ostd:
    ds_write_b96 v19, v[24:26] offset:32000
    s_waitcnt lgkmcnt(0)
    s_cmp_lt_u32 s63, 1
    s_cbranch_scc1 L_nopf2
    buffer_load_dword v250, v197, s[52:55], s42 offen
    s_add_u32 s42, s42, s40
    buffer_load_dword v250, v197, s[52:55], s42 offen
    s_add_u32 s42, s42, s41
    buffer_load_dword v250, v197, s[52:55], s42 offen
    s_add_u32 s42, s42, s40
    buffer_load_dword v250, v197, s[52:55], s42 offen
    s_add_u32 s42, s42, s41
    buffer_load_dword v250, v197, s[52:55], s42 offen
    s_add_u32 s42, s42, s40
    buffer_load_dword v250, v197, s[52:55], s42 offen
    s_add_u32 s42, s42, s41
    buffer_load_dword v250, v197, s[52:55], s42 offen
    s_add_u32 s42, s42, s40
    buffer_load_dword v250, v197, s[52:55], s42 offen
    s_add_u32 s42, s42, s41
L_nopf2:
    s_barrier
    s_cmp_lg_u32 s63, 0
    s_cbranch_scc1 L_r_nwo
    s_mov_b32 m0, s56
    s_nop 0
    buffer_load_dwordx4 v15, s[52:55], s57 offen  lds
    s_branch L_r_wo2
L_r_nwo:
    buffer_load_dword v250, v197, s[52:55], s42 offen
    s_add_u32 s42, s42, s40
    s_cmp_eq_u32 s63, 1
    s_cbranch_scc1 L_r_w1
    buffer_load_dword v250, v197, s[52:55], s42 offen
    s_add_u32 s42, s42, s40
    buffer_load_dword v250, v197, s[52:55], s42 offen
    s_add_u32 s42, s42, s41
    buffer_load_dword v250, v197, s[52:55], s42 offen
    s_add_u32 s42, s42, s40
    buffer_load_dword v250, v197, s[52:55], s42 offen
    s_add_u32 s42, s42, s41
    s_cmp_eq_u32 s63, 2
    s_cbranch_scc1 L_w2_red
    s_waitcnt vmcnt(0)
    s_mov_b64 exec, -1
    v_lshlrev_b32 v243, 4, v0
    v_add_u32 v243, 131328, v243
    ds_read_b96 v[240:242], v243
    s_waitcnt lgkmcnt(0)
    buffer_store_dwordx2 v[240:241], v242, s[44:47], 0 offen sc1
    s_branch L_fin
L_stream:
    s_sub_u32 s49, s3, 1
    s_lshl_b32 s49, s49, 12
    v_lshl_add_u32 v1, v0, 4, s49
    s_and_b32 s34, s2, 127
    s_lshl_b32 s34, s34, 21
    s_lshr_b32 s35, s2, 7
    s_lshl_b32 s35, s35, 18
    s_add_u32 s34, s34, s35
    s_add_u32 s34, s34, 1572864
    s_mov_b32 s38, 0x40000
    s_mov_b32 s42, 0x40000
    s_waitcnt lgkmcnt(0)
    s_add_u32 s36, s6, s34
    s_addc_u32 s37, s7, 0
    s_add_u32 s40, s8, s34
    s_addc_u32 s41, s9, 0
    s_barrier
    s_waitcnt vmcnt(2)
    s_mov_b32 s49, 0
    buffer_load_dwordx4 v[28:31], v1, s[36:39], s49 offen offset:3072 nt
    s_waitcnt vmcnt(2)
    s_mov_b32 s49, 28672
    buffer_load_dwordx4 v[32:35], v1, s[36:39], s49 offen offset:0 nt
    s_waitcnt vmcnt(2)
    buffer_load_dwordx4 v[36:39], v1, s[36:39], s49 offen offset:1024 nt
    s_waitcnt vmcnt(2)
    buffer_load_dwordx4 v[40:43], v1, s[36:39], s49 offen offset:2048 nt
    s_waitcnt vmcnt(2)
    buffer_load_dwordx4 v[44:47], v1, s[36:39], s49 offen offset:3072 nt
    s_add_u32 s44, s32, 0
    s_addc_u32 s45, s33, 0
    s_mov_b32 s63, 0
    s_mov_b32 s62, s61
    s_cmp_lt_u32 s61, 20
    s_cbranch_scc1 L_rd41
    s_mul_i32 s62, s60, 12
    s_add_u32 s62, s62, s61
    s_sub_u32 s62, s62, 20
    s_mov_b32 s63, 1
    s_cmp_lt_u32 s62, 54
    s_cbranch_scc1 L_rd41
    s_cmp_lt_u32 s62, 56
    s_cselect_b32 s63, 3, 2
    s_sub_u32 s62, s62, 56
L_rd41:
    v_and_b32 v8, 3, v0
    v_bfe_u32 v9, v0, 2, 2
    v_lshrrev_b32 v10, 4, v0
    s_mov_b32 s55, 0x20000
    s_lshl_b32 s35, s62, 6
    s_and_b32 s49, s62, 1
    s_cmp_eq_u32 s63, 0
    s_cbranch_scc1 L_dp43
    s_cmp_eq_u32 s63, 1
    s_cbranch_scc1 L_dp44
    s_mov_b32 s52, s20
    s_mov_b32 s53, s21
    s_mov_b32 s54, 2211840
    v_mov_b32 v15, 0
    s_branch L_dp45
L_dp44:
    s_mov_b32 s52, s16
    s_mov_b32 s53, s17
    s_mov_b32 s54, 2211840
    v_lshl_add_u32 v15, v9, 3, v10
    v_mul_u32_u24 v15, 3456, v15
    v_lshl_add_u32 v15, v8, 4, v15
    v_add_u32 v15, s35, v15
    s_bfe_u32 s50, s3, 0x10001
    s_lshl_b32 s50, s50, 7
    s_and_b32 s34, s3, 1
    s_lshl_b32 s34, s34, 2
    s_add_u32 s50, s50, s34
    s_and_b32 s51, s3, 3
    s_lshl_b32 s51, s51, 5
    s_add_u32 s51, s51, 512
    s_mul_i32 s50, s50, 3456
    s_mul_i32 s51, s51, 3456
    s_branch L_dp45
L_dp43:
    s_mov_b32 s52, s12
    s_mov_b32 s53, s13
    s_mov_b32 s54, 5242880
    s_lshr_b32 s50, s3, 1
    s_lshl_b32 s50, s50, 3
    s_add_u32 s50, s50, s60
    s_and_b32 s51, s3, 1
    s_lshl_b32 s34, s50, 1
    s_add_u32 s34, s34, s51
    s_mul_i32 s34, s34, 81920
    s_add_u32 s34, s34, s35
    v_lshl_add_u32 v15, v9, 2, v10
    v_mul_u32_u24 v15, 2560, v15
    v_lshl_add_u32 v15, v8, 4, v15
    v_add_u32 v15, s34, v15
    s_lshl_b32 s56, s3, 12
    s_lshl_b32 s34, s49, 11
    s_add_u32 s56, s56, s34
    s_add_u32 s56, s56, 40960
    s_add_u32 s58, s56, 1024
    s_mul_i32 s57, s49, 40960
    s_add_u32 s59, s57, 1280
L_dp45:
    v_and_b32 v2, 15, v0
    v_lshlrev_b32 v2, 4, v2
    v_add_u32 v2, 98304, v2
    s_waitcnt vmcnt(2)
    s_mov_b32 s49, 57344
    buffer_load_dwordx4 v[48:51], v1, s[36:39], s49 offen offset:0 nt
    s_waitcnt vmcnt(2)
    buffer_load_dwordx4 v[52:55], v1, s[36:39], s49 offen offset:1024 nt
    s_waitcnt vmcnt(2)
    s_cmp_ge_u32 s3, 4
    s_cbranch_scc1 L_sl46
    s_waitcnt vmcnt(1)
L_sl46:
    buffer_load_dwordx4 v[56:59], v1, s[36:39], s49 offen offset:2048 nt
    s_waitcnt vmcnt(2)
    s_cmp_ge_u32 s3, 4
    s_cbranch_scc1 L_sl47
    s_waitcnt vmcnt(1)
L_sl47:
    buffer_load_dwordx4 v[60:63], v1, s[36:39], s49 offen offset:3072 nt
    s_waitcnt vmcnt(2)
    s_cmp_ge_u32 s3, 4
    s_cbranch_scc1 L_sl48
    s_waitcnt vmcnt(1)
L_sl48:
    s_mov_b32 s49, 86016
    buffer_load_dwordx4 v[64:67], v1, s[36:39], s49 offen offset:0 nt
    s_waitcnt vmcnt(2)
    buffer_load_dwordx4 v[68:71], v1, s[36:39], s49 offen offset:1024 nt
    s_waitcnt vmcnt(2)
    buffer_load_dwordx4 v[72:75], v1, s[36:39], s49 offen offset:2048 nt
    s_waitcnt vmcnt(2)
    buffer_load_dwordx4 v[76:79], v1, s[36:39], s49 offen offset:3072 nt
    s_waitcnt vmcnt(2)
    s_mov_b32 s49, 114688
    buffer_load_dwordx4 v[80:83], v1, s[36:39], s49 offen offset:0 nt
    s_waitcnt vmcnt(2)
    buffer_load_dwordx4 v[84:87], v1, s[36:39], s49 offen offset:1024 nt
    s_waitcnt vmcnt(2)
    buffer_load_dwordx4 v[88:91], v1, s[36:39], s49 offen offset:2048 nt
    v_mov_b32 v3, 19
    ds_write_b32 v2, v3 offset:768
    s_waitcnt vmcnt(2)
    buffer_load_dwordx4 v[92:95], v1, s[36:39], s49 offen offset:3072 nt
    s_waitcnt vmcnt(2)
    s_mov_b32 s49, 143360
    buffer_load_dwordx4 v[96:99], v1, s[36:39], s49 offen offset:0 nt
    s_waitcnt vmcnt(2)
    buffer_load_dwordx4 v[100:103], v1, s[36:39], s49 offen offset:1024 nt
    s_waitcnt vmcnt(2)
    buffer_load_dwordx4 v[104:107], v1, s[36:39], s49 offen offset:2048 nt
    s_waitcnt vmcnt(2)
    buffer_load_dwordx4 v[108:111], v1, s[36:39], s49 offen offset:3072 nt
    s_waitcnt vmcnt(2)
    s_mov_b32 s49, 172032
    buffer_load_dwordx4 v[112:115], v1, s[36:39], s49 offen offset:0 nt
    s_waitcnt vmcnt(2)
    buffer_load_dwordx4 v[116:119], v1, s[36:39], s49 offen offset:1024 nt
    s_waitcnt vmcnt(2)
    buffer_load_dwordx4 v[120:123], v1, s[36:39], s49 offen offset:2048 nt
    s_waitcnt vmcnt(2)
    buffer_load_dwordx4 v[124:127], v1, s[36:39], s49 offen offset:3072 nt
    s_waitcnt vmcnt(2)
    s_mov_b32 s49, 200704
    buffer_load_dwordx4 v[128:131], v1, s[36:39], s49 offen offset:0 nt
    s_waitcnt vmcnt(2)
    buffer_load_dwordx4 v[132:135], v1, s[36:39], s49 offen offset:1024 nt
    s_waitcnt vmcnt(2)
    buffer_load_dwordx4 v[136:139], v1, s[36:39], s49 offen offset:2048 nt
    v_mov_b32 v3, 31
    ds_write_b32 v2, v3 offset:768
    s_waitcnt vmcnt(2)
    buffer_load_dwordx4 v[140:143], v1, s[36:39], s49 offen offset:3072 nt
    s_waitcnt vmcnt(2)
    s_mov_b32 s49, 229376
    buffer_load_dwordx4 v[144:147], v1, s[36:39], s49 offen offset:0 nt
    s_waitcnt vmcnt(2)
    buffer_load_dwordx4 v[148:151], v1, s[36:39], s49 offen offset:1024 nt
    s_waitcnt vmcnt(2)
    buffer_load_dwordx4 v[152:155], v1, s[36:39], s49 offen offset:2048 nt
    s_waitcnt vmcnt(2)
    buffer_load_dwordx4 v[156:159], v1, s[36:39], s49 offen offset:3072 nt
    s_waitcnt vmcnt(2)
    s_mov_b32 s49, 0
    buffer_load_dwordx4 v[160:163], v1, s[40:43], s49 offen offset:0 nt
    s_waitcnt vmcnt(2)
    buffer_load_dwordx4 v[164:167], v1, s[40:43], s49 offen offset:1024 nt
    s_waitcnt vmcnt(2)
    buffer_load_dwordx4 v[168:171], v1, s[40:43], s49 offen offset:2048 nt
    s_waitcnt vmcnt(2)
    buffer_load_dwordx4 v[172:175], v1, s[40:43], s49 offen offset:3072 nt
    s_waitcnt vmcnt(2)
    s_mov_b32 s49, 28672
    buffer_load_dwordx4 v[176:179], v1, s[40:43], s49 offen offset:0 nt
    s_waitcnt vmcnt(2)
    buffer_load_dwordx4 v[180:183], v1, s[40:43], s49 offen offset:1024 nt
    s_waitcnt vmcnt(2)
    buffer_load_dwordx4 v[184:187], v1, s[40:43], s49 offen offset:2048 nt
    s_waitcnt vmcnt(2)
    buffer_load_dwordx4 v[188:191], v1, s[40:43], s49 offen offset:3072 nt
    s_waitcnt vmcnt(2)
    s_mov_b32 s49, 57344
    buffer_load_dwordx4 v[192:195], v1, s[40:43], s49 offen offset:0 nt
    s_waitcnt vmcnt(2)
    buffer_load_dwordx4 v[196:199], v1, s[40:43], s49 offen offset:1024 nt
    s_waitcnt vmcnt(2)
    buffer_load_dwordx4 v[200:203], v1, s[40:43], s49 offen offset:2048 nt
    s_waitcnt vmcnt(2)
    buffer_load_dwordx4 v[204:207], v1, s[40:43], s49 offen offset:3072 nt
    s_waitcnt vmcnt(2)
    s_mov_b32 s49, 86016
    buffer_load_dwordx4 v[208:211], v1, s[40:43], s49 offen offset:0 nt
    s_waitcnt vmcnt(2)
    buffer_load_dwordx4 v[212:215], v1, s[40:43], s49 offen offset:1024 nt
    s_waitcnt vmcnt(2)
    buffer_load_dwordx4 v[216:219], v1, s[40:43], s49 offen offset:2048 nt
    s_waitcnt vmcnt(2)
    buffer_load_dwordx4 v[220:223], v1, s[40:43], s49 offen offset:3072 nt
    s_waitcnt vmcnt(2)
    s_mov_b32 s49, 114688
    buffer_load_dwordx4 v[224:227], v1, s[40:43], s49 offen offset:0 nt
    s_waitcnt vmcnt(2)
    buffer_load_dwordx4 v[228:231], v1, s[40:43], s49 offen offset:1024 nt
    s_waitcnt vmcnt(2)
    buffer_load_dwordx4 v[232:235], v1, s[40:43], s49 offen offset:2048 nt
    s_waitcnt vmcnt(2)
    buffer_load_dwordx4 v[236:239], v1, s[40:43], s49 offen offset:3072 nt
    v_mov_b32 v14, 99080
    s_mov_b32 s35, 0
L_poll49:
    ds_read_b128 v[4:7], v2
    ds_read_b32 v8, v14
    s_add_u32 s35, s35, 1
    s_waitcnt lgkmcnt(0)
    v_max3_u32 v3, v4, v5, v6
    v_max_u32 v3, v3, v7
    v_cmp_eq_u32 vcc, -1, v3
    s_cbranch_vccz L_done50
    s_sleep 2
    s_cmp_lt_u32 s35, 60000
    s_cbranch_scc1 L_poll49
L_done50:
    v_readfirstlane_b32 s99, v8
    s_waitcnt vmcnt(2)
    s_mov_b32 s49, 143360
    buffer_load_dwordx4 v[240:243], v1, s[40:43], s49 offen offset:0 nt
    v_dot2_f32_bf16 v8, v16, v4, 0
    v_dot2_f32_bf16 v9, v20, v4, 0
    v_dot2_f32_bf16 v10, v24, v4, 0
    v_dot2_f32_bf16 v11, v28, v4, 0
    v_dot2c_f32_bf16 v8, v17, v5
    v_dot2c_f32_bf16 v9, v21, v5
    v_dot2c_f32_bf16 v10, v25, v5
    v_dot2c_f32_bf16 v11, v29, v5
    v_dot2c_f32_bf16 v8, v18, v6
    v_dot2c_f32_bf16 v9, v22, v6
    v_dot2c_f32_bf16 v10, v26, v6
    v_dot2c_f32_bf16 v11, v30, v6
    v_dot2c_f32_bf16 v8, v19, v7
    v_dot2c_f32_bf16 v9, v23, v7
    v_dot2c_f32_bf16 v10, v27, v7
    v_dot2c_f32_bf16 v11, v31, v7
    v_add_f32_dpp v12, v8, v8 row_ror:8 row_mask:0xf bank_mask:0x3
    v_add_f32_dpp v12, v9, v9 row_ror:8 row_mask:0xf bank_mask:0xc
    v_add_f32_dpp v13, v10, v10 row_ror:8 row_mask:0xf bank_mask:0x3
    v_add_f32_dpp v13, v11, v11 row_ror:8 row_mask:0xf bank_mask:0xc
    v_dot2_f32_bf16 v8, v32, v4, 0
    v_dot2_f32_bf16 v9, v36, v4, 0
    v_dot2_f32_bf16 v10, v40, v4, 0
    v_dot2_f32_bf16 v11, v44, v4, 0
    v_add_f32_dpp v12, v12, v12 row_half_mirror row_mask:0xf bank_mask:0xf
    v_add_f32_dpp v13, v13, v13 row_half_mirror row_mask:0xf bank_mask:0xf
    v_dot2c_f32_bf16 v8, v33, v5
    v_dot2c_f32_bf16 v9, v37, v5
    v_dot2c_f32_bf16 v10, v41, v5
    v_dot2c_f32_bf16 v11, v45, v5
    v_add_f32_dpp v12, v12, v12 quad_perm:[1,0,3,2] row_mask:0xf bank_mask:0xf
    v_add_f32_dpp v13, v13, v13 quad_perm:[1,0,3,2] row_mask:0xf bank_mask:0xf
    v_dot2c_f32_bf16 v8, v34, v6
    v_dot2c_f32_bf16 v9, v38, v6
    v_dot2c_f32_bf16 v10, v42, v6
    v_dot2c_f32_bf16 v11, v46, v6
    s_waitcnt vmcnt(2)
    buffer_load_dwordx4 v[244:247], v1, s[40:43], s49 offen offset:1024 nt
    v_add_f32_dpp v12, v12, v12 quad_perm:[2,3,0,1] row_mask:0xf bank_mask:0xf
    v_add_f32_dpp v13, v13, v13 quad_perm:[2,3,0,1] row_mask:0xf bank_mask:0xf
    v_dot2c_f32_bf16 v8, v35, v7
    v_dot2c_f32_bf16 v9, v39, v7
    v_dot2c_f32_bf16 v10, v43, v7
    v_dot2c_f32_bf16 v11, v47, v7
    v_add_f32_dpp v16, v8, v8 row_ror:8 row_mask:0xf bank_mask:0x3
    v_add_f32_dpp v16, v9, v9 row_ror:8 row_mask:0xf bank_mask:0xc
    v_add_f32_dpp v17, v10, v10 row_ror:8 row_mask:0xf bank_mask:0x3
    v_add_f32_dpp v17, v11, v11 row_ror:8 row_mask:0xf bank_mask:0xc
    v_dot2_f32_bf16 v8, v48, v4, 0
    v_dot2_f32_bf16 v9, v52, v4, 0
    v_dot2_f32_bf16 v10, v56, v4, 0
    v_dot2_f32_bf16 v11, v60, v4, 0
    v_add_f32_dpp v16, v16, v16 row_half_mirror row_mask:0xf bank_mask:0xf
    v_add_f32_dpp v17, v17, v17 row_half_mirror row_mask:0xf bank_mask:0xf
    v_dot2c_f32_bf16 v8, v49, v5
    v_dot2c_f32_bf16 v9, v53, v5
    v_dot2c_f32_bf16 v10, v57, v5
    v_dot2c_f32_bf16 v11, v61, v5
    v_add_f32_dpp v16, v16, v16 quad_perm:[1,0,3,2] row_mask:0xf bank_mask:0xf
    v_add_f32_dpp v17, v17, v17 quad_perm:[1,0,3,2] row_mask:0xf bank_mask:0xf
    v_dot2c_f32_bf16 v8, v50, v6
    v_dot2c_f32_bf16 v9, v54, v6
    v_dot2c_f32_bf16 v10, v58, v6
    v_dot2c_f32_bf16 v11, v62, v6
    v_add_f32_dpp v16, v16, v16 quad_perm:[2,3,0,1] row_mask:0xf bank_mask:0xf
    v_add_f32_dpp v17, v17, v17 quad_perm:[2,3,0,1] row_mask:0xf bank_mask:0xf
    v_dot2c_f32_bf16 v8, v51, v7
    v_dot2c_f32_bf16 v9, v55, v7
    v_dot2c_f32_bf16 v10, v59, v7
    v_dot2c_f32_bf16 v11, v63, v7
    v_add_f32_dpp v18, v8, v8 row_ror:8 row_mask:0xf bank_mask:0x3
    v_add_f32_dpp v18, v9, v9 row_ror:8 row_mask:0xf bank_mask:0xc
    v_add_f32_dpp v19, v10, v10 row_ror:8 row_mask:0xf bank_mask:0x3
    v_add_f32_dpp v19, v11, v11 row_ror:8 row_mask:0xf bank_mask:0xc
    s_waitcnt vmcnt(2)
    buffer_load_dwordx4 v[248:251], v1, s[40:43], s49 offen offset:2048 nt
    v_dot2_f32_bf16 v8, v64, v4, 0
    v_dot2_f32_bf16 v9, v68, v4, 0
    v_dot2_f32_bf16 v10, v72, v4, 0
    v_dot2_f32_bf16 v11, v76, v4, 0
    v_add_f32_dpp v18, v18, v18 row_half_mirror row_mask:0xf bank_mask:0xf
    v_add_f32_dpp v19, v19, v19 row_half_mirror row_mask:0xf bank_mask:0xf
    v_dot2c_f32_bf16 v8, v65, v5
    v_dot2c_f32_bf16 v9, v69, v5
    v_dot2c_f32_bf16 v10, v73, v5
    v_dot2c_f32_bf16 v11, v77, v5
    v_add_f32_dpp v18, v18, v18 quad_perm:[1,0,3,2] row_mask:0xf bank_mask:0xf
    v_add_f32_dpp v19, v19, v19 quad_perm:[1,0,3,2] row_mask:0xf bank_mask:0xf
    v_dot2c_f32_bf16 v8, v66, v6
    v_dot2c_f32_bf16 v9, v70, v6
    v_dot2c_f32_bf16 v10, v74, v6
    v_dot2c_f32_bf16 v11, v78, v6
    v_add_f32_dpp v18, v18, v18 quad_perm:[2,3,0,1] row_mask:0xf bank_mask:0xf
    v_add_f32_dpp v19, v19, v19 quad_perm:[2,3,0,1] row_mask:0xf bank_mask:0xf
    v_dot2c_f32_bf16 v8, v67, v7
    v_dot2c_f32_bf16 v9, v71, v7
    v_dot2c_f32_bf16 v10, v75, v7
    v_dot2c_f32_bf16 v11, v79, v7
    v_add_f32_dpp v20, v8, v8 row_ror:8 row_mask:0xf bank_mask:0x3
    v_add_f32_dpp v20, v9, v9 row_ror:8 row_mask:0xf bank_mask:0xc
    v_add_f32_dpp v21, v10, v10 row_ror:8 row_mask:0xf bank_mask:0x3
    v_add_f32_dpp v21, v11, v11 row_ror:8 row_mask:0xf bank_mask:0xc
    v_dot2_f32_bf16 v8, v80, v4, 0
    v_dot2_f32_bf16 v9, v84, v4, 0
    v_dot2_f32_bf16 v10, v88, v4, 0
    v_dot2_f32_bf16 v11, v92, v4, 0
    v_add_f32_dpp v20, v20, v20 row_half_mirror row_mask:0xf bank_mask:0xf
    v_add_f32_dpp v21, v21, v21 row_half_mirror row_mask:0xf bank_mask:0xf
    v_dot2c_f32_bf16 v8, v81, v5
    v_dot2c_f32_bf16 v9, v85, v5
    v_dot2c_f32_bf16 v10, v89, v5
    v_dot2c_f32_bf16 v11, v93, v5
    s_waitcnt vmcnt(2)
    buffer_load_dwordx4 v[252:255], v1, s[40:43], s49 offen offset:3072 nt
    v_add_f32_dpp v20, v20, v20 quad_perm:[1,0,3,2] row_mask:0xf bank_mask:0xf
    v_add_f32_dpp v21, v21, v21 quad_perm:[1,0,3,2] row_mask:0xf bank_mask:0xf
    v_dot2c_f32_bf16 v8, v82, v6
    v_dot2c_f32_bf16 v9, v86, v6
    v_dot2c_f32_bf16 v10, v90, v6
    v_dot2c_f32_bf16 v11, v94, v6
    v_add_f32_dpp v20, v20, v20 quad_perm:[2,3,0,1] row_mask:0xf bank_mask:0xf
    v_add_f32_dpp v21, v21, v21 quad_perm:[2,3,0,1] row_mask:0xf bank_mask:0xf
    v_dot2c_f32_bf16 v8, v83, v7
    v_dot2c_f32_bf16 v9, v87, v7
    v_dot2c_f32_bf16 v10, v91, v7
    v_dot2c_f32_bf16 v11, v95, v7
    v_add_f32_dpp v22, v8, v8 row_ror:8 row_mask:0xf bank_mask:0x3
    v_add_f32_dpp v22, v9, v9 row_ror:8 row_mask:0xf bank_mask:0xc
    v_add_f32_dpp v23, v10, v10 row_ror:8 row_mask:0xf bank_mask:0x3
    v_add_f32_dpp v23, v11, v11 row_ror:8 row_mask:0xf bank_mask:0xc
    v_dot2_f32_bf16 v8, v96, v4, 0
    v_dot2_f32_bf16 v9, v100, v4, 0
    v_dot2_f32_bf16 v10, v104, v4, 0
    v_dot2_f32_bf16 v11, v108, v4, 0
    v_add_f32_dpp v22, v22, v22 row_half_mirror row_mask:0xf bank_mask:0xf
    v_add_f32_dpp v23, v23, v23 row_half_mirror row_mask:0xf bank_mask:0xf
    v_dot2c_f32_bf16 v8, v97, v5
    v_dot2c_f32_bf16 v9, v101, v5
    v_dot2c_f32_bf16 v10, v105, v5
    v_dot2c_f32_bf16 v11, v109, v5
    v_add_f32_dpp v22, v22, v22 quad_perm:[1,0,3,2] row_mask:0xf bank_mask:0xf
    v_add_f32_dpp v23, v23, v23 quad_perm:[1,0,3,2] row_mask:0xf bank_mask:0xf
    v_dot2c_f32_bf16 v8, v98, v6
    v_dot2c_f32_bf16 v9, v102, v6
    v_dot2c_f32_bf16 v10, v106, v6
    v_dot2c_f32_bf16 v11, v110, v6
    v_add_f32_dpp v22, v22, v22 quad_perm:[2,3,0,1] row_mask:0xf bank_mask:0xf
    v_add_f32_dpp v23, v23, v23 quad_perm:[2,3,0,1] row_mask:0xf bank_mask:0xf
    v_dot2c_f32_bf16 v8, v99, v7
    v_dot2c_f32_bf16 v9, v103, v7
    s_waitcnt vmcnt(2)
    s_mov_b32 s49, 172032
    buffer_load_dwordx4 v[32:35], v1, s[40:43], s49 offen offset:0 nt
    v_dot2c_f32_bf16 v10, v107, v7
    v_dot2c_f32_bf16 v11, v111, v7
    v_add_f32_dpp v24, v8, v8 row_ror:8 row_mask:0xf bank_mask:0x3
    v_add_f32_dpp v24, v9, v9 row_ror:8 row_mask:0xf bank_mask:0xc
    v_add_f32_dpp v25, v10, v10 row_ror:8 row_mask:0xf bank_mask:0x3
    v_add_f32_dpp v25, v11, v11 row_ror:8 row_mask:0xf bank_mask:0xc
    v_dot2_f32_bf16 v8, v112, v4, 0
    v_dot2_f32_bf16 v9, v116, v4, 0
    v_dot2_f32_bf16 v10, v120, v4, 0
    v_dot2_f32_bf16 v11, v124, v4, 0
    v_add_f32_dpp v24, v24, v24 row_half_mirror row_mask:0xf bank_mask:0xf
    v_add_f32_dpp v25, v25, v25 row_half_mirror row_mask:0xf bank_mask:0xf
    v_dot2c_f32_bf16 v8, v113, v5
    v_dot2c_f32_bf16 v9, v117, v5
    v_dot2c_f32_bf16 v10, v121, v5
    v_dot2c_f32_bf16 v11, v125, v5
    v_add_f32_dpp v24, v24, v24 quad_perm:[1,0,3,2] row_mask:0xf bank_mask:0xf
    v_add_f32_dpp v25, v25, v25 quad_perm:[1,0,3,2] row_mask:0xf bank_mask:0xf
    v_dot2c_f32_bf16 v8, v114, v6
    v_dot2c_f32_bf16 v9, v118, v6
    v_dot2c_f32_bf16 v10, v122, v6
    v_dot2c_f32_bf16 v11, v126, v6
    v_add_f32_dpp v24, v24, v24 quad_perm:[2,3,0,1] row_mask:0xf bank_mask:0xf
    v_add_f32_dpp v25, v25, v25 quad_perm:[2,3,0,1] row_mask:0xf bank_mask:0xf
    v_dot2c_f32_bf16 v8, v115, v7
    v_dot2c_f32_bf16 v9, v119, v7
    v_dot2c_f32_bf16 v10, v123, v7
    v_dot2c_f32_bf16 v11, v127, v7
    v_add_f32_dpp v26, v8, v8 row_ror:8 row_mask:0xf bank_mask:0x3
    v_add_f32_dpp v26, v9, v9 row_ror:8 row_mask:0xf bank_mask:0xc
    v_add_f32_dpp v27, v10, v10 row_ror:8 row_mask:0xf bank_mask:0x3
    v_add_f32_dpp v27, v11, v11 row_ror:8 row_mask:0xf bank_mask:0xc
    v_dot2_f32_bf16 v8, v128, v4, 0
    v_dot2_f32_bf16 v9, v132, v4, 0
    v_dot2_f32_bf16 v10, v136, v4, 0
    v_dot2_f32_bf16 v11, v140, v4, 0
    s_waitcnt vmcnt(2)
    buffer_load_dwordx4 v[36:39], v1, s[40:43], s49 offen offset:1024 nt
    v_add_f32_dpp v26, v26, v26 row_half_mirror row_mask:0xf bank_mask:0xf
    v_add_f32_dpp v27, v27, v27 row_half_mirror row_mask:0xf bank_mask:0xf
    v_dot2c_f32_bf16 v8, v129, v5
    v_dot2c_f32_bf16 v9, v133, v5
    v_dot2c_f32_bf16 v10, v137, v5
    v_dot2c_f32_bf16 v11, v141, v5
    v_add_f32_dpp v26, v26, v26 quad_perm:[1,0,3,2] row_mask:0xf bank_mask:0xf
    v_add_f32_dpp v27, v27, v27 quad_perm:[1,0,3,2] row_mask:0xf bank_mask:0xf
    v_dot2c_f32_bf16 v8, v130, v6
    v_dot2c_f32_bf16 v9, v134, v6
    v_dot2c_f32_bf16 v10, v138, v6
    v_dot2c_f32_bf16 v11, v142, v6
    v_add_f32_dpp v26, v26, v26 quad_perm:[2,3,0,1] row_mask:0xf bank_mask:0xf
    v_add_f32_dpp v27, v27, v27 quad_perm:[2,3,0,1] row_mask:0xf bank_mask:0xf
    v_dot2c_f32_bf16 v8, v131, v7
    v_dot2c_f32_bf16 v9, v135, v7
    v_dot2c_f32_bf16 v10, v139, v7
    v_dot2c_f32_bf16 v11, v143, v7
    v_add_f32_dpp v28, v8, v8 row_ror:8 row_mask:0xf bank_mask:0x3
    v_add_f32_dpp v28, v9, v9 row_ror:8 row_mask:0xf bank_mask:0xc
    v_add_f32_dpp v29, v10, v10 row_ror:8 row_mask:0xf bank_mask:0x3
    v_add_f32_dpp v29, v11, v11 row_ror:8 row_mask:0xf bank_mask:0xc
    v_dot2_f32_bf16 v8, v144, v4, 0
    v_dot2_f32_bf16 v9, v148, v4, 0
    v_dot2_f32_bf16 v10, v152, v4, 0
    v_dot2_f32_bf16 v11, v156, v4, 0
    v_add_f32_dpp v28, v28, v28 row_half_mirror row_mask:0xf bank_mask:0xf
    v_add_f32_dpp v29, v29, v29 row_half_mirror row_mask:0xf bank_mask:0xf
    v_dot2c_f32_bf16 v8, v145, v5
    v_dot2c_f32_bf16 v9, v149, v5
    v_dot2c_f32_bf16 v10, v153, v5
    v_dot2c_f32_bf16 v11, v157, v5
    v_add_f32_dpp v28, v28, v28 quad_perm:[1,0,3,2] row_mask:0xf bank_mask:0xf
    v_add_f32_dpp v29, v29, v29 quad_perm:[1,0,3,2] row_mask:0xf bank_mask:0xf
    v_dot2c_f32_bf16 v8, v146, v6
    v_dot2c_f32_bf16 v9, v150, v6
    buffer_load_dwordx4 v[40:43], v1, s[40:43], s49 offen offset:2048 nt
    v_dot2c_f32_bf16 v10, v154, v6
    v_dot2c_f32_bf16 v11, v158, v6
    v_add_f32_dpp v28, v28, v28 quad_perm:[2,3,0,1] row_mask:0xf bank_mask:0xf
    v_add_f32_dpp v29, v29, v29 quad_perm:[2,3,0,1] row_mask:0xf bank_mask:0xf
    v_dot2c_f32_bf16 v8, v147, v7
    v_dot2c_f32_bf16 v9, v151, v7
    v_dot2c_f32_bf16 v10, v155, v7
    v_dot2c_f32_bf16 v11, v159, v7
    v_add_f32_dpp v30, v8, v8 row_ror:8 row_mask:0xf bank_mask:0x3
    v_add_f32_dpp v30, v9, v9 row_ror:8 row_mask:0xf bank_mask:0xc
    v_add_f32_dpp v31, v10, v10 row_ror:8 row_mask:0xf bank_mask:0x3
    v_add_f32_dpp v31, v11, v11 row_ror:8 row_mask:0xf bank_mask:0xc
    v_add_f32_dpp v30, v30, v30 row_half_mirror row_mask:0xf bank_mask:0xf
    s_nop 0
    v_add_f32_dpp v31, v31, v31 row_half_mirror row_mask:0xf bank_mask:0xf
    v_add_f32_dpp v30, v30, v30 quad_perm:[1,0,3,2] row_mask:0xf bank_mask:0xf
    s_nop 0
    v_add_f32_dpp v31, v31, v31 quad_perm:[1,0,3,2] row_mask:0xf bank_mask:0xf
    v_add_f32_dpp v30, v30, v30 quad_perm:[2,3,0,1] row_mask:0xf bank_mask:0xf
    s_nop 0
    v_add_f32_dpp v31, v31, v31 quad_perm:[2,3,0,1] row_mask:0xf bank_mask:0xf
    v_max3_f32 v8, v12, v13, v16
    v_max3_f32 v8, v8, v17, v18
    v_max3_f32 v8, v8, v19, v20
    v_max3_f32 v8, v8, v21, v22
    v_max3_f32 v8, v8, v23, v24
    v_max3_f32 v8, v8, v25, v26
    v_max3_f32 v8, v8, v27, v28
    v_max3_f32 v8, v8, v29, v30
    v_max_f32 v8, v8, v31
    s_mov_b32 s34, 0x3e0293ee
    s_nop 0
    v_max_f32_dpp v8, v8, v8 row_ror:8 row_mask:0xf bank_mask:0xf
    v_mov_b32 v9, v8
    s_nop 1
    v_permlane16_swap_b32 v8, v9
    v_max_f32 v8, v8, v9
    v_mov_b32 v9, v8
    s_nop 1
    v_permlane32_swap_b32 v8, v9
    v_max_f32 v8, v8, v9
    v_mul_f32 v8, s34, v8
    s_waitcnt vmcnt(3)
    buffer_load_dwordx4 v[44:47], v1, s[40:43], s49 offen offset:3072 nt
    v_fma_f32 v12, v12, s34, -v8
    v_fma_f32 v13, v13, s34, -v8
    v_fma_f32 v16, v16, s34, -v8
    v_fma_f32 v17, v17, s34, -v8
    v_fma_f32 v18, v18, s34, -v8
    v_fma_f32 v19, v19, s34, -v8
    v_fma_f32 v20, v20, s34, -v8
    v_fma_f32 v21, v21, s34, -v8
    v_fma_f32 v22, v22, s34, -v8
    v_fma_f32 v23, v23, s34, -v8
    v_fma_f32 v24, v24, s34, -v8
    v_fma_f32 v25, v25, s34, -v8
    v_fma_f32 v26, v26, s34, -v8
    v_fma_f32 v27, v27, s34, -v8
    v_fma_f32 v28, v28, s34, -v8
    v_fma_f32 v29, v29, s34, -v8
    v_fma_f32 v30, v30, s34, -v8
    v_fma_f32 v31, v31, s34, -v8
    v_exp_f32 v12, v12
    v_exp_f32 v13, v13
    v_exp_f32 v16, v16
    v_exp_f32 v17, v17
    v_exp_f32 v18, v18
    v_exp_f32 v19, v19
    v_exp_f32 v20, v20
    v_exp_f32 v21, v21
    v_exp_f32 v22, v22
    v_exp_f32 v23, v23
    v_exp_f32 v24, v24
    v_exp_f32 v25, v25
    v_exp_f32 v26, v26
    v_exp_f32 v27, v27
    v_exp_f32 v28, v28
    v_exp_f32 v29, v29
    v_exp_f32 v30, v30
    v_exp_f32 v31, v31
    s_waitcnt vmcnt(3)
    s_mov_b32 s49, 200704
    buffer_load_dwordx4 v[48:51], v1, s[40:43], s49 offen offset:0 nt
    v_add_f32 v9, v12, v13
    v_add_f32 v9, v9, v16
    v_add_f32 v9, v9, v17
    v_add_f32 v9, v9, v18
    v_add_f32 v9, v9, v19
    v_add_f32 v9, v9, v20
    v_add_f32 v9, v9, v21
    v_add_f32 v9, v9, v22
    v_add_f32 v9, v9, v23
    v_add_f32 v9, v9, v24
    v_add_f32 v9, v9, v25
    v_add_f32 v9, v9, v26
    v_add_f32 v9, v9, v27
    v_add_f32 v9, v9, v28
    v_add_f32 v9, v9, v29
    v_add_f32 v9, v9, v30
    v_add_f32 v9, v9, v31
    v_and_b32 v10, 1, v0
    v_lshlrev_b32 v10, 4, v10
    v_mov_b32 v11, 0xffff
    v_lshlrev_b32 v10, v10, v11
    v_bfe_u32 v11, v0, 1, 2
    v_cmp_eq_u32 vcc, 0, v11
    s_nop 1
    v_cndmask_b32 v144, 0, v10, vcc
    v_cmp_eq_u32 vcc, 1, v11
    s_nop 1
    v_cndmask_b32 v145, 0, v10, vcc
    v_cmp_eq_u32 vcc, 2, v11
    s_nop 1
    v_cndmask_b32 v146, 0, v10, vcc
    v_cmp_eq_u32 vcc, 3, v11
    s_nop 1
    v_cndmask_b32 v147, 0, v10, vcc
    v_add_f32_dpp v9, v9, v9 row_ror:8 row_mask:0xf bank_mask:0xf
    v_mov_b32 v10, v9
    s_nop 1
    v_permlane16_swap_b32 v9, v10
    v_add_f32 v9, v9, v10
    v_mov_b32 v10, v9
    s_nop 1
    v_permlane32_swap_b32 v9, v10
    s_waitcnt vmcnt(3)
    buffer_load_dwordx4 v[52:55], v1, s[40:43], s49 offen offset:1024 nt
    v_add_f32 v9, v9, v10
    s_lshl_b32 s34, s3, 3
    s_add_u32 s34, s34, 98552
    v_mov_b32 v10, s34
    s_mov_b64 exec, 1
    ds_write_b64 v10, v[8:9]
    s_mov_b64 exec, -1
    s_lshl_b32 s34, s3, 10
    s_add_u32 s34, s34, 98304
    v_lshl_add_u32 v2, v0, 4, s34
    v_cvt_pk_bf16_f32 v10, v12, v12
    v_and_b32 v128, v10, v144
    v_and_b32 v129, v10, v145
    v_and_b32 v130, v10, v146
    v_and_b32 v131, v10, v147
    s_nop 1
    v_mfma_f32_16x16x32_bf16 v[148:151], v[160:163], v[128:131], 0
    v_mfma_f32_16x16x32_bf16 v[152:155], v[164:167], v[128:131], 0
    v_cvt_pk_bf16_f32 v10, v13, v13
    v_and_b32 v132, v10, v144
    v_and_b32 v133, v10, v145
    v_and_b32 v134, v10, v146
    v_and_b32 v135, v10, v147
    s_nop 1
    v_mfma_f32_16x16x32_bf16 v[148:151], v[168:171], v[132:135], v[148:151]
    v_mfma_f32_16x16x32_bf16 v[152:155], v[172:175], v[132:135], v[152:155]
    v_cvt_pk_bf16_f32 v10, v16, v16
    v_and_b32 v128, v10, v144
    v_and_b32 v129, v10, v145
    v_and_b32 v130, v10, v146
    v_and_b32 v131, v10, v147
    s_nop 1
    v_mfma_f32_16x16x32_bf16 v[148:151], v[176:179], v[128:131], v[148:151]
    v_mfma_f32_16x16x32_bf16 v[152:155], v[180:183], v[128:131], v[152:155]
    v_cvt_pk_bf16_f32 v10, v17, v17
    v_and_b32 v132, v10, v144
    v_and_b32 v133, v10, v145
    v_and_b32 v134, v10, v146
    v_and_b32 v135, v10, v147
    s_nop 1
    v_mfma_f32_16x16x32_bf16 v[148:151], v[184:187], v[132:135], v[148:151]
    v_mfma_f32_16x16x32_bf16 v[152:155], v[188:191], v[132:135], v[152:155]
    s_waitcnt vmcnt(3)
    buffer_load_dwordx4 v[56:59], v1, s[40:43], s49 offen offset:2048 nt
    v_cvt_pk_bf16_f32 v10, v18, v18
    v_and_b32 v128, v10, v144
    v_and_b32 v129, v10, v145
    v_and_b32 v130, v10, v146
    v_and_b32 v131, v10, v147
    s_nop 1
    v_mfma_f32_16x16x32_bf16 v[148:151], v[192:195], v[128:131], v[148:151]
    v_mfma_f32_16x16x32_bf16 v[152:155], v[196:199], v[128:131], v[152:155]
    v_cvt_pk_bf16_f32 v10, v19, v19
    v_and_b32 v132, v10, v144
    v_and_b32 v133, v10, v145
    v_and_b32 v134, v10, v146
    v_and_b32 v135, v10, v147
    s_nop 1
    v_mfma_f32_16x16x32_bf16 v[148:151], v[200:203], v[132:135], v[148:151]
    v_mfma_f32_16x16x32_bf16 v[152:155], v[204:207], v[132:135], v[152:155]
    v_cvt_pk_bf16_f32 v10, v20, v20
    v_and_b32 v128, v10, v144
    v_and_b32 v129, v10, v145
    v_and_b32 v130, v10, v146
    v_and_b32 v131, v10, v147
    s_nop 1
    v_mfma_f32_16x16x32_bf16 v[148:151], v[208:211], v[128:131], v[148:151]
    v_mfma_f32_16x16x32_bf16 v[152:155], v[212:215], v[128:131], v[152:155]
    v_cvt_pk_bf16_f32 v10, v21, v21
    v_and_b32 v132, v10, v144
    v_and_b32 v133, v10, v145
    v_and_b32 v134, v10, v146
    v_and_b32 v135, v10, v147
    s_nop 1
    v_mfma_f32_16x16x32_bf16 v[148:151], v[216:219], v[132:135], v[148:151]
    v_mfma_f32_16x16x32_bf16 v[152:155], v[220:223], v[132:135], v[152:155]
    v_cvt_pk_bf16_f32 v10, v22, v22
    v_and_b32 v128, v10, v144
    v_and_b32 v129, v10, v145
    v_and_b32 v130, v10, v146
    v_and_b32 v131, v10, v147
    s_nop 1
    v_mfma_f32_16x16x32_bf16 v[148:151], v[224:227], v[128:131], v[148:151]
    v_mfma_f32_16x16x32_bf16 v[152:155], v[228:231], v[128:131], v[152:155]
    v_cvt_pk_bf16_f32 v10, v23, v23
    s_waitcnt vmcnt(3)
    buffer_load_dwordx4 v[60:63], v1, s[40:43], s49 offen offset:3072 nt
    v_and_b32 v132, v10, v144
    v_and_b32 v133, v10, v145
    v_and_b32 v134, v10, v146
    v_and_b32 v135, v10, v147
    s_nop 1
    v_mfma_f32_16x16x32_bf16 v[148:151], v[232:235], v[132:135], v[148:151]
    v_mfma_f32_16x16x32_bf16 v[152:155], v[236:239], v[132:135], v[152:155]
    v_cvt_pk_bf16_f32 v10, v24, v24
    v_and_b32 v128, v10, v144
    v_and_b32 v129, v10, v145
    v_and_b32 v130, v10, v146
    v_and_b32 v131, v10, v147
    s_nop 1
    v_mfma_f32_16x16x32_bf16 v[148:151], v[240:243], v[128:131], v[148:151]
    v_mfma_f32_16x16x32_bf16 v[152:155], v[244:247], v[128:131], v[152:155]
    v_cvt_pk_bf16_f32 v10, v25, v25
    v_and_b32 v132, v10, v144
    v_and_b32 v133, v10, v145
    v_and_b32 v134, v10, v146
    v_and_b32 v135, v10, v147
    s_nop 1
    v_mfma_f32_16x16x32_bf16 v[148:151], v[248:251], v[132:135], v[148:151]
    v_mfma_f32_16x16x32_bf16 v[152:155], v[252:255], v[132:135], v[152:155]
    v_cvt_pk_bf16_f32 v10, v26, v26
    v_and_b32 v128, v10, v144
    v_and_b32 v129, v10, v145
    v_and_b32 v130, v10, v146
    v_and_b32 v131, v10, v147
    s_nop 1
    v_mfma_f32_16x16x32_bf16 v[148:151], v[32:35], v[128:131], v[148:151]
    v_mfma_f32_16x16x32_bf16 v[152:155], v[36:39], v[128:131], v[152:155]
    v_cvt_pk_bf16_f32 v10, v27, v27
    v_and_b32 v132, v10, v144
    v_and_b32 v133, v10, v145
    v_and_b32 v134, v10, v146
    v_and_b32 v135, v10, v147
    s_nop 1
    v_mfma_f32_16x16x32_bf16 v[148:151], v[40:43], v[132:135], v[148:151]
    v_mfma_f32_16x16x32_bf16 v[152:155], v[44:47], v[132:135], v[152:155]
    v_cvt_pk_bf16_f32 v10, v28, v28
    v_and_b32 v128, v10, v144
    s_waitcnt vmcnt(3)
    s_mov_b32 s49, 229376
    buffer_load_dwordx4 v[64:67], v1, s[40:43], s49 offen offset:0 nt
    v_and_b32 v129, v10, v145
    v_and_b32 v130, v10, v146
    v_and_b32 v131, v10, v147
    s_waitcnt vmcnt(3)
    buffer_load_dwordx4 v[68:71], v1, s[40:43], s49 offen offset:1024 nt
    v_mfma_f32_16x16x32_bf16 v[148:151], v[48:51], v[128:131], v[148:151]
    v_mfma_f32_16x16x32_bf16 v[152:155], v[52:55], v[128:131], v[152:155]
    v_cvt_pk_bf16_f32 v10, v29, v29
    v_and_b32 v132, v10, v144
    v_and_b32 v133, v10, v145
    v_and_b32 v134, v10, v146
    v_and_b32 v135, v10, v147
    s_waitcnt vmcnt(3)
    buffer_load_dwordx4 v[72:75], v1, s[40:43], s49 offen offset:2048 nt
    s_waitcnt vmcnt(3)
    buffer_load_dwordx4 v[76:79], v1, s[40:43], s49 offen offset:3072 nt
    s_barrier
    v_mfma_f32_16x16x32_bf16 v[148:151], v[56:59], v[132:135], v[148:151]
    v_mfma_f32_16x16x32_bf16 v[152:155], v[60:63], v[132:135], v[152:155]
    v_cvt_pk_bf16_f32 v10, v30, v30
    v_and_b32 v128, v10, v144
    v_and_b32 v129, v10, v145
    v_and_b32 v130, v10, v146
    v_and_b32 v131, v10, v147
    s_waitcnt vmcnt(2)
    s_nop 0
    v_mfma_f32_16x16x32_bf16 v[148:151], v[64:67], v[128:131], v[148:151]
    v_mfma_f32_16x16x32_bf16 v[152:155], v[68:71], v[128:131], v[152:155]
    v_cvt_pk_bf16_f32 v10, v31, v31
    v_and_b32 v132, v10, v144
    v_and_b32 v133, v10, v145
    v_and_b32 v134, v10, v146
    v_and_b32 v135, v10, v147
    s_waitcnt vmcnt(0)
    s_nop 0
    v_mfma_f32_16x16x32_bf16 v[148:151], v[72:75], v[132:135], v[148:151]
    v_mfma_f32_16x16x32_bf16 v[152:155], v[76:79], v[132:135], v[152:155]
    s_nop 7
    v_mov_b32_dpp v148, v152 quad_perm:[0,1,2,3] row_mask:0xf bank_mask:0xc
    v_mov_b32_dpp v149, v153 quad_perm:[0,1,2,3] row_mask:0xf bank_mask:0xc
    v_mov_b32_dpp v150, v154 quad_perm:[0,1,2,3] row_mask:0xf bank_mask:0xc
    v_mov_b32_dpp v151, v155 quad_perm:[0,1,2,3] row_mask:0xf bank_mask:0xc
    ds_write_b128 v2, v[148:151]
    s_waitcnt lgkmcnt(0)
    s_barrier
    v_and_b32 v200, 3, v0
    v_bfe_u32 v201, v0, 2, 2
    v_lshrrev_b32 v202, 4, v0
    s_lshl_b32 s34, s3, 10
    s_add_u32 s34, s34, 122112
    v_lshl_add_u32 v203, v0, 4, s34
    s_movk_i32 s48, 16384
    s_cmp_eq_u32 s63, 0
    s_cbranch_scc1 L_t_wo
    s_cmp_eq_u32 s63, 2
    s_cbranch_scc1 L_t_w2
    s_cmp_eq_u32 s63, 3
    s_cbranch_scc1 L_fin
    v_and_b32 v205, 15, v0
    v_lshlrev_b32 v205, 4, v205
    s_and_b32 s49, s3, 3
    s_mul_i32 s34, s49, 1280
    s_add_u32 s34, s34, s99
    s_add_u32 s34, s34, 98304
    v_lshl_add_u32 v206, v202, 18, v205
    v_add_u32 v206, s34, v206
    s_mul_i32 s34, s49, 3840
    v_add_u32 v205, s34, v205
    s_barrier
L_r_w1:
    s_cmp_lt_u32 s3, 4
    s_cbranch_scc1 L_w1_ln
    s_and_b32 s49, s3, 3
    s_lshl_b32 s42, s49, 11
    s_add_u32 s42, s42, 40960
    s_bitcmp1_b32 s62, 0
    s_cbranch_scc1 L_rot1
    s_add_u32 m0, s42, 0
    s_add_u32 s34, s50, 0
    buffer_load_dwordx4 v15, s[52:55], s34 offen  lds
    s_add_u32 m0, s42, 1024
    s_add_u32 s34, s50, 884736
    buffer_load_dwordx4 v15, s[52:55], s34 offen  lds
    s_add_u32 m0, s42, 8192
    s_add_u32 s34, s50, 110592
    buffer_load_dwordx4 v15, s[52:55], s34 offen  lds
    s_add_u32 m0, s42, 9216
    s_add_u32 s34, s50, 995328
    buffer_load_dwordx4 v15, s[52:55], s34 offen  lds
    s_add_u32 m0, s42, 32768
    s_add_u32 s34, s51, 0
    buffer_load_dwordx4 v15, s[52:55], s34 offen  lds
    s_add_u32 m0, s42, 33792
    s_add_u32 s34, s51, 13824
    buffer_load_dwordx4 v15, s[52:55], s34 offen  lds
    s_add_u32 m0, s42, 16384
    s_add_u32 s34, s50, 221184
    buffer_load_dwordx4 v15, s[52:55], s34 offen  lds
    s_add_u32 m0, s42, 17408
    s_add_u32 s34, s50, 1105920
    buffer_load_dwordx4 v15, s[52:55], s34 offen  lds
    s_add_u32 m0, s42, 24576
    s_add_u32 s34, s50, 331776
    buffer_load_dwordx4 v15, s[52:55], s34 offen  lds
    s_add_u32 m0, s42, 25600
    s_add_u32 s34, s50, 1216512
    buffer_load_dwordx4 v15, s[52:55], s34 offen  lds
    s_branch L_rot2
L_rot1:
    s_add_u32 m0, s42, 16384
    s_add_u32 s34, s50, 221184
    buffer_load_dwordx4 v15, s[52:55], s34 offen  lds
    s_add_u32 m0, s42, 17408
    s_add_u32 s34, s50, 1105920
    buffer_load_dwordx4 v15, s[52:55], s34 offen  lds
    s_add_u32 m0, s42, 24576
    s_add_u32 s34, s50, 331776
    buffer_load_dwordx4 v15, s[52:55], s34 offen  lds
    s_add_u32 m0, s42, 25600
    s_add_u32 s34, s50, 1216512
    buffer_load_dwordx4 v15, s[52:55], s34 offen  lds
    s_add_u32 m0, s42, 32768
    s_add_u32 s34, s51, 0
    buffer_load_dwordx4 v15, s[52:55], s34 offen  lds
    s_add_u32 m0, s42, 33792
    s_add_u32 s34, s51, 13824
    buffer_load_dwordx4 v15, s[52:55], s34 offen  lds
    s_add_u32 m0, s42, 0
    s_add_u32 s34, s50, 0
    buffer_load_dwordx4 v15, s[52:55], s34 offen  lds
    s_add_u32 m0, s42, 1024
    s_add_u32 s34, s50, 884736
    buffer_load_dwordx4 v15, s[52:55], s34 offen  lds
    s_add_u32 m0, s42, 8192
    s_add_u32 s34, s50, 110592
    buffer_load_dwordx4 v15, s[52:55], s34 offen  lds
    s_add_u32 m0, s42, 9216
    s_add_u32 s34, s50, 995328
    buffer_load_dwordx4 v15, s[52:55], s34 offen  lds
L_rot2:
    v_lshrrev_b32 v3, 2, v0
    v_lshlrev_b32 v3, 6, v3
    v_lshl_add_u32 v3, v200, 3, v3
    v_add_u32 v3, s42, v3
    s_lshl_b32 s35, s49, 6
    s_add_u32 s35, s35, 116736
    v_mul_u32_u24 v4, 1344, v200
    v_lshl_add_u32 v4, v202, 4, v4
    v_add_u32 v4, s35, v4
    s_lshl_b32 s35, s49, 11
    s_add_u32 s35, s35, 122112
    v_lshl_add_u32 v5, v0, 4, s35
    s_waitcnt vmcnt(0)
    s_barrier
    ds_read_b64_tr_b16 v[32:33], v3 offset:0
    ds_read_b64_tr_b16 v[34:35], v3 offset:1024
    ds_read_b64_tr_b16 v[36:37], v3 offset:32
    ds_read_b64_tr_b16 v[38:39], v3 offset:1056
    ds_read_b64_tr_b16 v[40:41], v3 offset:8192
    ds_read_b64_tr_b16 v[42:43], v3 offset:9216
    ds_read_b64_tr_b16 v[44:45], v3 offset:8224
    ds_read_b64_tr_b16 v[46:47], v3 offset:9248
    ds_read_b64_tr_b16 v[48:49], v3 offset:16384
    ds_read_b64_tr_b16 v[50:51], v3 offset:17408
    ds_read_b64_tr_b16 v[52:53], v3 offset:16416
    ds_read_b64_tr_b16 v[54:55], v3 offset:17440
    s_waitcnt lgkmcnt(4)
    ds_read_b64_tr_b16 v[56:57], v3 offset:24576
    ds_read_b64_tr_b16 v[58:59], v3 offset:25600
    ds_read_b64_tr_b16 v[60:61], v3 offset:24608
    ds_read_b64_tr_b16 v[62:63], v3 offset:25632
    ds_read_b64_tr_b16 v[64:65], v3 offset:32768
    ds_read_b64_tr_b16 v[66:67], v3 offset:33792
    ds_read_b64_tr_b16 v[68:69], v3 offset:32800
    ds_read_b64_tr_b16 v[70:71], v3 offset:33824
    s_waitcnt lgkmcnt(0)
    s_barrier
    ds_read_b128 v[140:143], v4 offset:0
    ds_read_b128 v[144:147], v4 offset:256
    ds_read_b128 v[148:151], v4 offset:512
    ds_read_b128 v[152:155], v4 offset:768
    ds_read_b128 v[156:159], v4 offset:1024
    s_waitcnt lgkmcnt(4)
    v_mfma_f32_16x16x32_bf16 v[20:23], v[32:35], v[140:143], 0
    v_mfma_f32_16x16x32_bf16 v[24:27], v[36:39], v[140:143], 0
    s_waitcnt lgkmcnt(3)
    v_mfma_f32_16x16x32_bf16 v[20:23], v[40:43], v[144:147], v[20:23]
    v_mfma_f32_16x16x32_bf16 v[24:27], v[44:47], v[144:147], v[24:27]
    s_waitcnt lgkmcnt(2)
    v_mfma_f32_16x16x32_bf16 v[20:23], v[48:51], v[148:151], v[20:23]
    v_mfma_f32_16x16x32_bf16 v[24:27], v[52:55], v[148:151], v[24:27]
    s_waitcnt lgkmcnt(1)
    v_mfma_f32_16x16x32_bf16 v[20:23], v[56:59], v[152:155], v[20:23]
    v_mfma_f32_16x16x32_bf16 v[24:27], v[60:63], v[152:155], v[24:27]
    s_waitcnt lgkmcnt(0)
    v_mfma_f32_16x16x32_bf16 v[20:23], v[64:67], v[156:159], v[20:23]
    v_mfma_f32_16x16x32_bf16 v[24:27], v[68:71], v[156:159], v[24:27]
    s_nop 6
    ds_write_b128 v5, v[20:23]
    ds_write_b128 v5, v[24:27] offset:1024
    s_waitcnt lgkmcnt(0)
    s_barrier
    s_branch L_fin
L_w1_ln:
    ds_read_b128 v[140:143], v205 offset:0
    ds_read_b128 v[144:147], v205 offset:256
    ds_read_b128 v[148:151], v205 offset:512
    ds_read_b128 v[152:155], v205 offset:768
    ds_read_b128 v[156:159], v205 offset:1024
    ds_read_b128 v[160:163], v205 offset:1280
    ds_read_b128 v[164:167], v205 offset:1536
    ds_read_b128 v[168:171], v205 offset:1792
    ds_read_b128 v[172:175], v205 offset:2048
    ds_read_b128 v[176:179], v205 offset:2304
    ds_read_b128 v[180:183], v205 offset:2560
    ds_read_b128 v[184:187], v205 offset:2816
    ds_read_b128 v[188:191], v205 offset:3072
    ds_read_b128 v[192:195], v205 offset:3328
    ds_read_b128 v[196:199], v205 offset:3584
    v_and_b32 v8, 1, v0
    v_lshlrev_b32 v8, 4, v8
    v_mov_b32 v9, 0xffff
    v_lshlrev_b32 v8, v8, v9
    v_bfe_u32 v9, v0, 1, 2
    v_cmp_eq_u32 vcc, 0, v9
    s_nop 1
    v_cndmask_b32 v16, 0, v8, vcc
    v_cmp_eq_u32 vcc, 1, v9
    s_nop 1
    v_cndmask_b32 v17, 0, v8, vcc
    v_cmp_eq_u32 vcc, 2, v9
    s_nop 1
    v_cndmask_b32 v18, 0, v8, vcc
    v_cmp_eq_u32 vcc, 3, v9
    s_nop 1
    v_cndmask_b32 v19, 0, v8, vcc
    v_bfe_u32 v8, v0, 3, 1
    v_cmp_eq_u32 vcc, 0, v8
    s_nop 1
    v_cndmask_b32 v20, 0, v16, vcc
    v_xor_b32 v24, v20, v16
    v_cndmask_b32 v21, 0, v17, vcc
    v_xor_b32 v25, v21, v17
    v_cndmask_b32 v22, 0, v18, vcc
    v_xor_b32 v26, v22, v18
    v_cndmask_b32 v23, 0, v19, vcc
    v_xor_b32 v27, v23, v19
    v_and_b32 v52, 0x3f803f80, v20
    v_and_b32 v60, 0x3e803e80, v20
    v_and_b32 v53, 0x3f803f80, v21
    v_and_b32 v61, 0x3e803e80, v21
    v_and_b32 v54, 0x3f803f80, v22
    v_and_b32 v62, 0x3e803e80, v22
    v_and_b32 v55, 0x3f803f80, v23
    v_and_b32 v63, 0x3e803e80, v23
    v_and_b32 v56, 0x3f803f80, v24
    v_and_b32 v64, 0x3e803e80, v24
    v_and_b32 v57, 0x3f803f80, v25
    v_and_b32 v65, 0x3e803e80, v25
    v_and_b32 v58, 0x3f803f80, v26
    v_and_b32 v66, 0x3e803e80, v26
    v_and_b32 v59, 0x3f803f80, v27
    v_and_b32 v67, 0x3e803e80, v27
    s_waitcnt lgkmcnt(0)
    v_mfma_f32_16x16x32_bf16 v[68:71], v[140:143], v[60:63], 0
    v_mfma_f32_16x16x32_bf16 v[68:71], v[144:147], v[64:67], v[68:71]
    v_mfma_f32_16x16x32_bf16 v[72:75], v[148:151], v[60:63], 0
    v_mfma_f32_16x16x32_bf16 v[72:75], v[152:155], v[64:67], v[72:75]
    v_mfma_f32_16x16x32_bf16 v[76:79], v[156:159], v[60:63], 0
    v_mfma_f32_16x16x32_bf16 v[116:119], v[160:163], v[60:63], 0
    v_mfma_f32_16x16x32_bf16 v[116:119], v[164:167], v[64:67], v[116:119]
    v_mfma_f32_16x16x32_bf16 v[120:123], v[168:171], v[60:63], 0
    v_mfma_f32_16x16x32_bf16 v[120:123], v[172:175], v[64:67], v[120:123]
    v_mfma_f32_16x16x32_bf16 v[124:127], v[176:179], v[60:63], 0
    v_mfma_f32_16x16x32_bf16 v[80:83], v[180:183], v[60:63], 1.0
    v_mfma_f32_16x16x32_bf16 v[80:83], v[184:187], v[64:67], v[80:83]
    v_mfma_f32_16x16x32_bf16 v[84:87], v[188:191], v[60:63], 1.0
    v_mfma_f32_16x16x32_bf16 v[84:87], v[192:195], v[64:67], v[84:87]
    v_mfma_f32_16x16x32_bf16 v[88:91], v[196:199], v[60:63], 1.0
    s_mul_i32 s34, s3, 1344
    s_add_u32 s34, s34, 116736
    v_lshl_add_u32 v7, v0, 4, s34
    v_lshlrev_b32 v8, 6, v202
    v_lshl_add_u32 v8, v200, 4, v8
    v_and_b32 v9, 1, v201
    v_lshl_add_u32 v8, v9, 3, v8
    v_add_u32 v8, s34, v8
    v_bfe_u32 v9, v0, 3, 1
    v_mul_u32_u24 v9, 9216, v9
    v_sub_u32 v8, v8, v9
    v_lshrrev_b32 v9, 5, v0
    v_lshlrev_b32 v9, 10, v9
    v_and_b32 v6, 1, v202
    v_lshl_add_u32 v9, v6, 9, v9
    v_bfe_u32 v6, v0, 1, 1
    v_lshl_add_u32 v9, v6, 8, v9
    v_lshl_add_u32 v9, v201, 4, v9
    v_and_b32 v6, 1, v0
    v_lshl_add_u32 v9, v6, 3, v9
    v_add_u32 v9, 122112, v9
    s_lshr_b32 s34, s62, 3
    s_lshl_b32 s34, s34, 8
    s_and_b32 s49, s62, 3
    s_lshl_b32 s49, s49, 18
    s_add_u32 s34, s34, s49
    s_bfe_u32 s49, s62, 0x10002
    s_lshl_b32 s49, s49, 14
    s_add_u32 s34, s34, s49
    s_add_u32 s34, s34, 103424
    v_lshl_add_u32 v5, v0, 2, s34
    s_bfe_u32 s49, s60, 0x10002
    s_lshl_b32 s49, s49, 13
    s_xor_b32 s53, s99, s49
    s_xor_b32 s52, s53, 8192
    v_mov_b32 v140, -1
    v_mov_b32 v141, -1
    v_mov_b32 v142, -1
    v_mov_b32 v143, -1
    v_mov_b32 v144, -1
    v_mov_b32 v145, -1
    v_mov_b32 v146, -1
    v_mov_b32 v147, -1
    v_mov_b32 v148, -1
    v_mov_b32 v149, -1
    v_mov_b32 v150, -1
    v_mov_b32 v151, -1
    v_mov_b32 v152, -1
    v_mov_b32 v153, -1
    v_mov_b32 v154, -1
    v_mov_b32 v155, -1
    v_mov_b32 v156, -1
    v_mov_b32 v157, -1
    v_mov_b32 v158, -1
    v_mov_b32 v159, -1
    v_mov_b32 v160, -1
    v_mov_b32 v161, -1
    v_mov_b32 v162, -1
    v_mov_b32 v163, -1
    v_mov_b32 v164, -1
    v_mov_b32 v165, -1
    v_mov_b32 v166, -1
    v_mov_b32 v167, -1
    v_mov_b32 v168, -1
    v_mov_b32 v169, -1
    v_mov_b32 v170, -1
    v_mov_b32 v171, -1
    v_mov_b32 v172, -1
    v_mov_b32 v173, -1
    v_mov_b32 v174, -1
    v_mov_b32 v175, -1
    v_mov_b32 v176, -1
    v_mov_b32 v177, -1
    v_mov_b32 v178, -1
    v_mov_b32 v179, -1
    s_barrier
    s_mov_b32 s35, 0
    s_mov_b64 s[40:41], -1
    s_mov_b64 s[42:43], -1
    s_mov_b64 s[36:37], -1
    s_mov_b64 s[50:51], -1
    s_mov_b32 s56, 0x00010001
    s_mov_b32 s57, 0x00010001
L_pb:
    s_or_b64 s[58:59], s[36:37], s[56:57]
    s_and_b64 exec, s[58:59], s[40:41]
    s_cbranch_execz L_pbs0
    buffer_load_dwordx4 v[140:143], v206, s[44:47], 0 offen offset:0 sc1
    s_and_b64 exec, s[36:37], s[40:41]
    s_cbranch_execz L_pbs0
    buffer_load_dwordx4 v[148:151], v206, s[44:47], 0 offen offset:256 sc1
    buffer_load_dwordx4 v[156:159], v206, s[44:47], 0 offen offset:512 sc1
    buffer_load_dwordx4 v[164:167], v206, s[44:47], 0 offen offset:768 sc1
    buffer_load_dwordx4 v[172:175], v206, s[44:47], 0 offen offset:1024 sc1
L_pbs0:
    s_or_b64 s[58:59], s[50:51], s[56:57]
    s_and_b64 exec, s[58:59], s[42:43]
    s_cbranch_execz L_pbs1
    buffer_load_dwordx4 v[144:147], v206, s[44:47], s48 offen offset:0 sc1
    s_and_b64 exec, s[50:51], s[42:43]
    s_cbranch_execz L_pbs1
    buffer_load_dwordx4 v[152:155], v206, s[44:47], s48 offen offset:256 sc1
    buffer_load_dwordx4 v[160:163], v206, s[44:47], s48 offen offset:512 sc1
    buffer_load_dwordx4 v[168:171], v206, s[44:47], s48 offen offset:768 sc1
    buffer_load_dwordx4 v[176:179], v206, s[44:47], s48 offen offset:1024 sc1
L_pbs1:
    s_mov_b64 exec, -1
    s_add_u32 s35, s35, 1
    s_waitcnt vmcnt(0)
    v_max3_u32 v28, v140, v141, v142
    v_max3_u32 v29, v144, v145, v146
    v_max3_u32 v28, v28, v143, v148
    v_max3_u32 v29, v29, v147, v152
    v_max3_u32 v28, v28, v149, v150
    v_max3_u32 v29, v29, v153, v154
    v_max3_u32 v28, v28, v151, v156
    v_max3_u32 v29, v29, v155, v160
    v_max3_u32 v28, v28, v157, v158
    v_max3_u32 v29, v29, v161, v162
    v_max3_u32 v28, v28, v159, v164
    v_max3_u32 v29, v29, v163, v168
    v_max3_u32 v28, v28, v165, v166
    v_max3_u32 v29, v29, v169, v170
    v_max3_u32 v28, v28, v167, v172
    v_max3_u32 v29, v29, v171, v176
    v_max3_u32 v28, v28, v173, v174
    v_max3_u32 v29, v29, v177, v178
    v_max_u32 v28, v28, v175
    v_max_u32 v29, v29, v179
    v_cmp_eq_u32 s[40:41], -1, v28
    v_cmp_eq_u32 s[42:43], -1, v29
    v_mfma_f32_16x16x32_bf16 v[128:131], v[140:143], v[52:55], v[68:71]
    s_or_b64 vcc, s[40:41], s[42:43]
    s_cbranch_scc0 L_pbd
    s_cmp_lg_u32 s35, 64
    s_cbranch_scc1 L_tmo52
    s_mov_b64 exec, -1
    v_lshlrev_b32 v243, 4, v0
    v_add_u32 v243, 131328, v243
    ds_read_b96 v[240:242], v243
    s_waitcnt lgkmcnt(0)
    buffer_store_dwordx2 v[240:241], v242, s[44:47], 0 offen sc1
L_tmo52:
    v_cmp_ne_u32 s[36:37], -1, v140
    v_cmp_ne_u32 s[50:51], -1, v144
    s_and_b64 s[36:37], s[36:37], s[56:57]
    s_and_b64 s[50:51], s[50:51], s[56:57]
    s_bcnt1_i32_b64 s34, s[36:37]
    s_bcnt1_i32_b64 s49, s[50:51]
    s_add_u32 s34, s34, s49
    s_cmp_ge_u32 s34, 4
    s_cselect_b64 s[36:37], s[56:57], s[36:37]
    s_cselect_b64 s[50:51], s[56:57], s[50:51]
    s_mul_i32 s36, s36, 0xffff
    s_mul_i32 s37, s37, 0xffff
    s_mul_i32 s50, s50, 0xffff
    s_mul_i32 s51, s51, 0xffff
    s_cmp_lt_u32 s35, 60000
    s_cbranch_scc1 L_pb
L_pbd:
    v_mfma_f32_16x16x32_bf16 v[128:131], v[144:147], v[52:55], v[128:131]
    v_mfma_f32_16x16x32_bf16 v[128:131], v[148:151], v[56:59], v[128:131]
    v_mfma_f32_16x16x32_bf16 v[128:131], v[152:155], v[56:59], v[128:131]
    v_mfma_f32_16x16x32_bf16 v[132:135], v[156:159], v[52:55], v[72:75]
    v_mfma_f32_16x16x32_bf16 v[132:135], v[160:163], v[52:55], v[132:135]
    v_mfma_f32_16x16x32_bf16 v[132:135], v[164:167], v[56:59], v[132:135]
    v_mfma_f32_16x16x32_bf16 v[132:135], v[168:171], v[56:59], v[132:135]
    v_mfma_f32_16x16x32_bf16 v[136:139], v[172:175], v[52:55], v[76:79]
    v_mfma_f32_16x16x32_bf16 v[136:139], v[176:179], v[52:55], v[136:139]
    s_nop 1
    v_pk_add_f32 v[20:21], v[128:129], v[130:131]
    v_pk_mul_f32 v[22:23], v[128:129], v[128:129]
    v_pk_fma_f32 v[22:23], v[130:131], v[130:131], v[22:23]
    s_nop 0
    v_pk_add_f32 v[20:21], v[20:21], v[132:133]
    v_pk_fma_f32 v[22:23], v[132:133], v[132:133], v[22:23]
    v_pk_add_f32 v[20:21], v[20:21], v[134:135]
    v_pk_fma_f32 v[22:23], v[134:135], v[134:135], v[22:23]
    v_pk_add_f32 v[20:21], v[20:21], v[136:137]
    v_pk_fma_f32 v[22:23], v[136:137], v[136:137], v[22:23]
    v_pk_add_f32 v[20:21], v[20:21], v[138:139]
    v_pk_fma_f32 v[22:23], v[138:139], v[138:139], v[22:23]
    v_add_f32 v20, v20, v21
    v_add_f32 v21, v22, v23
    s_nop 0
    v_add_f32_dpp v20, v20, v20 row_ror:8 row_mask:0xf bank_mask:0xf
    v_add_f32_dpp v21, v21, v21 row_ror:8 row_mask:0xf bank_mask:0xf
    s_nop 0
    v_add_f32_dpp v20, v20, v20 row_ror:4 row_mask:0xf bank_mask:0xf
    v_add_f32_dpp v21, v21, v21 row_ror:4 row_mask:0xf bank_mask:0xf
    s_nop 0
    v_add_f32_dpp v20, v20, v20 row_ror:2 row_mask:0xf bank_mask:0xf
    v_add_f32_dpp v21, v21, v21 row_ror:2 row_mask:0xf bank_mask:0xf
    s_nop 0
    v_add_f32_dpp v20, v20, v20 row_ror:1 row_mask:0xf bank_mask:0xf
    v_add_f32_dpp v21, v21, v21 row_ror:1 row_mask:0xf bank_mask:0xf
    v_mov_b32 v22, v20
    v_mov_b32 v23, v21
    s_nop 0
    v_permlane16_swap_b32 v20, v22
    v_permlane16_swap_b32 v21, v23
    v_add_f32 v20, v20, v22
    v_add_f32 v21, v21, v23
    v_mov_b32 v22, v20
    v_mov_b32 v23, v21
    s_nop 0
    v_permlane32_swap_b32 v20, v22
    v_permlane32_swap_b32 v21, v23
    v_add_f32 v20, v20, v22
    v_add_f32 v21, v21, v23
    v_mul_f32 v22, 0x3acccccd, v20
    v_mul_f32 v21, 0x3acccccd, v21
    v_fma_f32 v21, -v22, v22, v21
    v_max_f32 v21, 0, v21
    v_add_f32 v21, 0x3727c5ac, v21
    v_rsq_f32 v20, v21
    s_nop 0
    v_mul_f32_e64 v21, -v22, v20
    v_pk_fma_f32 v[128:129], v[128:129], v[20:21], v[20:21] op_sel:[0,0,1] op_sel_hi:[1,0,1]
    v_pk_fma_f32 v[130:131], v[130:131], v[20:21], v[20:21] op_sel:[0,0,1] op_sel_hi:[1,0,1]
    v_pk_fma_f32 v[132:133], v[132:133], v[20:21], v[20:21] op_sel:[0,0,1] op_sel_hi:[1,0,1]
    v_pk_fma_f32 v[134:135], v[134:135], v[20:21], v[20:21] op_sel:[0,0,1] op_sel_hi:[1,0,1]
    v_pk_fma_f32 v[136:137], v[136:137], v[20:21], v[20:21] op_sel:[0,0,1] op_sel_hi:[1,0,1]
    v_pk_fma_f32 v[138:139], v[138:139], v[20:21], v[20:21] op_sel:[0,0,1] op_sel_hi:[1,0,1]
    v_pk_fma_f32 v[128:129], v[128:129], v[80:81], v[116:117]
    v_pk_fma_f32 v[130:131], v[130:131], v[82:83], v[118:119]
    v_pk_fma_f32 v[132:133], v[132:133], v[84:85], v[120:121]
    v_pk_fma_f32 v[134:135], v[134:135], v[86:87], v[122:123]
    v_pk_fma_f32 v[136:137], v[136:137], v[88:89], v[124:125]
    v_pk_fma_f32 v[138:139], v[138:139], v[90:91], v[126:127]
    v_cvt_pk_bf16_f32 v20, v128, v129
    v_cvt_pk_bf16_f32 v21, v130, v131
    v_cvt_pk_bf16_f32 v22, v132, v133
    v_cvt_pk_bf16_f32 v23, v134, v135
    v_cvt_pk_bf16_f32 v24, v136, v137
    v_cvt_pk_bf16_f32 v25, v138, v139
    ds_write_b128 v7, v[20:23]
    ds_write_b64 v8, v[24:25] offset:1024
    s_waitcnt lgkmcnt(0)
    s_barrier
    s_barrier
    s_cmp_lg_u32 s3, 0
    s_cbranch_scc1 L_fin
    ds_read_b64 v[20:21], v9 offset:0
    ds_read_b64 v[22:23], v9 offset:2048
    ds_read_b64 v[24:25], v9 offset:4096
    ds_read_b64 v[26:27], v9 offset:6144
    s_mov_b32 s34, 0xbdd2d3e8
    v_mov_b32 v10, 0xc0135761
    s_waitcnt lgkmcnt(3)
    v_pk_add_f32 v[100:101], v[100:101], v[20:21]
    s_waitcnt lgkmcnt(2)
    v_pk_add_f32 v[100:101], v[100:101], v[22:23]
    s_waitcnt lgkmcnt(1)
    v_pk_add_f32 v[100:101], v[100:101], v[24:25]
    s_waitcnt lgkmcnt(0)
    v_pk_add_f32 v[100:101], v[100:101], v[26:27]
    v_pk_mul_f32 v[20:21], v[100:101], v[100:101]
    v_fma_f32 v20, v20, s34, v10
    v_fma_f32 v21, v21, s34, v10
    v_pk_mul_f32 v[20:21], v[20:21], v[100:101]
    v_exp_f32 v20, v20
    v_exp_f32 v21, v21
    v_add_f32 v20, 1.0, v20
    v_add_f32 v21, 1.0, v21
    v_rcp_f32 v20, v20
    v_rcp_f32 v21, v21
    s_nop 0
    v_pk_mul_f32 v[20:21], v[20:21], v[100:101]
    v_cvt_pk_bf16_f32 v20, v20, v21
    v_min_u32 v20, -2, v20
    buffer_store_dword v20, v5, s[44:47], s52 offen sc1
    buffer_store_dword v20, v5, s[44:47], s53 offen sc1
    s_branch L_fin
L_t_w2:
    v_bfe_u32 v205, v0, 3, 2
    v_lshlrev_b32 v204, 3, v205
    v_lshrrev_b32 v205, 5, v0
    v_lshl_add_u32 v204, v205, 2, v204
    v_bfe_u32 v205, v0, 1, 2
    v_add_u32 v204, v204, v205
    v_and_b32 v205, 1, v0
    s_sub_u32 s49, s3, 1
    v_mul_u32_u24 v204, 1280, v204
    v_lshl_add_u32 v204, v205, 4, v204
    s_lshl_b32 s34, s62, 5
    s_mul_i32 s35, s49, 327680
    s_add_u32 s34, s34, s35
    v_add_u32 v204, s34, v204
    s_lshl_b32 s50, s49, 13
    s_add_u32 s50, s50, 40960
    v_lshl_add_u32 v205, v0, 3, s50
    s_lshl_b32 s40, s62, 1
    s_add_u32 s41, s40, 8
    s_add_u32 s42, s40, 2
    s_barrier
L_w2_dma:
    s_and_b32 s34, s40, 7
    s_lshl_b32 s35, s34, 10
    s_add_u32 m0, s50, s35
    s_mul_i32 s34, s34, 40960
    buffer_load_dwordx4 v204, s[52:55], s34 offen  lds
    s_add_u32 s40, s40, 1
    s_cmp_lg_u32 s40, s42
    s_cbranch_scc1 L_w2_nw
L_w2_nw:
    s_cmp_lt_u32 s40, s41
    s_cbranch_scc1 L_w2_dma
    s_lshl_b32 s34, s49, 8
    s_add_u32 s34, s34, s99
    s_add_u32 s34, s34, 103424
    s_cmp_eq_u32 s49, 6
    s_cselect_b32 s35, 1, 3
    v_lshlrev_b32 v6, 6, v202
    v_lshl_add_u32 v6, v200, 4, v6
    v_add_u32 v6, s34, v6
    v_lshl_add_u32 v4, v201, 18, v6
    v_min_u32 v5, s35, v201
    v_lshl_add_u32 v5, v5, 18, v6
    s_waitcnt vmcnt(0)
    ds_read_b64_tr_b16 v[32:33], v205 offset:0
    ds_read_b64_tr_b16 v[34:35], v205 offset:512
    ds_read_b64_tr_b16 v[36:37], v205 offset:1024
    ds_read_b64_tr_b16 v[38:39], v205 offset:1536
    ds_read_b64_tr_b16 v[40:41], v205 offset:2048
    ds_read_b64_tr_b16 v[42:43], v205 offset:2560
    ds_read_b64_tr_b16 v[44:45], v205 offset:3072
    ds_read_b64_tr_b16 v[46:47], v205 offset:3584
    s_waitcnt lgkmcnt(0)
    ds_read_b64_tr_b16 v[48:49], v205 offset:4096
    ds_read_b64_tr_b16 v[50:51], v205 offset:4608
    ds_read_b64_tr_b16 v[52:53], v205 offset:5120
    ds_read_b64_tr_b16 v[54:55], v205 offset:5632
    ds_read_b64_tr_b16 v[56:57], v205 offset:6144
    ds_read_b64_tr_b16 v[58:59], v205 offset:6656
    ds_read_b64_tr_b16 v[60:61], v205 offset:7168
    ds_read_b64_tr_b16 v[62:63], v205 offset:7680
    s_waitcnt lgkmcnt(0)
    s_barrier
    s_sleep 1
    s_mov_b32 s35, 0
L_poll53:
    buffer_load_dwordx4 v[64:67], v4, s[44:47], 0 offen sc1
    buffer_load_dwordx4 v[68:71], v5, s[44:47], s48 offen sc1
    s_add_u32 s35, s35, 1
    s_waitcnt vmcnt(0)
    v_max3_u32 v28, v64, v65, v66
    v_max3_u32 v28, v28, v67, v68
    v_max3_u32 v28, v28, v69, v70
    v_max_u32 v28, v28, v71
    v_cmp_eq_u32 vcc, -1, v28
    s_cbranch_vccz L_done54
    s_cmp_lg_u32 s35, 64
    s_cbranch_scc1 L_tmo56
    s_mov_b64 exec, -1
    v_lshlrev_b32 v243, 4, v0
    v_add_u32 v243, 131328, v243
    ds_read_b96 v[240:242], v243
    s_waitcnt lgkmcnt(0)
    buffer_store_dwordx2 v[240:241], v242, s[44:47], 0 offen sc1
L_tmo56:
    s_cmp_lt_u32 s35, 60000
    s_cbranch_scc1 L_poll53
L_done54:
    v_mfma_f32_16x16x32_bf16 v[80:83], v[32:35], v[64:67], 0
    v_mfma_f32_16x16x32_bf16 v[84:87], v[36:39], v[64:67], 0
    v_mfma_f32_16x16x32_bf16 v[88:91], v[40:43], v[64:67], 0
    v_mfma_f32_16x16x32_bf16 v[92:95], v[44:47], v[64:67], 0
    v_mfma_f32_16x16x32_bf16 v[80:83], v[48:51], v[68:71], v[80:83]
    v_mfma_f32_16x16x32_bf16 v[84:87], v[52:55], v[68:71], v[84:87]
    v_mfma_f32_16x16x32_bf16 v[88:91], v[56:59], v[68:71], v[88:91]
    v_mfma_f32_16x16x32_bf16 v[92:95], v[60:63], v[68:71], v[92:95]
    s_nop 5
    v_mov_b32_dpp v80, v84 quad_perm:[0,1,2,3] row_mask:0xf bank_mask:0x2
    v_mov_b32_dpp v81, v85 quad_perm:[0,1,2,3] row_mask:0xf bank_mask:0x2
    v_mov_b32_dpp v82, v86 quad_perm:[0,1,2,3] row_mask:0xf bank_mask:0x2
    v_mov_b32_dpp v83, v87 quad_perm:[0,1,2,3] row_mask:0xf bank_mask:0x2
    v_mov_b32_dpp v80, v88 quad_perm:[0,1,2,3] row_mask:0xf bank_mask:0x4
    v_mov_b32_dpp v81, v89 quad_perm:[0,1,2,3] row_mask:0xf bank_mask:0x4
    v_mov_b32_dpp v82, v90 quad_perm:[0,1,2,3] row_mask:0xf bank_mask:0x4
    v_mov_b32_dpp v83, v91 quad_perm:[0,1,2,3] row_mask:0xf bank_mask:0x4
    v_mov_b32_dpp v80, v92 quad_perm:[0,1,2,3] row_mask:0xf bank_mask:0x8
    v_mov_b32_dpp v81, v93 quad_perm:[0,1,2,3] row_mask:0xf bank_mask:0x8
    v_mov_b32_dpp v82, v94 quad_perm:[0,1,2,3] row_mask:0xf bank_mask:0x8
    v_mov_b32_dpp v83, v95 quad_perm:[0,1,2,3] row_mask:0xf bank_mask:0x8
    ds_write_b128 v203, v[80:83]
    s_waitcnt lgkmcnt(0)
    s_barrier
    s_branch L_fin
L_w2_red:
    s_mov_b32 s35, 0
L_poll57:
    buffer_load_dwordx2 v[20:21], v204, s[44:47], 0 offen sc1
    buffer_load_dwordx2 v[22:23], v204, s[44:47], s48 offen sc1
    s_add_u32 s35, s35, 1
    s_waitcnt vmcnt(0)
    v_max3_u32 v28, v20, v21, v22
    v_max_u32 v28, v28, v23
    v_cmp_eq_u32 vcc, -1, v28
    s_cbranch_vccz L_done58
    s_cmp_lg_u32 s35, 21
    s_cbranch_scc1 L_tmo60
    s_mov_b64 exec, -1
    v_lshlrev_b32 v243, 4, v0
    v_add_u32 v243, 131328, v243
    ds_read_b96 v[240:242], v243
    s_waitcnt lgkmcnt(0)
    buffer_store_dwordx2 v[240:241], v242, s[44:47], 0 offen sc1
L_tmo60:
    s_sleep 12
    s_cmp_lt_u32 s35, 60000
    s_cbranch_scc1 L_poll57
L_done58:
    s_barrier
    v_lshlrev_b32 v44, 16, v20
    v_and_b32 v45, 0xffff0000, v20
    v_lshlrev_b32 v46, 16, v21
    v_and_b32 v47, 0xffff0000, v21
    v_lshlrev_b32 v48, 16, v22
    v_and_b32 v49, 0xffff0000, v22
    v_lshlrev_b32 v50, 16, v23
    v_and_b32 v51, 0xffff0000, v23
    v_add_f32 v108, v108, v44
    v_add_f32 v109, v109, v45
    v_add_f32 v110, v110, v46
    v_add_f32 v111, v111, v47
    v_add_f32 v108, v108, v48
    v_add_f32 v109, v109, v49
    v_add_f32 v110, v110, v50
    v_add_f32 v111, v111, v51
    s_mov_b32 s36, s28
    s_mov_b32 s37, s29
    s_movk_i32 s38, 5120
    v_lshl_add_u32 v112, v13, 28, v112
    s_barrier
    ds_read_b128 v[64:67], v203 offset:1024
    ds_read_b128 v[68:71], v203 offset:2048
    ds_read_b128 v[72:75], v203 offset:3072
    ds_read_b128 v[76:79], v203 offset:4096
    ds_read_b128 v[80:83], v203 offset:5120
    ds_read_b128 v[84:87], v203 offset:6144
    ds_read_b128 v[88:91], v203 offset:7168
    s_waitcnt lgkmcnt(5)
    v_pk_add_f32 v[64:65], v[64:65], v[68:69]
    v_pk_add_f32 v[66:67], v[66:67], v[70:71]
    s_waitcnt lgkmcnt(4)
    v_pk_add_f32 v[64:65], v[64:65], v[72:73]
    v_pk_add_f32 v[66:67], v[66:67], v[74:75]
    s_waitcnt lgkmcnt(3)
    v_pk_add_f32 v[64:65], v[64:65], v[76:77]
    v_pk_add_f32 v[66:67], v[66:67], v[78:79]
    s_waitcnt lgkmcnt(2)
    v_pk_add_f32 v[64:65], v[64:65], v[80:81]
    v_pk_add_f32 v[66:67], v[66:67], v[82:83]
    s_waitcnt lgkmcnt(1)
    v_pk_add_f32 v[64:65], v[64:65], v[84:85]
    v_pk_add_f32 v[66:67], v[66:67], v[86:87]
    s_waitcnt lgkmcnt(0)
    v_pk_add_f32 v[64:65], v[64:65], v[88:89]
    v_pk_add_f32 v[66:67], v[66:67], v[90:91]
    v_pk_fma_f32 v[64:65], v[64:65], v[104:105], v[108:109]
    v_pk_fma_f32 v[66:67], v[66:67], v[106:107], v[110:111]
    s_nop 0
    v_add_f32_dpp v64, v64, v64 row_ror:4 row_mask:0xf bank_mask:0xf
    v_add_f32_dpp v65, v65, v65 row_ror:4 row_mask:0xf bank_mask:0xf
    v_add_f32_dpp v66, v66, v66 row_ror:4 row_mask:0xf bank_mask:0xf
    v_add_f32_dpp v67, v67, v67 row_ror:4 row_mask:0xf bank_mask:0xf
    v_add_f32_dpp v64, v64, v64 row_ror:8 row_mask:0xf bank_mask:0xf
    v_add_f32_dpp v65, v65, v65 row_ror:8 row_mask:0xf bank_mask:0xf
    v_add_f32_dpp v66, v66, v66 row_ror:8 row_mask:0xf bank_mask:0xf
    v_add_f32_dpp v67, v67, v67 row_ror:8 row_mask:0xf bank_mask:0xf
    v_cvt_pk_bf16_f32 v20, v64, v65
    v_cvt_pk_bf16_f32 v21, v66, v67
    buffer_store_dwordx2 v[20:21], v112, s[36:39], 0 offen
    s_branch L_fin
L_t_wo:
    s_mov_b32 m0, s56
    s_nop 0
    buffer_load_dwordx4 v15, s[52:55], s57 offen  lds
    s_lshr_b32 s49, s3, 1
    s_lshl_b32 s49, s49, 18
    v_and_b32 v210, 7, v0
    s_mul_i32 s34, s60, 4096
    s_add_u32 s34, s34, s49
    s_add_u32 s34, s34, 147712
    v_lshrrev_b32 v211, 3, v0
    v_mul_u32_u24 v205, 512, v211
    v_add_u32 v204, s34, v205
    s_lshl_b32 s35, s51, 7
    s_add_u32 s34, s34, s35
    s_sub_u32 s34, s34, 256
    v_lshl_add_u32 v205, v210, 4, v205
    v_add_u32 v205, s34, v205
    s_lshl_b32 s34, s3, 12
    s_add_u32 s34, s34, 40960
    v_lshrrev_b32 v206, 2, v0
    v_lshlrev_b32 v206, 6, v206
    v_lshl_add_u32 v206, v200, 3, v206
    v_add_u32 v206, s34, v206
    s_mul_i32 s34, s3, 1152
    s_add_u32 s34, s34, 107520
    v_mul_u32_u24 v207, 144, v211
    v_lshl_add_u32 v207, v210, 4, v207
    v_add_u32 v207, s34, v207
    v_mul_u32_u24 v208, 144, v210
    v_lshl_add_u32 v208, v202, 4, v208
    v_add_u32 v208, s34, v208
    v_mul_u32_u24 v212, 144, v211
    v_add_u32 v212, s34, v212
    v_mul_u32_u24 v213, 144, v210
    v_add_u32 v213, s34, v213
    v_and_b32 v211, 1, v211
    v_lshl_add_u32 v203, v211, 6, v208
    v_add_u32 v203, 14592, v203
    v_mov_b32 v210, 98816
    v_cmp_eq_u32 vcc, 0, v211
    s_nop 1
    v_cndmask_b32 v209, v208, v210, vcc
    v_cndmask_b32 v208, v210, v208, vcc
    s_barrier
L_r_wo2:
    s_mov_b32 m0, s58
    s_nop 0
    buffer_load_dwordx4 v15, s[52:55], s59 offen  lds
    s_xor_b32 m0, s56, 2048
    s_sub_u32 s34, 40960, s57
    buffer_load_dwordx4 v15, s[52:55], s34 offen  lds
    s_xor_b32 m0, s58, 2048
    s_sub_u32 s34, 42240, s57
    buffer_load_dwordx4 v15, s[52:55], s34 offen  lds
L_r_wo3:
    s_mov_b32 s35, 0
    s_mov_b32 s48, 0
    buffer_load_dwordx4 v[64:67], v205, s[44:47], 0 offen sc1
    buffer_load_dwordx2 v[26:27], v204, s[44:47], 0 offen sc1
    s_waitcnt vmcnt(2)
    ds_read_b64_tr_b16 v[32:33], v206 offset:0
    ds_read_b64_tr_b16 v[34:35], v206 offset:1024
    ds_read_b64_tr_b16 v[36:37], v206 offset:32
    ds_read_b64_tr_b16 v[38:39], v206 offset:1056
    ds_read_b64_tr_b16 v[40:41], v206 offset:2048
    ds_read_b64_tr_b16 v[42:43], v206 offset:3072
    ds_read_b64_tr_b16 v[44:45], v206 offset:2080
    ds_read_b64_tr_b16 v[46:47], v206 offset:3104
    s_branch L_pam
L_pa:
    buffer_load_dwordx4 v[64:67], v205, s[44:47], 0 offen sc1
    buffer_load_dwordx2 v[26:27], v204, s[44:47], 0 offen sc1
L_pam:
    s_add_u32 s35, s35, 1
    s_waitcnt vmcnt(0)
    ds_write_b128 v207, v[64:67]
    ds_write_b32 v212, v26 offset:128
    v_max3_u32 v28, v64, v65, v66
    v_max3_u32 v28, v28, v67, v26
    v_cmp_eq_u32 vcc, -1, v28
    s_cbranch_vccz L_pad
    s_cmp_lg_u32 s35, 64
    s_cbranch_scc1 L_tmo61
    s_mov_b64 exec, -1
    v_lshlrev_b32 v243, 4, v0
    v_add_u32 v243, 131328, v243
    ds_read_b96 v[240:242], v243
    s_waitcnt lgkmcnt(0)
    buffer_store_dwordx2 v[240:241], v242, s[44:47], 0 offen sc1
L_tmo61:
    s_mov_b64 exec, vcc
    s_sleep 1
    s_cmp_lt_u32 s35, 60000
    s_cbranch_scc1 L_pa
L_pad:
    s_mov_b64 exec, -1
    ds_read_b32 v26, v213 offset:128
    ds_read_b128 v[68:71], v208 offset:0
    ds_read_b128 v[72:75], v209 offset:0
    ds_read_b128 v[76:79], v208 offset:64
    ds_read_b128 v[80:83], v209 offset:64
    s_waitcnt lgkmcnt(3)
    v_mfma_f32_16x16x32_bf16 v[20:23], v[32:35], v[68:71], 0
    s_waitcnt lgkmcnt(2)
    v_mfma_f32_16x16x32_bf16 v[20:23], v[36:39], v[72:75], v[20:23]
    s_waitcnt lgkmcnt(1)
    v_mfma_f32_16x16x32_bf16 v[20:23], v[40:43], v[76:79], v[20:23]
    s_waitcnt lgkmcnt(0)
    v_mfma_f32_16x16x32_bf16 v[20:23], v[44:47], v[80:83], v[20:23]
    v_sub_f32_dpp v26, v26, v26 quad_perm:[1,0,3,2] row_mask:0xf bank_mask:0xf
    v_exp_f32 v26, v26
    s_nop 0
    v_add_f32 v26, 1.0, v26
    v_rcp_f32 v26, v26
    s_nop 2
    v_pk_mul_f32 v[20:21], v[20:21], v[26:27] op_sel_hi:[1,0]
    v_pk_mul_f32 v[22:23], v[22:23], v[26:27] op_sel_hi:[1,0]
    ds_write_b128 v203, v[20:23]
    s_waitcnt lgkmcnt(0)
    s_barrier
    s_cmp_lg_u32 s3, 0
    s_cbranch_scc1 L_wo_x
    ds_read_b128 v[64:67], v207 offset:14592
    ds_read_b128 v[68:71], v207 offset:15744
    ds_read_b128 v[72:75], v207 offset:16896
    ds_read_b128 v[76:79], v207 offset:18048
    ds_read_b128 v[80:83], v207 offset:19200
    ds_read_b128 v[84:87], v207 offset:20352
    ds_read_b128 v[88:91], v207 offset:21504
    ds_read_b128 v[92:95], v207 offset:22656
    s_waitcnt lgkmcnt(6)
    v_pk_add_f32 v[64:65], v[64:65], v[68:69]
    v_pk_add_f32 v[66:67], v[66:67], v[70:71]
    s_waitcnt lgkmcnt(5)
    v_pk_add_f32 v[64:65], v[64:65], v[72:73]
    v_pk_add_f32 v[66:67], v[66:67], v[74:75]
    s_waitcnt lgkmcnt(4)
    v_pk_add_f32 v[64:65], v[64:65], v[76:77]
    v_pk_add_f32 v[66:67], v[66:67], v[78:79]
    s_waitcnt lgkmcnt(3)
    v_pk_add_f32 v[64:65], v[64:65], v[80:81]
    v_pk_add_f32 v[66:67], v[66:67], v[82:83]
    s_waitcnt lgkmcnt(2)
    v_pk_add_f32 v[64:65], v[64:65], v[84:85]
    v_pk_add_f32 v[66:67], v[66:67], v[86:87]
    s_waitcnt lgkmcnt(1)
    v_pk_add_f32 v[64:65], v[64:65], v[88:89]
    v_pk_add_f32 v[66:67], v[66:67], v[90:91]
    s_waitcnt lgkmcnt(0)
    v_pk_add_f32 v[64:65], v[64:65], v[92:93]
    v_pk_add_f32 v[66:67], v[66:67], v[94:95]
    v_pk_mul_f32 v[20:21], v[64:65], v[100:101]
    v_pk_mul_f32 v[22:23], v[66:67], v[102:103]
    s_nop 0
    v_add_f32_dpp v20, v20, v20 row_ror:8 row_mask:0xf bank_mask:0xf
    v_add_f32_dpp v21, v21, v21 row_ror:8 row_mask:0xf bank_mask:0xf
    v_add_f32_dpp v22, v22, v22 row_ror:8 row_mask:0xf bank_mask:0xf
    v_add_f32_dpp v23, v23, v23 row_ror:8 row_mask:0xf bank_mask:0xf
    v_cvt_pk_bf16_f32 v28, v20, v21
    v_cvt_pk_bf16_f32 v29, v22, v23
    v_min_u32 v28, -2, v28
    v_min_u32 v29, -2, v29
    buffer_store_dwordx2 v[28:29], v112, s[44:47], 0 offen sc1
L_wo_x:
    s_getreg_b32 s34, hwreg(HW_REG_XCC_ID, 0, 4)
    v_cmp_ne_u32 vcc, s34, v27
    s_cbranch_vccz L_fin
    s_mov_b64 exec, -1
    v_lshlrev_b32 v243, 4, v0
    v_add_u32 v243, 131328, v243
    ds_read_b96 v[240:242], v243
    s_waitcnt lgkmcnt(0)
    buffer_store_dwordx2 v[240:241], v242, s[44:47], 0 offen sc1
L_fin:
L_exit:
    s_endpgm
L_codeend:
.section .rodata,"a"
.p2align 6
.amdhsa_kernel adaLN_cond__sliding_block_cached__dense_activation_gelu__decode_kernel
  .amdhsa_next_free_vgpr 256
  .amdhsa_next_free_sgpr 102
  .amdhsa_accum_offset 256
  .amdhsa_group_segment_fixed_size 0
  .amdhsa_kernarg_size 120
  .amdhsa_user_sgpr_count 2
  .amdhsa_user_sgpr_kernarg_segment_ptr 1
  .amdhsa_system_sgpr_workgroup_id_x 1
  .amdhsa_float_denorm_mode_32 3
.end_amdhsa_kernel
```

```asm
; @launch grid=(256,1,1) block=(512,1,1) lds=132352
.amdgcn_target "amdgcn-amd-amdhsa--gfx950"
.text
.globl adaLN_cond__sliding_block_cached__dense_activation_gelu__decode_kernel
.p2align 8
.type adaLN_cond__sliding_block_cached__dense_activation_gelu__decode_kernel,@function
adaLN_cond__sliding_block_cached__dense_activation_gelu__decode_kernel:
    s_cmp_ge_u32 s2, 256
    s_cbranch_scc1 L_exit
    s_load_dwordx4 s[4:7], s[0:1], 0
    v_lshrrev_b32 v1, 6, v0
    v_and_b32 v0, 63, v0
    v_readfirstlane_b32 s3, v1
    s_and_b32 s34, s2, 127
    s_lshl_b32 s34, s34, 21
    s_lshr_b32 s35, s2, 7
    s_lshl_b32 s35, s35, 18
    s_add_u32 s34, s34, s35
    s_add_u32 s34, s34, 1572864
    s_mov_b32 s38, 0x40000
    s_mov_b32 s39, 0x20000
    s_sub_u32 s49, s3, 1
    s_cbranch_scc1 L_nohead
    s_lshl_b32 s49, s49, 12
    v_lshl_add_u32 v1, v0, 4, s49
    s_waitcnt lgkmcnt(0)
    s_add_u32 s36, s6, s34
    s_addc_u32 s37, s7, 0
    buffer_load_dwordx4 v[16:19], v1, s[36:39], 0 offen offset:0 nt
    buffer_load_dwordx4 v[20:23], v1, s[36:39], 0 offen offset:1024 nt
    buffer_load_dwordx4 v[24:27], v1, s[36:39], 0 offen offset:2048 nt
L_nohead:
    s_load_dwordx8 s[8:15], s[0:1], 16
    s_load_dwordx4 s[16:19], s[0:1], 48
    s_load_dwordx8 s[20:27], s[0:1], 64
    s_load_dwordx4 s[28:31], s[0:1], 96
    s_load_dwordx2 s[32:33], s[0:1], 112
    s_and_b32 s60, s2, 7
    s_lshr_b32 s61, s2, 3
    s_mov_b32 s39, 0x20000
    s_mov_b32 s43, 0x20000
    s_mov_b32 s46, 966656
    s_mov_b32 s47, 0x20000
    s_cmp_lg_u32 s3, 0
    s_cbranch_scc1 L_stream
    s_setprio 3
    v_and_b32 v12, 3, v0
    v_bfe_u32 v13, v0, 2, 2
    v_lshrrev_b32 v14, 4, v0
    v_lshrrev_b32 v10, 3, v0
    v_and_b32 v11, 7, v0
    v_lshlrev_b32 v11, 4, v11
    s_lshr_b32 s50, s2, 2
    s_and_b32 s51, s2, 3
    s_mul_i32 s34, s51, 1228800
    s_lshl_b32 s35, s50, 7
    s_add_u32 s34, s34, s35
    v_mul_u32_u24 v17, 7680, v10
    v_add3_u32 v17, v17, v11, s34
    v_mul_u32_u24 v16, 1280, v12
    v_lshl_add_u32 v18, v14, 4, v16
    s_mul_i32 s34, s51, 320
    v_add_u32 v19, s34, v18
    s_mov_b32 s38, 4915200
    s_sub_u32 s52, s50, 10
    s_waitcnt lgkmcnt(0)
    s_add_u32 s44, s32, 0
    s_addc_u32 s45, s33, 0
    s_cmp_ge_u32 s2, 240
    s_cbranch_scc1 L_clear
    s_cmp_ge_u32 s52, 10
    s_cbranch_scc1 L_nox
    v_lshl_add_u32 v18, v13, 6, v18
    global_load_dwordx4 v[52:55], v18, s[4:5] offset:0
    global_load_dwordx4 v[56:59], v18, s[4:5] offset:256
    global_load_dwordx4 v[60:63], v18, s[4:5] offset:512
    global_load_dwordx4 v[64:67], v18, s[4:5] offset:768
    global_load_dwordx4 v[68:71], v18, s[4:5] offset:1024
    s_lshl_b32 s34, s52, 7
    v_lshl_add_u32 v16, v13, 5, v16
    v_lshl_add_u32 v16, v14, 3, v16
    v_add_u32 v16, s34, v16
    global_load_dwordx2 v[72:73], v16, s[4:5]
L_nox:
    global_load_dwordx4 v[32:35], v19, s[24:25] offset:0
    global_load_dwordx4 v[36:39], v19, s[24:25] offset:64
    global_load_dwordx4 v[40:43], v19, s[24:25] offset:128
    global_load_dwordx4 v[44:47], v19, s[24:25] offset:192
    global_load_dwordx4 v[48:51], v19, s[24:25] offset:256
    s_mov_b32 s36, s26
    s_mov_b32 s37, s27
    s_mov_b32 m0, 0
    s_mov_b32 s34, 0
L_dma1:
    buffer_load_dwordx4 v17, s[36:39], s34 offen  lds
    s_add_u32 m0, m0, 1024
    s_add_u32 s34, s34, 61440
    buffer_load_dwordx4 v17, s[36:39], s34 offen  lds
    s_add_u32 m0, m0, 1024
    s_add_u32 s34, s34, 61440
    buffer_load_dwordx4 v17, s[36:39], s34 offen  lds
    s_add_u32 m0, m0, 1024
    s_add_u32 s34, s34, 61440
    buffer_load_dwordx4 v17, s[36:39], s34 offen  lds
    s_add_u32 m0, m0, 1024
    s_add_u32 s34, s34, 61440
    s_cmp_lt_u32 s34, 1228800
    s_cbranch_scc1 L_dma1
    v_lshlrev_b32 v1, 2, v0
    v_add_u32 v1, 98304, v1
    v_mov_b32 v2, -1
    v_mov_b32 v3, 0
    ds_write_b32 v1, v2
    ds_write_b32 v1, v2 offset:256
    ds_write_b32 v1, v3 offset:512
    ds_write_b32 v1, v3 offset:768
    s_waitcnt lgkmcnt(0)
    s_barrier
    s_getpc_b64 s[56:57]
L_pc2:
    s_sub_u32 s56, s56, L_pc2-adaLN_cond__sliding_block_cached__dense_activation_gelu__decode_kernel
    s_subb_u32 s57, s57, 0
    s_lshl_b32 s34, s61, 10
    v_lshl_add_u32 v9, v0, 4, s34
    v_min_u32 v9, L_codeend-adaLN_cond__sliding_block_cached__dense_activation_gelu__decode_kernel-16, v9
    global_load_dwordx4 v[76:79], v9, s[56:57]
    s_and_b32 s34, s2, 31
    s_lshl_b32 s34, s34, 8
    s_lshr_b32 s35, s2, 7
    s_lshl_b32 s35, s35, 7
    s_add_u32 s49, s34, s35
    s_bfe_u32 s53, s2, 0x20005
    s_mul_i32 s34, s53, 1310720
    s_add_u32 s34, s34, s49
    v_lshl_add_u32 v16, v10, 13, v11
    v_add_u32 v16, s34, v16
    s_mov_b32 s36, s10
    s_mov_b32 s37, s11
    s_mov_b32 s38, 5242880
    s_mov_b32 m0, 20480
    s_mov_b32 s34, 0
L_dma3:
    buffer_load_dwordx4 v16, s[36:39], s34 offen  lds
    s_add_u32 m0, m0, 1024
    s_add_u32 s34, s34, 65536
    buffer_load_dwordx4 v16, s[36:39], s34 offen  lds
    s_add_u32 m0, m0, 1024
    s_add_u32 s34, s34, 65536
    buffer_load_dwordx4 v16, s[36:39], s34 offen  lds
    s_add_u32 m0, m0, 1024
    s_add_u32 s34, s34, 65536
    buffer_load_dwordx4 v16, s[36:39], s34 offen  lds
    s_add_u32 m0, m0, 1024
    s_add_u32 s34, s34, 65536
    s_cmp_lt_u32 s34, 1310720
    s_cbranch_scc1 L_dma3
    v_lshl_add_u32 v15, v14, 3, v13
    v_lshlrev_b32 v15, 7, v15
    v_lshl_add_u32 v15, v12, 3, v15
    s_waitcnt vmcnt(41)
    s_mov_b32 s34, 0xbfb8aa3b
    v_lshlrev_b32 v20, 16, v32
    v_and_b32 v21, 0xffff0000, v32
    v_lshlrev_b32 v22, 16, v33
    v_and_b32 v23, 0xffff0000, v33
    v_mul_f32 v24, s34, v20
    v_mul_f32 v25, s34, v21
    v_mul_f32 v26, s34, v22
    v_mul_f32 v27, s34, v23
    v_exp_f32 v24, v24
    v_exp_f32 v25, v25
    v_exp_f32 v26, v26
    v_exp_f32 v27, v27
    v_add_f32 v24, 1.0, v24
    v_add_f32 v25, 1.0, v25
    v_add_f32 v26, 1.0, v26
    v_add_f32 v27, 1.0, v27
    v_rcp_f32 v24, v24
    v_rcp_f32 v25, v25
    v_rcp_f32 v26, v26
    v_rcp_f32 v27, v27
    v_mul_f32 v24, v20, v24
    v_mul_f32 v25, v21, v25
    v_mul_f32 v26, v22, v26
    v_mul_f32 v27, v23, v27
    v_cvt_pk_bf16_f32 v32, v24, v25
    v_cvt_pk_bf16_f32 v33, v26, v27
    v_lshlrev_b32 v20, 16, v34
    v_and_b32 v21, 0xffff0000, v34
    v_lshlrev_b32 v22, 16, v35
    v_and_b32 v23, 0xffff0000, v35
    v_mul_f32 v24, s34, v20
    v_mul_f32 v25, s34, v21
    v_mul_f32 v26, s34, v22
    v_mul_f32 v27, s34, v23
    v_exp_f32 v24, v24
    v_exp_f32 v25, v25
    v_exp_f32 v26, v26
    v_exp_f32 v27, v27
    v_add_f32 v24, 1.0, v24
    v_add_f32 v25, 1.0, v25
    v_add_f32 v26, 1.0, v26
    v_add_f32 v27, 1.0, v27
    v_rcp_f32 v24, v24
    v_rcp_f32 v25, v25
    v_rcp_f32 v26, v26
    v_rcp_f32 v27, v27
    v_mul_f32 v24, v20, v24
    v_mul_f32 v25, v21, v25
    v_mul_f32 v26, v22, v26
    v_mul_f32 v27, v23, v27
    v_cvt_pk_bf16_f32 v34, v24, v25
    v_cvt_pk_bf16_f32 v35, v26, v27
    v_lshlrev_b32 v20, 16, v36
    v_and_b32 v21, 0xffff0000, v36
    v_lshlrev_b32 v22, 16, v37
    v_and_b32 v23, 0xffff0000, v37
    v_mul_f32 v24, s34, v20
    v_mul_f32 v25, s34, v21
    v_mul_f32 v26, s34, v22
    v_mul_f32 v27, s34, v23
    v_exp_f32 v24, v24
    v_exp_f32 v25, v25
    v_exp_f32 v26, v26
    v_exp_f32 v27, v27
    v_add_f32 v24, 1.0, v24
    v_add_f32 v25, 1.0, v25
    v_add_f32 v26, 1.0, v26
    v_add_f32 v27, 1.0, v27
    v_rcp_f32 v24, v24
    v_rcp_f32 v25, v25
    v_rcp_f32 v26, v26
    v_rcp_f32 v27, v27
    v_mul_f32 v24, v20, v24
    v_mul_f32 v25, v21, v25
    v_mul_f32 v26, v22, v26
    v_mul_f32 v27, v23, v27
    v_cvt_pk_bf16_f32 v36, v24, v25
    v_cvt_pk_bf16_f32 v37, v26, v27
    v_lshlrev_b32 v20, 16, v38
    v_and_b32 v21, 0xffff0000, v38
    v_lshlrev_b32 v22, 16, v39
    v_and_b32 v23, 0xffff0000, v39
    v_mul_f32 v24, s34, v20
    v_mul_f32 v25, s34, v21
    v_mul_f32 v26, s34, v22
    v_mul_f32 v27, s34, v23
    v_exp_f32 v24, v24
    v_exp_f32 v25, v25
    v_exp_f32 v26, v26
    v_exp_f32 v27, v27
    v_add_f32 v24, 1.0, v24
    v_add_f32 v25, 1.0, v25
    v_add_f32 v26, 1.0, v26
    v_add_f32 v27, 1.0, v27
    v_rcp_f32 v24, v24
    v_rcp_f32 v25, v25
    v_rcp_f32 v26, v26
    v_rcp_f32 v27, v27
    v_mul_f32 v24, v20, v24
    v_mul_f32 v25, v21, v25
    v_mul_f32 v26, v22, v26
    v_mul_f32 v27, v23, v27
    v_cvt_pk_bf16_f32 v38, v24, v25
    v_cvt_pk_bf16_f32 v39, v26, v27
    v_lshlrev_b32 v20, 16, v40
    v_and_b32 v21, 0xffff0000, v40
    v_lshlrev_b32 v22, 16, v41
    v_and_b32 v23, 0xffff0000, v41
    v_mul_f32 v24, s34, v20
    v_mul_f32 v25, s34, v21
    v_mul_f32 v26, s34, v22
    v_mul_f32 v27, s34, v23
    v_exp_f32 v24, v24
    v_exp_f32 v25, v25
    v_exp_f32 v26, v26
    v_exp_f32 v27, v27
    v_add_f32 v24, 1.0, v24
    v_add_f32 v25, 1.0, v25
    v_add_f32 v26, 1.0, v26
    v_add_f32 v27, 1.0, v27
    v_rcp_f32 v24, v24
    v_rcp_f32 v25, v25
    v_rcp_f32 v26, v26
    v_rcp_f32 v27, v27
    v_mul_f32 v24, v20, v24
    v_mul_f32 v25, v21, v25
    v_mul_f32 v26, v22, v26
    v_mul_f32 v27, v23, v27
    v_cvt_pk_bf16_f32 v40, v24, v25
    v_cvt_pk_bf16_f32 v41, v26, v27
    v_lshlrev_b32 v20, 16, v42
    v_and_b32 v21, 0xffff0000, v42
    v_lshlrev_b32 v22, 16, v43
    v_and_b32 v23, 0xffff0000, v43
    v_mul_f32 v24, s34, v20
    v_mul_f32 v25, s34, v21
    v_mul_f32 v26, s34, v22
    v_mul_f32 v27, s34, v23
    v_exp_f32 v24, v24
    v_exp_f32 v25, v25
    v_exp_f32 v26, v26
    v_exp_f32 v27, v27
    v_add_f32 v24, 1.0, v24
    v_add_f32 v25, 1.0, v25
    v_add_f32 v26, 1.0, v26
    v_add_f32 v27, 1.0, v27
    v_rcp_f32 v24, v24
    v_rcp_f32 v25, v25
    v_rcp_f32 v26, v26
    v_rcp_f32 v27, v27
    v_mul_f32 v24, v20, v24
    v_mul_f32 v25, v21, v25
    v_mul_f32 v26, v22, v26
    v_mul_f32 v27, v23, v27
    v_cvt_pk_bf16_f32 v42, v24, v25
    v_cvt_pk_bf16_f32 v43, v26, v27
    v_lshlrev_b32 v20, 16, v44
    v_and_b32 v21, 0xffff0000, v44
    v_lshlrev_b32 v22, 16, v45
    v_and_b32 v23, 0xffff0000, v45
    v_mul_f32 v24, s34, v20
    v_mul_f32 v25, s34, v21
    v_mul_f32 v26, s34, v22
    v_mul_f32 v27, s34, v23
    v_exp_f32 v24, v24
    v_exp_f32 v25, v25
    v_exp_f32 v26, v26
    v_exp_f32 v27, v27
    v_add_f32 v24, 1.0, v24
    v_add_f32 v25, 1.0, v25
    v_add_f32 v26, 1.0, v26
    v_add_f32 v27, 1.0, v27
    v_rcp_f32 v24, v24
    v_rcp_f32 v25, v25
    v_rcp_f32 v26, v26
    v_rcp_f32 v27, v27
    v_mul_f32 v24, v20, v24
    v_mul_f32 v25, v21, v25
    v_mul_f32 v26, v22, v26
    v_mul_f32 v27, v23, v27
    v_cvt_pk_bf16_f32 v44, v24, v25
    v_cvt_pk_bf16_f32 v45, v26, v27
    v_lshlrev_b32 v20, 16, v46
    v_and_b32 v21, 0xffff0000, v46
    v_lshlrev_b32 v22, 16, v47
    v_and_b32 v23, 0xffff0000, v47
    v_mul_f32 v24, s34, v20
    v_mul_f32 v25, s34, v21
    v_mul_f32 v26, s34, v22
    v_mul_f32 v27, s34, v23
    v_exp_f32 v24, v24
    v_exp_f32 v25, v25
    v_exp_f32 v26, v26
    v_exp_f32 v27, v27
    v_add_f32 v24, 1.0, v24
    v_add_f32 v25, 1.0, v25
    v_add_f32 v26, 1.0, v26
    v_add_f32 v27, 1.0, v27
    v_rcp_f32 v24, v24
    v_rcp_f32 v25, v25
    v_rcp_f32 v26, v26
    v_rcp_f32 v27, v27
    v_mul_f32 v24, v20, v24
    v_mul_f32 v25, v21, v25
    v_mul_f32 v26, v22, v26
    v_mul_f32 v27, v23, v27
    v_cvt_pk_bf16_f32 v46, v24, v25
    v_cvt_pk_bf16_f32 v47, v26, v27
    v_lshlrev_b32 v20, 16, v48
    v_and_b32 v21, 0xffff0000, v48
    v_lshlrev_b32 v22, 16, v49
    v_and_b32 v23, 0xffff0000, v49
    v_mul_f32 v24, s34, v20
    v_mul_f32 v25, s34, v21
    v_mul_f32 v26, s34, v22
    v_mul_f32 v27, s34, v23
    v_exp_f32 v24, v24
    v_exp_f32 v25, v25
    v_exp_f32 v26, v26
    v_exp_f32 v27, v27
    v_add_f32 v24, 1.0, v24
    v_add_f32 v25, 1.0, v25
    v_add_f32 v26, 1.0, v26
    v_add_f32 v27, 1.0, v27
    v_rcp_f32 v24, v24
    v_rcp_f32 v25, v25
    v_rcp_f32 v26, v26
    v_rcp_f32 v27, v27
    v_mul_f32 v24, v20, v24
    v_mul_f32 v25, v21, v25
    v_mul_f32 v26, v22, v26
    v_mul_f32 v27, v23, v27
    v_cvt_pk_bf16_f32 v48, v24, v25
    v_cvt_pk_bf16_f32 v49, v26, v27
    v_lshlrev_b32 v20, 16, v50
    v_and_b32 v21, 0xffff0000, v50
    v_lshlrev_b32 v22, 16, v51
    v_and_b32 v23, 0xffff0000, v51
    v_mul_f32 v24, s34, v20
    v_mul_f32 v25, s34, v21
    v_mul_f32 v26, s34, v22
    v_mul_f32 v27, s34, v23
    v_exp_f32 v24, v24
    v_exp_f32 v25, v25
    v_exp_f32 v26, v26
    v_exp_f32 v27, v27
    v_add_f32 v24, 1.0, v24
    v_add_f32 v25, 1.0, v25
    v_add_f32 v26, 1.0, v26
    v_add_f32 v27, 1.0, v27
    v_rcp_f32 v24, v24
    v_rcp_f32 v25, v25
    v_rcp_f32 v26, v26
    v_rcp_f32 v27, v27
    v_mul_f32 v24, v20, v24
    v_mul_f32 v25, v21, v25
    v_mul_f32 v26, v22, v26
    v_mul_f32 v27, v23, v27
    v_cvt_pk_bf16_f32 v50, v24, v25
    v_cvt_pk_bf16_f32 v51, v26, v27
    s_cmp_ge_u32 s52, 10
    s_cbranch_scc1 L_nostats
    v_mov_b32 v20, 0
    v_mov_b32 v21, 0
    v_mov_b32 v22, 0x3f803f80
    v_dot2c_f32_bf16 v20, v52, v22
    v_dot2c_f32_bf16 v21, v52, v52
    v_dot2c_f32_bf16 v20, v53, v22
    v_dot2c_f32_bf16 v21, v53, v53
    v_dot2c_f32_bf16 v20, v54, v22
    v_dot2c_f32_bf16 v21, v54, v54
    v_dot2c_f32_bf16 v20, v55, v22
    v_dot2c_f32_bf16 v21, v55, v55
    v_dot2c_f32_bf16 v20, v56, v22
    v_dot2c_f32_bf16 v21, v56, v56
    v_dot2c_f32_bf16 v20, v57, v22
    v_dot2c_f32_bf16 v21, v57, v57
    v_dot2c_f32_bf16 v20, v58, v22
    v_dot2c_f32_bf16 v21, v58, v58
    v_dot2c_f32_bf16 v20, v59, v22
    v_dot2c_f32_bf16 v21, v59, v59
    v_dot2c_f32_bf16 v20, v60, v22
    v_dot2c_f32_bf16 v21, v60, v60
    v_dot2c_f32_bf16 v20, v61, v22
    v_dot2c_f32_bf16 v21, v61, v61
    v_dot2c_f32_bf16 v20, v62, v22
    v_dot2c_f32_bf16 v21, v62, v62
    v_dot2c_f32_bf16 v20, v63, v22
    v_dot2c_f32_bf16 v21, v63, v63
    v_dot2c_f32_bf16 v20, v64, v22
    v_dot2c_f32_bf16 v21, v64, v64
    v_dot2c_f32_bf16 v20, v65, v22
    v_dot2c_f32_bf16 v21, v65, v65
    v_dot2c_f32_bf16 v20, v66, v22
    v_dot2c_f32_bf16 v21, v66, v66
    v_dot2c_f32_bf16 v20, v67, v22
    v_dot2c_f32_bf16 v21, v67, v67
    v_dot2c_f32_bf16 v20, v68, v22
    v_dot2c_f32_bf16 v21, v68, v68
    v_dot2c_f32_bf16 v20, v69, v22
    v_dot2c_f32_bf16 v21, v69, v69
    v_dot2c_f32_bf16 v20, v70, v22
    v_dot2c_f32_bf16 v21, v70, v70
    v_dot2c_f32_bf16 v20, v71, v22
    v_dot2c_f32_bf16 v21, v71, v71
    s_nop 1
    v_add_f32_dpp v20, v20, v20 row_ror:4 row_mask:0xf bank_mask:0xf
    v_add_f32_dpp v21, v21, v21 row_ror:4 row_mask:0xf bank_mask:0xf
    s_nop 0
    v_add_f32_dpp v20, v20, v20 row_ror:8 row_mask:0xf bank_mask:0xf
    v_add_f32_dpp v21, v21, v21 row_ror:8 row_mask:0xf bank_mask:0xf
    v_mov_b32 v22, v20
    v_mov_b32 v23, v21
    s_nop 0
    v_permlane16_swap_b32 v20, v22
    v_permlane16_swap_b32 v21, v23
    v_add_f32 v20, v20, v22
    v_add_f32 v21, v21, v23
    v_mov_b32 v22, v20
    v_mov_b32 v23, v21
    s_nop 0
    v_permlane32_swap_b32 v20, v22
    v_permlane32_swap_b32 v21, v23
    v_add_f32 v20, v20, v22
    v_add_f32 v21, v21, v23
    v_mul_f32 v22, 0x3acccccd, v20
    v_mul_f32 v21, 0x3acccccd, v21
    v_fma_f32 v21, -v22, v22, v21
    v_max_f32 v21, 0, v21
    v_add_f32 v21, 0x3727c5ac, v21
    v_rsq_f32 v20, v21
    s_nop 0
    v_mul_f32_e64 v21, -v22, v20
    v_lshlrev_b32 v24, 16, v72
    v_and_b32 v25, 0xffff0000, v72
    v_lshlrev_b32 v26, 16, v73
    v_and_b32 v27, 0xffff0000, v73
    v_fma_f32 v24, v24, v20, v21
    v_fma_f32 v25, v25, v20, v21
    v_fma_f32 v26, v26, v20, v21
    v_fma_f32 v27, v27, v20, v21
L_nostats:
    s_waitcnt vmcnt(21)
    ds_read_b64_tr_b16 v[96:97], v15 offset:0
    ds_read_b64_tr_b16 v[98:99], v15 offset:512
    ds_read_b64_tr_b16 v[100:101], v15 offset:32
    ds_read_b64_tr_b16 v[102:103], v15 offset:544
    ds_read_b64_tr_b16 v[104:105], v15 offset:64
    ds_read_b64_tr_b16 v[106:107], v15 offset:576
    ds_read_b64_tr_b16 v[108:109], v15 offset:96
    ds_read_b64_tr_b16 v[110:111], v15 offset:608
    s_waitcnt lgkmcnt(7)
    ds_read_b64_tr_b16 v[112:113], v15 offset:4096
    ds_read_b64_tr_b16 v[114:115], v15 offset:4608
    ds_read_b64_tr_b16 v[116:117], v15 offset:4128
    ds_read_b64_tr_b16 v[118:119], v15 offset:4640
    ds_read_b64_tr_b16 v[120:121], v15 offset:4160
    ds_read_b64_tr_b16 v[122:123], v15 offset:4672
    ds_read_b64_tr_b16 v[124:125], v15 offset:4192
    ds_read_b64_tr_b16 v[126:127], v15 offset:4704
    s_waitcnt lgkmcnt(7)
    ds_read_b64_tr_b16 v[128:129], v15 offset:8192
    ds_read_b64_tr_b16 v[130:131], v15 offset:8704
    ds_read_b64_tr_b16 v[132:133], v15 offset:8224
    ds_read_b64_tr_b16 v[134:135], v15 offset:8736
    ds_read_b64_tr_b16 v[136:137], v15 offset:8256
    ds_read_b64_tr_b16 v[138:139], v15 offset:8768
    ds_read_b64_tr_b16 v[140:141], v15 offset:8288
    ds_read_b64_tr_b16 v[142:143], v15 offset:8800
    s_waitcnt lgkmcnt(7)
    ds_read_b64_tr_b16 v[144:145], v15 offset:12288
    ds_read_b64_tr_b16 v[146:147], v15 offset:12800
    ds_read_b64_tr_b16 v[148:149], v15 offset:12320
    ds_read_b64_tr_b16 v[150:151], v15 offset:12832
    ds_read_b64_tr_b16 v[152:153], v15 offset:12352
    ds_read_b64_tr_b16 v[154:155], v15 offset:12864
    ds_read_b64_tr_b16 v[156:157], v15 offset:12384
    ds_read_b64_tr_b16 v[158:159], v15 offset:12896
    s_waitcnt lgkmcnt(7)
    ds_read_b64_tr_b16 v[160:161], v15 offset:16384
    ds_read_b64_tr_b16 v[162:163], v15 offset:16896
    ds_read_b64_tr_b16 v[164:165], v15 offset:16416
    ds_read_b64_tr_b16 v[166:167], v15 offset:16928
    ds_read_b64_tr_b16 v[168:169], v15 offset:16448
    ds_read_b64_tr_b16 v[170:171], v15 offset:16960
    ds_read_b64_tr_b16 v[172:173], v15 offset:16480
    ds_read_b64_tr_b16 v[174:175], v15 offset:16992
    s_waitcnt lgkmcnt(0)
    v_mfma_f32_16x16x32_bf16 v[80:83], v[96:99], v[32:35], 0
    v_mfma_f32_16x16x32_bf16 v[84:87], v[100:103], v[32:35], 0
    v_mfma_f32_16x16x32_bf16 v[88:91], v[104:107], v[32:35], 0
    v_mfma_f32_16x16x32_bf16 v[92:95], v[108:111], v[32:35], 0
    v_mfma_f32_16x16x32_bf16 v[80:83], v[112:115], v[36:39], v[80:83]
    v_mfma_f32_16x16x32_bf16 v[84:87], v[116:119], v[36:39], v[84:87]
    v_mfma_f32_16x16x32_bf16 v[88:91], v[120:123], v[36:39], v[88:91]
    v_mfma_f32_16x16x32_bf16 v[92:95], v[124:127], v[36:39], v[92:95]
    v_mfma_f32_16x16x32_bf16 v[80:83], v[128:131], v[40:43], v[80:83]
    v_mfma_f32_16x16x32_bf16 v[84:87], v[132:135], v[40:43], v[84:87]
    v_mfma_f32_16x16x32_bf16 v[88:91], v[136:139], v[40:43], v[88:91]
    v_mfma_f32_16x16x32_bf16 v[92:95], v[140:143], v[40:43], v[92:95]
    v_mfma_f32_16x16x32_bf16 v[80:83], v[144:147], v[44:47], v[80:83]
    v_mfma_f32_16x16x32_bf16 v[84:87], v[148:151], v[44:47], v[84:87]
    v_mfma_f32_16x16x32_bf16 v[88:91], v[152:155], v[44:47], v[88:91]
    v_mfma_f32_16x16x32_bf16 v[92:95], v[156:159], v[44:47], v[92:95]
    v_mfma_f32_16x16x32_bf16 v[80:83], v[160:163], v[48:51], v[80:83]
    v_mfma_f32_16x16x32_bf16 v[84:87], v[164:167], v[48:51], v[84:87]
    v_mfma_f32_16x16x32_bf16 v[88:91], v[168:171], v[48:51], v[88:91]
    v_mfma_f32_16x16x32_bf16 v[92:95], v[172:175], v[48:51], v[92:95]
    s_cmp_ge_u32 s50, 20
    s_cbranch_scc1 L_adr_rest
    s_cmp_lt_u32 s50, 10
    s_cselect_b32 s34, 5120, 0
    s_cselect_b32 s35, s50, s52
    s_lshl_b32 s35, s35, 9
    s_add_u32 s34, s34, s35
    s_lshl_b32 s35, s51, 18
    s_add_u32 s34, s34, s35
    v_lshrrev_b32 v19, 1, v14
    v_lshl_add_u32 v19, v13, 1, v19
    v_lshlrev_b32 v19, 6, v19
    v_lshl_add_u32 v19, v12, 4, v19
    v_and_b32 v20, 1, v14
    v_lshl_add_u32 v19, v20, 3, v19
    s_branch L_adr_done
L_adr_rest:
    s_lshl_b32 s34, s51, 18
    s_lshl_b32 s35, s50, 9
    s_add_u32 s34, s34, s35
    s_add_u32 s34, s34, 0
    v_lshlrev_b32 v19, 7, v12
    v_lshl_add_u32 v19, v13, 5, v19
    v_lshl_add_u32 v19, v14, 3, v19
    s_nop 3
L_adr_done:
    v_add_u32 v19, s34, v19
    v_mov_b32_dpp v80, v84 quad_perm:[0,1,2,3] row_mask:0xf bank_mask:0x2
    v_mov_b32_dpp v81, v85 quad_perm:[0,1,2,3] row_mask:0xf bank_mask:0x2
    v_mov_b32_dpp v82, v86 quad_perm:[0,1,2,3] row_mask:0xf bank_mask:0x2
    v_mov_b32_dpp v83, v87 quad_perm:[0,1,2,3] row_mask:0xf bank_mask:0x2
    v_mov_b32_dpp v80, v88 quad_perm:[0,1,2,3] row_mask:0xf bank_mask:0x4
    v_mov_b32_dpp v81, v89 quad_perm:[0,1,2,3] row_mask:0xf bank_mask:0x4
    v_mov_b32_dpp v82, v90 quad_perm:[0,1,2,3] row_mask:0xf bank_mask:0x4
    v_mov_b32_dpp v83, v91 quad_perm:[0,1,2,3] row_mask:0xf bank_mask:0x4
    v_mov_b32_dpp v80, v92 quad_perm:[0,1,2,3] row_mask:0xf bank_mask:0x8
    v_mov_b32_dpp v81, v93 quad_perm:[0,1,2,3] row_mask:0xf bank_mask:0x8
    v_mov_b32_dpp v82, v94 quad_perm:[0,1,2,3] row_mask:0xf bank_mask:0x8
    v_mov_b32_dpp v83, v95 quad_perm:[0,1,2,3] row_mask:0xf bank_mask:0x8
    s_cmp_ge_u32 s52, 10
    s_cbranch_scc1 L_noz
    v_add_f32 v80, 0x3e800000, v80
    v_add_f32 v81, 0x3e800000, v81
    v_add_f32 v82, 0x3e800000, v82
    v_add_f32 v83, 0x3e800000, v83
    v_mul_f32 v80, v80, v24
    v_mul_f32 v81, v81, v25
    v_mul_f32 v82, v82, v26
    v_mul_f32 v83, v83, v27
L_noz:
    v_cvt_pk_bf16_f32 v20, v80, v81
    v_cvt_pk_bf16_f32 v21, v82, v83
    v_min_u32 v20, -2, v20
    v_min_u32 v21, -2, v21
    v_and_b32 v22, 15, v0
    v_lshlrev_b32 v22, 2, v22
    s_mov_b32 s35, 0
L_poll4:
    global_load_dword v23, v22, s[30:31] offset:128 sc1
    s_add_u32 s35, s35, 1
    s_waitcnt vmcnt(0)
    v_cmp_eq_u32 vcc, 0, v23
    s_cbranch_vccz L_done5
    s_sleep 8
    s_cmp_lt_u32 s35, 60000
    s_cbranch_scc1 L_poll4
L_done5:
    s_getreg_b32 s97, hwreg(HW_REG_XCC_ID, 0, 4)
    s_sub_u32 s97, s97, s2
    s_and_b32 s97, s97, 7
    s_add_u32 s97, s97, 1
    v_cmp_ne_u32 vcc, s97, v23
    s_nop 0
    s_mov_b32 s97, vcc_lo
    buffer_store_dwordx2 v[20:21], v19, s[44:47], 0 offen sc1
    s_branch L_p2
L_clear:
    s_sub_u32 s55, s2, 240
    s_lshr_b32 s34, s55, 2
    s_lshl_b32 s35, s34, 3
    s_lshr_b32 s54, 538910755, s35
    s_and_b32 s54, s54, 0xff
    s_lshl_b32 s54, s54, 10
    s_mul_i32 s34, s34, 49152
    s_lshl_b32 s35, s51, 18
    s_add_u32 s34, s34, s35
    v_lshl_add_u32 v19, v0, 4, s34
    v_mov_b32 v20, -1
    v_mov_b32 v21, -1
    v_mov_b32 v22, -1
    v_mov_b32 v23, -1
    s_mov_b32 s34, 0
L_clrloop:
    buffer_store_dwordx4 v[20:23], v19, s[44:47], s34 offen offset:0 sc1
    s_add_u32 s34, s34, 1024
    s_cmp_lt_u32 s34, s54
    s_cbranch_scc1 L_clrloop
    v_lshlrev_b32 v1, 2, v0
    v_add_u32 v1, 98304, v1
    v_mov_b32 v2, -1
    v_mov_b32 v3, 0
    ds_write_b32 v1, v2
    ds_write_b32 v1, v2 offset:256
    ds_write_b32 v1, v3 offset:512
    ds_write_b32 v1, v3 offset:768
    s_waitcnt lgkmcnt(0)
    s_barrier
    s_lshl_b32 s34, s55, 2
    v_mov_b32 v24, s34
    s_getreg_b32 s97, hwreg(HW_REG_XCC_ID, 0, 4)
    s_sub_u32 s97, s97, s2
    s_and_b32 s97, s97, 7
    s_add_u32 s97, s97, 1
    v_mov_b32 v25, s97
    v_readfirstlane_b32 s90, v19
    s_mov_b32 s91, 0
    s_waitcnt vmcnt(0)
    s_mov_b64 exec, 1
    global_store_dword v24, v25, s[30:31] offset:128 sc1
    s_mov_b64 exec, -1
    s_getpc_b64 s[56:57]
L_pc7:
    s_sub_u32 s56, s56, L_pc7-adaLN_cond__sliding_block_cached__dense_activation_gelu__decode_kernel
    s_subb_u32 s57, s57, 0
    s_lshl_b32 s34, s61, 10
    v_lshl_add_u32 v9, v0, 4, s34
    v_min_u32 v9, L_codeend-adaLN_cond__sliding_block_cached__dense_activation_gelu__decode_kernel-16, v9
    global_load_dwordx4 v[76:79], v9, s[56:57]
    s_and_b32 s34, s2, 31
    s_lshl_b32 s34, s34, 8
    s_lshr_b32 s35, s2, 7
    s_lshl_b32 s35, s35, 7
    s_add_u32 s49, s34, s35
    s_bfe_u32 s53, s2, 0x20005
    s_mul_i32 s34, s53, 1310720
    s_add_u32 s34, s34, s49
    v_lshl_add_u32 v16, v10, 13, v11
    v_add_u32 v16, s34, v16
    s_mov_b32 s36, s10
    s_mov_b32 s37, s11
    s_mov_b32 s38, 5242880
    s_mov_b32 m0, 20480
    s_mov_b32 s34, 0
L_dma8:
    buffer_load_dwordx4 v16, s[36:39], s34 offen  lds
    s_add_u32 m0, m0, 1024
    s_add_u32 s34, s34, 65536
    buffer_load_dwordx4 v16, s[36:39], s34 offen  lds
    s_add_u32 m0, m0, 1024
    s_add_u32 s34, s34, 65536
    buffer_load_dwordx4 v16, s[36:39], s34 offen  lds
    s_add_u32 m0, m0, 1024
    s_add_u32 s34, s34, 65536
    buffer_load_dwordx4 v16, s[36:39], s34 offen  lds
    s_add_u32 m0, m0, 1024
    s_add_u32 s34, s34, 65536
    s_cmp_lt_u32 s34, 1310720
    s_cbranch_scc1 L_dma8
    v_lshl_add_u32 v15, v14, 3, v13
    v_lshlrev_b32 v15, 7, v15
    v_lshl_add_u32 v15, v12, 3, v15
    s_add_u32 s34, s90, 0
    s_add_u32 s35, s90, 8192
    s_mov_b64 s[88:89], 0
    s_load_dword s88, s[44:45], s34
    s_load_dword s89, s[44:45], s35
    s_waitcnt lgkmcnt(1)
    s_cmp_lg_u32 s89, 0
    s_addc_u32 s91, s91, 0
    s_waitcnt lgkmcnt(0)
    s_add_u32 s34, s90, 1024
    s_add_u32 s35, s90, 9216
    s_mov_b64 s[88:89], 0
    s_load_dword s89, s[44:45], s35
    s_load_dword s88, s[44:45], s34
    s_waitcnt lgkmcnt(1)
    s_cmp_eq_u32 s88, 0
    s_addc_u32 s91, s91, 0
    s_waitcnt lgkmcnt(0)
    s_add_u32 s34, s90, 2048
    s_add_u32 s35, s90, 10240
    s_mov_b64 s[88:89], 0
    s_load_dword s88, s[44:45], s34
    s_load_dword s89, s[44:45], s35
    s_waitcnt lgkmcnt(1)
    s_cmp_lg_u32 s89, 0
    s_addc_u32 s91, s91, 0
    s_waitcnt lgkmcnt(0)
    s_add_u32 s34, s90, 3072
    s_add_u32 s35, s90, 11264
    s_mov_b64 s[88:89], 0
    s_load_dword s89, s[44:45], s35
    s_load_dword s88, s[44:45], s34
    s_waitcnt lgkmcnt(1)
    s_cmp_eq_u32 s88, 0
    s_addc_u32 s91, s91, 0
    s_waitcnt lgkmcnt(0)
    s_getreg_b32 s34, hwreg(HW_REG_XCC_ID, 2, 1)
    s_sub_u32 s35, 2, s91
    s_sub_u32 s91, s91, 2
    s_cmp_eq_u32 s34, 0
    s_cselect_b32 s91, s91, s35
    v_mov_b32 v25, s91
    s_mov_b64 exec, 1
    global_store_dword v24, v25, s[30:31] sc1
    s_mov_b64 exec, -1
    v_and_b32 v22, 15, v0
    v_lshlrev_b32 v22, 2, v22
    s_mov_b32 s35, 0
L_poll9:
    global_load_dword v23, v22, s[30:31] offset:128 sc1
    s_add_u32 s35, s35, 1
    s_waitcnt vmcnt(0)
    v_cmp_eq_u32 vcc, 0, v23
    s_cbranch_vccz L_done10
    s_sleep 8
    s_cmp_lt_u32 s35, 60000
    s_cbranch_scc1 L_poll9
L_done10:
    s_getreg_b32 s97, hwreg(HW_REG_XCC_ID, 0, 4)
    s_sub_u32 s97, s97, s2
    s_and_b32 s97, s97, 7
    s_add_u32 s97, s97, 1
    v_cmp_ne_u32 vcc, s97, v23
    s_nop 0
    s_mov_b32 s97, vcc_lo
L_p2:
    v_mov_b32 v199, v19
    ds_read_b64_tr_b16 v[96:97], v15 offset:20480
    ds_read_b64_tr_b16 v[98:99], v15 offset:20992
    ds_read_b64_tr_b16 v[100:101], v15 offset:20512
    ds_read_b64_tr_b16 v[102:103], v15 offset:21024
    ds_read_b64_tr_b16 v[104:105], v15 offset:20544
    ds_read_b64_tr_b16 v[106:107], v15 offset:21056
    ds_read_b64_tr_b16 v[108:109], v15 offset:20576
    ds_read_b64_tr_b16 v[110:111], v15 offset:21088
    s_waitcnt lgkmcnt(7)
    ds_read_b64_tr_b16 v[112:113], v15 offset:24576
    ds_read_b64_tr_b16 v[114:115], v15 offset:25088
    ds_read_b64_tr_b16 v[116:117], v15 offset:24608
    ds_read_b64_tr_b16 v[118:119], v15 offset:25120
    ds_read_b64_tr_b16 v[120:121], v15 offset:24640
    ds_read_b64_tr_b16 v[122:123], v15 offset:25152
    ds_read_b64_tr_b16 v[124:125], v15 offset:24672
    ds_read_b64_tr_b16 v[126:127], v15 offset:25184
    s_waitcnt lgkmcnt(7)
    ds_read_b64_tr_b16 v[128:129], v15 offset:28672
    ds_read_b64_tr_b16 v[130:131], v15 offset:29184
    ds_read_b64_tr_b16 v[132:133], v15 offset:28704
    ds_read_b64_tr_b16 v[134:135], v15 offset:29216
    ds_read_b64_tr_b16 v[136:137], v15 offset:28736
    ds_read_b64_tr_b16 v[138:139], v15 offset:29248
    ds_read_b64_tr_b16 v[140:141], v15 offset:28768
    ds_read_b64_tr_b16 v[142:143], v15 offset:29280
    s_waitcnt lgkmcnt(7)
    ds_read_b64_tr_b16 v[144:145], v15 offset:32768
    ds_read_b64_tr_b16 v[146:147], v15 offset:33280
    ds_read_b64_tr_b16 v[148:149], v15 offset:32800
    ds_read_b64_tr_b16 v[150:151], v15 offset:33312
    ds_read_b64_tr_b16 v[152:153], v15 offset:32832
    ds_read_b64_tr_b16 v[154:155], v15 offset:33344
    ds_read_b64_tr_b16 v[156:157], v15 offset:32864
    ds_read_b64_tr_b16 v[158:159], v15 offset:33376
    s_waitcnt lgkmcnt(7)
    ds_read_b64_tr_b16 v[160:161], v15 offset:36864
    ds_read_b64_tr_b16 v[162:163], v15 offset:37376
    ds_read_b64_tr_b16 v[164:165], v15 offset:36896
    ds_read_b64_tr_b16 v[166:167], v15 offset:37408
    ds_read_b64_tr_b16 v[168:169], v15 offset:36928
    ds_read_b64_tr_b16 v[170:171], v15 offset:37440
    ds_read_b64_tr_b16 v[172:173], v15 offset:36960
    ds_read_b64_tr_b16 v[174:175], v15 offset:37472
    s_waitcnt lgkmcnt(0)
    s_mul_i32 s34, s53, 1280
    v_lshlrev_b32 v19, 18, v13
    v_lshl_add_u32 v19, v14, 6, v19
    v_lshl_add_u32 v19, v12, 4, v19
    v_add_u32 v19, s34, v19
    s_movk_i32 s48, 5120
    s_mov_b32 s56, 262144
    s_mov_b32 s57, 524288
    s_mov_b32 s58, 786432
    s_sub_u32 s34, s2, 80
    s_cmp_lt_u32 s34, 160
    s_cselect_b32 s54, 1, 0
    s_and_b32 s34, s2, 3
    s_cselect_b32 s54, 0, s54
    v_mov_b32 v180, 0
    v_mov_b32 v181, 0
    v_mov_b32 v182, 0
    v_mov_b32 v183, 0
    v_mov_b32 v184, 0
    v_mov_b32 v185, 0
    v_mov_b32 v186, 0
    v_mov_b32 v187, 0
    v_mov_b32 v22, 99072
    s_mov_b32 s35, 0
L_poll12:
    ds_read_b32 v23, v22
    s_add_u32 s35, s35, 1
    s_waitcnt lgkmcnt(0)
    v_cmp_gt_u32 vcc, 19, v23
    s_cbranch_vccz L_done13
    s_sleep 2
    s_cmp_lt_u32 s35, 60000
    s_cbranch_scc1 L_poll12
L_done13:
    s_mov_b32 s35, 0
L_poll15:
    buffer_load_dwordx4 v[32:35], v19, s[44:47], 0 offen offset:0 sc1
    buffer_load_dwordx4 v[36:39], v19, s[44:47], s48 offen offset:0 sc1
    buffer_load_dwordx4 v[40:43], v19, s[44:47], 0 offen offset:256 sc1
    buffer_load_dwordx4 v[44:47], v19, s[44:47], s48 offen offset:256 sc1
    buffer_load_dwordx4 v[48:51], v19, s[44:47], 0 offen offset:512 sc1
    buffer_load_dwordx4 v[52:55], v19, s[44:47], s48 offen offset:512 sc1
    buffer_load_dwordx4 v[56:59], v19, s[44:47], 0 offen offset:768 sc1
    buffer_load_dwordx4 v[60:63], v19, s[44:47], s48 offen offset:768 sc1
    buffer_load_dwordx4 v[64:67], v19, s[44:47], 0 offen offset:1024 sc1
    buffer_load_dwordx4 v[68:71], v19, s[44:47], s48 offen offset:1024 sc1
    s_cmp_eq_u32 s54, 0
    s_cbranch_scc1 L_hskip
    buffer_load_dwordx2 v[180:181], v199, s[44:47], 0 offen sc1
    buffer_load_dwordx2 v[182:183], v199, s[44:47], s56 offen sc1
    buffer_load_dwordx2 v[184:185], v199, s[44:47], s57 offen sc1
    buffer_load_dwordx2 v[186:187], v199, s[44:47], s58 offen sc1
L_hskip:
    s_add_u32 s35, s35, 1
    s_waitcnt vmcnt(0)
    v_max3_u32 v20, v32, v33, v34
    v_max3_u32 v20, v20, v35, v36
    v_max3_u32 v20, v20, v37, v38
    v_max3_u32 v20, v20, v39, v40
    v_max3_u32 v20, v20, v41, v42
    v_max3_u32 v20, v20, v43, v44
    v_max3_u32 v20, v20, v45, v46
    v_max3_u32 v20, v20, v47, v48
    v_max3_u32 v20, v20, v49, v50
    v_max3_u32 v20, v20, v51, v52
    v_max3_u32 v20, v20, v53, v54
    v_max3_u32 v20, v20, v55, v56
    v_max3_u32 v20, v20, v57, v58
    v_max3_u32 v20, v20, v59, v60
    v_max3_u32 v20, v20, v61, v62
    v_max3_u32 v20, v20, v63, v64
    v_max3_u32 v20, v20, v65, v66
    v_max3_u32 v20, v20, v67, v68
    v_max3_u32 v20, v20, v69, v70
    v_max3_u32 v20, v20, v71, v180
    v_max3_u32 v20, v20, v181, v182
    v_max3_u32 v20, v20, v183, v184
    v_max3_u32 v20, v20, v185, v186
    v_max_u32 v20, v20, v187
    v_cmp_eq_u32 vcc, -1, v20
    s_cbranch_vccz L_done16
    s_sleep 16
    s_cmp_lt_u32 s35, 60000
    s_cbranch_scc1 L_poll15
L_done16:
    v_mfma_f32_16x16x32_bf16 v[80:83], v[96:99], v[32:35], 0
    v_mfma_f32_16x16x32_bf16 v[84:87], v[100:103], v[32:35], 0
    v_mfma_f32_16x16x32_bf16 v[88:91], v[104:107], v[32:35], 0
    v_mfma_f32_16x16x32_bf16 v[92:95], v[108:111], v[32:35], 0
    v_mfma_f32_16x16x32_bf16 v[80:83], v[96:99], v[36:39], v[80:83]
    v_mfma_f32_16x16x32_bf16 v[84:87], v[100:103], v[36:39], v[84:87]
    v_mfma_f32_16x16x32_bf16 v[88:91], v[104:107], v[36:39], v[88:91]
    v_mfma_f32_16x16x32_bf16 v[92:95], v[108:111], v[36:39], v[92:95]
    v_mfma_f32_16x16x32_bf16 v[80:83], v[112:115], v[40:43], v[80:83]
    v_mfma_f32_16x16x32_bf16 v[84:87], v[116:119], v[40:43], v[84:87]
    v_mfma_f32_16x16x32_bf16 v[88:91], v[120:123], v[40:43], v[88:91]
    v_mfma_f32_16x16x32_bf16 v[92:95], v[124:127], v[40:43], v[92:95]
    v_mfma_f32_16x16x32_bf16 v[80:83], v[112:115], v[44:47], v[80:83]
    v_mfma_f32_16x16x32_bf16 v[84:87], v[116:119], v[44:47], v[84:87]
    v_mfma_f32_16x16x32_bf16 v[88:91], v[120:123], v[44:47], v[88:91]
    v_mfma_f32_16x16x32_bf16 v[92:95], v[124:127], v[44:47], v[92:95]
    v_mfma_f32_16x16x32_bf16 v[80:83], v[128:131], v[48:51], v[80:83]
    v_mfma_f32_16x16x32_bf16 v[84:87], v[132:135], v[48:51], v[84:87]
    v_mfma_f32_16x16x32_bf16 v[88:91], v[136:139], v[48:51], v[88:91]
    v_mfma_f32_16x16x32_bf16 v[92:95], v[140:143], v[48:51], v[92:95]
    v_mfma_f32_16x16x32_bf16 v[80:83], v[128:131], v[52:55], v[80:83]
    v_mfma_f32_16x16x32_bf16 v[84:87], v[132:135], v[52:55], v[84:87]
    v_mfma_f32_16x16x32_bf16 v[88:91], v[136:139], v[52:55], v[88:91]
    v_mfma_f32_16x16x32_bf16 v[92:95], v[140:143], v[52:55], v[92:95]
    v_mfma_f32_16x16x32_bf16 v[80:83], v[144:147], v[56:59], v[80:83]
    v_mfma_f32_16x16x32_bf16 v[84:87], v[148:151], v[56:59], v[84:87]
    v_mfma_f32_16x16x32_bf16 v[88:91], v[152:155], v[56:59], v[88:91]
    v_mfma_f32_16x16x32_bf16 v[92:95], v[156:159], v[56:59], v[92:95]
    v_mfma_f32_16x16x32_bf16 v[80:83], v[144:147], v[60:63], v[80:83]
    v_mfma_f32_16x16x32_bf16 v[84:87], v[148:151], v[60:63], v[84:87]
    v_mfma_f32_16x16x32_bf16 v[88:91], v[152:155], v[60:63], v[88:91]
    v_mfma_f32_16x16x32_bf16 v[92:95], v[156:159], v[60:63], v[92:95]
    v_mfma_f32_16x16x32_bf16 v[80:83], v[160:163], v[64:67], v[80:83]
    v_mfma_f32_16x16x32_bf16 v[84:87], v[164:167], v[64:67], v[84:87]
    v_mfma_f32_16x16x32_bf16 v[88:91], v[168:171], v[64:67], v[88:91]
    v_mfma_f32_16x16x32_bf16 v[92:95], v[172:175], v[64:67], v[92:95]
    v_mfma_f32_16x16x32_bf16 v[80:83], v[160:163], v[68:71], v[80:83]
    v_mfma_f32_16x16x32_bf16 v[84:87], v[164:167], v[68:71], v[84:87]
    v_mfma_f32_16x16x32_bf16 v[88:91], v[168:171], v[68:71], v[88:91]
    v_mfma_f32_16x16x32_bf16 v[92:95], v[172:175], v[68:71], v[92:95]
    s_lshl_b32 s34, s53, 18
    s_lshl_b32 s35, s49, 2
    s_add_u32 s34, s34, s35
    s_add_u32 s34, s34, 49152
    v_lshlrev_b32 v19, 7, v12
    v_lshl_add_u32 v19, v13, 5, v19
    v_lshl_add_u32 v19, v14, 3, v19
    v_add_u32 v19, s34, v19
    v_add_f32_dpp v20, v80, v80 row_ror:8 row_mask:0xf bank_mask:0x3
    v_add_f32_dpp v24, v84, v84 row_ror:8 row_mask:0xf bank_mask:0x3
    v_add_f32_dpp v21, v81, v81 row_ror:8 row_mask:0xf bank_mask:0x3
    v_add_f32_dpp v25, v85, v85 row_ror:8 row_mask:0xf bank_mask:0x3
    v_add_f32_dpp v22, v82, v82 row_ror:8 row_mask:0xf bank_mask:0x3
    v_add_f32_dpp v26, v86, v86 row_ror:8 row_mask:0xf bank_mask:0x3
    v_add_f32_dpp v23, v83, v83 row_ror:8 row_mask:0xf bank_mask:0x3
    v_add_f32_dpp v27, v87, v87 row_ror:8 row_mask:0xf bank_mask:0x3
    v_add_f32_dpp v20, v88, v88 row_ror:8 row_mask:0xf bank_mask:0xc
    v_add_f32_dpp v24, v92, v92 row_ror:8 row_mask:0xf bank_mask:0xc
    v_add_f32_dpp v21, v89, v89 row_ror:8 row_mask:0xf bank_mask:0xc
    v_add_f32_dpp v25, v93, v93 row_ror:8 row_mask:0xf bank_mask:0xc
    v_add_f32_dpp v22, v90, v90 row_ror:8 row_mask:0xf bank_mask:0xc
    v_add_f32_dpp v26, v94, v94 row_ror:8 row_mask:0xf bank_mask:0xc
    v_add_f32_dpp v23, v91, v91 row_ror:8 row_mask:0xf bank_mask:0xc
    v_add_f32_dpp v27, v95, v95 row_ror:8 row_mask:0xf bank_mask:0xc
    v_add_f32_dpp v28, v20, v20 row_shl:4 row_mask:0xf bank_mask:0x5
    v_add_f32_dpp v29, v21, v21 row_shl:4 row_mask:0xf bank_mask:0x5
    v_add_f32_dpp v30, v22, v22 row_shl:4 row_mask:0xf bank_mask:0x5
    v_add_f32_dpp v31, v23, v23 row_shl:4 row_mask:0xf bank_mask:0x5
    v_add_f32_dpp v28, v24, v24 row_shr:4 row_mask:0xf bank_mask:0xa
    v_add_f32_dpp v29, v25, v25 row_shr:4 row_mask:0xf bank_mask:0xa
    v_add_f32_dpp v30, v26, v26 row_shr:4 row_mask:0xf bank_mask:0xa
    v_add_f32_dpp v31, v27, v27 row_shr:4 row_mask:0xf bank_mask:0xa
    v_cvt_pk_bf16_f32 v20, v28, v29
    v_cvt_pk_bf16_f32 v21, v30, v31
    v_min_u32 v20, -2, v20
    v_min_u32 v21, -2, v21
    buffer_store_dwordx2 v[20:21], v19, s[44:47], 0 offen sc1
    s_cmp_eq_u32 s54, 0
    s_cbranch_scc1 L_nomf
    v_lshlrev_b32 v24, 16, v180
    v_and_b32 v25, 0xffff0000, v180
    v_lshlrev_b32 v26, 16, v181
    v_and_b32 v27, 0xffff0000, v181
    v_lshlrev_b32 v28, 16, v182
    v_and_b32 v29, 0xffff0000, v182
    v_lshlrev_b32 v30, 16, v183
    v_and_b32 v31, 0xffff0000, v183
    v_add_f32 v24, v24, v28
    v_add_f32 v25, v25, v29
    v_add_f32 v26, v26, v30
    v_add_f32 v27, v27, v31
    v_lshlrev_b32 v28, 16, v184
    v_and_b32 v29, 0xffff0000, v184
    v_lshlrev_b32 v30, 16, v185
    v_and_b32 v31, 0xffff0000, v185
    v_add_f32 v24, v24, v28
    v_add_f32 v25, v25, v29
    v_add_f32 v26, v26, v30
    v_add_f32 v27, v27, v31
    v_lshlrev_b32 v28, 16, v186
    v_and_b32 v29, 0xffff0000, v186
    v_lshlrev_b32 v30, 16, v187
    v_and_b32 v31, 0xffff0000, v187
    v_add_f32 v24, v24, v28
    v_add_f32 v25, v25, v29
    v_add_f32 v26, v26, v30
    v_add_f32 v27, v27, v31
    v_cvt_pk_bf16_f32 v22, v24, v25
    v_cvt_pk_bf16_f32 v23, v26, v27
    v_min_u32 v22, -2, v22
    v_min_u32 v23, -2, v23
    s_sub_u32 s34, s50, 20
    s_lshl_b32 s35, s34, 9
    v_subrev_u32 v199, s35, v199
    s_lshr_b32 s35, s34, 2
    s_lshl_b32 s35, s35, 9
    s_and_b32 s34, s34, 3
    s_lshl_b32 s34, s34, 18
    s_add_u32 s34, s34, s35
    s_add_u32 s34, s34, 20480
    v_add_u32 v199, s34, v199
    buffer_store_dwordx2 v[22:23], v199, s[44:47], 0 offen sc1
L_nomf:
    s_and_b32 s34, s2, 127
    s_lshl_b32 s34, s34, 21
    s_lshr_b32 s35, s2, 7
    s_lshl_b32 s35, s35, 18
    s_add_u32 s34, s34, s35
    s_add_u32 s34, s34, 1572864
    s_mov_b32 s38, 0x40000
    s_mov_b32 s42, 0x40000
    s_waitcnt lgkmcnt(0)
    s_add_u32 s36, s6, s34
    s_addc_u32 s37, s7, 0
    s_add_u32 s40, s8, s34
    s_addc_u32 s41, s9, 0
    v_lshlrev_b32 v18, 4, v0
    s_mov_b32 s34, 258048
    buffer_load_dwordx4 v[128:131], v18, s[36:39], s34 offen offset:0 nt
    buffer_load_dwordx4 v[132:135], v18, s[36:39], s34 offen offset:1024 nt
    buffer_load_dwordx4 v[136:139], v18, s[36:39], s34 offen offset:2048 nt
    buffer_load_dwordx4 v[140:143], v18, s[36:39], s34 offen offset:3072 nt
    s_and_b32 s34, s2, 31
    s_lshl_b32 s34, s34, 10
    s_lshl_b32 s35, s53, 7
    s_add_u32 s34, s34, s35
    s_add_u32 s34, s34, 49152
    v_lshrrev_b32 v19, 5, v0
    v_mul_u32_u24 v19, 384, v19
    v_lshl_add_u32 v19, v0, 2, v19
    v_add_u32 v19, s34, v19
    v_mov_b32 v22, 99072
    s_mov_b32 s35, 0
L_poll18:
    ds_read_b32 v23, v22
    s_add_u32 s35, s35, 1
    s_waitcnt lgkmcnt(0)
    v_cmp_gt_u32 vcc, 31, v23
    s_cbranch_vccz L_done19
    s_sleep 2
    s_cmp_lt_u32 s35, 60000
    s_cbranch_scc1 L_poll18
L_done19:
    v_and_b32 v44, 15, v0
    v_lshlrev_b32 v44, 2, v44
    global_load_dword v44, v44, s[30:31] sc1
    s_mov_b32 s35, 0
L_poll21:
    buffer_load_dword v32, v19, s[44:47], 0 offen sc1
    buffer_load_dword v33, v19, s[44:47], s56 offen sc1
    buffer_load_dword v34, v19, s[44:47], s57 offen sc1
    buffer_load_dword v35, v19, s[44:47], s58 offen sc1
    s_add_u32 s35, s35, 1
    s_waitcnt vmcnt(0)
    v_max3_u32 v22, v32, v33, v34
    v_max_u32 v22, v22, v35
    v_cmp_eq_u32 vcc, -1, v22
    s_cbranch_vccz L_done22
    s_sleep 16
    s_cmp_lt_u32 s35, 60000
    s_cbranch_scc1 L_poll21
L_done22:
    v_add_u32_dpp v44, v44, v44 row_ror:8 row_mask:0xf bank_mask:0xf
    s_nop 1
    v_add_u32_dpp v44, v44, v44 row_ror:4 row_mask:0xf bank_mask:0xf
    s_nop 1
    v_add_u32_dpp v44, v44, v44 row_ror:2 row_mask:0xf bank_mask:0xf
    s_nop 1
    v_add_u32_dpp v44, v44, v44 row_ror:1 row_mask:0xf bank_mask:0xf
    s_nop 0
    v_readfirstlane_b32 s99, v44
    s_nop 0
    s_cmp_gt_i32 s99, 0
    s_cselect_b32 s99, 1, 0
    s_getreg_b32 s34, hwreg(HW_REG_XCC_ID, 2, 1)
    s_xor_b32 s99, s99, s34
    s_lshl_b32 s99, s99, 13
    v_mov_b32 v45, 99080
    v_mov_b32 v44, s99
    ds_write_b32 v45, v44
    v_lshlrev_b32 v36, 16, v32
    v_and_b32 v37, 0xffff0000, v32
    v_lshlrev_b32 v38, 16, v33
    v_and_b32 v39, 0xffff0000, v33
    v_lshlrev_b32 v40, 16, v34
    v_and_b32 v41, 0xffff0000, v34
    v_lshlrev_b32 v42, 16, v35
    v_and_b32 v43, 0xffff0000, v35
    v_pk_add_f32 v[36:37], v[36:37], v[38:39]
    v_pk_add_f32 v[40:41], v[40:41], v[42:43]
    v_pk_add_f32 v[36:37], v[36:37], v[40:41]
    v_cvt_pk_bf16_f32 v32, v36, v37
    v_min_u32 v32, -2, v32
    ds_write_b32 v1, v32
    s_mov_b32 s34, 258048
    buffer_load_dwordx4 v[144:147], v18, s[40:43], s34 offen offset:0 nt
    buffer_load_dwordx4 v[148:151], v18, s[40:43], s34 offen offset:1024 nt
    buffer_load_dwordx4 v[152:155], v18, s[40:43], s34 offen offset:2048 nt
    buffer_load_dwordx4 v[156:159], v18, s[40:43], s34 offen offset:3072 nt
    v_and_b32 v2, 15, v0
    v_lshlrev_b32 v2, 4, v2
    v_add_u32 v2, 98304, v2
    ds_read_b128 v[4:7], v2
    s_waitcnt lgkmcnt(0)
    v_dot2_f32_bf16 v8, v128, v4, 0
    v_dot2_f32_bf16 v9, v132, v4, 0
    v_dot2_f32_bf16 v10, v136, v4, 0
    v_dot2_f32_bf16 v11, v140, v4, 0
    v_dot2c_f32_bf16 v8, v129, v5
    v_dot2c_f32_bf16 v9, v133, v5
    v_dot2c_f32_bf16 v10, v137, v5
    v_dot2c_f32_bf16 v11, v141, v5
    v_dot2c_f32_bf16 v8, v130, v6
    v_dot2c_f32_bf16 v9, v134, v6
    v_dot2c_f32_bf16 v10, v138, v6
    v_dot2c_f32_bf16 v11, v142, v6
    v_dot2c_f32_bf16 v8, v131, v7
    v_dot2c_f32_bf16 v9, v135, v7
    v_dot2c_f32_bf16 v10, v139, v7
    v_dot2c_f32_bf16 v11, v143, v7
    v_add_f32_dpp v16, v8, v8 row_ror:8 row_mask:0xf bank_mask:0x3
    v_add_f32_dpp v16, v9, v9 row_ror:8 row_mask:0xf bank_mask:0xc
    v_add_f32_dpp v17, v10, v10 row_ror:8 row_mask:0xf bank_mask:0x3
    v_add_f32_dpp v17, v11, v11 row_ror:8 row_mask:0xf bank_mask:0xc
    v_add_f32_dpp v16, v16, v16 row_half_mirror row_mask:0xf bank_mask:0xf
    s_nop 0
    v_add_f32_dpp v17, v17, v17 row_half_mirror row_mask:0xf bank_mask:0xf
    v_add_f32_dpp v16, v16, v16 quad_perm:[1,0,3,2] row_mask:0xf bank_mask:0xf
    s_nop 0
    v_add_f32_dpp v17, v17, v17 quad_perm:[1,0,3,2] row_mask:0xf bank_mask:0xf
    v_add_f32_dpp v16, v16, v16 quad_perm:[2,3,0,1] row_mask:0xf bank_mask:0xf
    s_nop 0
    v_add_f32_dpp v17, v17, v17 quad_perm:[2,3,0,1] row_mask:0xf bank_mask:0xf
    v_max_f32 v8, v16, v17
    s_mov_b32 s34, 0x3e0293ee
    s_nop 0
    v_max_f32_dpp v8, v8, v8 row_ror:8 row_mask:0xf bank_mask:0xf
    v_mov_b32 v9, v8
    s_nop 1
    v_permlane16_swap_b32 v8, v9
    v_max_f32 v8, v8, v9
    v_mov_b32 v9, v8
    s_nop 1
    v_permlane32_swap_b32 v8, v9
    v_max_f32 v8, v8, v9
    v_mul_f32 v8, s34, v8
    v_fma_f32 v16, v16, s34, -v8
    v_fma_f32 v17, v17, s34, -v8
    v_exp_f32 v16, v16
    v_exp_f32 v17, v17
    s_nop 0
    v_add_f32 v9, v16, v17
    v_and_b32 v10, 1, v0
    v_lshlrev_b32 v10, 4, v10
    v_mov_b32 v11, 0xffff
    v_lshlrev_b32 v10, v10, v11
    v_bfe_u32 v11, v0, 1, 2
    v_cmp_eq_u32 vcc, 0, v11
    s_nop 1
    v_cndmask_b32 v20, 0, v10, vcc
    v_cmp_eq_u32 vcc, 1, v11
    s_nop 1
    v_cndmask_b32 v21, 0, v10, vcc
    v_cmp_eq_u32 vcc, 2, v11
    s_nop 1
    v_cndmask_b32 v22, 0, v10, vcc
    v_cmp_eq_u32 vcc, 3, v11
    s_nop 1
    v_cndmask_b32 v23, 0, v10, vcc
    v_add_f32_dpp v9, v9, v9 row_ror:8 row_mask:0xf bank_mask:0xf
    v_mov_b32 v10, v9
    s_nop 1
    v_permlane16_swap_b32 v9, v10
    v_add_f32 v9, v9, v10
    v_mov_b32 v10, v9
    s_nop 1
    v_permlane32_swap_b32 v9, v10
    v_add_f32 v9, v9, v10
    v_mov_b32 v10, 98616
    s_mov_b64 exec, 1
    ds_write_b64 v10, v[8:9]
    s_mov_b64 exec, -1
    s_waitcnt vmcnt(0)
    v_cvt_pk_bf16_f32 v10, v16, v16
    v_and_b32 v24, v10, v20
    v_and_b32 v25, v10, v21
    v_and_b32 v26, v10, v22
    v_and_b32 v27, v10, v23
    s_nop 1
    v_mfma_f32_16x16x32_bf16 v[116:119], v[144:147], v[24:27], 0
    v_mfma_f32_16x16x32_bf16 v[120:123], v[148:151], v[24:27], 0
    v_cvt_pk_bf16_f32 v10, v17, v17
    v_and_b32 v28, v10, v20
    v_and_b32 v29, v10, v21
    v_and_b32 v30, v10, v22
    v_and_b32 v31, v10, v23
    s_nop 1
    v_mfma_f32_16x16x32_bf16 v[116:119], v[152:155], v[28:31], v[116:119]
    v_mfma_f32_16x16x32_bf16 v[120:123], v[156:159], v[28:31], v[120:123]
    s_mov_b32 s34, 106496
    v_lshrrev_b32 v16, 4, v0
    v_and_b32 v17, 7, v0
    v_lshl_add_u32 v16, v16, 3, v17
    v_bfe_u32 v17, v0, 3, 1
    v_lshl_add_u32 v16, v17, 5, v16
    v_lshl_add_u32 v16, v16, 4, s34
    s_nop 0
    v_add_f32_dpp v116, v120, v116 row_ror:8 row_mask:0xf bank_mask:0xf
    v_add_f32_dpp v117, v121, v117 row_ror:8 row_mask:0xf bank_mask:0xf
    v_add_f32_dpp v118, v122, v118 row_ror:8 row_mask:0xf bank_mask:0xf
    v_add_f32_dpp v119, v123, v119 row_ror:8 row_mask:0xf bank_mask:0xf
    ds_write_b128 v16, v[116:119]
    v_lshl_add_u32 v16, v0, 3, s34
    ds_read_b64 v[116:117], v16
    s_waitcnt lgkmcnt(0)
    s_mov_b32 s63, 0
    s_mov_b32 s62, s61
    s_cmp_lt_u32 s61, 20
    s_cbranch_scc1 L_rd24
    s_mul_i32 s62, s60, 12
    s_add_u32 s62, s62, s61
    s_sub_u32 s62, s62, 20
    s_mov_b32 s63, 1
    s_cmp_lt_u32 s62, 54
    s_cbranch_scc1 L_rd24
    s_cmp_lt_u32 s62, 56
    s_cselect_b32 s63, 3, 2
    s_sub_u32 s62, s62, 56
L_rd24:
    v_and_b32 v8, 3, v0
    v_bfe_u32 v9, v0, 2, 2
    v_lshrrev_b32 v10, 4, v0
    s_mov_b32 s55, 0x20000
    s_lshl_b32 s35, s62, 6
    s_and_b32 s49, s62, 1
    s_cmp_eq_u32 s63, 0
    s_cbranch_scc1 L_dp26
    s_cmp_eq_u32 s63, 1
    s_cbranch_scc1 L_dp27
    s_mov_b32 s52, s20
    s_mov_b32 s53, s21
    s_mov_b32 s54, 2211840
    v_mov_b32 v15, 0
    s_branch L_dp28
L_dp27:
    s_mov_b32 s52, s16
    s_mov_b32 s53, s17
    s_mov_b32 s54, 2211840
    v_lshl_add_u32 v15, v9, 3, v10
    v_mul_u32_u24 v15, 3456, v15
    v_lshl_add_u32 v15, v8, 4, v15
    v_add_u32 v15, s35, v15
    s_bfe_u32 s50, s3, 0x10001
    s_lshl_b32 s50, s50, 7
    s_and_b32 s34, s3, 1
    s_lshl_b32 s34, s34, 2
    s_add_u32 s50, s50, s34
    s_and_b32 s51, s3, 3
    s_lshl_b32 s51, s51, 5
    s_add_u32 s51, s51, 512
    s_mul_i32 s50, s50, 3456
    s_mul_i32 s51, s51, 3456
    s_branch L_dp28
L_dp26:
    s_mov_b32 s52, s12
    s_mov_b32 s53, s13
    s_mov_b32 s54, 5242880
    s_lshr_b32 s50, s3, 1
    s_lshl_b32 s50, s50, 3
    s_add_u32 s50, s50, s60
    s_and_b32 s51, s3, 1
    s_lshl_b32 s34, s50, 1
    s_add_u32 s34, s34, s51
    s_mul_i32 s34, s34, 81920
    s_add_u32 s34, s34, s35
    v_lshl_add_u32 v15, v9, 2, v10
    v_mul_u32_u24 v15, 2560, v15
    v_lshl_add_u32 v15, v8, 4, v15
    v_add_u32 v15, s34, v15
    s_lshl_b32 s56, s3, 12
    s_lshl_b32 s34, s49, 11
    s_add_u32 s56, s56, s34
    s_add_u32 s56, s56, 40960
    s_add_u32 s58, s56, 1024
    s_mul_i32 s57, s49, 40960
    s_add_u32 s59, s57, 1280
L_dp28:
    v_and_b32 v200, 3, v0
    v_bfe_u32 v201, v0, 2, 2
    v_lshrrev_b32 v202, 4, v0
    s_lshl_b32 s34, s3, 10
    s_add_u32 s34, s34, 122112
    v_mul_u32_u24 v203, 320, v201
    v_min_u32 v203, 704, v203
    v_lshl_add_u32 v203, v202, 6, v203
    v_lshl_add_u32 v203, v200, 4, v203
    v_add_u32 v203, s34, v203
    s_movk_i32 s48, 16384
    v_mov_b32 v197, 0
    s_mov_b32 s40, 0
    s_mov_b32 s41, 0
    s_mov_b32 s42, 0
    s_cmp_eq_u32 s63, 0
    s_cbranch_scc1 L_d_wo
    s_cmp_eq_u32 s63, 2
    s_cbranch_scc1 L_d_w2
    s_cmp_eq_u32 s63, 3
    s_cbranch_scc1 L_d_none
    v_and_b32 v205, 15, v0
    v_lshlrev_b32 v205, 4, v205
    s_and_b32 s49, s3, 3
    s_mul_i32 s34, s49, 1280
    s_add_u32 s34, s34, s99
    s_add_u32 s34, s34, 98304
    v_lshl_add_u32 v206, v202, 18, v205
    v_add_u32 v206, s34, v206
    s_mul_i32 s34, s49, 3840
    v_add_u32 v205, s34, v205
    s_lshl_b32 s34, s62, 6
    v_lshlrev_b32 v5, 4, v14
    v_lshl_add_u32 v5, v12, 2, v5
    v_add_u32 v5, s34, v5
    global_load_dword v6, v5, s[18:19]
    v_and_b32 v7, 15, v0
    v_lshlrev_b32 v7, 4, v7
    v_mul_u32_u24 v8, 1280, v14
    v_add_u32 v8, v8, v7
    v_bfe_u32 v9, v0, 3, 1
    v_lshlrev_b32 v9, 18, v9
    v_lshl_add_u32 v9, v14, 7, v9
    v_and_b32 v10, 7, v0
    v_lshl_add_u32 v9, v10, 4, v9
    v_add_u32 v9, 30720, v9
    s_mov_b32 s57, 524288
    v_mul_u32_u24 v5, 3840, v14
    v_add_u32 v5, v5, v7
    global_load_dwordx4 v[32:35], v8, s[4:5] offset:0
    global_load_dwordx4 v[36:39], v8, s[4:5] offset:256
    global_load_dwordx4 v[40:43], v8, s[4:5] offset:512
    global_load_dwordx4 v[44:47], v8, s[4:5] offset:768
    global_load_dwordx4 v[48:51], v8, s[4:5] offset:1024
    s_mov_b32 s35, 0
L_poll29:
    buffer_load_dwordx4 v[52:55], v9, s[44:47], s57 offen offset:1024 sc1
    buffer_load_dwordx4 v[56:59], v9, s[44:47], 0 offen offset:1536 sc1
    buffer_load_dwordx4 v[60:63], v9, s[44:47], s57 offen offset:1536 sc1
    buffer_load_dwordx4 v[64:67], v9, s[44:47], 0 offen offset:2048 sc1
    buffer_load_dwordx4 v[68:71], v9, s[44:47], s57 offen offset:2048 sc1
    buffer_load_dwordx4 v[72:75], v9, s[44:47], 0 offen offset:2560 sc1
    buffer_load_dwordx4 v[76:79], v9, s[44:47], s57 offen offset:2560 sc1
    buffer_load_dwordx4 v[80:83], v9, s[44:47], 0 offen offset:3072 sc1
    buffer_load_dwordx4 v[84:87], v9, s[44:47], s57 offen offset:3072 sc1
    buffer_load_dwordx4 v[88:91], v9, s[44:47], 0 offen offset:3584 sc1
    s_add_u32 s35, s35, 1
    s_waitcnt vmcnt(0)
    v_max3_u32 v28, v52, v53, v54
    v_max3_u32 v28, v28, v55, v56
    v_max3_u32 v28, v28, v57, v58
    v_max3_u32 v28, v28, v59, v60
    v_max3_u32 v28, v28, v61, v62
    v_max3_u32 v28, v28, v63, v64
    v_max3_u32 v28, v28, v65, v66
    v_max3_u32 v28, v28, v67, v68
    v_max3_u32 v28, v28, v69, v70
    v_max3_u32 v28, v28, v71, v72
    v_max3_u32 v28, v28, v73, v74
    v_max3_u32 v28, v28, v75, v76
    v_max3_u32 v28, v28, v77, v78
    v_max3_u32 v28, v28, v79, v80
    v_max3_u32 v28, v28, v81, v82
    v_max3_u32 v28, v28, v83, v84
    v_max3_u32 v28, v28, v85, v86
    v_max3_u32 v28, v28, v87, v88
    v_max3_u32 v28, v28, v89, v90
    v_max_u32 v28, v28, v91
    v_cmp_eq_u32 vcc, -1, v28
    s_cbranch_vccz L_done30
    s_sleep 16
    s_cmp_lt_u32 s35, 60000
    s_cbranch_scc1 L_poll29
L_done30:
    ds_write_b128 v5, v[32:35] offset:0
    ds_write_b128 v5, v[36:39] offset:256
    ds_write_b128 v5, v[40:43] offset:512
    ds_write_b128 v5, v[44:47] offset:768
    ds_write_b128 v5, v[48:51] offset:1024
    ds_write_b128 v5, v[52:55] offset:1280
    ds_write_b128 v5, v[56:59] offset:1536
    ds_write_b128 v5, v[60:63] offset:1792
    ds_write_b128 v5, v[64:67] offset:2048
    ds_write_b128 v5, v[68:71] offset:2304
    ds_write_b128 v5, v[72:75] offset:2560
    ds_write_b128 v5, v[76:79] offset:2816
    ds_write_b128 v5, v[80:83] offset:3072
    ds_write_b128 v5, v[84:87] offset:3328
    ds_write_b128 v5, v[88:91] offset:3584
    s_waitcnt lgkmcnt(0)
    v_lshlrev_b32 v100, 16, v6
    v_and_b32 v101, 0xffff0000, v6
    s_cmp_eq_u32 s60, 4
    s_cselect_b32 s40, 6, 12
    s_mov_b32 s41, 5462
    s_cmov_b32 s41, 10923
    s_cselect_b32 s34, 20, 20
    s_mov_b32 s49, 17280
    s_cmov_b32 s49, 34560
    v_min_u32 v196, 59, v0
    v_mul_u32_u24 v197, s41, v196
    v_lshrrev_b32 v197, 16, v197
    v_mul_u32_u24 v194, s40, v197
    v_sub_u32 v196, v196, v194
    v_mul_u32_u24 v197, 3456, v197
    v_lshl_add_u32 v197, v196, 6, v197
    s_mul_i32 s35, s60, 768
    s_add_i32 s35, s35, 0
    s_cmp_eq_u32 s60, 4
    s_cselect_b32 s35, 3072, s35
    s_sub_u32 s34, s61, s34
    s_mul_i32 s34, s34, s49
    s_mul_i32 s34, s34, 11
    s_add_u32 s34, s34, s35
    v_add_u32 v197, s34, v197
    s_mov_b32 s40, s49
    s_mov_b32 s41, s49
    s_branch L_d_none
L_d_w2:
    s_lshl_b32 s34, s62, 5
    v_lshl_add_u32 v3, v14, 3, s34
    global_load_dwordx2 v[20:21], v3, s[22:23]
    v_mul_u32_u24 v112, 1280, v12
    v_add_u32 v112, v112, v3
    global_load_dwordx2 v[22:23], v112, s[4:5]
    s_lshr_b32 s34, s62, 2
    s_add_u32 s34, s34, 30
    s_lshr_b32 s35, s34, 2
    s_lshl_b32 s35, s35, 9
    s_and_b32 s34, s34, 3
    s_lshl_b32 s34, s34, 18
    s_add_u32 s34, s34, s35
    s_and_b32 s35, s62, 3
    s_mul_i32 s35, s35, 32
    s_add_u32 s34, s34, s35
    s_add_u32 s34, s34, 30720
    v_lshlrev_b32 v5, 7, v12
    v_lshl_add_u32 v5, v14, 3, v5
    v_add_u32 v5, s34, v5
    s_waitcnt vmcnt(0)
    v_lshlrev_b32 v32, 16, v20
    v_and_b32 v33, 0xffff0000, v20
    v_lshlrev_b32 v34, 16, v21
    v_and_b32 v35, 0xffff0000, v21
    v_lshlrev_b32 v108, 16, v22
    v_and_b32 v109, 0xffff0000, v22
    v_lshlrev_b32 v110, 16, v23
    v_and_b32 v111, 0xffff0000, v23
    s_mov_b32 s35, 0
L_poll32:
    buffer_load_dwordx2 v[24:25], v5, s[44:47], 0 offen sc1
    s_add_u32 s35, s35, 1
    s_waitcnt vmcnt(0)
    v_max_u32 v28, v24, v25
    v_cmp_eq_u32 vcc, -1, v28
    s_cbranch_vccz L_done33
    s_sleep 16
    s_cmp_lt_u32 s35, 60000
    s_cbranch_scc1 L_poll32
L_done33:
    v_lshlrev_b32 v104, 16, v24
    v_and_b32 v105, 0xffff0000, v24
    v_lshlrev_b32 v106, 16, v25
    v_and_b32 v107, 0xffff0000, v25
    v_fma_f32 v108, v104, v32, v108
    v_fma_f32 v109, v105, v33, v109
    v_fma_f32 v110, v106, v34, v110
    v_fma_f32 v111, v107, v35, v111
    v_mul_f32 v108, 0x3e800000, v108
    v_mul_f32 v109, 0x3e800000, v109
    v_mul_f32 v110, 0x3e800000, v110
    v_mul_f32 v111, 0x3e800000, v111
    v_lshl_add_u32 v204, v13, 18, v112
    s_add_u32 s34, s99, 98304
    v_add_u32 v204, s34, v204
    s_cmp_eq_u32 s60, 4
    s_cselect_b32 s40, 2, 6
    s_mov_b32 s41, 10923
    s_cmov_b32 s41, 32769
    s_cselect_b32 s34, 28, 20
    s_mov_b32 s49, 12800
    s_cmov_b32 s49, 38400
    v_min_u32 v196, 59, v0
    v_mul_u32_u24 v197, s41, v196
    v_lshrrev_b32 v197, 16, v197
    v_mul_u32_u24 v194, s40, v197
    v_sub_u32 v196, v196, v194
    v_mul_u32_u24 v197, 1280, v197
    v_lshl_add_u32 v197, v196, 6, v197
    s_mul_i32 s35, s60, 384
    s_add_i32 s35, s35, -1792
    s_cmp_eq_u32 s60, 4
    s_cselect_b32 s35, 0, s35
    s_sub_u32 s34, s61, s34
    s_mul_i32 s34, s34, s49
    s_mul_i32 s34, s34, 15
    s_add_u32 s34, s34, s35
    v_add_u32 v197, s34, v197
    s_mov_b32 s40, s49
    s_mov_b32 s41, s49
    s_branch L_d_none
L_d_wo:
    s_lshr_b32 s49, s3, 1
    s_lshl_b32 s49, s49, 18
    v_and_b32 v210, 7, v0
    s_mul_i32 s34, s60, 4096
    s_add_u32 s34, s34, s49
    s_add_u32 s34, s34, 147712
    v_lshrrev_b32 v211, 3, v0
    v_mul_u32_u24 v205, 512, v211
    v_add_u32 v204, s34, v205
    s_lshl_b32 s35, s51, 7
    s_add_u32 s34, s34, s35
    s_sub_u32 s34, s34, 256
    v_lshl_add_u32 v205, v210, 4, v205
    v_add_u32 v205, s34, v205
    s_lshl_b32 s34, s3, 12
    s_add_u32 s34, s34, 40960
    v_lshrrev_b32 v206, 2, v0
    v_lshlrev_b32 v206, 6, v206
    v_lshl_add_u32 v206, v200, 3, v206
    v_add_u32 v206, s34, v206
    s_mul_i32 s34, s3, 1152
    s_add_u32 s34, s34, 107520
    v_mul_u32_u24 v207, 144, v211
    v_lshl_add_u32 v207, v210, 4, v207
    v_add_u32 v207, s34, v207
    v_mul_u32_u24 v208, 144, v210
    v_lshl_add_u32 v208, v202, 4, v208
    v_add_u32 v208, s34, v208
    v_mul_u32_u24 v212, 144, v211
    v_add_u32 v212, s34, v212
    v_mul_u32_u24 v213, 144, v210
    v_add_u32 v213, s34, v213
    v_and_b32 v211, 1, v211
    v_bfe_u32 v203, v0, 1, 2
    v_mul_u32_u24 v203, 144, v203
    v_and_b32 v214, 1, v0
    v_mul_u32_u24 v214, 576, v214
    v_lshl_add_u32 v214, v211, 6, v214
    v_lshl_add_u32 v214, v202, 4, v214
    s_add_u32 s34, s34, 14592
    v_add3_u32 v203, v203, v214, s34
    v_mov_b32 v210, 98816
    v_cmp_eq_u32 vcc, 0, v211
    s_nop 1
    v_cndmask_b32 v209, v208, v210, vcc
    v_cndmask_b32 v208, v210, v208, vcc
    v_and_b32 v8, 15, v0
    s_lshr_b32 s34, s62, 1
    s_add_u32 s34, s34, 0
    s_lshr_b32 s35, s34, 2
    s_lshl_b32 s35, s35, 9
    s_and_b32 s34, s34, 3
    s_lshl_b32 s34, s34, 18
    s_add_u32 s34, s34, s35
    s_and_b32 s35, s62, 1
    s_mul_i32 s35, s35, 64
    s_add_u32 s34, s34, s35
    s_add_u32 s34, s34, 30720
    v_lshlrev_b32 v9, 2, v8
    v_lshl_add_u32 v9, v14, 7, v9
    v_add_u32 v9, s34, v9
    s_lshr_b32 s34, s60, 2
    s_lshl_b32 s34, s34, 14
    s_and_b32 s35, s60, 3
    s_lshl_b32 s35, s35, 18
    s_add_u32 s34, s34, s35
    s_lshl_b32 s35, s62, 6
    s_add_u32 s34, s34, s35
    s_add_u32 s34, s34, 98304
    v_mul_u32_u24 v112, 1280, v14
    v_lshl_add_u32 v112, v8, 2, v112
    v_add_u32 v112, s34, v112
    v_mul_u32_u24 v113, 144, v14
    v_lshl_add_u32 v113, v8, 3, v113
    v_add_u32 v113, 122112, v113
    s_bfe_u32 s35, s60, 0x10002
    s_lshl_b32 s35, s35, 13
    s_xor_b32 s101, s99, s35
    s_xor_b32 s93, s101, 8192
    s_mul_i32 s34, s62, 52
    s_lshr_b32 s34, s34, 8
    s_mul_i32 s35, s34, 5
    s_sub_u32 s35, s62, s35
    s_mul_i32 s34, s34, 1310720
    s_lshl_b32 s35, s35, 15
    s_add_u32 s34, s34, s35
    s_mul_i32 s35, s60, 163840
    s_add_u32 s34, s34, s35
    v_lshl_add_u32 v197, v0, 6, s34
    s_movk_i32 s40, 4096
    s_movk_i32 s41, 4096
    s_mov_b32 s35, 0
L_poll35:
    buffer_load_dword v32, v9, s[44:47], 0 offen sc1
    s_add_u32 s35, s35, 1
    s_waitcnt vmcnt(0)
    v_mov_b32 v22, v32
    v_cmp_eq_u32 vcc, -1, v22
    s_cbranch_vccz L_done36
    s_sleep 16
    s_cmp_lt_u32 s35, 60000
    s_cbranch_scc1 L_poll35
L_done36:
    v_lshlrev_b32 v100, 16, v32
    v_and_b32 v101, 0xffff0000, v32
L_d_none:
    v_and_b32 v19, 7, v0
    v_lshlrev_b32 v19, 3, v19
    v_add_u32 v19, 98560, v19
    s_mov_b32 s35, 0
L_poll38:
    ds_read_b64 v[20:21], v19
    s_add_u32 s35, s35, 1
    s_waitcnt lgkmcnt(0)
    v_max_u32 v22, v20, v21
    v_cmp_eq_u32 vcc, -1, v22
    s_cbranch_vccz L_done39
    s_sleep 2
    s_cmp_lt_u32 s35, 60000
    s_cbranch_scc1 L_poll38
L_done39:
    v_max_f32_dpp v22, v20, v20 row_half_mirror row_mask:0xf bank_mask:0xf
    s_nop 1
    v_max_f32_dpp v22, v22, v22 quad_perm:[1,0,3,2] row_mask:0xf bank_mask:0xf
    s_nop 1
    v_max_f32_dpp v22, v22, v22 quad_perm:[2,3,0,1] row_mask:0xf bank_mask:0xf
    v_sub_f32 v20, v20, v22
    v_exp_f32 v20, v20
    s_nop 0
    v_mul_f32 v21, v21, v20
    s_nop 1
    v_add_f32_dpp v21, v21, v21 row_half_mirror row_mask:0xf bank_mask:0xf
    s_nop 1
    v_add_f32_dpp v21, v21, v21 quad_perm:[1,0,3,2] row_mask:0xf bank_mask:0xf
    s_nop 1
    v_add_f32_dpp v21, v21, v21 quad_perm:[2,3,0,1] row_mask:0xf bank_mask:0xf
    v_rcp_f32 v23, v21
    v_log_f32 v21, v21
    v_mul_f32 v20, v20, v23
    v_add_f32 v21, v21, v22
    v_min_u32 v21, -2, v21
    v_readlane_b32 s88, v20, 0
    v_readlane_b32 s90, v20, 1
    v_readlane_b32 s92, v20, 2
    v_readlane_b32 s94, v20, 3
    v_readlane_b32 s96, v20, 4
    v_readlane_b32 s98, v20, 5
    v_readlane_b32 s100, v20, 6
    v_readlane_b32 s89, v20, 7
    s_and_b32 s95, s61, 3
    s_lshl_b32 s95, s95, 18
    s_bfe_u32 s35, s2, 0x20005
    s_lshl_b32 s35, s35, 1
    s_lshr_b32 s91, s2, 7
    s_add_u32 s35, s35, s91
    s_getreg_b32 s91, hwreg(HW_REG_XCC_ID, 0, 4)
    v_and_b32 v24, 1, v0
    v_cmp_eq_u32 vcc, 0, v24
    v_mov_b32 v25, s91
    s_nop 0
    v_cndmask_b32 v25, v25, v21, vcc
    v_mul_f32 v20, s89, v116
    v_mul_f32 v21, s89, v117
    s_mul_i32 s34, s60, 4096
    s_mul_i32 s35, s35, 512
    s_add_u32 s34, s34, s35
    s_add_u32 s34, s34, s95
    s_add_u32 s34, s34, 147456
    v_lshl_add_u32 v26, v0, 2, s34
    v_lshlrev_b32 v19, 3, v0
    v_add_u32 v19, 99328, v19
    v_lshlrev_b32 v18, 4, v0
    v_add_u32 v18, 131328, v18
    s_mov_b32 s36, s12
    s_mov_b32 s37, s13
    s_mov_b32 s38, 5242880
    s_and_b32 s34, s61, 24
    s_add_u32 s34, s34, s60
    s_mul_i32 s34, s34, 163840
    s_and_b32 s35, s61, 7
    s_mul_i32 s35, s35, 20480
    s_add_u32 s34, s34, s35
    v_lshl_add_u32 v195, v0, 6, s34
    s_mov_b32 s34, 0
    s_barrier
    buffer_load_dword v250, v195, s[36:39], s34 offen
    s_add_u32 s34, s34, 4096
    buffer_load_dword v250, v195, s[36:39], s34 offen
    s_add_u32 s34, s34, 4096
    buffer_load_dword v250, v195, s[36:39], s34 offen
    s_add_u32 s34, s34, 4096
    buffer_load_dword v250, v195, s[36:39], s34 offen
    s_add_u32 s34, s34, 4096
    buffer_load_dword v250, v195, s[36:39], s34 offen
    s_add_u32 s34, s34, 4096
    s_cmp_lt_u32 s63, 1
    s_cbranch_scc1 L_nopf
    buffer_load_dword v250, v197, s[52:55], s42 offen
    s_add_u32 s42, s42, s40
    buffer_load_dword v250, v197, s[52:55], s42 offen
    s_add_u32 s42, s42, s41
L_nopf:
    s_cmp_eq_u32 s97, 0
    buffer_store_dword v25, v26, s[44:47], 0 offen offset:256
    s_barrier
    ds_read_b64 v[32:33], v19 offset:0
    ds_read_b64 v[34:35], v19 offset:1024
    ds_read_b64 v[36:37], v19 offset:2048
    ds_read_b64 v[38:39], v19 offset:3072
    ds_read_b64 v[40:41], v19 offset:4096
    ds_read_b64 v[42:43], v19 offset:5120
    ds_read_b64 v[44:45], v19 offset:6144
    s_waitcnt lgkmcnt(6)
    v_pk_fma_f32 v[20:21], v[32:33], s[88:89], v[20:21] op_sel_hi:[1,0,1]
    s_waitcnt lgkmcnt(5)
    v_pk_fma_f32 v[20:21], v[34:35], s[90:91], v[20:21] op_sel_hi:[1,0,1]
    s_waitcnt lgkmcnt(4)
    v_pk_fma_f32 v[20:21], v[36:37], s[92:93], v[20:21] op_sel_hi:[1,0,1]
    s_waitcnt lgkmcnt(3)
    v_pk_fma_f32 v[20:21], v[38:39], s[94:95], v[20:21] op_sel_hi:[1,0,1]
    s_waitcnt lgkmcnt(2)
    v_pk_fma_f32 v[20:21], v[40:41], s[96:97], v[20:21] op_sel_hi:[1,0,1]
    s_waitcnt lgkmcnt(1)
    v_pk_fma_f32 v[20:21], v[42:43], s[98:99], v[20:21] op_sel_hi:[1,0,1]
    s_waitcnt lgkmcnt(0)
    v_pk_fma_f32 v[20:21], v[44:45], s[100:101], v[20:21] op_sel_hi:[1,0,1]
    v_cvt_pk_bf16_f32 v24, v20, v21
    v_min_u32 v24, -2, v24
    buffer_store_dword v24, v26, s[44:47], 0 offen
    s_cbranch_scc1 L_ostd
    buffer_store_dword v24, v26, s[44:47], 0 offen sc1
    buffer_store_dword v25, v26, s[44:47], 0 offen offset:256 sc1
L_ostd:
    ds_write_b96 v18, v[24:26]
    s_waitcnt lgkmcnt(0)
    s_cmp_lt_u32 s63, 1
    s_cbranch_scc1 L_nopf2
    buffer_load_dword v250, v197, s[52:55], s42 offen
    s_add_u32 s42, s42, s40
    buffer_load_dword v250, v197, s[52:55], s42 offen
    s_add_u32 s42, s42, s41
    buffer_load_dword v250, v197, s[52:55], s42 offen
    s_add_u32 s42, s42, s40
    buffer_load_dword v250, v197, s[52:55], s42 offen
    s_add_u32 s42, s42, s41
    buffer_load_dword v250, v197, s[52:55], s42 offen
    s_add_u32 s42, s42, s40
    buffer_load_dword v250, v197, s[52:55], s42 offen
    s_add_u32 s42, s42, s41
    buffer_load_dword v250, v197, s[52:55], s42 offen
    s_add_u32 s42, s42, s40
    buffer_load_dword v250, v197, s[52:55], s42 offen
    s_add_u32 s42, s42, s41
L_nopf2:
    s_barrier
    s_cmp_eq_u32 s63, 0
    s_cbranch_scc1 L_r_wo2
    buffer_load_dword v250, v197, s[52:55], s42 offen
    s_add_u32 s42, s42, s40
    s_cmp_eq_u32 s63, 1
    s_cbranch_scc1 L_r_w1
    buffer_load_dword v250, v197, s[52:55], s42 offen
    s_add_u32 s42, s42, s40
    buffer_load_dword v250, v197, s[52:55], s42 offen
    s_add_u32 s42, s42, s41
    buffer_load_dword v250, v197, s[52:55], s42 offen
    s_add_u32 s42, s42, s40
    buffer_load_dword v250, v197, s[52:55], s42 offen
    s_add_u32 s42, s42, s41
    s_cmp_eq_u32 s63, 2
    s_cbranch_scc1 L_w2_red
    s_waitcnt vmcnt(0)
    s_mov_b64 exec, -1
    v_lshlrev_b32 v243, 4, v0
    v_add_u32 v243, 131328, v243
    ds_read_b96 v[240:242], v243
    s_waitcnt lgkmcnt(0)
    buffer_store_dword v240, v242, s[44:47], 0 offen sc1
    buffer_store_dword v241, v242, s[44:47], 0 offen offset:256 sc1
    s_branch L_fin
L_stream:
    s_sub_u32 s49, s3, 1
    s_lshl_b32 s49, s49, 12
    v_lshl_add_u32 v1, v0, 4, s49
    s_and_b32 s34, s2, 127
    s_lshl_b32 s34, s34, 21
    s_lshr_b32 s35, s2, 7
    s_lshl_b32 s35, s35, 18
    s_add_u32 s34, s34, s35
    s_add_u32 s34, s34, 1572864
    s_mov_b32 s38, 0x40000
    s_mov_b32 s42, 0x40000
    s_waitcnt lgkmcnt(0)
    s_add_u32 s36, s6, s34
    s_addc_u32 s37, s7, 0
    s_add_u32 s40, s8, s34
    s_addc_u32 s41, s9, 0
    s_barrier
    s_waitcnt vmcnt(2)
    s_mov_b32 s49, 0
    buffer_load_dwordx4 v[28:31], v1, s[36:39], s49 offen offset:3072 nt
    s_waitcnt vmcnt(2)
    s_mov_b32 s49, 28672
    buffer_load_dwordx4 v[32:35], v1, s[36:39], s49 offen offset:0 nt
    s_waitcnt vmcnt(2)
    buffer_load_dwordx4 v[36:39], v1, s[36:39], s49 offen offset:1024 nt
    s_waitcnt vmcnt(2)
    buffer_load_dwordx4 v[40:43], v1, s[36:39], s49 offen offset:2048 nt
    s_waitcnt vmcnt(2)
    buffer_load_dwordx4 v[44:47], v1, s[36:39], s49 offen offset:3072 nt
    s_add_u32 s44, s32, 0
    s_addc_u32 s45, s33, 0
    s_mov_b32 s63, 0
    s_mov_b32 s62, s61
    s_cmp_lt_u32 s61, 20
    s_cbranch_scc1 L_rd41
    s_mul_i32 s62, s60, 12
    s_add_u32 s62, s62, s61
    s_sub_u32 s62, s62, 20
    s_mov_b32 s63, 1
    s_cmp_lt_u32 s62, 54
    s_cbranch_scc1 L_rd41
    s_cmp_lt_u32 s62, 56
    s_cselect_b32 s63, 3, 2
    s_sub_u32 s62, s62, 56
L_rd41:
    v_and_b32 v8, 3, v0
    v_bfe_u32 v9, v0, 2, 2
    v_lshrrev_b32 v10, 4, v0
    s_mov_b32 s55, 0x20000
    s_lshl_b32 s35, s62, 6
    s_and_b32 s49, s62, 1
    s_cmp_eq_u32 s63, 0
    s_cbranch_scc1 L_dp43
    s_cmp_eq_u32 s63, 1
    s_cbranch_scc1 L_dp44
    s_mov_b32 s52, s20
    s_mov_b32 s53, s21
    s_mov_b32 s54, 2211840
    v_mov_b32 v15, 0
    s_branch L_dp45
L_dp44:
    s_mov_b32 s52, s16
    s_mov_b32 s53, s17
    s_mov_b32 s54, 2211840
    v_lshl_add_u32 v15, v9, 3, v10
    v_mul_u32_u24 v15, 3456, v15
    v_lshl_add_u32 v15, v8, 4, v15
    v_add_u32 v15, s35, v15
    s_bfe_u32 s50, s3, 0x10001
    s_lshl_b32 s50, s50, 7
    s_and_b32 s34, s3, 1
    s_lshl_b32 s34, s34, 2
    s_add_u32 s50, s50, s34
    s_and_b32 s51, s3, 3
    s_lshl_b32 s51, s51, 5
    s_add_u32 s51, s51, 512
    s_mul_i32 s50, s50, 3456
    s_mul_i32 s51, s51, 3456
    s_branch L_dp45
L_dp43:
    s_mov_b32 s52, s12
    s_mov_b32 s53, s13
    s_mov_b32 s54, 5242880
    s_lshr_b32 s50, s3, 1
    s_lshl_b32 s50, s50, 3
    s_add_u32 s50, s50, s60
    s_and_b32 s51, s3, 1
    s_lshl_b32 s34, s50, 1
    s_add_u32 s34, s34, s51
    s_mul_i32 s34, s34, 81920
    s_add_u32 s34, s34, s35
    v_lshl_add_u32 v15, v9, 2, v10
    v_mul_u32_u24 v15, 2560, v15
    v_lshl_add_u32 v15, v8, 4, v15
    v_add_u32 v15, s34, v15
    s_lshl_b32 s56, s3, 12
    s_lshl_b32 s34, s49, 11
    s_add_u32 s56, s56, s34
    s_add_u32 s56, s56, 40960
    s_add_u32 s58, s56, 1024
    s_mul_i32 s57, s49, 40960
    s_add_u32 s59, s57, 1280
L_dp45:
    v_and_b32 v2, 15, v0
    v_lshlrev_b32 v2, 4, v2
    v_add_u32 v2, 98304, v2
    s_waitcnt vmcnt(2)
    s_mov_b32 s49, 57344
    buffer_load_dwordx4 v[48:51], v1, s[36:39], s49 offen offset:0 nt
    s_waitcnt vmcnt(2)
    buffer_load_dwordx4 v[52:55], v1, s[36:39], s49 offen offset:1024 nt
    s_waitcnt vmcnt(2)
    s_cmp_ge_u32 s3, 4
    s_cbranch_scc1 L_sl46
    s_waitcnt vmcnt(1)
L_sl46:
    buffer_load_dwordx4 v[56:59], v1, s[36:39], s49 offen offset:2048 nt
    s_waitcnt vmcnt(2)
    s_cmp_ge_u32 s3, 4
    s_cbranch_scc1 L_sl47
    s_waitcnt vmcnt(1)
L_sl47:
    buffer_load_dwordx4 v[60:63], v1, s[36:39], s49 offen offset:3072 nt
    s_waitcnt vmcnt(2)
    s_cmp_ge_u32 s3, 4
    s_cbranch_scc1 L_sl48
    s_waitcnt vmcnt(1)
L_sl48:
    s_mov_b32 s49, 86016
    buffer_load_dwordx4 v[64:67], v1, s[36:39], s49 offen offset:0 nt
    s_waitcnt vmcnt(2)
    buffer_load_dwordx4 v[68:71], v1, s[36:39], s49 offen offset:1024 nt
    s_waitcnt vmcnt(2)
    buffer_load_dwordx4 v[72:75], v1, s[36:39], s49 offen offset:2048 nt
    s_waitcnt vmcnt(2)
    buffer_load_dwordx4 v[76:79], v1, s[36:39], s49 offen offset:3072 nt
    s_waitcnt vmcnt(2)
    s_mov_b32 s49, 114688
    buffer_load_dwordx4 v[80:83], v1, s[36:39], s49 offen offset:0 nt
    s_waitcnt vmcnt(2)
    buffer_load_dwordx4 v[84:87], v1, s[36:39], s49 offen offset:1024 nt
    s_waitcnt vmcnt(2)
    buffer_load_dwordx4 v[88:91], v1, s[36:39], s49 offen offset:2048 nt
    v_mov_b32 v3, 19
    ds_write_b32 v2, v3 offset:768
    s_waitcnt vmcnt(2)
    buffer_load_dwordx4 v[92:95], v1, s[36:39], s49 offen offset:3072 nt
    s_waitcnt vmcnt(2)
    s_mov_b32 s49, 143360
    buffer_load_dwordx4 v[96:99], v1, s[36:39], s49 offen offset:0 nt
    s_waitcnt vmcnt(2)
    buffer_load_dwordx4 v[100:103], v1, s[36:39], s49 offen offset:1024 nt
    s_waitcnt vmcnt(2)
    buffer_load_dwordx4 v[104:107], v1, s[36:39], s49 offen offset:2048 nt
    s_waitcnt vmcnt(2)
    buffer_load_dwordx4 v[108:111], v1, s[36:39], s49 offen offset:3072 nt
    s_waitcnt vmcnt(2)
    s_mov_b32 s49, 172032
    buffer_load_dwordx4 v[112:115], v1, s[36:39], s49 offen offset:0 nt
    s_waitcnt vmcnt(2)
    buffer_load_dwordx4 v[116:119], v1, s[36:39], s49 offen offset:1024 nt
    s_waitcnt vmcnt(2)
    buffer_load_dwordx4 v[120:123], v1, s[36:39], s49 offen offset:2048 nt
    s_waitcnt vmcnt(2)
    buffer_load_dwordx4 v[124:127], v1, s[36:39], s49 offen offset:3072 nt
    s_waitcnt vmcnt(2)
    s_mov_b32 s49, 200704
    buffer_load_dwordx4 v[128:131], v1, s[36:39], s49 offen offset:0 nt
    s_waitcnt vmcnt(2)
    buffer_load_dwordx4 v[132:135], v1, s[36:39], s49 offen offset:1024 nt
    s_waitcnt vmcnt(2)
    buffer_load_dwordx4 v[136:139], v1, s[36:39], s49 offen offset:2048 nt
    v_mov_b32 v3, 31
    ds_write_b32 v2, v3 offset:768
    s_waitcnt vmcnt(2)
    buffer_load_dwordx4 v[140:143], v1, s[36:39], s49 offen offset:3072 nt
    s_waitcnt vmcnt(2)
    s_mov_b32 s49, 229376
    buffer_load_dwordx4 v[144:147], v1, s[36:39], s49 offen offset:0 nt
    s_waitcnt vmcnt(2)
    buffer_load_dwordx4 v[148:151], v1, s[36:39], s49 offen offset:1024 nt
    s_waitcnt vmcnt(2)
    buffer_load_dwordx4 v[152:155], v1, s[36:39], s49 offen offset:2048 nt
    s_waitcnt vmcnt(2)
    buffer_load_dwordx4 v[156:159], v1, s[36:39], s49 offen offset:3072 nt
    s_waitcnt vmcnt(2)
    s_mov_b32 s49, 0
    buffer_load_dwordx4 v[160:163], v1, s[40:43], s49 offen offset:0 nt
    s_waitcnt vmcnt(2)
    buffer_load_dwordx4 v[164:167], v1, s[40:43], s49 offen offset:1024 nt
    s_waitcnt vmcnt(2)
    buffer_load_dwordx4 v[168:171], v1, s[40:43], s49 offen offset:2048 nt
    s_waitcnt vmcnt(2)
    buffer_load_dwordx4 v[172:175], v1, s[40:43], s49 offen offset:3072 nt
    s_waitcnt vmcnt(2)
    s_mov_b32 s49, 28672
    buffer_load_dwordx4 v[176:179], v1, s[40:43], s49 offen offset:0 nt
    s_waitcnt vmcnt(2)
    buffer_load_dwordx4 v[180:183], v1, s[40:43], s49 offen offset:1024 nt
    s_waitcnt vmcnt(2)
    buffer_load_dwordx4 v[184:187], v1, s[40:43], s49 offen offset:2048 nt
    s_waitcnt vmcnt(2)
    buffer_load_dwordx4 v[188:191], v1, s[40:43], s49 offen offset:3072 nt
    s_waitcnt vmcnt(2)
    s_mov_b32 s49, 57344
    buffer_load_dwordx4 v[192:195], v1, s[40:43], s49 offen offset:0 nt
    s_waitcnt vmcnt(2)
    buffer_load_dwordx4 v[196:199], v1, s[40:43], s49 offen offset:1024 nt
    s_waitcnt vmcnt(2)
    buffer_load_dwordx4 v[200:203], v1, s[40:43], s49 offen offset:2048 nt
    s_waitcnt vmcnt(2)
    buffer_load_dwordx4 v[204:207], v1, s[40:43], s49 offen offset:3072 nt
    s_waitcnt vmcnt(2)
    s_mov_b32 s49, 86016
    buffer_load_dwordx4 v[208:211], v1, s[40:43], s49 offen offset:0 nt
    s_waitcnt vmcnt(2)
    buffer_load_dwordx4 v[212:215], v1, s[40:43], s49 offen offset:1024 nt
    s_waitcnt vmcnt(2)
    buffer_load_dwordx4 v[216:219], v1, s[40:43], s49 offen offset:2048 nt
    s_waitcnt vmcnt(2)
    buffer_load_dwordx4 v[220:223], v1, s[40:43], s49 offen offset:3072 nt
    s_waitcnt vmcnt(2)
    s_mov_b32 s49, 114688
    buffer_load_dwordx4 v[224:227], v1, s[40:43], s49 offen offset:0 nt
    s_waitcnt vmcnt(2)
    buffer_load_dwordx4 v[228:231], v1, s[40:43], s49 offen offset:1024 nt
    s_waitcnt vmcnt(2)
    buffer_load_dwordx4 v[232:235], v1, s[40:43], s49 offen offset:2048 nt
    s_waitcnt vmcnt(2)
    buffer_load_dwordx4 v[236:239], v1, s[40:43], s49 offen offset:3072 nt
    v_mov_b32 v14, 99080
    s_mov_b32 s35, 0
L_poll49:
    ds_read_b128 v[4:7], v2
    ds_read_b32 v8, v14
    s_add_u32 s35, s35, 1
    s_waitcnt lgkmcnt(0)
    v_max3_u32 v3, v4, v5, v6
    v_max_u32 v3, v3, v7
    v_cmp_eq_u32 vcc, -1, v3
    s_cbranch_vccz L_done50
    s_sleep 2
    s_cmp_lt_u32 s35, 60000
    s_cbranch_scc1 L_poll49
L_done50:
    v_readfirstlane_b32 s99, v8
    s_waitcnt vmcnt(2)
    s_mov_b32 s49, 143360
    buffer_load_dwordx4 v[240:243], v1, s[40:43], s49 offen offset:0 nt
    v_dot2_f32_bf16 v8, v16, v4, 0
    v_dot2_f32_bf16 v9, v20, v4, 0
    v_dot2_f32_bf16 v10, v24, v4, 0
    v_dot2_f32_bf16 v11, v28, v4, 0
    v_dot2c_f32_bf16 v8, v17, v5
    v_dot2c_f32_bf16 v9, v21, v5
    v_dot2c_f32_bf16 v10, v25, v5
    v_dot2c_f32_bf16 v11, v29, v5
    v_dot2c_f32_bf16 v8, v18, v6
    v_dot2c_f32_bf16 v9, v22, v6
    v_dot2c_f32_bf16 v10, v26, v6
    v_dot2c_f32_bf16 v11, v30, v6
    v_dot2c_f32_bf16 v8, v19, v7
    v_dot2c_f32_bf16 v9, v23, v7
    v_dot2c_f32_bf16 v10, v27, v7
    v_dot2c_f32_bf16 v11, v31, v7
    v_add_f32_dpp v12, v8, v8 row_ror:8 row_mask:0xf bank_mask:0x3
    v_add_f32_dpp v12, v9, v9 row_ror:8 row_mask:0xf bank_mask:0xc
    v_add_f32_dpp v13, v10, v10 row_ror:8 row_mask:0xf bank_mask:0x3
    v_add_f32_dpp v13, v11, v11 row_ror:8 row_mask:0xf bank_mask:0xc
    v_dot2_f32_bf16 v8, v32, v4, 0
    v_dot2_f32_bf16 v9, v36, v4, 0
    v_dot2_f32_bf16 v10, v40, v4, 0
    v_dot2_f32_bf16 v11, v44, v4, 0
    v_add_f32_dpp v12, v12, v12 row_half_mirror row_mask:0xf bank_mask:0xf
    v_add_f32_dpp v13, v13, v13 row_half_mirror row_mask:0xf bank_mask:0xf
    v_dot2c_f32_bf16 v8, v33, v5
    v_dot2c_f32_bf16 v9, v37, v5
    v_dot2c_f32_bf16 v10, v41, v5
    v_dot2c_f32_bf16 v11, v45, v5
    v_add_f32_dpp v12, v12, v12 quad_perm:[1,0,3,2] row_mask:0xf bank_mask:0xf
    v_add_f32_dpp v13, v13, v13 quad_perm:[1,0,3,2] row_mask:0xf bank_mask:0xf
    v_dot2c_f32_bf16 v8, v34, v6
    v_dot2c_f32_bf16 v9, v38, v6
    v_dot2c_f32_bf16 v10, v42, v6
    v_dot2c_f32_bf16 v11, v46, v6
    s_waitcnt vmcnt(2)
    buffer_load_dwordx4 v[244:247], v1, s[40:43], s49 offen offset:1024 nt
    v_add_f32_dpp v12, v12, v12 quad_perm:[2,3,0,1] row_mask:0xf bank_mask:0xf
    v_add_f32_dpp v13, v13, v13 quad_perm:[2,3,0,1] row_mask:0xf bank_mask:0xf
    v_dot2c_f32_bf16 v8, v35, v7
    v_dot2c_f32_bf16 v9, v39, v7
    v_dot2c_f32_bf16 v10, v43, v7
    v_dot2c_f32_bf16 v11, v47, v7
    v_add_f32_dpp v16, v8, v8 row_ror:8 row_mask:0xf bank_mask:0x3
    v_add_f32_dpp v16, v9, v9 row_ror:8 row_mask:0xf bank_mask:0xc
    v_add_f32_dpp v17, v10, v10 row_ror:8 row_mask:0xf bank_mask:0x3
    v_add_f32_dpp v17, v11, v11 row_ror:8 row_mask:0xf bank_mask:0xc
    v_dot2_f32_bf16 v8, v48, v4, 0
    v_dot2_f32_bf16 v9, v52, v4, 0
    v_dot2_f32_bf16 v10, v56, v4, 0
    v_dot2_f32_bf16 v11, v60, v4, 0
    v_add_f32_dpp v16, v16, v16 row_half_mirror row_mask:0xf bank_mask:0xf
    v_add_f32_dpp v17, v17, v17 row_half_mirror row_mask:0xf bank_mask:0xf
    v_dot2c_f32_bf16 v8, v49, v5
    v_dot2c_f32_bf16 v9, v53, v5
    v_dot2c_f32_bf16 v10, v57, v5
    v_dot2c_f32_bf16 v11, v61, v5
    v_add_f32_dpp v16, v16, v16 quad_perm:[1,0,3,2] row_mask:0xf bank_mask:0xf
    v_add_f32_dpp v17, v17, v17 quad_perm:[1,0,3,2] row_mask:0xf bank_mask:0xf
    v_dot2c_f32_bf16 v8, v50, v6
    v_dot2c_f32_bf16 v9, v54, v6
    v_dot2c_f32_bf16 v10, v58, v6
    v_dot2c_f32_bf16 v11, v62, v6
    v_add_f32_dpp v16, v16, v16 quad_perm:[2,3,0,1] row_mask:0xf bank_mask:0xf
    v_add_f32_dpp v17, v17, v17 quad_perm:[2,3,0,1] row_mask:0xf bank_mask:0xf
    v_dot2c_f32_bf16 v8, v51, v7
    v_dot2c_f32_bf16 v9, v55, v7
    v_dot2c_f32_bf16 v10, v59, v7
    v_dot2c_f32_bf16 v11, v63, v7
    v_add_f32_dpp v18, v8, v8 row_ror:8 row_mask:0xf bank_mask:0x3
    v_add_f32_dpp v18, v9, v9 row_ror:8 row_mask:0xf bank_mask:0xc
    v_add_f32_dpp v19, v10, v10 row_ror:8 row_mask:0xf bank_mask:0x3
    v_add_f32_dpp v19, v11, v11 row_ror:8 row_mask:0xf bank_mask:0xc
    s_waitcnt vmcnt(2)
    buffer_load_dwordx4 v[248:251], v1, s[40:43], s49 offen offset:2048 nt
    v_dot2_f32_bf16 v8, v64, v4, 0
    v_dot2_f32_bf16 v9, v68, v4, 0
    v_dot2_f32_bf16 v10, v72, v4, 0
    v_dot2_f32_bf16 v11, v76, v4, 0
    v_add_f32_dpp v18, v18, v18 row_half_mirror row_mask:0xf bank_mask:0xf
    v_add_f32_dpp v19, v19, v19 row_half_mirror row_mask:0xf bank_mask:0xf
    v_dot2c_f32_bf16 v8, v65, v5
    v_dot2c_f32_bf16 v9, v69, v5
    v_dot2c_f32_bf16 v10, v73, v5
    v_dot2c_f32_bf16 v11, v77, v5
    v_add_f32_dpp v18, v18, v18 quad_perm:[1,0,3,2] row_mask:0xf bank_mask:0xf
    v_add_f32_dpp v19, v19, v19 quad_perm:[1,0,3,2] row_mask:0xf bank_mask:0xf
    v_dot2c_f32_bf16 v8, v66, v6
    v_dot2c_f32_bf16 v9, v70, v6
    v_dot2c_f32_bf16 v10, v74, v6
    v_dot2c_f32_bf16 v11, v78, v6
    v_add_f32_dpp v18, v18, v18 quad_perm:[2,3,0,1] row_mask:0xf bank_mask:0xf
    v_add_f32_dpp v19, v19, v19 quad_perm:[2,3,0,1] row_mask:0xf bank_mask:0xf
    v_dot2c_f32_bf16 v8, v67, v7
    v_dot2c_f32_bf16 v9, v71, v7
    v_dot2c_f32_bf16 v10, v75, v7
    v_dot2c_f32_bf16 v11, v79, v7
    v_add_f32_dpp v20, v8, v8 row_ror:8 row_mask:0xf bank_mask:0x3
    v_add_f32_dpp v20, v9, v9 row_ror:8 row_mask:0xf bank_mask:0xc
    v_add_f32_dpp v21, v10, v10 row_ror:8 row_mask:0xf bank_mask:0x3
    v_add_f32_dpp v21, v11, v11 row_ror:8 row_mask:0xf bank_mask:0xc
    v_dot2_f32_bf16 v8, v80, v4, 0
    v_dot2_f32_bf16 v9, v84, v4, 0
    v_dot2_f32_bf16 v10, v88, v4, 0
    v_dot2_f32_bf16 v11, v92, v4, 0
    v_add_f32_dpp v20, v20, v20 row_half_mirror row_mask:0xf bank_mask:0xf
    v_add_f32_dpp v21, v21, v21 row_half_mirror row_mask:0xf bank_mask:0xf
    v_dot2c_f32_bf16 v8, v81, v5
    v_dot2c_f32_bf16 v9, v85, v5
    v_dot2c_f32_bf16 v10, v89, v5
    v_dot2c_f32_bf16 v11, v93, v5
    s_waitcnt vmcnt(2)
    buffer_load_dwordx4 v[252:255], v1, s[40:43], s49 offen offset:3072 nt
    v_add_f32_dpp v20, v20, v20 quad_perm:[1,0,3,2] row_mask:0xf bank_mask:0xf
    v_add_f32_dpp v21, v21, v21 quad_perm:[1,0,3,2] row_mask:0xf bank_mask:0xf
    v_dot2c_f32_bf16 v8, v82, v6
    v_dot2c_f32_bf16 v9, v86, v6
    v_dot2c_f32_bf16 v10, v90, v6
    v_dot2c_f32_bf16 v11, v94, v6
    v_add_f32_dpp v20, v20, v20 quad_perm:[2,3,0,1] row_mask:0xf bank_mask:0xf
    v_add_f32_dpp v21, v21, v21 quad_perm:[2,3,0,1] row_mask:0xf bank_mask:0xf
    v_dot2c_f32_bf16 v8, v83, v7
    v_dot2c_f32_bf16 v9, v87, v7
    v_dot2c_f32_bf16 v10, v91, v7
    v_dot2c_f32_bf16 v11, v95, v7
    v_add_f32_dpp v22, v8, v8 row_ror:8 row_mask:0xf bank_mask:0x3
    v_add_f32_dpp v22, v9, v9 row_ror:8 row_mask:0xf bank_mask:0xc
    v_add_f32_dpp v23, v10, v10 row_ror:8 row_mask:0xf bank_mask:0x3
    v_add_f32_dpp v23, v11, v11 row_ror:8 row_mask:0xf bank_mask:0xc
    v_dot2_f32_bf16 v8, v96, v4, 0
    v_dot2_f32_bf16 v9, v100, v4, 0
    v_dot2_f32_bf16 v10, v104, v4, 0
    v_dot2_f32_bf16 v11, v108, v4, 0
    v_add_f32_dpp v22, v22, v22 row_half_mirror row_mask:0xf bank_mask:0xf
    v_add_f32_dpp v23, v23, v23 row_half_mirror row_mask:0xf bank_mask:0xf
    v_dot2c_f32_bf16 v8, v97, v5
    v_dot2c_f32_bf16 v9, v101, v5
    v_dot2c_f32_bf16 v10, v105, v5
    v_dot2c_f32_bf16 v11, v109, v5
    v_add_f32_dpp v22, v22, v22 quad_perm:[1,0,3,2] row_mask:0xf bank_mask:0xf
    v_add_f32_dpp v23, v23, v23 quad_perm:[1,0,3,2] row_mask:0xf bank_mask:0xf
    v_dot2c_f32_bf16 v8, v98, v6
    v_dot2c_f32_bf16 v9, v102, v6
    v_dot2c_f32_bf16 v10, v106, v6
    v_dot2c_f32_bf16 v11, v110, v6
    v_add_f32_dpp v22, v22, v22 quad_perm:[2,3,0,1] row_mask:0xf bank_mask:0xf
    v_add_f32_dpp v23, v23, v23 quad_perm:[2,3,0,1] row_mask:0xf bank_mask:0xf
    v_dot2c_f32_bf16 v8, v99, v7
    v_dot2c_f32_bf16 v9, v103, v7
    s_waitcnt vmcnt(2)
    s_mov_b32 s49, 172032
    buffer_load_dwordx4 v[32:35], v1, s[40:43], s49 offen offset:0 nt
    v_dot2c_f32_bf16 v10, v107, v7
    v_dot2c_f32_bf16 v11, v111, v7
    v_add_f32_dpp v24, v8, v8 row_ror:8 row_mask:0xf bank_mask:0x3
    v_add_f32_dpp v24, v9, v9 row_ror:8 row_mask:0xf bank_mask:0xc
    v_add_f32_dpp v25, v10, v10 row_ror:8 row_mask:0xf bank_mask:0x3
    v_add_f32_dpp v25, v11, v11 row_ror:8 row_mask:0xf bank_mask:0xc
    v_dot2_f32_bf16 v8, v112, v4, 0
    v_dot2_f32_bf16 v9, v116, v4, 0
    v_dot2_f32_bf16 v10, v120, v4, 0
    v_dot2_f32_bf16 v11, v124, v4, 0
    v_add_f32_dpp v24, v24, v24 row_half_mirror row_mask:0xf bank_mask:0xf
    v_add_f32_dpp v25, v25, v25 row_half_mirror row_mask:0xf bank_mask:0xf
    v_dot2c_f32_bf16 v8, v113, v5
    v_dot2c_f32_bf16 v9, v117, v5
    v_dot2c_f32_bf16 v10, v121, v5
    v_dot2c_f32_bf16 v11, v125, v5
    v_add_f32_dpp v24, v24, v24 quad_perm:[1,0,3,2] row_mask:0xf bank_mask:0xf
    v_add_f32_dpp v25, v25, v25 quad_perm:[1,0,3,2] row_mask:0xf bank_mask:0xf
    v_dot2c_f32_bf16 v8, v114, v6
    v_dot2c_f32_bf16 v9, v118, v6
    v_dot2c_f32_bf16 v10, v122, v6
    v_dot2c_f32_bf16 v11, v126, v6
    v_add_f32_dpp v24, v24, v24 quad_perm:[2,3,0,1] row_mask:0xf bank_mask:0xf
    v_add_f32_dpp v25, v25, v25 quad_perm:[2,3,0,1] row_mask:0xf bank_mask:0xf
    v_dot2c_f32_bf16 v8, v115, v7
    v_dot2c_f32_bf16 v9, v119, v7
    v_dot2c_f32_bf16 v10, v123, v7
    v_dot2c_f32_bf16 v11, v127, v7
    v_add_f32_dpp v26, v8, v8 row_ror:8 row_mask:0xf bank_mask:0x3
    v_add_f32_dpp v26, v9, v9 row_ror:8 row_mask:0xf bank_mask:0xc
    v_add_f32_dpp v27, v10, v10 row_ror:8 row_mask:0xf bank_mask:0x3
    v_add_f32_dpp v27, v11, v11 row_ror:8 row_mask:0xf bank_mask:0xc
    v_dot2_f32_bf16 v8, v128, v4, 0
    v_dot2_f32_bf16 v9, v132, v4, 0
    v_dot2_f32_bf16 v10, v136, v4, 0
    v_dot2_f32_bf16 v11, v140, v4, 0
    s_waitcnt vmcnt(2)
    buffer_load_dwordx4 v[36:39], v1, s[40:43], s49 offen offset:1024 nt
    v_add_f32_dpp v26, v26, v26 row_half_mirror row_mask:0xf bank_mask:0xf
    v_add_f32_dpp v27, v27, v27 row_half_mirror row_mask:0xf bank_mask:0xf
    v_dot2c_f32_bf16 v8, v129, v5
    v_dot2c_f32_bf16 v9, v133, v5
    v_dot2c_f32_bf16 v10, v137, v5
    v_dot2c_f32_bf16 v11, v141, v5
    v_add_f32_dpp v26, v26, v26 quad_perm:[1,0,3,2] row_mask:0xf bank_mask:0xf
    v_add_f32_dpp v27, v27, v27 quad_perm:[1,0,3,2] row_mask:0xf bank_mask:0xf
    v_dot2c_f32_bf16 v8, v130, v6
    v_dot2c_f32_bf16 v9, v134, v6
    v_dot2c_f32_bf16 v10, v138, v6
    v_dot2c_f32_bf16 v11, v142, v6
    v_add_f32_dpp v26, v26, v26 quad_perm:[2,3,0,1] row_mask:0xf bank_mask:0xf
    v_add_f32_dpp v27, v27, v27 quad_perm:[2,3,0,1] row_mask:0xf bank_mask:0xf
    v_dot2c_f32_bf16 v8, v131, v7
    v_dot2c_f32_bf16 v9, v135, v7
    v_dot2c_f32_bf16 v10, v139, v7
    v_dot2c_f32_bf16 v11, v143, v7
    v_add_f32_dpp v28, v8, v8 row_ror:8 row_mask:0xf bank_mask:0x3
    v_add_f32_dpp v28, v9, v9 row_ror:8 row_mask:0xf bank_mask:0xc
    v_add_f32_dpp v29, v10, v10 row_ror:8 row_mask:0xf bank_mask:0x3
    v_add_f32_dpp v29, v11, v11 row_ror:8 row_mask:0xf bank_mask:0xc
    v_dot2_f32_bf16 v8, v144, v4, 0
    v_dot2_f32_bf16 v9, v148, v4, 0
    v_dot2_f32_bf16 v10, v152, v4, 0
    v_dot2_f32_bf16 v11, v156, v4, 0
    v_add_f32_dpp v28, v28, v28 row_half_mirror row_mask:0xf bank_mask:0xf
    v_add_f32_dpp v29, v29, v29 row_half_mirror row_mask:0xf bank_mask:0xf
    v_dot2c_f32_bf16 v8, v145, v5
    v_dot2c_f32_bf16 v9, v149, v5
    v_dot2c_f32_bf16 v10, v153, v5
    v_dot2c_f32_bf16 v11, v157, v5
    v_add_f32_dpp v28, v28, v28 quad_perm:[1,0,3,2] row_mask:0xf bank_mask:0xf
    v_add_f32_dpp v29, v29, v29 quad_perm:[1,0,3,2] row_mask:0xf bank_mask:0xf
    v_dot2c_f32_bf16 v8, v146, v6
    v_dot2c_f32_bf16 v9, v150, v6
    buffer_load_dwordx4 v[40:43], v1, s[40:43], s49 offen offset:2048 nt
    v_dot2c_f32_bf16 v10, v154, v6
    v_dot2c_f32_bf16 v11, v158, v6
    v_add_f32_dpp v28, v28, v28 quad_perm:[2,3,0,1] row_mask:0xf bank_mask:0xf
    v_add_f32_dpp v29, v29, v29 quad_perm:[2,3,0,1] row_mask:0xf bank_mask:0xf
    v_dot2c_f32_bf16 v8, v147, v7
    v_dot2c_f32_bf16 v9, v151, v7
    v_dot2c_f32_bf16 v10, v155, v7
    v_dot2c_f32_bf16 v11, v159, v7
    v_add_f32_dpp v30, v8, v8 row_ror:8 row_mask:0xf bank_mask:0x3
    v_add_f32_dpp v30, v9, v9 row_ror:8 row_mask:0xf bank_mask:0xc
    v_add_f32_dpp v31, v10, v10 row_ror:8 row_mask:0xf bank_mask:0x3
    v_add_f32_dpp v31, v11, v11 row_ror:8 row_mask:0xf bank_mask:0xc
    v_add_f32_dpp v30, v30, v30 row_half_mirror row_mask:0xf bank_mask:0xf
    s_nop 0
    v_add_f32_dpp v31, v31, v31 row_half_mirror row_mask:0xf bank_mask:0xf
    v_add_f32_dpp v30, v30, v30 quad_perm:[1,0,3,2] row_mask:0xf bank_mask:0xf
    s_nop 0
    v_add_f32_dpp v31, v31, v31 quad_perm:[1,0,3,2] row_mask:0xf bank_mask:0xf
    v_add_f32_dpp v30, v30, v30 quad_perm:[2,3,0,1] row_mask:0xf bank_mask:0xf
    s_nop 0
    v_add_f32_dpp v31, v31, v31 quad_perm:[2,3,0,1] row_mask:0xf bank_mask:0xf
    v_max3_f32 v8, v12, v13, v16
    v_max3_f32 v8, v8, v17, v18
    v_max3_f32 v8, v8, v19, v20
    v_max3_f32 v8, v8, v21, v22
    v_max3_f32 v8, v8, v23, v24
    v_max3_f32 v8, v8, v25, v26
    v_max3_f32 v8, v8, v27, v28
    v_max3_f32 v8, v8, v29, v30
    v_max_f32 v8, v8, v31
    s_mov_b32 s34, 0x3e0293ee
    s_nop 0
    v_max_f32_dpp v8, v8, v8 row_ror:8 row_mask:0xf bank_mask:0xf
    v_mov_b32 v9, v8
    s_nop 1
    v_permlane16_swap_b32 v8, v9
    v_max_f32 v8, v8, v9
    v_mov_b32 v9, v8
    s_nop 1
    v_permlane32_swap_b32 v8, v9
    v_max_f32 v8, v8, v9
    v_mul_f32 v8, s34, v8
    s_waitcnt vmcnt(3)
    buffer_load_dwordx4 v[44:47], v1, s[40:43], s49 offen offset:3072 nt
    v_fma_f32 v12, v12, s34, -v8
    v_fma_f32 v13, v13, s34, -v8
    v_fma_f32 v16, v16, s34, -v8
    v_fma_f32 v17, v17, s34, -v8
    v_fma_f32 v18, v18, s34, -v8
    v_fma_f32 v19, v19, s34, -v8
    v_fma_f32 v20, v20, s34, -v8
    v_fma_f32 v21, v21, s34, -v8
    v_fma_f32 v22, v22, s34, -v8
    v_fma_f32 v23, v23, s34, -v8
    v_fma_f32 v24, v24, s34, -v8
    v_fma_f32 v25, v25, s34, -v8
    v_fma_f32 v26, v26, s34, -v8
    v_fma_f32 v27, v27, s34, -v8
    v_fma_f32 v28, v28, s34, -v8
    v_fma_f32 v29, v29, s34, -v8
    v_fma_f32 v30, v30, s34, -v8
    v_fma_f32 v31, v31, s34, -v8
    v_exp_f32 v12, v12
    v_exp_f32 v13, v13
    v_exp_f32 v16, v16
    v_exp_f32 v17, v17
    v_exp_f32 v18, v18
    v_exp_f32 v19, v19
    v_exp_f32 v20, v20
    v_exp_f32 v21, v21
    v_exp_f32 v22, v22
    v_exp_f32 v23, v23
    v_exp_f32 v24, v24
    v_exp_f32 v25, v25
    v_exp_f32 v26, v26
    v_exp_f32 v27, v27
    v_exp_f32 v28, v28
    v_exp_f32 v29, v29
    v_exp_f32 v30, v30
    v_exp_f32 v31, v31
    s_waitcnt vmcnt(3)
    s_mov_b32 s49, 200704
    buffer_load_dwordx4 v[48:51], v1, s[40:43], s49 offen offset:0 nt
    v_add_f32 v9, v12, v13
    v_add_f32 v9, v9, v16
    v_add_f32 v9, v9, v17
    v_add_f32 v9, v9, v18
    v_add_f32 v9, v9, v19
    v_add_f32 v9, v9, v20
    v_add_f32 v9, v9, v21
    v_add_f32 v9, v9, v22
    v_add_f32 v9, v9, v23
    v_add_f32 v9, v9, v24
    v_add_f32 v9, v9, v25
    v_add_f32 v9, v9, v26
    v_add_f32 v9, v9, v27
    v_add_f32 v9, v9, v28
    v_add_f32 v9, v9, v29
    v_add_f32 v9, v9, v30
    v_add_f32 v9, v9, v31
    v_and_b32 v10, 1, v0
    v_lshlrev_b32 v10, 4, v10
    v_mov_b32 v11, 0xffff
    v_lshlrev_b32 v10, v10, v11
    v_bfe_u32 v11, v0, 1, 2
    v_cmp_eq_u32 vcc, 0, v11
    s_nop 1
    v_cndmask_b32 v144, 0, v10, vcc
    v_cmp_eq_u32 vcc, 1, v11
    s_nop 1
    v_cndmask_b32 v145, 0, v10, vcc
    v_cmp_eq_u32 vcc, 2, v11
    s_nop 1
    v_cndmask_b32 v146, 0, v10, vcc
    v_cmp_eq_u32 vcc, 3, v11
    s_nop 1
    v_cndmask_b32 v147, 0, v10, vcc
    v_add_f32_dpp v9, v9, v9 row_ror:8 row_mask:0xf bank_mask:0xf
    v_mov_b32 v10, v9
    s_nop 1
    v_permlane16_swap_b32 v9, v10
    v_add_f32 v9, v9, v10
    v_mov_b32 v10, v9
    s_nop 1
    v_permlane32_swap_b32 v9, v10
    s_waitcnt vmcnt(3)
    buffer_load_dwordx4 v[52:55], v1, s[40:43], s49 offen offset:1024 nt
    v_add_f32 v9, v9, v10
    s_lshl_b32 s34, s3, 3
    s_add_u32 s34, s34, 98552
    v_mov_b32 v10, s34
    s_mov_b64 exec, 1
    ds_write_b64 v10, v[8:9]
    s_mov_b64 exec, -1
    s_lshl_b32 s34, s3, 10
    s_add_u32 s34, s34, 98304
    v_lshrrev_b32 v2, 4, v0
    v_and_b32 v11, 7, v0
    v_lshl_add_u32 v2, v2, 3, v11
    v_bfe_u32 v11, v0, 3, 1
    v_lshl_add_u32 v2, v11, 5, v2
    v_lshl_add_u32 v2, v2, 4, s34
    v_cvt_pk_bf16_f32 v10, v12, v12
    v_and_b32 v128, v10, v144
    v_and_b32 v129, v10, v145
    v_and_b32 v130, v10, v146
    v_and_b32 v131, v10, v147
    s_nop 1
    v_mfma_f32_16x16x32_bf16 v[148:151], v[160:163], v[128:131], 0
    v_mfma_f32_16x16x32_bf16 v[152:155], v[164:167], v[128:131], 0
    v_cvt_pk_bf16_f32 v10, v13, v13
    v_and_b32 v132, v10, v144
    v_and_b32 v133, v10, v145
    v_and_b32 v134, v10, v146
    v_and_b32 v135, v10, v147
    s_nop 1
    v_mfma_f32_16x16x32_bf16 v[148:151], v[168:171], v[132:135], v[148:151]
    v_mfma_f32_16x16x32_bf16 v[152:155], v[172:175], v[132:135], v[152:155]
    v_cvt_pk_bf16_f32 v10, v16, v16
    v_and_b32 v128, v10, v144
    v_and_b32 v129, v10, v145
    v_and_b32 v130, v10, v146
    v_and_b32 v131, v10, v147
    s_nop 1
    v_mfma_f32_16x16x32_bf16 v[148:151], v[176:179], v[128:131], v[148:151]
    v_mfma_f32_16x16x32_bf16 v[152:155], v[180:183], v[128:131], v[152:155]
    v_cvt_pk_bf16_f32 v10, v17, v17
    v_and_b32 v132, v10, v144
    s_waitcnt vmcnt(3)
    buffer_load_dwordx4 v[56:59], v1, s[40:43], s49 offen offset:2048 nt
    v_and_b32 v133, v10, v145
    v_and_b32 v134, v10, v146
    v_and_b32 v135, v10, v147
    s_nop 1
    v_mfma_f32_16x16x32_bf16 v[148:151], v[184:187], v[132:135], v[148:151]
    v_mfma_f32_16x16x32_bf16 v[152:155], v[188:191], v[132:135], v[152:155]
    v_cvt_pk_bf16_f32 v10, v18, v18
    v_and_b32 v128, v10, v144
    v_and_b32 v129, v10, v145
    v_and_b32 v130, v10, v146
    v_and_b32 v131, v10, v147
    s_nop 1
    v_mfma_f32_16x16x32_bf16 v[148:151], v[192:195], v[128:131], v[148:151]
    v_mfma_f32_16x16x32_bf16 v[152:155], v[196:199], v[128:131], v[152:155]
    v_cvt_pk_bf16_f32 v10, v19, v19
    v_and_b32 v132, v10, v144
    v_and_b32 v133, v10, v145
    v_and_b32 v134, v10, v146
    v_and_b32 v135, v10, v147
    s_nop 1
    v_mfma_f32_16x16x32_bf16 v[148:151], v[200:203], v[132:135], v[148:151]
    v_mfma_f32_16x16x32_bf16 v[152:155], v[204:207], v[132:135], v[152:155]
    v_cvt_pk_bf16_f32 v10, v20, v20
    v_and_b32 v128, v10, v144
    v_and_b32 v129, v10, v145
    v_and_b32 v130, v10, v146
    v_and_b32 v131, v10, v147
    s_nop 1
    v_mfma_f32_16x16x32_bf16 v[148:151], v[208:211], v[128:131], v[148:151]
    v_mfma_f32_16x16x32_bf16 v[152:155], v[212:215], v[128:131], v[152:155]
    v_cvt_pk_bf16_f32 v10, v21, v21
    v_and_b32 v132, v10, v144
    v_and_b32 v133, v10, v145
    v_and_b32 v134, v10, v146
    v_and_b32 v135, v10, v147
    s_nop 1
    v_mfma_f32_16x16x32_bf16 v[148:151], v[216:219], v[132:135], v[148:151]
    v_mfma_f32_16x16x32_bf16 v[152:155], v[220:223], v[132:135], v[152:155]
    v_cvt_pk_bf16_f32 v10, v22, v22
    v_and_b32 v128, v10, v144
    v_and_b32 v129, v10, v145
    s_waitcnt vmcnt(3)
    buffer_load_dwordx4 v[60:63], v1, s[40:43], s49 offen offset:3072 nt
    v_and_b32 v130, v10, v146
    v_and_b32 v131, v10, v147
    s_nop 1
    v_mfma_f32_16x16x32_bf16 v[148:151], v[224:227], v[128:131], v[148:151]
    v_mfma_f32_16x16x32_bf16 v[152:155], v[228:231], v[128:131], v[152:155]
    v_cvt_pk_bf16_f32 v10, v23, v23
    v_and_b32 v132, v10, v144
    v_and_b32 v133, v10, v145
    v_and_b32 v134, v10, v146
    v_and_b32 v135, v10, v147
    s_nop 1
    v_mfma_f32_16x16x32_bf16 v[148:151], v[232:235], v[132:135], v[148:151]
    v_mfma_f32_16x16x32_bf16 v[152:155], v[236:239], v[132:135], v[152:155]
    v_cvt_pk_bf16_f32 v10, v24, v24
    v_and_b32 v128, v10, v144
    v_and_b32 v129, v10, v145
    v_and_b32 v130, v10, v146
    v_and_b32 v131, v10, v147
    s_nop 1
    v_mfma_f32_16x16x32_bf16 v[148:151], v[240:243], v[128:131], v[148:151]
    v_mfma_f32_16x16x32_bf16 v[152:155], v[244:247], v[128:131], v[152:155]
    v_cvt_pk_bf16_f32 v10, v25, v25
    v_and_b32 v132, v10, v144
    v_and_b32 v133, v10, v145
    v_and_b32 v134, v10, v146
    v_and_b32 v135, v10, v147
    s_nop 1
    v_mfma_f32_16x16x32_bf16 v[148:151], v[248:251], v[132:135], v[148:151]
    v_mfma_f32_16x16x32_bf16 v[152:155], v[252:255], v[132:135], v[152:155]
    v_cvt_pk_bf16_f32 v10, v26, v26
    v_and_b32 v128, v10, v144
    v_and_b32 v129, v10, v145
    v_and_b32 v130, v10, v146
    v_and_b32 v131, v10, v147
    s_nop 1
    v_mfma_f32_16x16x32_bf16 v[148:151], v[32:35], v[128:131], v[148:151]
    v_mfma_f32_16x16x32_bf16 v[152:155], v[36:39], v[128:131], v[152:155]
    v_cvt_pk_bf16_f32 v10, v27, v27
    v_and_b32 v132, v10, v144
    v_and_b32 v133, v10, v145
    v_and_b32 v134, v10, v146
    s_waitcnt vmcnt(3)
    s_mov_b32 s49, 229376
    buffer_load_dwordx4 v[64:67], v1, s[40:43], s49 offen offset:0 nt
    v_and_b32 v135, v10, v147
    s_nop 1
    v_mfma_f32_16x16x32_bf16 v[148:151], v[40:43], v[132:135], v[148:151]
    v_mfma_f32_16x16x32_bf16 v[152:155], v[44:47], v[132:135], v[152:155]
    v_cvt_pk_bf16_f32 v10, v28, v28
    v_and_b32 v128, v10, v144
    v_and_b32 v129, v10, v145
    v_and_b32 v130, v10, v146
    v_and_b32 v131, v10, v147
    s_waitcnt vmcnt(3)
    buffer_load_dwordx4 v[68:71], v1, s[40:43], s49 offen offset:1024 nt
    v_mfma_f32_16x16x32_bf16 v[148:151], v[48:51], v[128:131], v[148:151]
    v_mfma_f32_16x16x32_bf16 v[152:155], v[52:55], v[128:131], v[152:155]
    v_cvt_pk_bf16_f32 v10, v29, v29
    v_and_b32 v132, v10, v144
    v_and_b32 v133, v10, v145
    v_and_b32 v134, v10, v146
    v_and_b32 v135, v10, v147
    s_waitcnt vmcnt(3)
    buffer_load_dwordx4 v[72:75], v1, s[40:43], s49 offen offset:2048 nt
    s_waitcnt vmcnt(3)
    buffer_load_dwordx4 v[76:79], v1, s[40:43], s49 offen offset:3072 nt
    s_barrier
    v_and_b32 v200, 3, v0
    v_bfe_u32 v201, v0, 2, 2
    v_lshrrev_b32 v202, 4, v0
    s_lshl_b32 s34, s3, 10
    s_add_u32 s34, s34, 122112
    v_mul_u32_u24 v203, 320, v201
    v_min_u32 v203, 704, v203
    v_lshl_add_u32 v203, v202, 6, v203
    v_lshl_add_u32 v203, v200, 4, v203
    v_add_u32 v203, s34, v203
    s_movk_i32 s48, 16384
    s_cmp_eq_u32 s63, 0
    s_cbranch_scc1 L_tp_wo
    s_cmp_eq_u32 s63, 1
    s_cbranch_scc1 L_tp_w1
    v_bfe_u32 v205, v0, 3, 2
    v_lshlrev_b32 v204, 3, v205
    v_lshrrev_b32 v205, 5, v0
    v_lshl_add_u32 v204, v205, 2, v204
    v_bfe_u32 v205, v0, 1, 2
    v_add_u32 v204, v204, v205
    v_and_b32 v205, 1, v0
    s_sub_u32 s49, s3, 1
    v_mul_u32_u24 v204, 1280, v204
    v_lshl_add_u32 v204, v205, 4, v204
    s_lshl_b32 s34, s62, 5
    s_mul_i32 s35, s49, 327680
    s_add_u32 s34, s34, s35
    v_add_u32 v204, s34, v204
    s_lshl_b32 s50, s49, 13
    s_add_u32 s50, s50, 40960
    v_lshl_add_u32 v205, v0, 3, s50
    s_lshl_b32 s34, s49, 8
    s_add_u32 s34, s34, s99
    s_add_u32 s34, s34, 103424
    s_cmp_eq_u32 s49, 6
    s_cselect_b32 s35, 1, 3
    v_lshlrev_b32 v6, 6, v202
    v_lshl_add_u32 v6, v200, 4, v6
    v_add_u32 v6, s34, v6
    v_lshl_add_u32 v4, v201, 18, v6
    v_min_u32 v5, s35, v201
    v_lshl_add_u32 v5, v5, 18, v6
    v_mov_b32 v7, 99084
    s_lshl_b32 s40, s62, 1
    s_add_u32 s41, s40, 8
    s_add_u32 s42, s40, 2
    s_branch L_tp_e
L_tp_w1:
    v_and_b32 v205, 15, v0
    v_lshlrev_b32 v205, 4, v205
    s_and_b32 s49, s3, 3
    s_mul_i32 s34, s49, 1280
    s_add_u32 s34, s34, s99
    s_add_u32 s34, s34, 98304
    v_lshl_add_u32 v206, v202, 18, v205
    v_add_u32 v206, s34, v206
    s_mul_i32 s34, s49, 3840
    v_add_u32 v205, s34, v205
    s_branch L_tp_e
L_tp_wo:
    s_lshr_b32 s49, s3, 1
    s_lshl_b32 s49, s49, 18
    v_and_b32 v210, 7, v0
    s_mul_i32 s34, s60, 4096
    s_add_u32 s34, s34, s49
    s_add_u32 s34, s34, 147712
    v_lshrrev_b32 v211, 3, v0
    v_mul_u32_u24 v205, 512, v211
    v_add_u32 v204, s34, v205
    s_lshl_b32 s35, s51, 7
    s_add_u32 s34, s34, s35
    s_sub_u32 s34, s34, 256
    v_lshl_add_u32 v205, v210, 4, v205
    v_add_u32 v205, s34, v205
    s_lshl_b32 s34, s3, 12
    s_add_u32 s34, s34, 40960
    v_lshrrev_b32 v206, 2, v0
    v_lshlrev_b32 v206, 6, v206
    v_lshl_add_u32 v206, v200, 3, v206
    v_add_u32 v206, s34, v206
    s_mul_i32 s34, s3, 1152
    s_add_u32 s34, s34, 107520
    v_mul_u32_u24 v207, 144, v211
    v_lshl_add_u32 v207, v210, 4, v207
    v_add_u32 v207, s34, v207
    v_mul_u32_u24 v208, 144, v210
    v_lshl_add_u32 v208, v202, 4, v208
    v_add_u32 v208, s34, v208
    v_mul_u32_u24 v212, 144, v211
    v_add_u32 v212, s34, v212
    v_mul_u32_u24 v213, 144, v210
    v_add_u32 v213, s34, v213
    v_and_b32 v211, 1, v211
    v_bfe_u32 v203, v0, 1, 2
    v_mul_u32_u24 v203, 144, v203
    v_and_b32 v214, 1, v0
    v_mul_u32_u24 v214, 576, v214
    v_lshl_add_u32 v214, v211, 6, v214
    v_lshl_add_u32 v214, v202, 4, v214
    s_add_u32 s34, s34, 14592
    v_add3_u32 v203, v203, v214, s34
    v_mov_b32 v210, 98816
    v_cmp_eq_u32 vcc, 0, v211
    s_nop 1
    v_cndmask_b32 v209, v208, v210, vcc
    v_cndmask_b32 v208, v210, v208, vcc
L_tp_e:
    v_mfma_f32_16x16x32_bf16 v[148:151], v[56:59], v[132:135], v[148:151]
    v_mfma_f32_16x16x32_bf16 v[152:155], v[60:63], v[132:135], v[152:155]
    v_cvt_pk_bf16_f32 v10, v30, v30
    v_and_b32 v128, v10, v144
    v_and_b32 v129, v10, v145
    v_and_b32 v130, v10, v146
    v_and_b32 v131, v10, v147
    s_waitcnt vmcnt(2)
    s_nop 0
    v_mfma_f32_16x16x32_bf16 v[148:151], v[64:67], v[128:131], v[148:151]
    v_mfma_f32_16x16x32_bf16 v[152:155], v[68:71], v[128:131], v[152:155]
    v_cvt_pk_bf16_f32 v10, v31, v31
    v_and_b32 v132, v10, v144
    v_and_b32 v133, v10, v145
    v_and_b32 v134, v10, v146
    v_and_b32 v135, v10, v147
    s_waitcnt vmcnt(0)
    s_nop 0
    v_mfma_f32_16x16x32_bf16 v[148:151], v[72:75], v[132:135], v[148:151]
    v_mfma_f32_16x16x32_bf16 v[152:155], v[76:79], v[132:135], v[152:155]
    s_nop 7
    v_add_f32_dpp v148, v152, v148 row_ror:8 row_mask:0xf bank_mask:0xf
    v_add_f32_dpp v149, v153, v149 row_ror:8 row_mask:0xf bank_mask:0xf
    v_add_f32_dpp v150, v154, v150 row_ror:8 row_mask:0xf bank_mask:0xf
    v_add_f32_dpp v151, v155, v151 row_ror:8 row_mask:0xf bank_mask:0xf
    ds_write_b128 v2, v[148:151]
    s_waitcnt lgkmcnt(0)
    s_barrier
    s_cmp_eq_u32 s63, 0
    s_cbranch_scc1 L_t_wo
    s_cmp_eq_u32 s63, 2
    s_cbranch_scc1 L_t_w2
    s_cmp_eq_u32 s63, 3
    s_cbranch_scc1 L_fin
    s_barrier
L_r_w1:
    s_cmp_lt_u32 s3, 4
    s_cbranch_scc1 L_w1_ln
    s_and_b32 s49, s3, 3
    s_lshl_b32 s42, s49, 11
    s_add_u32 s42, s42, 40960
    s_bitcmp1_b32 s62, 0
    s_cbranch_scc1 L_rot1
    s_add_u32 m0, s42, 0
    s_add_u32 s34, s50, 0
    buffer_load_dwordx4 v15, s[52:55], s34 offen  lds
    s_add_u32 m0, s42, 1024
    s_add_u32 s34, s50, 884736
    buffer_load_dwordx4 v15, s[52:55], s34 offen  lds
    s_add_u32 m0, s42, 8192
    s_add_u32 s34, s50, 110592
    buffer_load_dwordx4 v15, s[52:55], s34 offen  lds
    s_add_u32 m0, s42, 9216
    s_add_u32 s34, s50, 995328
    buffer_load_dwordx4 v15, s[52:55], s34 offen  lds
    s_add_u32 m0, s42, 32768
    s_add_u32 s34, s51, 0
    buffer_load_dwordx4 v15, s[52:55], s34 offen  lds
    s_add_u32 m0, s42, 33792
    s_add_u32 s34, s51, 13824
    buffer_load_dwordx4 v15, s[52:55], s34 offen  lds
    s_add_u32 m0, s42, 16384
    s_add_u32 s34, s50, 221184
    buffer_load_dwordx4 v15, s[52:55], s34 offen  lds
    s_add_u32 m0, s42, 17408
    s_add_u32 s34, s50, 1105920
    buffer_load_dwordx4 v15, s[52:55], s34 offen  lds
    s_add_u32 m0, s42, 24576
    s_add_u32 s34, s50, 331776
    buffer_load_dwordx4 v15, s[52:55], s34 offen  lds
    s_add_u32 m0, s42, 25600
    s_add_u32 s34, s50, 1216512
    buffer_load_dwordx4 v15, s[52:55], s34 offen  lds
    s_branch L_rot2
L_rot1:
    s_add_u32 m0, s42, 16384
    s_add_u32 s34, s50, 221184
    buffer_load_dwordx4 v15, s[52:55], s34 offen  lds
    s_add_u32 m0, s42, 17408
    s_add_u32 s34, s50, 1105920
    buffer_load_dwordx4 v15, s[52:55], s34 offen  lds
    s_add_u32 m0, s42, 24576
    s_add_u32 s34, s50, 331776
    buffer_load_dwordx4 v15, s[52:55], s34 offen  lds
    s_add_u32 m0, s42, 25600
    s_add_u32 s34, s50, 1216512
    buffer_load_dwordx4 v15, s[52:55], s34 offen  lds
    s_add_u32 m0, s42, 32768
    s_add_u32 s34, s51, 0
    buffer_load_dwordx4 v15, s[52:55], s34 offen  lds
    s_add_u32 m0, s42, 33792
    s_add_u32 s34, s51, 13824
    buffer_load_dwordx4 v15, s[52:55], s34 offen  lds
    s_add_u32 m0, s42, 0
    s_add_u32 s34, s50, 0
    buffer_load_dwordx4 v15, s[52:55], s34 offen  lds
    s_add_u32 m0, s42, 1024
    s_add_u32 s34, s50, 884736
    buffer_load_dwordx4 v15, s[52:55], s34 offen  lds
    s_add_u32 m0, s42, 8192
    s_add_u32 s34, s50, 110592
    buffer_load_dwordx4 v15, s[52:55], s34 offen  lds
    s_add_u32 m0, s42, 9216
    s_add_u32 s34, s50, 995328
    buffer_load_dwordx4 v15, s[52:55], s34 offen  lds
L_rot2:
    v_lshrrev_b32 v3, 2, v0
    v_lshlrev_b32 v3, 6, v3
    v_lshl_add_u32 v3, v200, 3, v3
    v_add_u32 v3, s42, v3
    s_lshl_b32 s35, s49, 6
    s_add_u32 s35, s35, 116736
    v_mul_u32_u24 v4, 1344, v200
    v_lshl_add_u32 v4, v202, 4, v4
    v_add_u32 v4, s35, v4
    s_lshl_b32 s35, s49, 10
    s_sub_u32 s35, s35, 4096
    v_add_u32 v5, s35, v203
    v_and_b32 v6, 1, v201
    v_mul_u32_u24 v6, 5376, v6
    v_add_u32 v6, v6, v4
    v_subrev_u32 v6, 90112, v6
    v_subrev_u32 v7, 22784, v5
    s_waitcnt vmcnt(0)
    s_barrier
    ds_read_b64_tr_b16 v[32:33], v3 offset:0
    ds_read_b64_tr_b16 v[34:35], v3 offset:1024
    ds_read_b64_tr_b16 v[36:37], v3 offset:32
    ds_read_b64_tr_b16 v[38:39], v3 offset:1056
    ds_read_b64_tr_b16 v[40:41], v3 offset:8192
    ds_read_b64_tr_b16 v[42:43], v3 offset:9216
    ds_read_b64_tr_b16 v[44:45], v3 offset:8224
    ds_read_b64_tr_b16 v[46:47], v3 offset:9248
    ds_read_b64_tr_b16 v[48:49], v3 offset:16384
    ds_read_b64_tr_b16 v[50:51], v3 offset:17408
    ds_read_b64_tr_b16 v[52:53], v3 offset:16416
    ds_read_b64_tr_b16 v[54:55], v3 offset:17440
    s_waitcnt lgkmcnt(4)
    ds_read_b64_tr_b16 v[56:57], v3 offset:24576
    ds_read_b64_tr_b16 v[58:59], v3 offset:25600
    ds_read_b64_tr_b16 v[60:61], v3 offset:24608
    ds_read_b64_tr_b16 v[62:63], v3 offset:25632
    ds_read_b64_tr_b16 v[64:65], v3 offset:32768
    ds_read_b64_tr_b16 v[66:67], v3 offset:33792
    ds_read_b64_tr_b16 v[68:69], v3 offset:32800
    ds_read_b64_tr_b16 v[70:71], v3 offset:33824
    s_waitcnt lgkmcnt(0)
    ds_read_b128 v[140:143], v6 offset:0
    ds_read_b128 v[144:147], v6 offset:256
    ds_read_b128 v[148:151], v6 offset:512
    ds_read_b128 v[152:155], v6 offset:768
    ds_read_b128 v[156:159], v6 offset:1024
    s_waitcnt lgkmcnt(4)
    v_mfma_f32_16x16x32_bf16 v[20:23], v[32:35], v[140:143], 0
    v_mfma_f32_16x16x32_bf16 v[24:27], v[36:39], v[140:143], 0
    s_waitcnt lgkmcnt(3)
    v_mfma_f32_16x16x32_bf16 v[20:23], v[40:43], v[144:147], v[20:23]
    v_mfma_f32_16x16x32_bf16 v[24:27], v[44:47], v[144:147], v[24:27]
    s_waitcnt lgkmcnt(2)
    v_mfma_f32_16x16x32_bf16 v[20:23], v[48:51], v[148:151], v[20:23]
    v_mfma_f32_16x16x32_bf16 v[24:27], v[52:55], v[148:151], v[24:27]
    s_waitcnt lgkmcnt(1)
    v_mfma_f32_16x16x32_bf16 v[20:23], v[56:59], v[152:155], v[20:23]
    v_mfma_f32_16x16x32_bf16 v[24:27], v[60:63], v[152:155], v[24:27]
    s_waitcnt lgkmcnt(0)
    v_mfma_f32_16x16x32_bf16 v[20:23], v[64:67], v[156:159], v[20:23]
    v_mfma_f32_16x16x32_bf16 v[24:27], v[68:71], v[156:159], v[24:27]
    s_nop 6
    ds_write_b128 v7, v[20:23]
    ds_write_b128 v7, v[24:27] offset:1024
    s_waitcnt lgkmcnt(0)
    s_setprio 3
    s_barrier
    ds_read_b128 v[140:143], v4 offset:0
    ds_read_b128 v[144:147], v4 offset:256
    ds_read_b128 v[148:151], v4 offset:512
    ds_read_b128 v[152:155], v4 offset:768
    ds_read_b128 v[156:159], v4 offset:1024
    s_waitcnt lgkmcnt(4)
    v_mfma_f32_16x16x32_bf16 v[20:23], v[32:35], v[140:143], 0
    v_mfma_f32_16x16x32_bf16 v[24:27], v[36:39], v[140:143], 0
    s_waitcnt lgkmcnt(3)
    v_mfma_f32_16x16x32_bf16 v[20:23], v[40:43], v[144:147], v[20:23]
    v_mfma_f32_16x16x32_bf16 v[24:27], v[44:47], v[144:147], v[24:27]
    s_waitcnt lgkmcnt(2)
    v_mfma_f32_16x16x32_bf16 v[20:23], v[48:51], v[148:151], v[20:23]
    v_mfma_f32_16x16x32_bf16 v[24:27], v[52:55], v[148:151], v[24:27]
    s_waitcnt lgkmcnt(1)
    v_mfma_f32_16x16x32_bf16 v[20:23], v[56:59], v[152:155], v[20:23]
    v_mfma_f32_16x16x32_bf16 v[24:27], v[60:63], v[152:155], v[24:27]
    s_waitcnt lgkmcnt(0)
    v_mfma_f32_16x16x32_bf16 v[20:23], v[64:67], v[156:159], v[20:23]
    v_mfma_f32_16x16x32_bf16 v[24:27], v[68:71], v[156:159], v[24:27]
    s_nop 6
    ds_write_b128 v5, v[20:23]
    ds_write_b128 v5, v[24:27] offset:1024
    s_waitcnt lgkmcnt(0)
    s_barrier
    s_branch L_fin
L_w1_ln:
    s_setprio 1
    ds_read_b128 v[140:143], v205 offset:0
    ds_read_b128 v[144:147], v205 offset:256
    ds_read_b128 v[148:151], v205 offset:512
    ds_read_b128 v[152:155], v205 offset:768
    ds_read_b128 v[156:159], v205 offset:1024
    ds_read_b128 v[160:163], v205 offset:1280
    ds_read_b128 v[164:167], v205 offset:1536
    ds_read_b128 v[168:171], v205 offset:1792
    ds_read_b128 v[172:175], v205 offset:2048
    ds_read_b128 v[176:179], v205 offset:2304
    ds_read_b128 v[180:183], v205 offset:2560
    ds_read_b128 v[184:187], v205 offset:2816
    ds_read_b128 v[188:191], v205 offset:3072
    ds_read_b128 v[192:195], v205 offset:3328
    ds_read_b128 v[196:199], v205 offset:3584
    v_and_b32 v8, 1, v0
    v_lshlrev_b32 v8, 4, v8
    v_mov_b32 v9, 0xffff
    v_lshlrev_b32 v8, v8, v9
    v_bfe_u32 v9, v0, 1, 2
    v_cmp_eq_u32 vcc, 0, v9
    s_nop 1
    v_cndmask_b32 v16, 0, v8, vcc
    v_cmp_eq_u32 vcc, 1, v9
    s_nop 1
    v_cndmask_b32 v17, 0, v8, vcc
    v_cmp_eq_u32 vcc, 2, v9
    s_nop 1
    v_cndmask_b32 v18, 0, v8, vcc
    v_cmp_eq_u32 vcc, 3, v9
    s_nop 1
    v_cndmask_b32 v19, 0, v8, vcc
    v_bfe_u32 v8, v0, 3, 1
    v_cmp_eq_u32 vcc, 0, v8
    s_nop 1
    v_cndmask_b32 v20, 0, v16, vcc
    v_xor_b32 v24, v20, v16
    v_cndmask_b32 v21, 0, v17, vcc
    v_xor_b32 v25, v21, v17
    v_cndmask_b32 v22, 0, v18, vcc
    v_xor_b32 v26, v22, v18
    v_cndmask_b32 v23, 0, v19, vcc
    v_xor_b32 v27, v23, v19
    v_and_b32 v52, 0x3f803f80, v20
    v_and_b32 v60, 0x3e803e80, v20
    v_and_b32 v53, 0x3f803f80, v21
    v_and_b32 v61, 0x3e803e80, v21
    v_and_b32 v54, 0x3f803f80, v22
    v_and_b32 v62, 0x3e803e80, v22
    v_and_b32 v55, 0x3f803f80, v23
    v_and_b32 v63, 0x3e803e80, v23
    v_and_b32 v56, 0x3f803f80, v24
    v_and_b32 v64, 0x3e803e80, v24
    v_and_b32 v57, 0x3f803f80, v25
    v_and_b32 v65, 0x3e803e80, v25
    v_and_b32 v58, 0x3f803f80, v26
    v_and_b32 v66, 0x3e803e80, v26
    v_and_b32 v59, 0x3f803f80, v27
    v_and_b32 v67, 0x3e803e80, v27
    s_waitcnt lgkmcnt(0)
    v_mfma_f32_16x16x32_bf16 v[68:71], v[140:143], v[60:63], 0
    v_mfma_f32_16x16x32_bf16 v[68:71], v[144:147], v[64:67], v[68:71]
    v_mfma_f32_16x16x32_bf16 v[72:75], v[148:151], v[60:63], 0
    v_mfma_f32_16x16x32_bf16 v[72:75], v[152:155], v[64:67], v[72:75]
    v_mfma_f32_16x16x32_bf16 v[76:79], v[156:159], v[60:63], 0
    v_mfma_f32_16x16x32_bf16 v[116:119], v[160:163], v[60:63], 0
    v_mfma_f32_16x16x32_bf16 v[116:119], v[164:167], v[64:67], v[116:119]
    v_mfma_f32_16x16x32_bf16 v[120:123], v[168:171], v[60:63], 0
    v_mfma_f32_16x16x32_bf16 v[120:123], v[172:175], v[64:67], v[120:123]
    v_mfma_f32_16x16x32_bf16 v[124:127], v[176:179], v[60:63], 0
    v_mfma_f32_16x16x32_bf16 v[80:83], v[180:183], v[60:63], 1.0
    v_mfma_f32_16x16x32_bf16 v[80:83], v[184:187], v[64:67], v[80:83]
    v_mfma_f32_16x16x32_bf16 v[84:87], v[188:191], v[60:63], 1.0
    v_mfma_f32_16x16x32_bf16 v[84:87], v[192:195], v[64:67], v[84:87]
    v_mfma_f32_16x16x32_bf16 v[88:91], v[196:199], v[60:63], 1.0
    s_mul_i32 s34, s3, 1344
    s_add_u32 s34, s34, 116736
    v_lshl_add_u32 v7, v0, 4, s34
    v_lshlrev_b32 v8, 6, v202
    v_lshl_add_u32 v8, v200, 4, v8
    v_and_b32 v9, 1, v201
    v_lshl_add_u32 v8, v9, 3, v8
    v_add_u32 v8, s34, v8
    v_bfe_u32 v9, v0, 3, 1
    v_mul_u32_u24 v9, 6144, v9
    v_sub_u32 v8, v8, v9
    v_lshrrev_b32 v9, 5, v0
    v_lshlrev_b32 v9, 10, v9
    v_and_b32 v6, 1, v202
    v_lshl_add_u32 v9, v6, 7, v9
    v_bfe_u32 v6, v0, 1, 1
    v_lshl_add_u32 v9, v6, 6, v9
    v_lshl_add_u32 v9, v201, 4, v9
    v_and_b32 v6, 1, v0
    v_lshl_add_u32 v9, v6, 3, v9
    v_add_u32 v9, 122112, v9
    s_lshr_b32 s34, s62, 3
    s_lshl_b32 s34, s34, 8
    s_and_b32 s49, s62, 3
    s_lshl_b32 s49, s49, 18
    s_add_u32 s34, s34, s49
    s_bfe_u32 s49, s62, 0x10002
    s_lshl_b32 s49, s49, 14
    s_add_u32 s34, s34, s49
    s_add_u32 s34, s34, 103424
    v_lshl_add_u32 v5, v0, 2, s34
    s_bfe_u32 s49, s60, 0x10002
    s_lshl_b32 s49, s49, 13
    s_xor_b32 s53, s99, s49
    s_xor_b32 s52, s53, 8192
    v_subrev_u32 v10, 90112, v7
    v_subrev_u32 v11, 90112, v8
    v_cvt_pk_bf16_f32 v32, v116, v117
    v_cvt_pk_bf16_f32 v33, v118, v119
    v_cvt_pk_bf16_f32 v34, v120, v121
    v_cvt_pk_bf16_f32 v35, v122, v123
    v_cvt_pk_bf16_f32 v36, v124, v125
    v_cvt_pk_bf16_f32 v37, v126, v127
    s_mov_b32 exec_lo, 0x00ff00ff
    s_mov_b32 exec_hi, 0x00ff00ff
    ds_write_b64 v11, v[36:37] offset:6400
    s_mov_b64 exec, -1
    ds_write_b128 v10, v[32:35] offset:5376
    v_cvt_pk_bf16_f32 v20, v80, v81
    v_cvt_pk_bf16_f32 v21, v82, v83
    v_cvt_pk_bf16_f32 v22, v84, v85
    v_cvt_pk_bf16_f32 v23, v86, v87
    v_cvt_pk_bf16_f32 v24, v88, v89
    v_cvt_pk_bf16_f32 v25, v90, v91
    ds_write_b128 v10, v[20:23]
    ds_write_b64 v11, v[24:25] offset:1024
    v_lshlrev_b32 v80, 16, v20
    v_and_b32 v81, 0xffff0000, v20
    v_lshlrev_b32 v82, 16, v21
    v_and_b32 v83, 0xffff0000, v21
    v_lshlrev_b32 v84, 16, v22
    v_and_b32 v85, 0xffff0000, v22
    v_lshlrev_b32 v86, 16, v23
    v_and_b32 v87, 0xffff0000, v23
    v_lshlrev_b32 v88, 16, v24
    v_and_b32 v89, 0xffff0000, v24
    v_lshlrev_b32 v90, 16, v25
    v_and_b32 v91, 0xffff0000, v25
    v_subrev_u32 v11, 22784, v9
    s_lshl_b32 s34, s3, 3
    s_add_u32 s34, s34, 99136
    v_mov_b32 v12, s34
    v_lshlrev_b32 v13, 3, v201
    v_add_u32 v13, 99136, v13
    s_mov_b32 s54, 0
    s_brev_b32 s55, 1
    s_waitcnt lgkmcnt(0)
    s_barrier
    s_mov_b32 s35, 0
    s_mov_b64 s[40:41], -1
    s_mov_b64 s[42:43], -1
L_pb:
    s_mov_b64 exec, s[40:41]
    s_cbranch_execz L_pbs0
    buffer_load_dwordx4 v[140:143], v206, s[44:47], 0 offen offset:0 sc1
    buffer_load_dwordx4 v[148:151], v206, s[44:47], 0 offen offset:256 sc1
    buffer_load_dwordx4 v[156:159], v206, s[44:47], 0 offen offset:512 sc1
    buffer_load_dwordx4 v[164:167], v206, s[44:47], 0 offen offset:768 sc1
    buffer_load_dwordx4 v[172:175], v206, s[44:47], 0 offen offset:1024 sc1
L_pbs0:
    s_mov_b64 exec, s[42:43]
    s_cbranch_execz L_pbs1
    buffer_load_dwordx4 v[144:147], v206, s[44:47], s48 offen offset:0 sc1
    buffer_load_dwordx4 v[152:155], v206, s[44:47], s48 offen offset:256 sc1
    buffer_load_dwordx4 v[160:163], v206, s[44:47], s48 offen offset:512 sc1
    buffer_load_dwordx4 v[168:171], v206, s[44:47], s48 offen offset:768 sc1
    buffer_load_dwordx4 v[176:179], v206, s[44:47], s48 offen offset:1024 sc1
L_pbs1:
    s_mov_b64 exec, -1
    s_add_u32 s35, s35, 1
    s_waitcnt vmcnt(0)
    v_mfma_f32_16x16x32_bf16 v[128:131], v[140:143], v[52:55], v[68:71]
    v_max3_u32 v28, v140, v141, v142
    v_max3_u32 v29, v144, v145, v146
    v_mfma_f32_16x16x32_bf16 v[128:131], v[144:147], v[52:55], v[128:131]
    v_max3_u32 v28, v28, v143, v148
    v_max3_u32 v29, v29, v147, v152
    v_mfma_f32_16x16x32_bf16 v[128:131], v[148:151], v[56:59], v[128:131]
    v_max3_u32 v28, v28, v149, v150
    v_max3_u32 v29, v29, v153, v154
    v_mfma_f32_16x16x32_bf16 v[128:131], v[152:155], v[56:59], v[128:131]
    v_max3_u32 v28, v28, v151, v156
    v_max3_u32 v29, v29, v155, v160
    v_mfma_f32_16x16x32_bf16 v[132:135], v[156:159], v[52:55], v[72:75]
    v_max3_u32 v28, v28, v157, v158
    v_max3_u32 v29, v29, v161, v162
    v_mfma_f32_16x16x32_bf16 v[132:135], v[160:163], v[52:55], v[132:135]
    v_max3_u32 v28, v28, v159, v164
    v_max3_u32 v29, v29, v163, v168
    v_mfma_f32_16x16x32_bf16 v[132:135], v[164:167], v[56:59], v[132:135]
    v_max3_u32 v28, v28, v165, v166
    v_max3_u32 v29, v29, v169, v170
    v_mfma_f32_16x16x32_bf16 v[132:135], v[168:171], v[56:59], v[132:135]
    v_max3_u32 v28, v28, v167, v172
    v_max3_u32 v29, v29, v171, v176
    v_mfma_f32_16x16x32_bf16 v[136:139], v[172:175], v[52:55], v[76:79]
    v_max3_u32 v28, v28, v173, v174
    v_max3_u32 v29, v29, v177, v178
    v_mfma_f32_16x16x32_bf16 v[136:139], v[176:179], v[52:55], v[136:139]
    v_max_u32 v28, v28, v175
    v_max_u32 v29, v29, v179
    v_cmp_eq_u32 s[40:41], -1, v28
    v_cmp_eq_u32 s[42:43], -1, v29
    s_nop 0
    s_or_b64 vcc, s[40:41], s[42:43]
    s_cbranch_scc0 L_pbd
    s_cmp_lg_u32 s35, 64
    s_cbranch_scc1 L_tmo52
    s_mov_b64 exec, -1
    v_lshlrev_b32 v243, 4, v0
    v_add_u32 v243, 131328, v243
    ds_read_b96 v[240:242], v243
    s_waitcnt lgkmcnt(0)
    buffer_store_dword v240, v242, s[44:47], 0 offen sc1
    buffer_store_dword v241, v242, s[44:47], 0 offen offset:256 sc1
L_tmo52:
    s_cmp_lt_u32 s35, 60000
    s_cbranch_scc1 L_pb
L_pbd:
    v_pk_mul_f32 v[32:33], v[128:129], v[80:81]
    v_pk_mul_f32 v[34:35], v[130:131], v[82:83]
    v_pk_mul_f32 v[36:37], v[132:133], v[84:85]
    v_pk_mul_f32 v[38:39], v[134:135], v[86:87]
    v_cvt_pk_bf16_f32 v24, v32, v33
    v_cvt_pk_bf16_f32 v25, v34, v35
    v_cvt_pk_bf16_f32 v26, v36, v37
    v_cvt_pk_bf16_f32 v27, v38, v39
    ds_write_b128 v7, v[24:27]
    v_pk_mul_f32 v[40:41], v[136:137], v[88:89]
    v_pk_mul_f32 v[42:43], v[138:139], v[90:91]
    v_cvt_pk_bf16_f32 v28, v40, v41
    v_cvt_pk_bf16_f32 v29, v42, v43
    ds_write_b64 v8, v[28:29] offset:1024
    v_pk_add_f32 v[20:21], v[128:129], v[130:131]
    v_pk_mul_f32 v[22:23], v[128:129], v[128:129]
    v_pk_add_f32 v[20:21], v[20:21], v[132:133]
    v_pk_fma_f32 v[22:23], v[130:131], v[130:131], v[22:23]
    v_pk_add_f32 v[20:21], v[20:21], v[134:135]
    v_pk_fma_f32 v[22:23], v[132:133], v[132:133], v[22:23]
    v_pk_add_f32 v[20:21], v[20:21], v[136:137]
    v_pk_fma_f32 v[22:23], v[134:135], v[134:135], v[22:23]
    v_pk_add_f32 v[20:21], v[20:21], v[138:139]
    v_pk_fma_f32 v[22:23], v[136:137], v[136:137], v[22:23]
    v_pk_fma_f32 v[22:23], v[138:139], v[138:139], v[22:23]
    s_waitcnt lgkmcnt(0)
    s_barrier
    v_add_f32 v20, v20, v21
    v_add_f32 v21, v22, v23
    s_nop 0
    v_add_f32_dpp v20, v20, v20 row_ror:8 row_mask:0xf bank_mask:0xf
    v_add_f32_dpp v21, v21, v21 row_ror:8 row_mask:0xf bank_mask:0xf
    s_nop 0
    v_add_f32_dpp v20, v20, v20 row_ror:4 row_mask:0xf bank_mask:0xf
    v_add_f32_dpp v21, v21, v21 row_ror:4 row_mask:0xf bank_mask:0xf
    s_nop 0
    v_add_f32_dpp v20, v20, v20 row_ror:2 row_mask:0xf bank_mask:0xf
    v_add_f32_dpp v21, v21, v21 row_ror:2 row_mask:0xf bank_mask:0xf
    s_nop 0
    v_add_f32_dpp v20, v20, v20 row_ror:1 row_mask:0xf bank_mask:0xf
    v_add_f32_dpp v21, v21, v21 row_ror:1 row_mask:0xf bank_mask:0xf
    s_nop 0
    v_add_f32_dpp v20, v20, v20 row_bcast:15 row_mask:0xa bank_mask:0xf
    v_add_f32_dpp v21, v21, v21 row_bcast:15 row_mask:0xa bank_mask:0xf
    s_nop 0
    v_add_f32_dpp v20, v20, v20 row_bcast:31 row_mask:0xc bank_mask:0xf
    v_add_f32_dpp v21, v21, v21 row_bcast:31 row_mask:0xc bank_mask:0xf
    v_mul_f32 v22, 0x3acccccd, v20
    v_mul_f32 v21, 0x3acccccd, v21
    v_fma_f32 v21, -v22, v22, v21
    v_max_f32 v21, 0, v21
    v_add_f32 v21, 0x3727c5ac, v21
    v_rsq_f32 v20, v21
    s_nop 0
    v_mul_f32_e64 v21, -v22, v20
    s_mov_b64 exec, s[54:55]
    ds_write_b64 v12, v[20:21]
    s_mov_b64 exec, -1
    s_cmp_lg_u32 s3, 0
    s_cbranch_scc1 L_w1_x
    ds_read_b64 v[32:33], v11 offset:0
    ds_read_b64 v[40:41], v11 offset:320
    ds_read_b64 v[34:35], v11 offset:2048
    ds_read_b64 v[42:43], v11 offset:2368
    ds_read_b64 v[36:37], v11 offset:4096
    ds_read_b64 v[44:45], v11 offset:4416
    ds_read_b64 v[38:39], v11 offset:6144
    ds_read_b64 v[46:47], v11 offset:6464
    s_mov_b32 s34, 0xbdd2d3e8
    v_mov_b32 v10, 0xc0135761
    s_waitcnt lgkmcnt(8)
    s_barrier
    ds_read_b64 v[28:29], v13
    ds_read_b64 v[20:21], v9 offset:0
    ds_read_b64 v[22:23], v9 offset:2048
    ds_read_b64 v[24:25], v9 offset:4096
    ds_read_b64 v[26:27], v9 offset:6144
    s_waitcnt lgkmcnt(5)
    v_pk_add_f32 v[100:101], v[100:101], v[40:41]
    v_pk_add_f32 v[100:101], v[100:101], v[42:43]
    v_pk_add_f32 v[32:33], v[32:33], v[34:35]
    v_pk_add_f32 v[100:101], v[100:101], v[44:45]
    v_pk_add_f32 v[32:33], v[32:33], v[36:37]
    v_pk_add_f32 v[100:101], v[100:101], v[46:47]
    v_pk_add_f32 v[32:33], v[32:33], v[38:39]
    s_waitcnt lgkmcnt(4)
    v_pk_fma_f32 v[100:101], v[32:33], v[28:29], v[100:101] op_sel:[0,1,0] op_sel_hi:[1,1,1]
    s_waitcnt lgkmcnt(3)
    v_pk_fma_f32 v[100:101], v[20:21], v[28:29], v[100:101] op_sel_hi:[1,0,1]
    s_waitcnt lgkmcnt(2)
    v_pk_fma_f32 v[100:101], v[22:23], v[28:29], v[100:101] op_sel_hi:[1,0,1]
    s_waitcnt lgkmcnt(1)
    v_pk_fma_f32 v[100:101], v[24:25], v[28:29], v[100:101] op_sel_hi:[1,0,1]
    s_waitcnt lgkmcnt(0)
    v_pk_fma_f32 v[100:101], v[26:27], v[28:29], v[100:101] op_sel_hi:[1,0,1]
    v_pk_mul_f32 v[20:21], v[100:101], v[100:101]
    v_fma_f32 v20, v20, s34, v10
    v_fma_f32 v21, v21, s34, v10
    v_pk_mul_f32 v[20:21], v[20:21], v[100:101]
    v_exp_f32 v20, v20
    v_exp_f32 v21, v21
    v_add_f32 v20, 1.0, v20
    v_add_f32 v21, 1.0, v21
    v_rcp_f32 v20, v20
    v_rcp_f32 v21, v21
    s_nop 0
    v_pk_mul_f32 v[20:21], v[20:21], v[100:101]
    v_cvt_pk_bf16_f32 v20, v20, v21
    v_min_u32 v20, -2, v20
    buffer_store_dword v20, v5, s[44:47], s52 offen sc1
    buffer_store_dword v20, v5, s[44:47], s53 offen sc1
    s_branch L_fin
L_w1_x:
    s_waitcnt lgkmcnt(0)
    s_barrier
    s_branch L_fin
L_t_w2:
    s_barrier
L_w2_dma:
    s_and_b32 s34, s40, 7
    s_lshl_b32 s35, s34, 10
    s_add_u32 m0, s50, s35
    s_mul_i32 s34, s34, 40960
    buffer_load_dwordx4 v204, s[52:55], s34 offen  lds
    s_add_u32 s40, s40, 1
    s_cmp_lg_u32 s40, s42
    s_cbranch_scc1 L_w2_nw
L_w2_nw:
    s_cmp_lt_u32 s40, s41
    s_cbranch_scc1 L_w2_dma
    ds_read_b32 v8, v7
    s_waitcnt lgkmcnt(0)
    v_cmp_eq_u32 vcc, 0, v8
    s_cbranch_vccnz L_w2_slow
    s_mov_b32 s35, 0
    buffer_load_dwordx4 v[64:67], v4, s[44:47], 0 offen sc1
    buffer_load_dwordx4 v[68:71], v5, s[44:47], s48 offen sc1
    s_waitcnt vmcnt(2)
    ds_read_b64_tr_b16 v[32:33], v205 offset:0
    ds_read_b64_tr_b16 v[34:35], v205 offset:512
    ds_read_b64_tr_b16 v[36:37], v205 offset:1024
    ds_read_b64_tr_b16 v[38:39], v205 offset:1536
    ds_read_b64_tr_b16 v[40:41], v205 offset:2048
    ds_read_b64_tr_b16 v[42:43], v205 offset:2560
    ds_read_b64_tr_b16 v[44:45], v205 offset:3072
    ds_read_b64_tr_b16 v[46:47], v205 offset:3584
    s_waitcnt lgkmcnt(0)
    ds_read_b64_tr_b16 v[48:49], v205 offset:4096
    ds_read_b64_tr_b16 v[50:51], v205 offset:4608
    ds_read_b64_tr_b16 v[52:53], v205 offset:5120
    ds_read_b64_tr_b16 v[54:55], v205 offset:5632
    ds_read_b64_tr_b16 v[56:57], v205 offset:6144
    ds_read_b64_tr_b16 v[58:59], v205 offset:6656
    ds_read_b64_tr_b16 v[60:61], v205 offset:7168
    ds_read_b64_tr_b16 v[62:63], v205 offset:7680
    s_waitcnt lgkmcnt(0)
    s_branch L_w2_mid
L_w2_slow:
    s_waitcnt vmcnt(0)
    ds_read_b64_tr_b16 v[32:33], v205 offset:0
    ds_read_b64_tr_b16 v[34:35], v205 offset:512
    ds_read_b64_tr_b16 v[36:37], v205 offset:1024
    ds_read_b64_tr_b16 v[38:39], v205 offset:1536
    ds_read_b64_tr_b16 v[40:41], v205 offset:2048
    ds_read_b64_tr_b16 v[42:43], v205 offset:2560
    ds_read_b64_tr_b16 v[44:45], v205 offset:3072
    ds_read_b64_tr_b16 v[46:47], v205 offset:3584
    s_waitcnt lgkmcnt(0)
    ds_read_b64_tr_b16 v[48:49], v205 offset:4096
    ds_read_b64_tr_b16 v[50:51], v205 offset:4608
    ds_read_b64_tr_b16 v[52:53], v205 offset:5120
    ds_read_b64_tr_b16 v[54:55], v205 offset:5632
    ds_read_b64_tr_b16 v[56:57], v205 offset:6144
    ds_read_b64_tr_b16 v[58:59], v205 offset:6656
    ds_read_b64_tr_b16 v[60:61], v205 offset:7168
    ds_read_b64_tr_b16 v[62:63], v205 offset:7680
    s_waitcnt lgkmcnt(0)
    s_mov_b32 s35, 0
L_poll53:
    ds_read_b32 v8, v7
    s_add_u32 s35, s35, 1
    s_waitcnt lgkmcnt(0)
    v_cmp_eq_u32 vcc, 0, v8
    s_cbranch_vccz L_done54
    s_sleep 1
    s_cmp_lt_u32 s35, 60000
    s_cbranch_scc1 L_poll53
L_done54:
    s_mov_b32 s35, 0
L_poll56:
    buffer_load_dwordx4 v[64:67], v4, s[44:47], 0 offen sc1
    buffer_load_dwordx4 v[68:71], v5, s[44:47], s48 offen sc1
L_w2_mid:
    s_add_u32 s35, s35, 1
    s_waitcnt vmcnt(0)
    v_max3_u32 v28, v64, v65, v66
    v_max3_u32 v28, v28, v67, v68
    v_max3_u32 v28, v28, v69, v70
    v_max_u32 v28, v28, v71
    v_cmp_eq_u32 vcc, -1, v28
    s_cbranch_vccz L_done57
    s_cmp_lg_u32 s35, 64
    s_cbranch_scc1 L_tmo59
    s_mov_b64 exec, -1
    v_lshlrev_b32 v243, 4, v0
    v_add_u32 v243, 131328, v243
    ds_read_b96 v[240:242], v243
    s_waitcnt lgkmcnt(0)
    buffer_store_dword v240, v242, s[44:47], 0 offen sc1
    buffer_store_dword v241, v242, s[44:47], 0 offen offset:256 sc1
L_tmo59:
    s_cmp_lt_u32 s35, 60000
    s_cbranch_scc1 L_poll56
L_done57:
    v_mfma_f32_16x16x32_bf16 v[80:83], v[32:35], v[64:67], 0
    v_mfma_f32_16x16x32_bf16 v[80:83], v[48:51], v[68:71], v[80:83]
    v_mfma_f32_16x16x32_bf16 v[84:87], v[36:39], v[64:67], 0
    v_mfma_f32_16x16x32_bf16 v[84:87], v[52:55], v[68:71], v[84:87]
    v_mfma_f32_16x16x32_bf16 v[88:91], v[40:43], v[64:67], 0
    v_mfma_f32_16x16x32_bf16 v[88:91], v[56:59], v[68:71], v[88:91]
    v_mfma_f32_16x16x32_bf16 v[92:95], v[44:47], v[64:67], 0
    v_mfma_f32_16x16x32_bf16 v[92:95], v[60:63], v[68:71], v[92:95]
    s_nop 3
    v_add_f32_dpp v80, v84, v80 row_shl:4 row_mask:0xf bank_mask:0x1
    v_add_f32_dpp v81, v85, v81 row_shl:4 row_mask:0xf bank_mask:0x1
    v_add_f32_dpp v82, v86, v82 row_shl:4 row_mask:0xf bank_mask:0x1
    v_add_f32_dpp v83, v87, v83 row_shl:4 row_mask:0xf bank_mask:0x1
    v_add_f32_dpp v80, v88, v80 row_shl:8 row_mask:0xf bank_mask:0x1
    v_add_f32_dpp v81, v89, v81 row_shl:8 row_mask:0xf bank_mask:0x1
    v_add_f32_dpp v82, v90, v82 row_shl:8 row_mask:0xf bank_mask:0x1
    v_add_f32_dpp v83, v91, v83 row_shl:8 row_mask:0xf bank_mask:0x1
    v_add_f32_dpp v80, v92, v80 row_shl:12 row_mask:0xf bank_mask:0x1
    v_add_f32_dpp v81, v93, v81 row_shl:12 row_mask:0xf bank_mask:0x1
    v_add_f32_dpp v82, v94, v82 row_shl:12 row_mask:0xf bank_mask:0x1
    v_add_f32_dpp v83, v95, v83 row_shl:12 row_mask:0xf bank_mask:0x1
    ds_write_b128 v203, v[80:83]
    s_waitcnt lgkmcnt(0)
    s_barrier
    s_branch L_fin
L_w2_red:
    s_mov_b32 s35, 0
L_poll60:
    buffer_load_dwordx2 v[20:21], v204, s[44:47], 0 offen sc1
    buffer_load_dwordx2 v[22:23], v204, s[44:47], s48 offen sc1
    s_add_u32 s35, s35, 1
    s_waitcnt vmcnt(0)
    v_max3_u32 v28, v20, v21, v22
    v_max_u32 v28, v28, v23
    v_cmp_eq_u32 vcc, -1, v28
    s_cbranch_vccz L_done61
    s_cmp_lg_u32 s35, 21
    s_cbranch_scc1 L_tmo63
    s_mov_b64 exec, -1
    v_lshlrev_b32 v243, 4, v0
    v_add_u32 v243, 131328, v243
    ds_read_b96 v[240:242], v243
    s_waitcnt lgkmcnt(0)
    buffer_store_dword v240, v242, s[44:47], 0 offen sc1
    buffer_store_dword v241, v242, s[44:47], 0 offen offset:256 sc1
L_tmo63:
    s_sleep 12
    s_cmp_lt_u32 s35, 60000
    s_cbranch_scc1 L_poll60
L_done61:
    v_mov_b32 v7, 99084
    ds_write_b32 v7, v7
    v_lshlrev_b32 v44, 16, v20
    v_and_b32 v45, 0xffff0000, v20
    v_lshlrev_b32 v46, 16, v21
    v_and_b32 v47, 0xffff0000, v21
    v_lshlrev_b32 v48, 16, v22
    v_and_b32 v49, 0xffff0000, v22
    v_lshlrev_b32 v50, 16, v23
    v_and_b32 v51, 0xffff0000, v23
    v_add_f32 v108, v108, v44
    v_add_f32 v109, v109, v45
    v_add_f32 v110, v110, v46
    v_add_f32 v111, v111, v47
    v_add_f32 v108, v108, v48
    v_add_f32 v109, v109, v49
    v_add_f32 v110, v110, v50
    v_add_f32 v111, v111, v51
    s_mov_b32 s36, s28
    s_mov_b32 s37, s29
    s_movk_i32 s38, 5120
    v_add_f32_dpp v108, v108, v108 row_ror:4 row_mask:0xf bank_mask:0xf
    v_add_f32_dpp v109, v109, v109 row_ror:4 row_mask:0xf bank_mask:0xf
    v_add_f32_dpp v110, v110, v110 row_ror:4 row_mask:0xf bank_mask:0xf
    v_add_f32_dpp v111, v111, v111 row_ror:4 row_mask:0xf bank_mask:0xf
    v_add_f32_dpp v108, v108, v108 row_ror:8 row_mask:0xf bank_mask:0xf
    v_add_f32_dpp v109, v109, v109 row_ror:8 row_mask:0xf bank_mask:0xf
    v_add_f32_dpp v110, v110, v110 row_ror:8 row_mask:0xf bank_mask:0xf
    v_add_f32_dpp v111, v111, v111 row_ror:8 row_mask:0xf bank_mask:0xf
    v_mov_b32_dpp v108, v104 quad_perm:[0,1,2,3] row_mask:0xf bank_mask:0x2
    v_mov_b32_dpp v109, v105 quad_perm:[0,1,2,3] row_mask:0xf bank_mask:0x2
    v_mov_b32_dpp v110, v106 quad_perm:[0,1,2,3] row_mask:0xf bank_mask:0x2
    v_mov_b32_dpp v111, v107 quad_perm:[0,1,2,3] row_mask:0xf bank_mask:0x2
    ds_write_b128 v203, v[108:111]
    v_and_b32 v6, 31, v0
    v_lshlrev_b32 v6, 3, v6
    v_add_u32 v6, 122112, v6
    ds_read_b64 v[108:109], v6
    ds_read_b64 v[104:105], v6 offset:320
    v_bfe_u32 v112, v0, 1, 2
    v_mul_u32_u24 v112, 1280, v112
    v_bfe_u32 v7, v0, 3, 2
    v_lshl_add_u32 v112, v7, 3, v112
    v_and_b32 v7, 1, v0
    v_lshl_add_u32 v112, v7, 2, v112
    v_lshrrev_b32 v7, 5, v0
    v_lshl_add_u32 v112, v7, 28, v112
    s_lshl_b32 s34, s62, 5
    s_waitcnt lgkmcnt(0)
    s_barrier
    ds_read_b64 v[64:65], v6 offset:1024
    ds_read_b64 v[66:67], v6 offset:2048
    ds_read_b64 v[68:69], v6 offset:3072
    ds_read_b64 v[70:71], v6 offset:4096
    ds_read_b64 v[72:73], v6 offset:5120
    ds_read_b64 v[74:75], v6 offset:6144
    ds_read_b64 v[76:77], v6 offset:7168
    s_waitcnt lgkmcnt(6)
    v_pk_fma_f32 v[108:109], v[64:65], v[104:105], v[108:109]
    s_waitcnt lgkmcnt(5)
    v_pk_fma_f32 v[108:109], v[66:67], v[104:105], v[108:109]
    s_waitcnt lgkmcnt(4)
    v_pk_fma_f32 v[108:109], v[68:69], v[104:105], v[108:109]
    s_waitcnt lgkmcnt(3)
    v_pk_fma_f32 v[108:109], v[70:71], v[104:105], v[108:109]
    s_waitcnt lgkmcnt(2)
    v_pk_fma_f32 v[108:109], v[72:73], v[104:105], v[108:109]
    s_waitcnt lgkmcnt(1)
    v_pk_fma_f32 v[108:109], v[74:75], v[104:105], v[108:109]
    s_waitcnt lgkmcnt(0)
    v_pk_fma_f32 v[108:109], v[76:77], v[104:105], v[108:109]
    v_cvt_pk_bf16_f32 v20, v108, v109
    buffer_store_dword v20, v112, s[36:39], s34 offen
    s_branch L_fin
L_t_wo:
    s_barrier
L_r_wo2:
    s_mov_b32 m0, s56
    s_nop 0
    buffer_load_dwordx4 v15, s[52:55], s57 offen  lds
    s_mov_b32 m0, s58
    s_nop 0
    buffer_load_dwordx4 v15, s[52:55], s59 offen  lds
    s_xor_b32 m0, s56, 2048
    s_sub_u32 s34, 40960, s57
    buffer_load_dwordx4 v15, s[52:55], s34 offen  lds
    s_xor_b32 m0, s58, 2048
    s_sub_u32 s34, 42240, s57
    buffer_load_dwordx4 v15, s[52:55], s34 offen  lds
L_r_wo3:
    s_mov_b32 s35, 0
    s_mov_b32 s48, 0
    buffer_load_dwordx4 v[64:67], v205, s[44:47], 0 offen sc1
    buffer_load_dwordx2 v[26:27], v204, s[44:47], 0 offen sc1
    s_waitcnt vmcnt(2)
    ds_read_b64_tr_b16 v[32:33], v206 offset:0
    ds_read_b64_tr_b16 v[34:35], v206 offset:1024
    ds_read_b64_tr_b16 v[36:37], v206 offset:32
    ds_read_b64_tr_b16 v[38:39], v206 offset:1056
    ds_read_b64_tr_b16 v[40:41], v206 offset:2048
    ds_read_b64_tr_b16 v[42:43], v206 offset:3072
    ds_read_b64_tr_b16 v[44:45], v206 offset:2080
    ds_read_b64_tr_b16 v[46:47], v206 offset:3104
    s_branch L_pam
L_pa:
    buffer_load_dwordx4 v[64:67], v205, s[44:47], 0 offen sc1
    buffer_load_dwordx2 v[26:27], v204, s[44:47], 0 offen sc1
L_pam:
    s_add_u32 s35, s35, 1
    s_waitcnt vmcnt(0)
    ds_write_b128 v207, v[64:67]
    ds_write_b32 v212, v26 offset:128
    v_max3_u32 v28, v64, v65, v66
    v_max3_u32 v28, v28, v67, v26
    v_cmp_eq_u32 vcc, -1, v28
    s_cbranch_vccz L_pad
    s_cmp_lg_u32 s35, 64
    s_cbranch_scc1 L_tmo64
    s_mov_b64 exec, -1
    v_lshlrev_b32 v243, 4, v0
    v_add_u32 v243, 131328, v243
    ds_read_b96 v[240:242], v243
    s_waitcnt lgkmcnt(0)
    buffer_store_dword v240, v242, s[44:47], 0 offen sc1
    buffer_store_dword v241, v242, s[44:47], 0 offen offset:256 sc1
L_tmo64:
    s_mov_b64 exec, vcc
    s_cmp_lt_u32 s35, 60000
    s_cbranch_scc1 L_pa
L_pad:
    s_mov_b64 exec, -1
    ds_read_b32 v26, v213 offset:128
    ds_read_b128 v[68:71], v208 offset:0
    ds_read_b128 v[72:75], v209 offset:0
    ds_read_b128 v[76:79], v208 offset:64
    ds_read_b128 v[80:83], v209 offset:64
    s_waitcnt lgkmcnt(3)
    v_mfma_f32_16x16x32_bf16 v[20:23], v[32:35], v[68:71], 0
    s_waitcnt lgkmcnt(2)
    v_mfma_f32_16x16x32_bf16 v[20:23], v[36:39], v[72:75], v[20:23]
    s_waitcnt lgkmcnt(1)
    v_mfma_f32_16x16x32_bf16 v[20:23], v[40:43], v[76:79], v[20:23]
    s_waitcnt lgkmcnt(0)
    v_mfma_f32_16x16x32_bf16 v[20:23], v[44:47], v[80:83], v[20:23]
    v_sub_f32_dpp v26, v26, v26 quad_perm:[1,0,3,2] row_mask:0xf bank_mask:0xf
    v_exp_f32 v26, v26
    s_nop 0
    v_add_f32 v26, 1.0, v26
    v_rcp_f32 v26, v26
    s_nop 0
    v_sub_f32 v30, 1.0, v26
    s_nop 0
    v_pk_mul_f32 v[48:49], v[20:21], v[26:27] op_sel_hi:[1,0]
    v_pk_mul_f32 v[50:51], v[22:23], v[26:27] op_sel_hi:[1,0]
    v_fmac_f32_dpp v48, v20, v30 quad_perm:[1,0,3,2] row_mask:0xf bank_mask:0xf
    v_fmac_f32_dpp v49, v21, v30 quad_perm:[1,0,3,2] row_mask:0xf bank_mask:0xf
    v_fmac_f32_dpp v50, v22, v30 quad_perm:[1,0,3,2] row_mask:0xf bank_mask:0xf
    v_fmac_f32_dpp v51, v23, v30 quad_perm:[1,0,3,2] row_mask:0xf bank_mask:0xf
    ds_write_b128 v203, v[48:51]
    s_cmp_lg_u32 s3, 0
    s_waitcnt lgkmcnt(0)
    s_barrier
    s_cbranch_scc1 L_wo_x
    ds_read_b64 v[64:65], v113 offset:0
    ds_read_b64 v[66:67], v113 offset:1152
    ds_read_b64 v[68:69], v113 offset:2304
    ds_read_b64 v[70:71], v113 offset:3456
    ds_read_b64 v[72:73], v113 offset:4608
    ds_read_b64 v[74:75], v113 offset:5760
    ds_read_b64 v[76:77], v113 offset:6912
    ds_read_b64 v[78:79], v113 offset:8064
    s_waitcnt lgkmcnt(6)
    v_pk_add_f32 v[64:65], v[64:65], v[66:67]
    s_waitcnt lgkmcnt(5)
    v_pk_add_f32 v[64:65], v[64:65], v[68:69]
    s_waitcnt lgkmcnt(4)
    v_pk_add_f32 v[64:65], v[64:65], v[70:71]
    s_waitcnt lgkmcnt(3)
    v_pk_add_f32 v[64:65], v[64:65], v[72:73]
    s_waitcnt lgkmcnt(2)
    v_pk_add_f32 v[64:65], v[64:65], v[74:75]
    s_waitcnt lgkmcnt(1)
    v_pk_add_f32 v[64:65], v[64:65], v[76:77]
    s_waitcnt lgkmcnt(0)
    v_pk_add_f32 v[64:65], v[64:65], v[78:79]
    v_pk_mul_f32 v[64:65], v[64:65], v[100:101]
    v_cvt_pk_bf16_f32 v28, v64, v65
    v_min_u32 v28, -2, v28
    buffer_store_dword v28, v112, s[44:47], s101 offen sc1
    buffer_store_dword v28, v112, s[44:47], s93 offen sc1
L_wo_x:
    s_getreg_b32 s34, hwreg(HW_REG_XCC_ID, 0, 4)
    v_cmp_ne_u32 vcc, s34, v27
    s_cbranch_vccz L_fin
    s_mov_b64 exec, -1
    v_lshlrev_b32 v243, 4, v0
    v_add_u32 v243, 131328, v243
    ds_read_b96 v[240:242], v243
    s_waitcnt lgkmcnt(0)
    buffer_store_dword v240, v242, s[44:47], 0 offen sc1
    buffer_store_dword v241, v242, s[44:47], 0 offen offset:256 sc1
L_fin:
L_exit:
    s_endpgm
L_codeend:
.section .rodata,"a"
.p2align 6
.amdhsa_kernel adaLN_cond__sliding_block_cached__dense_activation_gelu__decode_kernel
  .amdhsa_next_free_vgpr 256
  .amdhsa_next_free_sgpr 102
  .amdhsa_accum_offset 256
  .amdhsa_group_segment_fixed_size 0
  .amdhsa_kernarg_size 120
  .amdhsa_user_sgpr_count 2
  .amdhsa_user_sgpr_kernarg_segment_ptr 1
  .amdhsa_system_sgpr_workgroup_id_x 1
  .amdhsa_float_denorm_mode_32 3
.end_amdhsa_kernel
```

```asm
; @launch grid=(256,1,1) block=(512,1,1) lds=132352
.amdgcn_target "amdgcn-amd-amdhsa--gfx950"
.text
.globl adaLN_cond__sliding_block_cached__dense_activation_gelu__decode_kernel
.p2align 8
.type adaLN_cond__sliding_block_cached__dense_activation_gelu__decode_kernel,@function
adaLN_cond__sliding_block_cached__dense_activation_gelu__decode_kernel:
    s_cmp_ge_u32 s2, 256
    s_cbranch_scc1 L_exit
    s_load_dwordx4 s[4:7], s[0:1], 0
    v_lshrrev_b32 v1, 6, v0
    v_and_b32 v0, 63, v0
    v_readfirstlane_b32 s3, v1
    s_and_b32 s34, s2, 127
    s_lshl_b32 s34, s34, 21
    s_lshr_b32 s35, s2, 7
    s_lshl_b32 s35, s35, 18
    s_add_u32 s34, s34, s35
    s_add_u32 s34, s34, 1572864
    s_mov_b32 s38, 0x40000
    s_mov_b32 s39, 0x20000
    s_sub_u32 s49, s3, 1
    s_cbranch_scc1 L_nohead
    s_lshl_b32 s49, s49, 12
    v_lshl_add_u32 v1, v0, 4, s49
    s_waitcnt lgkmcnt(0)
    s_add_u32 s36, s6, s34
    s_addc_u32 s37, s7, 0
    buffer_load_dwordx4 v[16:19], v1, s[36:39], 0 offen offset:0 nt
    buffer_load_dwordx4 v[20:23], v1, s[36:39], 0 offen offset:1024 nt
    buffer_load_dwordx4 v[24:27], v1, s[36:39], 0 offen offset:2048 nt
L_nohead:
    s_load_dwordx8 s[8:15], s[0:1], 16
    s_load_dwordx4 s[16:19], s[0:1], 48
    s_load_dwordx8 s[20:27], s[0:1], 64
    s_load_dwordx4 s[28:31], s[0:1], 96
    s_load_dwordx2 s[32:33], s[0:1], 112
    s_and_b32 s60, s2, 7
    s_lshr_b32 s61, s2, 3
    s_mov_b32 s39, 0x20000
    s_mov_b32 s43, 0x20000
    s_mov_b32 s46, 966656
    s_mov_b32 s47, 0x20000
    s_cmp_lg_u32 s3, 0
    s_cbranch_scc1 L_stream
    s_setprio 3
    v_and_b32 v12, 3, v0
    v_bfe_u32 v13, v0, 2, 2
    v_lshrrev_b32 v14, 4, v0
    v_lshrrev_b32 v10, 3, v0
    v_and_b32 v11, 7, v0
    v_lshlrev_b32 v11, 4, v11
    s_lshr_b32 s50, s2, 2
    s_and_b32 s51, s2, 3
    s_mul_i32 s34, s51, 1228800
    s_lshl_b32 s35, s50, 7
    s_add_u32 s34, s34, s35
    v_mul_u32_u24 v17, 7680, v10
    v_add3_u32 v17, v17, v11, s34
    v_mul_u32_u24 v16, 1280, v12
    v_lshl_add_u32 v18, v14, 4, v16
    s_mul_i32 s34, s51, 320
    v_add_u32 v19, s34, v18
    s_mov_b32 s38, 4915200
    s_sub_u32 s52, s50, 10
    s_waitcnt lgkmcnt(0)
    s_add_u32 s44, s32, 0
    s_addc_u32 s45, s33, 0
    s_cmp_ge_u32 s2, 240
    s_cbranch_scc1 L_clear
    s_cmp_ge_u32 s52, 10
    s_cbranch_scc1 L_nox
    v_lshl_add_u32 v18, v13, 6, v18
    global_load_dwordx4 v[52:55], v18, s[4:5] offset:0
    global_load_dwordx4 v[56:59], v18, s[4:5] offset:256
    global_load_dwordx4 v[60:63], v18, s[4:5] offset:512
    global_load_dwordx4 v[64:67], v18, s[4:5] offset:768
    global_load_dwordx4 v[68:71], v18, s[4:5] offset:1024
    s_lshl_b32 s34, s52, 7
    v_lshl_add_u32 v16, v13, 5, v16
    v_lshl_add_u32 v16, v14, 3, v16
    v_add_u32 v16, s34, v16
    global_load_dwordx2 v[72:73], v16, s[4:5]
L_nox:
    global_load_dwordx4 v[32:35], v19, s[24:25] offset:0
    global_load_dwordx4 v[36:39], v19, s[24:25] offset:64
    global_load_dwordx4 v[40:43], v19, s[24:25] offset:128
    global_load_dwordx4 v[44:47], v19, s[24:25] offset:192
    global_load_dwordx4 v[48:51], v19, s[24:25] offset:256
    s_mov_b32 s36, s26
    s_mov_b32 s37, s27
    s_mov_b32 m0, 0
    s_mov_b32 s34, 0
L_dma1:
    buffer_load_dwordx4 v17, s[36:39], s34 offen  lds
    s_add_u32 m0, m0, 1024
    s_add_u32 s34, s34, 61440
    buffer_load_dwordx4 v17, s[36:39], s34 offen  lds
    s_add_u32 m0, m0, 1024
    s_add_u32 s34, s34, 61440
    buffer_load_dwordx4 v17, s[36:39], s34 offen  lds
    s_add_u32 m0, m0, 1024
    s_add_u32 s34, s34, 61440
    buffer_load_dwordx4 v17, s[36:39], s34 offen  lds
    s_add_u32 m0, m0, 1024
    s_add_u32 s34, s34, 61440
    s_cmp_lt_u32 s34, 1228800
    s_cbranch_scc1 L_dma1
    v_lshlrev_b32 v1, 2, v0
    v_add_u32 v1, 98304, v1
    v_mov_b32 v2, -1
    v_mov_b32 v3, 0
    ds_write_b32 v1, v2
    ds_write_b32 v1, v2 offset:256
    ds_write_b32 v1, v3 offset:512
    ds_write_b32 v1, v3 offset:768
    s_waitcnt lgkmcnt(0)
    s_barrier
    s_and_b32 s34, s2, 31
    s_lshl_b32 s34, s34, 8
    s_lshr_b32 s35, s2, 7
    s_lshl_b32 s35, s35, 7
    s_add_u32 s49, s34, s35
    s_bfe_u32 s53, s2, 0x20005
    s_mul_i32 s34, s53, 1310720
    s_add_u32 s34, s34, s49
    v_lshl_add_u32 v16, v10, 13, v11
    v_add_u32 v16, s34, v16
    s_mov_b32 s36, s10
    s_mov_b32 s37, s11
    s_mov_b32 s38, 5242880
    s_mov_b32 m0, 20480
    s_mov_b32 s34, 0
L_dma2:
    buffer_load_dwordx4 v16, s[36:39], s34 offen  lds
    s_add_u32 m0, m0, 1024
    s_add_u32 s34, s34, 65536
    buffer_load_dwordx4 v16, s[36:39], s34 offen  lds
    s_add_u32 m0, m0, 1024
    s_add_u32 s34, s34, 65536
    buffer_load_dwordx4 v16, s[36:39], s34 offen  lds
    s_add_u32 m0, m0, 1024
    s_add_u32 s34, s34, 65536
    buffer_load_dwordx4 v16, s[36:39], s34 offen  lds
    s_add_u32 m0, m0, 1024
    s_add_u32 s34, s34, 65536
    s_cmp_lt_u32 s34, 1310720
    s_cbranch_scc1 L_dma2
    v_lshl_add_u32 v15, v14, 3, v13
    v_lshlrev_b32 v15, 7, v15
    v_lshl_add_u32 v15, v12, 3, v15
    s_waitcnt vmcnt(40)
    s_mov_b32 s34, 0xbfb8aa3b
    v_lshlrev_b32 v20, 16, v32
    v_and_b32 v21, 0xffff0000, v32
    v_lshlrev_b32 v22, 16, v33
    v_and_b32 v23, 0xffff0000, v33
    v_mul_f32 v24, s34, v20
    v_mul_f32 v25, s34, v21
    v_mul_f32 v26, s34, v22
    v_mul_f32 v27, s34, v23
    v_exp_f32 v24, v24
    v_exp_f32 v25, v25
    v_exp_f32 v26, v26
    v_exp_f32 v27, v27
    v_add_f32 v24, 1.0, v24
    v_add_f32 v25, 1.0, v25
    v_add_f32 v26, 1.0, v26
    v_add_f32 v27, 1.0, v27
    v_rcp_f32 v24, v24
    v_rcp_f32 v25, v25
    v_rcp_f32 v26, v26
    v_rcp_f32 v27, v27
    v_mul_f32 v24, v20, v24
    v_mul_f32 v25, v21, v25
    v_mul_f32 v26, v22, v26
    v_mul_f32 v27, v23, v27
    v_cvt_pk_bf16_f32 v32, v24, v25
    v_cvt_pk_bf16_f32 v33, v26, v27
    v_lshlrev_b32 v20, 16, v34
    v_and_b32 v21, 0xffff0000, v34
    v_lshlrev_b32 v22, 16, v35
    v_and_b32 v23, 0xffff0000, v35
    v_mul_f32 v24, s34, v20
    v_mul_f32 v25, s34, v21
    v_mul_f32 v26, s34, v22
    v_mul_f32 v27, s34, v23
    v_exp_f32 v24, v24
    v_exp_f32 v25, v25
    v_exp_f32 v26, v26
    v_exp_f32 v27, v27
    v_add_f32 v24, 1.0, v24
    v_add_f32 v25, 1.0, v25
    v_add_f32 v26, 1.0, v26
    v_add_f32 v27, 1.0, v27
    v_rcp_f32 v24, v24
    v_rcp_f32 v25, v25
    v_rcp_f32 v26, v26
    v_rcp_f32 v27, v27
    v_mul_f32 v24, v20, v24
    v_mul_f32 v25, v21, v25
    v_mul_f32 v26, v22, v26
    v_mul_f32 v27, v23, v27
    v_cvt_pk_bf16_f32 v34, v24, v25
    v_cvt_pk_bf16_f32 v35, v26, v27
    v_lshlrev_b32 v20, 16, v36
    v_and_b32 v21, 0xffff0000, v36
    v_lshlrev_b32 v22, 16, v37
    v_and_b32 v23, 0xffff0000, v37
    v_mul_f32 v24, s34, v20
    v_mul_f32 v25, s34, v21
    v_mul_f32 v26, s34, v22
    v_mul_f32 v27, s34, v23
    v_exp_f32 v24, v24
    v_exp_f32 v25, v25
    v_exp_f32 v26, v26
    v_exp_f32 v27, v27
    v_add_f32 v24, 1.0, v24
    v_add_f32 v25, 1.0, v25
    v_add_f32 v26, 1.0, v26
    v_add_f32 v27, 1.0, v27
    v_rcp_f32 v24, v24
    v_rcp_f32 v25, v25
    v_rcp_f32 v26, v26
    v_rcp_f32 v27, v27
    v_mul_f32 v24, v20, v24
    v_mul_f32 v25, v21, v25
    v_mul_f32 v26, v22, v26
    v_mul_f32 v27, v23, v27
    v_cvt_pk_bf16_f32 v36, v24, v25
    v_cvt_pk_bf16_f32 v37, v26, v27
    v_lshlrev_b32 v20, 16, v38
    v_and_b32 v21, 0xffff0000, v38
    v_lshlrev_b32 v22, 16, v39
    v_and_b32 v23, 0xffff0000, v39
    v_mul_f32 v24, s34, v20
    v_mul_f32 v25, s34, v21
    v_mul_f32 v26, s34, v22
    v_mul_f32 v27, s34, v23
    v_exp_f32 v24, v24
    v_exp_f32 v25, v25
    v_exp_f32 v26, v26
    v_exp_f32 v27, v27
    v_add_f32 v24, 1.0, v24
    v_add_f32 v25, 1.0, v25
    v_add_f32 v26, 1.0, v26
    v_add_f32 v27, 1.0, v27
    v_rcp_f32 v24, v24
    v_rcp_f32 v25, v25
    v_rcp_f32 v26, v26
    v_rcp_f32 v27, v27
    v_mul_f32 v24, v20, v24
    v_mul_f32 v25, v21, v25
    v_mul_f32 v26, v22, v26
    v_mul_f32 v27, v23, v27
    v_cvt_pk_bf16_f32 v38, v24, v25
    v_cvt_pk_bf16_f32 v39, v26, v27
    v_lshlrev_b32 v20, 16, v40
    v_and_b32 v21, 0xffff0000, v40
    v_lshlrev_b32 v22, 16, v41
    v_and_b32 v23, 0xffff0000, v41
    v_mul_f32 v24, s34, v20
    v_mul_f32 v25, s34, v21
    v_mul_f32 v26, s34, v22
    v_mul_f32 v27, s34, v23
    v_exp_f32 v24, v24
    v_exp_f32 v25, v25
    v_exp_f32 v26, v26
    v_exp_f32 v27, v27
    v_add_f32 v24, 1.0, v24
    v_add_f32 v25, 1.0, v25
    v_add_f32 v26, 1.0, v26
    v_add_f32 v27, 1.0, v27
    v_rcp_f32 v24, v24
    v_rcp_f32 v25, v25
    v_rcp_f32 v26, v26
    v_rcp_f32 v27, v27
    v_mul_f32 v24, v20, v24
    v_mul_f32 v25, v21, v25
    v_mul_f32 v26, v22, v26
    v_mul_f32 v27, v23, v27
    v_cvt_pk_bf16_f32 v40, v24, v25
    v_cvt_pk_bf16_f32 v41, v26, v27
    v_lshlrev_b32 v20, 16, v42
    v_and_b32 v21, 0xffff0000, v42
    v_lshlrev_b32 v22, 16, v43
    v_and_b32 v23, 0xffff0000, v43
    v_mul_f32 v24, s34, v20
    v_mul_f32 v25, s34, v21
    v_mul_f32 v26, s34, v22
    v_mul_f32 v27, s34, v23
    v_exp_f32 v24, v24
    v_exp_f32 v25, v25
    v_exp_f32 v26, v26
    v_exp_f32 v27, v27
    v_add_f32 v24, 1.0, v24
    v_add_f32 v25, 1.0, v25
    v_add_f32 v26, 1.0, v26
    v_add_f32 v27, 1.0, v27
    v_rcp_f32 v24, v24
    v_rcp_f32 v25, v25
    v_rcp_f32 v26, v26
    v_rcp_f32 v27, v27
    v_mul_f32 v24, v20, v24
    v_mul_f32 v25, v21, v25
    v_mul_f32 v26, v22, v26
    v_mul_f32 v27, v23, v27
    v_cvt_pk_bf16_f32 v42, v24, v25
    v_cvt_pk_bf16_f32 v43, v26, v27
    v_lshlrev_b32 v20, 16, v44
    v_and_b32 v21, 0xffff0000, v44
    v_lshlrev_b32 v22, 16, v45
    v_and_b32 v23, 0xffff0000, v45
    v_mul_f32 v24, s34, v20
    v_mul_f32 v25, s34, v21
    v_mul_f32 v26, s34, v22
    v_mul_f32 v27, s34, v23
    v_exp_f32 v24, v24
    v_exp_f32 v25, v25
    v_exp_f32 v26, v26
    v_exp_f32 v27, v27
    v_add_f32 v24, 1.0, v24
    v_add_f32 v25, 1.0, v25
    v_add_f32 v26, 1.0, v26
    v_add_f32 v27, 1.0, v27
    v_rcp_f32 v24, v24
    v_rcp_f32 v25, v25
    v_rcp_f32 v26, v26
    v_rcp_f32 v27, v27
    v_mul_f32 v24, v20, v24
    v_mul_f32 v25, v21, v25
    v_mul_f32 v26, v22, v26
    v_mul_f32 v27, v23, v27
    v_cvt_pk_bf16_f32 v44, v24, v25
    v_cvt_pk_bf16_f32 v45, v26, v27
    v_lshlrev_b32 v20, 16, v46
    v_and_b32 v21, 0xffff0000, v46
    v_lshlrev_b32 v22, 16, v47
    v_and_b32 v23, 0xffff0000, v47
    v_mul_f32 v24, s34, v20
    v_mul_f32 v25, s34, v21
    v_mul_f32 v26, s34, v22
    v_mul_f32 v27, s34, v23
    v_exp_f32 v24, v24
    v_exp_f32 v25, v25
    v_exp_f32 v26, v26
    v_exp_f32 v27, v27
    v_add_f32 v24, 1.0, v24
    v_add_f32 v25, 1.0, v25
    v_add_f32 v26, 1.0, v26
    v_add_f32 v27, 1.0, v27
    v_rcp_f32 v24, v24
    v_rcp_f32 v25, v25
    v_rcp_f32 v26, v26
    v_rcp_f32 v27, v27
    v_mul_f32 v24, v20, v24
    v_mul_f32 v25, v21, v25
    v_mul_f32 v26, v22, v26
    v_mul_f32 v27, v23, v27
    v_cvt_pk_bf16_f32 v46, v24, v25
    v_cvt_pk_bf16_f32 v47, v26, v27
    v_lshlrev_b32 v20, 16, v48
    v_and_b32 v21, 0xffff0000, v48
    v_lshlrev_b32 v22, 16, v49
    v_and_b32 v23, 0xffff0000, v49
    v_mul_f32 v24, s34, v20
    v_mul_f32 v25, s34, v21
    v_mul_f32 v26, s34, v22
    v_mul_f32 v27, s34, v23
    v_exp_f32 v24, v24
    v_exp_f32 v25, v25
    v_exp_f32 v26, v26
    v_exp_f32 v27, v27
    v_add_f32 v24, 1.0, v24
    v_add_f32 v25, 1.0, v25
    v_add_f32 v26, 1.0, v26
    v_add_f32 v27, 1.0, v27
    v_rcp_f32 v24, v24
    v_rcp_f32 v25, v25
    v_rcp_f32 v26, v26
    v_rcp_f32 v27, v27
    v_mul_f32 v24, v20, v24
    v_mul_f32 v25, v21, v25
    v_mul_f32 v26, v22, v26
    v_mul_f32 v27, v23, v27
    v_cvt_pk_bf16_f32 v48, v24, v25
    v_cvt_pk_bf16_f32 v49, v26, v27
    v_lshlrev_b32 v20, 16, v50
    v_and_b32 v21, 0xffff0000, v50
    v_lshlrev_b32 v22, 16, v51
    v_and_b32 v23, 0xffff0000, v51
    v_mul_f32 v24, s34, v20
    v_mul_f32 v25, s34, v21
    v_mul_f32 v26, s34, v22
    v_mul_f32 v27, s34, v23
    v_exp_f32 v24, v24
    v_exp_f32 v25, v25
    v_exp_f32 v26, v26
    v_exp_f32 v27, v27
    v_add_f32 v24, 1.0, v24
    v_add_f32 v25, 1.0, v25
    v_add_f32 v26, 1.0, v26
    v_add_f32 v27, 1.0, v27
    v_rcp_f32 v24, v24
    v_rcp_f32 v25, v25
    v_rcp_f32 v26, v26
    v_rcp_f32 v27, v27
    v_mul_f32 v24, v20, v24
    v_mul_f32 v25, v21, v25
    v_mul_f32 v26, v22, v26
    v_mul_f32 v27, v23, v27
    v_cvt_pk_bf16_f32 v50, v24, v25
    v_cvt_pk_bf16_f32 v51, v26, v27
    s_cmp_ge_u32 s52, 10
    s_cbranch_scc1 L_nostats
    v_mov_b32 v20, 0
    v_mov_b32 v21, 0
    v_mov_b32 v22, 0x3f803f80
    v_dot2c_f32_bf16 v20, v52, v22
    v_dot2c_f32_bf16 v21, v52, v52
    v_dot2c_f32_bf16 v20, v53, v22
    v_dot2c_f32_bf16 v21, v53, v53
    v_dot2c_f32_bf16 v20, v54, v22
    v_dot2c_f32_bf16 v21, v54, v54
    v_dot2c_f32_bf16 v20, v55, v22
    v_dot2c_f32_bf16 v21, v55, v55
    v_dot2c_f32_bf16 v20, v56, v22
    v_dot2c_f32_bf16 v21, v56, v56
    v_dot2c_f32_bf16 v20, v57, v22
    v_dot2c_f32_bf16 v21, v57, v57
    v_dot2c_f32_bf16 v20, v58, v22
    v_dot2c_f32_bf16 v21, v58, v58
    v_dot2c_f32_bf16 v20, v59, v22
    v_dot2c_f32_bf16 v21, v59, v59
    v_dot2c_f32_bf16 v20, v60, v22
    v_dot2c_f32_bf16 v21, v60, v60
    v_dot2c_f32_bf16 v20, v61, v22
    v_dot2c_f32_bf16 v21, v61, v61
    v_dot2c_f32_bf16 v20, v62, v22
    v_dot2c_f32_bf16 v21, v62, v62
    v_dot2c_f32_bf16 v20, v63, v22
    v_dot2c_f32_bf16 v21, v63, v63
    v_dot2c_f32_bf16 v20, v64, v22
    v_dot2c_f32_bf16 v21, v64, v64
    v_dot2c_f32_bf16 v20, v65, v22
    v_dot2c_f32_bf16 v21, v65, v65
    v_dot2c_f32_bf16 v20, v66, v22
    v_dot2c_f32_bf16 v21, v66, v66
    v_dot2c_f32_bf16 v20, v67, v22
    v_dot2c_f32_bf16 v21, v67, v67
    v_dot2c_f32_bf16 v20, v68, v22
    v_dot2c_f32_bf16 v21, v68, v68
    v_dot2c_f32_bf16 v20, v69, v22
    v_dot2c_f32_bf16 v21, v69, v69
    v_dot2c_f32_bf16 v20, v70, v22
    v_dot2c_f32_bf16 v21, v70, v70
    v_dot2c_f32_bf16 v20, v71, v22
    v_dot2c_f32_bf16 v21, v71, v71
    s_nop 1
    v_add_f32_dpp v20, v20, v20 row_ror:4 row_mask:0xf bank_mask:0xf
    v_add_f32_dpp v21, v21, v21 row_ror:4 row_mask:0xf bank_mask:0xf
    s_nop 0
    v_add_f32_dpp v20, v20, v20 row_ror:8 row_mask:0xf bank_mask:0xf
    v_add_f32_dpp v21, v21, v21 row_ror:8 row_mask:0xf bank_mask:0xf
    v_mov_b32 v22, v20
    v_mov_b32 v23, v21
    s_nop 0
    v_permlane16_swap_b32 v20, v22
    v_permlane16_swap_b32 v21, v23
    v_add_f32 v20, v20, v22
    v_add_f32 v21, v21, v23
    v_mov_b32 v22, v20
    v_mov_b32 v23, v21
    s_nop 0
    v_permlane32_swap_b32 v20, v22
    v_permlane32_swap_b32 v21, v23
    v_add_f32 v20, v20, v22
    v_add_f32 v21, v21, v23
    v_mul_f32 v22, 0x3acccccd, v20
    v_mul_f32 v21, 0x3acccccd, v21
    v_fma_f32 v21, -v22, v22, v21
    v_max_f32 v21, 0, v21
    v_add_f32 v21, 0x3727c5ac, v21
    v_rsq_f32 v20, v21
    s_nop 0
    v_mul_f32_e64 v21, -v22, v20
    v_lshlrev_b32 v24, 16, v72
    v_and_b32 v25, 0xffff0000, v72
    v_lshlrev_b32 v26, 16, v73
    v_and_b32 v27, 0xffff0000, v73
    v_fma_f32 v24, v24, v20, v21
    v_fma_f32 v25, v25, v20, v21
    v_fma_f32 v26, v26, v20, v21
    v_fma_f32 v27, v27, v20, v21
L_nostats:
    s_waitcnt vmcnt(20)
    ds_read_b64_tr_b16 v[96:97], v15 offset:0
    ds_read_b64_tr_b16 v[98:99], v15 offset:512
    ds_read_b64_tr_b16 v[100:101], v15 offset:32
    ds_read_b64_tr_b16 v[102:103], v15 offset:544
    ds_read_b64_tr_b16 v[104:105], v15 offset:64
    ds_read_b64_tr_b16 v[106:107], v15 offset:576
    ds_read_b64_tr_b16 v[108:109], v15 offset:96
    ds_read_b64_tr_b16 v[110:111], v15 offset:608
    s_waitcnt lgkmcnt(7)
    ds_read_b64_tr_b16 v[112:113], v15 offset:4096
    ds_read_b64_tr_b16 v[114:115], v15 offset:4608
    ds_read_b64_tr_b16 v[116:117], v15 offset:4128
    ds_read_b64_tr_b16 v[118:119], v15 offset:4640
    ds_read_b64_tr_b16 v[120:121], v15 offset:4160
    ds_read_b64_tr_b16 v[122:123], v15 offset:4672
    ds_read_b64_tr_b16 v[124:125], v15 offset:4192
    ds_read_b64_tr_b16 v[126:127], v15 offset:4704
    s_waitcnt lgkmcnt(7)
    ds_read_b64_tr_b16 v[128:129], v15 offset:8192
    ds_read_b64_tr_b16 v[130:131], v15 offset:8704
    ds_read_b64_tr_b16 v[132:133], v15 offset:8224
    ds_read_b64_tr_b16 v[134:135], v15 offset:8736
    ds_read_b64_tr_b16 v[136:137], v15 offset:8256
    ds_read_b64_tr_b16 v[138:139], v15 offset:8768
    ds_read_b64_tr_b16 v[140:141], v15 offset:8288
    ds_read_b64_tr_b16 v[142:143], v15 offset:8800
    s_waitcnt lgkmcnt(7)
    ds_read_b64_tr_b16 v[144:145], v15 offset:12288
    ds_read_b64_tr_b16 v[146:147], v15 offset:12800
    ds_read_b64_tr_b16 v[148:149], v15 offset:12320
    ds_read_b64_tr_b16 v[150:151], v15 offset:12832
    ds_read_b64_tr_b16 v[152:153], v15 offset:12352
    ds_read_b64_tr_b16 v[154:155], v15 offset:12864
    ds_read_b64_tr_b16 v[156:157], v15 offset:12384
    ds_read_b64_tr_b16 v[158:159], v15 offset:12896
    s_waitcnt lgkmcnt(7)
    ds_read_b64_tr_b16 v[160:161], v15 offset:16384
    ds_read_b64_tr_b16 v[162:163], v15 offset:16896
    ds_read_b64_tr_b16 v[164:165], v15 offset:16416
    ds_read_b64_tr_b16 v[166:167], v15 offset:16928
    ds_read_b64_tr_b16 v[168:169], v15 offset:16448
    ds_read_b64_tr_b16 v[170:171], v15 offset:16960
    ds_read_b64_tr_b16 v[172:173], v15 offset:16480
    ds_read_b64_tr_b16 v[174:175], v15 offset:16992
    s_waitcnt lgkmcnt(0)
    v_mfma_f32_16x16x32_bf16 v[80:83], v[96:99], v[32:35], 0
    v_mfma_f32_16x16x32_bf16 v[84:87], v[100:103], v[32:35], 0
    v_mfma_f32_16x16x32_bf16 v[88:91], v[104:107], v[32:35], 0
    v_mfma_f32_16x16x32_bf16 v[92:95], v[108:111], v[32:35], 0
    v_mfma_f32_16x16x32_bf16 v[80:83], v[112:115], v[36:39], v[80:83]
    v_mfma_f32_16x16x32_bf16 v[84:87], v[116:119], v[36:39], v[84:87]
    v_mfma_f32_16x16x32_bf16 v[88:91], v[120:123], v[36:39], v[88:91]
    v_mfma_f32_16x16x32_bf16 v[92:95], v[124:127], v[36:39], v[92:95]
    v_mfma_f32_16x16x32_bf16 v[80:83], v[128:131], v[40:43], v[80:83]
    v_mfma_f32_16x16x32_bf16 v[84:87], v[132:135], v[40:43], v[84:87]
    v_mfma_f32_16x16x32_bf16 v[88:91], v[136:139], v[40:43], v[88:91]
    v_mfma_f32_16x16x32_bf16 v[92:95], v[140:143], v[40:43], v[92:95]
    v_mfma_f32_16x16x32_bf16 v[80:83], v[144:147], v[44:47], v[80:83]
    v_mfma_f32_16x16x32_bf16 v[84:87], v[148:151], v[44:47], v[84:87]
    v_mfma_f32_16x16x32_bf16 v[88:91], v[152:155], v[44:47], v[88:91]
    v_mfma_f32_16x16x32_bf16 v[92:95], v[156:159], v[44:47], v[92:95]
    v_mfma_f32_16x16x32_bf16 v[80:83], v[160:163], v[48:51], v[80:83]
    v_mfma_f32_16x16x32_bf16 v[84:87], v[164:167], v[48:51], v[84:87]
    v_mfma_f32_16x16x32_bf16 v[88:91], v[168:171], v[48:51], v[88:91]
    v_mfma_f32_16x16x32_bf16 v[92:95], v[172:175], v[48:51], v[92:95]
    s_cmp_ge_u32 s50, 20
    s_cbranch_scc1 L_adr_rest
    s_cmp_lt_u32 s50, 10
    s_cselect_b32 s34, 5120, 0
    s_cselect_b32 s35, s50, s52
    s_lshl_b32 s35, s35, 9
    s_add_u32 s34, s34, s35
    s_lshl_b32 s35, s51, 18
    s_add_u32 s34, s34, s35
    v_lshrrev_b32 v19, 1, v14
    v_lshl_add_u32 v19, v13, 1, v19
    v_lshlrev_b32 v19, 6, v19
    v_lshl_add_u32 v19, v12, 4, v19
    v_and_b32 v20, 1, v14
    v_lshl_add_u32 v19, v20, 3, v19
    s_branch L_adr_done
L_adr_rest:
    s_lshl_b32 s34, s51, 18
    s_lshl_b32 s35, s50, 9
    s_add_u32 s34, s34, s35
    s_add_u32 s34, s34, 0
    v_lshlrev_b32 v19, 7, v12
    v_lshl_add_u32 v19, v13, 5, v19
    v_lshl_add_u32 v19, v14, 3, v19
    s_nop 3
L_adr_done:
    v_add_u32 v19, s34, v19
    v_mov_b32_dpp v80, v84 quad_perm:[0,1,2,3] row_mask:0xf bank_mask:0x2
    v_mov_b32_dpp v81, v85 quad_perm:[0,1,2,3] row_mask:0xf bank_mask:0x2
    v_mov_b32_dpp v82, v86 quad_perm:[0,1,2,3] row_mask:0xf bank_mask:0x2
    v_mov_b32_dpp v83, v87 quad_perm:[0,1,2,3] row_mask:0xf bank_mask:0x2
    v_mov_b32_dpp v80, v88 quad_perm:[0,1,2,3] row_mask:0xf bank_mask:0x4
    v_mov_b32_dpp v81, v89 quad_perm:[0,1,2,3] row_mask:0xf bank_mask:0x4
    v_mov_b32_dpp v82, v90 quad_perm:[0,1,2,3] row_mask:0xf bank_mask:0x4
    v_mov_b32_dpp v83, v91 quad_perm:[0,1,2,3] row_mask:0xf bank_mask:0x4
    v_mov_b32_dpp v80, v92 quad_perm:[0,1,2,3] row_mask:0xf bank_mask:0x8
    v_mov_b32_dpp v81, v93 quad_perm:[0,1,2,3] row_mask:0xf bank_mask:0x8
    v_mov_b32_dpp v82, v94 quad_perm:[0,1,2,3] row_mask:0xf bank_mask:0x8
    v_mov_b32_dpp v83, v95 quad_perm:[0,1,2,3] row_mask:0xf bank_mask:0x8
    s_cmp_ge_u32 s52, 10
    s_cbranch_scc1 L_noz
    v_add_f32 v80, 0x3e800000, v80
    v_add_f32 v81, 0x3e800000, v81
    v_add_f32 v82, 0x3e800000, v82
    v_add_f32 v83, 0x3e800000, v83
    v_mul_f32 v80, v80, v24
    v_mul_f32 v81, v81, v25
    v_mul_f32 v82, v82, v26
    v_mul_f32 v83, v83, v27
L_noz:
    v_cvt_pk_bf16_f32 v20, v80, v81
    v_cvt_pk_bf16_f32 v21, v82, v83
    v_min_u32 v20, -2, v20
    v_min_u32 v21, -2, v21
    v_and_b32 v22, 15, v0
    v_lshlrev_b32 v22, 2, v22
    s_mov_b32 s35, 0
L_poll3:
    global_load_dword v23, v22, s[30:31] offset:128 sc1
    s_add_u32 s35, s35, 1
    s_waitcnt vmcnt(0)
    v_cmp_eq_u32 vcc, 0, v23
    s_cbranch_vccz L_done4
    s_sleep 8
    s_cmp_lt_u32 s35, 60000
    s_cbranch_scc1 L_poll3
L_done4:
    s_getreg_b32 s97, hwreg(HW_REG_XCC_ID, 0, 4)
    s_sub_u32 s97, s97, s2
    s_and_b32 s97, s97, 7
    s_add_u32 s97, s97, 1
    v_cmp_ne_u32 vcc, s97, v23
    s_nop 0
    s_mov_b32 s97, vcc_lo
    buffer_store_dwordx2 v[20:21], v19, s[44:47], 0 offen sc1
    s_branch L_p2
L_clear:
    s_sub_u32 s55, s2, 240
    s_lshr_b32 s34, s55, 2
    s_lshl_b32 s35, s34, 3
    s_lshr_b32 s54, 538910755, s35
    s_and_b32 s54, s54, 0xff
    s_lshl_b32 s54, s54, 10
    s_mul_i32 s34, s34, 49152
    s_lshl_b32 s35, s51, 18
    s_add_u32 s34, s34, s35
    v_lshl_add_u32 v19, v0, 4, s34
    v_mov_b32 v20, -1
    v_mov_b32 v21, -1
    v_mov_b32 v22, -1
    v_mov_b32 v23, -1
    s_mov_b32 s34, 0
L_clrloop:
    buffer_store_dwordx4 v[20:23], v19, s[44:47], s34 offen offset:0 sc1
    s_add_u32 s34, s34, 1024
    s_cmp_lt_u32 s34, s54
    s_cbranch_scc1 L_clrloop
L_clrend:
    v_lshlrev_b32 v1, 2, v0
    v_add_u32 v1, 98304, v1
    v_mov_b32 v2, -1
    v_mov_b32 v3, 0
    ds_write_b32 v1, v2
    ds_write_b32 v1, v2 offset:256
    ds_write_b32 v1, v3 offset:512
    ds_write_b32 v1, v3 offset:768
    s_waitcnt lgkmcnt(0)
    s_barrier
    s_lshl_b32 s34, s55, 2
    v_mov_b32 v24, s34
    s_getreg_b32 s97, hwreg(HW_REG_XCC_ID, 0, 4)
    s_sub_u32 s97, s97, s2
    s_and_b32 s97, s97, 7
    s_add_u32 s97, s97, 1
    v_mov_b32 v25, s97
    v_readfirstlane_b32 s90, v19
    s_mov_b32 s91, 0
    s_waitcnt vmcnt(0)
    s_mov_b64 exec, 1
    global_store_dword v24, v25, s[30:31] offset:128 sc1
    s_mov_b64 exec, -1
    s_and_b32 s34, s2, 31
    s_lshl_b32 s34, s34, 8
    s_lshr_b32 s35, s2, 7
    s_lshl_b32 s35, s35, 7
    s_add_u32 s49, s34, s35
    s_bfe_u32 s53, s2, 0x20005
    s_mul_i32 s34, s53, 1310720
    s_add_u32 s34, s34, s49
    v_lshl_add_u32 v16, v10, 13, v11
    v_add_u32 v16, s34, v16
    s_mov_b32 s36, s10
    s_mov_b32 s37, s11
    s_mov_b32 s38, 5242880
    s_mov_b32 m0, 20480
    s_mov_b32 s34, 0
L_dma6:
    buffer_load_dwordx4 v16, s[36:39], s34 offen  lds
    s_add_u32 m0, m0, 1024
    s_add_u32 s34, s34, 65536
    buffer_load_dwordx4 v16, s[36:39], s34 offen  lds
    s_add_u32 m0, m0, 1024
    s_add_u32 s34, s34, 65536
    buffer_load_dwordx4 v16, s[36:39], s34 offen  lds
    s_add_u32 m0, m0, 1024
    s_add_u32 s34, s34, 65536
    buffer_load_dwordx4 v16, s[36:39], s34 offen  lds
    s_add_u32 m0, m0, 1024
    s_add_u32 s34, s34, 65536
    s_cmp_lt_u32 s34, 1310720
    s_cbranch_scc1 L_dma6
    v_lshl_add_u32 v15, v14, 3, v13
    v_lshlrev_b32 v15, 7, v15
    v_lshl_add_u32 v15, v12, 3, v15
    s_add_u32 s34, s90, 0
    s_add_u32 s35, s90, 8192
    s_mov_b64 s[88:89], 0
    s_load_dword s88, s[44:45], s34
    s_load_dword s89, s[44:45], s35
    s_waitcnt lgkmcnt(1)
    s_cmp_lg_u32 s89, 0
    s_addc_u32 s91, s91, 0
    s_waitcnt lgkmcnt(0)
    s_add_u32 s34, s90, 1024
    s_add_u32 s35, s90, 9216
    s_mov_b64 s[88:89], 0
    s_load_dword s89, s[44:45], s35
    s_load_dword s88, s[44:45], s34
    s_waitcnt lgkmcnt(1)
    s_cmp_eq_u32 s88, 0
    s_addc_u32 s91, s91, 0
    s_waitcnt lgkmcnt(0)
    s_add_u32 s34, s90, 2048
    s_add_u32 s35, s90, 10240
    s_mov_b64 s[88:89], 0
    s_load_dword s88, s[44:45], s34
    s_load_dword s89, s[44:45], s35
    s_waitcnt lgkmcnt(1)
    s_cmp_lg_u32 s89, 0
    s_addc_u32 s91, s91, 0
    s_waitcnt lgkmcnt(0)
    s_add_u32 s34, s90, 3072
    s_add_u32 s35, s90, 11264
    s_mov_b64 s[88:89], 0
    s_load_dword s89, s[44:45], s35
    s_load_dword s88, s[44:45], s34
    s_waitcnt lgkmcnt(1)
    s_cmp_eq_u32 s88, 0
    s_addc_u32 s91, s91, 0
    s_waitcnt lgkmcnt(0)
    s_getreg_b32 s34, hwreg(HW_REG_XCC_ID, 2, 1)
    s_sub_u32 s35, 2, s91
    s_sub_u32 s91, s91, 2
    s_cmp_eq_u32 s34, 0
    s_cselect_b32 s91, s91, s35
    v_mov_b32 v25, s91
    s_mov_b64 exec, 1
    global_store_dword v24, v25, s[30:31] sc1
    s_mov_b64 exec, -1
    v_and_b32 v22, 15, v0
    v_lshlrev_b32 v22, 2, v22
    s_mov_b32 s35, 0
L_poll7:
    global_load_dword v23, v22, s[30:31] offset:128 sc1
    s_add_u32 s35, s35, 1
    s_waitcnt vmcnt(0)
    v_cmp_eq_u32 vcc, 0, v23
    s_cbranch_vccz L_done8
    s_sleep 8
    s_cmp_lt_u32 s35, 60000
    s_cbranch_scc1 L_poll7
L_done8:
    s_getreg_b32 s97, hwreg(HW_REG_XCC_ID, 0, 4)
    s_sub_u32 s97, s97, s2
    s_and_b32 s97, s97, 7
    s_add_u32 s97, s97, 1
    v_cmp_ne_u32 vcc, s97, v23
    s_nop 0
    s_mov_b32 s97, vcc_lo
L_p2:
    v_mov_b32 v199, v19
    ds_read_b64_tr_b16 v[96:97], v15 offset:20480
    ds_read_b64_tr_b16 v[98:99], v15 offset:20992
    ds_read_b64_tr_b16 v[100:101], v15 offset:20512
    ds_read_b64_tr_b16 v[102:103], v15 offset:21024
    ds_read_b64_tr_b16 v[104:105], v15 offset:20544
    ds_read_b64_tr_b16 v[106:107], v15 offset:21056
    ds_read_b64_tr_b16 v[108:109], v15 offset:20576
    ds_read_b64_tr_b16 v[110:111], v15 offset:21088
    s_waitcnt lgkmcnt(7)
    ds_read_b64_tr_b16 v[112:113], v15 offset:24576
    ds_read_b64_tr_b16 v[114:115], v15 offset:25088
    ds_read_b64_tr_b16 v[116:117], v15 offset:24608
    ds_read_b64_tr_b16 v[118:119], v15 offset:25120
    ds_read_b64_tr_b16 v[120:121], v15 offset:24640
    ds_read_b64_tr_b16 v[122:123], v15 offset:25152
    ds_read_b64_tr_b16 v[124:125], v15 offset:24672
    ds_read_b64_tr_b16 v[126:127], v15 offset:25184
    s_waitcnt lgkmcnt(7)
    ds_read_b64_tr_b16 v[128:129], v15 offset:28672
    ds_read_b64_tr_b16 v[130:131], v15 offset:29184
    ds_read_b64_tr_b16 v[132:133], v15 offset:28704
    ds_read_b64_tr_b16 v[134:135], v15 offset:29216
    ds_read_b64_tr_b16 v[136:137], v15 offset:28736
    ds_read_b64_tr_b16 v[138:139], v15 offset:29248
    ds_read_b64_tr_b16 v[140:141], v15 offset:28768
    ds_read_b64_tr_b16 v[142:143], v15 offset:29280
    s_waitcnt lgkmcnt(7)
    ds_read_b64_tr_b16 v[144:145], v15 offset:32768
    ds_read_b64_tr_b16 v[146:147], v15 offset:33280
    ds_read_b64_tr_b16 v[148:149], v15 offset:32800
    ds_read_b64_tr_b16 v[150:151], v15 offset:33312
    ds_read_b64_tr_b16 v[152:153], v15 offset:32832
    ds_read_b64_tr_b16 v[154:155], v15 offset:33344
    ds_read_b64_tr_b16 v[156:157], v15 offset:32864
    ds_read_b64_tr_b16 v[158:159], v15 offset:33376
    s_waitcnt lgkmcnt(7)
    ds_read_b64_tr_b16 v[160:161], v15 offset:36864
    ds_read_b64_tr_b16 v[162:163], v15 offset:37376
    ds_read_b64_tr_b16 v[164:165], v15 offset:36896
    ds_read_b64_tr_b16 v[166:167], v15 offset:37408
    ds_read_b64_tr_b16 v[168:169], v15 offset:36928
    ds_read_b64_tr_b16 v[170:171], v15 offset:37440
    ds_read_b64_tr_b16 v[172:173], v15 offset:36960
    ds_read_b64_tr_b16 v[174:175], v15 offset:37472
    s_waitcnt lgkmcnt(0)
    s_mul_i32 s34, s53, 1280
    v_lshlrev_b32 v19, 18, v13
    v_lshl_add_u32 v19, v14, 6, v19
    v_lshl_add_u32 v19, v12, 4, v19
    v_add_u32 v19, s34, v19
    s_movk_i32 s48, 5120
    s_mov_b32 s56, 262144
    s_mov_b32 s57, 524288
    s_mov_b32 s58, 786432
    s_sub_u32 s34, s2, 80
    s_cmp_lt_u32 s34, 160
    s_cselect_b32 s54, 1, 0
    s_and_b32 s34, s2, 3
    s_cselect_b32 s54, 0, s54
    v_mov_b32 v180, 0
    v_mov_b32 v181, 0
    v_mov_b32 v182, 0
    v_mov_b32 v183, 0
    v_mov_b32 v184, 0
    v_mov_b32 v185, 0
    v_mov_b32 v186, 0
    v_mov_b32 v187, 0
    v_mov_b32 v22, 99072
    s_mov_b32 s35, 0
L_poll10:
    ds_read_b32 v23, v22
    s_add_u32 s35, s35, 1
    s_waitcnt lgkmcnt(0)
    v_cmp_gt_u32 vcc, 21, v23
    s_cbranch_vccz L_done11
    s_sleep 2
    s_cmp_lt_u32 s35, 60000
    s_cbranch_scc1 L_poll10
L_done11:
    s_mov_b32 s35, 0
L_poll13:
    buffer_load_dwordx4 v[32:35], v19, s[44:47], 0 offen offset:0 sc1
    buffer_load_dwordx4 v[36:39], v19, s[44:47], s48 offen offset:0 sc1
    buffer_load_dwordx4 v[40:43], v19, s[44:47], 0 offen offset:256 sc1
    buffer_load_dwordx4 v[44:47], v19, s[44:47], s48 offen offset:256 sc1
    buffer_load_dwordx4 v[48:51], v19, s[44:47], 0 offen offset:512 sc1
    buffer_load_dwordx4 v[52:55], v19, s[44:47], s48 offen offset:512 sc1
    buffer_load_dwordx4 v[56:59], v19, s[44:47], 0 offen offset:768 sc1
    buffer_load_dwordx4 v[60:63], v19, s[44:47], s48 offen offset:768 sc1
    buffer_load_dwordx4 v[64:67], v19, s[44:47], 0 offen offset:1024 sc1
    buffer_load_dwordx4 v[68:71], v19, s[44:47], s48 offen offset:1024 sc1
    s_cmp_eq_u32 s54, 0
    s_cbranch_scc1 L_hskip
    buffer_load_dwordx2 v[180:181], v199, s[44:47], 0 offen sc1
    buffer_load_dwordx2 v[182:183], v199, s[44:47], s56 offen sc1
    buffer_load_dwordx2 v[184:185], v199, s[44:47], s57 offen sc1
    buffer_load_dwordx2 v[186:187], v199, s[44:47], s58 offen sc1
L_hskip:
    s_add_u32 s35, s35, 1
    s_waitcnt vmcnt(0)
    v_max3_u32 v20, v32, v33, v34
    v_max3_u32 v20, v20, v35, v36
    v_max3_u32 v20, v20, v37, v38
    v_max3_u32 v20, v20, v39, v40
    v_max3_u32 v20, v20, v41, v42
    v_max3_u32 v20, v20, v43, v44
    v_max3_u32 v20, v20, v45, v46
    v_max3_u32 v20, v20, v47, v48
    v_max3_u32 v20, v20, v49, v50
    v_max3_u32 v20, v20, v51, v52
    v_max3_u32 v20, v20, v53, v54
    v_max3_u32 v20, v20, v55, v56
    v_max3_u32 v20, v20, v57, v58
    v_max3_u32 v20, v20, v59, v60
    v_max3_u32 v20, v20, v61, v62
    v_max3_u32 v20, v20, v63, v64
    v_max3_u32 v20, v20, v65, v66
    v_max3_u32 v20, v20, v67, v68
    v_max3_u32 v20, v20, v69, v70
    v_max3_u32 v20, v20, v71, v180
    v_max3_u32 v20, v20, v181, v182
    v_max3_u32 v20, v20, v183, v184
    v_max3_u32 v20, v20, v185, v186
    v_max_u32 v20, v20, v187
    v_cmp_eq_u32 vcc, -1, v20
    s_cbranch_vccz L_done14
    s_sleep 16
    s_cmp_lt_u32 s35, 60000
    s_cbranch_scc1 L_poll13
L_done14:
    v_mfma_f32_16x16x32_bf16 v[80:83], v[96:99], v[32:35], 0
    v_mfma_f32_16x16x32_bf16 v[84:87], v[100:103], v[32:35], 0
    v_mfma_f32_16x16x32_bf16 v[88:91], v[104:107], v[32:35], 0
    v_mfma_f32_16x16x32_bf16 v[92:95], v[108:111], v[32:35], 0
    v_mfma_f32_16x16x32_bf16 v[80:83], v[96:99], v[36:39], v[80:83]
    v_mfma_f32_16x16x32_bf16 v[84:87], v[100:103], v[36:39], v[84:87]
    v_mfma_f32_16x16x32_bf16 v[88:91], v[104:107], v[36:39], v[88:91]
    v_mfma_f32_16x16x32_bf16 v[92:95], v[108:111], v[36:39], v[92:95]
    v_mfma_f32_16x16x32_bf16 v[80:83], v[112:115], v[40:43], v[80:83]
    v_mfma_f32_16x16x32_bf16 v[84:87], v[116:119], v[40:43], v[84:87]
    v_mfma_f32_16x16x32_bf16 v[88:91], v[120:123], v[40:43], v[88:91]
    v_mfma_f32_16x16x32_bf16 v[92:95], v[124:127], v[40:43], v[92:95]
    v_mfma_f32_16x16x32_bf16 v[80:83], v[112:115], v[44:47], v[80:83]
    v_mfma_f32_16x16x32_bf16 v[84:87], v[116:119], v[44:47], v[84:87]
    v_mfma_f32_16x16x32_bf16 v[88:91], v[120:123], v[44:47], v[88:91]
    v_mfma_f32_16x16x32_bf16 v[92:95], v[124:127], v[44:47], v[92:95]
    v_mfma_f32_16x16x32_bf16 v[80:83], v[128:131], v[48:51], v[80:83]
    v_mfma_f32_16x16x32_bf16 v[84:87], v[132:135], v[48:51], v[84:87]
    v_mfma_f32_16x16x32_bf16 v[88:91], v[136:139], v[48:51], v[88:91]
    v_mfma_f32_16x16x32_bf16 v[92:95], v[140:143], v[48:51], v[92:95]
    v_mfma_f32_16x16x32_bf16 v[80:83], v[128:131], v[52:55], v[80:83]
    v_mfma_f32_16x16x32_bf16 v[84:87], v[132:135], v[52:55], v[84:87]
    v_mfma_f32_16x16x32_bf16 v[88:91], v[136:139], v[52:55], v[88:91]
    v_mfma_f32_16x16x32_bf16 v[92:95], v[140:143], v[52:55], v[92:95]
    v_mfma_f32_16x16x32_bf16 v[80:83], v[144:147], v[56:59], v[80:83]
    v_mfma_f32_16x16x32_bf16 v[84:87], v[148:151], v[56:59], v[84:87]
    v_mfma_f32_16x16x32_bf16 v[88:91], v[152:155], v[56:59], v[88:91]
    v_mfma_f32_16x16x32_bf16 v[92:95], v[156:159], v[56:59], v[92:95]
    v_mfma_f32_16x16x32_bf16 v[80:83], v[144:147], v[60:63], v[80:83]
    v_mfma_f32_16x16x32_bf16 v[84:87], v[148:151], v[60:63], v[84:87]
    v_mfma_f32_16x16x32_bf16 v[88:91], v[152:155], v[60:63], v[88:91]
    v_mfma_f32_16x16x32_bf16 v[92:95], v[156:159], v[60:63], v[92:95]
    v_mfma_f32_16x16x32_bf16 v[80:83], v[160:163], v[64:67], v[80:83]
    v_mfma_f32_16x16x32_bf16 v[84:87], v[164:167], v[64:67], v[84:87]
    v_mfma_f32_16x16x32_bf16 v[88:91], v[168:171], v[64:67], v[88:91]
    v_mfma_f32_16x16x32_bf16 v[92:95], v[172:175], v[64:67], v[92:95]
    v_mfma_f32_16x16x32_bf16 v[80:83], v[160:163], v[68:71], v[80:83]
    v_mfma_f32_16x16x32_bf16 v[84:87], v[164:167], v[68:71], v[84:87]
    v_mfma_f32_16x16x32_bf16 v[88:91], v[168:171], v[68:71], v[88:91]
    v_mfma_f32_16x16x32_bf16 v[92:95], v[172:175], v[68:71], v[92:95]
    s_lshl_b32 s34, s53, 18
    s_lshl_b32 s35, s49, 2
    s_add_u32 s34, s34, s35
    s_add_u32 s34, s34, 49152
    v_lshlrev_b32 v19, 7, v12
    v_lshl_add_u32 v19, v13, 5, v19
    v_lshl_add_u32 v19, v14, 3, v19
    v_add_u32 v19, s34, v19
    v_add_f32_dpp v20, v80, v80 row_ror:8 row_mask:0xf bank_mask:0x3
    v_add_f32_dpp v24, v84, v84 row_ror:8 row_mask:0xf bank_mask:0x3
    v_add_f32_dpp v21, v81, v81 row_ror:8 row_mask:0xf bank_mask:0x3
    v_add_f32_dpp v25, v85, v85 row_ror:8 row_mask:0xf bank_mask:0x3
    v_add_f32_dpp v22, v82, v82 row_ror:8 row_mask:0xf bank_mask:0x3
    v_add_f32_dpp v26, v86, v86 row_ror:8 row_mask:0xf bank_mask:0x3
    v_add_f32_dpp v23, v83, v83 row_ror:8 row_mask:0xf bank_mask:0x3
    v_add_f32_dpp v27, v87, v87 row_ror:8 row_mask:0xf bank_mask:0x3
    v_add_f32_dpp v20, v88, v88 row_ror:8 row_mask:0xf bank_mask:0xc
    v_add_f32_dpp v24, v92, v92 row_ror:8 row_mask:0xf bank_mask:0xc
    v_add_f32_dpp v21, v89, v89 row_ror:8 row_mask:0xf bank_mask:0xc
    v_add_f32_dpp v25, v93, v93 row_ror:8 row_mask:0xf bank_mask:0xc
    v_add_f32_dpp v22, v90, v90 row_ror:8 row_mask:0xf bank_mask:0xc
    v_add_f32_dpp v26, v94, v94 row_ror:8 row_mask:0xf bank_mask:0xc
    v_add_f32_dpp v23, v91, v91 row_ror:8 row_mask:0xf bank_mask:0xc
    v_add_f32_dpp v27, v95, v95 row_ror:8 row_mask:0xf bank_mask:0xc
    v_add_f32_dpp v28, v20, v20 row_shl:4 row_mask:0xf bank_mask:0x5
    v_add_f32_dpp v29, v21, v21 row_shl:4 row_mask:0xf bank_mask:0x5
    v_add_f32_dpp v30, v22, v22 row_shl:4 row_mask:0xf bank_mask:0x5
    v_add_f32_dpp v31, v23, v23 row_shl:4 row_mask:0xf bank_mask:0x5
    v_add_f32_dpp v28, v24, v24 row_shr:4 row_mask:0xf bank_mask:0xa
    v_add_f32_dpp v29, v25, v25 row_shr:4 row_mask:0xf bank_mask:0xa
    v_add_f32_dpp v30, v26, v26 row_shr:4 row_mask:0xf bank_mask:0xa
    v_add_f32_dpp v31, v27, v27 row_shr:4 row_mask:0xf bank_mask:0xa
    v_cvt_pk_bf16_f32 v20, v28, v29
    v_cvt_pk_bf16_f32 v21, v30, v31
    v_min_u32 v20, -2, v20
    v_min_u32 v21, -2, v21
    buffer_store_dwordx2 v[20:21], v19, s[44:47], 0 offen sc1
    s_cmp_eq_u32 s54, 0
    s_cbranch_scc1 L_nomf
    v_lshlrev_b32 v24, 16, v180
    v_and_b32 v25, 0xffff0000, v180
    v_lshlrev_b32 v26, 16, v181
    v_and_b32 v27, 0xffff0000, v181
    v_lshlrev_b32 v28, 16, v182
    v_and_b32 v29, 0xffff0000, v182
    v_lshlrev_b32 v30, 16, v183
    v_and_b32 v31, 0xffff0000, v183
    v_add_f32 v24, v24, v28
    v_add_f32 v25, v25, v29
    v_add_f32 v26, v26, v30
    v_add_f32 v27, v27, v31
    v_lshlrev_b32 v28, 16, v184
    v_and_b32 v29, 0xffff0000, v184
    v_lshlrev_b32 v30, 16, v185
    v_and_b32 v31, 0xffff0000, v185
    v_add_f32 v24, v24, v28
    v_add_f32 v25, v25, v29
    v_add_f32 v26, v26, v30
    v_add_f32 v27, v27, v31
    v_lshlrev_b32 v28, 16, v186
    v_and_b32 v29, 0xffff0000, v186
    v_lshlrev_b32 v30, 16, v187
    v_and_b32 v31, 0xffff0000, v187
    v_add_f32 v24, v24, v28
    v_add_f32 v25, v25, v29
    v_add_f32 v26, v26, v30
    v_add_f32 v27, v27, v31
    v_cvt_pk_bf16_f32 v22, v24, v25
    v_cvt_pk_bf16_f32 v23, v26, v27
    v_min_u32 v22, -2, v22
    v_min_u32 v23, -2, v23
    s_sub_u32 s34, s50, 20
    s_lshl_b32 s35, s34, 9
    v_subrev_u32 v199, s35, v199
    s_lshr_b32 s35, s34, 2
    s_lshl_b32 s35, s35, 9
    s_and_b32 s34, s34, 3
    s_lshl_b32 s34, s34, 18
    s_add_u32 s34, s34, s35
    s_add_u32 s34, s34, 20480
    v_add_u32 v199, s34, v199
    buffer_store_dwordx2 v[22:23], v199, s[44:47], 0 offen sc1
L_nomf:
    s_and_b32 s34, s2, 127
    s_lshl_b32 s34, s34, 21
    s_lshr_b32 s35, s2, 7
    s_lshl_b32 s35, s35, 18
    s_add_u32 s34, s34, s35
    s_add_u32 s34, s34, 1572864
    s_mov_b32 s38, 0x40000
    s_mov_b32 s42, 0x40000
    s_waitcnt lgkmcnt(0)
    s_add_u32 s36, s6, s34
    s_addc_u32 s37, s7, 0
    s_add_u32 s40, s8, s34
    s_addc_u32 s41, s9, 0
    v_lshlrev_b32 v18, 4, v0
    s_mov_b32 s34, 258048
    buffer_load_dwordx4 v[128:131], v18, s[36:39], s34 offen offset:0 nt
    buffer_load_dwordx4 v[132:135], v18, s[36:39], s34 offen offset:1024 nt
    buffer_load_dwordx4 v[136:139], v18, s[36:39], s34 offen offset:2048 nt
    buffer_load_dwordx4 v[140:143], v18, s[36:39], s34 offen offset:3072 nt
    s_and_b32 s34, s2, 31
    s_lshl_b32 s34, s34, 10
    s_lshl_b32 s35, s53, 7
    s_add_u32 s34, s34, s35
    s_add_u32 s34, s34, 49152
    v_lshrrev_b32 v19, 5, v0
    v_mul_u32_u24 v19, 384, v19
    v_lshl_add_u32 v19, v0, 2, v19
    v_add_u32 v19, s34, v19
    v_mov_b32 v22, 99072
    s_mov_b32 s35, 0
L_poll16:
    ds_read_b32 v23, v22
    s_add_u32 s35, s35, 1
    s_waitcnt lgkmcnt(0)
    v_cmp_gt_u32 vcc, 33, v23
    s_cbranch_vccz L_done17
    s_sleep 2
    s_cmp_lt_u32 s35, 60000
    s_cbranch_scc1 L_poll16
L_done17:
    v_and_b32 v44, 15, v0
    v_lshlrev_b32 v44, 2, v44
    global_load_dword v44, v44, s[30:31] sc1
    s_mov_b32 s35, 0
L_poll19:
    buffer_load_dword v32, v19, s[44:47], 0 offen sc1
    buffer_load_dword v33, v19, s[44:47], s56 offen sc1
    buffer_load_dword v34, v19, s[44:47], s57 offen sc1
    buffer_load_dword v35, v19, s[44:47], s58 offen sc1
    s_add_u32 s35, s35, 1
    s_waitcnt vmcnt(0)
    v_max3_u32 v22, v32, v33, v34
    v_max_u32 v22, v22, v35
    v_cmp_eq_u32 vcc, -1, v22
    s_cbranch_vccz L_done20
    s_sleep 16
    s_cmp_lt_u32 s35, 60000
    s_cbranch_scc1 L_poll19
L_done20:
    v_add_u32_dpp v44, v44, v44 row_ror:8 row_mask:0xf bank_mask:0xf
    s_nop 1
    v_add_u32_dpp v44, v44, v44 row_ror:4 row_mask:0xf bank_mask:0xf
    s_nop 1
    v_add_u32_dpp v44, v44, v44 row_ror:2 row_mask:0xf bank_mask:0xf
    s_nop 1
    v_add_u32_dpp v44, v44, v44 row_ror:1 row_mask:0xf bank_mask:0xf
    s_nop 0
    v_readfirstlane_b32 s99, v44
    s_nop 0
    s_cmp_gt_i32 s99, 0
    s_cselect_b32 s99, 1, 0
    s_getreg_b32 s34, hwreg(HW_REG_XCC_ID, 2, 1)
    s_xor_b32 s99, s99, s34
    s_lshl_b32 s99, s99, 13
    v_mov_b32 v45, 99080
    v_mov_b32 v44, s99
    ds_write_b32 v45, v44
    v_lshlrev_b32 v36, 16, v32
    v_and_b32 v37, 0xffff0000, v32
    v_lshlrev_b32 v38, 16, v33
    v_and_b32 v39, 0xffff0000, v33
    v_lshlrev_b32 v40, 16, v34
    v_and_b32 v41, 0xffff0000, v34
    v_lshlrev_b32 v42, 16, v35
    v_and_b32 v43, 0xffff0000, v35
    v_pk_add_f32 v[36:37], v[36:37], v[38:39]
    v_pk_add_f32 v[40:41], v[40:41], v[42:43]
    v_pk_add_f32 v[36:37], v[36:37], v[40:41]
    v_cvt_pk_bf16_f32 v32, v36, v37
    v_min_u32 v32, -2, v32
    ds_write_b32 v1, v32
    s_mov_b32 s34, 258048
    buffer_load_dwordx4 v[144:147], v18, s[40:43], s34 offen offset:0 nt
    buffer_load_dwordx4 v[148:151], v18, s[40:43], s34 offen offset:1024 nt
    buffer_load_dwordx4 v[152:155], v18, s[40:43], s34 offen offset:2048 nt
    buffer_load_dwordx4 v[156:159], v18, s[40:43], s34 offen offset:3072 nt
    v_and_b32 v2, 15, v0
    v_lshlrev_b32 v2, 4, v2
    v_add_u32 v2, 98304, v2
    ds_read_b128 v[4:7], v2
    s_waitcnt lgkmcnt(0)
    v_dot2_f32_bf16 v8, v128, v4, 0
    v_dot2_f32_bf16 v9, v132, v4, 0
    v_dot2_f32_bf16 v10, v136, v4, 0
    v_dot2_f32_bf16 v11, v140, v4, 0
    v_dot2c_f32_bf16 v8, v129, v5
    v_dot2c_f32_bf16 v9, v133, v5
    v_dot2c_f32_bf16 v10, v137, v5
    v_dot2c_f32_bf16 v11, v141, v5
    v_dot2c_f32_bf16 v8, v130, v6
    v_dot2c_f32_bf16 v9, v134, v6
    v_dot2c_f32_bf16 v10, v138, v6
    v_dot2c_f32_bf16 v11, v142, v6
    v_dot2c_f32_bf16 v8, v131, v7
    v_dot2c_f32_bf16 v9, v135, v7
    v_dot2c_f32_bf16 v10, v139, v7
    v_dot2c_f32_bf16 v11, v143, v7
    v_add_f32_dpp v16, v8, v8 row_ror:8 row_mask:0xf bank_mask:0x3
    v_add_f32_dpp v16, v9, v9 row_ror:8 row_mask:0xf bank_mask:0xc
    v_add_f32_dpp v17, v10, v10 row_ror:8 row_mask:0xf bank_mask:0x3
    v_add_f32_dpp v17, v11, v11 row_ror:8 row_mask:0xf bank_mask:0xc
    v_add_f32_dpp v16, v16, v16 row_half_mirror row_mask:0xf bank_mask:0xf
    s_nop 0
    v_add_f32_dpp v17, v17, v17 row_half_mirror row_mask:0xf bank_mask:0xf
    v_add_f32_dpp v16, v16, v16 quad_perm:[1,0,3,2] row_mask:0xf bank_mask:0xf
    s_nop 0
    v_add_f32_dpp v17, v17, v17 quad_perm:[1,0,3,2] row_mask:0xf bank_mask:0xf
    v_add_f32_dpp v16, v16, v16 quad_perm:[2,3,0,1] row_mask:0xf bank_mask:0xf
    s_nop 0
    v_add_f32_dpp v17, v17, v17 quad_perm:[2,3,0,1] row_mask:0xf bank_mask:0xf
    v_max_f32 v8, v16, v17
    s_mov_b32 s34, 0x3e0293ee
    s_nop 0
    v_max_f32_dpp v8, v8, v8 row_ror:8 row_mask:0xf bank_mask:0xf
    v_mov_b32 v9, v8
    s_nop 1
    v_permlane16_swap_b32 v8, v9
    v_max_f32 v8, v8, v9
    v_mov_b32 v9, v8
    s_nop 1
    v_permlane32_swap_b32 v8, v9
    v_max_f32 v8, v8, v9
    v_mul_f32 v8, s34, v8
    v_fma_f32 v16, v16, s34, -v8
    v_fma_f32 v17, v17, s34, -v8
    v_exp_f32 v16, v16
    v_exp_f32 v17, v17
    s_nop 0
    v_add_f32 v9, v16, v17
    v_and_b32 v10, 1, v0
    v_lshlrev_b32 v10, 4, v10
    v_mov_b32 v11, 0xffff
    v_lshlrev_b32 v10, v10, v11
    v_bfe_u32 v11, v0, 1, 2
    v_cmp_eq_u32 vcc, 0, v11
    s_nop 1
    v_cndmask_b32 v20, 0, v10, vcc
    v_cmp_eq_u32 vcc, 1, v11
    s_nop 1
    v_cndmask_b32 v21, 0, v10, vcc
    v_cmp_eq_u32 vcc, 2, v11
    s_nop 1
    v_cndmask_b32 v22, 0, v10, vcc
    v_cmp_eq_u32 vcc, 3, v11
    s_nop 1
    v_cndmask_b32 v23, 0, v10, vcc
    v_add_f32_dpp v9, v9, v9 row_ror:8 row_mask:0xf bank_mask:0xf
    v_mov_b32 v10, v9
    s_nop 1
    v_permlane16_swap_b32 v9, v10
    v_add_f32 v9, v9, v10
    v_mov_b32 v10, v9
    s_nop 1
    v_permlane32_swap_b32 v9, v10
    v_add_f32 v9, v9, v10
    v_mov_b32 v10, 98616
    s_mov_b64 exec, 1
    ds_write_b64 v10, v[8:9]
    s_mov_b64 exec, -1
    s_waitcnt vmcnt(0)
    v_cvt_pk_bf16_f32 v10, v16, v16
    v_and_b32 v24, v10, v20
    v_and_b32 v25, v10, v21
    v_and_b32 v26, v10, v22
    v_and_b32 v27, v10, v23
    s_nop 1
    v_mfma_f32_16x16x32_bf16 v[116:119], v[144:147], v[24:27], 0
    v_mfma_f32_16x16x32_bf16 v[120:123], v[148:151], v[24:27], 0
    v_cvt_pk_bf16_f32 v10, v17, v17
    v_and_b32 v28, v10, v20
    v_and_b32 v29, v10, v21
    v_and_b32 v30, v10, v22
    v_and_b32 v31, v10, v23
    s_nop 1
    v_mfma_f32_16x16x32_bf16 v[116:119], v[152:155], v[28:31], v[116:119]
    v_mfma_f32_16x16x32_bf16 v[120:123], v[156:159], v[28:31], v[120:123]
    s_mov_b32 s34, 106496
    v_lshrrev_b32 v16, 4, v0
    v_and_b32 v17, 7, v0
    v_lshl_add_u32 v16, v16, 3, v17
    v_bfe_u32 v17, v0, 3, 1
    v_lshl_add_u32 v16, v17, 5, v16
    v_lshl_add_u32 v16, v16, 4, s34
    s_nop 0
    v_add_f32_dpp v116, v120, v116 row_ror:8 row_mask:0xf bank_mask:0xf
    v_add_f32_dpp v117, v121, v117 row_ror:8 row_mask:0xf bank_mask:0xf
    v_add_f32_dpp v118, v122, v118 row_ror:8 row_mask:0xf bank_mask:0xf
    v_add_f32_dpp v119, v123, v119 row_ror:8 row_mask:0xf bank_mask:0xf
    ds_write_b128 v16, v[116:119]
    v_lshl_add_u32 v16, v0, 3, s34
    ds_read_b64 v[116:117], v16
    s_waitcnt lgkmcnt(0)
    s_mov_b32 s63, 0
    s_mov_b32 s62, s61
    s_cmp_lt_u32 s61, 20
    s_cbranch_scc1 L_rd22
    s_mul_i32 s62, s60, 12
    s_add_u32 s62, s62, s61
    s_sub_u32 s62, s62, 20
    s_mov_b32 s63, 1
    s_cmp_lt_u32 s62, 54
    s_cbranch_scc1 L_rd22
    s_cmp_lt_u32 s62, 56
    s_cselect_b32 s63, 3, 2
    s_sub_u32 s62, s62, 56
L_rd22:
    v_and_b32 v8, 3, v0
    v_bfe_u32 v9, v0, 2, 2
    v_lshrrev_b32 v10, 4, v0
    s_mov_b32 s55, 0x20000
    s_lshl_b32 s35, s62, 6
    s_and_b32 s49, s62, 1
    s_cmp_eq_u32 s63, 0
    s_cbranch_scc1 L_dp24
    s_cmp_eq_u32 s63, 1
    s_cbranch_scc1 L_dp25
    s_mov_b32 s52, s20
    s_mov_b32 s53, s21
    s_mov_b32 s54, 2211840
    v_mov_b32 v15, 0
    s_branch L_dp26
L_dp25:
    s_mov_b32 s52, s16
    s_mov_b32 s53, s17
    s_mov_b32 s54, 2211840
    v_lshl_add_u32 v15, v9, 3, v10
    v_mul_u32_u24 v15, 3456, v15
    v_lshl_add_u32 v15, v8, 4, v15
    v_add_u32 v15, s35, v15
    s_bfe_u32 s50, s3, 0x10001
    s_lshl_b32 s50, s50, 7
    s_and_b32 s34, s3, 1
    s_lshl_b32 s34, s34, 2
    s_add_u32 s50, s50, s34
    s_and_b32 s51, s3, 3
    s_lshl_b32 s51, s51, 5
    s_add_u32 s51, s51, 512
    s_mul_i32 s50, s50, 3456
    s_mul_i32 s51, s51, 3456
    s_branch L_dp26
L_dp24:
    s_mov_b32 s52, s12
    s_mov_b32 s53, s13
    s_mov_b32 s54, 5242880
    s_lshr_b32 s50, s3, 1
    s_lshl_b32 s50, s50, 3
    s_add_u32 s50, s50, s60
    s_and_b32 s51, s3, 1
    s_lshl_b32 s34, s50, 1
    s_add_u32 s34, s34, s51
    s_mul_i32 s34, s34, 81920
    s_add_u32 s34, s34, s35
    v_lshl_add_u32 v15, v9, 2, v10
    v_mul_u32_u24 v15, 2560, v15
    v_lshl_add_u32 v15, v8, 4, v15
    v_add_u32 v15, s34, v15
    s_lshl_b32 s56, s3, 12
    s_lshl_b32 s34, s49, 11
    s_add_u32 s56, s56, s34
    s_add_u32 s56, s56, 40960
    s_add_u32 s58, s56, 1024
    s_mul_i32 s57, s49, 40960
    s_add_u32 s59, s57, 1280
L_dp26:
    v_and_b32 v200, 3, v0
    v_bfe_u32 v201, v0, 2, 2
    v_lshrrev_b32 v202, 4, v0
    s_lshl_b32 s34, s3, 10
    s_add_u32 s34, s34, 122112
    v_mul_u32_u24 v203, 320, v201
    v_min_u32 v203, 704, v203
    v_lshl_add_u32 v203, v202, 6, v203
    v_lshl_add_u32 v203, v200, 4, v203
    v_add_u32 v203, s34, v203
    s_movk_i32 s48, 16384
    v_mov_b32 v197, 0
    s_mov_b32 s40, 0
    s_mov_b32 s41, 0
    s_mov_b32 s42, 0
    s_cmp_eq_u32 s63, 0
    s_cbranch_scc1 L_d_wo
    s_cmp_eq_u32 s63, 2
    s_cbranch_scc1 L_d_w2
    s_cmp_eq_u32 s63, 3
    s_cbranch_scc1 L_d_none
    v_and_b32 v205, 15, v0
    v_lshlrev_b32 v205, 4, v205
    s_and_b32 s49, s3, 3
    s_mul_i32 s34, s49, 1280
    s_add_u32 s34, s34, s99
    s_add_u32 s34, s34, 98304
    v_lshl_add_u32 v206, v202, 18, v205
    v_add_u32 v206, s34, v206
    s_mul_i32 s34, s49, 3840
    v_add_u32 v205, s34, v205
    s_lshl_b32 s34, s62, 6
    v_lshlrev_b32 v5, 4, v14
    v_lshl_add_u32 v5, v12, 2, v5
    v_add_u32 v5, s34, v5
    global_load_dword v6, v5, s[18:19]
    v_and_b32 v7, 15, v0
    v_lshlrev_b32 v7, 4, v7
    v_mul_u32_u24 v8, 1280, v14
    v_add_u32 v8, v8, v7
    v_bfe_u32 v9, v0, 3, 1
    v_lshlrev_b32 v9, 18, v9
    v_lshl_add_u32 v9, v14, 7, v9
    v_and_b32 v10, 7, v0
    v_lshl_add_u32 v9, v10, 4, v9
    v_add_u32 v9, 30720, v9
    s_mov_b32 s57, 524288
    v_mul_u32_u24 v5, 3840, v14
    v_add_u32 v5, v5, v7
    global_load_dwordx4 v[32:35], v8, s[4:5] offset:0
    global_load_dwordx4 v[36:39], v8, s[4:5] offset:256
    global_load_dwordx4 v[40:43], v8, s[4:5] offset:512
    global_load_dwordx4 v[44:47], v8, s[4:5] offset:768
    global_load_dwordx4 v[48:51], v8, s[4:5] offset:1024
    s_mov_b32 s35, 0
L_poll27:
    buffer_load_dwordx4 v[52:55], v9, s[44:47], s57 offen offset:1024 sc1
    buffer_load_dwordx4 v[56:59], v9, s[44:47], 0 offen offset:1536 sc1
    buffer_load_dwordx4 v[60:63], v9, s[44:47], s57 offen offset:1536 sc1
    buffer_load_dwordx4 v[64:67], v9, s[44:47], 0 offen offset:2048 sc1
    buffer_load_dwordx4 v[68:71], v9, s[44:47], s57 offen offset:2048 sc1
    buffer_load_dwordx4 v[72:75], v9, s[44:47], 0 offen offset:2560 sc1
    buffer_load_dwordx4 v[76:79], v9, s[44:47], s57 offen offset:2560 sc1
    buffer_load_dwordx4 v[80:83], v9, s[44:47], 0 offen offset:3072 sc1
    buffer_load_dwordx4 v[84:87], v9, s[44:47], s57 offen offset:3072 sc1
    buffer_load_dwordx4 v[88:91], v9, s[44:47], 0 offen offset:3584 sc1
    s_add_u32 s35, s35, 1
    s_waitcnt vmcnt(0)
    v_max3_u32 v28, v52, v53, v54
    v_max3_u32 v28, v28, v55, v56
    v_max3_u32 v28, v28, v57, v58
    v_max3_u32 v28, v28, v59, v60
    v_max3_u32 v28, v28, v61, v62
    v_max3_u32 v28, v28, v63, v64
    v_max3_u32 v28, v28, v65, v66
    v_max3_u32 v28, v28, v67, v68
    v_max3_u32 v28, v28, v69, v70
    v_max3_u32 v28, v28, v71, v72
    v_max3_u32 v28, v28, v73, v74
    v_max3_u32 v28, v28, v75, v76
    v_max3_u32 v28, v28, v77, v78
    v_max3_u32 v28, v28, v79, v80
    v_max3_u32 v28, v28, v81, v82
    v_max3_u32 v28, v28, v83, v84
    v_max3_u32 v28, v28, v85, v86
    v_max3_u32 v28, v28, v87, v88
    v_max3_u32 v28, v28, v89, v90
    v_max_u32 v28, v28, v91
    v_cmp_eq_u32 vcc, -1, v28
    s_cbranch_vccz L_done28
    s_sleep 16
    s_cmp_lt_u32 s35, 60000
    s_cbranch_scc1 L_poll27
L_done28:
    ds_write_b128 v5, v[32:35] offset:0
    ds_write_b128 v5, v[36:39] offset:256
    ds_write_b128 v5, v[40:43] offset:512
    ds_write_b128 v5, v[44:47] offset:768
    ds_write_b128 v5, v[48:51] offset:1024
    ds_write_b128 v5, v[52:55] offset:1280
    ds_write_b128 v5, v[56:59] offset:1536
    ds_write_b128 v5, v[60:63] offset:1792
    ds_write_b128 v5, v[64:67] offset:2048
    ds_write_b128 v5, v[68:71] offset:2304
    ds_write_b128 v5, v[72:75] offset:2560
    ds_write_b128 v5, v[76:79] offset:2816
    ds_write_b128 v5, v[80:83] offset:3072
    ds_write_b128 v5, v[84:87] offset:3328
    ds_write_b128 v5, v[88:91] offset:3584
    s_waitcnt lgkmcnt(0)
    v_lshlrev_b32 v100, 16, v6
    v_and_b32 v101, 0xffff0000, v6
    s_cmp_eq_u32 s60, 4
    s_cselect_b32 s40, 6, 12
    s_mov_b32 s41, 5462
    s_cmov_b32 s41, 10923
    s_cselect_b32 s34, 20, 20
    s_mov_b32 s49, 17280
    s_cmov_b32 s49, 34560
    v_min_u32 v196, 59, v0
    v_mul_u32_u24 v197, s41, v196
    v_lshrrev_b32 v197, 16, v197
    v_mul_u32_u24 v194, s40, v197
    v_sub_u32 v196, v196, v194
    v_mul_u32_u24 v197, 3456, v197
    v_lshl_add_u32 v197, v196, 6, v197
    s_mul_i32 s35, s60, 768
    s_add_i32 s35, s35, 0
    s_cmp_eq_u32 s60, 4
    s_cselect_b32 s35, 3072, s35
    s_sub_u32 s34, s61, s34
    s_mul_i32 s34, s34, s49
    s_mul_i32 s34, s34, 11
    s_add_u32 s34, s34, s35
    v_add_u32 v197, s34, v197
    s_mov_b32 s40, s49
    s_mov_b32 s41, s49
    s_branch L_d_none
L_d_w2:
    s_lshl_b32 s34, s62, 5
    v_lshl_add_u32 v3, v14, 3, s34
    global_load_dwordx2 v[20:21], v3, s[22:23]
    v_mul_u32_u24 v112, 1280, v12
    v_add_u32 v112, v112, v3
    global_load_dwordx2 v[22:23], v112, s[4:5]
    s_lshr_b32 s34, s62, 2
    s_add_u32 s34, s34, 30
    s_lshr_b32 s35, s34, 2
    s_lshl_b32 s35, s35, 9
    s_and_b32 s34, s34, 3
    s_lshl_b32 s34, s34, 18
    s_add_u32 s34, s34, s35
    s_and_b32 s35, s62, 3
    s_mul_i32 s35, s35, 32
    s_add_u32 s34, s34, s35
    s_add_u32 s34, s34, 30720
    v_lshlrev_b32 v5, 7, v12
    v_lshl_add_u32 v5, v14, 3, v5
    v_add_u32 v5, s34, v5
    s_waitcnt vmcnt(0)
    v_lshlrev_b32 v32, 16, v20
    v_and_b32 v33, 0xffff0000, v20
    v_lshlrev_b32 v34, 16, v21
    v_and_b32 v35, 0xffff0000, v21
    v_lshlrev_b32 v108, 16, v22
    v_and_b32 v109, 0xffff0000, v22
    v_lshlrev_b32 v110, 16, v23
    v_and_b32 v111, 0xffff0000, v23
    s_mov_b32 s35, 0
L_poll30:
    buffer_load_dwordx2 v[24:25], v5, s[44:47], 0 offen sc1
    s_add_u32 s35, s35, 1
    s_waitcnt vmcnt(0)
    v_max_u32 v28, v24, v25
    v_cmp_eq_u32 vcc, -1, v28
    s_cbranch_vccz L_done31
    s_sleep 16
    s_cmp_lt_u32 s35, 60000
    s_cbranch_scc1 L_poll30
L_done31:
    v_lshlrev_b32 v104, 16, v24
    v_and_b32 v105, 0xffff0000, v24
    v_lshlrev_b32 v106, 16, v25
    v_and_b32 v107, 0xffff0000, v25
    v_fma_f32 v108, v104, v32, v108
    v_fma_f32 v109, v105, v33, v109
    v_fma_f32 v110, v106, v34, v110
    v_fma_f32 v111, v107, v35, v111
    v_mul_f32 v108, 0x3e800000, v108
    v_mul_f32 v109, 0x3e800000, v109
    v_mul_f32 v110, 0x3e800000, v110
    v_mul_f32 v111, 0x3e800000, v111
    v_lshl_add_u32 v204, v13, 18, v112
    s_add_u32 s34, s99, 98304
    v_add_u32 v204, s34, v204
    s_cmp_eq_u32 s60, 4
    s_cselect_b32 s40, 2, 6
    s_mov_b32 s41, 10923
    s_cmov_b32 s41, 32769
    s_cselect_b32 s34, 28, 20
    s_mov_b32 s49, 12800
    s_cmov_b32 s49, 38400
    v_min_u32 v196, 59, v0
    v_mul_u32_u24 v197, s41, v196
    v_lshrrev_b32 v197, 16, v197
    v_mul_u32_u24 v194, s40, v197
    v_sub_u32 v196, v196, v194
    v_mul_u32_u24 v197, 1280, v197
    v_lshl_add_u32 v197, v196, 6, v197
    s_mul_i32 s35, s60, 384
    s_add_i32 s35, s35, -1792
    s_cmp_eq_u32 s60, 4
    s_cselect_b32 s35, 0, s35
    s_sub_u32 s34, s61, s34
    s_mul_i32 s34, s34, s49
    s_mul_i32 s34, s34, 15
    s_add_u32 s34, s34, s35
    v_add_u32 v197, s34, v197
    s_mov_b32 s40, s49
    s_mov_b32 s41, s49
    s_branch L_d_none
L_d_wo:
    s_lshr_b32 s49, s3, 1
    s_lshl_b32 s49, s49, 18
    v_and_b32 v210, 7, v0
    s_mul_i32 s34, s60, 4096
    s_add_u32 s34, s34, s49
    s_add_u32 s34, s34, 147712
    v_lshrrev_b32 v211, 3, v0
    v_mul_u32_u24 v205, 512, v211
    v_add_u32 v204, s34, v205
    s_lshl_b32 s35, s51, 7
    s_add_u32 s34, s34, s35
    s_sub_u32 s34, s34, 256
    v_lshl_add_u32 v205, v210, 4, v205
    v_add_u32 v205, s34, v205
    s_lshl_b32 s34, s3, 12
    s_add_u32 s34, s34, 40960
    v_lshrrev_b32 v206, 2, v0
    v_lshlrev_b32 v206, 6, v206
    v_lshl_add_u32 v206, v200, 3, v206
    v_add_u32 v206, s34, v206
    s_mul_i32 s34, s3, 1152
    s_add_u32 s34, s34, 107520
    v_mul_u32_u24 v207, 144, v211
    v_lshl_add_u32 v207, v210, 4, v207
    v_add_u32 v207, s34, v207
    v_mul_u32_u24 v208, 144, v210
    v_lshl_add_u32 v208, v202, 4, v208
    v_add_u32 v208, s34, v208
    v_mul_u32_u24 v212, 144, v211
    v_add_u32 v212, s34, v212
    v_mul_u32_u24 v213, 144, v210
    v_add_u32 v213, s34, v213
    v_and_b32 v211, 1, v211
    v_bfe_u32 v203, v0, 1, 2
    v_mul_u32_u24 v203, 144, v203
    v_and_b32 v214, 1, v0
    v_mul_u32_u24 v214, 576, v214
    v_lshl_add_u32 v214, v211, 6, v214
    v_lshl_add_u32 v214, v202, 4, v214
    s_add_u32 s34, s34, 14592
    v_add3_u32 v203, v203, v214, s34
    v_mov_b32 v210, 98816
    v_cmp_eq_u32 vcc, 0, v211
    s_nop 1
    v_cndmask_b32 v209, v208, v210, vcc
    v_cndmask_b32 v208, v210, v208, vcc
    v_and_b32 v8, 15, v0
    s_lshr_b32 s34, s62, 1
    s_add_u32 s34, s34, 0
    s_lshr_b32 s35, s34, 2
    s_lshl_b32 s35, s35, 9
    s_and_b32 s34, s34, 3
    s_lshl_b32 s34, s34, 18
    s_add_u32 s34, s34, s35
    s_and_b32 s35, s62, 1
    s_mul_i32 s35, s35, 64
    s_add_u32 s34, s34, s35
    s_add_u32 s34, s34, 30720
    v_lshlrev_b32 v9, 2, v8
    v_lshl_add_u32 v9, v14, 7, v9
    v_add_u32 v9, s34, v9
    s_lshr_b32 s34, s60, 2
    s_lshl_b32 s34, s34, 14
    s_and_b32 s35, s60, 3
    s_lshl_b32 s35, s35, 18
    s_add_u32 s34, s34, s35
    s_lshl_b32 s35, s62, 6
    s_add_u32 s34, s34, s35
    s_add_u32 s34, s34, 98304
    v_mul_u32_u24 v112, 1280, v14
    v_lshl_add_u32 v112, v8, 2, v112
    v_add_u32 v112, s34, v112
    v_mul_u32_u24 v113, 144, v14
    v_lshl_add_u32 v113, v8, 3, v113
    v_add_u32 v113, 122112, v113
    s_bfe_u32 s35, s60, 0x10002
    s_lshl_b32 s35, s35, 13
    s_xor_b32 s101, s99, s35
    s_xor_b32 s93, s101, 8192
    s_mul_i32 s34, s62, 52
    s_lshr_b32 s34, s34, 8
    s_mul_i32 s35, s34, 5
    s_sub_u32 s35, s62, s35
    s_mul_i32 s34, s34, 1310720
    s_lshl_b32 s35, s35, 15
    s_add_u32 s34, s34, s35
    s_mul_i32 s35, s60, 163840
    s_add_u32 s34, s34, s35
    v_lshl_add_u32 v197, v0, 6, s34
    s_movk_i32 s40, 4096
    s_movk_i32 s41, 4096
    s_mov_b32 s35, 0
L_poll33:
    buffer_load_dword v32, v9, s[44:47], 0 offen sc1
    s_add_u32 s35, s35, 1
    s_waitcnt vmcnt(0)
    v_mov_b32 v22, v32
    v_cmp_eq_u32 vcc, -1, v22
    s_cbranch_vccz L_done34
    s_sleep 16
    s_cmp_lt_u32 s35, 60000
    s_cbranch_scc1 L_poll33
L_done34:
    v_lshlrev_b32 v100, 16, v32
    v_and_b32 v101, 0xffff0000, v32
L_d_none:
    v_and_b32 v19, 7, v0
    v_lshlrev_b32 v19, 3, v19
    v_add_u32 v19, 98560, v19
    s_mov_b32 s35, 0
L_poll36:
    ds_read_b64 v[20:21], v19
    s_add_u32 s35, s35, 1
    s_waitcnt lgkmcnt(0)
    v_max_u32 v22, v20, v21
    v_cmp_eq_u32 vcc, -1, v22
    s_cbranch_vccz L_done37
    s_sleep 2
    s_cmp_lt_u32 s35, 60000
    s_cbranch_scc1 L_poll36
L_done37:
    v_max_f32_dpp v22, v20, v20 row_half_mirror row_mask:0xf bank_mask:0xf
    s_nop 1
    v_max_f32_dpp v22, v22, v22 quad_perm:[1,0,3,2] row_mask:0xf bank_mask:0xf
    s_nop 1
    v_max_f32_dpp v22, v22, v22 quad_perm:[2,3,0,1] row_mask:0xf bank_mask:0xf
    v_sub_f32 v20, v20, v22
    v_exp_f32 v20, v20
    s_nop 0
    v_mul_f32 v21, v21, v20
    s_nop 1
    v_add_f32_dpp v21, v21, v21 row_half_mirror row_mask:0xf bank_mask:0xf
    s_nop 1
    v_add_f32_dpp v21, v21, v21 quad_perm:[1,0,3,2] row_mask:0xf bank_mask:0xf
    s_nop 1
    v_add_f32_dpp v21, v21, v21 quad_perm:[2,3,0,1] row_mask:0xf bank_mask:0xf
    v_rcp_f32 v23, v21
    v_log_f32 v21, v21
    v_mul_f32 v20, v20, v23
    v_add_f32 v21, v21, v22
    v_min_u32 v21, -2, v21
    v_readlane_b32 s88, v20, 0
    v_readlane_b32 s90, v20, 1
    v_readlane_b32 s92, v20, 2
    v_readlane_b32 s94, v20, 3
    v_readlane_b32 s96, v20, 4
    v_readlane_b32 s98, v20, 5
    v_readlane_b32 s100, v20, 6
    v_readlane_b32 s89, v20, 7
    s_and_b32 s95, s61, 3
    s_lshl_b32 s95, s95, 18
    s_bfe_u32 s35, s2, 0x20005
    s_lshl_b32 s35, s35, 1
    s_lshr_b32 s91, s2, 7
    s_add_u32 s35, s35, s91
    s_getreg_b32 s91, hwreg(HW_REG_XCC_ID, 0, 4)
    v_and_b32 v24, 1, v0
    v_cmp_eq_u32 vcc, 0, v24
    v_mov_b32 v25, s91
    s_nop 0
    v_cndmask_b32 v25, v25, v21, vcc
    v_mul_f32 v20, s89, v116
    v_mul_f32 v21, s89, v117
    s_mul_i32 s34, s60, 4096
    s_mul_i32 s35, s35, 512
    s_add_u32 s34, s34, s35
    s_add_u32 s34, s34, s95
    s_add_u32 s34, s34, 147456
    v_lshl_add_u32 v26, v0, 2, s34
    v_lshlrev_b32 v19, 3, v0
    v_add_u32 v19, 99328, v19
    v_lshlrev_b32 v18, 4, v0
    v_add_u32 v18, 131328, v18
    s_mov_b32 s36, s12
    s_mov_b32 s37, s13
    s_mov_b32 s38, 5242880
    s_and_b32 s34, s61, 24
    s_add_u32 s34, s34, s60
    s_mul_i32 s34, s34, 163840
    s_and_b32 s35, s61, 7
    s_mul_i32 s35, s35, 20480
    s_add_u32 s34, s34, s35
    v_lshl_add_u32 v195, v0, 6, s34
    s_mov_b32 s34, 0
    s_barrier
    buffer_load_dword v250, v195, s[36:39], s34 offen
    s_add_u32 s34, s34, 4096
    buffer_load_dword v250, v195, s[36:39], s34 offen
    s_add_u32 s34, s34, 4096
    buffer_load_dword v250, v195, s[36:39], s34 offen
    s_add_u32 s34, s34, 4096
    buffer_load_dword v250, v195, s[36:39], s34 offen
    s_add_u32 s34, s34, 4096
    buffer_load_dword v250, v195, s[36:39], s34 offen
    s_add_u32 s34, s34, 4096
    s_cmp_lt_u32 s63, 1
    s_cbranch_scc1 L_nopf
    buffer_load_dword v250, v197, s[52:55], s42 offen
    s_add_u32 s42, s42, s40
    buffer_load_dword v250, v197, s[52:55], s42 offen
    s_add_u32 s42, s42, s41
L_nopf:
    s_cmp_eq_u32 s97, 0
    s_barrier
    ds_read_b64 v[32:33], v19 offset:0
    ds_read_b64 v[34:35], v19 offset:1024
    ds_read_b64 v[36:37], v19 offset:2048
    ds_read_b64 v[38:39], v19 offset:3072
    ds_read_b64 v[40:41], v19 offset:4096
    ds_read_b64 v[42:43], v19 offset:5120
    ds_read_b64 v[44:45], v19 offset:6144
    buffer_store_dword v25, v26, s[44:47], 0 offen offset:256
    s_waitcnt lgkmcnt(6)
    v_pk_fma_f32 v[20:21], v[32:33], s[88:89], v[20:21] op_sel_hi:[1,0,1]
    s_waitcnt lgkmcnt(5)
    v_pk_fma_f32 v[20:21], v[34:35], s[90:91], v[20:21] op_sel_hi:[1,0,1]
    s_waitcnt lgkmcnt(4)
    v_pk_fma_f32 v[20:21], v[36:37], s[92:93], v[20:21] op_sel_hi:[1,0,1]
    s_waitcnt lgkmcnt(3)
    v_pk_fma_f32 v[20:21], v[38:39], s[94:95], v[20:21] op_sel_hi:[1,0,1]
    s_waitcnt lgkmcnt(2)
    v_pk_fma_f32 v[20:21], v[40:41], s[96:97], v[20:21] op_sel_hi:[1,0,1]
    s_waitcnt lgkmcnt(1)
    v_pk_fma_f32 v[20:21], v[42:43], s[98:99], v[20:21] op_sel_hi:[1,0,1]
    s_waitcnt lgkmcnt(0)
    v_pk_fma_f32 v[20:21], v[44:45], s[100:101], v[20:21] op_sel_hi:[1,0,1]
    v_cvt_pk_bf16_f32 v24, v20, v21
    v_min_u32 v24, -2, v24
    buffer_store_dword v24, v26, s[44:47], 0 offen
    s_cbranch_scc1 L_ostd
    buffer_store_dword v24, v26, s[44:47], 0 offen sc1
    buffer_store_dword v25, v26, s[44:47], 0 offen offset:256 sc1
L_ostd:
    ds_write_b96 v18, v[24:26]
    s_waitcnt lgkmcnt(0)
    s_cmp_lt_u32 s63, 1
    s_cbranch_scc1 L_nopf2
    buffer_load_dword v250, v197, s[52:55], s42 offen
    s_add_u32 s42, s42, s40
    buffer_load_dword v250, v197, s[52:55], s42 offen
    s_add_u32 s42, s42, s41
    buffer_load_dword v250, v197, s[52:55], s42 offen
    s_add_u32 s42, s42, s40
    buffer_load_dword v250, v197, s[52:55], s42 offen
    s_add_u32 s42, s42, s41
    buffer_load_dword v250, v197, s[52:55], s42 offen
    s_add_u32 s42, s42, s40
    buffer_load_dword v250, v197, s[52:55], s42 offen
    s_add_u32 s42, s42, s41
    buffer_load_dword v250, v197, s[52:55], s42 offen
    s_add_u32 s42, s42, s40
    buffer_load_dword v250, v197, s[52:55], s42 offen
    s_add_u32 s42, s42, s41
L_nopf2:
    s_barrier
    s_cmp_eq_u32 s63, 0
    s_cbranch_scc1 L_r_wo2
    buffer_load_dword v250, v197, s[52:55], s42 offen
    s_add_u32 s42, s42, s40
    s_cmp_eq_u32 s63, 1
    s_cbranch_scc1 L_r_w1
    buffer_load_dword v250, v197, s[52:55], s42 offen
    s_add_u32 s42, s42, s40
    buffer_load_dword v250, v197, s[52:55], s42 offen
    s_add_u32 s42, s42, s41
    buffer_load_dword v250, v197, s[52:55], s42 offen
    s_add_u32 s42, s42, s40
    buffer_load_dword v250, v197, s[52:55], s42 offen
    s_add_u32 s42, s42, s41
    s_cmp_eq_u32 s63, 2
    s_cbranch_scc1 L_w2_red
    s_waitcnt vmcnt(0)
    s_mov_b64 exec, -1
    v_lshlrev_b32 v243, 4, v0
    v_add_u32 v243, 131328, v243
    ds_read_b96 v[240:242], v243
    s_waitcnt lgkmcnt(0)
    buffer_store_dword v240, v242, s[44:47], 0 offen sc1
    buffer_store_dword v241, v242, s[44:47], 0 offen offset:256 sc1
    s_branch L_fin
L_stream:
    s_sub_u32 s49, s3, 1
    s_lshl_b32 s49, s49, 12
    v_lshl_add_u32 v1, v0, 4, s49
    s_and_b32 s34, s2, 127
    s_lshl_b32 s34, s34, 21
    s_lshr_b32 s35, s2, 7
    s_lshl_b32 s35, s35, 18
    s_add_u32 s34, s34, s35
    s_add_u32 s34, s34, 1572864
    s_mov_b32 s38, 0x40000
    s_mov_b32 s42, 0x40000
    s_waitcnt lgkmcnt(0)
    s_add_u32 s36, s6, s34
    s_addc_u32 s37, s7, 0
    s_add_u32 s40, s8, s34
    s_addc_u32 s41, s9, 0
    s_barrier
    s_waitcnt vmcnt(2)
    s_mov_b32 s49, 0
    buffer_load_dwordx4 v[28:31], v1, s[36:39], s49 offen offset:3072 nt
    s_waitcnt vmcnt(2)
    s_mov_b32 s49, 28672
    buffer_load_dwordx4 v[32:35], v1, s[36:39], s49 offen offset:0 nt
    s_waitcnt vmcnt(2)
    buffer_load_dwordx4 v[36:39], v1, s[36:39], s49 offen offset:1024 nt
    s_waitcnt vmcnt(2)
    buffer_load_dwordx4 v[40:43], v1, s[36:39], s49 offen offset:2048 nt
    s_waitcnt vmcnt(2)
    buffer_load_dwordx4 v[44:47], v1, s[36:39], s49 offen offset:3072 nt
    s_add_u32 s44, s32, 0
    s_addc_u32 s45, s33, 0
    s_mov_b32 s63, 0
    s_mov_b32 s62, s61
    s_cmp_lt_u32 s61, 20
    s_cbranch_scc1 L_rd39
    s_mul_i32 s62, s60, 12
    s_add_u32 s62, s62, s61
    s_sub_u32 s62, s62, 20
    s_mov_b32 s63, 1
    s_cmp_lt_u32 s62, 54
    s_cbranch_scc1 L_rd39
    s_cmp_lt_u32 s62, 56
    s_cselect_b32 s63, 3, 2
    s_sub_u32 s62, s62, 56
L_rd39:
    v_and_b32 v8, 3, v0
    v_bfe_u32 v9, v0, 2, 2
    v_lshrrev_b32 v10, 4, v0
    s_mov_b32 s55, 0x20000
    s_lshl_b32 s35, s62, 6
    s_and_b32 s49, s62, 1
    s_cmp_eq_u32 s63, 0
    s_cbranch_scc1 L_dp41
    s_cmp_eq_u32 s63, 1
    s_cbranch_scc1 L_dp42
    s_mov_b32 s52, s20
    s_mov_b32 s53, s21
    s_mov_b32 s54, 2211840
    v_mov_b32 v15, 0
    s_branch L_dp43
L_dp42:
    s_mov_b32 s52, s16
    s_mov_b32 s53, s17
    s_mov_b32 s54, 2211840
    v_lshl_add_u32 v15, v9, 3, v10
    v_mul_u32_u24 v15, 3456, v15
    v_lshl_add_u32 v15, v8, 4, v15
    v_add_u32 v15, s35, v15
    s_bfe_u32 s50, s3, 0x10001
    s_lshl_b32 s50, s50, 7
    s_and_b32 s34, s3, 1
    s_lshl_b32 s34, s34, 2
    s_add_u32 s50, s50, s34
    s_and_b32 s51, s3, 3
    s_lshl_b32 s51, s51, 5
    s_add_u32 s51, s51, 512
    s_mul_i32 s50, s50, 3456
    s_mul_i32 s51, s51, 3456
    s_branch L_dp43
L_dp41:
    s_mov_b32 s52, s12
    s_mov_b32 s53, s13
    s_mov_b32 s54, 5242880
    s_lshr_b32 s50, s3, 1
    s_lshl_b32 s50, s50, 3
    s_add_u32 s50, s50, s60
    s_and_b32 s51, s3, 1
    s_lshl_b32 s34, s50, 1
    s_add_u32 s34, s34, s51
    s_mul_i32 s34, s34, 81920
    s_add_u32 s34, s34, s35
    v_lshl_add_u32 v15, v9, 2, v10
    v_mul_u32_u24 v15, 2560, v15
    v_lshl_add_u32 v15, v8, 4, v15
    v_add_u32 v15, s34, v15
    s_lshl_b32 s56, s3, 12
    s_lshl_b32 s34, s49, 11
    s_add_u32 s56, s56, s34
    s_add_u32 s56, s56, 40960
    s_add_u32 s58, s56, 1024
    s_mul_i32 s57, s49, 40960
    s_add_u32 s59, s57, 1280
L_dp43:
    v_and_b32 v2, 15, v0
    v_lshlrev_b32 v2, 4, v2
    v_add_u32 v2, 98304, v2
    s_waitcnt vmcnt(2)
    s_mov_b32 s49, 57344
    buffer_load_dwordx4 v[48:51], v1, s[36:39], s49 offen offset:0 nt
    s_waitcnt vmcnt(2)
    buffer_load_dwordx4 v[52:55], v1, s[36:39], s49 offen offset:1024 nt
    s_waitcnt vmcnt(2)
    s_cmp_ge_u32 s3, 4
    s_cbranch_scc1 L_sl44
    s_waitcnt vmcnt(1)
L_sl44:
    buffer_load_dwordx4 v[56:59], v1, s[36:39], s49 offen offset:2048 nt
    s_waitcnt vmcnt(2)
    s_cmp_ge_u32 s3, 4
    s_cbranch_scc1 L_sl45
    s_waitcnt vmcnt(1)
L_sl45:
    buffer_load_dwordx4 v[60:63], v1, s[36:39], s49 offen offset:3072 nt
    s_waitcnt vmcnt(2)
    s_cmp_ge_u32 s3, 4
    s_cbranch_scc1 L_sl46
    s_waitcnt vmcnt(1)
L_sl46:
    s_mov_b32 s49, 86016
    buffer_load_dwordx4 v[64:67], v1, s[36:39], s49 offen offset:0 nt
    s_waitcnt vmcnt(2)
    buffer_load_dwordx4 v[68:71], v1, s[36:39], s49 offen offset:1024 nt
    s_waitcnt vmcnt(2)
    buffer_load_dwordx4 v[72:75], v1, s[36:39], s49 offen offset:2048 nt
    s_waitcnt vmcnt(2)
    buffer_load_dwordx4 v[76:79], v1, s[36:39], s49 offen offset:3072 nt
    s_waitcnt vmcnt(2)
    s_mov_b32 s49, 114688
    buffer_load_dwordx4 v[80:83], v1, s[36:39], s49 offen offset:0 nt
    s_waitcnt vmcnt(2)
    buffer_load_dwordx4 v[84:87], v1, s[36:39], s49 offen offset:1024 nt
    s_waitcnt vmcnt(2)
    buffer_load_dwordx4 v[88:91], v1, s[36:39], s49 offen offset:2048 nt
    s_waitcnt vmcnt(2)
    buffer_load_dwordx4 v[92:95], v1, s[36:39], s49 offen offset:3072 nt
    s_waitcnt vmcnt(2)
    s_mov_b32 s49, 143360
    buffer_load_dwordx4 v[96:99], v1, s[36:39], s49 offen offset:0 nt
    v_mov_b32 v3, 21
    ds_write_b32 v2, v3 offset:768
    s_waitcnt vmcnt(2)
    buffer_load_dwordx4 v[100:103], v1, s[36:39], s49 offen offset:1024 nt
    s_waitcnt vmcnt(2)
    buffer_load_dwordx4 v[104:107], v1, s[36:39], s49 offen offset:2048 nt
    s_waitcnt vmcnt(2)
    buffer_load_dwordx4 v[108:111], v1, s[36:39], s49 offen offset:3072 nt
    s_waitcnt vmcnt(2)
    s_mov_b32 s49, 172032
    buffer_load_dwordx4 v[112:115], v1, s[36:39], s49 offen offset:0 nt
    s_waitcnt vmcnt(2)
    buffer_load_dwordx4 v[116:119], v1, s[36:39], s49 offen offset:1024 nt
    s_waitcnt vmcnt(2)
    buffer_load_dwordx4 v[120:123], v1, s[36:39], s49 offen offset:2048 nt
    s_waitcnt vmcnt(2)
    buffer_load_dwordx4 v[124:127], v1, s[36:39], s49 offen offset:3072 nt
    s_waitcnt vmcnt(2)
    s_mov_b32 s49, 200704
    buffer_load_dwordx4 v[128:131], v1, s[36:39], s49 offen offset:0 nt
    s_waitcnt vmcnt(2)
    buffer_load_dwordx4 v[132:135], v1, s[36:39], s49 offen offset:1024 nt
    s_waitcnt vmcnt(2)
    buffer_load_dwordx4 v[136:139], v1, s[36:39], s49 offen offset:2048 nt
    s_waitcnt vmcnt(2)
    buffer_load_dwordx4 v[140:143], v1, s[36:39], s49 offen offset:3072 nt
    s_waitcnt vmcnt(2)
    s_mov_b32 s49, 229376
    buffer_load_dwordx4 v[144:147], v1, s[36:39], s49 offen offset:0 nt
    v_mov_b32 v3, 33
    ds_write_b32 v2, v3 offset:768
    s_waitcnt vmcnt(2)
    buffer_load_dwordx4 v[148:151], v1, s[36:39], s49 offen offset:1024 nt
    s_waitcnt vmcnt(2)
    buffer_load_dwordx4 v[152:155], v1, s[36:39], s49 offen offset:2048 nt
    s_waitcnt vmcnt(2)
    buffer_load_dwordx4 v[156:159], v1, s[36:39], s49 offen offset:3072 nt
    s_waitcnt vmcnt(2)
    s_mov_b32 s49, 0
    buffer_load_dwordx4 v[160:163], v1, s[40:43], s49 offen offset:0 nt
    s_waitcnt vmcnt(2)
    buffer_load_dwordx4 v[164:167], v1, s[40:43], s49 offen offset:1024 nt
    s_waitcnt vmcnt(2)
    buffer_load_dwordx4 v[168:171], v1, s[40:43], s49 offen offset:2048 nt
    s_waitcnt vmcnt(2)
    buffer_load_dwordx4 v[172:175], v1, s[40:43], s49 offen offset:3072 nt
    s_waitcnt vmcnt(2)
    s_mov_b32 s49, 28672
    buffer_load_dwordx4 v[176:179], v1, s[40:43], s49 offen offset:0 nt
    s_waitcnt vmcnt(2)
    buffer_load_dwordx4 v[180:183], v1, s[40:43], s49 offen offset:1024 nt
    s_waitcnt vmcnt(2)
    buffer_load_dwordx4 v[184:187], v1, s[40:43], s49 offen offset:2048 nt
    s_waitcnt vmcnt(2)
    buffer_load_dwordx4 v[188:191], v1, s[40:43], s49 offen offset:3072 nt
    s_waitcnt vmcnt(2)
    s_mov_b32 s49, 57344
    buffer_load_dwordx4 v[192:195], v1, s[40:43], s49 offen offset:0 nt
    s_waitcnt vmcnt(2)
    buffer_load_dwordx4 v[196:199], v1, s[40:43], s49 offen offset:1024 nt
    s_waitcnt vmcnt(2)
    buffer_load_dwordx4 v[200:203], v1, s[40:43], s49 offen offset:2048 nt
    s_waitcnt vmcnt(2)
    buffer_load_dwordx4 v[204:207], v1, s[40:43], s49 offen offset:3072 nt
    s_waitcnt vmcnt(2)
    s_mov_b32 s49, 86016
    buffer_load_dwordx4 v[208:211], v1, s[40:43], s49 offen offset:0 nt
    s_waitcnt vmcnt(2)
    buffer_load_dwordx4 v[212:215], v1, s[40:43], s49 offen offset:1024 nt
    s_waitcnt vmcnt(2)
    buffer_load_dwordx4 v[216:219], v1, s[40:43], s49 offen offset:2048 nt
    s_waitcnt vmcnt(2)
    buffer_load_dwordx4 v[220:223], v1, s[40:43], s49 offen offset:3072 nt
    s_waitcnt vmcnt(2)
    s_mov_b32 s49, 114688
    buffer_load_dwordx4 v[224:227], v1, s[40:43], s49 offen offset:0 nt
    s_waitcnt vmcnt(2)
    buffer_load_dwordx4 v[228:231], v1, s[40:43], s49 offen offset:1024 nt
    s_waitcnt vmcnt(2)
    buffer_load_dwordx4 v[232:235], v1, s[40:43], s49 offen offset:2048 nt
    s_waitcnt vmcnt(2)
    buffer_load_dwordx4 v[236:239], v1, s[40:43], s49 offen offset:3072 nt
    v_mov_b32 v14, 99080
    s_mov_b32 s35, 0
L_poll47:
    ds_read_b128 v[4:7], v2
    ds_read_b32 v8, v14
    s_add_u32 s35, s35, 1
    s_waitcnt lgkmcnt(0)
    v_max3_u32 v3, v4, v5, v6
    v_max_u32 v3, v3, v7
    v_cmp_eq_u32 vcc, -1, v3
    s_cbranch_vccz L_done48
    s_sleep 2
    s_cmp_lt_u32 s35, 60000
    s_cbranch_scc1 L_poll47
L_done48:
    v_readfirstlane_b32 s99, v8
    s_waitcnt vmcnt(2)
    s_mov_b32 s49, 143360
    buffer_load_dwordx4 v[240:243], v1, s[40:43], s49 offen offset:0 nt
    v_dot2_f32_bf16 v8, v16, v4, 0
    v_dot2_f32_bf16 v9, v20, v4, 0
    v_dot2_f32_bf16 v10, v24, v4, 0
    v_dot2_f32_bf16 v11, v28, v4, 0
    v_dot2c_f32_bf16 v8, v17, v5
    v_dot2c_f32_bf16 v9, v21, v5
    v_dot2c_f32_bf16 v10, v25, v5
    v_dot2c_f32_bf16 v11, v29, v5
    v_dot2c_f32_bf16 v8, v18, v6
    v_dot2c_f32_bf16 v9, v22, v6
    v_dot2c_f32_bf16 v10, v26, v6
    v_dot2c_f32_bf16 v11, v30, v6
    v_dot2c_f32_bf16 v8, v19, v7
    v_dot2c_f32_bf16 v9, v23, v7
    v_dot2c_f32_bf16 v10, v27, v7
    v_dot2c_f32_bf16 v11, v31, v7
    v_add_f32_dpp v12, v8, v8 row_ror:8 row_mask:0xf bank_mask:0x3
    v_add_f32_dpp v12, v9, v9 row_ror:8 row_mask:0xf bank_mask:0xc
    v_add_f32_dpp v13, v10, v10 row_ror:8 row_mask:0xf bank_mask:0x3
    v_add_f32_dpp v13, v11, v11 row_ror:8 row_mask:0xf bank_mask:0xc
    v_dot2_f32_bf16 v8, v32, v4, 0
    v_dot2_f32_bf16 v9, v36, v4, 0
    v_dot2_f32_bf16 v10, v40, v4, 0
    v_dot2_f32_bf16 v11, v44, v4, 0
    v_add_f32_dpp v12, v12, v12 row_half_mirror row_mask:0xf bank_mask:0xf
    v_add_f32_dpp v13, v13, v13 row_half_mirror row_mask:0xf bank_mask:0xf
    v_dot2c_f32_bf16 v8, v33, v5
    v_dot2c_f32_bf16 v9, v37, v5
    v_dot2c_f32_bf16 v10, v41, v5
    v_dot2c_f32_bf16 v11, v45, v5
    v_add_f32_dpp v12, v12, v12 quad_perm:[1,0,3,2] row_mask:0xf bank_mask:0xf
    v_add_f32_dpp v13, v13, v13 quad_perm:[1,0,3,2] row_mask:0xf bank_mask:0xf
    v_dot2c_f32_bf16 v8, v34, v6
    v_dot2c_f32_bf16 v9, v38, v6
    v_dot2c_f32_bf16 v10, v42, v6
    v_dot2c_f32_bf16 v11, v46, v6
    s_waitcnt vmcnt(2)
    buffer_load_dwordx4 v[244:247], v1, s[40:43], s49 offen offset:1024 nt
    v_add_f32_dpp v12, v12, v12 quad_perm:[2,3,0,1] row_mask:0xf bank_mask:0xf
    v_add_f32_dpp v13, v13, v13 quad_perm:[2,3,0,1] row_mask:0xf bank_mask:0xf
    v_dot2c_f32_bf16 v8, v35, v7
    v_dot2c_f32_bf16 v9, v39, v7
    v_dot2c_f32_bf16 v10, v43, v7
    v_dot2c_f32_bf16 v11, v47, v7
    v_add_f32_dpp v16, v8, v8 row_ror:8 row_mask:0xf bank_mask:0x3
    v_add_f32_dpp v16, v9, v9 row_ror:8 row_mask:0xf bank_mask:0xc
    v_add_f32_dpp v17, v10, v10 row_ror:8 row_mask:0xf bank_mask:0x3
    v_add_f32_dpp v17, v11, v11 row_ror:8 row_mask:0xf bank_mask:0xc
    v_dot2_f32_bf16 v8, v48, v4, 0
    v_dot2_f32_bf16 v9, v52, v4, 0
    v_dot2_f32_bf16 v10, v56, v4, 0
    v_dot2_f32_bf16 v11, v60, v4, 0
    v_add_f32_dpp v16, v16, v16 row_half_mirror row_mask:0xf bank_mask:0xf
    v_add_f32_dpp v17, v17, v17 row_half_mirror row_mask:0xf bank_mask:0xf
    v_dot2c_f32_bf16 v8, v49, v5
    v_dot2c_f32_bf16 v9, v53, v5
    v_dot2c_f32_bf16 v10, v57, v5
    v_dot2c_f32_bf16 v11, v61, v5
    v_add_f32_dpp v16, v16, v16 quad_perm:[1,0,3,2] row_mask:0xf bank_mask:0xf
    v_add_f32_dpp v17, v17, v17 quad_perm:[1,0,3,2] row_mask:0xf bank_mask:0xf
    v_dot2c_f32_bf16 v8, v50, v6
    v_dot2c_f32_bf16 v9, v54, v6
    v_dot2c_f32_bf16 v10, v58, v6
    v_dot2c_f32_bf16 v11, v62, v6
    v_add_f32_dpp v16, v16, v16 quad_perm:[2,3,0,1] row_mask:0xf bank_mask:0xf
    v_add_f32_dpp v17, v17, v17 quad_perm:[2,3,0,1] row_mask:0xf bank_mask:0xf
    v_dot2c_f32_bf16 v8, v51, v7
    v_dot2c_f32_bf16 v9, v55, v7
    v_dot2c_f32_bf16 v10, v59, v7
    v_dot2c_f32_bf16 v11, v63, v7
    v_add_f32_dpp v18, v8, v8 row_ror:8 row_mask:0xf bank_mask:0x3
    v_add_f32_dpp v18, v9, v9 row_ror:8 row_mask:0xf bank_mask:0xc
    v_add_f32_dpp v19, v10, v10 row_ror:8 row_mask:0xf bank_mask:0x3
    v_add_f32_dpp v19, v11, v11 row_ror:8 row_mask:0xf bank_mask:0xc
    s_waitcnt vmcnt(2)
    buffer_load_dwordx4 v[248:251], v1, s[40:43], s49 offen offset:2048 nt
    v_dot2_f32_bf16 v8, v64, v4, 0
    v_dot2_f32_bf16 v9, v68, v4, 0
    v_dot2_f32_bf16 v10, v72, v4, 0
    v_dot2_f32_bf16 v11, v76, v4, 0
    v_add_f32_dpp v18, v18, v18 row_half_mirror row_mask:0xf bank_mask:0xf
    v_add_f32_dpp v19, v19, v19 row_half_mirror row_mask:0xf bank_mask:0xf
    v_dot2c_f32_bf16 v8, v65, v5
    v_dot2c_f32_bf16 v9, v69, v5
    v_dot2c_f32_bf16 v10, v73, v5
    v_dot2c_f32_bf16 v11, v77, v5
    v_add_f32_dpp v18, v18, v18 quad_perm:[1,0,3,2] row_mask:0xf bank_mask:0xf
    v_add_f32_dpp v19, v19, v19 quad_perm:[1,0,3,2] row_mask:0xf bank_mask:0xf
    v_dot2c_f32_bf16 v8, v66, v6
    v_dot2c_f32_bf16 v9, v70, v6
    v_dot2c_f32_bf16 v10, v74, v6
    v_dot2c_f32_bf16 v11, v78, v6
    v_add_f32_dpp v18, v18, v18 quad_perm:[2,3,0,1] row_mask:0xf bank_mask:0xf
    v_add_f32_dpp v19, v19, v19 quad_perm:[2,3,0,1] row_mask:0xf bank_mask:0xf
    v_dot2c_f32_bf16 v8, v67, v7
    v_dot2c_f32_bf16 v9, v71, v7
    v_dot2c_f32_bf16 v10, v75, v7
    v_dot2c_f32_bf16 v11, v79, v7
    v_add_f32_dpp v20, v8, v8 row_ror:8 row_mask:0xf bank_mask:0x3
    v_add_f32_dpp v20, v9, v9 row_ror:8 row_mask:0xf bank_mask:0xc
    v_add_f32_dpp v21, v10, v10 row_ror:8 row_mask:0xf bank_mask:0x3
    v_add_f32_dpp v21, v11, v11 row_ror:8 row_mask:0xf bank_mask:0xc
    v_dot2_f32_bf16 v8, v80, v4, 0
    v_dot2_f32_bf16 v9, v84, v4, 0
    v_dot2_f32_bf16 v10, v88, v4, 0
    v_dot2_f32_bf16 v11, v92, v4, 0
    v_add_f32_dpp v20, v20, v20 row_half_mirror row_mask:0xf bank_mask:0xf
    v_add_f32_dpp v21, v21, v21 row_half_mirror row_mask:0xf bank_mask:0xf
    v_dot2c_f32_bf16 v8, v81, v5
    v_dot2c_f32_bf16 v9, v85, v5
    v_dot2c_f32_bf16 v10, v89, v5
    v_dot2c_f32_bf16 v11, v93, v5
    s_waitcnt vmcnt(2)
    buffer_load_dwordx4 v[252:255], v1, s[40:43], s49 offen offset:3072 nt
    v_add_f32_dpp v20, v20, v20 quad_perm:[1,0,3,2] row_mask:0xf bank_mask:0xf
    v_add_f32_dpp v21, v21, v21 quad_perm:[1,0,3,2] row_mask:0xf bank_mask:0xf
    v_dot2c_f32_bf16 v8, v82, v6
    v_dot2c_f32_bf16 v9, v86, v6
    v_dot2c_f32_bf16 v10, v90, v6
    v_dot2c_f32_bf16 v11, v94, v6
    v_add_f32_dpp v20, v20, v20 quad_perm:[2,3,0,1] row_mask:0xf bank_mask:0xf
    v_add_f32_dpp v21, v21, v21 quad_perm:[2,3,0,1] row_mask:0xf bank_mask:0xf
    v_dot2c_f32_bf16 v8, v83, v7
    v_dot2c_f32_bf16 v9, v87, v7
    v_dot2c_f32_bf16 v10, v91, v7
    v_dot2c_f32_bf16 v11, v95, v7
    v_add_f32_dpp v22, v8, v8 row_ror:8 row_mask:0xf bank_mask:0x3
    v_add_f32_dpp v22, v9, v9 row_ror:8 row_mask:0xf bank_mask:0xc
    v_add_f32_dpp v23, v10, v10 row_ror:8 row_mask:0xf bank_mask:0x3
    v_add_f32_dpp v23, v11, v11 row_ror:8 row_mask:0xf bank_mask:0xc
    v_dot2_f32_bf16 v8, v96, v4, 0
    v_dot2_f32_bf16 v9, v100, v4, 0
    v_dot2_f32_bf16 v10, v104, v4, 0
    v_dot2_f32_bf16 v11, v108, v4, 0
    v_add_f32_dpp v22, v22, v22 row_half_mirror row_mask:0xf bank_mask:0xf
    v_add_f32_dpp v23, v23, v23 row_half_mirror row_mask:0xf bank_mask:0xf
    v_dot2c_f32_bf16 v8, v97, v5
    v_dot2c_f32_bf16 v9, v101, v5
    v_dot2c_f32_bf16 v10, v105, v5
    v_dot2c_f32_bf16 v11, v109, v5
    v_add_f32_dpp v22, v22, v22 quad_perm:[1,0,3,2] row_mask:0xf bank_mask:0xf
    v_add_f32_dpp v23, v23, v23 quad_perm:[1,0,3,2] row_mask:0xf bank_mask:0xf
    v_dot2c_f32_bf16 v8, v98, v6
    v_dot2c_f32_bf16 v9, v102, v6
    v_dot2c_f32_bf16 v10, v106, v6
    v_dot2c_f32_bf16 v11, v110, v6
    v_add_f32_dpp v22, v22, v22 quad_perm:[2,3,0,1] row_mask:0xf bank_mask:0xf
    v_add_f32_dpp v23, v23, v23 quad_perm:[2,3,0,1] row_mask:0xf bank_mask:0xf
    v_dot2c_f32_bf16 v8, v99, v7
    v_dot2c_f32_bf16 v9, v103, v7
    s_waitcnt vmcnt(2)
    s_mov_b32 s49, 172032
    buffer_load_dwordx4 v[32:35], v1, s[40:43], s49 offen offset:0 nt
    v_dot2c_f32_bf16 v10, v107, v7
    v_dot2c_f32_bf16 v11, v111, v7
    v_add_f32_dpp v24, v8, v8 row_ror:8 row_mask:0xf bank_mask:0x3
    v_add_f32_dpp v24, v9, v9 row_ror:8 row_mask:0xf bank_mask:0xc
    v_add_f32_dpp v25, v10, v10 row_ror:8 row_mask:0xf bank_mask:0x3
    v_add_f32_dpp v25, v11, v11 row_ror:8 row_mask:0xf bank_mask:0xc
    v_dot2_f32_bf16 v8, v112, v4, 0
    v_dot2_f32_bf16 v9, v116, v4, 0
    v_dot2_f32_bf16 v10, v120, v4, 0
    v_dot2_f32_bf16 v11, v124, v4, 0
    v_add_f32_dpp v24, v24, v24 row_half_mirror row_mask:0xf bank_mask:0xf
    v_add_f32_dpp v25, v25, v25 row_half_mirror row_mask:0xf bank_mask:0xf
    v_dot2c_f32_bf16 v8, v113, v5
    v_dot2c_f32_bf16 v9, v117, v5
    v_dot2c_f32_bf16 v10, v121, v5
    v_dot2c_f32_bf16 v11, v125, v5
    v_add_f32_dpp v24, v24, v24 quad_perm:[1,0,3,2] row_mask:0xf bank_mask:0xf
    v_add_f32_dpp v25, v25, v25 quad_perm:[1,0,3,2] row_mask:0xf bank_mask:0xf
    v_dot2c_f32_bf16 v8, v114, v6
    v_dot2c_f32_bf16 v9, v118, v6
    v_dot2c_f32_bf16 v10, v122, v6
    v_dot2c_f32_bf16 v11, v126, v6
    v_add_f32_dpp v24, v24, v24 quad_perm:[2,3,0,1] row_mask:0xf bank_mask:0xf
    v_add_f32_dpp v25, v25, v25 quad_perm:[2,3,0,1] row_mask:0xf bank_mask:0xf
    v_dot2c_f32_bf16 v8, v115, v7
    v_dot2c_f32_bf16 v9, v119, v7
    v_dot2c_f32_bf16 v10, v123, v7
    v_dot2c_f32_bf16 v11, v127, v7
    v_add_f32_dpp v26, v8, v8 row_ror:8 row_mask:0xf bank_mask:0x3
    v_add_f32_dpp v26, v9, v9 row_ror:8 row_mask:0xf bank_mask:0xc
    v_add_f32_dpp v27, v10, v10 row_ror:8 row_mask:0xf bank_mask:0x3
    v_add_f32_dpp v27, v11, v11 row_ror:8 row_mask:0xf bank_mask:0xc
    v_dot2_f32_bf16 v8, v128, v4, 0
    v_dot2_f32_bf16 v9, v132, v4, 0
    v_dot2_f32_bf16 v10, v136, v4, 0
    v_dot2_f32_bf16 v11, v140, v4, 0
    s_waitcnt vmcnt(2)
    buffer_load_dwordx4 v[36:39], v1, s[40:43], s49 offen offset:1024 nt
    v_add_f32_dpp v26, v26, v26 row_half_mirror row_mask:0xf bank_mask:0xf
    v_add_f32_dpp v27, v27, v27 row_half_mirror row_mask:0xf bank_mask:0xf
    v_dot2c_f32_bf16 v8, v129, v5
    v_dot2c_f32_bf16 v9, v133, v5
    v_dot2c_f32_bf16 v10, v137, v5
    v_dot2c_f32_bf16 v11, v141, v5
    v_add_f32_dpp v26, v26, v26 quad_perm:[1,0,3,2] row_mask:0xf bank_mask:0xf
    v_add_f32_dpp v27, v27, v27 quad_perm:[1,0,3,2] row_mask:0xf bank_mask:0xf
    v_dot2c_f32_bf16 v8, v130, v6
    v_dot2c_f32_bf16 v9, v134, v6
    v_dot2c_f32_bf16 v10, v138, v6
    v_dot2c_f32_bf16 v11, v142, v6
    v_add_f32_dpp v26, v26, v26 quad_perm:[2,3,0,1] row_mask:0xf bank_mask:0xf
    v_add_f32_dpp v27, v27, v27 quad_perm:[2,3,0,1] row_mask:0xf bank_mask:0xf
    v_dot2c_f32_bf16 v8, v131, v7
    v_dot2c_f32_bf16 v9, v135, v7
    v_dot2c_f32_bf16 v10, v139, v7
    v_dot2c_f32_bf16 v11, v143, v7
    v_add_f32_dpp v28, v8, v8 row_ror:8 row_mask:0xf bank_mask:0x3
    v_add_f32_dpp v28, v9, v9 row_ror:8 row_mask:0xf bank_mask:0xc
    v_add_f32_dpp v29, v10, v10 row_ror:8 row_mask:0xf bank_mask:0x3
    v_add_f32_dpp v29, v11, v11 row_ror:8 row_mask:0xf bank_mask:0xc
    v_dot2_f32_bf16 v8, v144, v4, 0
    v_dot2_f32_bf16 v9, v148, v4, 0
    v_dot2_f32_bf16 v10, v152, v4, 0
    v_dot2_f32_bf16 v11, v156, v4, 0
    v_add_f32_dpp v28, v28, v28 row_half_mirror row_mask:0xf bank_mask:0xf
    v_add_f32_dpp v29, v29, v29 row_half_mirror row_mask:0xf bank_mask:0xf
    v_dot2c_f32_bf16 v8, v145, v5
    v_dot2c_f32_bf16 v9, v149, v5
    v_dot2c_f32_bf16 v10, v153, v5
    v_dot2c_f32_bf16 v11, v157, v5
    v_add_f32_dpp v28, v28, v28 quad_perm:[1,0,3,2] row_mask:0xf bank_mask:0xf
    v_add_f32_dpp v29, v29, v29 quad_perm:[1,0,3,2] row_mask:0xf bank_mask:0xf
    v_dot2c_f32_bf16 v8, v146, v6
    v_dot2c_f32_bf16 v9, v150, v6
    s_waitcnt vmcnt(2)
    buffer_load_dwordx4 v[40:43], v1, s[40:43], s49 offen offset:2048 nt
    v_dot2c_f32_bf16 v10, v154, v6
    v_dot2c_f32_bf16 v11, v158, v6
    v_add_f32_dpp v28, v28, v28 quad_perm:[2,3,0,1] row_mask:0xf bank_mask:0xf
    v_add_f32_dpp v29, v29, v29 quad_perm:[2,3,0,1] row_mask:0xf bank_mask:0xf
    v_dot2c_f32_bf16 v8, v147, v7
    v_dot2c_f32_bf16 v9, v151, v7
    v_dot2c_f32_bf16 v10, v155, v7
    v_dot2c_f32_bf16 v11, v159, v7
    v_add_f32_dpp v30, v8, v8 row_ror:8 row_mask:0xf bank_mask:0x3
    v_add_f32_dpp v30, v9, v9 row_ror:8 row_mask:0xf bank_mask:0xc
    v_add_f32_dpp v31, v10, v10 row_ror:8 row_mask:0xf bank_mask:0x3
    v_add_f32_dpp v31, v11, v11 row_ror:8 row_mask:0xf bank_mask:0xc
    v_add_f32_dpp v30, v30, v30 row_half_mirror row_mask:0xf bank_mask:0xf
    s_nop 0
    v_add_f32_dpp v31, v31, v31 row_half_mirror row_mask:0xf bank_mask:0xf
    v_add_f32_dpp v30, v30, v30 quad_perm:[1,0,3,2] row_mask:0xf bank_mask:0xf
    s_nop 0
    v_add_f32_dpp v31, v31, v31 quad_perm:[1,0,3,2] row_mask:0xf bank_mask:0xf
    v_add_f32_dpp v30, v30, v30 quad_perm:[2,3,0,1] row_mask:0xf bank_mask:0xf
    s_nop 0
    v_add_f32_dpp v31, v31, v31 quad_perm:[2,3,0,1] row_mask:0xf bank_mask:0xf
    v_max3_f32 v8, v12, v13, v16
    v_max3_f32 v8, v8, v17, v18
    v_max3_f32 v8, v8, v19, v20
    v_max3_f32 v8, v8, v21, v22
    v_max3_f32 v8, v8, v23, v24
    v_max3_f32 v8, v8, v25, v26
    v_max3_f32 v8, v8, v27, v28
    v_max3_f32 v8, v8, v29, v30
    v_max_f32 v8, v8, v31
    s_mov_b32 s34, 0x3e0293ee
    s_nop 0
    v_max_f32_dpp v8, v8, v8 row_ror:8 row_mask:0xf bank_mask:0xf
    v_mov_b32 v9, v8
    s_nop 1
    v_permlane16_swap_b32 v8, v9
    v_max_f32 v8, v8, v9
    v_mov_b32 v9, v8
    s_nop 1
    v_permlane32_swap_b32 v8, v9
    v_max_f32 v8, v8, v9
    v_mul_f32 v8, s34, v8
    s_waitcnt vmcnt(2)
    buffer_load_dwordx4 v[44:47], v1, s[40:43], s49 offen offset:3072 nt
    v_fma_f32 v12, v12, s34, -v8
    v_fma_f32 v13, v13, s34, -v8
    v_fma_f32 v16, v16, s34, -v8
    v_fma_f32 v17, v17, s34, -v8
    v_fma_f32 v18, v18, s34, -v8
    v_fma_f32 v19, v19, s34, -v8
    v_fma_f32 v20, v20, s34, -v8
    v_fma_f32 v21, v21, s34, -v8
    v_fma_f32 v22, v22, s34, -v8
    v_fma_f32 v23, v23, s34, -v8
    v_fma_f32 v24, v24, s34, -v8
    v_fma_f32 v25, v25, s34, -v8
    v_fma_f32 v26, v26, s34, -v8
    v_fma_f32 v27, v27, s34, -v8
    v_fma_f32 v28, v28, s34, -v8
    v_fma_f32 v29, v29, s34, -v8
    v_fma_f32 v30, v30, s34, -v8
    v_fma_f32 v31, v31, s34, -v8
    v_exp_f32 v12, v12
    v_exp_f32 v13, v13
    v_exp_f32 v16, v16
    v_exp_f32 v17, v17
    v_exp_f32 v18, v18
    v_exp_f32 v19, v19
    v_exp_f32 v20, v20
    v_exp_f32 v21, v21
    v_exp_f32 v22, v22
    v_exp_f32 v23, v23
    v_exp_f32 v24, v24
    v_exp_f32 v25, v25
    v_exp_f32 v26, v26
    v_exp_f32 v27, v27
    v_exp_f32 v28, v28
    v_exp_f32 v29, v29
    v_exp_f32 v30, v30
    v_exp_f32 v31, v31
    s_waitcnt vmcnt(2)
    s_mov_b32 s49, 200704
    buffer_load_dwordx4 v[48:51], v1, s[40:43], s49 offen offset:0 nt
    v_add_f32 v9, v12, v13
    v_add_f32 v9, v9, v16
    v_add_f32 v9, v9, v17
    v_add_f32 v9, v9, v18
    v_add_f32 v9, v9, v19
    v_add_f32 v9, v9, v20
    v_add_f32 v9, v9, v21
    v_add_f32 v9, v9, v22
    v_add_f32 v9, v9, v23
    v_add_f32 v9, v9, v24
    v_add_f32 v9, v9, v25
    v_add_f32 v9, v9, v26
    v_add_f32 v9, v9, v27
    v_add_f32 v9, v9, v28
    v_add_f32 v9, v9, v29
    v_add_f32 v9, v9, v30
    v_add_f32 v9, v9, v31
    v_and_b32 v10, 1, v0
    v_lshlrev_b32 v10, 4, v10
    v_mov_b32 v11, 0xffff
    v_lshlrev_b32 v10, v10, v11
    v_bfe_u32 v11, v0, 1, 2
    v_cmp_eq_u32 vcc, 0, v11
    s_nop 1
    v_cndmask_b32 v144, 0, v10, vcc
    v_cmp_eq_u32 vcc, 1, v11
    s_nop 1
    v_cndmask_b32 v145, 0, v10, vcc
    v_cmp_eq_u32 vcc, 2, v11
    s_nop 1
    v_cndmask_b32 v146, 0, v10, vcc
    v_cmp_eq_u32 vcc, 3, v11
    s_nop 1
    v_cndmask_b32 v147, 0, v10, vcc
    v_add_f32_dpp v9, v9, v9 row_ror:8 row_mask:0xf bank_mask:0xf
    v_mov_b32 v10, v9
    s_nop 1
    v_permlane16_swap_b32 v9, v10
    v_add_f32 v9, v9, v10
    v_mov_b32 v10, v9
    s_nop 1
    v_permlane32_swap_b32 v9, v10
    s_waitcnt vmcnt(2)
    buffer_load_dwordx4 v[52:55], v1, s[40:43], s49 offen offset:1024 nt
    v_add_f32 v9, v9, v10
    s_lshl_b32 s34, s3, 3
    s_add_u32 s34, s34, 98552
    v_mov_b32 v10, s34
    s_mov_b64 exec, 1
    ds_write_b64 v10, v[8:9]
    s_mov_b64 exec, -1
    s_lshl_b32 s34, s3, 10
    s_add_u32 s34, s34, 98304
    v_lshrrev_b32 v2, 4, v0
    v_and_b32 v11, 7, v0
    v_lshl_add_u32 v2, v2, 3, v11
    v_bfe_u32 v11, v0, 3, 1
    v_lshl_add_u32 v2, v11, 5, v2
    v_lshl_add_u32 v2, v2, 4, s34
    v_cvt_pk_bf16_f32 v10, v12, v12
    v_and_b32 v128, v10, v144
    v_and_b32 v129, v10, v145
    v_and_b32 v130, v10, v146
    v_and_b32 v131, v10, v147
    s_nop 1
    v_mfma_f32_16x16x32_bf16 v[148:151], v[160:163], v[128:131], 0
    v_mfma_f32_16x16x32_bf16 v[152:155], v[164:167], v[128:131], 0
    v_cvt_pk_bf16_f32 v10, v13, v13
    v_and_b32 v132, v10, v144
    v_and_b32 v133, v10, v145
    v_and_b32 v134, v10, v146
    v_and_b32 v135, v10, v147
    s_nop 1
    v_mfma_f32_16x16x32_bf16 v[148:151], v[168:171], v[132:135], v[148:151]
    v_mfma_f32_16x16x32_bf16 v[152:155], v[172:175], v[132:135], v[152:155]
    v_cvt_pk_bf16_f32 v10, v16, v16
    v_and_b32 v128, v10, v144
    v_and_b32 v129, v10, v145
    v_and_b32 v130, v10, v146
    v_and_b32 v131, v10, v147
    s_nop 1
    v_mfma_f32_16x16x32_bf16 v[148:151], v[176:179], v[128:131], v[148:151]
    v_mfma_f32_16x16x32_bf16 v[152:155], v[180:183], v[128:131], v[152:155]
    v_cvt_pk_bf16_f32 v10, v17, v17
    v_and_b32 v132, v10, v144
    buffer_load_dwordx4 v[56:59], v1, s[40:43], s49 offen offset:2048 nt
    v_and_b32 v133, v10, v145
    v_and_b32 v134, v10, v146
    v_and_b32 v135, v10, v147
    s_nop 1
    v_mfma_f32_16x16x32_bf16 v[148:151], v[184:187], v[132:135], v[148:151]
    v_mfma_f32_16x16x32_bf16 v[152:155], v[188:191], v[132:135], v[152:155]
    v_cvt_pk_bf16_f32 v10, v18, v18
    v_and_b32 v128, v10, v144
    v_and_b32 v129, v10, v145
    v_and_b32 v130, v10, v146
    v_and_b32 v131, v10, v147
    s_nop 1
    v_mfma_f32_16x16x32_bf16 v[148:151], v[192:195], v[128:131], v[148:151]
    v_mfma_f32_16x16x32_bf16 v[152:155], v[196:199], v[128:131], v[152:155]
    v_cvt_pk_bf16_f32 v10, v19, v19
    v_and_b32 v132, v10, v144
    v_and_b32 v133, v10, v145
    v_and_b32 v134, v10, v146
    v_and_b32 v135, v10, v147
    s_nop 1
    v_mfma_f32_16x16x32_bf16 v[148:151], v[200:203], v[132:135], v[148:151]
    v_mfma_f32_16x16x32_bf16 v[152:155], v[204:207], v[132:135], v[152:155]
    v_cvt_pk_bf16_f32 v10, v20, v20
    v_and_b32 v128, v10, v144
    v_and_b32 v129, v10, v145
    v_and_b32 v130, v10, v146
    v_and_b32 v131, v10, v147
    s_nop 1
    v_mfma_f32_16x16x32_bf16 v[148:151], v[208:211], v[128:131], v[148:151]
    v_mfma_f32_16x16x32_bf16 v[152:155], v[212:215], v[128:131], v[152:155]
    v_cvt_pk_bf16_f32 v10, v21, v21
    v_and_b32 v132, v10, v144
    v_and_b32 v133, v10, v145
    v_and_b32 v134, v10, v146
    v_and_b32 v135, v10, v147
    s_nop 1
    v_mfma_f32_16x16x32_bf16 v[148:151], v[216:219], v[132:135], v[148:151]
    v_mfma_f32_16x16x32_bf16 v[152:155], v[220:223], v[132:135], v[152:155]
    v_cvt_pk_bf16_f32 v10, v22, v22
    v_and_b32 v128, v10, v144
    v_and_b32 v129, v10, v145
    s_waitcnt vmcnt(3)
    buffer_load_dwordx4 v[60:63], v1, s[40:43], s49 offen offset:3072 nt
    v_and_b32 v130, v10, v146
    v_and_b32 v131, v10, v147
    s_nop 1
    v_mfma_f32_16x16x32_bf16 v[148:151], v[224:227], v[128:131], v[148:151]
    v_mfma_f32_16x16x32_bf16 v[152:155], v[228:231], v[128:131], v[152:155]
    v_cvt_pk_bf16_f32 v10, v23, v23
    v_and_b32 v132, v10, v144
    v_and_b32 v133, v10, v145
    v_and_b32 v134, v10, v146
    v_and_b32 v135, v10, v147
    s_nop 1
    v_mfma_f32_16x16x32_bf16 v[148:151], v[232:235], v[132:135], v[148:151]
    v_mfma_f32_16x16x32_bf16 v[152:155], v[236:239], v[132:135], v[152:155]
    v_cvt_pk_bf16_f32 v10, v24, v24
    v_and_b32 v128, v10, v144
    v_and_b32 v129, v10, v145
    v_and_b32 v130, v10, v146
    v_and_b32 v131, v10, v147
    s_nop 1
    v_mfma_f32_16x16x32_bf16 v[148:151], v[240:243], v[128:131], v[148:151]
    v_mfma_f32_16x16x32_bf16 v[152:155], v[244:247], v[128:131], v[152:155]
    v_cvt_pk_bf16_f32 v10, v25, v25
    v_and_b32 v132, v10, v144
    v_and_b32 v133, v10, v145
    v_and_b32 v134, v10, v146
    v_and_b32 v135, v10, v147
    s_nop 1
    v_mfma_f32_16x16x32_bf16 v[148:151], v[248:251], v[132:135], v[148:151]
    v_mfma_f32_16x16x32_bf16 v[152:155], v[252:255], v[132:135], v[152:155]
    v_cvt_pk_bf16_f32 v10, v26, v26
    v_and_b32 v128, v10, v144
    v_and_b32 v129, v10, v145
    v_and_b32 v130, v10, v146
    v_and_b32 v131, v10, v147
    s_nop 1
    v_mfma_f32_16x16x32_bf16 v[148:151], v[32:35], v[128:131], v[148:151]
    v_mfma_f32_16x16x32_bf16 v[152:155], v[36:39], v[128:131], v[152:155]
    v_cvt_pk_bf16_f32 v10, v27, v27
    v_and_b32 v132, v10, v144
    v_and_b32 v133, v10, v145
    v_and_b32 v134, v10, v146
    s_waitcnt vmcnt(3)
    s_mov_b32 s49, 229376
    buffer_load_dwordx4 v[64:67], v1, s[40:43], s49 offen offset:0 nt
    v_and_b32 v135, v10, v147
    s_nop 1
    v_mfma_f32_16x16x32_bf16 v[148:151], v[40:43], v[132:135], v[148:151]
    v_mfma_f32_16x16x32_bf16 v[152:155], v[44:47], v[132:135], v[152:155]
    v_cvt_pk_bf16_f32 v10, v28, v28
    v_and_b32 v128, v10, v144
    v_and_b32 v129, v10, v145
    v_and_b32 v130, v10, v146
    v_and_b32 v131, v10, v147
    s_waitcnt vmcnt(3)
    buffer_load_dwordx4 v[68:71], v1, s[40:43], s49 offen offset:1024 nt
    buffer_load_dwordx4 v[72:75], v1, s[40:43], s49 offen offset:2048 nt
    buffer_load_dwordx4 v[76:79], v1, s[40:43], s49 offen offset:3072 nt
    s_barrier
    v_and_b32 v200, 3, v0
    v_bfe_u32 v201, v0, 2, 2
    v_lshrrev_b32 v202, 4, v0
    s_lshl_b32 s34, s3, 10
    s_add_u32 s34, s34, 122112
    v_mul_u32_u24 v203, 320, v201
    v_min_u32 v203, 704, v203
    v_lshl_add_u32 v203, v202, 6, v203
    v_lshl_add_u32 v203, v200, 4, v203
    v_add_u32 v203, s34, v203
    s_movk_i32 s48, 16384
    s_cmp_eq_u32 s63, 0
    s_cbranch_scc1 L_tp_wo
    s_cmp_eq_u32 s63, 1
    s_cbranch_scc1 L_tp_w1
    v_bfe_u32 v205, v0, 3, 2
    v_lshlrev_b32 v204, 3, v205
    v_lshrrev_b32 v205, 5, v0
    v_lshl_add_u32 v204, v205, 2, v204
    v_bfe_u32 v205, v0, 1, 2
    v_add_u32 v204, v204, v205
    v_and_b32 v205, 1, v0
    s_sub_u32 s49, s3, 1
    v_mul_u32_u24 v204, 1280, v204
    v_lshl_add_u32 v204, v205, 4, v204
    s_lshl_b32 s34, s62, 5
    s_mul_i32 s35, s49, 327680
    s_add_u32 s34, s34, s35
    v_add_u32 v204, s34, v204
    s_lshl_b32 s50, s49, 13
    s_add_u32 s50, s50, 40960
    v_lshl_add_u32 v205, v0, 3, s50
    s_lshl_b32 s34, s49, 8
    s_add_u32 s34, s34, s99
    s_add_u32 s34, s34, 103424
    s_cmp_eq_u32 s49, 6
    s_cselect_b32 s35, 1, 3
    v_lshlrev_b32 v6, 6, v202
    v_lshl_add_u32 v6, v200, 4, v6
    v_add_u32 v6, s34, v6
    v_lshl_add_u32 v4, v201, 18, v6
    v_min_u32 v5, s35, v201
    v_lshl_add_u32 v5, v5, 18, v6
    v_mov_b32 v7, 99084
    s_lshl_b32 s40, s62, 1
    s_add_u32 s41, s40, 8
    s_add_u32 s42, s40, 2
    s_branch L_tp_e
L_tp_w1:
    v_and_b32 v205, 15, v0
    v_lshlrev_b32 v205, 4, v205
    s_and_b32 s49, s3, 3
    s_mul_i32 s34, s49, 1280
    s_add_u32 s34, s34, s99
    s_add_u32 s34, s34, 98304
    v_lshl_add_u32 v206, v202, 18, v205
    v_add_u32 v206, s34, v206
    s_mul_i32 s34, s49, 3840
    v_add_u32 v205, s34, v205
    s_branch L_tp_e
L_tp_wo:
    s_lshr_b32 s49, s3, 1
    s_lshl_b32 s49, s49, 18
    v_and_b32 v210, 7, v0
    s_mul_i32 s34, s60, 4096
    s_add_u32 s34, s34, s49
    s_add_u32 s34, s34, 147712
    v_lshrrev_b32 v211, 3, v0
    v_mul_u32_u24 v205, 512, v211
    v_add_u32 v204, s34, v205
    s_lshl_b32 s35, s51, 7
    s_add_u32 s34, s34, s35
    s_sub_u32 s34, s34, 256
    v_lshl_add_u32 v205, v210, 4, v205
    v_add_u32 v205, s34, v205
    s_lshl_b32 s34, s3, 12
    s_add_u32 s34, s34, 40960
    v_lshrrev_b32 v206, 2, v0
    v_lshlrev_b32 v206, 6, v206
    v_lshl_add_u32 v206, v200, 3, v206
    v_add_u32 v206, s34, v206
    s_mul_i32 s34, s3, 1152
    s_add_u32 s34, s34, 107520
    v_mul_u32_u24 v207, 144, v211
    v_lshl_add_u32 v207, v210, 4, v207
    v_add_u32 v207, s34, v207
    v_mul_u32_u24 v208, 144, v210
    v_lshl_add_u32 v208, v202, 4, v208
    v_add_u32 v208, s34, v208
    v_mul_u32_u24 v212, 144, v211
    v_add_u32 v212, s34, v212
    v_mul_u32_u24 v213, 144, v210
    v_add_u32 v213, s34, v213
    v_and_b32 v211, 1, v211
    v_bfe_u32 v203, v0, 1, 2
    v_mul_u32_u24 v203, 144, v203
    v_and_b32 v214, 1, v0
    v_mul_u32_u24 v214, 576, v214
    v_lshl_add_u32 v214, v211, 6, v214
    v_lshl_add_u32 v214, v202, 4, v214
    s_add_u32 s34, s34, 14592
    v_add3_u32 v203, v203, v214, s34
    v_mov_b32 v210, 98816
    v_cmp_eq_u32 vcc, 0, v211
    s_nop 1
    v_cndmask_b32 v209, v208, v210, vcc
    v_cndmask_b32 v208, v210, v208, vcc
L_tp_e:
    v_mfma_f32_16x16x32_bf16 v[148:151], v[48:51], v[128:131], v[148:151]
    v_mfma_f32_16x16x32_bf16 v[152:155], v[52:55], v[128:131], v[152:155]
    v_cvt_pk_bf16_f32 v10, v29, v29
    v_and_b32 v132, v10, v144
    v_and_b32 v133, v10, v145
    v_and_b32 v134, v10, v146
    v_and_b32 v135, v10, v147
    s_waitcnt vmcnt(4)
    s_nop 0
    v_mfma_f32_16x16x32_bf16 v[148:151], v[56:59], v[132:135], v[148:151]
    v_mfma_f32_16x16x32_bf16 v[152:155], v[60:63], v[132:135], v[152:155]
    v_cvt_pk_bf16_f32 v10, v30, v30
    v_and_b32 v128, v10, v144
    v_and_b32 v129, v10, v145
    v_and_b32 v130, v10, v146
    v_and_b32 v131, v10, v147
    s_waitcnt vmcnt(2)
    s_nop 0
    v_mfma_f32_16x16x32_bf16 v[148:151], v[64:67], v[128:131], v[148:151]
    v_mfma_f32_16x16x32_bf16 v[152:155], v[68:71], v[128:131], v[152:155]
    v_cvt_pk_bf16_f32 v10, v31, v31
    v_and_b32 v132, v10, v144
    v_and_b32 v133, v10, v145
    v_and_b32 v134, v10, v146
    v_and_b32 v135, v10, v147
    s_waitcnt vmcnt(0)
    s_nop 0
    v_mfma_f32_16x16x32_bf16 v[148:151], v[72:75], v[132:135], v[148:151]
    v_mfma_f32_16x16x32_bf16 v[152:155], v[76:79], v[132:135], v[152:155]
    s_nop 7
    v_add_f32_dpp v148, v152, v148 row_ror:8 row_mask:0xf bank_mask:0xf
    v_add_f32_dpp v149, v153, v149 row_ror:8 row_mask:0xf bank_mask:0xf
    v_add_f32_dpp v150, v154, v150 row_ror:8 row_mask:0xf bank_mask:0xf
    v_add_f32_dpp v151, v155, v151 row_ror:8 row_mask:0xf bank_mask:0xf
    ds_write_b128 v2, v[148:151]
    s_waitcnt lgkmcnt(0)
    s_barrier
    s_cmp_eq_u32 s63, 0
    s_cbranch_scc1 L_t_wo
    s_cmp_eq_u32 s63, 2
    s_cbranch_scc1 L_t_w2
    s_cmp_eq_u32 s63, 3
    s_cbranch_scc1 L_fin
    s_barrier
L_r_w1:
    s_cmp_lt_u32 s3, 4
    s_cbranch_scc1 L_w1_ln
    s_and_b32 s49, s3, 3
    s_lshl_b32 s42, s49, 11
    s_add_u32 s42, s42, 40960
    s_bitcmp1_b32 s62, 0
    s_cbranch_scc1 L_rot1
    s_add_u32 m0, s42, 0
    s_add_u32 s34, s50, 0
    buffer_load_dwordx4 v15, s[52:55], s34 offen  lds
    s_add_u32 m0, s42, 1024
    s_add_u32 s34, s50, 884736
    buffer_load_dwordx4 v15, s[52:55], s34 offen  lds
    s_add_u32 m0, s42, 8192
    s_add_u32 s34, s50, 110592
    buffer_load_dwordx4 v15, s[52:55], s34 offen  lds
    s_add_u32 m0, s42, 9216
    s_add_u32 s34, s50, 995328
    buffer_load_dwordx4 v15, s[52:55], s34 offen  lds
    s_add_u32 m0, s42, 32768
    s_add_u32 s34, s51, 0
    buffer_load_dwordx4 v15, s[52:55], s34 offen  lds
    s_add_u32 m0, s42, 33792
    s_add_u32 s34, s51, 13824
    buffer_load_dwordx4 v15, s[52:55], s34 offen  lds
    s_add_u32 m0, s42, 16384
    s_add_u32 s34, s50, 221184
    buffer_load_dwordx4 v15, s[52:55], s34 offen  lds
    s_add_u32 m0, s42, 17408
    s_add_u32 s34, s50, 1105920
    buffer_load_dwordx4 v15, s[52:55], s34 offen  lds
    s_add_u32 m0, s42, 24576
    s_add_u32 s34, s50, 331776
    buffer_load_dwordx4 v15, s[52:55], s34 offen  lds
    s_add_u32 m0, s42, 25600
    s_add_u32 s34, s50, 1216512
    buffer_load_dwordx4 v15, s[52:55], s34 offen  lds
    s_branch L_rot2
L_rot1:
    s_add_u32 m0, s42, 16384
    s_add_u32 s34, s50, 221184
    buffer_load_dwordx4 v15, s[52:55], s34 offen  lds
    s_add_u32 m0, s42, 17408
    s_add_u32 s34, s50, 1105920
    buffer_load_dwordx4 v15, s[52:55], s34 offen  lds
    s_add_u32 m0, s42, 24576
    s_add_u32 s34, s50, 331776
    buffer_load_dwordx4 v15, s[52:55], s34 offen  lds
    s_add_u32 m0, s42, 25600
    s_add_u32 s34, s50, 1216512
    buffer_load_dwordx4 v15, s[52:55], s34 offen  lds
    s_add_u32 m0, s42, 32768
    s_add_u32 s34, s51, 0
    buffer_load_dwordx4 v15, s[52:55], s34 offen  lds
    s_add_u32 m0, s42, 33792
    s_add_u32 s34, s51, 13824
    buffer_load_dwordx4 v15, s[52:55], s34 offen  lds
    s_add_u32 m0, s42, 0
    s_add_u32 s34, s50, 0
    buffer_load_dwordx4 v15, s[52:55], s34 offen  lds
    s_add_u32 m0, s42, 1024
    s_add_u32 s34, s50, 884736
    buffer_load_dwordx4 v15, s[52:55], s34 offen  lds
    s_add_u32 m0, s42, 8192
    s_add_u32 s34, s50, 110592
    buffer_load_dwordx4 v15, s[52:55], s34 offen  lds
    s_add_u32 m0, s42, 9216
    s_add_u32 s34, s50, 995328
    buffer_load_dwordx4 v15, s[52:55], s34 offen  lds
L_rot2:
    v_lshrrev_b32 v3, 2, v0
    v_lshlrev_b32 v3, 6, v3
    v_lshl_add_u32 v3, v200, 3, v3
    v_add_u32 v3, s42, v3
    s_lshl_b32 s35, s49, 6
    s_add_u32 s35, s35, 116736
    v_mul_u32_u24 v4, 1344, v200
    v_lshl_add_u32 v4, v202, 4, v4
    v_add_u32 v4, s35, v4
    s_lshl_b32 s35, s49, 10
    s_sub_u32 s35, s35, 4096
    v_add_u32 v5, s35, v203
    v_and_b32 v6, 1, v201
    v_mul_u32_u24 v6, 5376, v6
    v_add_u32 v6, v6, v4
    v_subrev_u32 v6, 90112, v6
    v_subrev_u32 v7, 22784, v5
    s_waitcnt vmcnt(0)
    s_barrier
    ds_read_b64_tr_b16 v[32:33], v3 offset:0
    ds_read_b64_tr_b16 v[34:35], v3 offset:1024
    ds_read_b64_tr_b16 v[36:37], v3 offset:32
    ds_read_b64_tr_b16 v[38:39], v3 offset:1056
    ds_read_b64_tr_b16 v[40:41], v3 offset:8192
    ds_read_b64_tr_b16 v[42:43], v3 offset:9216
    ds_read_b64_tr_b16 v[44:45], v3 offset:8224
    ds_read_b64_tr_b16 v[46:47], v3 offset:9248
    ds_read_b64_tr_b16 v[48:49], v3 offset:16384
    ds_read_b64_tr_b16 v[50:51], v3 offset:17408
    ds_read_b64_tr_b16 v[52:53], v3 offset:16416
    ds_read_b64_tr_b16 v[54:55], v3 offset:17440
    s_waitcnt lgkmcnt(4)
    ds_read_b64_tr_b16 v[56:57], v3 offset:24576
    ds_read_b64_tr_b16 v[58:59], v3 offset:25600
    ds_read_b64_tr_b16 v[60:61], v3 offset:24608
    ds_read_b64_tr_b16 v[62:63], v3 offset:25632
    ds_read_b64_tr_b16 v[64:65], v3 offset:32768
    ds_read_b64_tr_b16 v[66:67], v3 offset:33792
    ds_read_b64_tr_b16 v[68:69], v3 offset:32800
    ds_read_b64_tr_b16 v[70:71], v3 offset:33824
    s_waitcnt lgkmcnt(0)
    ds_read_b128 v[140:143], v6 offset:0
    ds_read_b128 v[144:147], v6 offset:256
    ds_read_b128 v[148:151], v6 offset:512
    ds_read_b128 v[152:155], v6 offset:768
    ds_read_b128 v[156:159], v6 offset:1024
    s_waitcnt lgkmcnt(4)
    v_mfma_f32_16x16x32_bf16 v[20:23], v[32:35], v[140:143], 0
    v_mfma_f32_16x16x32_bf16 v[24:27], v[36:39], v[140:143], 0
    s_waitcnt lgkmcnt(3)
    v_mfma_f32_16x16x32_bf16 v[20:23], v[40:43], v[144:147], v[20:23]
    v_mfma_f32_16x16x32_bf16 v[24:27], v[44:47], v[144:147], v[24:27]
    s_waitcnt lgkmcnt(2)
    v_mfma_f32_16x16x32_bf16 v[20:23], v[48:51], v[148:151], v[20:23]
    v_mfma_f32_16x16x32_bf16 v[24:27], v[52:55], v[148:151], v[24:27]
    s_waitcnt lgkmcnt(1)
    v_mfma_f32_16x16x32_bf16 v[20:23], v[56:59], v[152:155], v[20:23]
    v_mfma_f32_16x16x32_bf16 v[24:27], v[60:63], v[152:155], v[24:27]
    s_waitcnt lgkmcnt(0)
    v_mfma_f32_16x16x32_bf16 v[20:23], v[64:67], v[156:159], v[20:23]
    v_mfma_f32_16x16x32_bf16 v[24:27], v[68:71], v[156:159], v[24:27]
    s_nop 6
    ds_write_b128 v7, v[20:23]
    ds_write_b128 v7, v[24:27] offset:1024
    s_waitcnt lgkmcnt(0)
    s_setprio 3
    s_barrier
    ds_read_b128 v[140:143], v4 offset:0
    ds_read_b128 v[144:147], v4 offset:256
    ds_read_b128 v[148:151], v4 offset:512
    ds_read_b128 v[152:155], v4 offset:768
    ds_read_b128 v[156:159], v4 offset:1024
    s_waitcnt lgkmcnt(4)
    v_mfma_f32_16x16x32_bf16 v[20:23], v[32:35], v[140:143], 0
    v_mfma_f32_16x16x32_bf16 v[24:27], v[36:39], v[140:143], 0
    s_waitcnt lgkmcnt(3)
    v_mfma_f32_16x16x32_bf16 v[20:23], v[40:43], v[144:147], v[20:23]
    v_mfma_f32_16x16x32_bf16 v[24:27], v[44:47], v[144:147], v[24:27]
    s_waitcnt lgkmcnt(2)
    v_mfma_f32_16x16x32_bf16 v[20:23], v[48:51], v[148:151], v[20:23]
    v_mfma_f32_16x16x32_bf16 v[24:27], v[52:55], v[148:151], v[24:27]
    s_waitcnt lgkmcnt(1)
    v_mfma_f32_16x16x32_bf16 v[20:23], v[56:59], v[152:155], v[20:23]
    v_mfma_f32_16x16x32_bf16 v[24:27], v[60:63], v[152:155], v[24:27]
    s_waitcnt lgkmcnt(0)
    v_mfma_f32_16x16x32_bf16 v[20:23], v[64:67], v[156:159], v[20:23]
    v_mfma_f32_16x16x32_bf16 v[24:27], v[68:71], v[156:159], v[24:27]
    s_nop 6
    ds_write_b128 v5, v[20:23]
    ds_write_b128 v5, v[24:27] offset:1024
    s_waitcnt lgkmcnt(0)
    s_barrier
    s_branch L_fin
L_w1_ln:
    s_setprio 1
    ds_read_b128 v[140:143], v205 offset:0
    ds_read_b128 v[144:147], v205 offset:256
    ds_read_b128 v[148:151], v205 offset:512
    ds_read_b128 v[152:155], v205 offset:768
    ds_read_b128 v[156:159], v205 offset:1024
    ds_read_b128 v[160:163], v205 offset:1280
    ds_read_b128 v[164:167], v205 offset:1536
    ds_read_b128 v[168:171], v205 offset:1792
    ds_read_b128 v[172:175], v205 offset:2048
    ds_read_b128 v[176:179], v205 offset:2304
    ds_read_b128 v[180:183], v205 offset:2560
    ds_read_b128 v[184:187], v205 offset:2816
    ds_read_b128 v[188:191], v205 offset:3072
    ds_read_b128 v[192:195], v205 offset:3328
    ds_read_b128 v[196:199], v205 offset:3584
    v_and_b32 v8, 1, v0
    v_lshlrev_b32 v8, 4, v8
    v_mov_b32 v9, 0xffff
    v_lshlrev_b32 v8, v8, v9
    v_bfe_u32 v9, v0, 1, 2
    v_cmp_eq_u32 vcc, 0, v9
    s_nop 1
    v_cndmask_b32 v16, 0, v8, vcc
    v_cmp_eq_u32 vcc, 1, v9
    s_nop 1
    v_cndmask_b32 v17, 0, v8, vcc
    v_cmp_eq_u32 vcc, 2, v9
    s_nop 1
    v_cndmask_b32 v18, 0, v8, vcc
    v_cmp_eq_u32 vcc, 3, v9
    s_nop 1
    v_cndmask_b32 v19, 0, v8, vcc
    v_bfe_u32 v8, v0, 3, 1
    v_cmp_eq_u32 vcc, 0, v8
    s_nop 1
    v_cndmask_b32 v20, 0, v16, vcc
    v_xor_b32 v24, v20, v16
    v_cndmask_b32 v21, 0, v17, vcc
    v_xor_b32 v25, v21, v17
    v_cndmask_b32 v22, 0, v18, vcc
    v_xor_b32 v26, v22, v18
    v_cndmask_b32 v23, 0, v19, vcc
    v_xor_b32 v27, v23, v19
    v_and_b32 v52, 0x3f803f80, v20
    v_and_b32 v60, 0x3e803e80, v20
    v_and_b32 v53, 0x3f803f80, v21
    v_and_b32 v61, 0x3e803e80, v21
    v_and_b32 v54, 0x3f803f80, v22
    v_and_b32 v62, 0x3e803e80, v22
    v_and_b32 v55, 0x3f803f80, v23
    v_and_b32 v63, 0x3e803e80, v23
    v_and_b32 v56, 0x3f803f80, v24
    v_and_b32 v64, 0x3e803e80, v24
    v_and_b32 v57, 0x3f803f80, v25
    v_and_b32 v65, 0x3e803e80, v25
    v_and_b32 v58, 0x3f803f80, v26
    v_and_b32 v66, 0x3e803e80, v26
    v_and_b32 v59, 0x3f803f80, v27
    v_and_b32 v67, 0x3e803e80, v27
    s_waitcnt lgkmcnt(0)
    v_mfma_f32_16x16x32_bf16 v[68:71], v[140:143], v[60:63], 0
    v_mfma_f32_16x16x32_bf16 v[68:71], v[144:147], v[64:67], v[68:71]
    v_mfma_f32_16x16x32_bf16 v[72:75], v[148:151], v[60:63], 0
    v_mfma_f32_16x16x32_bf16 v[72:75], v[152:155], v[64:67], v[72:75]
    v_mfma_f32_16x16x32_bf16 v[76:79], v[156:159], v[60:63], 0
    v_mfma_f32_16x16x32_bf16 v[116:119], v[160:163], v[60:63], 0
    v_mfma_f32_16x16x32_bf16 v[116:119], v[164:167], v[64:67], v[116:119]
    v_mfma_f32_16x16x32_bf16 v[120:123], v[168:171], v[60:63], 0
    v_mfma_f32_16x16x32_bf16 v[120:123], v[172:175], v[64:67], v[120:123]
    v_mfma_f32_16x16x32_bf16 v[124:127], v[176:179], v[60:63], 0
    v_mfma_f32_16x16x32_bf16 v[80:83], v[180:183], v[60:63], 1.0
    v_mfma_f32_16x16x32_bf16 v[80:83], v[184:187], v[64:67], v[80:83]
    v_mfma_f32_16x16x32_bf16 v[84:87], v[188:191], v[60:63], 1.0
    v_mfma_f32_16x16x32_bf16 v[84:87], v[192:195], v[64:67], v[84:87]
    v_mfma_f32_16x16x32_bf16 v[88:91], v[196:199], v[60:63], 1.0
    s_mul_i32 s34, s3, 1344
    s_add_u32 s34, s34, 116736
    v_lshl_add_u32 v7, v0, 4, s34
    v_lshlrev_b32 v8, 6, v202
    v_lshl_add_u32 v8, v200, 4, v8
    v_and_b32 v9, 1, v201
    v_lshl_add_u32 v8, v9, 3, v8
    v_add_u32 v8, s34, v8
    v_bfe_u32 v9, v0, 3, 1
    v_mul_u32_u24 v9, 6144, v9
    v_sub_u32 v8, v8, v9
    v_lshrrev_b32 v9, 5, v0
    v_lshlrev_b32 v9, 10, v9
    v_and_b32 v6, 1, v202
    v_lshl_add_u32 v9, v6, 7, v9
    v_bfe_u32 v6, v0, 1, 1
    v_lshl_add_u32 v9, v6, 6, v9
    v_lshl_add_u32 v9, v201, 4, v9
    v_and_b32 v6, 1, v0
    v_lshl_add_u32 v9, v6, 3, v9
    v_add_u32 v9, 122112, v9
    s_lshr_b32 s34, s62, 3
    s_lshl_b32 s34, s34, 8
    s_and_b32 s49, s62, 3
    s_lshl_b32 s49, s49, 18
    s_add_u32 s34, s34, s49
    s_bfe_u32 s49, s62, 0x10002
    s_lshl_b32 s49, s49, 14
    s_add_u32 s34, s34, s49
    s_add_u32 s34, s34, 103424
    v_lshl_add_u32 v5, v0, 2, s34
    s_bfe_u32 s49, s60, 0x10002
    s_lshl_b32 s49, s49, 13
    s_xor_b32 s53, s99, s49
    s_xor_b32 s52, s53, 8192
    v_subrev_u32 v10, 90112, v7
    v_subrev_u32 v11, 90112, v8
    v_cvt_pk_bf16_f32 v32, v116, v117
    v_cvt_pk_bf16_f32 v33, v118, v119
    v_cvt_pk_bf16_f32 v34, v120, v121
    v_cvt_pk_bf16_f32 v35, v122, v123
    v_cvt_pk_bf16_f32 v36, v124, v125
    v_cvt_pk_bf16_f32 v37, v126, v127
    s_mov_b32 exec_lo, 0x00ff00ff
    s_mov_b32 exec_hi, 0x00ff00ff
    ds_write_b64 v11, v[36:37] offset:6400
    s_mov_b64 exec, -1
    ds_write_b128 v10, v[32:35] offset:5376
    v_cvt_pk_bf16_f32 v20, v80, v81
    v_cvt_pk_bf16_f32 v21, v82, v83
    v_cvt_pk_bf16_f32 v22, v84, v85
    v_cvt_pk_bf16_f32 v23, v86, v87
    v_cvt_pk_bf16_f32 v24, v88, v89
    v_cvt_pk_bf16_f32 v25, v90, v91
    ds_write_b128 v10, v[20:23]
    ds_write_b64 v11, v[24:25] offset:1024
    v_lshlrev_b32 v80, 16, v20
    v_and_b32 v81, 0xffff0000, v20
    v_lshlrev_b32 v82, 16, v21
    v_and_b32 v83, 0xffff0000, v21
    v_lshlrev_b32 v84, 16, v22
    v_and_b32 v85, 0xffff0000, v22
    v_lshlrev_b32 v86, 16, v23
    v_and_b32 v87, 0xffff0000, v23
    v_lshlrev_b32 v88, 16, v24
    v_and_b32 v89, 0xffff0000, v24
    v_lshlrev_b32 v90, 16, v25
    v_and_b32 v91, 0xffff0000, v25
    v_subrev_u32 v11, 22784, v9
    s_lshl_b32 s34, s3, 3
    s_add_u32 s34, s34, 99136
    v_mov_b32 v12, s34
    v_lshlrev_b32 v13, 3, v201
    v_add_u32 v13, 99136, v13
    s_mov_b32 s54, 0
    s_brev_b32 s55, 1
    s_waitcnt lgkmcnt(0)
    s_barrier
    s_mov_b32 s35, 0
    s_mov_b64 s[40:41], -1
    s_mov_b64 s[42:43], -1
L_pb:
    s_mov_b64 exec, s[40:41]
    s_cbranch_execz L_pbs0
    buffer_load_dwordx4 v[140:143], v206, s[44:47], 0 offen offset:0 sc1
    buffer_load_dwordx4 v[148:151], v206, s[44:47], 0 offen offset:256 sc1
    buffer_load_dwordx4 v[156:159], v206, s[44:47], 0 offen offset:512 sc1
    buffer_load_dwordx4 v[164:167], v206, s[44:47], 0 offen offset:768 sc1
    buffer_load_dwordx4 v[172:175], v206, s[44:47], 0 offen offset:1024 sc1
L_pbs0:
    s_mov_b64 exec, s[42:43]
    s_cbranch_execz L_pbs1
    buffer_load_dwordx4 v[144:147], v206, s[44:47], s48 offen offset:0 sc1
    buffer_load_dwordx4 v[152:155], v206, s[44:47], s48 offen offset:256 sc1
    buffer_load_dwordx4 v[160:163], v206, s[44:47], s48 offen offset:512 sc1
    buffer_load_dwordx4 v[168:171], v206, s[44:47], s48 offen offset:768 sc1
    buffer_load_dwordx4 v[176:179], v206, s[44:47], s48 offen offset:1024 sc1
L_pbs1:
    s_mov_b64 exec, -1
    s_add_u32 s35, s35, 1
    s_waitcnt vmcnt(0)
    v_mfma_f32_16x16x32_bf16 v[128:131], v[140:143], v[52:55], v[68:71]
    v_max3_u32 v28, v140, v141, v142
    v_max3_u32 v29, v144, v145, v146
    v_mfma_f32_16x16x32_bf16 v[128:131], v[144:147], v[52:55], v[128:131]
    v_max3_u32 v28, v28, v143, v148
    v_max3_u32 v29, v29, v147, v152
    v_mfma_f32_16x16x32_bf16 v[128:131], v[148:151], v[56:59], v[128:131]
    v_max3_u32 v28, v28, v149, v150
    v_max3_u32 v29, v29, v153, v154
    v_mfma_f32_16x16x32_bf16 v[128:131], v[152:155], v[56:59], v[128:131]
    v_max3_u32 v28, v28, v151, v156
    v_max3_u32 v29, v29, v155, v160
    v_mfma_f32_16x16x32_bf16 v[132:135], v[156:159], v[52:55], v[72:75]
    v_max3_u32 v28, v28, v157, v158
    v_max3_u32 v29, v29, v161, v162
    v_mfma_f32_16x16x32_bf16 v[132:135], v[160:163], v[52:55], v[132:135]
    v_max3_u32 v28, v28, v159, v164
    v_max3_u32 v29, v29, v163, v168
    v_mfma_f32_16x16x32_bf16 v[132:135], v[164:167], v[56:59], v[132:135]
    v_max3_u32 v28, v28, v165, v166
    v_max3_u32 v29, v29, v169, v170
    v_mfma_f32_16x16x32_bf16 v[132:135], v[168:171], v[56:59], v[132:135]
    v_max3_u32 v28, v28, v167, v172
    v_max3_u32 v29, v29, v171, v176
    v_mfma_f32_16x16x32_bf16 v[136:139], v[172:175], v[52:55], v[76:79]
    v_max3_u32 v28, v28, v173, v174
    v_max3_u32 v29, v29, v177, v178
    v_mfma_f32_16x16x32_bf16 v[136:139], v[176:179], v[52:55], v[136:139]
    v_max_u32 v28, v28, v175
    v_max_u32 v29, v29, v179
    v_cmp_eq_u32 s[40:41], -1, v28
    v_cmp_eq_u32 s[42:43], -1, v29
    s_nop 0
    s_or_b64 vcc, s[40:41], s[42:43]
    s_cbranch_scc0 L_pbd
    s_cmp_lg_u32 s35, 64
    s_cbranch_scc1 L_tmo50
    s_mov_b64 exec, -1
    v_lshlrev_b32 v243, 4, v0
    v_add_u32 v243, 131328, v243
    ds_read_b96 v[240:242], v243
    s_waitcnt lgkmcnt(0)
    buffer_store_dword v240, v242, s[44:47], 0 offen sc1
    buffer_store_dword v241, v242, s[44:47], 0 offen offset:256 sc1
L_tmo50:
    s_cmp_lt_u32 s35, 60000
    s_cbranch_scc1 L_pb
L_pbd:
    v_pk_mul_f32 v[32:33], v[128:129], v[80:81]
    v_pk_mul_f32 v[34:35], v[130:131], v[82:83]
    v_pk_mul_f32 v[36:37], v[132:133], v[84:85]
    v_pk_mul_f32 v[38:39], v[134:135], v[86:87]
    v_cvt_pk_bf16_f32 v24, v32, v33
    v_cvt_pk_bf16_f32 v25, v34, v35
    v_cvt_pk_bf16_f32 v26, v36, v37
    v_cvt_pk_bf16_f32 v27, v38, v39
    ds_write_b128 v7, v[24:27]
    v_pk_mul_f32 v[40:41], v[136:137], v[88:89]
    v_pk_mul_f32 v[42:43], v[138:139], v[90:91]
    v_cvt_pk_bf16_f32 v28, v40, v41
    v_cvt_pk_bf16_f32 v29, v42, v43
    ds_write_b64 v8, v[28:29] offset:1024
    v_pk_add_f32 v[20:21], v[128:129], v[130:131]
    v_pk_mul_f32 v[22:23], v[128:129], v[128:129]
    v_pk_add_f32 v[20:21], v[20:21], v[132:133]
    v_pk_fma_f32 v[22:23], v[130:131], v[130:131], v[22:23]
    v_pk_add_f32 v[20:21], v[20:21], v[134:135]
    v_pk_fma_f32 v[22:23], v[132:133], v[132:133], v[22:23]
    v_pk_add_f32 v[20:21], v[20:21], v[136:137]
    v_pk_fma_f32 v[22:23], v[134:135], v[134:135], v[22:23]
    v_pk_add_f32 v[20:21], v[20:21], v[138:139]
    v_pk_fma_f32 v[22:23], v[136:137], v[136:137], v[22:23]
    v_pk_fma_f32 v[22:23], v[138:139], v[138:139], v[22:23]
    s_waitcnt lgkmcnt(0)
    s_barrier
    v_add_f32 v20, v20, v21
    v_add_f32 v21, v22, v23
    s_nop 0
    v_add_f32_dpp v20, v20, v20 row_ror:8 row_mask:0xf bank_mask:0xf
    v_add_f32_dpp v21, v21, v21 row_ror:8 row_mask:0xf bank_mask:0xf
    s_nop 0
    v_add_f32_dpp v20, v20, v20 row_ror:4 row_mask:0xf bank_mask:0xf
    v_add_f32_dpp v21, v21, v21 row_ror:4 row_mask:0xf bank_mask:0xf
    s_nop 0
    v_add_f32_dpp v20, v20, v20 row_ror:2 row_mask:0xf bank_mask:0xf
    v_add_f32_dpp v21, v21, v21 row_ror:2 row_mask:0xf bank_mask:0xf
    s_nop 0
    v_add_f32_dpp v20, v20, v20 row_ror:1 row_mask:0xf bank_mask:0xf
    v_add_f32_dpp v21, v21, v21 row_ror:1 row_mask:0xf bank_mask:0xf
    s_nop 0
    v_add_f32_dpp v20, v20, v20 row_bcast:15 row_mask:0xa bank_mask:0xf
    v_add_f32_dpp v21, v21, v21 row_bcast:15 row_mask:0xa bank_mask:0xf
    s_nop 0
    v_add_f32_dpp v20, v20, v20 row_bcast:31 row_mask:0xc bank_mask:0xf
    v_add_f32_dpp v21, v21, v21 row_bcast:31 row_mask:0xc bank_mask:0xf
    v_mul_f32 v22, 0x3acccccd, v20
    v_mul_f32 v21, 0x3acccccd, v21
    v_fma_f32 v21, -v22, v22, v21
    v_max_f32 v21, 0, v21
    v_add_f32 v21, 0x3727c5ac, v21
    v_rsq_f32 v20, v21
    s_nop 0
    v_mul_f32_e64 v21, -v22, v20
    s_mov_b64 exec, s[54:55]
    ds_write_b64 v12, v[20:21]
    s_mov_b64 exec, -1
    s_cmp_lg_u32 s3, 0
    s_cbranch_scc1 L_w1_x
    ds_read_b64 v[32:33], v11 offset:0
    ds_read_b64 v[40:41], v11 offset:320
    ds_read_b64 v[34:35], v11 offset:2048
    ds_read_b64 v[42:43], v11 offset:2368
    ds_read_b64 v[36:37], v11 offset:4096
    ds_read_b64 v[44:45], v11 offset:4416
    ds_read_b64 v[38:39], v11 offset:6144
    ds_read_b64 v[46:47], v11 offset:6464
    s_mov_b32 s34, 0xbdd2d3e8
    v_mov_b32 v10, 0xc0135761
    s_waitcnt lgkmcnt(8)
    s_barrier
    ds_read_b64 v[28:29], v13
    ds_read_b64 v[20:21], v9 offset:0
    ds_read_b64 v[22:23], v9 offset:2048
    ds_read_b64 v[24:25], v9 offset:4096
    ds_read_b64 v[26:27], v9 offset:6144
    s_waitcnt lgkmcnt(5)
    v_pk_add_f32 v[100:101], v[100:101], v[40:41]
    v_pk_add_f32 v[100:101], v[100:101], v[42:43]
    v_pk_add_f32 v[32:33], v[32:33], v[34:35]
    v_pk_add_f32 v[100:101], v[100:101], v[44:45]
    v_pk_add_f32 v[32:33], v[32:33], v[36:37]
    v_pk_add_f32 v[100:101], v[100:101], v[46:47]
    v_pk_add_f32 v[32:33], v[32:33], v[38:39]
    s_waitcnt lgkmcnt(4)
    v_pk_fma_f32 v[100:101], v[32:33], v[28:29], v[100:101] op_sel:[0,1,0] op_sel_hi:[1,1,1]
    s_waitcnt lgkmcnt(3)
    v_pk_fma_f32 v[100:101], v[20:21], v[28:29], v[100:101] op_sel_hi:[1,0,1]
    s_waitcnt lgkmcnt(2)
    v_pk_fma_f32 v[100:101], v[22:23], v[28:29], v[100:101] op_sel_hi:[1,0,1]
    s_waitcnt lgkmcnt(1)
    v_pk_fma_f32 v[100:101], v[24:25], v[28:29], v[100:101] op_sel_hi:[1,0,1]
    s_waitcnt lgkmcnt(0)
    v_pk_fma_f32 v[100:101], v[26:27], v[28:29], v[100:101] op_sel_hi:[1,0,1]
    v_pk_mul_f32 v[20:21], v[100:101], v[100:101]
    v_fma_f32 v20, v20, s34, v10
    v_fma_f32 v21, v21, s34, v10
    v_pk_mul_f32 v[20:21], v[20:21], v[100:101]
    v_exp_f32 v20, v20
    v_exp_f32 v21, v21
    v_add_f32 v20, 1.0, v20
    v_add_f32 v21, 1.0, v21
    v_rcp_f32 v20, v20
    v_rcp_f32 v21, v21
    s_nop 0
    v_pk_mul_f32 v[20:21], v[20:21], v[100:101]
    v_cvt_pk_bf16_f32 v20, v20, v21
    v_min_u32 v20, -2, v20
    buffer_store_dword v20, v5, s[44:47], s52 offen sc1
    buffer_store_dword v20, v5, s[44:47], s53 offen sc1
    s_branch L_fin
L_w1_x:
    s_waitcnt lgkmcnt(0)
    s_barrier
    s_branch L_fin
L_t_w2:
    s_barrier
L_w2_dma:
    s_and_b32 s34, s40, 7
    s_lshl_b32 s35, s34, 10
    s_add_u32 m0, s50, s35
    s_mul_i32 s34, s34, 40960
    buffer_load_dwordx4 v204, s[52:55], s34 offen  lds
    s_add_u32 s40, s40, 1
    s_cmp_lg_u32 s40, s42
    s_cbranch_scc1 L_w2_nw
L_w2_nw:
    s_cmp_lt_u32 s40, s41
    s_cbranch_scc1 L_w2_dma
    ds_read_b32 v8, v7
    s_waitcnt lgkmcnt(0)
    v_cmp_eq_u32 vcc, 0, v8
    s_cbranch_vccnz L_w2_slow
    s_mov_b32 s35, 0
    buffer_load_dwordx4 v[64:67], v4, s[44:47], 0 offen sc1
    buffer_load_dwordx4 v[68:71], v5, s[44:47], s48 offen sc1
    s_waitcnt vmcnt(2)
    ds_read_b64_tr_b16 v[32:33], v205 offset:0
    ds_read_b64_tr_b16 v[34:35], v205 offset:512
    ds_read_b64_tr_b16 v[36:37], v205 offset:1024
    ds_read_b64_tr_b16 v[38:39], v205 offset:1536
    ds_read_b64_tr_b16 v[40:41], v205 offset:2048
    ds_read_b64_tr_b16 v[42:43], v205 offset:2560
    ds_read_b64_tr_b16 v[44:45], v205 offset:3072
    ds_read_b64_tr_b16 v[46:47], v205 offset:3584
    s_waitcnt lgkmcnt(0)
    ds_read_b64_tr_b16 v[48:49], v205 offset:4096
    ds_read_b64_tr_b16 v[50:51], v205 offset:4608
    ds_read_b64_tr_b16 v[52:53], v205 offset:5120
    ds_read_b64_tr_b16 v[54:55], v205 offset:5632
    ds_read_b64_tr_b16 v[56:57], v205 offset:6144
    ds_read_b64_tr_b16 v[58:59], v205 offset:6656
    ds_read_b64_tr_b16 v[60:61], v205 offset:7168
    ds_read_b64_tr_b16 v[62:63], v205 offset:7680
    s_waitcnt lgkmcnt(0)
    s_branch L_w2_mid
L_w2_slow:
    s_waitcnt vmcnt(0)
    ds_read_b64_tr_b16 v[32:33], v205 offset:0
    ds_read_b64_tr_b16 v[34:35], v205 offset:512
    ds_read_b64_tr_b16 v[36:37], v205 offset:1024
    ds_read_b64_tr_b16 v[38:39], v205 offset:1536
    ds_read_b64_tr_b16 v[40:41], v205 offset:2048
    ds_read_b64_tr_b16 v[42:43], v205 offset:2560
    ds_read_b64_tr_b16 v[44:45], v205 offset:3072
    ds_read_b64_tr_b16 v[46:47], v205 offset:3584
    s_waitcnt lgkmcnt(0)
    ds_read_b64_tr_b16 v[48:49], v205 offset:4096
    ds_read_b64_tr_b16 v[50:51], v205 offset:4608
    ds_read_b64_tr_b16 v[52:53], v205 offset:5120
    ds_read_b64_tr_b16 v[54:55], v205 offset:5632
    ds_read_b64_tr_b16 v[56:57], v205 offset:6144
    ds_read_b64_tr_b16 v[58:59], v205 offset:6656
    ds_read_b64_tr_b16 v[60:61], v205 offset:7168
    ds_read_b64_tr_b16 v[62:63], v205 offset:7680
    s_waitcnt lgkmcnt(0)
    s_mov_b32 s35, 0
L_poll51:
    ds_read_b32 v8, v7
    s_add_u32 s35, s35, 1
    s_waitcnt lgkmcnt(0)
    v_cmp_eq_u32 vcc, 0, v8
    s_cbranch_vccz L_done52
    s_sleep 1
    s_cmp_lt_u32 s35, 60000
    s_cbranch_scc1 L_poll51
L_done52:
    s_mov_b32 s35, 0
L_poll54:
    buffer_load_dwordx4 v[64:67], v4, s[44:47], 0 offen sc1
    buffer_load_dwordx4 v[68:71], v5, s[44:47], s48 offen sc1
L_w2_mid:
    s_add_u32 s35, s35, 1
    s_waitcnt vmcnt(0)
    v_max3_u32 v28, v64, v65, v66
    v_max3_u32 v28, v28, v67, v68
    v_max3_u32 v28, v28, v69, v70
    v_max_u32 v28, v28, v71
    v_cmp_eq_u32 vcc, -1, v28
    s_cbranch_vccz L_done55
    s_cmp_lg_u32 s35, 64
    s_cbranch_scc1 L_tmo57
    s_mov_b64 exec, -1
    v_lshlrev_b32 v243, 4, v0
    v_add_u32 v243, 131328, v243
    ds_read_b96 v[240:242], v243
    s_waitcnt lgkmcnt(0)
    buffer_store_dword v240, v242, s[44:47], 0 offen sc1
    buffer_store_dword v241, v242, s[44:47], 0 offen offset:256 sc1
L_tmo57:
    s_cmp_lt_u32 s35, 60000
    s_cbranch_scc1 L_poll54
L_done55:
    v_mfma_f32_16x16x32_bf16 v[80:83], v[32:35], v[64:67], 0
    v_mfma_f32_16x16x32_bf16 v[80:83], v[48:51], v[68:71], v[80:83]
    v_mfma_f32_16x16x32_bf16 v[84:87], v[36:39], v[64:67], 0
    v_mfma_f32_16x16x32_bf16 v[84:87], v[52:55], v[68:71], v[84:87]
    v_mfma_f32_16x16x32_bf16 v[88:91], v[40:43], v[64:67], 0
    v_mfma_f32_16x16x32_bf16 v[88:91], v[56:59], v[68:71], v[88:91]
    v_mfma_f32_16x16x32_bf16 v[92:95], v[44:47], v[64:67], 0
    v_mfma_f32_16x16x32_bf16 v[92:95], v[60:63], v[68:71], v[92:95]
    s_nop 3
    v_add_f32_dpp v80, v84, v80 row_shl:4 row_mask:0xf bank_mask:0x1
    v_add_f32_dpp v81, v85, v81 row_shl:4 row_mask:0xf bank_mask:0x1
    v_add_f32_dpp v82, v86, v82 row_shl:4 row_mask:0xf bank_mask:0x1
    v_add_f32_dpp v83, v87, v83 row_shl:4 row_mask:0xf bank_mask:0x1
    v_add_f32_dpp v80, v88, v80 row_shl:8 row_mask:0xf bank_mask:0x1
    v_add_f32_dpp v81, v89, v81 row_shl:8 row_mask:0xf bank_mask:0x1
    v_add_f32_dpp v82, v90, v82 row_shl:8 row_mask:0xf bank_mask:0x1
    v_add_f32_dpp v83, v91, v83 row_shl:8 row_mask:0xf bank_mask:0x1
    v_add_f32_dpp v80, v92, v80 row_shl:12 row_mask:0xf bank_mask:0x1
    v_add_f32_dpp v81, v93, v81 row_shl:12 row_mask:0xf bank_mask:0x1
    v_add_f32_dpp v82, v94, v82 row_shl:12 row_mask:0xf bank_mask:0x1
    v_add_f32_dpp v83, v95, v83 row_shl:12 row_mask:0xf bank_mask:0x1
    ds_write_b128 v203, v[80:83]
    s_waitcnt lgkmcnt(0)
    s_barrier
    s_branch L_fin
L_w2_red:
    s_mov_b32 s35, 0
L_poll58:
    buffer_load_dwordx2 v[20:21], v204, s[44:47], 0 offen sc1
    buffer_load_dwordx2 v[22:23], v204, s[44:47], s48 offen sc1
    s_add_u32 s35, s35, 1
    s_waitcnt vmcnt(0)
    v_max3_u32 v28, v20, v21, v22
    v_max_u32 v28, v28, v23
    v_cmp_eq_u32 vcc, -1, v28
    s_cbranch_vccz L_done59
    s_cmp_lg_u32 s35, 21
    s_cbranch_scc1 L_tmo61
    s_mov_b64 exec, -1
    v_lshlrev_b32 v243, 4, v0
    v_add_u32 v243, 131328, v243
    ds_read_b96 v[240:242], v243
    s_waitcnt lgkmcnt(0)
    buffer_store_dword v240, v242, s[44:47], 0 offen sc1
    buffer_store_dword v241, v242, s[44:47], 0 offen offset:256 sc1
L_tmo61:
    s_sleep 6
    s_cmp_lt_u32 s35, 60000
    s_cbranch_scc1 L_poll58
L_done59:
    v_mov_b32 v7, 99084
    ds_write_b32 v7, v7
    v_lshlrev_b32 v44, 16, v20
    v_and_b32 v45, 0xffff0000, v20
    v_lshlrev_b32 v46, 16, v21
    v_and_b32 v47, 0xffff0000, v21
    v_lshlrev_b32 v48, 16, v22
    v_and_b32 v49, 0xffff0000, v22
    v_lshlrev_b32 v50, 16, v23
    v_and_b32 v51, 0xffff0000, v23
    v_add_f32 v108, v108, v44
    v_add_f32 v109, v109, v45
    v_add_f32 v110, v110, v46
    v_add_f32 v111, v111, v47
    v_add_f32 v108, v108, v48
    v_add_f32 v109, v109, v49
    v_add_f32 v110, v110, v50
    v_add_f32 v111, v111, v51
    s_mov_b32 s36, s28
    s_mov_b32 s37, s29
    s_movk_i32 s38, 5120
    v_add_f32_dpp v108, v108, v108 row_ror:4 row_mask:0xf bank_mask:0xf
    v_add_f32_dpp v109, v109, v109 row_ror:4 row_mask:0xf bank_mask:0xf
    v_add_f32_dpp v110, v110, v110 row_ror:4 row_mask:0xf bank_mask:0xf
    v_add_f32_dpp v111, v111, v111 row_ror:4 row_mask:0xf bank_mask:0xf
    v_add_f32_dpp v108, v108, v108 row_ror:8 row_mask:0xf bank_mask:0xf
    v_add_f32_dpp v109, v109, v109 row_ror:8 row_mask:0xf bank_mask:0xf
    v_add_f32_dpp v110, v110, v110 row_ror:8 row_mask:0xf bank_mask:0xf
    v_add_f32_dpp v111, v111, v111 row_ror:8 row_mask:0xf bank_mask:0xf
    v_mov_b32_dpp v108, v104 quad_perm:[0,1,2,3] row_mask:0xf bank_mask:0x2
    v_mov_b32_dpp v109, v105 quad_perm:[0,1,2,3] row_mask:0xf bank_mask:0x2
    v_mov_b32_dpp v110, v106 quad_perm:[0,1,2,3] row_mask:0xf bank_mask:0x2
    v_mov_b32_dpp v111, v107 quad_perm:[0,1,2,3] row_mask:0xf bank_mask:0x2
    ds_write_b128 v203, v[108:111]
    v_and_b32 v6, 31, v0
    v_lshlrev_b32 v6, 3, v6
    v_add_u32 v6, 122112, v6
    ds_read_b64 v[108:109], v6
    ds_read_b64 v[104:105], v6 offset:320
    v_bfe_u32 v112, v0, 1, 2
    v_mul_u32_u24 v112, 1280, v112
    v_bfe_u32 v7, v0, 3, 2
    v_lshl_add_u32 v112, v7, 3, v112
    v_and_b32 v7, 1, v0
    v_lshl_add_u32 v112, v7, 2, v112
    v_lshrrev_b32 v7, 5, v0
    v_lshl_add_u32 v112, v7, 28, v112
    s_lshl_b32 s34, s62, 5
    s_waitcnt lgkmcnt(0)
    s_barrier
    ds_read_b64 v[64:65], v6 offset:1024
    ds_read_b64 v[66:67], v6 offset:2048
    ds_read_b64 v[68:69], v6 offset:3072
    ds_read_b64 v[70:71], v6 offset:4096
    ds_read_b64 v[72:73], v6 offset:5120
    ds_read_b64 v[74:75], v6 offset:6144
    ds_read_b64 v[76:77], v6 offset:7168
    s_waitcnt lgkmcnt(6)
    v_pk_fma_f32 v[108:109], v[64:65], v[104:105], v[108:109]
    s_waitcnt lgkmcnt(5)
    v_pk_fma_f32 v[108:109], v[66:67], v[104:105], v[108:109]
    s_waitcnt lgkmcnt(4)
    v_pk_fma_f32 v[108:109], v[68:69], v[104:105], v[108:109]
    s_waitcnt lgkmcnt(3)
    v_pk_fma_f32 v[108:109], v[70:71], v[104:105], v[108:109]
    s_waitcnt lgkmcnt(2)
    v_pk_fma_f32 v[108:109], v[72:73], v[104:105], v[108:109]
    s_waitcnt lgkmcnt(1)
    v_pk_fma_f32 v[108:109], v[74:75], v[104:105], v[108:109]
    s_waitcnt lgkmcnt(0)
    v_pk_fma_f32 v[108:109], v[76:77], v[104:105], v[108:109]
    v_cvt_pk_bf16_f32 v20, v108, v109
    buffer_store_dword v20, v112, s[36:39], s34 offen
    s_branch L_fin
L_t_wo:
    s_barrier
L_r_wo2:
    s_mov_b32 m0, s56
    s_nop 0
    buffer_load_dwordx4 v15, s[52:55], s57 offen  lds
    s_mov_b32 m0, s58
    s_nop 0
    buffer_load_dwordx4 v15, s[52:55], s59 offen  lds
    s_xor_b32 m0, s56, 2048
    s_sub_u32 s34, 40960, s57
    buffer_load_dwordx4 v15, s[52:55], s34 offen  lds
    s_xor_b32 m0, s58, 2048
    s_sub_u32 s34, 42240, s57
    buffer_load_dwordx4 v15, s[52:55], s34 offen  lds
L_r_wo3:
    s_mov_b32 s35, 0
    s_mov_b32 s48, 0
    buffer_load_dwordx4 v[64:67], v205, s[44:47], 0 offen sc1
    buffer_load_dwordx2 v[26:27], v204, s[44:47], 0 offen sc1
    s_waitcnt vmcnt(2)
    ds_read_b64_tr_b16 v[32:33], v206 offset:0
    ds_read_b64_tr_b16 v[34:35], v206 offset:1024
    ds_read_b64_tr_b16 v[36:37], v206 offset:32
    ds_read_b64_tr_b16 v[38:39], v206 offset:1056
    ds_read_b64_tr_b16 v[40:41], v206 offset:2048
    ds_read_b64_tr_b16 v[42:43], v206 offset:3072
    ds_read_b64_tr_b16 v[44:45], v206 offset:2080
    ds_read_b64_tr_b16 v[46:47], v206 offset:3104
    s_branch L_pam
L_pa:
    buffer_load_dwordx4 v[64:67], v205, s[44:47], 0 offen sc1
    buffer_load_dwordx2 v[26:27], v204, s[44:47], 0 offen sc1
L_pam:
    s_add_u32 s35, s35, 1
    s_waitcnt vmcnt(0)
    ds_write_b128 v207, v[64:67]
    ds_write_b32 v212, v26 offset:128
    v_max3_u32 v28, v64, v65, v66
    v_max3_u32 v28, v28, v67, v26
    v_cmp_eq_u32 vcc, -1, v28
    s_cbranch_vccz L_pad
    s_cmp_lg_u32 s35, 64
    s_cbranch_scc1 L_tmo62
    s_mov_b64 exec, -1
    v_lshlrev_b32 v243, 4, v0
    v_add_u32 v243, 131328, v243
    ds_read_b96 v[240:242], v243
    s_waitcnt lgkmcnt(0)
    buffer_store_dword v240, v242, s[44:47], 0 offen sc1
    buffer_store_dword v241, v242, s[44:47], 0 offen offset:256 sc1
L_tmo62:
    s_mov_b64 exec, vcc
    s_cmp_lt_u32 s35, 60000
    s_cbranch_scc1 L_pa
L_pad:
    s_mov_b64 exec, -1
    ds_read_b32 v26, v213 offset:128
    ds_read_b128 v[68:71], v208 offset:0
    ds_read_b128 v[72:75], v209 offset:0
    ds_read_b128 v[76:79], v208 offset:64
    ds_read_b128 v[80:83], v209 offset:64
    s_waitcnt lgkmcnt(3)
    v_mfma_f32_16x16x32_bf16 v[20:23], v[32:35], v[68:71], 0
    s_waitcnt lgkmcnt(2)
    v_mfma_f32_16x16x32_bf16 v[20:23], v[36:39], v[72:75], v[20:23]
    s_waitcnt lgkmcnt(1)
    v_mfma_f32_16x16x32_bf16 v[20:23], v[40:43], v[76:79], v[20:23]
    s_waitcnt lgkmcnt(0)
    v_mfma_f32_16x16x32_bf16 v[20:23], v[44:47], v[80:83], v[20:23]
    v_sub_f32_dpp v26, v26, v26 quad_perm:[1,0,3,2] row_mask:0xf bank_mask:0xf
    v_exp_f32 v26, v26
    s_nop 0
    v_add_f32 v26, 1.0, v26
    v_rcp_f32 v26, v26
    s_nop 0
    v_sub_f32 v30, 1.0, v26
    s_nop 0
    v_pk_mul_f32 v[48:49], v[20:21], v[26:27] op_sel_hi:[1,0]
    v_pk_mul_f32 v[50:51], v[22:23], v[26:27] op_sel_hi:[1,0]
    v_fmac_f32_dpp v48, v20, v30 quad_perm:[1,0,3,2] row_mask:0xf bank_mask:0xf
    v_fmac_f32_dpp v49, v21, v30 quad_perm:[1,0,3,2] row_mask:0xf bank_mask:0xf
    v_fmac_f32_dpp v50, v22, v30 quad_perm:[1,0,3,2] row_mask:0xf bank_mask:0xf
    v_fmac_f32_dpp v51, v23, v30 quad_perm:[1,0,3,2] row_mask:0xf bank_mask:0xf
    ds_write_b128 v203, v[48:51]
    s_cmp_lg_u32 s3, 0
    s_waitcnt lgkmcnt(0)
    s_barrier
    s_cbranch_scc1 L_wo_x
    ds_read_b64 v[64:65], v113 offset:0
    ds_read_b64 v[66:67], v113 offset:1152
    ds_read_b64 v[68:69], v113 offset:2304
    ds_read_b64 v[70:71], v113 offset:3456
    ds_read_b64 v[72:73], v113 offset:4608
    ds_read_b64 v[74:75], v113 offset:5760
    ds_read_b64 v[76:77], v113 offset:6912
    ds_read_b64 v[78:79], v113 offset:8064
    s_waitcnt lgkmcnt(6)
    v_pk_add_f32 v[64:65], v[64:65], v[66:67]
    s_waitcnt lgkmcnt(5)
    v_pk_add_f32 v[64:65], v[64:65], v[68:69]
    s_waitcnt lgkmcnt(4)
    v_pk_add_f32 v[64:65], v[64:65], v[70:71]
    s_waitcnt lgkmcnt(3)
    v_pk_add_f32 v[64:65], v[64:65], v[72:73]
    s_waitcnt lgkmcnt(2)
    v_pk_add_f32 v[64:65], v[64:65], v[74:75]
    s_waitcnt lgkmcnt(1)
    v_pk_add_f32 v[64:65], v[64:65], v[76:77]
    s_waitcnt lgkmcnt(0)
    v_pk_add_f32 v[64:65], v[64:65], v[78:79]
    v_pk_mul_f32 v[64:65], v[64:65], v[100:101]
    v_cvt_pk_bf16_f32 v28, v64, v65
    v_min_u32 v28, -2, v28
    buffer_store_dword v28, v112, s[44:47], s101 offen sc1
    buffer_store_dword v28, v112, s[44:47], s93 offen sc1
L_wo_x:
    s_getreg_b32 s34, hwreg(HW_REG_XCC_ID, 0, 4)
    v_cmp_ne_u32 vcc, s34, v27
    s_cbranch_vccz L_fin
    s_mov_b64 exec, -1
    v_lshlrev_b32 v243, 4, v0
    v_add_u32 v243, 131328, v243
    ds_read_b96 v[240:242], v243
    s_waitcnt lgkmcnt(0)
    buffer_store_dword v240, v242, s[44:47], 0 offen sc1
    buffer_store_dword v241, v242, s[44:47], 0 offen offset:256 sc1
L_fin:
L_exit:
    s_endpgm
L_codeend:
.section .rodata,"a"
.p2align 6
.amdhsa_kernel adaLN_cond__sliding_block_cached__dense_activation_gelu__decode_kernel
  .amdhsa_next_free_vgpr 256
  .amdhsa_next_free_sgpr 102
  .amdhsa_accum_offset 256
  .amdhsa_group_segment_fixed_size 0
  .amdhsa_kernarg_size 120
  .amdhsa_user_sgpr_count 2
  .amdhsa_user_sgpr_kernarg_segment_ptr 1
  .amdhsa_system_sgpr_workgroup_id_x 1
  .amdhsa_float_denorm_mode_32 3
.end_amdhsa_kernel
```

```asm
; @launch grid=(256,1,1) block=(512,1,1) lds=132352
.amdgcn_target "amdgcn-amd-amdhsa--gfx950"
.text
.globl adaLN_cond__sliding_block_cached__dense_activation_gelu__decode_kernel
.p2align 8
.type adaLN_cond__sliding_block_cached__dense_activation_gelu__decode_kernel,@function
adaLN_cond__sliding_block_cached__dense_activation_gelu__decode_kernel:
    s_cmp_ge_u32 s2, 256
    s_cbranch_scc1 L_exit
    s_load_dwordx4 s[4:7], s[0:1], 0
    v_lshrrev_b32 v1, 6, v0
    v_and_b32 v0, 63, v0
    v_readfirstlane_b32 s3, v1
    s_and_b32 s34, s2, 127
    s_lshl_b32 s34, s34, 21
    s_lshr_b32 s35, s2, 7
    s_lshl_b32 s35, s35, 18
    s_add_u32 s34, s34, s35
    s_add_u32 s34, s34, 1572864
    s_mov_b32 s38, 0x40000
    s_mov_b32 s39, 0x20000
    s_sub_u32 s49, s3, 1
    s_cbranch_scc1 L_nohead
    s_lshl_b32 s49, s49, 12
    v_lshl_add_u32 v1, v0, 4, s49
    s_waitcnt lgkmcnt(0)
    s_add_u32 s36, s6, s34
    s_addc_u32 s37, s7, 0
    buffer_load_dwordx4 v[16:19], v1, s[36:39], 0 offen offset:0 nt
    buffer_load_dwordx4 v[20:23], v1, s[36:39], 0 offen offset:1024 nt
    buffer_load_dwordx4 v[24:27], v1, s[36:39], 0 offen offset:2048 nt
L_nohead:
    s_load_dwordx8 s[8:15], s[0:1], 16
    s_load_dwordx4 s[16:19], s[0:1], 48
    s_load_dwordx8 s[20:27], s[0:1], 64
    s_load_dwordx4 s[28:31], s[0:1], 96
    s_load_dwordx2 s[32:33], s[0:1], 112
    s_and_b32 s60, s2, 7
    s_lshr_b32 s61, s2, 3
    s_mov_b32 s39, 0x20000
    s_mov_b32 s43, 0x20000
    s_mov_b32 s46, 1703936
    s_mov_b32 s47, 0x20000
    s_cmp_lg_u32 s3, 0
    s_cbranch_scc1 L_stream
    s_setprio 3
    v_and_b32 v12, 3, v0
    v_bfe_u32 v13, v0, 2, 2
    v_lshrrev_b32 v14, 4, v0
    v_lshrrev_b32 v10, 3, v0
    v_and_b32 v11, 7, v0
    v_lshlrev_b32 v11, 4, v11
    s_lshr_b32 s50, s2, 2
    s_and_b32 s51, s2, 3
    s_mul_i32 s34, s51, 1228800
    s_lshl_b32 s35, s50, 7
    s_add_u32 s34, s34, s35
    v_mul_u32_u24 v17, 7680, v10
    v_add3_u32 v17, v17, v11, s34
    v_mul_u32_u24 v16, 1280, v12
    v_lshl_add_u32 v18, v14, 4, v16
    s_mul_i32 s34, s51, 320
    v_add_u32 v19, s34, v18
    s_mov_b32 s38, 4915200
    s_sub_u32 s52, s50, 10
    s_waitcnt lgkmcnt(0)
    s_add_u32 s44, s32, 0
    s_addc_u32 s45, s33, 0
    s_cmp_ge_u32 s2, 240
    s_cbranch_scc1 L_clear
    s_cmp_ge_u32 s52, 10
    s_cbranch_scc1 L_nox
    v_lshl_add_u32 v18, v13, 6, v18
    global_load_dwordx4 v[52:55], v18, s[4:5] offset:0
    global_load_dwordx4 v[56:59], v18, s[4:5] offset:256
    global_load_dwordx4 v[60:63], v18, s[4:5] offset:512
    global_load_dwordx4 v[64:67], v18, s[4:5] offset:768
    global_load_dwordx4 v[68:71], v18, s[4:5] offset:1024
    s_lshl_b32 s34, s52, 7
    v_lshl_add_u32 v16, v13, 5, v16
    v_lshl_add_u32 v16, v14, 3, v16
    v_add_u32 v16, s34, v16
    global_load_dwordx2 v[72:73], v16, s[4:5]
L_nox:
    global_load_dwordx4 v[32:35], v19, s[24:25] offset:0
    global_load_dwordx4 v[36:39], v19, s[24:25] offset:64
    global_load_dwordx4 v[40:43], v19, s[24:25] offset:128
    global_load_dwordx4 v[44:47], v19, s[24:25] offset:192
    global_load_dwordx4 v[48:51], v19, s[24:25] offset:256
    s_mov_b32 s36, s26
    s_mov_b32 s37, s27
    s_mov_b32 m0, 0
    s_mov_b32 s34, 0
L_dma1:
    buffer_load_dwordx4 v17, s[36:39], s34 offen  lds
    s_add_u32 m0, m0, 1024
    s_add_u32 s34, s34, 61440
    buffer_load_dwordx4 v17, s[36:39], s34 offen  lds
    s_add_u32 m0, m0, 1024
    s_add_u32 s34, s34, 61440
    buffer_load_dwordx4 v17, s[36:39], s34 offen  lds
    s_add_u32 m0, m0, 1024
    s_add_u32 s34, s34, 61440
    buffer_load_dwordx4 v17, s[36:39], s34 offen  lds
    s_add_u32 m0, m0, 1024
    s_add_u32 s34, s34, 61440
    s_cmp_lt_u32 s34, 1228800
    s_cbranch_scc1 L_dma1
    v_lshlrev_b32 v1, 2, v0
    v_add_u32 v1, 98304, v1
    v_mov_b32 v2, -1
    v_mov_b32 v3, 0
    ds_write_b32 v1, v2
    ds_write_b32 v1, v2 offset:256
    ds_write_b32 v1, v3 offset:512
    ds_write_b32 v1, v3 offset:768
    s_waitcnt lgkmcnt(0)
    s_barrier
    s_and_b32 s34, s2, 31
    s_lshl_b32 s34, s34, 8
    s_lshr_b32 s35, s2, 7
    s_lshl_b32 s35, s35, 7
    s_add_u32 s49, s34, s35
    s_bfe_u32 s53, s2, 0x20005
    s_mul_i32 s34, s53, 1310720
    s_add_u32 s34, s34, s49
    v_lshl_add_u32 v16, v10, 13, v11
    v_add_u32 v16, s34, v16
    s_mov_b32 s36, s10
    s_mov_b32 s37, s11
    s_mov_b32 s38, 5242880
    s_mov_b32 m0, 20480
    s_mov_b32 s34, 0
L_dma2:
    buffer_load_dwordx4 v16, s[36:39], s34 offen  lds
    s_add_u32 m0, m0, 1024
    s_add_u32 s34, s34, 65536
    buffer_load_dwordx4 v16, s[36:39], s34 offen  lds
    s_add_u32 m0, m0, 1024
    s_add_u32 s34, s34, 65536
    buffer_load_dwordx4 v16, s[36:39], s34 offen  lds
    s_add_u32 m0, m0, 1024
    s_add_u32 s34, s34, 65536
    buffer_load_dwordx4 v16, s[36:39], s34 offen  lds
    s_add_u32 m0, m0, 1024
    s_add_u32 s34, s34, 65536
    s_cmp_lt_u32 s34, 1310720
    s_cbranch_scc1 L_dma2
    v_lshl_add_u32 v15, v14, 3, v13
    v_lshlrev_b32 v15, 7, v15
    v_lshl_add_u32 v15, v12, 3, v15
    s_waitcnt vmcnt(40)
    s_mov_b32 s34, 0xbfb8aa3b
    v_lshlrev_b32 v20, 16, v32
    v_and_b32 v21, 0xffff0000, v32
    v_lshlrev_b32 v22, 16, v33
    v_and_b32 v23, 0xffff0000, v33
    v_mul_f32 v24, s34, v20
    v_mul_f32 v25, s34, v21
    v_mul_f32 v26, s34, v22
    v_mul_f32 v27, s34, v23
    v_exp_f32 v24, v24
    v_exp_f32 v25, v25
    v_exp_f32 v26, v26
    v_exp_f32 v27, v27
    v_add_f32 v24, 1.0, v24
    v_add_f32 v25, 1.0, v25
    v_add_f32 v26, 1.0, v26
    v_add_f32 v27, 1.0, v27
    v_rcp_f32 v24, v24
    v_rcp_f32 v25, v25
    v_rcp_f32 v26, v26
    v_rcp_f32 v27, v27
    v_mul_f32 v24, v20, v24
    v_mul_f32 v25, v21, v25
    v_mul_f32 v26, v22, v26
    v_mul_f32 v27, v23, v27
    v_cvt_pk_bf16_f32 v32, v24, v25
    v_cvt_pk_bf16_f32 v33, v26, v27
    v_lshlrev_b32 v20, 16, v34
    v_and_b32 v21, 0xffff0000, v34
    v_lshlrev_b32 v22, 16, v35
    v_and_b32 v23, 0xffff0000, v35
    v_mul_f32 v24, s34, v20
    v_mul_f32 v25, s34, v21
    v_mul_f32 v26, s34, v22
    v_mul_f32 v27, s34, v23
    v_exp_f32 v24, v24
    v_exp_f32 v25, v25
    v_exp_f32 v26, v26
    v_exp_f32 v27, v27
    v_add_f32 v24, 1.0, v24
    v_add_f32 v25, 1.0, v25
    v_add_f32 v26, 1.0, v26
    v_add_f32 v27, 1.0, v27
    v_rcp_f32 v24, v24
    v_rcp_f32 v25, v25
    v_rcp_f32 v26, v26
    v_rcp_f32 v27, v27
    v_mul_f32 v24, v20, v24
    v_mul_f32 v25, v21, v25
    v_mul_f32 v26, v22, v26
    v_mul_f32 v27, v23, v27
    v_cvt_pk_bf16_f32 v34, v24, v25
    v_cvt_pk_bf16_f32 v35, v26, v27
    v_lshlrev_b32 v20, 16, v36
    v_and_b32 v21, 0xffff0000, v36
    v_lshlrev_b32 v22, 16, v37
    v_and_b32 v23, 0xffff0000, v37
    v_mul_f32 v24, s34, v20
    v_mul_f32 v25, s34, v21
    v_mul_f32 v26, s34, v22
    v_mul_f32 v27, s34, v23
    v_exp_f32 v24, v24
    v_exp_f32 v25, v25
    v_exp_f32 v26, v26
    v_exp_f32 v27, v27
    v_add_f32 v24, 1.0, v24
    v_add_f32 v25, 1.0, v25
    v_add_f32 v26, 1.0, v26
    v_add_f32 v27, 1.0, v27
    v_rcp_f32 v24, v24
    v_rcp_f32 v25, v25
    v_rcp_f32 v26, v26
    v_rcp_f32 v27, v27
    v_mul_f32 v24, v20, v24
    v_mul_f32 v25, v21, v25
    v_mul_f32 v26, v22, v26
    v_mul_f32 v27, v23, v27
    v_cvt_pk_bf16_f32 v36, v24, v25
    v_cvt_pk_bf16_f32 v37, v26, v27
    v_lshlrev_b32 v20, 16, v38
    v_and_b32 v21, 0xffff0000, v38
    v_lshlrev_b32 v22, 16, v39
    v_and_b32 v23, 0xffff0000, v39
    v_mul_f32 v24, s34, v20
    v_mul_f32 v25, s34, v21
    v_mul_f32 v26, s34, v22
    v_mul_f32 v27, s34, v23
    v_exp_f32 v24, v24
    v_exp_f32 v25, v25
    v_exp_f32 v26, v26
    v_exp_f32 v27, v27
    v_add_f32 v24, 1.0, v24
    v_add_f32 v25, 1.0, v25
    v_add_f32 v26, 1.0, v26
    v_add_f32 v27, 1.0, v27
    v_rcp_f32 v24, v24
    v_rcp_f32 v25, v25
    v_rcp_f32 v26, v26
    v_rcp_f32 v27, v27
    v_mul_f32 v24, v20, v24
    v_mul_f32 v25, v21, v25
    v_mul_f32 v26, v22, v26
    v_mul_f32 v27, v23, v27
    v_cvt_pk_bf16_f32 v38, v24, v25
    v_cvt_pk_bf16_f32 v39, v26, v27
    v_lshlrev_b32 v20, 16, v40
    v_and_b32 v21, 0xffff0000, v40
    v_lshlrev_b32 v22, 16, v41
    v_and_b32 v23, 0xffff0000, v41
    v_mul_f32 v24, s34, v20
    v_mul_f32 v25, s34, v21
    v_mul_f32 v26, s34, v22
    v_mul_f32 v27, s34, v23
    v_exp_f32 v24, v24
    v_exp_f32 v25, v25
    v_exp_f32 v26, v26
    v_exp_f32 v27, v27
    v_add_f32 v24, 1.0, v24
    v_add_f32 v25, 1.0, v25
    v_add_f32 v26, 1.0, v26
    v_add_f32 v27, 1.0, v27
    v_rcp_f32 v24, v24
    v_rcp_f32 v25, v25
    v_rcp_f32 v26, v26
    v_rcp_f32 v27, v27
    v_mul_f32 v24, v20, v24
    v_mul_f32 v25, v21, v25
    v_mul_f32 v26, v22, v26
    v_mul_f32 v27, v23, v27
    v_cvt_pk_bf16_f32 v40, v24, v25
    v_cvt_pk_bf16_f32 v41, v26, v27
    v_lshlrev_b32 v20, 16, v42
    v_and_b32 v21, 0xffff0000, v42
    v_lshlrev_b32 v22, 16, v43
    v_and_b32 v23, 0xffff0000, v43
    v_mul_f32 v24, s34, v20
    v_mul_f32 v25, s34, v21
    v_mul_f32 v26, s34, v22
    v_mul_f32 v27, s34, v23
    v_exp_f32 v24, v24
    v_exp_f32 v25, v25
    v_exp_f32 v26, v26
    v_exp_f32 v27, v27
    v_add_f32 v24, 1.0, v24
    v_add_f32 v25, 1.0, v25
    v_add_f32 v26, 1.0, v26
    v_add_f32 v27, 1.0, v27
    v_rcp_f32 v24, v24
    v_rcp_f32 v25, v25
    v_rcp_f32 v26, v26
    v_rcp_f32 v27, v27
    v_mul_f32 v24, v20, v24
    v_mul_f32 v25, v21, v25
    v_mul_f32 v26, v22, v26
    v_mul_f32 v27, v23, v27
    v_cvt_pk_bf16_f32 v42, v24, v25
    v_cvt_pk_bf16_f32 v43, v26, v27
    v_lshlrev_b32 v20, 16, v44
    v_and_b32 v21, 0xffff0000, v44
    v_lshlrev_b32 v22, 16, v45
    v_and_b32 v23, 0xffff0000, v45
    v_mul_f32 v24, s34, v20
    v_mul_f32 v25, s34, v21
    v_mul_f32 v26, s34, v22
    v_mul_f32 v27, s34, v23
    v_exp_f32 v24, v24
    v_exp_f32 v25, v25
    v_exp_f32 v26, v26
    v_exp_f32 v27, v27
    v_add_f32 v24, 1.0, v24
    v_add_f32 v25, 1.0, v25
    v_add_f32 v26, 1.0, v26
    v_add_f32 v27, 1.0, v27
    v_rcp_f32 v24, v24
    v_rcp_f32 v25, v25
    v_rcp_f32 v26, v26
    v_rcp_f32 v27, v27
    v_mul_f32 v24, v20, v24
    v_mul_f32 v25, v21, v25
    v_mul_f32 v26, v22, v26
    v_mul_f32 v27, v23, v27
    v_cvt_pk_bf16_f32 v44, v24, v25
    v_cvt_pk_bf16_f32 v45, v26, v27
    v_lshlrev_b32 v20, 16, v46
    v_and_b32 v21, 0xffff0000, v46
    v_lshlrev_b32 v22, 16, v47
    v_and_b32 v23, 0xffff0000, v47
    v_mul_f32 v24, s34, v20
    v_mul_f32 v25, s34, v21
    v_mul_f32 v26, s34, v22
    v_mul_f32 v27, s34, v23
    v_exp_f32 v24, v24
    v_exp_f32 v25, v25
    v_exp_f32 v26, v26
    v_exp_f32 v27, v27
    v_add_f32 v24, 1.0, v24
    v_add_f32 v25, 1.0, v25
    v_add_f32 v26, 1.0, v26
    v_add_f32 v27, 1.0, v27
    v_rcp_f32 v24, v24
    v_rcp_f32 v25, v25
    v_rcp_f32 v26, v26
    v_rcp_f32 v27, v27
    v_mul_f32 v24, v20, v24
    v_mul_f32 v25, v21, v25
    v_mul_f32 v26, v22, v26
    v_mul_f32 v27, v23, v27
    v_cvt_pk_bf16_f32 v46, v24, v25
    v_cvt_pk_bf16_f32 v47, v26, v27
    v_lshlrev_b32 v20, 16, v48
    v_and_b32 v21, 0xffff0000, v48
    v_lshlrev_b32 v22, 16, v49
    v_and_b32 v23, 0xffff0000, v49
    v_mul_f32 v24, s34, v20
    v_mul_f32 v25, s34, v21
    v_mul_f32 v26, s34, v22
    v_mul_f32 v27, s34, v23
    v_exp_f32 v24, v24
    v_exp_f32 v25, v25
    v_exp_f32 v26, v26
    v_exp_f32 v27, v27
    v_add_f32 v24, 1.0, v24
    v_add_f32 v25, 1.0, v25
    v_add_f32 v26, 1.0, v26
    v_add_f32 v27, 1.0, v27
    v_rcp_f32 v24, v24
    v_rcp_f32 v25, v25
    v_rcp_f32 v26, v26
    v_rcp_f32 v27, v27
    v_mul_f32 v24, v20, v24
    v_mul_f32 v25, v21, v25
    v_mul_f32 v26, v22, v26
    v_mul_f32 v27, v23, v27
    v_cvt_pk_bf16_f32 v48, v24, v25
    v_cvt_pk_bf16_f32 v49, v26, v27
    v_lshlrev_b32 v20, 16, v50
    v_and_b32 v21, 0xffff0000, v50
    v_lshlrev_b32 v22, 16, v51
    v_and_b32 v23, 0xffff0000, v51
    v_mul_f32 v24, s34, v20
    v_mul_f32 v25, s34, v21
    v_mul_f32 v26, s34, v22
    v_mul_f32 v27, s34, v23
    v_exp_f32 v24, v24
    v_exp_f32 v25, v25
    v_exp_f32 v26, v26
    v_exp_f32 v27, v27
    v_add_f32 v24, 1.0, v24
    v_add_f32 v25, 1.0, v25
    v_add_f32 v26, 1.0, v26
    v_add_f32 v27, 1.0, v27
    v_rcp_f32 v24, v24
    v_rcp_f32 v25, v25
    v_rcp_f32 v26, v26
    v_rcp_f32 v27, v27
    v_mul_f32 v24, v20, v24
    v_mul_f32 v25, v21, v25
    v_mul_f32 v26, v22, v26
    v_mul_f32 v27, v23, v27
    v_cvt_pk_bf16_f32 v50, v24, v25
    v_cvt_pk_bf16_f32 v51, v26, v27
    s_cmp_ge_u32 s52, 10
    s_cbranch_scc1 L_nostats
    v_mov_b32 v20, 0
    v_mov_b32 v21, 0
    v_mov_b32 v22, 0x3f803f80
    v_dot2c_f32_bf16 v20, v52, v22
    v_dot2c_f32_bf16 v21, v52, v52
    v_dot2c_f32_bf16 v20, v53, v22
    v_dot2c_f32_bf16 v21, v53, v53
    v_dot2c_f32_bf16 v20, v54, v22
    v_dot2c_f32_bf16 v21, v54, v54
    v_dot2c_f32_bf16 v20, v55, v22
    v_dot2c_f32_bf16 v21, v55, v55
    v_dot2c_f32_bf16 v20, v56, v22
    v_dot2c_f32_bf16 v21, v56, v56
    v_dot2c_f32_bf16 v20, v57, v22
    v_dot2c_f32_bf16 v21, v57, v57
    v_dot2c_f32_bf16 v20, v58, v22
    v_dot2c_f32_bf16 v21, v58, v58
    v_dot2c_f32_bf16 v20, v59, v22
    v_dot2c_f32_bf16 v21, v59, v59
    v_dot2c_f32_bf16 v20, v60, v22
    v_dot2c_f32_bf16 v21, v60, v60
    v_dot2c_f32_bf16 v20, v61, v22
    v_dot2c_f32_bf16 v21, v61, v61
    v_dot2c_f32_bf16 v20, v62, v22
    v_dot2c_f32_bf16 v21, v62, v62
    v_dot2c_f32_bf16 v20, v63, v22
    v_dot2c_f32_bf16 v21, v63, v63
    v_dot2c_f32_bf16 v20, v64, v22
    v_dot2c_f32_bf16 v21, v64, v64
    v_dot2c_f32_bf16 v20, v65, v22
    v_dot2c_f32_bf16 v21, v65, v65
    v_dot2c_f32_bf16 v20, v66, v22
    v_dot2c_f32_bf16 v21, v66, v66
    v_dot2c_f32_bf16 v20, v67, v22
    v_dot2c_f32_bf16 v21, v67, v67
    v_dot2c_f32_bf16 v20, v68, v22
    v_dot2c_f32_bf16 v21, v68, v68
    v_dot2c_f32_bf16 v20, v69, v22
    v_dot2c_f32_bf16 v21, v69, v69
    v_dot2c_f32_bf16 v20, v70, v22
    v_dot2c_f32_bf16 v21, v70, v70
    v_dot2c_f32_bf16 v20, v71, v22
    v_dot2c_f32_bf16 v21, v71, v71
    s_nop 1
    v_add_f32_dpp v20, v20, v20 row_ror:4 row_mask:0xf bank_mask:0xf
    v_add_f32_dpp v21, v21, v21 row_ror:4 row_mask:0xf bank_mask:0xf
    s_nop 0
    v_add_f32_dpp v20, v20, v20 row_ror:8 row_mask:0xf bank_mask:0xf
    v_add_f32_dpp v21, v21, v21 row_ror:8 row_mask:0xf bank_mask:0xf
    v_mov_b32 v22, v20
    v_mov_b32 v23, v21
    s_nop 0
    v_permlane16_swap_b32 v20, v22
    v_permlane16_swap_b32 v21, v23
    v_add_f32 v20, v20, v22
    v_add_f32 v21, v21, v23
    v_mov_b32 v22, v20
    v_mov_b32 v23, v21
    s_nop 0
    v_permlane32_swap_b32 v20, v22
    v_permlane32_swap_b32 v21, v23
    v_add_f32 v20, v20, v22
    v_add_f32 v21, v21, v23
    v_mul_f32 v22, 0x3acccccd, v20
    v_mul_f32 v21, 0x3acccccd, v21
    v_fma_f32 v21, -v22, v22, v21
    v_max_f32 v21, 0, v21
    v_add_f32 v21, 0x3727c5ac, v21
    v_rsq_f32 v20, v21
    s_nop 0
    v_mul_f32_e64 v21, -v22, v20
    v_lshlrev_b32 v24, 16, v72
    v_and_b32 v25, 0xffff0000, v72
    v_lshlrev_b32 v26, 16, v73
    v_and_b32 v27, 0xffff0000, v73
    v_fma_f32 v24, v24, v20, v21
    v_fma_f32 v25, v25, v20, v21
    v_fma_f32 v26, v26, v20, v21
    v_fma_f32 v27, v27, v20, v21
L_nostats:
    s_waitcnt vmcnt(20)
    ds_read_b64_tr_b16 v[96:97], v15 offset:0
    ds_read_b64_tr_b16 v[98:99], v15 offset:512
    ds_read_b64_tr_b16 v[100:101], v15 offset:32
    ds_read_b64_tr_b16 v[102:103], v15 offset:544
    ds_read_b64_tr_b16 v[104:105], v15 offset:64
    ds_read_b64_tr_b16 v[106:107], v15 offset:576
    ds_read_b64_tr_b16 v[108:109], v15 offset:96
    ds_read_b64_tr_b16 v[110:111], v15 offset:608
    s_waitcnt lgkmcnt(7)
    ds_read_b64_tr_b16 v[112:113], v15 offset:4096
    ds_read_b64_tr_b16 v[114:115], v15 offset:4608
    ds_read_b64_tr_b16 v[116:117], v15 offset:4128
    ds_read_b64_tr_b16 v[118:119], v15 offset:4640
    ds_read_b64_tr_b16 v[120:121], v15 offset:4160
    ds_read_b64_tr_b16 v[122:123], v15 offset:4672
    ds_read_b64_tr_b16 v[124:125], v15 offset:4192
    ds_read_b64_tr_b16 v[126:127], v15 offset:4704
    s_waitcnt lgkmcnt(7)
    ds_read_b64_tr_b16 v[128:129], v15 offset:8192
    ds_read_b64_tr_b16 v[130:131], v15 offset:8704
    ds_read_b64_tr_b16 v[132:133], v15 offset:8224
    ds_read_b64_tr_b16 v[134:135], v15 offset:8736
    ds_read_b64_tr_b16 v[136:137], v15 offset:8256
    ds_read_b64_tr_b16 v[138:139], v15 offset:8768
    ds_read_b64_tr_b16 v[140:141], v15 offset:8288
    ds_read_b64_tr_b16 v[142:143], v15 offset:8800
    s_waitcnt lgkmcnt(7)
    ds_read_b64_tr_b16 v[144:145], v15 offset:12288
    ds_read_b64_tr_b16 v[146:147], v15 offset:12800
    ds_read_b64_tr_b16 v[148:149], v15 offset:12320
    ds_read_b64_tr_b16 v[150:151], v15 offset:12832
    ds_read_b64_tr_b16 v[152:153], v15 offset:12352
    ds_read_b64_tr_b16 v[154:155], v15 offset:12864
    ds_read_b64_tr_b16 v[156:157], v15 offset:12384
    ds_read_b64_tr_b16 v[158:159], v15 offset:12896
    s_waitcnt lgkmcnt(7)
    ds_read_b64_tr_b16 v[160:161], v15 offset:16384
    ds_read_b64_tr_b16 v[162:163], v15 offset:16896
    ds_read_b64_tr_b16 v[164:165], v15 offset:16416
    ds_read_b64_tr_b16 v[166:167], v15 offset:16928
    ds_read_b64_tr_b16 v[168:169], v15 offset:16448
    ds_read_b64_tr_b16 v[170:171], v15 offset:16960
    ds_read_b64_tr_b16 v[172:173], v15 offset:16480
    ds_read_b64_tr_b16 v[174:175], v15 offset:16992
    s_waitcnt lgkmcnt(0)
    v_mfma_f32_16x16x32_bf16 v[80:83], v[96:99], v[32:35], 0
    v_mfma_f32_16x16x32_bf16 v[84:87], v[100:103], v[32:35], 0
    v_mfma_f32_16x16x32_bf16 v[88:91], v[104:107], v[32:35], 0
    v_mfma_f32_16x16x32_bf16 v[92:95], v[108:111], v[32:35], 0
    v_mfma_f32_16x16x32_bf16 v[80:83], v[112:115], v[36:39], v[80:83]
    v_mfma_f32_16x16x32_bf16 v[84:87], v[116:119], v[36:39], v[84:87]
    v_mfma_f32_16x16x32_bf16 v[88:91], v[120:123], v[36:39], v[88:91]
    v_mfma_f32_16x16x32_bf16 v[92:95], v[124:127], v[36:39], v[92:95]
    v_mfma_f32_16x16x32_bf16 v[80:83], v[128:131], v[40:43], v[80:83]
    v_mfma_f32_16x16x32_bf16 v[84:87], v[132:135], v[40:43], v[84:87]
    v_mfma_f32_16x16x32_bf16 v[88:91], v[136:139], v[40:43], v[88:91]
    v_mfma_f32_16x16x32_bf16 v[92:95], v[140:143], v[40:43], v[92:95]
    v_mfma_f32_16x16x32_bf16 v[80:83], v[144:147], v[44:47], v[80:83]
    v_mfma_f32_16x16x32_bf16 v[84:87], v[148:151], v[44:47], v[84:87]
    v_mfma_f32_16x16x32_bf16 v[88:91], v[152:155], v[44:47], v[88:91]
    v_mfma_f32_16x16x32_bf16 v[92:95], v[156:159], v[44:47], v[92:95]
    v_mfma_f32_16x16x32_bf16 v[80:83], v[160:163], v[48:51], v[80:83]
    v_mfma_f32_16x16x32_bf16 v[84:87], v[164:167], v[48:51], v[84:87]
    v_mfma_f32_16x16x32_bf16 v[88:91], v[168:171], v[48:51], v[88:91]
    v_mfma_f32_16x16x32_bf16 v[92:95], v[172:175], v[48:51], v[92:95]
    s_cmp_ge_u32 s50, 20
    s_cbranch_scc1 L_adr_rest
    s_cmp_lt_u32 s50, 10
    s_cselect_b32 s34, 5120, 0
    s_cselect_b32 s35, s50, s52
    s_lshl_b32 s35, s35, 9
    s_add_u32 s34, s34, s35
    s_lshl_b32 s35, s51, 15
    s_add_u32 s34, s34, s35
    v_lshrrev_b32 v19, 1, v14
    v_lshl_add_u32 v19, v13, 1, v19
    v_lshlrev_b32 v19, 6, v19
    v_lshl_add_u32 v19, v12, 4, v19
    v_and_b32 v20, 1, v14
    v_lshl_add_u32 v19, v20, 3, v19
    s_branch L_adr_done
L_adr_rest:
    s_lshl_b32 s34, s51, 15
    s_lshl_b32 s35, s50, 9
    s_add_u32 s34, s34, s35
    s_add_u32 s34, s34, 0
    v_lshlrev_b32 v19, 7, v12
    v_lshl_add_u32 v19, v13, 5, v19
    v_lshl_add_u32 v19, v14, 3, v19
    s_nop 3
L_adr_done:
    v_add_u32 v19, s34, v19
    v_mov_b32_dpp v80, v84 quad_perm:[0,1,2,3] row_mask:0xf bank_mask:0x2
    v_mov_b32_dpp v81, v85 quad_perm:[0,1,2,3] row_mask:0xf bank_mask:0x2
    v_mov_b32_dpp v82, v86 quad_perm:[0,1,2,3] row_mask:0xf bank_mask:0x2
    v_mov_b32_dpp v83, v87 quad_perm:[0,1,2,3] row_mask:0xf bank_mask:0x2
    v_mov_b32_dpp v80, v88 quad_perm:[0,1,2,3] row_mask:0xf bank_mask:0x4
    v_mov_b32_dpp v81, v89 quad_perm:[0,1,2,3] row_mask:0xf bank_mask:0x4
    v_mov_b32_dpp v82, v90 quad_perm:[0,1,2,3] row_mask:0xf bank_mask:0x4
    v_mov_b32_dpp v83, v91 quad_perm:[0,1,2,3] row_mask:0xf bank_mask:0x4
    v_mov_b32_dpp v80, v92 quad_perm:[0,1,2,3] row_mask:0xf bank_mask:0x8
    v_mov_b32_dpp v81, v93 quad_perm:[0,1,2,3] row_mask:0xf bank_mask:0x8
    v_mov_b32_dpp v82, v94 quad_perm:[0,1,2,3] row_mask:0xf bank_mask:0x8
    v_mov_b32_dpp v83, v95 quad_perm:[0,1,2,3] row_mask:0xf bank_mask:0x8
    s_cmp_ge_u32 s52, 10
    s_cbranch_scc1 L_noz
    v_add_f32 v80, 0x3e800000, v80
    v_add_f32 v81, 0x3e800000, v81
    v_add_f32 v82, 0x3e800000, v82
    v_add_f32 v83, 0x3e800000, v83
    v_mul_f32 v80, v80, v24
    v_mul_f32 v81, v81, v25
    v_mul_f32 v82, v82, v26
    v_mul_f32 v83, v83, v27
L_noz:
    v_cvt_pk_bf16_f32 v20, v80, v81
    v_cvt_pk_bf16_f32 v21, v82, v83
    v_min_u32 v20, -2, v20
    v_min_u32 v21, -2, v21
    v_and_b32 v22, 15, v0
    v_lshlrev_b32 v22, 2, v22
    s_mov_b32 s35, 0
L_poll3:
    global_load_dword v23, v22, s[30:31] offset:128 sc1
    s_add_u32 s35, s35, 1
    s_waitcnt vmcnt(0)
    v_cmp_eq_u32 vcc, 0, v23
    s_cbranch_vccz L_done4
    s_sleep 8
    s_cmp_lt_u32 s35, 60000
    s_cbranch_scc1 L_poll3
L_done4:
    s_getreg_b32 s97, hwreg(HW_REG_XCC_ID, 0, 4)
    s_sub_u32 s97, s97, s2
    s_and_b32 s97, s97, 7
    s_add_u32 s97, s97, 1
    v_cmp_ne_u32 vcc, s97, v23
    s_nop 0
    s_mov_b32 s97, vcc_lo
    buffer_store_dwordx2 v[20:21], v19, s[44:47], 0 offen sc1
    s_branch L_p2
L_clear:
    s_sub_u32 s55, s2, 240
    s_lshr_b32 s34, s55, 2
    s_lshl_b32 s35, s34, 3
    s_lshr_b32 s54, 538910750, s35
    s_and_b32 s54, s54, 0xff
    s_lshl_b32 s54, s54, 10
    s_mul_i32 s34, s34, 393216
    s_lshl_b32 s35, s51, 15
    s_add_u32 s34, s34, s35
    v_lshl_add_u32 v19, v0, 4, s34
    v_mov_b32 v20, -1
    v_mov_b32 v21, -1
    v_mov_b32 v22, -1
    v_mov_b32 v23, -1
    s_mov_b32 s34, 0
L_clrloop:
    buffer_store_dwordx4 v[20:23], v19, s[44:47], s34 offen offset:0 sc1
    s_add_u32 s34, s34, 1024
    s_cmp_lt_u32 s34, s54
    s_cbranch_scc1 L_clrloop
L_clrend:
    s_cmp_ge_u32 s55, 4
    s_cbranch_scc1 L_clrend2
    s_mov_b32 s34, 1572864
    buffer_store_dwordx4 v[20:23], v19, s[44:47], s34 offen sc1
    s_mov_b32 s34, 1573888
    buffer_store_dwordx4 v[20:23], v19, s[44:47], s34 offen sc1
    s_mov_b32 s34, 1574912
    buffer_store_dwordx4 v[20:23], v19, s[44:47], s34 offen sc1
    s_mov_b32 s34, 1575936
    buffer_store_dwordx4 v[20:23], v19, s[44:47], s34 offen sc1
    s_mov_b32 s34, 1576960
    buffer_store_dwordx4 v[20:23], v19, s[44:47], s34 offen sc1
L_clrend2:
    v_lshlrev_b32 v1, 2, v0
    v_add_u32 v1, 98304, v1
    v_mov_b32 v2, -1
    v_mov_b32 v3, 0
    ds_write_b32 v1, v2
    ds_write_b32 v1, v2 offset:256
    ds_write_b32 v1, v3 offset:512
    ds_write_b32 v1, v3 offset:768
    s_waitcnt lgkmcnt(0)
    s_barrier
    s_lshl_b32 s34, s55, 2
    v_mov_b32 v24, s34
    s_getreg_b32 s97, hwreg(HW_REG_XCC_ID, 0, 4)
    s_sub_u32 s97, s97, s2
    s_and_b32 s97, s97, 7
    s_add_u32 s97, s97, 1
    v_mov_b32 v25, s97
    v_readfirstlane_b32 s90, v19
    s_mov_b32 s91, 0
    s_waitcnt vmcnt(0)
    s_mov_b64 exec, 1
    global_store_dword v24, v25, s[30:31] offset:128 sc1
    s_mov_b64 exec, -1
    s_and_b32 s34, s2, 31
    s_lshl_b32 s34, s34, 8
    s_lshr_b32 s35, s2, 7
    s_lshl_b32 s35, s35, 7
    s_add_u32 s49, s34, s35
    s_bfe_u32 s53, s2, 0x20005
    s_mul_i32 s34, s53, 1310720
    s_add_u32 s34, s34, s49
    v_lshl_add_u32 v16, v10, 13, v11
    v_add_u32 v16, s34, v16
    s_mov_b32 s36, s10
    s_mov_b32 s37, s11
    s_mov_b32 s38, 5242880
    s_mov_b32 m0, 20480
    s_mov_b32 s34, 0
L_dma6:
    buffer_load_dwordx4 v16, s[36:39], s34 offen  lds
    s_add_u32 m0, m0, 1024
    s_add_u32 s34, s34, 65536
    buffer_load_dwordx4 v16, s[36:39], s34 offen  lds
    s_add_u32 m0, m0, 1024
    s_add_u32 s34, s34, 65536
    buffer_load_dwordx4 v16, s[36:39], s34 offen  lds
    s_add_u32 m0, m0, 1024
    s_add_u32 s34, s34, 65536
    buffer_load_dwordx4 v16, s[36:39], s34 offen  lds
    s_add_u32 m0, m0, 1024
    s_add_u32 s34, s34, 65536
    s_cmp_lt_u32 s34, 1310720
    s_cbranch_scc1 L_dma6
    v_lshl_add_u32 v15, v14, 3, v13
    v_lshlrev_b32 v15, 7, v15
    v_lshl_add_u32 v15, v12, 3, v15
    s_add_u32 s34, s90, 0
    s_add_u32 s35, s90, 8192
    s_mov_b64 s[88:89], 0
    s_load_dword s88, s[44:45], s34
    s_load_dword s89, s[44:45], s35
    s_waitcnt lgkmcnt(1)
    s_cmp_lg_u32 s89, 0
    s_addc_u32 s91, s91, 0
    s_waitcnt lgkmcnt(0)
    s_add_u32 s34, s90, 1024
    s_add_u32 s35, s90, 9216
    s_mov_b64 s[88:89], 0
    s_load_dword s89, s[44:45], s35
    s_load_dword s88, s[44:45], s34
    s_waitcnt lgkmcnt(1)
    s_cmp_eq_u32 s88, 0
    s_addc_u32 s91, s91, 0
    s_waitcnt lgkmcnt(0)
    s_add_u32 s34, s90, 2048
    s_add_u32 s35, s90, 10240
    s_mov_b64 s[88:89], 0
    s_load_dword s88, s[44:45], s34
    s_load_dword s89, s[44:45], s35
    s_waitcnt lgkmcnt(1)
    s_cmp_lg_u32 s89, 0
    s_addc_u32 s91, s91, 0
    s_waitcnt lgkmcnt(0)
    s_add_u32 s34, s90, 3072
    s_add_u32 s35, s90, 11264
    s_mov_b64 s[88:89], 0
    s_load_dword s89, s[44:45], s35
    s_load_dword s88, s[44:45], s34
    s_waitcnt lgkmcnt(1)
    s_cmp_eq_u32 s88, 0
    s_addc_u32 s91, s91, 0
    s_waitcnt lgkmcnt(0)
    s_getreg_b32 s34, hwreg(HW_REG_XCC_ID, 2, 1)
    s_sub_u32 s35, 2, s91
    s_sub_u32 s91, s91, 2
    s_cmp_eq_u32 s34, 0
    s_cselect_b32 s91, s91, s35
    v_mov_b32 v25, s91
    s_mov_b64 exec, 1
    global_store_dword v24, v25, s[30:31] sc1
    s_mov_b64 exec, -1
    v_and_b32 v22, 15, v0
    v_lshlrev_b32 v22, 2, v22
    s_mov_b32 s35, 0
L_poll7:
    global_load_dword v23, v22, s[30:31] offset:128 sc1
    s_add_u32 s35, s35, 1
    s_waitcnt vmcnt(0)
    v_cmp_eq_u32 vcc, 0, v23
    s_cbranch_vccz L_done8
    s_sleep 8
    s_cmp_lt_u32 s35, 60000
    s_cbranch_scc1 L_poll7
L_done8:
    s_getreg_b32 s97, hwreg(HW_REG_XCC_ID, 0, 4)
    s_sub_u32 s97, s97, s2
    s_and_b32 s97, s97, 7
    s_add_u32 s97, s97, 1
    v_cmp_ne_u32 vcc, s97, v23
    s_nop 0
    s_mov_b32 s97, vcc_lo
L_p2:
    v_mov_b32 v199, v19
    ds_read_b64_tr_b16 v[96:97], v15 offset:20480
    ds_read_b64_tr_b16 v[98:99], v15 offset:20992
    ds_read_b64_tr_b16 v[100:101], v15 offset:20512
    ds_read_b64_tr_b16 v[102:103], v15 offset:21024
    ds_read_b64_tr_b16 v[104:105], v15 offset:20544
    ds_read_b64_tr_b16 v[106:107], v15 offset:21056
    ds_read_b64_tr_b16 v[108:109], v15 offset:20576
    ds_read_b64_tr_b16 v[110:111], v15 offset:21088
    s_waitcnt lgkmcnt(7)
    ds_read_b64_tr_b16 v[112:113], v15 offset:24576
    ds_read_b64_tr_b16 v[114:115], v15 offset:25088
    ds_read_b64_tr_b16 v[116:117], v15 offset:24608
    ds_read_b64_tr_b16 v[118:119], v15 offset:25120
    ds_read_b64_tr_b16 v[120:121], v15 offset:24640
    ds_read_b64_tr_b16 v[122:123], v15 offset:25152
    ds_read_b64_tr_b16 v[124:125], v15 offset:24672
    ds_read_b64_tr_b16 v[126:127], v15 offset:25184
    s_waitcnt lgkmcnt(7)
    ds_read_b64_tr_b16 v[128:129], v15 offset:28672
    ds_read_b64_tr_b16 v[130:131], v15 offset:29184
    ds_read_b64_tr_b16 v[132:133], v15 offset:28704
    ds_read_b64_tr_b16 v[134:135], v15 offset:29216
    ds_read_b64_tr_b16 v[136:137], v15 offset:28736
    ds_read_b64_tr_b16 v[138:139], v15 offset:29248
    ds_read_b64_tr_b16 v[140:141], v15 offset:28768
    ds_read_b64_tr_b16 v[142:143], v15 offset:29280
    s_waitcnt lgkmcnt(7)
    ds_read_b64_tr_b16 v[144:145], v15 offset:32768
    ds_read_b64_tr_b16 v[146:147], v15 offset:33280
    ds_read_b64_tr_b16 v[148:149], v15 offset:32800
    ds_read_b64_tr_b16 v[150:151], v15 offset:33312
    ds_read_b64_tr_b16 v[152:153], v15 offset:32832
    ds_read_b64_tr_b16 v[154:155], v15 offset:33344
    ds_read_b64_tr_b16 v[156:157], v15 offset:32864
    ds_read_b64_tr_b16 v[158:159], v15 offset:33376
    s_waitcnt lgkmcnt(7)
    ds_read_b64_tr_b16 v[160:161], v15 offset:36864
    ds_read_b64_tr_b16 v[162:163], v15 offset:37376
    ds_read_b64_tr_b16 v[164:165], v15 offset:36896
    ds_read_b64_tr_b16 v[166:167], v15 offset:37408
    ds_read_b64_tr_b16 v[168:169], v15 offset:36928
    ds_read_b64_tr_b16 v[170:171], v15 offset:37440
    ds_read_b64_tr_b16 v[172:173], v15 offset:36960
    ds_read_b64_tr_b16 v[174:175], v15 offset:37472
    s_waitcnt lgkmcnt(0)
    s_mul_i32 s34, s53, 1280
    v_lshlrev_b32 v19, 15, v13
    v_lshl_add_u32 v19, v14, 6, v19
    v_lshl_add_u32 v19, v12, 4, v19
    v_add_u32 v19, s34, v19
    s_movk_i32 s48, 5120
    s_mov_b32 s56, 32768
    s_mov_b32 s57, 65536
    s_mov_b32 s58, 98304
    s_sub_u32 s34, s2, 80
    s_cmp_lt_u32 s34, 160
    s_cselect_b32 s54, 1, 0
    s_and_b32 s34, s2, 3
    s_cselect_b32 s54, 0, s54
    v_mov_b32 v180, 0
    v_mov_b32 v181, 0
    v_mov_b32 v182, 0
    v_mov_b32 v183, 0
    v_mov_b32 v184, 0
    v_mov_b32 v185, 0
    v_mov_b32 v186, 0
    v_mov_b32 v187, 0
    v_mov_b32 v22, 99072
    s_mov_b32 s35, 0
L_poll10:
    ds_read_b32 v23, v22
    s_add_u32 s35, s35, 1
    s_waitcnt lgkmcnt(0)
    v_cmp_gt_u32 vcc, 21, v23
    s_cbranch_vccz L_done11
    s_sleep 2
    s_cmp_lt_u32 s35, 60000
    s_cbranch_scc1 L_poll10
L_done11:
    s_mov_b32 s35, 0
L_poll13:
    buffer_load_dwordx4 v[32:35], v19, s[44:47], 0 offen offset:0 sc1
    buffer_load_dwordx4 v[36:39], v19, s[44:47], s48 offen offset:0 sc1
    buffer_load_dwordx4 v[40:43], v19, s[44:47], 0 offen offset:256 sc1
    buffer_load_dwordx4 v[44:47], v19, s[44:47], s48 offen offset:256 sc1
    buffer_load_dwordx4 v[48:51], v19, s[44:47], 0 offen offset:512 sc1
    buffer_load_dwordx4 v[52:55], v19, s[44:47], s48 offen offset:512 sc1
    buffer_load_dwordx4 v[56:59], v19, s[44:47], 0 offen offset:768 sc1
    buffer_load_dwordx4 v[60:63], v19, s[44:47], s48 offen offset:768 sc1
    buffer_load_dwordx4 v[64:67], v19, s[44:47], 0 offen offset:1024 sc1
    buffer_load_dwordx4 v[68:71], v19, s[44:47], s48 offen offset:1024 sc1
    s_cmp_eq_u32 s54, 0
    s_cbranch_scc1 L_hskip
    buffer_load_dwordx2 v[180:181], v199, s[44:47], 0 offen sc1
    buffer_load_dwordx2 v[182:183], v199, s[44:47], s56 offen sc1
    buffer_load_dwordx2 v[184:185], v199, s[44:47], s57 offen sc1
    buffer_load_dwordx2 v[186:187], v199, s[44:47], s58 offen sc1
L_hskip:
    s_add_u32 s35, s35, 1
    s_waitcnt vmcnt(0)
    v_max3_u32 v20, v32, v33, v34
    v_max3_u32 v20, v20, v35, v36
    v_max3_u32 v20, v20, v37, v38
    v_max3_u32 v20, v20, v39, v40
    v_max3_u32 v20, v20, v41, v42
    v_max3_u32 v20, v20, v43, v44
    v_max3_u32 v20, v20, v45, v46
    v_max3_u32 v20, v20, v47, v48
    v_max3_u32 v20, v20, v49, v50
    v_max3_u32 v20, v20, v51, v52
    v_max3_u32 v20, v20, v53, v54
    v_max3_u32 v20, v20, v55, v56
    v_max3_u32 v20, v20, v57, v58
    v_max3_u32 v20, v20, v59, v60
    v_max3_u32 v20, v20, v61, v62
    v_max3_u32 v20, v20, v63, v64
    v_max3_u32 v20, v20, v65, v66
    v_max3_u32 v20, v20, v67, v68
    v_max3_u32 v20, v20, v69, v70
    v_max3_u32 v20, v20, v71, v180
    v_max3_u32 v20, v20, v181, v182
    v_max3_u32 v20, v20, v183, v184
    v_max3_u32 v20, v20, v185, v186
    v_max_u32 v20, v20, v187
    v_cmp_eq_u32 vcc, -1, v20
    s_cbranch_vccz L_done14
    s_sleep 16
    s_cmp_lt_u32 s35, 60000
    s_cbranch_scc1 L_poll13
L_done14:
    v_mfma_f32_16x16x32_bf16 v[80:83], v[96:99], v[32:35], 0
    v_mfma_f32_16x16x32_bf16 v[84:87], v[100:103], v[32:35], 0
    v_mfma_f32_16x16x32_bf16 v[88:91], v[104:107], v[32:35], 0
    v_mfma_f32_16x16x32_bf16 v[92:95], v[108:111], v[32:35], 0
    v_mfma_f32_16x16x32_bf16 v[80:83], v[96:99], v[36:39], v[80:83]
    v_mfma_f32_16x16x32_bf16 v[84:87], v[100:103], v[36:39], v[84:87]
    v_mfma_f32_16x16x32_bf16 v[88:91], v[104:107], v[36:39], v[88:91]
    v_mfma_f32_16x16x32_bf16 v[92:95], v[108:111], v[36:39], v[92:95]
    v_mfma_f32_16x16x32_bf16 v[80:83], v[112:115], v[40:43], v[80:83]
    v_mfma_f32_16x16x32_bf16 v[84:87], v[116:119], v[40:43], v[84:87]
    v_mfma_f32_16x16x32_bf16 v[88:91], v[120:123], v[40:43], v[88:91]
    v_mfma_f32_16x16x32_bf16 v[92:95], v[124:127], v[40:43], v[92:95]
    v_mfma_f32_16x16x32_bf16 v[80:83], v[112:115], v[44:47], v[80:83]
    v_mfma_f32_16x16x32_bf16 v[84:87], v[116:119], v[44:47], v[84:87]
    v_mfma_f32_16x16x32_bf16 v[88:91], v[120:123], v[44:47], v[88:91]
    v_mfma_f32_16x16x32_bf16 v[92:95], v[124:127], v[44:47], v[92:95]
    v_mfma_f32_16x16x32_bf16 v[80:83], v[128:131], v[48:51], v[80:83]
    v_mfma_f32_16x16x32_bf16 v[84:87], v[132:135], v[48:51], v[84:87]
    v_mfma_f32_16x16x32_bf16 v[88:91], v[136:139], v[48:51], v[88:91]
    v_mfma_f32_16x16x32_bf16 v[92:95], v[140:143], v[48:51], v[92:95]
    v_mfma_f32_16x16x32_bf16 v[80:83], v[128:131], v[52:55], v[80:83]
    v_mfma_f32_16x16x32_bf16 v[84:87], v[132:135], v[52:55], v[84:87]
    v_mfma_f32_16x16x32_bf16 v[88:91], v[136:139], v[52:55], v[88:91]
    v_mfma_f32_16x16x32_bf16 v[92:95], v[140:143], v[52:55], v[92:95]
    v_mfma_f32_16x16x32_bf16 v[80:83], v[144:147], v[56:59], v[80:83]
    v_mfma_f32_16x16x32_bf16 v[84:87], v[148:151], v[56:59], v[84:87]
    v_mfma_f32_16x16x32_bf16 v[88:91], v[152:155], v[56:59], v[88:91]
    v_mfma_f32_16x16x32_bf16 v[92:95], v[156:159], v[56:59], v[92:95]
    v_mfma_f32_16x16x32_bf16 v[80:83], v[144:147], v[60:63], v[80:83]
    v_mfma_f32_16x16x32_bf16 v[84:87], v[148:151], v[60:63], v[84:87]
    v_mfma_f32_16x16x32_bf16 v[88:91], v[152:155], v[60:63], v[88:91]
    v_mfma_f32_16x16x32_bf16 v[92:95], v[156:159], v[60:63], v[92:95]
    v_mfma_f32_16x16x32_bf16 v[80:83], v[160:163], v[64:67], v[80:83]
    v_mfma_f32_16x16x32_bf16 v[84:87], v[164:167], v[64:67], v[84:87]
    v_mfma_f32_16x16x32_bf16 v[88:91], v[168:171], v[64:67], v[88:91]
    v_mfma_f32_16x16x32_bf16 v[92:95], v[172:175], v[64:67], v[92:95]
    v_mfma_f32_16x16x32_bf16 v[80:83], v[160:163], v[68:71], v[80:83]
    v_mfma_f32_16x16x32_bf16 v[84:87], v[164:167], v[68:71], v[84:87]
    v_mfma_f32_16x16x32_bf16 v[88:91], v[168:171], v[68:71], v[88:91]
    v_mfma_f32_16x16x32_bf16 v[92:95], v[172:175], v[68:71], v[92:95]
    s_lshl_b32 s34, s53, 15
    s_lshl_b32 s35, s49, 2
    s_add_u32 s34, s34, s35
    s_add_u32 s34, s34, 393216
    v_lshlrev_b32 v19, 7, v12
    v_lshl_add_u32 v19, v13, 5, v19
    v_lshl_add_u32 v19, v14, 3, v19
    v_add_u32 v19, s34, v19
    v_add_f32_dpp v20, v80, v80 row_ror:8 row_mask:0xf bank_mask:0x3
    v_add_f32_dpp v24, v84, v84 row_ror:8 row_mask:0xf bank_mask:0x3
    v_add_f32_dpp v21, v81, v81 row_ror:8 row_mask:0xf bank_mask:0x3
    v_add_f32_dpp v25, v85, v85 row_ror:8 row_mask:0xf bank_mask:0x3
    v_add_f32_dpp v22, v82, v82 row_ror:8 row_mask:0xf bank_mask:0x3
    v_add_f32_dpp v26, v86, v86 row_ror:8 row_mask:0xf bank_mask:0x3
    v_add_f32_dpp v23, v83, v83 row_ror:8 row_mask:0xf bank_mask:0x3
    v_add_f32_dpp v27, v87, v87 row_ror:8 row_mask:0xf bank_mask:0x3
    v_add_f32_dpp v20, v88, v88 row_ror:8 row_mask:0xf bank_mask:0xc
    v_add_f32_dpp v24, v92, v92 row_ror:8 row_mask:0xf bank_mask:0xc
    v_add_f32_dpp v21, v89, v89 row_ror:8 row_mask:0xf bank_mask:0xc
    v_add_f32_dpp v25, v93, v93 row_ror:8 row_mask:0xf bank_mask:0xc
    v_add_f32_dpp v22, v90, v90 row_ror:8 row_mask:0xf bank_mask:0xc
    v_add_f32_dpp v26, v94, v94 row_ror:8 row_mask:0xf bank_mask:0xc
    v_add_f32_dpp v23, v91, v91 row_ror:8 row_mask:0xf bank_mask:0xc
    v_add_f32_dpp v27, v95, v95 row_ror:8 row_mask:0xf bank_mask:0xc
    v_add_f32_dpp v28, v20, v20 row_shl:4 row_mask:0xf bank_mask:0x5
    v_add_f32_dpp v29, v21, v21 row_shl:4 row_mask:0xf bank_mask:0x5
    v_add_f32_dpp v30, v22, v22 row_shl:4 row_mask:0xf bank_mask:0x5
    v_add_f32_dpp v31, v23, v23 row_shl:4 row_mask:0xf bank_mask:0x5
    v_add_f32_dpp v28, v24, v24 row_shr:4 row_mask:0xf bank_mask:0xa
    v_add_f32_dpp v29, v25, v25 row_shr:4 row_mask:0xf bank_mask:0xa
    v_add_f32_dpp v30, v26, v26 row_shr:4 row_mask:0xf bank_mask:0xa
    v_add_f32_dpp v31, v27, v27 row_shr:4 row_mask:0xf bank_mask:0xa
    v_cvt_pk_bf16_f32 v20, v28, v29
    v_cvt_pk_bf16_f32 v21, v30, v31
    v_min_u32 v20, -2, v20
    v_min_u32 v21, -2, v21
    buffer_store_dwordx2 v[20:21], v19, s[44:47], 0 offen sc1
    s_cmp_eq_u32 s54, 0
    s_cbranch_scc1 L_nomf
    v_lshlrev_b32 v24, 16, v180
    v_and_b32 v25, 0xffff0000, v180
    v_lshlrev_b32 v26, 16, v181
    v_and_b32 v27, 0xffff0000, v181
    v_lshlrev_b32 v28, 16, v182
    v_and_b32 v29, 0xffff0000, v182
    v_lshlrev_b32 v30, 16, v183
    v_and_b32 v31, 0xffff0000, v183
    v_add_f32 v24, v24, v28
    v_add_f32 v25, v25, v29
    v_add_f32 v26, v26, v30
    v_add_f32 v27, v27, v31
    v_lshlrev_b32 v28, 16, v184
    v_and_b32 v29, 0xffff0000, v184
    v_lshlrev_b32 v30, 16, v185
    v_and_b32 v31, 0xffff0000, v185
    v_add_f32 v24, v24, v28
    v_add_f32 v25, v25, v29
    v_add_f32 v26, v26, v30
    v_add_f32 v27, v27, v31
    v_lshlrev_b32 v28, 16, v186
    v_and_b32 v29, 0xffff0000, v186
    v_lshlrev_b32 v30, 16, v187
    v_and_b32 v31, 0xffff0000, v187
    v_add_f32 v24, v24, v28
    v_add_f32 v25, v25, v29
    v_add_f32 v26, v26, v30
    v_add_f32 v27, v27, v31
    v_cvt_pk_bf16_f32 v22, v24, v25
    v_cvt_pk_bf16_f32 v23, v26, v27
    v_min_u32 v22, -2, v22
    v_min_u32 v23, -2, v23
    s_sub_u32 s34, s50, 20
    s_lshl_b32 s35, s34, 9
    v_subrev_u32 v199, s35, v199
    s_lshr_b32 s35, s34, 2
    s_lshl_b32 s35, s35, 9
    s_and_b32 s34, s34, 3
    s_lshl_b32 s34, s34, 15
    s_add_u32 s34, s34, s35
    s_add_u32 s34, s34, 1562624
    v_add_u32 v199, s34, v199
    buffer_store_dwordx2 v[22:23], v199, s[44:47], 0 offen sc1
L_nomf:
    s_and_b32 s34, s2, 127
    s_lshl_b32 s34, s34, 21
    s_lshr_b32 s35, s2, 7
    s_lshl_b32 s35, s35, 18
    s_add_u32 s34, s34, s35
    s_add_u32 s34, s34, 1572864
    s_mov_b32 s38, 0x40000
    s_mov_b32 s42, 0x40000
    s_waitcnt lgkmcnt(0)
    s_add_u32 s36, s6, s34
    s_addc_u32 s37, s7, 0
    s_add_u32 s40, s8, s34
    s_addc_u32 s41, s9, 0
    v_lshlrev_b32 v18, 4, v0
    s_mov_b32 s34, 258048
    buffer_load_dwordx4 v[128:131], v18, s[36:39], s34 offen offset:0 nt
    buffer_load_dwordx4 v[132:135], v18, s[36:39], s34 offen offset:1024 nt
    buffer_load_dwordx4 v[136:139], v18, s[36:39], s34 offen offset:2048 nt
    buffer_load_dwordx4 v[140:143], v18, s[36:39], s34 offen offset:3072 nt
    s_and_b32 s34, s2, 31
    s_lshl_b32 s34, s34, 10
    s_lshl_b32 s35, s53, 7
    s_add_u32 s34, s34, s35
    s_add_u32 s34, s34, 393216
    v_lshrrev_b32 v19, 5, v0
    v_mul_u32_u24 v19, 384, v19
    v_lshl_add_u32 v19, v0, 2, v19
    v_add_u32 v19, s34, v19
    v_mov_b32 v22, 99072
    s_mov_b32 s35, 0
L_poll16:
    ds_read_b32 v23, v22
    s_add_u32 s35, s35, 1
    s_waitcnt lgkmcnt(0)
    v_cmp_gt_u32 vcc, 33, v23
    s_cbranch_vccz L_done17
    s_sleep 2
    s_cmp_lt_u32 s35, 60000
    s_cbranch_scc1 L_poll16
L_done17:
    v_and_b32 v44, 15, v0
    v_lshlrev_b32 v44, 2, v44
    global_load_dword v44, v44, s[30:31] sc1
    s_mov_b32 s35, 0
L_poll19:
    buffer_load_dword v32, v19, s[44:47], 0 offen sc1
    buffer_load_dword v33, v19, s[44:47], s56 offen sc1
    buffer_load_dword v34, v19, s[44:47], s57 offen sc1
    buffer_load_dword v35, v19, s[44:47], s58 offen sc1
    s_add_u32 s35, s35, 1
    s_waitcnt vmcnt(0)
    v_max3_u32 v22, v32, v33, v34
    v_max_u32 v22, v22, v35
    v_cmp_eq_u32 vcc, -1, v22
    s_cbranch_vccz L_done20
    s_sleep 16
    s_cmp_lt_u32 s35, 60000
    s_cbranch_scc1 L_poll19
L_done20:
    v_add_u32_dpp v44, v44, v44 row_ror:8 row_mask:0xf bank_mask:0xf
    s_nop 1
    v_add_u32_dpp v44, v44, v44 row_ror:4 row_mask:0xf bank_mask:0xf
    s_nop 1
    v_add_u32_dpp v44, v44, v44 row_ror:2 row_mask:0xf bank_mask:0xf
    s_nop 1
    v_add_u32_dpp v44, v44, v44 row_ror:1 row_mask:0xf bank_mask:0xf
    s_nop 0
    v_readfirstlane_b32 s99, v44
    s_nop 0
    s_cmp_gt_i32 s99, 0
    s_cselect_b32 s99, 1, 0
    s_getreg_b32 s34, hwreg(HW_REG_XCC_ID, 2, 1)
    s_xor_b32 s99, s99, s34
    s_lshl_b32 s99, s99, 13
    v_mov_b32 v45, 99080
    v_mov_b32 v44, s99
    ds_write_b32 v45, v44
    v_lshlrev_b32 v36, 16, v32
    v_and_b32 v37, 0xffff0000, v32
    v_lshlrev_b32 v38, 16, v33
    v_and_b32 v39, 0xffff0000, v33
    v_lshlrev_b32 v40, 16, v34
    v_and_b32 v41, 0xffff0000, v34
    v_lshlrev_b32 v42, 16, v35
    v_and_b32 v43, 0xffff0000, v35
    v_pk_add_f32 v[36:37], v[36:37], v[38:39]
    v_pk_add_f32 v[40:41], v[40:41], v[42:43]
    v_pk_add_f32 v[36:37], v[36:37], v[40:41]
    v_cvt_pk_bf16_f32 v32, v36, v37
    v_min_u32 v32, -2, v32
    ds_write_b32 v1, v32
    s_mov_b32 s34, 258048
    buffer_load_dwordx4 v[144:147], v18, s[40:43], s34 offen offset:0 nt
    buffer_load_dwordx4 v[148:151], v18, s[40:43], s34 offen offset:1024 nt
    buffer_load_dwordx4 v[152:155], v18, s[40:43], s34 offen offset:2048 nt
    buffer_load_dwordx4 v[156:159], v18, s[40:43], s34 offen offset:3072 nt
    v_and_b32 v2, 15, v0
    v_lshlrev_b32 v2, 4, v2
    v_add_u32 v2, 98304, v2
    ds_read_b128 v[4:7], v2
    s_waitcnt lgkmcnt(0)
    v_dot2_f32_bf16 v8, v128, v4, 0
    v_dot2_f32_bf16 v9, v132, v4, 0
    v_dot2_f32_bf16 v10, v136, v4, 0
    v_dot2_f32_bf16 v11, v140, v4, 0
    v_dot2c_f32_bf16 v8, v129, v5
    v_dot2c_f32_bf16 v9, v133, v5
    v_dot2c_f32_bf16 v10, v137, v5
    v_dot2c_f32_bf16 v11, v141, v5
    v_dot2c_f32_bf16 v8, v130, v6
    v_dot2c_f32_bf16 v9, v134, v6
    v_dot2c_f32_bf16 v10, v138, v6
    v_dot2c_f32_bf16 v11, v142, v6
    v_dot2c_f32_bf16 v8, v131, v7
    v_dot2c_f32_bf16 v9, v135, v7
    v_dot2c_f32_bf16 v10, v139, v7
    v_dot2c_f32_bf16 v11, v143, v7
    v_add_f32_dpp v16, v8, v8 row_ror:8 row_mask:0xf bank_mask:0x3
    v_add_f32_dpp v16, v9, v9 row_ror:8 row_mask:0xf bank_mask:0xc
    v_add_f32_dpp v17, v10, v10 row_ror:8 row_mask:0xf bank_mask:0x3
    v_add_f32_dpp v17, v11, v11 row_ror:8 row_mask:0xf bank_mask:0xc
    v_add_f32_dpp v16, v16, v16 row_half_mirror row_mask:0xf bank_mask:0xf
    s_nop 0
    v_add_f32_dpp v17, v17, v17 row_half_mirror row_mask:0xf bank_mask:0xf
    v_add_f32_dpp v16, v16, v16 quad_perm:[1,0,3,2] row_mask:0xf bank_mask:0xf
    s_nop 0
    v_add_f32_dpp v17, v17, v17 quad_perm:[1,0,3,2] row_mask:0xf bank_mask:0xf
    v_add_f32_dpp v16, v16, v16 quad_perm:[2,3,0,1] row_mask:0xf bank_mask:0xf
    s_nop 0
    v_add_f32_dpp v17, v17, v17 quad_perm:[2,3,0,1] row_mask:0xf bank_mask:0xf
    v_max_f32 v8, v16, v17
    s_mov_b32 s34, 0x3e0293ee
    s_nop 0
    v_max_f32_dpp v8, v8, v8 row_ror:8 row_mask:0xf bank_mask:0xf
    v_mov_b32 v9, v8
    s_nop 1
    v_permlane16_swap_b32 v8, v9
    v_max_f32 v8, v8, v9
    v_mov_b32 v9, v8
    s_nop 1
    v_permlane32_swap_b32 v8, v9
    v_max_f32 v8, v8, v9
    v_mul_f32 v8, s34, v8
    v_fma_f32 v16, v16, s34, -v8
    v_fma_f32 v17, v17, s34, -v8
    v_exp_f32 v16, v16
    v_exp_f32 v17, v17
    s_nop 0
    v_add_f32 v9, v16, v17
    v_and_b32 v10, 1, v0
    v_lshlrev_b32 v10, 4, v10
    v_mov_b32 v11, 0xffff
    v_lshlrev_b32 v10, v10, v11
    v_bfe_u32 v11, v0, 1, 2
    v_cmp_eq_u32 vcc, 0, v11
    s_nop 1
    v_cndmask_b32 v20, 0, v10, vcc
    v_cmp_eq_u32 vcc, 1, v11
    s_nop 1
    v_cndmask_b32 v21, 0, v10, vcc
    v_cmp_eq_u32 vcc, 2, v11
    s_nop 1
    v_cndmask_b32 v22, 0, v10, vcc
    v_cmp_eq_u32 vcc, 3, v11
    s_nop 1
    v_cndmask_b32 v23, 0, v10, vcc
    v_add_f32_dpp v9, v9, v9 row_ror:8 row_mask:0xf bank_mask:0xf
    v_mov_b32 v10, v9
    s_nop 1
    v_permlane16_swap_b32 v9, v10
    v_add_f32 v9, v9, v10
    v_mov_b32 v10, v9
    s_nop 1
    v_permlane32_swap_b32 v9, v10
    v_add_f32 v9, v9, v10
    v_mov_b32 v10, 98616
    s_mov_b64 exec, 1
    ds_write_b64 v10, v[8:9]
    s_mov_b64 exec, -1
    s_waitcnt vmcnt(0)
    v_cvt_pk_bf16_f32 v10, v16, v16
    v_and_b32 v24, v10, v20
    v_and_b32 v25, v10, v21
    v_and_b32 v26, v10, v22
    v_and_b32 v27, v10, v23
    s_nop 1
    v_mfma_f32_16x16x32_bf16 v[116:119], v[144:147], v[24:27], 0
    v_mfma_f32_16x16x32_bf16 v[120:123], v[148:151], v[24:27], 0
    v_cvt_pk_bf16_f32 v10, v17, v17
    v_and_b32 v28, v10, v20
    v_and_b32 v29, v10, v21
    v_and_b32 v30, v10, v22
    v_and_b32 v31, v10, v23
    s_nop 1
    v_mfma_f32_16x16x32_bf16 v[116:119], v[152:155], v[28:31], v[116:119]
    v_mfma_f32_16x16x32_bf16 v[120:123], v[156:159], v[28:31], v[120:123]
    s_mov_b32 s34, 106496
    v_lshrrev_b32 v16, 4, v0
    v_and_b32 v17, 7, v0
    v_lshl_add_u32 v16, v16, 3, v17
    v_bfe_u32 v17, v0, 3, 1
    v_lshl_add_u32 v16, v17, 5, v16
    v_lshl_add_u32 v16, v16, 4, s34
    s_nop 0
    v_add_f32_dpp v116, v120, v116 row_ror:8 row_mask:0xf bank_mask:0xf
    v_add_f32_dpp v117, v121, v117 row_ror:8 row_mask:0xf bank_mask:0xf
    v_add_f32_dpp v118, v122, v118 row_ror:8 row_mask:0xf bank_mask:0xf
    v_add_f32_dpp v119, v123, v119 row_ror:8 row_mask:0xf bank_mask:0xf
    ds_write_b128 v16, v[116:119]
    v_lshl_add_u32 v16, v0, 3, s34
    ds_read_b64 v[116:117], v16
    s_waitcnt lgkmcnt(0)
    s_mov_b32 s63, 0
    s_mov_b32 s62, s61
    s_cmp_lt_u32 s61, 20
    s_cbranch_scc1 L_rd22
    s_mul_i32 s62, s60, 12
    s_add_u32 s62, s62, s61
    s_sub_u32 s62, s62, 20
    s_mov_b32 s63, 1
    s_cmp_lt_u32 s62, 54
    s_cbranch_scc1 L_rd22
    s_cmp_lt_u32 s62, 56
    s_cselect_b32 s63, 3, 2
    s_sub_u32 s62, s62, 56
L_rd22:
    v_and_b32 v8, 3, v0
    v_bfe_u32 v9, v0, 2, 2
    v_lshrrev_b32 v10, 4, v0
    s_mov_b32 s55, 0x20000
    s_lshl_b32 s35, s62, 6
    s_and_b32 s49, s62, 1
    s_cmp_eq_u32 s63, 0
    s_cbranch_scc1 L_dp24
    s_cmp_eq_u32 s63, 1
    s_cbranch_scc1 L_dp25
    s_mov_b32 s52, s20
    s_mov_b32 s53, s21
    s_mov_b32 s54, 2211840
    v_mov_b32 v15, 0
    s_branch L_dp26
L_dp25:
    s_mov_b32 s52, s16
    s_mov_b32 s53, s17
    s_mov_b32 s54, 2211840
    v_lshl_add_u32 v15, v9, 3, v10
    v_mul_u32_u24 v15, 3456, v15
    v_lshl_add_u32 v15, v8, 4, v15
    v_add_u32 v15, s35, v15
    s_bfe_u32 s50, s3, 0x10001
    s_lshl_b32 s50, s50, 7
    s_and_b32 s34, s3, 1
    s_lshl_b32 s34, s34, 2
    s_add_u32 s50, s50, s34
    s_and_b32 s51, s3, 3
    s_lshl_b32 s51, s51, 5
    s_add_u32 s51, s51, 512
    s_mul_i32 s50, s50, 3456
    s_mul_i32 s51, s51, 3456
    s_branch L_dp26
L_dp24:
    s_mov_b32 s52, s12
    s_mov_b32 s53, s13
    s_mov_b32 s54, 5242880
    s_lshr_b32 s50, s3, 1
    s_lshl_b32 s50, s50, 3
    s_add_u32 s50, s50, s60
    s_and_b32 s51, s3, 1
    s_lshl_b32 s34, s50, 1
    s_add_u32 s34, s34, s51
    s_mul_i32 s34, s34, 81920
    s_add_u32 s34, s34, s35
    v_lshl_add_u32 v15, v9, 2, v10
    v_mul_u32_u24 v15, 2560, v15
    v_lshl_add_u32 v15, v8, 4, v15
    v_add_u32 v15, s34, v15
    s_lshl_b32 s56, s3, 12
    s_lshl_b32 s34, s49, 11
    s_add_u32 s56, s56, s34
    s_add_u32 s56, s56, 40960
    s_add_u32 s58, s56, 1024
    s_mul_i32 s57, s49, 40960
    s_add_u32 s59, s57, 1280
L_dp26:
    v_and_b32 v200, 3, v0
    v_bfe_u32 v201, v0, 2, 2
    v_lshrrev_b32 v202, 4, v0
    s_lshl_b32 s34, s3, 10
    s_add_u32 s34, s34, 122112
    v_mul_u32_u24 v203, 320, v201
    v_min_u32 v203, 704, v203
    v_lshl_add_u32 v203, v202, 6, v203
    v_lshl_add_u32 v203, v200, 4, v203
    v_add_u32 v203, s34, v203
    s_movk_i32 s48, 16384
    v_mov_b32 v197, 0
    s_mov_b32 s40, 0
    s_mov_b32 s41, 0
    s_mov_b32 s42, 0
    s_cmp_eq_u32 s63, 0
    s_cbranch_scc1 L_d_wo
    s_cmp_eq_u32 s63, 2
    s_cbranch_scc1 L_d_w2
    s_cmp_eq_u32 s63, 3
    s_cbranch_scc1 L_d_none
    v_and_b32 v205, 15, v0
    v_lshlrev_b32 v205, 4, v205
    s_and_b32 s49, s3, 3
    s_mul_i32 s34, s49, 1280
    s_add_u32 s34, s34, s99
    s_add_u32 s34, s34, 786432
    v_lshl_add_u32 v206, v202, 15, v205
    v_add_u32 v206, s34, v206
    s_mul_i32 s34, s49, 3840
    v_add_u32 v205, s34, v205
    s_lshl_b32 s34, s62, 6
    v_lshlrev_b32 v5, 4, v14
    v_lshl_add_u32 v5, v12, 2, v5
    v_add_u32 v5, s34, v5
    global_load_dword v6, v5, s[18:19]
    v_and_b32 v7, 15, v0
    v_lshlrev_b32 v7, 4, v7
    v_mul_u32_u24 v8, 1280, v14
    v_add_u32 v8, v8, v7
    v_bfe_u32 v9, v0, 3, 1
    v_lshlrev_b32 v9, 15, v9
    v_lshl_add_u32 v9, v14, 7, v9
    v_and_b32 v10, 7, v0
    v_lshl_add_u32 v9, v10, 4, v9
    v_add_u32 v9, 1572864, v9
    s_mov_b32 s57, 65536
    v_mul_u32_u24 v5, 3840, v14
    v_add_u32 v5, v5, v7
    global_load_dwordx4 v[32:35], v8, s[4:5] offset:0
    global_load_dwordx4 v[36:39], v8, s[4:5] offset:256
    global_load_dwordx4 v[40:43], v8, s[4:5] offset:512
    global_load_dwordx4 v[44:47], v8, s[4:5] offset:768
    global_load_dwordx4 v[48:51], v8, s[4:5] offset:1024
    s_mov_b32 s35, 0
L_poll27:
    buffer_load_dwordx4 v[52:55], v9, s[44:47], s57 offen offset:1024 sc1
    buffer_load_dwordx4 v[56:59], v9, s[44:47], 0 offen offset:1536 sc1
    buffer_load_dwordx4 v[60:63], v9, s[44:47], s57 offen offset:1536 sc1
    buffer_load_dwordx4 v[64:67], v9, s[44:47], 0 offen offset:2048 sc1
    buffer_load_dwordx4 v[68:71], v9, s[44:47], s57 offen offset:2048 sc1
    buffer_load_dwordx4 v[72:75], v9, s[44:47], 0 offen offset:2560 sc1
    buffer_load_dwordx4 v[76:79], v9, s[44:47], s57 offen offset:2560 sc1
    buffer_load_dwordx4 v[80:83], v9, s[44:47], 0 offen offset:3072 sc1
    buffer_load_dwordx4 v[84:87], v9, s[44:47], s57 offen offset:3072 sc1
    buffer_load_dwordx4 v[88:91], v9, s[44:47], 0 offen offset:3584 sc1
    s_add_u32 s35, s35, 1
    s_waitcnt vmcnt(0)
    v_max3_u32 v28, v52, v53, v54
    v_max3_u32 v28, v28, v55, v56
    v_max3_u32 v28, v28, v57, v58
    v_max3_u32 v28, v28, v59, v60
    v_max3_u32 v28, v28, v61, v62
    v_max3_u32 v28, v28, v63, v64
    v_max3_u32 v28, v28, v65, v66
    v_max3_u32 v28, v28, v67, v68
    v_max3_u32 v28, v28, v69, v70
    v_max3_u32 v28, v28, v71, v72
    v_max3_u32 v28, v28, v73, v74
    v_max3_u32 v28, v28, v75, v76
    v_max3_u32 v28, v28, v77, v78
    v_max3_u32 v28, v28, v79, v80
    v_max3_u32 v28, v28, v81, v82
    v_max3_u32 v28, v28, v83, v84
    v_max3_u32 v28, v28, v85, v86
    v_max3_u32 v28, v28, v87, v88
    v_max3_u32 v28, v28, v89, v90
    v_max_u32 v28, v28, v91
    v_cmp_eq_u32 vcc, -1, v28
    s_cbranch_vccz L_done28
    s_sleep 16
    s_cmp_lt_u32 s35, 60000
    s_cbranch_scc1 L_poll27
L_done28:
    ds_write_b128 v5, v[32:35] offset:0
    ds_write_b128 v5, v[36:39] offset:256
    ds_write_b128 v5, v[40:43] offset:512
    ds_write_b128 v5, v[44:47] offset:768
    ds_write_b128 v5, v[48:51] offset:1024
    ds_write_b128 v5, v[52:55] offset:1280
    ds_write_b128 v5, v[56:59] offset:1536
    ds_write_b128 v5, v[60:63] offset:1792
    ds_write_b128 v5, v[64:67] offset:2048
    ds_write_b128 v5, v[68:71] offset:2304
    ds_write_b128 v5, v[72:75] offset:2560
    ds_write_b128 v5, v[76:79] offset:2816
    ds_write_b128 v5, v[80:83] offset:3072
    ds_write_b128 v5, v[84:87] offset:3328
    ds_write_b128 v5, v[88:91] offset:3584
    s_waitcnt lgkmcnt(0)
    v_lshlrev_b32 v100, 16, v6
    v_and_b32 v101, 0xffff0000, v6
    s_cmp_eq_u32 s60, 4
    s_cselect_b32 s40, 6, 12
    s_mov_b32 s41, 5462
    s_cmov_b32 s41, 10923
    s_cselect_b32 s34, 20, 20
    s_mov_b32 s49, 17280
    s_cmov_b32 s49, 34560
    v_min_u32 v196, 59, v0
    v_mul_u32_u24 v197, s41, v196
    v_lshrrev_b32 v197, 16, v197
    v_mul_u32_u24 v194, s40, v197
    v_sub_u32 v196, v196, v194
    v_mul_u32_u24 v197, 3456, v197
    v_lshl_add_u32 v197, v196, 6, v197
    s_mul_i32 s35, s60, 768
    s_add_i32 s35, s35, 0
    s_cmp_eq_u32 s60, 4
    s_cselect_b32 s35, 3072, s35
    s_sub_u32 s34, s61, s34
    s_mul_i32 s34, s34, s49
    s_mul_i32 s34, s34, 11
    s_add_u32 s34, s34, s35
    v_add_u32 v197, s34, v197
    s_mov_b32 s40, s49
    s_mov_b32 s41, s49
    s_branch L_d_none
L_d_w2:
    s_lshl_b32 s34, s62, 5
    v_lshl_add_u32 v3, v14, 3, s34
    global_load_dwordx2 v[20:21], v3, s[22:23]
    v_mul_u32_u24 v112, 1280, v12
    v_add_u32 v112, v112, v3
    global_load_dwordx2 v[22:23], v112, s[4:5]
    s_lshr_b32 s34, s62, 2
    s_add_u32 s34, s34, 30
    s_lshr_b32 s35, s34, 2
    s_lshl_b32 s35, s35, 9
    s_and_b32 s34, s34, 3
    s_lshl_b32 s34, s34, 15
    s_add_u32 s34, s34, s35
    s_and_b32 s35, s62, 3
    s_mul_i32 s35, s35, 32
    s_add_u32 s34, s34, s35
    s_add_u32 s34, s34, 1572864
    v_lshlrev_b32 v5, 7, v12
    v_lshl_add_u32 v5, v14, 3, v5
    v_add_u32 v5, s34, v5
    s_waitcnt vmcnt(0)
    v_lshlrev_b32 v32, 16, v20
    v_and_b32 v33, 0xffff0000, v20
    v_lshlrev_b32 v34, 16, v21
    v_and_b32 v35, 0xffff0000, v21
    v_lshlrev_b32 v108, 16, v22
    v_and_b32 v109, 0xffff0000, v22
    v_lshlrev_b32 v110, 16, v23
    v_and_b32 v111, 0xffff0000, v23
    s_mov_b32 s35, 0
L_poll30:
    buffer_load_dwordx2 v[24:25], v5, s[44:47], 0 offen sc1
    s_add_u32 s35, s35, 1
    s_waitcnt vmcnt(0)
    v_max_u32 v28, v24, v25
    v_cmp_eq_u32 vcc, -1, v28
    s_cbranch_vccz L_done31
    s_sleep 16
    s_cmp_lt_u32 s35, 60000
    s_cbranch_scc1 L_poll30
L_done31:
    v_lshlrev_b32 v104, 16, v24
    v_and_b32 v105, 0xffff0000, v24
    v_lshlrev_b32 v106, 16, v25
    v_and_b32 v107, 0xffff0000, v25
    v_fma_f32 v108, v104, v32, v108
    v_fma_f32 v109, v105, v33, v109
    v_fma_f32 v110, v106, v34, v110
    v_fma_f32 v111, v107, v35, v111
    v_mul_f32 v108, 0x3e800000, v108
    v_mul_f32 v109, 0x3e800000, v109
    v_mul_f32 v110, 0x3e800000, v110
    v_mul_f32 v111, 0x3e800000, v111
    v_lshl_add_u32 v204, v13, 15, v112
    s_add_u32 s34, s99, 786432
    v_add_u32 v204, s34, v204
    s_cmp_eq_u32 s60, 4
    s_cselect_b32 s40, 2, 6
    s_mov_b32 s41, 10923
    s_cmov_b32 s41, 32769
    s_cselect_b32 s34, 28, 20
    s_mov_b32 s49, 12800
    s_cmov_b32 s49, 38400
    v_min_u32 v196, 59, v0
    v_mul_u32_u24 v197, s41, v196
    v_lshrrev_b32 v197, 16, v197
    v_mul_u32_u24 v194, s40, v197
    v_sub_u32 v196, v196, v194
    v_mul_u32_u24 v197, 1280, v197
    v_lshl_add_u32 v197, v196, 6, v197
    s_mul_i32 s35, s60, 384
    s_add_i32 s35, s35, -1792
    s_cmp_eq_u32 s60, 4
    s_cselect_b32 s35, 0, s35
    s_sub_u32 s34, s61, s34
    s_mul_i32 s34, s34, s49
    s_mul_i32 s34, s34, 15
    s_add_u32 s34, s34, s35
    v_add_u32 v197, s34, v197
    s_mov_b32 s40, s49
    s_mov_b32 s41, s49
    s_branch L_d_none
L_d_wo:
    s_lshr_b32 s49, s3, 1
    s_lshl_b32 s49, s49, 15
    v_and_b32 v210, 7, v0
    s_mul_i32 s34, s60, 4096
    s_add_u32 s34, s34, s49
    s_add_u32 s34, s34, 1179904
    v_lshrrev_b32 v211, 3, v0
    v_mul_u32_u24 v205, 512, v211
    v_add_u32 v204, s34, v205
    s_lshl_b32 s35, s51, 7
    s_add_u32 s34, s34, s35
    s_sub_u32 s34, s34, 256
    v_lshl_add_u32 v205, v210, 4, v205
    v_add_u32 v205, s34, v205
    s_lshl_b32 s34, s3, 12
    s_add_u32 s34, s34, 40960
    v_lshrrev_b32 v206, 2, v0
    v_lshlrev_b32 v206, 6, v206
    v_lshl_add_u32 v206, v200, 3, v206
    v_add_u32 v206, s34, v206
    s_mul_i32 s34, s3, 1152
    s_add_u32 s34, s34, 107520
    v_mul_u32_u24 v207, 144, v211
    v_lshl_add_u32 v207, v210, 4, v207
    v_add_u32 v207, s34, v207
    v_mul_u32_u24 v208, 144, v210
    v_lshl_add_u32 v208, v202, 4, v208
    v_add_u32 v208, s34, v208
    v_mul_u32_u24 v212, 144, v211
    v_add_u32 v212, s34, v212
    v_mul_u32_u24 v213, 144, v210
    v_add_u32 v213, s34, v213
    v_and_b32 v211, 1, v211
    v_bfe_u32 v203, v0, 1, 2
    v_mul_u32_u24 v203, 144, v203
    v_and_b32 v214, 1, v0
    v_mul_u32_u24 v214, 576, v214
    v_lshl_add_u32 v214, v211, 6, v214
    v_lshl_add_u32 v214, v202, 4, v214
    s_add_u32 s34, s34, 14592
    v_add3_u32 v203, v203, v214, s34
    v_mov_b32 v210, 98816
    v_cmp_eq_u32 vcc, 0, v211
    s_nop 1
    v_cndmask_b32 v209, v208, v210, vcc
    v_cndmask_b32 v208, v210, v208, vcc
    v_and_b32 v8, 15, v0
    s_lshr_b32 s34, s62, 1
    s_add_u32 s34, s34, 0
    s_lshr_b32 s35, s34, 2
    s_lshl_b32 s35, s35, 9
    s_and_b32 s34, s34, 3
    s_lshl_b32 s34, s34, 15
    s_add_u32 s34, s34, s35
    s_and_b32 s35, s62, 1
    s_mul_i32 s35, s35, 64
    s_add_u32 s34, s34, s35
    s_add_u32 s34, s34, 1572864
    v_lshlrev_b32 v9, 2, v8
    v_lshl_add_u32 v9, v14, 7, v9
    v_add_u32 v9, s34, v9
    s_lshr_b32 s34, s60, 2
    s_lshl_b32 s34, s34, 14
    s_and_b32 s35, s60, 3
    s_lshl_b32 s35, s35, 15
    s_add_u32 s34, s34, s35
    s_lshl_b32 s35, s62, 6
    s_add_u32 s34, s34, s35
    s_add_u32 s34, s34, 786432
    v_mul_u32_u24 v112, 1280, v14
    v_lshl_add_u32 v112, v8, 2, v112
    v_add_u32 v112, s34, v112
    v_mul_u32_u24 v113, 144, v14
    v_lshl_add_u32 v113, v8, 3, v113
    v_add_u32 v113, 122112, v113
    s_bfe_u32 s35, s60, 0x10002
    s_lshl_b32 s35, s35, 13
    s_xor_b32 s101, s99, s35
    s_xor_b32 s93, s101, 8192
    s_mul_i32 s34, s62, 52
    s_lshr_b32 s34, s34, 8
    s_mul_i32 s35, s34, 5
    s_sub_u32 s35, s62, s35
    s_mul_i32 s34, s34, 1310720
    s_lshl_b32 s35, s35, 15
    s_add_u32 s34, s34, s35
    s_mul_i32 s35, s60, 163840
    s_add_u32 s34, s34, s35
    v_lshl_add_u32 v197, v0, 6, s34
    s_movk_i32 s40, 4096
    s_movk_i32 s41, 4096
    s_mov_b32 s35, 0
L_poll33:
    buffer_load_dword v32, v9, s[44:47], 0 offen sc1
    s_add_u32 s35, s35, 1
    s_waitcnt vmcnt(0)
    v_mov_b32 v22, v32
    v_cmp_eq_u32 vcc, -1, v22
    s_cbranch_vccz L_done34
    s_sleep 16
    s_cmp_lt_u32 s35, 60000
    s_cbranch_scc1 L_poll33
L_done34:
    v_lshlrev_b32 v100, 16, v32
    v_and_b32 v101, 0xffff0000, v32
L_d_none:
    v_and_b32 v19, 7, v0
    v_lshlrev_b32 v19, 3, v19
    v_add_u32 v19, 98560, v19
    s_mov_b32 s35, 0
L_poll36:
    ds_read_b64 v[20:21], v19
    s_add_u32 s35, s35, 1
    s_waitcnt lgkmcnt(0)
    v_max_u32 v22, v20, v21
    v_cmp_eq_u32 vcc, -1, v22
    s_cbranch_vccz L_done37
    s_sleep 2
    s_cmp_lt_u32 s35, 60000
    s_cbranch_scc1 L_poll36
L_done37:
    v_max_f32_dpp v22, v20, v20 row_half_mirror row_mask:0xf bank_mask:0xf
    s_nop 1
    v_max_f32_dpp v22, v22, v22 quad_perm:[1,0,3,2] row_mask:0xf bank_mask:0xf
    s_nop 1
    v_max_f32_dpp v22, v22, v22 quad_perm:[2,3,0,1] row_mask:0xf bank_mask:0xf
    v_sub_f32 v20, v20, v22
    v_exp_f32 v20, v20
    s_nop 0
    v_mul_f32 v21, v21, v20
    s_nop 1
    v_add_f32_dpp v21, v21, v21 row_half_mirror row_mask:0xf bank_mask:0xf
    s_nop 1
    v_add_f32_dpp v21, v21, v21 quad_perm:[1,0,3,2] row_mask:0xf bank_mask:0xf
    s_nop 1
    v_add_f32_dpp v21, v21, v21 quad_perm:[2,3,0,1] row_mask:0xf bank_mask:0xf
    v_rcp_f32 v23, v21
    v_log_f32 v21, v21
    v_mul_f32 v20, v20, v23
    v_add_f32 v21, v21, v22
    v_min_u32 v21, -2, v21
    v_readlane_b32 s88, v20, 0
    v_readlane_b32 s90, v20, 1
    v_readlane_b32 s92, v20, 2
    v_readlane_b32 s94, v20, 3
    v_readlane_b32 s96, v20, 4
    v_readlane_b32 s98, v20, 5
    v_readlane_b32 s100, v20, 6
    v_readlane_b32 s89, v20, 7
    s_and_b32 s95, s61, 3
    s_lshl_b32 s95, s95, 15
    s_bfe_u32 s35, s2, 0x20005
    s_lshl_b32 s35, s35, 1
    s_lshr_b32 s91, s2, 7
    s_add_u32 s35, s35, s91
    s_getreg_b32 s91, hwreg(HW_REG_XCC_ID, 0, 4)
    v_and_b32 v24, 1, v0
    v_cmp_eq_u32 vcc, 0, v24
    v_mov_b32 v25, s91
    s_nop 0
    v_cndmask_b32 v25, v25, v21, vcc
    v_mul_f32 v20, s89, v116
    v_mul_f32 v21, s89, v117
    s_mul_i32 s34, s60, 4096
    s_mul_i32 s35, s35, 512
    s_add_u32 s34, s34, s35
    s_add_u32 s34, s34, s95
    s_add_u32 s34, s34, 1179648
    v_lshl_add_u32 v26, v0, 2, s34
    v_lshlrev_b32 v19, 3, v0
    v_add_u32 v19, 99328, v19
    v_lshlrev_b32 v18, 4, v0
    v_add_u32 v18, 131328, v18
    s_mov_b32 s36, s12
    s_mov_b32 s37, s13
    s_mov_b32 s38, 5242880
    s_and_b32 s34, s61, 24
    s_add_u32 s34, s34, s60
    s_mul_i32 s34, s34, 163840
    s_and_b32 s35, s61, 7
    s_mul_i32 s35, s35, 20480
    s_add_u32 s34, s34, s35
    v_lshl_add_u32 v195, v0, 6, s34
    s_mov_b32 s34, 0
    s_barrier
    buffer_load_dword v250, v195, s[36:39], s34 offen
    s_add_u32 s34, s34, 4096
    buffer_load_dword v250, v195, s[36:39], s34 offen
    s_add_u32 s34, s34, 4096
    buffer_load_dword v250, v195, s[36:39], s34 offen
    s_add_u32 s34, s34, 4096
    buffer_load_dword v250, v195, s[36:39], s34 offen
    s_add_u32 s34, s34, 4096
    buffer_load_dword v250, v195, s[36:39], s34 offen
    s_add_u32 s34, s34, 4096
    s_cmp_lt_u32 s63, 1
    s_cbranch_scc1 L_nopf
    buffer_load_dword v250, v197, s[52:55], s42 offen
    s_add_u32 s42, s42, s40
    buffer_load_dword v250, v197, s[52:55], s42 offen
    s_add_u32 s42, s42, s41
L_nopf:
    s_cmp_eq_u32 s97, 0
    s_barrier
    ds_read_b64 v[32:33], v19 offset:0
    ds_read_b64 v[34:35], v19 offset:1024
    ds_read_b64 v[36:37], v19 offset:2048
    ds_read_b64 v[38:39], v19 offset:3072
    ds_read_b64 v[40:41], v19 offset:4096
    ds_read_b64 v[42:43], v19 offset:5120
    ds_read_b64 v[44:45], v19 offset:6144
    buffer_store_dword v25, v26, s[44:47], 0 offen offset:256
    s_waitcnt lgkmcnt(6)
    v_pk_fma_f32 v[20:21], v[32:33], s[88:89], v[20:21] op_sel_hi:[1,0,1]
    s_waitcnt lgkmcnt(5)
    v_pk_fma_f32 v[20:21], v[34:35], s[90:91], v[20:21] op_sel_hi:[1,0,1]
    s_waitcnt lgkmcnt(4)
    v_pk_fma_f32 v[20:21], v[36:37], s[92:93], v[20:21] op_sel_hi:[1,0,1]
    s_waitcnt lgkmcnt(3)
    v_pk_fma_f32 v[20:21], v[38:39], s[94:95], v[20:21] op_sel_hi:[1,0,1]
    s_waitcnt lgkmcnt(2)
    v_pk_fma_f32 v[20:21], v[40:41], s[96:97], v[20:21] op_sel_hi:[1,0,1]
    s_waitcnt lgkmcnt(1)
    v_pk_fma_f32 v[20:21], v[42:43], s[98:99], v[20:21] op_sel_hi:[1,0,1]
    s_waitcnt lgkmcnt(0)
    v_pk_fma_f32 v[20:21], v[44:45], s[100:101], v[20:21] op_sel_hi:[1,0,1]
    v_cvt_pk_bf16_f32 v24, v20, v21
    v_min_u32 v24, -2, v24
    buffer_store_dword v24, v26, s[44:47], 0 offen
    s_cbranch_scc1 L_ostd
    buffer_store_dword v24, v26, s[44:47], 0 offen sc1
    buffer_store_dword v25, v26, s[44:47], 0 offen offset:256 sc1
L_ostd:
    ds_write_b96 v18, v[24:26]
    s_waitcnt lgkmcnt(0)
    s_cmp_lt_u32 s63, 1
    s_cbranch_scc1 L_nopf2
    buffer_load_dword v250, v197, s[52:55], s42 offen
    s_add_u32 s42, s42, s40
    buffer_load_dword v250, v197, s[52:55], s42 offen
    s_add_u32 s42, s42, s41
    buffer_load_dword v250, v197, s[52:55], s42 offen
    s_add_u32 s42, s42, s40
    buffer_load_dword v250, v197, s[52:55], s42 offen
    s_add_u32 s42, s42, s41
    buffer_load_dword v250, v197, s[52:55], s42 offen
    s_add_u32 s42, s42, s40
    buffer_load_dword v250, v197, s[52:55], s42 offen
    s_add_u32 s42, s42, s41
    buffer_load_dword v250, v197, s[52:55], s42 offen
    s_add_u32 s42, s42, s40
    buffer_load_dword v250, v197, s[52:55], s42 offen
    s_add_u32 s42, s42, s41
L_nopf2:
    s_barrier
    s_cmp_eq_u32 s63, 0
    s_cbranch_scc1 L_r_wo2
    buffer_load_dword v250, v197, s[52:55], s42 offen
    s_add_u32 s42, s42, s40
    s_cmp_eq_u32 s63, 1
    s_cbranch_scc1 L_r_w1
    buffer_load_dword v250, v197, s[52:55], s42 offen
    s_add_u32 s42, s42, s40
    buffer_load_dword v250, v197, s[52:55], s42 offen
    s_add_u32 s42, s42, s41
    buffer_load_dword v250, v197, s[52:55], s42 offen
    s_add_u32 s42, s42, s40
    buffer_load_dword v250, v197, s[52:55], s42 offen
    s_add_u32 s42, s42, s41
    s_cmp_eq_u32 s63, 2
    s_cbranch_scc1 L_w2_red
    s_waitcnt vmcnt(0)
    s_mov_b64 exec, -1
    v_lshlrev_b32 v243, 4, v0
    v_add_u32 v243, 131328, v243
    ds_read_b96 v[240:242], v243
    s_waitcnt lgkmcnt(0)
    buffer_store_dword v240, v242, s[44:47], 0 offen sc1
    buffer_store_dword v241, v242, s[44:47], 0 offen offset:256 sc1
    s_branch L_fin
L_stream:
    s_sub_u32 s49, s3, 1
    s_lshl_b32 s49, s49, 12
    v_lshl_add_u32 v1, v0, 4, s49
    s_and_b32 s34, s2, 127
    s_lshl_b32 s34, s34, 21
    s_lshr_b32 s35, s2, 7
    s_lshl_b32 s35, s35, 18
    s_add_u32 s34, s34, s35
    s_add_u32 s34, s34, 1572864
    s_mov_b32 s38, 0x40000
    s_mov_b32 s42, 0x40000
    s_waitcnt lgkmcnt(0)
    s_add_u32 s36, s6, s34
    s_addc_u32 s37, s7, 0
    s_add_u32 s40, s8, s34
    s_addc_u32 s41, s9, 0
    s_barrier
    s_waitcnt vmcnt(2)
    s_mov_b32 s49, 0
    buffer_load_dwordx4 v[28:31], v1, s[36:39], s49 offen offset:3072 nt
    s_waitcnt vmcnt(2)
    s_mov_b32 s49, 28672
    buffer_load_dwordx4 v[32:35], v1, s[36:39], s49 offen offset:0 nt
    s_waitcnt vmcnt(2)
    buffer_load_dwordx4 v[36:39], v1, s[36:39], s49 offen offset:1024 nt
    s_waitcnt vmcnt(2)
    buffer_load_dwordx4 v[40:43], v1, s[36:39], s49 offen offset:2048 nt
    s_waitcnt vmcnt(2)
    buffer_load_dwordx4 v[44:47], v1, s[36:39], s49 offen offset:3072 nt
    s_add_u32 s44, s32, 0
    s_addc_u32 s45, s33, 0
    s_mov_b32 s63, 0
    s_mov_b32 s62, s61
    s_cmp_lt_u32 s61, 20
    s_cbranch_scc1 L_rd39
    s_mul_i32 s62, s60, 12
    s_add_u32 s62, s62, s61
    s_sub_u32 s62, s62, 20
    s_mov_b32 s63, 1
    s_cmp_lt_u32 s62, 54
    s_cbranch_scc1 L_rd39
    s_cmp_lt_u32 s62, 56
    s_cselect_b32 s63, 3, 2
    s_sub_u32 s62, s62, 56
L_rd39:
    v_and_b32 v8, 3, v0
    v_bfe_u32 v9, v0, 2, 2
    v_lshrrev_b32 v10, 4, v0
    s_mov_b32 s55, 0x20000
    s_lshl_b32 s35, s62, 6
    s_and_b32 s49, s62, 1
    s_cmp_eq_u32 s63, 0
    s_cbranch_scc1 L_dp41
    s_cmp_eq_u32 s63, 1
    s_cbranch_scc1 L_dp42
    s_mov_b32 s52, s20
    s_mov_b32 s53, s21
    s_mov_b32 s54, 2211840
    v_mov_b32 v15, 0
    s_branch L_dp43
L_dp42:
    s_mov_b32 s52, s16
    s_mov_b32 s53, s17
    s_mov_b32 s54, 2211840
    v_lshl_add_u32 v15, v9, 3, v10
    v_mul_u32_u24 v15, 3456, v15
    v_lshl_add_u32 v15, v8, 4, v15
    v_add_u32 v15, s35, v15
    s_bfe_u32 s50, s3, 0x10001
    s_lshl_b32 s50, s50, 7
    s_and_b32 s34, s3, 1
    s_lshl_b32 s34, s34, 2
    s_add_u32 s50, s50, s34
    s_and_b32 s51, s3, 3
    s_lshl_b32 s51, s51, 5
    s_add_u32 s51, s51, 512
    s_mul_i32 s50, s50, 3456
    s_mul_i32 s51, s51, 3456
    s_branch L_dp43
L_dp41:
    s_mov_b32 s52, s12
    s_mov_b32 s53, s13
    s_mov_b32 s54, 5242880
    s_lshr_b32 s50, s3, 1
    s_lshl_b32 s50, s50, 3
    s_add_u32 s50, s50, s60
    s_and_b32 s51, s3, 1
    s_lshl_b32 s34, s50, 1
    s_add_u32 s34, s34, s51
    s_mul_i32 s34, s34, 81920
    s_add_u32 s34, s34, s35
    v_lshl_add_u32 v15, v9, 2, v10
    v_mul_u32_u24 v15, 2560, v15
    v_lshl_add_u32 v15, v8, 4, v15
    v_add_u32 v15, s34, v15
    s_lshl_b32 s56, s3, 12
    s_lshl_b32 s34, s49, 11
    s_add_u32 s56, s56, s34
    s_add_u32 s56, s56, 40960
    s_add_u32 s58, s56, 1024
    s_mul_i32 s57, s49, 40960
    s_add_u32 s59, s57, 1280
L_dp43:
    v_and_b32 v2, 15, v0
    v_lshlrev_b32 v2, 4, v2
    v_add_u32 v2, 98304, v2
    s_waitcnt vmcnt(2)
    s_mov_b32 s49, 57344
    buffer_load_dwordx4 v[48:51], v1, s[36:39], s49 offen offset:0 nt
    s_waitcnt vmcnt(2)
    buffer_load_dwordx4 v[52:55], v1, s[36:39], s49 offen offset:1024 nt
    s_waitcnt vmcnt(2)
    s_cmp_ge_u32 s3, 4
    s_cbranch_scc1 L_sl44
    s_waitcnt vmcnt(1)
L_sl44:
    buffer_load_dwordx4 v[56:59], v1, s[36:39], s49 offen offset:2048 nt
    s_waitcnt vmcnt(2)
    s_cmp_ge_u32 s3, 4
    s_cbranch_scc1 L_sl45
    s_waitcnt vmcnt(1)
L_sl45:
    buffer_load_dwordx4 v[60:63], v1, s[36:39], s49 offen offset:3072 nt
    s_waitcnt vmcnt(2)
    s_cmp_ge_u32 s3, 4
    s_cbranch_scc1 L_sl46
    s_waitcnt vmcnt(1)
L_sl46:
    s_mov_b32 s49, 86016
    buffer_load_dwordx4 v[64:67], v1, s[36:39], s49 offen offset:0 nt
    s_waitcnt vmcnt(2)
    buffer_load_dwordx4 v[68:71], v1, s[36:39], s49 offen offset:1024 nt
    s_waitcnt vmcnt(2)
    buffer_load_dwordx4 v[72:75], v1, s[36:39], s49 offen offset:2048 nt
    s_waitcnt vmcnt(2)
    buffer_load_dwordx4 v[76:79], v1, s[36:39], s49 offen offset:3072 nt
    s_waitcnt vmcnt(2)
    s_mov_b32 s49, 114688
    buffer_load_dwordx4 v[80:83], v1, s[36:39], s49 offen offset:0 nt
    s_waitcnt vmcnt(2)
    buffer_load_dwordx4 v[84:87], v1, s[36:39], s49 offen offset:1024 nt
    s_waitcnt vmcnt(2)
    buffer_load_dwordx4 v[88:91], v1, s[36:39], s49 offen offset:2048 nt
    s_waitcnt vmcnt(2)
    buffer_load_dwordx4 v[92:95], v1, s[36:39], s49 offen offset:3072 nt
    s_waitcnt vmcnt(2)
    s_mov_b32 s49, 143360
    buffer_load_dwordx4 v[96:99], v1, s[36:39], s49 offen offset:0 nt
    v_mov_b32 v3, 21
    ds_write_b32 v2, v3 offset:768
    s_waitcnt vmcnt(2)
    buffer_load_dwordx4 v[100:103], v1, s[36:39], s49 offen offset:1024 nt
    s_waitcnt vmcnt(2)
    buffer_load_dwordx4 v[104:107], v1, s[36:39], s49 offen offset:2048 nt
    s_waitcnt vmcnt(2)
    buffer_load_dwordx4 v[108:111], v1, s[36:39], s49 offen offset:3072 nt
    s_waitcnt vmcnt(2)
    s_mov_b32 s49, 172032
    buffer_load_dwordx4 v[112:115], v1, s[36:39], s49 offen offset:0 nt
    s_waitcnt vmcnt(2)
    buffer_load_dwordx4 v[116:119], v1, s[36:39], s49 offen offset:1024 nt
    s_waitcnt vmcnt(2)
    buffer_load_dwordx4 v[120:123], v1, s[36:39], s49 offen offset:2048 nt
    s_waitcnt vmcnt(2)
    buffer_load_dwordx4 v[124:127], v1, s[36:39], s49 offen offset:3072 nt
    s_waitcnt vmcnt(2)
    s_mov_b32 s49, 200704
    buffer_load_dwordx4 v[128:131], v1, s[36:39], s49 offen offset:0 nt
    s_waitcnt vmcnt(2)
    buffer_load_dwordx4 v[132:135], v1, s[36:39], s49 offen offset:1024 nt
    s_waitcnt vmcnt(2)
    buffer_load_dwordx4 v[136:139], v1, s[36:39], s49 offen offset:2048 nt
    s_waitcnt vmcnt(2)
    buffer_load_dwordx4 v[140:143], v1, s[36:39], s49 offen offset:3072 nt
    s_waitcnt vmcnt(2)
    s_mov_b32 s49, 229376
    buffer_load_dwordx4 v[144:147], v1, s[36:39], s49 offen offset:0 nt
    v_mov_b32 v3, 33
    ds_write_b32 v2, v3 offset:768
    s_waitcnt vmcnt(2)
    buffer_load_dwordx4 v[148:151], v1, s[36:39], s49 offen offset:1024 nt
    s_waitcnt vmcnt(2)
    buffer_load_dwordx4 v[152:155], v1, s[36:39], s49 offen offset:2048 nt
    s_waitcnt vmcnt(2)
    buffer_load_dwordx4 v[156:159], v1, s[36:39], s49 offen offset:3072 nt
    s_waitcnt vmcnt(2)
    s_mov_b32 s49, 0
    buffer_load_dwordx4 v[160:163], v1, s[40:43], s49 offen offset:0 nt
    s_waitcnt vmcnt(2)
    buffer_load_dwordx4 v[164:167], v1, s[40:43], s49 offen offset:1024 nt
    s_waitcnt vmcnt(2)
    buffer_load_dwordx4 v[168:171], v1, s[40:43], s49 offen offset:2048 nt
    s_waitcnt vmcnt(2)
    buffer_load_dwordx4 v[172:175], v1, s[40:43], s49 offen offset:3072 nt
    s_waitcnt vmcnt(2)
    s_mov_b32 s49, 28672
    buffer_load_dwordx4 v[176:179], v1, s[40:43], s49 offen offset:0 nt
    s_waitcnt vmcnt(2)
    buffer_load_dwordx4 v[180:183], v1, s[40:43], s49 offen offset:1024 nt
    s_waitcnt vmcnt(2)
    buffer_load_dwordx4 v[184:187], v1, s[40:43], s49 offen offset:2048 nt
    s_waitcnt vmcnt(2)
    buffer_load_dwordx4 v[188:191], v1, s[40:43], s49 offen offset:3072 nt
    s_waitcnt vmcnt(2)
    s_mov_b32 s49, 57344
    buffer_load_dwordx4 v[192:195], v1, s[40:43], s49 offen offset:0 nt
    s_waitcnt vmcnt(2)
    buffer_load_dwordx4 v[196:199], v1, s[40:43], s49 offen offset:1024 nt
    s_waitcnt vmcnt(2)
    buffer_load_dwordx4 v[200:203], v1, s[40:43], s49 offen offset:2048 nt
    s_waitcnt vmcnt(2)
    buffer_load_dwordx4 v[204:207], v1, s[40:43], s49 offen offset:3072 nt
    s_waitcnt vmcnt(2)
    s_mov_b32 s49, 86016
    buffer_load_dwordx4 v[208:211], v1, s[40:43], s49 offen offset:0 nt
    s_waitcnt vmcnt(2)
    buffer_load_dwordx4 v[212:215], v1, s[40:43], s49 offen offset:1024 nt
    s_waitcnt vmcnt(2)
    buffer_load_dwordx4 v[216:219], v1, s[40:43], s49 offen offset:2048 nt
    s_waitcnt vmcnt(2)
    buffer_load_dwordx4 v[220:223], v1, s[40:43], s49 offen offset:3072 nt
    s_waitcnt vmcnt(2)
    s_mov_b32 s49, 114688
    buffer_load_dwordx4 v[224:227], v1, s[40:43], s49 offen offset:0 nt
    s_waitcnt vmcnt(2)
    buffer_load_dwordx4 v[228:231], v1, s[40:43], s49 offen offset:1024 nt
    s_waitcnt vmcnt(2)
    buffer_load_dwordx4 v[232:235], v1, s[40:43], s49 offen offset:2048 nt
    s_waitcnt vmcnt(2)
    buffer_load_dwordx4 v[236:239], v1, s[40:43], s49 offen offset:3072 nt
    v_mov_b32 v14, 99080
    s_mov_b32 s35, 0
L_poll47:
    ds_read_b128 v[4:7], v2
    ds_read_b32 v8, v14
    s_add_u32 s35, s35, 1
    s_waitcnt lgkmcnt(0)
    v_max3_u32 v3, v4, v5, v6
    v_max_u32 v3, v3, v7
    v_cmp_eq_u32 vcc, -1, v3
    s_cbranch_vccz L_done48
    s_sleep 2
    s_cmp_lt_u32 s35, 60000
    s_cbranch_scc1 L_poll47
L_done48:
    v_readfirstlane_b32 s99, v8
    s_waitcnt vmcnt(2)
    s_mov_b32 s49, 143360
    buffer_load_dwordx4 v[240:243], v1, s[40:43], s49 offen offset:0 nt
    v_dot2_f32_bf16 v8, v16, v4, 0
    v_dot2_f32_bf16 v9, v20, v4, 0
    v_dot2_f32_bf16 v10, v24, v4, 0
    v_dot2_f32_bf16 v11, v28, v4, 0
    v_dot2c_f32_bf16 v8, v17, v5
    v_dot2c_f32_bf16 v9, v21, v5
    v_dot2c_f32_bf16 v10, v25, v5
    v_dot2c_f32_bf16 v11, v29, v5
    v_dot2c_f32_bf16 v8, v18, v6
    v_dot2c_f32_bf16 v9, v22, v6
    v_dot2c_f32_bf16 v10, v26, v6
    v_dot2c_f32_bf16 v11, v30, v6
    v_dot2c_f32_bf16 v8, v19, v7
    v_dot2c_f32_bf16 v9, v23, v7
    v_dot2c_f32_bf16 v10, v27, v7
    v_dot2c_f32_bf16 v11, v31, v7
    v_add_f32_dpp v12, v8, v8 row_ror:8 row_mask:0xf bank_mask:0x3
    v_add_f32_dpp v12, v9, v9 row_ror:8 row_mask:0xf bank_mask:0xc
    v_add_f32_dpp v13, v10, v10 row_ror:8 row_mask:0xf bank_mask:0x3
    v_add_f32_dpp v13, v11, v11 row_ror:8 row_mask:0xf bank_mask:0xc
    v_dot2_f32_bf16 v8, v32, v4, 0
    v_dot2_f32_bf16 v9, v36, v4, 0
    v_dot2_f32_bf16 v10, v40, v4, 0
    v_dot2_f32_bf16 v11, v44, v4, 0
    v_add_f32_dpp v12, v12, v12 row_half_mirror row_mask:0xf bank_mask:0xf
    v_add_f32_dpp v13, v13, v13 row_half_mirror row_mask:0xf bank_mask:0xf
    v_dot2c_f32_bf16 v8, v33, v5
    v_dot2c_f32_bf16 v9, v37, v5
    v_dot2c_f32_bf16 v10, v41, v5
    v_dot2c_f32_bf16 v11, v45, v5
    v_add_f32_dpp v12, v12, v12 quad_perm:[1,0,3,2] row_mask:0xf bank_mask:0xf
    v_add_f32_dpp v13, v13, v13 quad_perm:[1,0,3,2] row_mask:0xf bank_mask:0xf
    v_dot2c_f32_bf16 v8, v34, v6
    v_dot2c_f32_bf16 v9, v38, v6
    v_dot2c_f32_bf16 v10, v42, v6
    v_dot2c_f32_bf16 v11, v46, v6
    s_waitcnt vmcnt(2)
    buffer_load_dwordx4 v[244:247], v1, s[40:43], s49 offen offset:1024 nt
    v_add_f32_dpp v12, v12, v12 quad_perm:[2,3,0,1] row_mask:0xf bank_mask:0xf
    v_add_f32_dpp v13, v13, v13 quad_perm:[2,3,0,1] row_mask:0xf bank_mask:0xf
    v_dot2c_f32_bf16 v8, v35, v7
    v_dot2c_f32_bf16 v9, v39, v7
    v_dot2c_f32_bf16 v10, v43, v7
    v_dot2c_f32_bf16 v11, v47, v7
    v_add_f32_dpp v16, v8, v8 row_ror:8 row_mask:0xf bank_mask:0x3
    v_add_f32_dpp v16, v9, v9 row_ror:8 row_mask:0xf bank_mask:0xc
    v_add_f32_dpp v17, v10, v10 row_ror:8 row_mask:0xf bank_mask:0x3
    v_add_f32_dpp v17, v11, v11 row_ror:8 row_mask:0xf bank_mask:0xc
    v_dot2_f32_bf16 v8, v48, v4, 0
    v_dot2_f32_bf16 v9, v52, v4, 0
    v_dot2_f32_bf16 v10, v56, v4, 0
    v_dot2_f32_bf16 v11, v60, v4, 0
    v_add_f32_dpp v16, v16, v16 row_half_mirror row_mask:0xf bank_mask:0xf
    v_add_f32_dpp v17, v17, v17 row_half_mirror row_mask:0xf bank_mask:0xf
    v_dot2c_f32_bf16 v8, v49, v5
    v_dot2c_f32_bf16 v9, v53, v5
    v_dot2c_f32_bf16 v10, v57, v5
    v_dot2c_f32_bf16 v11, v61, v5
    v_add_f32_dpp v16, v16, v16 quad_perm:[1,0,3,2] row_mask:0xf bank_mask:0xf
    v_add_f32_dpp v17, v17, v17 quad_perm:[1,0,3,2] row_mask:0xf bank_mask:0xf
    v_dot2c_f32_bf16 v8, v50, v6
    v_dot2c_f32_bf16 v9, v54, v6
    v_dot2c_f32_bf16 v10, v58, v6
    v_dot2c_f32_bf16 v11, v62, v6
    v_add_f32_dpp v16, v16, v16 quad_perm:[2,3,0,1] row_mask:0xf bank_mask:0xf
    v_add_f32_dpp v17, v17, v17 quad_perm:[2,3,0,1] row_mask:0xf bank_mask:0xf
    v_dot2c_f32_bf16 v8, v51, v7
    v_dot2c_f32_bf16 v9, v55, v7
    v_dot2c_f32_bf16 v10, v59, v7
    v_dot2c_f32_bf16 v11, v63, v7
    v_add_f32_dpp v18, v8, v8 row_ror:8 row_mask:0xf bank_mask:0x3
    v_add_f32_dpp v18, v9, v9 row_ror:8 row_mask:0xf bank_mask:0xc
    v_add_f32_dpp v19, v10, v10 row_ror:8 row_mask:0xf bank_mask:0x3
    v_add_f32_dpp v19, v11, v11 row_ror:8 row_mask:0xf bank_mask:0xc
    s_waitcnt vmcnt(2)
    buffer_load_dwordx4 v[248:251], v1, s[40:43], s49 offen offset:2048 nt
    v_dot2_f32_bf16 v8, v64, v4, 0
    v_dot2_f32_bf16 v9, v68, v4, 0
    v_dot2_f32_bf16 v10, v72, v4, 0
    v_dot2_f32_bf16 v11, v76, v4, 0
    v_add_f32_dpp v18, v18, v18 row_half_mirror row_mask:0xf bank_mask:0xf
    v_add_f32_dpp v19, v19, v19 row_half_mirror row_mask:0xf bank_mask:0xf
    v_dot2c_f32_bf16 v8, v65, v5
    v_dot2c_f32_bf16 v9, v69, v5
    v_dot2c_f32_bf16 v10, v73, v5
    v_dot2c_f32_bf16 v11, v77, v5
    v_add_f32_dpp v18, v18, v18 quad_perm:[1,0,3,2] row_mask:0xf bank_mask:0xf
    v_add_f32_dpp v19, v19, v19 quad_perm:[1,0,3,2] row_mask:0xf bank_mask:0xf
    v_dot2c_f32_bf16 v8, v66, v6
    v_dot2c_f32_bf16 v9, v70, v6
    v_dot2c_f32_bf16 v10, v74, v6
    v_dot2c_f32_bf16 v11, v78, v6
    v_add_f32_dpp v18, v18, v18 quad_perm:[2,3,0,1] row_mask:0xf bank_mask:0xf
    v_add_f32_dpp v19, v19, v19 quad_perm:[2,3,0,1] row_mask:0xf bank_mask:0xf
    v_dot2c_f32_bf16 v8, v67, v7
    v_dot2c_f32_bf16 v9, v71, v7
    v_dot2c_f32_bf16 v10, v75, v7
    v_dot2c_f32_bf16 v11, v79, v7
    v_add_f32_dpp v20, v8, v8 row_ror:8 row_mask:0xf bank_mask:0x3
    v_add_f32_dpp v20, v9, v9 row_ror:8 row_mask:0xf bank_mask:0xc
    v_add_f32_dpp v21, v10, v10 row_ror:8 row_mask:0xf bank_mask:0x3
    v_add_f32_dpp v21, v11, v11 row_ror:8 row_mask:0xf bank_mask:0xc
    v_dot2_f32_bf16 v8, v80, v4, 0
    v_dot2_f32_bf16 v9, v84, v4, 0
    v_dot2_f32_bf16 v10, v88, v4, 0
    v_dot2_f32_bf16 v11, v92, v4, 0
    v_add_f32_dpp v20, v20, v20 row_half_mirror row_mask:0xf bank_mask:0xf
    v_add_f32_dpp v21, v21, v21 row_half_mirror row_mask:0xf bank_mask:0xf
    v_dot2c_f32_bf16 v8, v81, v5
    v_dot2c_f32_bf16 v9, v85, v5
    v_dot2c_f32_bf16 v10, v89, v5
    v_dot2c_f32_bf16 v11, v93, v5
    s_waitcnt vmcnt(2)
    buffer_load_dwordx4 v[252:255], v1, s[40:43], s49 offen offset:3072 nt
    v_add_f32_dpp v20, v20, v20 quad_perm:[1,0,3,2] row_mask:0xf bank_mask:0xf
    v_add_f32_dpp v21, v21, v21 quad_perm:[1,0,3,2] row_mask:0xf bank_mask:0xf
    v_dot2c_f32_bf16 v8, v82, v6
    v_dot2c_f32_bf16 v9, v86, v6
    v_dot2c_f32_bf16 v10, v90, v6
    v_dot2c_f32_bf16 v11, v94, v6
    v_add_f32_dpp v20, v20, v20 quad_perm:[2,3,0,1] row_mask:0xf bank_mask:0xf
    v_add_f32_dpp v21, v21, v21 quad_perm:[2,3,0,1] row_mask:0xf bank_mask:0xf
    v_dot2c_f32_bf16 v8, v83, v7
    v_dot2c_f32_bf16 v9, v87, v7
    v_dot2c_f32_bf16 v10, v91, v7
    v_dot2c_f32_bf16 v11, v95, v7
    v_add_f32_dpp v22, v8, v8 row_ror:8 row_mask:0xf bank_mask:0x3
    v_add_f32_dpp v22, v9, v9 row_ror:8 row_mask:0xf bank_mask:0xc
    v_add_f32_dpp v23, v10, v10 row_ror:8 row_mask:0xf bank_mask:0x3
    v_add_f32_dpp v23, v11, v11 row_ror:8 row_mask:0xf bank_mask:0xc
    v_dot2_f32_bf16 v8, v96, v4, 0
    v_dot2_f32_bf16 v9, v100, v4, 0
    v_dot2_f32_bf16 v10, v104, v4, 0
    v_dot2_f32_bf16 v11, v108, v4, 0
    v_add_f32_dpp v22, v22, v22 row_half_mirror row_mask:0xf bank_mask:0xf
    v_add_f32_dpp v23, v23, v23 row_half_mirror row_mask:0xf bank_mask:0xf
    v_dot2c_f32_bf16 v8, v97, v5
    v_dot2c_f32_bf16 v9, v101, v5
    v_dot2c_f32_bf16 v10, v105, v5
    v_dot2c_f32_bf16 v11, v109, v5
    v_add_f32_dpp v22, v22, v22 quad_perm:[1,0,3,2] row_mask:0xf bank_mask:0xf
    v_add_f32_dpp v23, v23, v23 quad_perm:[1,0,3,2] row_mask:0xf bank_mask:0xf
    v_dot2c_f32_bf16 v8, v98, v6
    v_dot2c_f32_bf16 v9, v102, v6
    v_dot2c_f32_bf16 v10, v106, v6
    v_dot2c_f32_bf16 v11, v110, v6
    v_add_f32_dpp v22, v22, v22 quad_perm:[2,3,0,1] row_mask:0xf bank_mask:0xf
    v_add_f32_dpp v23, v23, v23 quad_perm:[2,3,0,1] row_mask:0xf bank_mask:0xf
    v_dot2c_f32_bf16 v8, v99, v7
    v_dot2c_f32_bf16 v9, v103, v7
    s_waitcnt vmcnt(2)
    s_mov_b32 s49, 172032
    buffer_load_dwordx4 v[32:35], v1, s[40:43], s49 offen offset:0 nt
    v_dot2c_f32_bf16 v10, v107, v7
    v_dot2c_f32_bf16 v11, v111, v7
    v_add_f32_dpp v24, v8, v8 row_ror:8 row_mask:0xf bank_mask:0x3
    v_add_f32_dpp v24, v9, v9 row_ror:8 row_mask:0xf bank_mask:0xc
    v_add_f32_dpp v25, v10, v10 row_ror:8 row_mask:0xf bank_mask:0x3
    v_add_f32_dpp v25, v11, v11 row_ror:8 row_mask:0xf bank_mask:0xc
    v_dot2_f32_bf16 v8, v112, v4, 0
    v_dot2_f32_bf16 v9, v116, v4, 0
    v_dot2_f32_bf16 v10, v120, v4, 0
    v_dot2_f32_bf16 v11, v124, v4, 0
    v_add_f32_dpp v24, v24, v24 row_half_mirror row_mask:0xf bank_mask:0xf
    v_add_f32_dpp v25, v25, v25 row_half_mirror row_mask:0xf bank_mask:0xf
    v_dot2c_f32_bf16 v8, v113, v5
    v_dot2c_f32_bf16 v9, v117, v5
    v_dot2c_f32_bf16 v10, v121, v5
    v_dot2c_f32_bf16 v11, v125, v5
    v_add_f32_dpp v24, v24, v24 quad_perm:[1,0,3,2] row_mask:0xf bank_mask:0xf
    v_add_f32_dpp v25, v25, v25 quad_perm:[1,0,3,2] row_mask:0xf bank_mask:0xf
    v_dot2c_f32_bf16 v8, v114, v6
    v_dot2c_f32_bf16 v9, v118, v6
    v_dot2c_f32_bf16 v10, v122, v6
    v_dot2c_f32_bf16 v11, v126, v6
    v_add_f32_dpp v24, v24, v24 quad_perm:[2,3,0,1] row_mask:0xf bank_mask:0xf
    v_add_f32_dpp v25, v25, v25 quad_perm:[2,3,0,1] row_mask:0xf bank_mask:0xf
    v_dot2c_f32_bf16 v8, v115, v7
    v_dot2c_f32_bf16 v9, v119, v7
    v_dot2c_f32_bf16 v10, v123, v7
    v_dot2c_f32_bf16 v11, v127, v7
    v_add_f32_dpp v26, v8, v8 row_ror:8 row_mask:0xf bank_mask:0x3
    v_add_f32_dpp v26, v9, v9 row_ror:8 row_mask:0xf bank_mask:0xc
    v_add_f32_dpp v27, v10, v10 row_ror:8 row_mask:0xf bank_mask:0x3
    v_add_f32_dpp v27, v11, v11 row_ror:8 row_mask:0xf bank_mask:0xc
    v_dot2_f32_bf16 v8, v128, v4, 0
    v_dot2_f32_bf16 v9, v132, v4, 0
    v_dot2_f32_bf16 v10, v136, v4, 0
    v_dot2_f32_bf16 v11, v140, v4, 0
    s_waitcnt vmcnt(2)
    buffer_load_dwordx4 v[36:39], v1, s[40:43], s49 offen offset:1024 nt
    v_add_f32_dpp v26, v26, v26 row_half_mirror row_mask:0xf bank_mask:0xf
    v_add_f32_dpp v27, v27, v27 row_half_mirror row_mask:0xf bank_mask:0xf
    v_dot2c_f32_bf16 v8, v129, v5
    v_dot2c_f32_bf16 v9, v133, v5
    v_dot2c_f32_bf16 v10, v137, v5
    v_dot2c_f32_bf16 v11, v141, v5
    v_add_f32_dpp v26, v26, v26 quad_perm:[1,0,3,2] row_mask:0xf bank_mask:0xf
    v_add_f32_dpp v27, v27, v27 quad_perm:[1,0,3,2] row_mask:0xf bank_mask:0xf
    v_dot2c_f32_bf16 v8, v130, v6
    v_dot2c_f32_bf16 v9, v134, v6
    v_dot2c_f32_bf16 v10, v138, v6
    v_dot2c_f32_bf16 v11, v142, v6
    v_add_f32_dpp v26, v26, v26 quad_perm:[2,3,0,1] row_mask:0xf bank_mask:0xf
    v_add_f32_dpp v27, v27, v27 quad_perm:[2,3,0,1] row_mask:0xf bank_mask:0xf
    v_dot2c_f32_bf16 v8, v131, v7
    v_dot2c_f32_bf16 v9, v135, v7
    v_dot2c_f32_bf16 v10, v139, v7
    v_dot2c_f32_bf16 v11, v143, v7
    v_add_f32_dpp v28, v8, v8 row_ror:8 row_mask:0xf bank_mask:0x3
    v_add_f32_dpp v28, v9, v9 row_ror:8 row_mask:0xf bank_mask:0xc
    v_add_f32_dpp v29, v10, v10 row_ror:8 row_mask:0xf bank_mask:0x3
    v_add_f32_dpp v29, v11, v11 row_ror:8 row_mask:0xf bank_mask:0xc
    v_dot2_f32_bf16 v8, v144, v4, 0
    v_dot2_f32_bf16 v9, v148, v4, 0
    v_dot2_f32_bf16 v10, v152, v4, 0
    v_dot2_f32_bf16 v11, v156, v4, 0
    v_add_f32_dpp v28, v28, v28 row_half_mirror row_mask:0xf bank_mask:0xf
    v_add_f32_dpp v29, v29, v29 row_half_mirror row_mask:0xf bank_mask:0xf
    v_dot2c_f32_bf16 v8, v145, v5
    v_dot2c_f32_bf16 v9, v149, v5
    v_dot2c_f32_bf16 v10, v153, v5
    v_dot2c_f32_bf16 v11, v157, v5
    v_add_f32_dpp v28, v28, v28 quad_perm:[1,0,3,2] row_mask:0xf bank_mask:0xf
    v_add_f32_dpp v29, v29, v29 quad_perm:[1,0,3,2] row_mask:0xf bank_mask:0xf
    v_dot2c_f32_bf16 v8, v146, v6
    v_dot2c_f32_bf16 v9, v150, v6
    s_waitcnt vmcnt(2)
    buffer_load_dwordx4 v[40:43], v1, s[40:43], s49 offen offset:2048 nt
    v_dot2c_f32_bf16 v10, v154, v6
    v_dot2c_f32_bf16 v11, v158, v6
    v_add_f32_dpp v28, v28, v28 quad_perm:[2,3,0,1] row_mask:0xf bank_mask:0xf
    v_add_f32_dpp v29, v29, v29 quad_perm:[2,3,0,1] row_mask:0xf bank_mask:0xf
    v_dot2c_f32_bf16 v8, v147, v7
    v_dot2c_f32_bf16 v9, v151, v7
    v_dot2c_f32_bf16 v10, v155, v7
    v_dot2c_f32_bf16 v11, v159, v7
    v_add_f32_dpp v30, v8, v8 row_ror:8 row_mask:0xf bank_mask:0x3
    v_add_f32_dpp v30, v9, v9 row_ror:8 row_mask:0xf bank_mask:0xc
    v_add_f32_dpp v31, v10, v10 row_ror:8 row_mask:0xf bank_mask:0x3
    v_add_f32_dpp v31, v11, v11 row_ror:8 row_mask:0xf bank_mask:0xc
    v_add_f32_dpp v30, v30, v30 row_half_mirror row_mask:0xf bank_mask:0xf
    s_nop 0
    v_add_f32_dpp v31, v31, v31 row_half_mirror row_mask:0xf bank_mask:0xf
    v_add_f32_dpp v30, v30, v30 quad_perm:[1,0,3,2] row_mask:0xf bank_mask:0xf
    s_nop 0
    v_add_f32_dpp v31, v31, v31 quad_perm:[1,0,3,2] row_mask:0xf bank_mask:0xf
    v_add_f32_dpp v30, v30, v30 quad_perm:[2,3,0,1] row_mask:0xf bank_mask:0xf
    s_nop 0
    v_add_f32_dpp v31, v31, v31 quad_perm:[2,3,0,1] row_mask:0xf bank_mask:0xf
    v_max3_f32 v8, v12, v13, v16
    v_max3_f32 v8, v8, v17, v18
    v_max3_f32 v8, v8, v19, v20
    v_max3_f32 v8, v8, v21, v22
    v_max3_f32 v8, v8, v23, v24
    v_max3_f32 v8, v8, v25, v26
    v_max3_f32 v8, v8, v27, v28
    v_max3_f32 v8, v8, v29, v30
    v_max_f32 v8, v8, v31
    s_mov_b32 s34, 0x3e0293ee
    s_nop 0
    v_max_f32_dpp v8, v8, v8 row_ror:8 row_mask:0xf bank_mask:0xf
    v_mov_b32 v9, v8
    s_nop 1
    v_permlane16_swap_b32 v8, v9
    v_max_f32 v8, v8, v9
    v_mov_b32 v9, v8
    s_nop 1
    v_permlane32_swap_b32 v8, v9
    v_max_f32 v8, v8, v9
    v_mul_f32 v8, s34, v8
    s_waitcnt vmcnt(2)
    buffer_load_dwordx4 v[44:47], v1, s[40:43], s49 offen offset:3072 nt
    v_fma_f32 v12, v12, s34, -v8
    v_fma_f32 v13, v13, s34, -v8
    v_fma_f32 v16, v16, s34, -v8
    v_fma_f32 v17, v17, s34, -v8
    v_fma_f32 v18, v18, s34, -v8
    v_fma_f32 v19, v19, s34, -v8
    v_fma_f32 v20, v20, s34, -v8
    v_fma_f32 v21, v21, s34, -v8
    v_fma_f32 v22, v22, s34, -v8
    v_fma_f32 v23, v23, s34, -v8
    v_fma_f32 v24, v24, s34, -v8
    v_fma_f32 v25, v25, s34, -v8
    v_fma_f32 v26, v26, s34, -v8
    v_fma_f32 v27, v27, s34, -v8
    v_fma_f32 v28, v28, s34, -v8
    v_fma_f32 v29, v29, s34, -v8
    v_fma_f32 v30, v30, s34, -v8
    v_fma_f32 v31, v31, s34, -v8
    v_exp_f32 v12, v12
    v_exp_f32 v13, v13
    v_exp_f32 v16, v16
    v_exp_f32 v17, v17
    v_exp_f32 v18, v18
    v_exp_f32 v19, v19
    v_exp_f32 v20, v20
    v_exp_f32 v21, v21
    v_exp_f32 v22, v22
    v_exp_f32 v23, v23
    v_exp_f32 v24, v24
    v_exp_f32 v25, v25
    v_exp_f32 v26, v26
    v_exp_f32 v27, v27
    v_exp_f32 v28, v28
    v_exp_f32 v29, v29
    v_exp_f32 v30, v30
    v_exp_f32 v31, v31
    s_waitcnt vmcnt(2)
    s_mov_b32 s49, 200704
    buffer_load_dwordx4 v[48:51], v1, s[40:43], s49 offen offset:0 nt
    v_add_f32 v9, v12, v13
    v_add_f32 v9, v9, v16
    v_add_f32 v9, v9, v17
    v_add_f32 v9, v9, v18
    v_add_f32 v9, v9, v19
    v_add_f32 v9, v9, v20
    v_add_f32 v9, v9, v21
    v_add_f32 v9, v9, v22
    v_add_f32 v9, v9, v23
    v_add_f32 v9, v9, v24
    v_add_f32 v9, v9, v25
    v_add_f32 v9, v9, v26
    v_add_f32 v9, v9, v27
    v_add_f32 v9, v9, v28
    v_add_f32 v9, v9, v29
    v_add_f32 v9, v9, v30
    v_add_f32 v9, v9, v31
    v_and_b32 v10, 1, v0
    v_lshlrev_b32 v10, 4, v10
    v_mov_b32 v11, 0xffff
    v_lshlrev_b32 v10, v10, v11
    v_bfe_u32 v11, v0, 1, 2
    v_cmp_eq_u32 vcc, 0, v11
    s_nop 1
    v_cndmask_b32 v144, 0, v10, vcc
    v_cmp_eq_u32 vcc, 1, v11
    s_nop 1
    v_cndmask_b32 v145, 0, v10, vcc
    v_cmp_eq_u32 vcc, 2, v11
    s_nop 1
    v_cndmask_b32 v146, 0, v10, vcc
    v_cmp_eq_u32 vcc, 3, v11
    s_nop 1
    v_cndmask_b32 v147, 0, v10, vcc
    v_add_f32_dpp v9, v9, v9 row_ror:8 row_mask:0xf bank_mask:0xf
    v_mov_b32 v10, v9
    s_nop 1
    v_permlane16_swap_b32 v9, v10
    v_add_f32 v9, v9, v10
    v_mov_b32 v10, v9
    s_nop 1
    v_permlane32_swap_b32 v9, v10
    s_waitcnt vmcnt(2)
    buffer_load_dwordx4 v[52:55], v1, s[40:43], s49 offen offset:1024 nt
    v_add_f32 v9, v9, v10
    s_lshl_b32 s34, s3, 3
    s_add_u32 s34, s34, 98552
    v_mov_b32 v10, s34
    s_mov_b64 exec, 1
    ds_write_b64 v10, v[8:9]
    s_mov_b64 exec, -1
    s_lshl_b32 s34, s3, 10
    s_add_u32 s34, s34, 98304
    v_lshrrev_b32 v2, 4, v0
    v_and_b32 v11, 7, v0
    v_lshl_add_u32 v2, v2, 3, v11
    v_bfe_u32 v11, v0, 3, 1
    v_lshl_add_u32 v2, v11, 5, v2
    v_lshl_add_u32 v2, v2, 4, s34
    v_cvt_pk_bf16_f32 v10, v12, v12
    v_and_b32 v128, v10, v144
    v_and_b32 v129, v10, v145
    v_and_b32 v130, v10, v146
    v_and_b32 v131, v10, v147
    s_nop 1
    v_mfma_f32_16x16x32_bf16 v[148:151], v[160:163], v[128:131], 0
    v_mfma_f32_16x16x32_bf16 v[152:155], v[164:167], v[128:131], 0
    v_cvt_pk_bf16_f32 v10, v13, v13
    v_and_b32 v132, v10, v144
    v_and_b32 v133, v10, v145
    v_and_b32 v134, v10, v146
    v_and_b32 v135, v10, v147
    s_nop 1
    v_mfma_f32_16x16x32_bf16 v[148:151], v[168:171], v[132:135], v[148:151]
    v_mfma_f32_16x16x32_bf16 v[152:155], v[172:175], v[132:135], v[152:155]
    v_cvt_pk_bf16_f32 v10, v16, v16
    v_and_b32 v128, v10, v144
    v_and_b32 v129, v10, v145
    v_and_b32 v130, v10, v146
    v_and_b32 v131, v10, v147
    s_nop 1
    v_mfma_f32_16x16x32_bf16 v[148:151], v[176:179], v[128:131], v[148:151]
    v_mfma_f32_16x16x32_bf16 v[152:155], v[180:183], v[128:131], v[152:155]
    v_cvt_pk_bf16_f32 v10, v17, v17
    v_and_b32 v132, v10, v144
    buffer_load_dwordx4 v[56:59], v1, s[40:43], s49 offen offset:2048 nt
    v_and_b32 v133, v10, v145
    v_and_b32 v134, v10, v146
    v_and_b32 v135, v10, v147
    s_nop 1
    v_mfma_f32_16x16x32_bf16 v[148:151], v[184:187], v[132:135], v[148:151]
    v_mfma_f32_16x16x32_bf16 v[152:155], v[188:191], v[132:135], v[152:155]
    v_cvt_pk_bf16_f32 v10, v18, v18
    v_and_b32 v128, v10, v144
    v_and_b32 v129, v10, v145
    v_and_b32 v130, v10, v146
    v_and_b32 v131, v10, v147
    s_nop 1
    v_mfma_f32_16x16x32_bf16 v[148:151], v[192:195], v[128:131], v[148:151]
    v_mfma_f32_16x16x32_bf16 v[152:155], v[196:199], v[128:131], v[152:155]
    v_cvt_pk_bf16_f32 v10, v19, v19
    v_and_b32 v132, v10, v144
    v_and_b32 v133, v10, v145
    v_and_b32 v134, v10, v146
    v_and_b32 v135, v10, v147
    s_nop 1
    v_mfma_f32_16x16x32_bf16 v[148:151], v[200:203], v[132:135], v[148:151]
    v_mfma_f32_16x16x32_bf16 v[152:155], v[204:207], v[132:135], v[152:155]
    v_cvt_pk_bf16_f32 v10, v20, v20
    v_and_b32 v128, v10, v144
    v_and_b32 v129, v10, v145
    v_and_b32 v130, v10, v146
    v_and_b32 v131, v10, v147
    s_nop 1
    v_mfma_f32_16x16x32_bf16 v[148:151], v[208:211], v[128:131], v[148:151]
    v_mfma_f32_16x16x32_bf16 v[152:155], v[212:215], v[128:131], v[152:155]
    v_cvt_pk_bf16_f32 v10, v21, v21
    v_and_b32 v132, v10, v144
    v_and_b32 v133, v10, v145
    v_and_b32 v134, v10, v146
    v_and_b32 v135, v10, v147
    s_nop 1
    v_mfma_f32_16x16x32_bf16 v[148:151], v[216:219], v[132:135], v[148:151]
    v_mfma_f32_16x16x32_bf16 v[152:155], v[220:223], v[132:135], v[152:155]
    v_cvt_pk_bf16_f32 v10, v22, v22
    v_and_b32 v128, v10, v144
    v_and_b32 v129, v10, v145
    s_waitcnt vmcnt(3)
    buffer_load_dwordx4 v[60:63], v1, s[40:43], s49 offen offset:3072 nt
    v_and_b32 v130, v10, v146
    v_and_b32 v131, v10, v147
    s_nop 1
    v_mfma_f32_16x16x32_bf16 v[148:151], v[224:227], v[128:131], v[148:151]
    v_mfma_f32_16x16x32_bf16 v[152:155], v[228:231], v[128:131], v[152:155]
    v_cvt_pk_bf16_f32 v10, v23, v23
    v_and_b32 v132, v10, v144
    v_and_b32 v133, v10, v145
    v_and_b32 v134, v10, v146
    v_and_b32 v135, v10, v147
    s_nop 1
    v_mfma_f32_16x16x32_bf16 v[148:151], v[232:235], v[132:135], v[148:151]
    v_mfma_f32_16x16x32_bf16 v[152:155], v[236:239], v[132:135], v[152:155]
    v_cvt_pk_bf16_f32 v10, v24, v24
    v_and_b32 v128, v10, v144
    v_and_b32 v129, v10, v145
    v_and_b32 v130, v10, v146
    v_and_b32 v131, v10, v147
    s_nop 1
    v_mfma_f32_16x16x32_bf16 v[148:151], v[240:243], v[128:131], v[148:151]
    v_mfma_f32_16x16x32_bf16 v[152:155], v[244:247], v[128:131], v[152:155]
    v_cvt_pk_bf16_f32 v10, v25, v25
    v_and_b32 v132, v10, v144
    v_and_b32 v133, v10, v145
    v_and_b32 v134, v10, v146
    v_and_b32 v135, v10, v147
    s_nop 1
    v_mfma_f32_16x16x32_bf16 v[148:151], v[248:251], v[132:135], v[148:151]
    v_mfma_f32_16x16x32_bf16 v[152:155], v[252:255], v[132:135], v[152:155]
    v_cvt_pk_bf16_f32 v10, v26, v26
    v_and_b32 v128, v10, v144
    v_and_b32 v129, v10, v145
    v_and_b32 v130, v10, v146
    v_and_b32 v131, v10, v147
    s_nop 1
    v_mfma_f32_16x16x32_bf16 v[148:151], v[32:35], v[128:131], v[148:151]
    v_mfma_f32_16x16x32_bf16 v[152:155], v[36:39], v[128:131], v[152:155]
    v_cvt_pk_bf16_f32 v10, v27, v27
    v_and_b32 v132, v10, v144
    v_and_b32 v133, v10, v145
    v_and_b32 v134, v10, v146
    s_waitcnt vmcnt(3)
    s_mov_b32 s49, 229376
    buffer_load_dwordx4 v[64:67], v1, s[40:43], s49 offen offset:0 nt
    v_and_b32 v135, v10, v147
    s_nop 1
    v_mfma_f32_16x16x32_bf16 v[148:151], v[40:43], v[132:135], v[148:151]
    v_mfma_f32_16x16x32_bf16 v[152:155], v[44:47], v[132:135], v[152:155]
    v_cvt_pk_bf16_f32 v10, v28, v28
    v_and_b32 v128, v10, v144
    v_and_b32 v129, v10, v145
    v_and_b32 v130, v10, v146
    v_and_b32 v131, v10, v147
    s_waitcnt vmcnt(3)
    buffer_load_dwordx4 v[68:71], v1, s[40:43], s49 offen offset:1024 nt
    buffer_load_dwordx4 v[72:75], v1, s[40:43], s49 offen offset:2048 nt
    buffer_load_dwordx4 v[76:79], v1, s[40:43], s49 offen offset:3072 nt
    s_barrier
    v_and_b32 v200, 3, v0
    v_bfe_u32 v201, v0, 2, 2
    v_lshrrev_b32 v202, 4, v0
    s_lshl_b32 s34, s3, 10
    s_add_u32 s34, s34, 122112
    v_mul_u32_u24 v203, 320, v201
    v_min_u32 v203, 704, v203
    v_lshl_add_u32 v203, v202, 6, v203
    v_lshl_add_u32 v203, v200, 4, v203
    v_add_u32 v203, s34, v203
    s_movk_i32 s48, 16384
    s_cmp_eq_u32 s63, 0
    s_cbranch_scc1 L_tp_wo
    s_cmp_eq_u32 s63, 1
    s_cbranch_scc1 L_tp_w1
    v_bfe_u32 v205, v0, 3, 2
    v_lshlrev_b32 v204, 3, v205
    v_lshrrev_b32 v205, 5, v0
    v_lshl_add_u32 v204, v205, 2, v204
    v_bfe_u32 v205, v0, 1, 2
    v_add_u32 v204, v204, v205
    v_and_b32 v205, 1, v0
    s_sub_u32 s49, s3, 1
    v_mul_u32_u24 v204, 1280, v204
    v_lshl_add_u32 v204, v205, 4, v204
    s_lshl_b32 s34, s62, 5
    s_mul_i32 s35, s49, 327680
    s_add_u32 s34, s34, s35
    v_add_u32 v204, s34, v204
    s_lshl_b32 s50, s49, 13
    s_add_u32 s50, s50, 40960
    v_lshl_add_u32 v205, v0, 3, s50
    s_lshl_b32 s34, s49, 8
    s_add_u32 s34, s34, s99
    s_add_u32 s34, s34, 791552
    s_cmp_eq_u32 s49, 6
    s_cselect_b32 s35, 1, 3
    v_lshlrev_b32 v6, 6, v202
    v_lshl_add_u32 v6, v200, 4, v6
    v_add_u32 v6, s34, v6
    v_lshl_add_u32 v4, v201, 15, v6
    v_min_u32 v5, s35, v201
    v_lshl_add_u32 v5, v5, 15, v6
    v_mov_b32 v7, 99084
    s_lshl_b32 s40, s62, 1
    s_add_u32 s41, s40, 8
    s_add_u32 s42, s40, 2
    s_branch L_tp_e
L_tp_w1:
    v_and_b32 v205, 15, v0
    v_lshlrev_b32 v205, 4, v205
    s_and_b32 s49, s3, 3
    s_mul_i32 s34, s49, 1280
    s_add_u32 s34, s34, s99
    s_add_u32 s34, s34, 786432
    v_lshl_add_u32 v206, v202, 15, v205
    v_add_u32 v206, s34, v206
    s_mul_i32 s34, s49, 3840
    v_add_u32 v205, s34, v205
    s_branch L_tp_e
L_tp_wo:
    s_lshr_b32 s49, s3, 1
    s_lshl_b32 s49, s49, 15
    v_and_b32 v210, 7, v0
    s_mul_i32 s34, s60, 4096
    s_add_u32 s34, s34, s49
    s_add_u32 s34, s34, 1179904
    v_lshrrev_b32 v211, 3, v0
    v_mul_u32_u24 v205, 512, v211
    v_add_u32 v204, s34, v205
    s_lshl_b32 s35, s51, 7
    s_add_u32 s34, s34, s35
    s_sub_u32 s34, s34, 256
    v_lshl_add_u32 v205, v210, 4, v205
    v_add_u32 v205, s34, v205
    s_lshl_b32 s34, s3, 12
    s_add_u32 s34, s34, 40960
    v_lshrrev_b32 v206, 2, v0
    v_lshlrev_b32 v206, 6, v206
    v_lshl_add_u32 v206, v200, 3, v206
    v_add_u32 v206, s34, v206
    s_mul_i32 s34, s3, 1152
    s_add_u32 s34, s34, 107520
    v_mul_u32_u24 v207, 144, v211
    v_lshl_add_u32 v207, v210, 4, v207
    v_add_u32 v207, s34, v207
    v_mul_u32_u24 v208, 144, v210
    v_lshl_add_u32 v208, v202, 4, v208
    v_add_u32 v208, s34, v208
    v_mul_u32_u24 v212, 144, v211
    v_add_u32 v212, s34, v212
    v_mul_u32_u24 v213, 144, v210
    v_add_u32 v213, s34, v213
    v_and_b32 v211, 1, v211
    v_bfe_u32 v203, v0, 1, 2
    v_mul_u32_u24 v203, 144, v203
    v_and_b32 v214, 1, v0
    v_mul_u32_u24 v214, 576, v214
    v_lshl_add_u32 v214, v211, 6, v214
    v_lshl_add_u32 v214, v202, 4, v214
    s_add_u32 s34, s34, 14592
    v_add3_u32 v203, v203, v214, s34
    v_mov_b32 v210, 98816
    v_cmp_eq_u32 vcc, 0, v211
    s_nop 1
    v_cndmask_b32 v209, v208, v210, vcc
    v_cndmask_b32 v208, v210, v208, vcc
L_tp_e:
    v_mfma_f32_16x16x32_bf16 v[148:151], v[48:51], v[128:131], v[148:151]
    v_mfma_f32_16x16x32_bf16 v[152:155], v[52:55], v[128:131], v[152:155]
    v_cvt_pk_bf16_f32 v10, v29, v29
    v_and_b32 v132, v10, v144
    v_and_b32 v133, v10, v145
    v_and_b32 v134, v10, v146
    v_and_b32 v135, v10, v147
    s_waitcnt vmcnt(4)
    s_nop 0
    v_mfma_f32_16x16x32_bf16 v[148:151], v[56:59], v[132:135], v[148:151]
    v_mfma_f32_16x16x32_bf16 v[152:155], v[60:63], v[132:135], v[152:155]
    v_cvt_pk_bf16_f32 v10, v30, v30
    v_and_b32 v128, v10, v144
    v_and_b32 v129, v10, v145
    v_and_b32 v130, v10, v146
    v_and_b32 v131, v10, v147
    s_waitcnt vmcnt(2)
    s_nop 0
    v_mfma_f32_16x16x32_bf16 v[148:151], v[64:67], v[128:131], v[148:151]
    v_mfma_f32_16x16x32_bf16 v[152:155], v[68:71], v[128:131], v[152:155]
    v_cvt_pk_bf16_f32 v10, v31, v31
    v_and_b32 v132, v10, v144
    v_and_b32 v133, v10, v145
    v_and_b32 v134, v10, v146
    v_and_b32 v135, v10, v147
    s_waitcnt vmcnt(0)
    s_nop 0
    v_mfma_f32_16x16x32_bf16 v[148:151], v[72:75], v[132:135], v[148:151]
    v_mfma_f32_16x16x32_bf16 v[152:155], v[76:79], v[132:135], v[152:155]
    s_nop 7
    v_add_f32_dpp v148, v152, v148 row_ror:8 row_mask:0xf bank_mask:0xf
    v_add_f32_dpp v149, v153, v149 row_ror:8 row_mask:0xf bank_mask:0xf
    v_add_f32_dpp v150, v154, v150 row_ror:8 row_mask:0xf bank_mask:0xf
    v_add_f32_dpp v151, v155, v151 row_ror:8 row_mask:0xf bank_mask:0xf
    ds_write_b128 v2, v[148:151]
    s_waitcnt lgkmcnt(0)
    s_barrier
    s_cmp_eq_u32 s63, 0
    s_cbranch_scc1 L_t_wo
    s_cmp_eq_u32 s63, 2
    s_cbranch_scc1 L_t_w2
    s_cmp_eq_u32 s63, 3
    s_cbranch_scc1 L_fin
    s_barrier
L_r_w1:
    s_cmp_lt_u32 s3, 4
    s_cbranch_scc1 L_w1_ln
    s_and_b32 s49, s3, 3
    s_lshl_b32 s42, s49, 11
    s_add_u32 s42, s42, 40960
    s_bitcmp1_b32 s62, 0
    s_cbranch_scc1 L_rot1
    s_add_u32 m0, s42, 0
    s_add_u32 s34, s50, 0
    buffer_load_dwordx4 v15, s[52:55], s34 offen  lds
    s_add_u32 m0, s42, 1024
    s_add_u32 s34, s50, 884736
    buffer_load_dwordx4 v15, s[52:55], s34 offen  lds
    s_add_u32 m0, s42, 8192
    s_add_u32 s34, s50, 110592
    buffer_load_dwordx4 v15, s[52:55], s34 offen  lds
    s_add_u32 m0, s42, 9216
    s_add_u32 s34, s50, 995328
    buffer_load_dwordx4 v15, s[52:55], s34 offen  lds
    s_add_u32 m0, s42, 32768
    s_add_u32 s34, s51, 0
    buffer_load_dwordx4 v15, s[52:55], s34 offen  lds
    s_add_u32 m0, s42, 33792
    s_add_u32 s34, s51, 13824
    buffer_load_dwordx4 v15, s[52:55], s34 offen  lds
    s_add_u32 m0, s42, 16384
    s_add_u32 s34, s50, 221184
    buffer_load_dwordx4 v15, s[52:55], s34 offen  lds
    s_add_u32 m0, s42, 17408
    s_add_u32 s34, s50, 1105920
    buffer_load_dwordx4 v15, s[52:55], s34 offen  lds
    s_add_u32 m0, s42, 24576
    s_add_u32 s34, s50, 331776
    buffer_load_dwordx4 v15, s[52:55], s34 offen  lds
    s_add_u32 m0, s42, 25600
    s_add_u32 s34, s50, 1216512
    buffer_load_dwordx4 v15, s[52:55], s34 offen  lds
    s_branch L_rot2
L_rot1:
    s_add_u32 m0, s42, 16384
    s_add_u32 s34, s50, 221184
    buffer_load_dwordx4 v15, s[52:55], s34 offen  lds
    s_add_u32 m0, s42, 17408
    s_add_u32 s34, s50, 1105920
    buffer_load_dwordx4 v15, s[52:55], s34 offen  lds
    s_add_u32 m0, s42, 24576
    s_add_u32 s34, s50, 331776
    buffer_load_dwordx4 v15, s[52:55], s34 offen  lds
    s_add_u32 m0, s42, 25600
    s_add_u32 s34, s50, 1216512
    buffer_load_dwordx4 v15, s[52:55], s34 offen  lds
    s_add_u32 m0, s42, 32768
    s_add_u32 s34, s51, 0
    buffer_load_dwordx4 v15, s[52:55], s34 offen  lds
    s_add_u32 m0, s42, 33792
    s_add_u32 s34, s51, 13824
    buffer_load_dwordx4 v15, s[52:55], s34 offen  lds
    s_add_u32 m0, s42, 0
    s_add_u32 s34, s50, 0
    buffer_load_dwordx4 v15, s[52:55], s34 offen  lds
    s_add_u32 m0, s42, 1024
    s_add_u32 s34, s50, 884736
    buffer_load_dwordx4 v15, s[52:55], s34 offen  lds
    s_add_u32 m0, s42, 8192
    s_add_u32 s34, s50, 110592
    buffer_load_dwordx4 v15, s[52:55], s34 offen  lds
    s_add_u32 m0, s42, 9216
    s_add_u32 s34, s50, 995328
    buffer_load_dwordx4 v15, s[52:55], s34 offen  lds
L_rot2:
    v_lshrrev_b32 v3, 2, v0
    v_lshlrev_b32 v3, 6, v3
    v_lshl_add_u32 v3, v200, 3, v3
    v_add_u32 v3, s42, v3
    s_lshl_b32 s35, s49, 6
    s_add_u32 s35, s35, 116736
    v_mul_u32_u24 v4, 1344, v200
    v_lshl_add_u32 v4, v202, 4, v4
    v_add_u32 v4, s35, v4
    s_lshl_b32 s35, s49, 10
    s_sub_u32 s35, s35, 4096
    v_add_u32 v5, s35, v203
    v_and_b32 v6, 1, v201
    v_mul_u32_u24 v6, 5376, v6
    v_add_u32 v6, v6, v4
    v_subrev_u32 v6, 90112, v6
    v_subrev_u32 v7, 22784, v5
    s_waitcnt vmcnt(0)
    s_barrier
    ds_read_b64_tr_b16 v[32:33], v3 offset:0
    ds_read_b64_tr_b16 v[34:35], v3 offset:1024
    ds_read_b64_tr_b16 v[36:37], v3 offset:32
    ds_read_b64_tr_b16 v[38:39], v3 offset:1056
    ds_read_b64_tr_b16 v[40:41], v3 offset:8192
    ds_read_b64_tr_b16 v[42:43], v3 offset:9216
    ds_read_b64_tr_b16 v[44:45], v3 offset:8224
    ds_read_b64_tr_b16 v[46:47], v3 offset:9248
    ds_read_b64_tr_b16 v[48:49], v3 offset:16384
    ds_read_b64_tr_b16 v[50:51], v3 offset:17408
    ds_read_b64_tr_b16 v[52:53], v3 offset:16416
    ds_read_b64_tr_b16 v[54:55], v3 offset:17440
    s_waitcnt lgkmcnt(4)
    ds_read_b64_tr_b16 v[56:57], v3 offset:24576
    ds_read_b64_tr_b16 v[58:59], v3 offset:25600
    ds_read_b64_tr_b16 v[60:61], v3 offset:24608
    ds_read_b64_tr_b16 v[62:63], v3 offset:25632
    ds_read_b64_tr_b16 v[64:65], v3 offset:32768
    ds_read_b64_tr_b16 v[66:67], v3 offset:33792
    ds_read_b64_tr_b16 v[68:69], v3 offset:32800
    ds_read_b64_tr_b16 v[70:71], v3 offset:33824
    s_waitcnt lgkmcnt(0)
    ds_read_b128 v[140:143], v6 offset:0
    ds_read_b128 v[144:147], v6 offset:256
    ds_read_b128 v[148:151], v6 offset:512
    ds_read_b128 v[152:155], v6 offset:768
    ds_read_b128 v[156:159], v6 offset:1024
    s_waitcnt lgkmcnt(4)
    v_mfma_f32_16x16x32_bf16 v[20:23], v[32:35], v[140:143], 0
    v_mfma_f32_16x16x32_bf16 v[24:27], v[36:39], v[140:143], 0
    s_waitcnt lgkmcnt(3)
    v_mfma_f32_16x16x32_bf16 v[20:23], v[40:43], v[144:147], v[20:23]
    v_mfma_f32_16x16x32_bf16 v[24:27], v[44:47], v[144:147], v[24:27]
    s_waitcnt lgkmcnt(2)
    v_mfma_f32_16x16x32_bf16 v[20:23], v[48:51], v[148:151], v[20:23]
    v_mfma_f32_16x16x32_bf16 v[24:27], v[52:55], v[148:151], v[24:27]
    s_waitcnt lgkmcnt(1)
    v_mfma_f32_16x16x32_bf16 v[20:23], v[56:59], v[152:155], v[20:23]
    v_mfma_f32_16x16x32_bf16 v[24:27], v[60:63], v[152:155], v[24:27]
    s_waitcnt lgkmcnt(0)
    v_mfma_f32_16x16x32_bf16 v[20:23], v[64:67], v[156:159], v[20:23]
    v_mfma_f32_16x16x32_bf16 v[24:27], v[68:71], v[156:159], v[24:27]
    s_nop 6
    ds_write_b128 v7, v[20:23]
    ds_write_b128 v7, v[24:27] offset:1024
    s_waitcnt lgkmcnt(0)
    s_setprio 3
    s_barrier
    ds_read_b128 v[140:143], v4 offset:0
    ds_read_b128 v[144:147], v4 offset:256
    ds_read_b128 v[148:151], v4 offset:512
    ds_read_b128 v[152:155], v4 offset:768
    ds_read_b128 v[156:159], v4 offset:1024
    s_waitcnt lgkmcnt(4)
    v_mfma_f32_16x16x32_bf16 v[20:23], v[32:35], v[140:143], 0
    v_mfma_f32_16x16x32_bf16 v[24:27], v[36:39], v[140:143], 0
    s_waitcnt lgkmcnt(3)
    v_mfma_f32_16x16x32_bf16 v[20:23], v[40:43], v[144:147], v[20:23]
    v_mfma_f32_16x16x32_bf16 v[24:27], v[44:47], v[144:147], v[24:27]
    s_waitcnt lgkmcnt(2)
    v_mfma_f32_16x16x32_bf16 v[20:23], v[48:51], v[148:151], v[20:23]
    v_mfma_f32_16x16x32_bf16 v[24:27], v[52:55], v[148:151], v[24:27]
    s_waitcnt lgkmcnt(1)
    v_mfma_f32_16x16x32_bf16 v[20:23], v[56:59], v[152:155], v[20:23]
    v_mfma_f32_16x16x32_bf16 v[24:27], v[60:63], v[152:155], v[24:27]
    s_waitcnt lgkmcnt(0)
    v_mfma_f32_16x16x32_bf16 v[20:23], v[64:67], v[156:159], v[20:23]
    v_mfma_f32_16x16x32_bf16 v[24:27], v[68:71], v[156:159], v[24:27]
    s_nop 6
    ds_write_b128 v5, v[20:23]
    ds_write_b128 v5, v[24:27] offset:1024
    s_waitcnt lgkmcnt(0)
    s_barrier
    s_branch L_fin
L_w1_ln:
    s_setprio 1
    ds_read_b128 v[140:143], v205 offset:0
    ds_read_b128 v[144:147], v205 offset:256
    ds_read_b128 v[148:151], v205 offset:512
    ds_read_b128 v[152:155], v205 offset:768
    ds_read_b128 v[156:159], v205 offset:1024
    ds_read_b128 v[160:163], v205 offset:1280
    ds_read_b128 v[164:167], v205 offset:1536
    ds_read_b128 v[168:171], v205 offset:1792
    ds_read_b128 v[172:175], v205 offset:2048
    ds_read_b128 v[176:179], v205 offset:2304
    ds_read_b128 v[180:183], v205 offset:2560
    ds_read_b128 v[184:187], v205 offset:2816
    ds_read_b128 v[188:191], v205 offset:3072
    ds_read_b128 v[192:195], v205 offset:3328
    ds_read_b128 v[196:199], v205 offset:3584
    v_and_b32 v8, 1, v0
    v_lshlrev_b32 v8, 4, v8
    v_mov_b32 v9, 0xffff
    v_lshlrev_b32 v8, v8, v9
    v_bfe_u32 v9, v0, 1, 2
    v_cmp_eq_u32 vcc, 0, v9
    s_nop 1
    v_cndmask_b32 v16, 0, v8, vcc
    v_cmp_eq_u32 vcc, 1, v9
    s_nop 1
    v_cndmask_b32 v17, 0, v8, vcc
    v_cmp_eq_u32 vcc, 2, v9
    s_nop 1
    v_cndmask_b32 v18, 0, v8, vcc
    v_cmp_eq_u32 vcc, 3, v9
    s_nop 1
    v_cndmask_b32 v19, 0, v8, vcc
    v_bfe_u32 v8, v0, 3, 1
    v_cmp_eq_u32 vcc, 0, v8
    s_nop 1
    v_cndmask_b32 v20, 0, v16, vcc
    v_xor_b32 v24, v20, v16
    v_cndmask_b32 v21, 0, v17, vcc
    v_xor_b32 v25, v21, v17
    v_cndmask_b32 v22, 0, v18, vcc
    v_xor_b32 v26, v22, v18
    v_cndmask_b32 v23, 0, v19, vcc
    v_xor_b32 v27, v23, v19
    v_and_b32 v52, 0x3f803f80, v20
    v_and_b32 v60, 0x3e803e80, v20
    v_and_b32 v53, 0x3f803f80, v21
    v_and_b32 v61, 0x3e803e80, v21
    v_and_b32 v54, 0x3f803f80, v22
    v_and_b32 v62, 0x3e803e80, v22
    v_and_b32 v55, 0x3f803f80, v23
    v_and_b32 v63, 0x3e803e80, v23
    v_and_b32 v56, 0x3f803f80, v24
    v_and_b32 v64, 0x3e803e80, v24
    v_and_b32 v57, 0x3f803f80, v25
    v_and_b32 v65, 0x3e803e80, v25
    v_and_b32 v58, 0x3f803f80, v26
    v_and_b32 v66, 0x3e803e80, v26
    v_and_b32 v59, 0x3f803f80, v27
    v_and_b32 v67, 0x3e803e80, v27
    s_waitcnt lgkmcnt(0)
    v_mfma_f32_16x16x32_bf16 v[68:71], v[140:143], v[60:63], 0
    v_mfma_f32_16x16x32_bf16 v[68:71], v[144:147], v[64:67], v[68:71]
    v_mfma_f32_16x16x32_bf16 v[72:75], v[148:151], v[60:63], 0
    v_mfma_f32_16x16x32_bf16 v[72:75], v[152:155], v[64:67], v[72:75]
    v_mfma_f32_16x16x32_bf16 v[76:79], v[156:159], v[60:63], 0
    v_mfma_f32_16x16x32_bf16 v[116:119], v[160:163], v[60:63], 0
    v_mfma_f32_16x16x32_bf16 v[116:119], v[164:167], v[64:67], v[116:119]
    v_mfma_f32_16x16x32_bf16 v[120:123], v[168:171], v[60:63], 0
    v_mfma_f32_16x16x32_bf16 v[120:123], v[172:175], v[64:67], v[120:123]
    v_mfma_f32_16x16x32_bf16 v[124:127], v[176:179], v[60:63], 0
    v_mfma_f32_16x16x32_bf16 v[80:83], v[180:183], v[60:63], 1.0
    v_mfma_f32_16x16x32_bf16 v[80:83], v[184:187], v[64:67], v[80:83]
    v_mfma_f32_16x16x32_bf16 v[84:87], v[188:191], v[60:63], 1.0
    v_mfma_f32_16x16x32_bf16 v[84:87], v[192:195], v[64:67], v[84:87]
    v_mfma_f32_16x16x32_bf16 v[88:91], v[196:199], v[60:63], 1.0
    s_mul_i32 s34, s3, 1344
    s_add_u32 s34, s34, 116736
    v_lshl_add_u32 v7, v0, 4, s34
    v_lshlrev_b32 v8, 6, v202
    v_lshl_add_u32 v8, v200, 4, v8
    v_and_b32 v9, 1, v201
    v_lshl_add_u32 v8, v9, 3, v8
    v_add_u32 v8, s34, v8
    v_bfe_u32 v9, v0, 3, 1
    v_mul_u32_u24 v9, 6144, v9
    v_sub_u32 v8, v8, v9
    v_lshrrev_b32 v9, 5, v0
    v_lshlrev_b32 v9, 10, v9
    v_and_b32 v6, 1, v202
    v_lshl_add_u32 v9, v6, 7, v9
    v_bfe_u32 v6, v0, 1, 1
    v_lshl_add_u32 v9, v6, 6, v9
    v_lshl_add_u32 v9, v201, 4, v9
    v_and_b32 v6, 1, v0
    v_lshl_add_u32 v9, v6, 3, v9
    v_add_u32 v9, 122112, v9
    s_lshr_b32 s34, s62, 3
    s_lshl_b32 s34, s34, 8
    s_and_b32 s49, s62, 3
    s_lshl_b32 s49, s49, 15
    s_add_u32 s34, s34, s49
    s_bfe_u32 s49, s62, 0x10002
    s_lshl_b32 s49, s49, 14
    s_add_u32 s34, s34, s49
    s_add_u32 s34, s34, 791552
    v_lshl_add_u32 v5, v0, 2, s34
    s_bfe_u32 s49, s60, 0x10002
    s_lshl_b32 s49, s49, 13
    s_xor_b32 s53, s99, s49
    s_xor_b32 s52, s53, 8192
    v_subrev_u32 v10, 90112, v7
    v_subrev_u32 v11, 90112, v8
    v_cvt_pk_bf16_f32 v32, v116, v117
    v_cvt_pk_bf16_f32 v33, v118, v119
    v_cvt_pk_bf16_f32 v34, v120, v121
    v_cvt_pk_bf16_f32 v35, v122, v123
    v_cvt_pk_bf16_f32 v36, v124, v125
    v_cvt_pk_bf16_f32 v37, v126, v127
    s_mov_b32 exec_lo, 0x00ff00ff
    s_mov_b32 exec_hi, 0x00ff00ff
    ds_write_b64 v11, v[36:37] offset:6400
    s_mov_b64 exec, -1
    ds_write_b128 v10, v[32:35] offset:5376
    v_cvt_pk_bf16_f32 v20, v80, v81
    v_cvt_pk_bf16_f32 v21, v82, v83
    v_cvt_pk_bf16_f32 v22, v84, v85
    v_cvt_pk_bf16_f32 v23, v86, v87
    v_cvt_pk_bf16_f32 v24, v88, v89
    v_cvt_pk_bf16_f32 v25, v90, v91
    ds_write_b128 v10, v[20:23]
    ds_write_b64 v11, v[24:25] offset:1024
    v_lshlrev_b32 v80, 16, v20
    v_and_b32 v81, 0xffff0000, v20
    v_lshlrev_b32 v82, 16, v21
    v_and_b32 v83, 0xffff0000, v21
    v_lshlrev_b32 v84, 16, v22
    v_and_b32 v85, 0xffff0000, v22
    v_lshlrev_b32 v86, 16, v23
    v_and_b32 v87, 0xffff0000, v23
    v_lshlrev_b32 v88, 16, v24
    v_and_b32 v89, 0xffff0000, v24
    v_lshlrev_b32 v90, 16, v25
    v_and_b32 v91, 0xffff0000, v25
    v_subrev_u32 v11, 22784, v9
    s_lshl_b32 s34, s3, 3
    s_add_u32 s34, s34, 99136
    v_mov_b32 v12, s34
    v_lshlrev_b32 v13, 3, v201
    v_add_u32 v13, 99136, v13
    s_mov_b32 s54, 0
    s_brev_b32 s55, 1
    s_waitcnt lgkmcnt(0)
    s_barrier
    s_mov_b32 s35, 0
    s_mov_b64 s[40:41], -1
    s_mov_b64 s[42:43], -1
L_pb:
    s_mov_b64 exec, s[40:41]
    s_cbranch_execz L_pbs0
    buffer_load_dwordx4 v[140:143], v206, s[44:47], 0 offen offset:0 sc1
    buffer_load_dwordx4 v[148:151], v206, s[44:47], 0 offen offset:256 sc1
    buffer_load_dwordx4 v[156:159], v206, s[44:47], 0 offen offset:512 sc1
    buffer_load_dwordx4 v[164:167], v206, s[44:47], 0 offen offset:768 sc1
    buffer_load_dwordx4 v[172:175], v206, s[44:47], 0 offen offset:1024 sc1
L_pbs0:
    s_mov_b64 exec, s[42:43]
    s_cbranch_execz L_pbs1
    buffer_load_dwordx4 v[144:147], v206, s[44:47], s48 offen offset:0 sc1
    buffer_load_dwordx4 v[152:155], v206, s[44:47], s48 offen offset:256 sc1
    buffer_load_dwordx4 v[160:163], v206, s[44:47], s48 offen offset:512 sc1
    buffer_load_dwordx4 v[168:171], v206, s[44:47], s48 offen offset:768 sc1
    buffer_load_dwordx4 v[176:179], v206, s[44:47], s48 offen offset:1024 sc1
L_pbs1:
    s_mov_b64 exec, -1
    s_add_u32 s35, s35, 1
    s_waitcnt vmcnt(0)
    v_mfma_f32_16x16x32_bf16 v[128:131], v[140:143], v[52:55], v[68:71]
    v_max3_u32 v28, v140, v141, v142
    v_max3_u32 v29, v144, v145, v146
    v_mfma_f32_16x16x32_bf16 v[128:131], v[144:147], v[52:55], v[128:131]
    v_max3_u32 v28, v28, v143, v148
    v_max3_u32 v29, v29, v147, v152
    v_mfma_f32_16x16x32_bf16 v[128:131], v[148:151], v[56:59], v[128:131]
    v_max3_u32 v28, v28, v149, v150
    v_max3_u32 v29, v29, v153, v154
    v_mfma_f32_16x16x32_bf16 v[128:131], v[152:155], v[56:59], v[128:131]
    v_max3_u32 v28, v28, v151, v156
    v_max3_u32 v29, v29, v155, v160
    v_mfma_f32_16x16x32_bf16 v[132:135], v[156:159], v[52:55], v[72:75]
    v_max3_u32 v28, v28, v157, v158
    v_max3_u32 v29, v29, v161, v162
    v_mfma_f32_16x16x32_bf16 v[132:135], v[160:163], v[52:55], v[132:135]
    v_max3_u32 v28, v28, v159, v164
    v_max3_u32 v29, v29, v163, v168
    v_mfma_f32_16x16x32_bf16 v[132:135], v[164:167], v[56:59], v[132:135]
    v_max3_u32 v28, v28, v165, v166
    v_max3_u32 v29, v29, v169, v170
    v_mfma_f32_16x16x32_bf16 v[132:135], v[168:171], v[56:59], v[132:135]
    v_max3_u32 v28, v28, v167, v172
    v_max3_u32 v29, v29, v171, v176
    v_mfma_f32_16x16x32_bf16 v[136:139], v[172:175], v[52:55], v[76:79]
    v_max3_u32 v28, v28, v173, v174
    v_max3_u32 v29, v29, v177, v178
    v_mfma_f32_16x16x32_bf16 v[136:139], v[176:179], v[52:55], v[136:139]
    v_max_u32 v28, v28, v175
    v_max_u32 v29, v29, v179
    v_cmp_eq_u32 s[40:41], -1, v28
    v_cmp_eq_u32 s[42:43], -1, v29
    s_nop 0
    s_or_b64 vcc, s[40:41], s[42:43]
    s_cbranch_scc0 L_pbd
    s_cmp_lg_u32 s35, 64
    s_cbranch_scc1 L_tmo50
    s_mov_b64 exec, -1
    v_lshlrev_b32 v243, 4, v0
    v_add_u32 v243, 131328, v243
    ds_read_b96 v[240:242], v243
    s_waitcnt lgkmcnt(0)
    buffer_store_dword v240, v242, s[44:47], 0 offen sc1
    buffer_store_dword v241, v242, s[44:47], 0 offen offset:256 sc1
L_tmo50:
    s_cmp_lt_u32 s35, 60000
    s_cbranch_scc1 L_pb
L_pbd:
    v_pk_mul_f32 v[32:33], v[128:129], v[80:81]
    v_pk_mul_f32 v[34:35], v[130:131], v[82:83]
    v_pk_mul_f32 v[36:37], v[132:133], v[84:85]
    v_pk_mul_f32 v[38:39], v[134:135], v[86:87]
    v_cvt_pk_bf16_f32 v24, v32, v33
    v_cvt_pk_bf16_f32 v25, v34, v35
    v_cvt_pk_bf16_f32 v26, v36, v37
    v_cvt_pk_bf16_f32 v27, v38, v39
    ds_write_b128 v7, v[24:27]
    v_pk_mul_f32 v[40:41], v[136:137], v[88:89]
    v_pk_mul_f32 v[42:43], v[138:139], v[90:91]
    v_cvt_pk_bf16_f32 v28, v40, v41
    v_cvt_pk_bf16_f32 v29, v42, v43
    ds_write_b64 v8, v[28:29] offset:1024
    v_pk_add_f32 v[20:21], v[128:129], v[130:131]
    v_pk_mul_f32 v[22:23], v[128:129], v[128:129]
    v_pk_add_f32 v[20:21], v[20:21], v[132:133]
    v_pk_fma_f32 v[22:23], v[130:131], v[130:131], v[22:23]
    v_pk_add_f32 v[20:21], v[20:21], v[134:135]
    v_pk_fma_f32 v[22:23], v[132:133], v[132:133], v[22:23]
    v_pk_add_f32 v[20:21], v[20:21], v[136:137]
    v_pk_fma_f32 v[22:23], v[134:135], v[134:135], v[22:23]
    v_pk_add_f32 v[20:21], v[20:21], v[138:139]
    v_pk_fma_f32 v[22:23], v[136:137], v[136:137], v[22:23]
    v_pk_fma_f32 v[22:23], v[138:139], v[138:139], v[22:23]
    s_waitcnt lgkmcnt(0)
    s_barrier
    v_add_f32 v20, v20, v21
    v_add_f32 v21, v22, v23
    s_nop 0
    v_add_f32_dpp v20, v20, v20 row_ror:8 row_mask:0xf bank_mask:0xf
    v_add_f32_dpp v21, v21, v21 row_ror:8 row_mask:0xf bank_mask:0xf
    s_nop 0
    v_add_f32_dpp v20, v20, v20 row_ror:4 row_mask:0xf bank_mask:0xf
    v_add_f32_dpp v21, v21, v21 row_ror:4 row_mask:0xf bank_mask:0xf
    s_nop 0
    v_add_f32_dpp v20, v20, v20 row_ror:2 row_mask:0xf bank_mask:0xf
    v_add_f32_dpp v21, v21, v21 row_ror:2 row_mask:0xf bank_mask:0xf
    s_nop 0
    v_add_f32_dpp v20, v20, v20 row_ror:1 row_mask:0xf bank_mask:0xf
    v_add_f32_dpp v21, v21, v21 row_ror:1 row_mask:0xf bank_mask:0xf
    s_nop 0
    v_add_f32_dpp v20, v20, v20 row_bcast:15 row_mask:0xa bank_mask:0xf
    v_add_f32_dpp v21, v21, v21 row_bcast:15 row_mask:0xa bank_mask:0xf
    s_nop 0
    v_add_f32_dpp v20, v20, v20 row_bcast:31 row_mask:0xc bank_mask:0xf
    v_add_f32_dpp v21, v21, v21 row_bcast:31 row_mask:0xc bank_mask:0xf
    v_mul_f32 v22, 0x3acccccd, v20
    v_mul_f32 v21, 0x3acccccd, v21
    v_fma_f32 v21, -v22, v22, v21
    v_max_f32 v21, 0, v21
    v_add_f32 v21, 0x3727c5ac, v21
    v_rsq_f32 v20, v21
    s_nop 0
    v_mul_f32_e64 v21, -v22, v20
    s_mov_b64 exec, s[54:55]
    ds_write_b64 v12, v[20:21]
    s_mov_b64 exec, -1
    s_cmp_lg_u32 s3, 0
    s_cbranch_scc1 L_w1_x
    ds_read_b64 v[32:33], v11 offset:0
    ds_read_b64 v[40:41], v11 offset:320
    ds_read_b64 v[34:35], v11 offset:2048
    ds_read_b64 v[42:43], v11 offset:2368
    ds_read_b64 v[36:37], v11 offset:4096
    ds_read_b64 v[44:45], v11 offset:4416
    ds_read_b64 v[38:39], v11 offset:6144
    ds_read_b64 v[46:47], v11 offset:6464
    s_mov_b32 s34, 0xbdd2d3e8
    v_mov_b32 v10, 0xc0135761
    s_waitcnt lgkmcnt(8)
    s_barrier
    ds_read_b64 v[28:29], v13
    ds_read_b64 v[20:21], v9 offset:0
    ds_read_b64 v[22:23], v9 offset:2048
    ds_read_b64 v[24:25], v9 offset:4096
    ds_read_b64 v[26:27], v9 offset:6144
    s_waitcnt lgkmcnt(5)
    v_pk_add_f32 v[100:101], v[100:101], v[40:41]
    v_pk_add_f32 v[100:101], v[100:101], v[42:43]
    v_pk_add_f32 v[32:33], v[32:33], v[34:35]
    v_pk_add_f32 v[100:101], v[100:101], v[44:45]
    v_pk_add_f32 v[32:33], v[32:33], v[36:37]
    v_pk_add_f32 v[100:101], v[100:101], v[46:47]
    v_pk_add_f32 v[32:33], v[32:33], v[38:39]
    s_waitcnt lgkmcnt(4)
    v_pk_fma_f32 v[100:101], v[32:33], v[28:29], v[100:101] op_sel:[0,1,0] op_sel_hi:[1,1,1]
    s_waitcnt lgkmcnt(3)
    v_pk_fma_f32 v[100:101], v[20:21], v[28:29], v[100:101] op_sel_hi:[1,0,1]
    s_waitcnt lgkmcnt(2)
    v_pk_fma_f32 v[100:101], v[22:23], v[28:29], v[100:101] op_sel_hi:[1,0,1]
    s_waitcnt lgkmcnt(1)
    v_pk_fma_f32 v[100:101], v[24:25], v[28:29], v[100:101] op_sel_hi:[1,0,1]
    s_waitcnt lgkmcnt(0)
    v_pk_fma_f32 v[100:101], v[26:27], v[28:29], v[100:101] op_sel_hi:[1,0,1]
    v_pk_mul_f32 v[20:21], v[100:101], v[100:101]
    v_fma_f32 v20, v20, s34, v10
    v_fma_f32 v21, v21, s34, v10
    v_pk_mul_f32 v[20:21], v[20:21], v[100:101]
    v_exp_f32 v20, v20
    v_exp_f32 v21, v21
    v_add_f32 v20, 1.0, v20
    v_add_f32 v21, 1.0, v21
    v_rcp_f32 v20, v20
    v_rcp_f32 v21, v21
    s_nop 0
    v_pk_mul_f32 v[20:21], v[20:21], v[100:101]
    v_cvt_pk_bf16_f32 v20, v20, v21
    v_min_u32 v20, -2, v20
    buffer_store_dword v20, v5, s[44:47], s52 offen sc1
    buffer_store_dword v20, v5, s[44:47], s53 offen sc1
    s_branch L_fin
L_w1_x:
    s_waitcnt lgkmcnt(0)
    s_barrier
    s_branch L_fin
L_t_w2:
    s_barrier
L_w2_dma:
    s_and_b32 s34, s40, 7
    s_lshl_b32 s35, s34, 10
    s_add_u32 m0, s50, s35
    s_mul_i32 s34, s34, 40960
    buffer_load_dwordx4 v204, s[52:55], s34 offen  lds
    s_add_u32 s40, s40, 1
    s_cmp_lg_u32 s40, s42
    s_cbranch_scc1 L_w2_nw
L_w2_nw:
    s_cmp_lt_u32 s40, s41
    s_cbranch_scc1 L_w2_dma
    ds_read_b32 v8, v7
    s_waitcnt lgkmcnt(0)
    v_cmp_eq_u32 vcc, 0, v8
    s_cbranch_vccnz L_w2_slow
    s_mov_b32 s35, 0
    buffer_load_dwordx4 v[64:67], v4, s[44:47], 0 offen sc1
    buffer_load_dwordx4 v[68:71], v5, s[44:47], s48 offen sc1
    s_waitcnt vmcnt(2)
    ds_read_b64_tr_b16 v[32:33], v205 offset:0
    ds_read_b64_tr_b16 v[34:35], v205 offset:512
    ds_read_b64_tr_b16 v[36:37], v205 offset:1024
    ds_read_b64_tr_b16 v[38:39], v205 offset:1536
    ds_read_b64_tr_b16 v[40:41], v205 offset:2048
    ds_read_b64_tr_b16 v[42:43], v205 offset:2560
    ds_read_b64_tr_b16 v[44:45], v205 offset:3072
    ds_read_b64_tr_b16 v[46:47], v205 offset:3584
    s_waitcnt lgkmcnt(0)
    ds_read_b64_tr_b16 v[48:49], v205 offset:4096
    ds_read_b64_tr_b16 v[50:51], v205 offset:4608
    ds_read_b64_tr_b16 v[52:53], v205 offset:5120
    ds_read_b64_tr_b16 v[54:55], v205 offset:5632
    ds_read_b64_tr_b16 v[56:57], v205 offset:6144
    ds_read_b64_tr_b16 v[58:59], v205 offset:6656
    ds_read_b64_tr_b16 v[60:61], v205 offset:7168
    ds_read_b64_tr_b16 v[62:63], v205 offset:7680
    s_waitcnt lgkmcnt(0)
    s_branch L_w2_mid
L_w2_slow:
    s_waitcnt vmcnt(0)
    ds_read_b64_tr_b16 v[32:33], v205 offset:0
    ds_read_b64_tr_b16 v[34:35], v205 offset:512
    ds_read_b64_tr_b16 v[36:37], v205 offset:1024
    ds_read_b64_tr_b16 v[38:39], v205 offset:1536
    ds_read_b64_tr_b16 v[40:41], v205 offset:2048
    ds_read_b64_tr_b16 v[42:43], v205 offset:2560
    ds_read_b64_tr_b16 v[44:45], v205 offset:3072
    ds_read_b64_tr_b16 v[46:47], v205 offset:3584
    s_waitcnt lgkmcnt(0)
    ds_read_b64_tr_b16 v[48:49], v205 offset:4096
    ds_read_b64_tr_b16 v[50:51], v205 offset:4608
    ds_read_b64_tr_b16 v[52:53], v205 offset:5120
    ds_read_b64_tr_b16 v[54:55], v205 offset:5632
    ds_read_b64_tr_b16 v[56:57], v205 offset:6144
    ds_read_b64_tr_b16 v[58:59], v205 offset:6656
    ds_read_b64_tr_b16 v[60:61], v205 offset:7168
    ds_read_b64_tr_b16 v[62:63], v205 offset:7680
    s_waitcnt lgkmcnt(0)
    s_mov_b32 s35, 0
L_poll51:
    ds_read_b32 v8, v7
    s_add_u32 s35, s35, 1
    s_waitcnt lgkmcnt(0)
    v_cmp_eq_u32 vcc, 0, v8
    s_cbranch_vccz L_done52
    s_sleep 1
    s_cmp_lt_u32 s35, 60000
    s_cbranch_scc1 L_poll51
L_done52:
    s_mov_b32 s35, 0
L_poll54:
    buffer_load_dwordx4 v[64:67], v4, s[44:47], 0 offen sc1
    buffer_load_dwordx4 v[68:71], v5, s[44:47], s48 offen sc1
L_w2_mid:
    s_add_u32 s35, s35, 1
    s_waitcnt vmcnt(0)
    v_max3_u32 v28, v64, v65, v66
    v_max3_u32 v28, v28, v67, v68
    v_max3_u32 v28, v28, v69, v70
    v_max_u32 v28, v28, v71
    v_cmp_eq_u32 vcc, -1, v28
    s_cbranch_vccz L_done55
    s_cmp_lg_u32 s35, 64
    s_cbranch_scc1 L_tmo57
    s_mov_b64 exec, -1
    v_lshlrev_b32 v243, 4, v0
    v_add_u32 v243, 131328, v243
    ds_read_b96 v[240:242], v243
    s_waitcnt lgkmcnt(0)
    buffer_store_dword v240, v242, s[44:47], 0 offen sc1
    buffer_store_dword v241, v242, s[44:47], 0 offen offset:256 sc1
L_tmo57:
    s_cmp_lt_u32 s35, 60000
    s_cbranch_scc1 L_poll54
L_done55:
    v_mfma_f32_16x16x32_bf16 v[80:83], v[32:35], v[64:67], 0
    v_mfma_f32_16x16x32_bf16 v[80:83], v[48:51], v[68:71], v[80:83]
    v_mfma_f32_16x16x32_bf16 v[84:87], v[36:39], v[64:67], 0
    v_mfma_f32_16x16x32_bf16 v[84:87], v[52:55], v[68:71], v[84:87]
    v_mfma_f32_16x16x32_bf16 v[88:91], v[40:43], v[64:67], 0
    v_mfma_f32_16x16x32_bf16 v[88:91], v[56:59], v[68:71], v[88:91]
    v_mfma_f32_16x16x32_bf16 v[92:95], v[44:47], v[64:67], 0
    v_mfma_f32_16x16x32_bf16 v[92:95], v[60:63], v[68:71], v[92:95]
    s_nop 3
    v_add_f32_dpp v80, v84, v80 row_shl:4 row_mask:0xf bank_mask:0x1
    v_add_f32_dpp v81, v85, v81 row_shl:4 row_mask:0xf bank_mask:0x1
    v_add_f32_dpp v82, v86, v82 row_shl:4 row_mask:0xf bank_mask:0x1
    v_add_f32_dpp v83, v87, v83 row_shl:4 row_mask:0xf bank_mask:0x1
    v_add_f32_dpp v80, v88, v80 row_shl:8 row_mask:0xf bank_mask:0x1
    v_add_f32_dpp v81, v89, v81 row_shl:8 row_mask:0xf bank_mask:0x1
    v_add_f32_dpp v82, v90, v82 row_shl:8 row_mask:0xf bank_mask:0x1
    v_add_f32_dpp v83, v91, v83 row_shl:8 row_mask:0xf bank_mask:0x1
    v_add_f32_dpp v80, v92, v80 row_shl:12 row_mask:0xf bank_mask:0x1
    v_add_f32_dpp v81, v93, v81 row_shl:12 row_mask:0xf bank_mask:0x1
    v_add_f32_dpp v82, v94, v82 row_shl:12 row_mask:0xf bank_mask:0x1
    v_add_f32_dpp v83, v95, v83 row_shl:12 row_mask:0xf bank_mask:0x1
    ds_write_b128 v203, v[80:83]
    s_waitcnt lgkmcnt(0)
    s_barrier
    s_branch L_fin
L_w2_red:
    s_mov_b32 s35, 0
L_poll58:
    buffer_load_dwordx2 v[20:21], v204, s[44:47], 0 offen sc1
    buffer_load_dwordx2 v[22:23], v204, s[44:47], s48 offen sc1
    s_add_u32 s35, s35, 1
    s_waitcnt vmcnt(0)
    v_max3_u32 v28, v20, v21, v22
    v_max_u32 v28, v28, v23
    v_cmp_eq_u32 vcc, -1, v28
    s_cbranch_vccz L_done59
    s_cmp_lg_u32 s35, 21
    s_cbranch_scc1 L_tmo61
    s_mov_b64 exec, -1
    v_lshlrev_b32 v243, 4, v0
    v_add_u32 v243, 131328, v243
    ds_read_b96 v[240:242], v243
    s_waitcnt lgkmcnt(0)
    buffer_store_dword v240, v242, s[44:47], 0 offen sc1
    buffer_store_dword v241, v242, s[44:47], 0 offen offset:256 sc1
L_tmo61:
    s_sleep 6
    s_cmp_lt_u32 s35, 60000
    s_cbranch_scc1 L_poll58
L_done59:
    v_mov_b32 v7, 99084
    ds_write_b32 v7, v7
    v_lshlrev_b32 v44, 16, v20
    v_and_b32 v45, 0xffff0000, v20
    v_lshlrev_b32 v46, 16, v21
    v_and_b32 v47, 0xffff0000, v21
    v_lshlrev_b32 v48, 16, v22
    v_and_b32 v49, 0xffff0000, v22
    v_lshlrev_b32 v50, 16, v23
    v_and_b32 v51, 0xffff0000, v23
    v_add_f32 v108, v108, v44
    v_add_f32 v109, v109, v45
    v_add_f32 v110, v110, v46
    v_add_f32 v111, v111, v47
    v_add_f32 v108, v108, v48
    v_add_f32 v109, v109, v49
    v_add_f32 v110, v110, v50
    v_add_f32 v111, v111, v51
    s_mov_b32 s36, s28
    s_mov_b32 s37, s29
    s_movk_i32 s38, 5120
    v_add_f32_dpp v108, v108, v108 row_ror:4 row_mask:0xf bank_mask:0xf
    v_add_f32_dpp v109, v109, v109 row_ror:4 row_mask:0xf bank_mask:0xf
    v_add_f32_dpp v110, v110, v110 row_ror:4 row_mask:0xf bank_mask:0xf
    v_add_f32_dpp v111, v111, v111 row_ror:4 row_mask:0xf bank_mask:0xf
    v_add_f32_dpp v108, v108, v108 row_ror:8 row_mask:0xf bank_mask:0xf
    v_add_f32_dpp v109, v109, v109 row_ror:8 row_mask:0xf bank_mask:0xf
    v_add_f32_dpp v110, v110, v110 row_ror:8 row_mask:0xf bank_mask:0xf
    v_add_f32_dpp v111, v111, v111 row_ror:8 row_mask:0xf bank_mask:0xf
    v_mov_b32_dpp v108, v104 quad_perm:[0,1,2,3] row_mask:0xf bank_mask:0x2
    v_mov_b32_dpp v109, v105 quad_perm:[0,1,2,3] row_mask:0xf bank_mask:0x2
    v_mov_b32_dpp v110, v106 quad_perm:[0,1,2,3] row_mask:0xf bank_mask:0x2
    v_mov_b32_dpp v111, v107 quad_perm:[0,1,2,3] row_mask:0xf bank_mask:0x2
    ds_write_b128 v203, v[108:111]
    v_and_b32 v6, 31, v0
    v_lshlrev_b32 v6, 3, v6
    v_add_u32 v6, 122112, v6
    ds_read_b64 v[108:109], v6
    ds_read_b64 v[104:105], v6 offset:320
    v_bfe_u32 v112, v0, 1, 2
    v_mul_u32_u24 v112, 1280, v112
    v_bfe_u32 v7, v0, 3, 2
    v_lshl_add_u32 v112, v7, 3, v112
    v_and_b32 v7, 1, v0
    v_lshl_add_u32 v112, v7, 2, v112
    v_lshrrev_b32 v7, 5, v0
    v_lshl_add_u32 v112, v7, 28, v112
    s_lshl_b32 s34, s62, 5
    s_waitcnt lgkmcnt(0)
    s_barrier
    ds_read_b64 v[64:65], v6 offset:1024
    ds_read_b64 v[66:67], v6 offset:2048
    ds_read_b64 v[68:69], v6 offset:3072
    ds_read_b64 v[70:71], v6 offset:4096
    ds_read_b64 v[72:73], v6 offset:5120
    ds_read_b64 v[74:75], v6 offset:6144
    ds_read_b64 v[76:77], v6 offset:7168
    s_waitcnt lgkmcnt(6)
    v_pk_fma_f32 v[108:109], v[64:65], v[104:105], v[108:109]
    s_waitcnt lgkmcnt(5)
    v_pk_fma_f32 v[108:109], v[66:67], v[104:105], v[108:109]
    s_waitcnt lgkmcnt(4)
    v_pk_fma_f32 v[108:109], v[68:69], v[104:105], v[108:109]
    s_waitcnt lgkmcnt(3)
    v_pk_fma_f32 v[108:109], v[70:71], v[104:105], v[108:109]
    s_waitcnt lgkmcnt(2)
    v_pk_fma_f32 v[108:109], v[72:73], v[104:105], v[108:109]
    s_waitcnt lgkmcnt(1)
    v_pk_fma_f32 v[108:109], v[74:75], v[104:105], v[108:109]
    s_waitcnt lgkmcnt(0)
    v_pk_fma_f32 v[108:109], v[76:77], v[104:105], v[108:109]
    v_cvt_pk_bf16_f32 v20, v108, v109
    buffer_store_dword v20, v112, s[36:39], s34 offen
    s_branch L_fin
L_t_wo:
    s_barrier
L_r_wo2:
    s_mov_b32 m0, s56
    s_nop 0
    buffer_load_dwordx4 v15, s[52:55], s57 offen  lds
    s_mov_b32 m0, s58
    s_nop 0
    buffer_load_dwordx4 v15, s[52:55], s59 offen  lds
    s_xor_b32 m0, s56, 2048
    s_sub_u32 s34, 40960, s57
    buffer_load_dwordx4 v15, s[52:55], s34 offen  lds
    s_xor_b32 m0, s58, 2048
    s_sub_u32 s34, 42240, s57
    buffer_load_dwordx4 v15, s[52:55], s34 offen  lds
L_r_wo3:
    s_mov_b32 s35, 0
    s_mov_b32 s48, 0
    buffer_load_dwordx4 v[64:67], v205, s[44:47], 0 offen sc1
    buffer_load_dwordx2 v[26:27], v204, s[44:47], 0 offen sc1
    s_waitcnt vmcnt(2)
    ds_read_b64_tr_b16 v[32:33], v206 offset:0
    ds_read_b64_tr_b16 v[34:35], v206 offset:1024
    ds_read_b64_tr_b16 v[36:37], v206 offset:32
    ds_read_b64_tr_b16 v[38:39], v206 offset:1056
    ds_read_b64_tr_b16 v[40:41], v206 offset:2048
    ds_read_b64_tr_b16 v[42:43], v206 offset:3072
    ds_read_b64_tr_b16 v[44:45], v206 offset:2080
    ds_read_b64_tr_b16 v[46:47], v206 offset:3104
    s_branch L_pam
L_pa:
    buffer_load_dwordx4 v[64:67], v205, s[44:47], 0 offen sc1
    buffer_load_dwordx2 v[26:27], v204, s[44:47], 0 offen sc1
L_pam:
    s_add_u32 s35, s35, 1
    s_waitcnt vmcnt(0)
    ds_write_b128 v207, v[64:67]
    ds_write_b32 v212, v26 offset:128
    v_max3_u32 v28, v64, v65, v66
    v_max3_u32 v28, v28, v67, v26
    v_cmp_eq_u32 vcc, -1, v28
    s_cbranch_vccz L_pad
    s_cmp_lg_u32 s35, 64
    s_cbranch_scc1 L_tmo62
    s_mov_b64 exec, -1
    v_lshlrev_b32 v243, 4, v0
    v_add_u32 v243, 131328, v243
    ds_read_b96 v[240:242], v243
    s_waitcnt lgkmcnt(0)
    buffer_store_dword v240, v242, s[44:47], 0 offen sc1
    buffer_store_dword v241, v242, s[44:47], 0 offen offset:256 sc1
L_tmo62:
    s_mov_b64 exec, vcc
    s_cmp_lt_u32 s35, 60000
    s_cbranch_scc1 L_pa
L_pad:
    s_mov_b64 exec, -1
    ds_read_b32 v26, v213 offset:128
    ds_read_b128 v[68:71], v208 offset:0
    ds_read_b128 v[72:75], v209 offset:0
    ds_read_b128 v[76:79], v208 offset:64
    ds_read_b128 v[80:83], v209 offset:64
    s_waitcnt lgkmcnt(3)
    v_mfma_f32_16x16x32_bf16 v[20:23], v[32:35], v[68:71], 0
    s_waitcnt lgkmcnt(2)
    v_mfma_f32_16x16x32_bf16 v[20:23], v[36:39], v[72:75], v[20:23]
    s_waitcnt lgkmcnt(1)
    v_mfma_f32_16x16x32_bf16 v[20:23], v[40:43], v[76:79], v[20:23]
    s_waitcnt lgkmcnt(0)
    v_mfma_f32_16x16x32_bf16 v[20:23], v[44:47], v[80:83], v[20:23]
    v_sub_f32_dpp v26, v26, v26 quad_perm:[1,0,3,2] row_mask:0xf bank_mask:0xf
    v_exp_f32 v26, v26
    s_nop 0
    v_add_f32 v26, 1.0, v26
    v_rcp_f32 v26, v26
    s_nop 0
    v_sub_f32 v30, 1.0, v26
    s_nop 0
    v_pk_mul_f32 v[48:49], v[20:21], v[26:27] op_sel_hi:[1,0]
    v_pk_mul_f32 v[50:51], v[22:23], v[26:27] op_sel_hi:[1,0]
    v_fmac_f32_dpp v48, v20, v30 quad_perm:[1,0,3,2] row_mask:0xf bank_mask:0xf
    v_fmac_f32_dpp v49, v21, v30 quad_perm:[1,0,3,2] row_mask:0xf bank_mask:0xf
    v_fmac_f32_dpp v50, v22, v30 quad_perm:[1,0,3,2] row_mask:0xf bank_mask:0xf
    v_fmac_f32_dpp v51, v23, v30 quad_perm:[1,0,3,2] row_mask:0xf bank_mask:0xf
    ds_write_b128 v203, v[48:51]
    s_cmp_lg_u32 s3, 0
    s_waitcnt lgkmcnt(0)
    s_barrier
    s_cbranch_scc1 L_wo_x
    ds_read_b64 v[64:65], v113 offset:0
    ds_read_b64 v[66:67], v113 offset:1152
    ds_read_b64 v[68:69], v113 offset:2304
    ds_read_b64 v[70:71], v113 offset:3456
    ds_read_b64 v[72:73], v113 offset:4608
    ds_read_b64 v[74:75], v113 offset:5760
    ds_read_b64 v[76:77], v113 offset:6912
    ds_read_b64 v[78:79], v113 offset:8064
    s_waitcnt lgkmcnt(6)
    v_pk_add_f32 v[64:65], v[64:65], v[66:67]
    s_waitcnt lgkmcnt(5)
    v_pk_add_f32 v[64:65], v[64:65], v[68:69]
    s_waitcnt lgkmcnt(4)
    v_pk_add_f32 v[64:65], v[64:65], v[70:71]
    s_waitcnt lgkmcnt(3)
    v_pk_add_f32 v[64:65], v[64:65], v[72:73]
    s_waitcnt lgkmcnt(2)
    v_pk_add_f32 v[64:65], v[64:65], v[74:75]
    s_waitcnt lgkmcnt(1)
    v_pk_add_f32 v[64:65], v[64:65], v[76:77]
    s_waitcnt lgkmcnt(0)
    v_pk_add_f32 v[64:65], v[64:65], v[78:79]
    v_pk_mul_f32 v[64:65], v[64:65], v[100:101]
    v_cvt_pk_bf16_f32 v28, v64, v65
    v_min_u32 v28, -2, v28
    buffer_store_dword v28, v112, s[44:47], s101 offen sc1
    buffer_store_dword v28, v112, s[44:47], s93 offen sc1
L_wo_x:
    s_getreg_b32 s34, hwreg(HW_REG_XCC_ID, 0, 4)
    v_cmp_ne_u32 vcc, s34, v27
    s_cbranch_vccz L_fin
    s_mov_b64 exec, -1
    v_lshlrev_b32 v243, 4, v0
    v_add_u32 v243, 131328, v243
    ds_read_b96 v[240:242], v243
    s_waitcnt lgkmcnt(0)
    buffer_store_dword v240, v242, s[44:47], 0 offen sc1
    buffer_store_dword v241, v242, s[44:47], 0 offen offset:256 sc1
L_fin:
L_exit:
    s_endpgm
L_codeend:
.section .rodata,"a"
.p2align 6
.amdhsa_kernel adaLN_cond__sliding_block_cached__dense_activation_gelu__decode_kernel
  .amdhsa_next_free_vgpr 256
  .amdhsa_next_free_sgpr 102
  .amdhsa_accum_offset 256
  .amdhsa_group_segment_fixed_size 0
  .amdhsa_kernarg_size 120
  .amdhsa_user_sgpr_count 2
  .amdhsa_user_sgpr_kernarg_segment_ptr 1
  .amdhsa_system_sgpr_workgroup_id_x 1
  .amdhsa_float_denorm_mode_32 3
.end_amdhsa_kernel
```

```asm
; @launch grid=(256,1,1) block=(512,1,1) lds=132352
.amdgcn_target "amdgcn-amd-amdhsa--gfx950"
.text
.globl adaLN_cond__sliding_block_cached__dense_activation_gelu__decode_kernel
.p2align 8
.type adaLN_cond__sliding_block_cached__dense_activation_gelu__decode_kernel,@function
adaLN_cond__sliding_block_cached__dense_activation_gelu__decode_kernel:
    s_cmp_ge_u32 s2, 256
    s_cbranch_scc1 L_exit
    s_load_dwordx4 s[4:7], s[0:1], 0
    v_lshrrev_b32 v1, 6, v0
    v_and_b32 v0, 63, v0
    v_readfirstlane_b32 s3, v1
    s_and_b32 s34, s2, 127
    s_lshl_b32 s34, s34, 21
    s_lshr_b32 s35, s2, 7
    s_lshl_b32 s35, s35, 18
    s_add_u32 s34, s34, s35
    s_add_u32 s34, s34, 1572864
    s_mov_b32 s38, 0x40000
    s_mov_b32 s39, 0x20000
    s_sub_u32 s49, s3, 1
    s_cbranch_scc1 L_nohead
    s_lshl_b32 s49, s49, 12
    v_lshl_add_u32 v1, v0, 4, s49
    s_waitcnt lgkmcnt(0)
    s_add_u32 s36, s6, s34
    s_addc_u32 s37, s7, 0
    buffer_load_dwordx4 v[16:19], v1, s[36:39], 0 offen offset:0 nt
    buffer_load_dwordx4 v[20:23], v1, s[36:39], 0 offen offset:1024 nt
    buffer_load_dwordx4 v[24:27], v1, s[36:39], 0 offen offset:2048 nt
L_nohead:
    s_load_dwordx8 s[8:15], s[0:1], 16
    s_load_dwordx4 s[16:19], s[0:1], 48
    s_load_dwordx8 s[20:27], s[0:1], 64
    s_load_dwordx4 s[28:31], s[0:1], 96
    s_load_dwordx2 s[32:33], s[0:1], 112
    s_and_b32 s60, s2, 7
    s_lshr_b32 s61, s2, 3
    s_mov_b32 s39, 0x20000
    s_mov_b32 s43, 0x20000
    s_mov_b32 s46, 1703936
    s_mov_b32 s47, 0x20000
    s_cmp_lg_u32 s3, 0
    s_cbranch_scc1 L_stream
    s_setprio 3
    v_and_b32 v12, 3, v0
    v_bfe_u32 v13, v0, 2, 2
    v_lshrrev_b32 v14, 4, v0
    v_lshrrev_b32 v10, 3, v0
    v_and_b32 v11, 7, v0
    v_lshlrev_b32 v11, 4, v11
    s_lshr_b32 s50, s2, 2
    s_and_b32 s51, s2, 3
    s_mul_i32 s34, s51, 1228800
    s_lshl_b32 s35, s50, 7
    s_add_u32 s34, s34, s35
    v_mul_u32_u24 v17, 7680, v10
    v_add3_u32 v17, v17, v11, s34
    v_mul_u32_u24 v16, 1280, v12
    v_lshl_add_u32 v18, v14, 4, v16
    s_mul_i32 s34, s51, 320
    v_add_u32 v19, s34, v18
    s_mov_b32 s38, 4915200
    s_sub_u32 s52, s50, 10
    s_waitcnt lgkmcnt(0)
    s_add_u32 s44, s32, 0
    s_addc_u32 s45, s33, 0
    s_cmp_ge_u32 s2, 240
    s_cbranch_scc1 L_clear
    s_cmp_ge_u32 s52, 10
    s_cbranch_scc1 L_nox
    v_lshl_add_u32 v18, v13, 6, v18
    global_load_dwordx4 v[52:55], v18, s[4:5] offset:0
    global_load_dwordx4 v[56:59], v18, s[4:5] offset:256
    global_load_dwordx4 v[60:63], v18, s[4:5] offset:512
    global_load_dwordx4 v[64:67], v18, s[4:5] offset:768
    global_load_dwordx4 v[68:71], v18, s[4:5] offset:1024
    s_lshl_b32 s34, s52, 7
    v_lshl_add_u32 v16, v13, 5, v16
    v_lshl_add_u32 v16, v14, 3, v16
    v_add_u32 v16, s34, v16
    global_load_dwordx2 v[72:73], v16, s[4:5]
L_nox:
    global_load_dwordx4 v[32:35], v19, s[24:25] offset:0
    global_load_dwordx4 v[36:39], v19, s[24:25] offset:64
    global_load_dwordx4 v[40:43], v19, s[24:25] offset:128
    global_load_dwordx4 v[44:47], v19, s[24:25] offset:192
    global_load_dwordx4 v[48:51], v19, s[24:25] offset:256
    s_mov_b32 s36, s26
    s_mov_b32 s37, s27
    s_mov_b32 m0, 0
    s_mov_b32 s34, 0
L_dma1:
    buffer_load_dwordx4 v17, s[36:39], s34 offen  lds
    s_add_u32 m0, m0, 1024
    s_add_u32 s34, s34, 61440
    buffer_load_dwordx4 v17, s[36:39], s34 offen  lds
    s_add_u32 m0, m0, 1024
    s_add_u32 s34, s34, 61440
    buffer_load_dwordx4 v17, s[36:39], s34 offen  lds
    s_add_u32 m0, m0, 1024
    s_add_u32 s34, s34, 61440
    buffer_load_dwordx4 v17, s[36:39], s34 offen  lds
    s_add_u32 m0, m0, 1024
    s_add_u32 s34, s34, 61440
    s_cmp_lt_u32 s34, 1228800
    s_cbranch_scc1 L_dma1
    v_lshlrev_b32 v1, 2, v0
    v_add_u32 v1, 98304, v1
    v_mov_b32 v2, -1
    v_mov_b32 v3, 0
    ds_write_b32 v1, v2
    ds_write_b32 v1, v2 offset:256
    ds_write_b32 v1, v3 offset:512
    ds_write_b32 v1, v3 offset:768
    s_waitcnt lgkmcnt(0)
    s_barrier
    s_and_b32 s34, s2, 31
    s_lshl_b32 s34, s34, 8
    s_lshr_b32 s35, s2, 7
    s_lshl_b32 s35, s35, 7
    s_add_u32 s49, s34, s35
    s_bfe_u32 s53, s2, 0x20005
    s_mul_i32 s34, s53, 1310720
    s_add_u32 s34, s34, s49
    v_lshl_add_u32 v16, v10, 13, v11
    v_add_u32 v16, s34, v16
    s_mov_b32 s36, s10
    s_mov_b32 s37, s11
    s_mov_b32 s38, 5242880
    s_mov_b32 m0, 20480
    s_mov_b32 s34, 0
L_dma2:
    buffer_load_dwordx4 v16, s[36:39], s34 offen  lds
    s_add_u32 m0, m0, 1024
    s_add_u32 s34, s34, 65536
    buffer_load_dwordx4 v16, s[36:39], s34 offen  lds
    s_add_u32 m0, m0, 1024
    s_add_u32 s34, s34, 65536
    buffer_load_dwordx4 v16, s[36:39], s34 offen  lds
    s_add_u32 m0, m0, 1024
    s_add_u32 s34, s34, 65536
    buffer_load_dwordx4 v16, s[36:39], s34 offen  lds
    s_add_u32 m0, m0, 1024
    s_add_u32 s34, s34, 65536
    s_cmp_lt_u32 s34, 1310720
    s_cbranch_scc1 L_dma2
    v_lshl_add_u32 v15, v14, 3, v13
    v_lshlrev_b32 v15, 7, v15
    v_lshl_add_u32 v15, v12, 3, v15
    s_waitcnt vmcnt(40)
    s_mov_b32 s34, 0xbfb8aa3b
    v_lshlrev_b32 v20, 16, v32
    v_and_b32 v21, 0xffff0000, v32
    v_lshlrev_b32 v22, 16, v33
    v_and_b32 v23, 0xffff0000, v33
    v_mul_f32 v24, s34, v20
    v_mul_f32 v25, s34, v21
    v_mul_f32 v26, s34, v22
    v_mul_f32 v27, s34, v23
    v_exp_f32 v24, v24
    v_exp_f32 v25, v25
    v_exp_f32 v26, v26
    v_exp_f32 v27, v27
    v_add_f32 v24, 1.0, v24
    v_add_f32 v25, 1.0, v25
    v_add_f32 v26, 1.0, v26
    v_add_f32 v27, 1.0, v27
    v_rcp_f32 v24, v24
    v_rcp_f32 v25, v25
    v_rcp_f32 v26, v26
    v_rcp_f32 v27, v27
    v_mul_f32 v24, v20, v24
    v_mul_f32 v25, v21, v25
    v_mul_f32 v26, v22, v26
    v_mul_f32 v27, v23, v27
    v_cvt_pk_bf16_f32 v32, v24, v25
    v_cvt_pk_bf16_f32 v33, v26, v27
    v_lshlrev_b32 v20, 16, v34
    v_and_b32 v21, 0xffff0000, v34
    v_lshlrev_b32 v22, 16, v35
    v_and_b32 v23, 0xffff0000, v35
    v_mul_f32 v24, s34, v20
    v_mul_f32 v25, s34, v21
    v_mul_f32 v26, s34, v22
    v_mul_f32 v27, s34, v23
    v_exp_f32 v24, v24
    v_exp_f32 v25, v25
    v_exp_f32 v26, v26
    v_exp_f32 v27, v27
    v_add_f32 v24, 1.0, v24
    v_add_f32 v25, 1.0, v25
    v_add_f32 v26, 1.0, v26
    v_add_f32 v27, 1.0, v27
    v_rcp_f32 v24, v24
    v_rcp_f32 v25, v25
    v_rcp_f32 v26, v26
    v_rcp_f32 v27, v27
    v_mul_f32 v24, v20, v24
    v_mul_f32 v25, v21, v25
    v_mul_f32 v26, v22, v26
    v_mul_f32 v27, v23, v27
    v_cvt_pk_bf16_f32 v34, v24, v25
    v_cvt_pk_bf16_f32 v35, v26, v27
    v_lshlrev_b32 v20, 16, v36
    v_and_b32 v21, 0xffff0000, v36
    v_lshlrev_b32 v22, 16, v37
    v_and_b32 v23, 0xffff0000, v37
    v_mul_f32 v24, s34, v20
    v_mul_f32 v25, s34, v21
    v_mul_f32 v26, s34, v22
    v_mul_f32 v27, s34, v23
    v_exp_f32 v24, v24
    v_exp_f32 v25, v25
    v_exp_f32 v26, v26
    v_exp_f32 v27, v27
    v_add_f32 v24, 1.0, v24
    v_add_f32 v25, 1.0, v25
    v_add_f32 v26, 1.0, v26
    v_add_f32 v27, 1.0, v27
    v_rcp_f32 v24, v24
    v_rcp_f32 v25, v25
    v_rcp_f32 v26, v26
    v_rcp_f32 v27, v27
    v_mul_f32 v24, v20, v24
    v_mul_f32 v25, v21, v25
    v_mul_f32 v26, v22, v26
    v_mul_f32 v27, v23, v27
    v_cvt_pk_bf16_f32 v36, v24, v25
    v_cvt_pk_bf16_f32 v37, v26, v27
    v_lshlrev_b32 v20, 16, v38
    v_and_b32 v21, 0xffff0000, v38
    v_lshlrev_b32 v22, 16, v39
    v_and_b32 v23, 0xffff0000, v39
    v_mul_f32 v24, s34, v20
    v_mul_f32 v25, s34, v21
    v_mul_f32 v26, s34, v22
    v_mul_f32 v27, s34, v23
    v_exp_f32 v24, v24
    v_exp_f32 v25, v25
    v_exp_f32 v26, v26
    v_exp_f32 v27, v27
    v_add_f32 v24, 1.0, v24
    v_add_f32 v25, 1.0, v25
    v_add_f32 v26, 1.0, v26
    v_add_f32 v27, 1.0, v27
    v_rcp_f32 v24, v24
    v_rcp_f32 v25, v25
    v_rcp_f32 v26, v26
    v_rcp_f32 v27, v27
    v_mul_f32 v24, v20, v24
    v_mul_f32 v25, v21, v25
    v_mul_f32 v26, v22, v26
    v_mul_f32 v27, v23, v27
    v_cvt_pk_bf16_f32 v38, v24, v25
    v_cvt_pk_bf16_f32 v39, v26, v27
    v_lshlrev_b32 v20, 16, v40
    v_and_b32 v21, 0xffff0000, v40
    v_lshlrev_b32 v22, 16, v41
    v_and_b32 v23, 0xffff0000, v41
    v_mul_f32 v24, s34, v20
    v_mul_f32 v25, s34, v21
    v_mul_f32 v26, s34, v22
    v_mul_f32 v27, s34, v23
    v_exp_f32 v24, v24
    v_exp_f32 v25, v25
    v_exp_f32 v26, v26
    v_exp_f32 v27, v27
    v_add_f32 v24, 1.0, v24
    v_add_f32 v25, 1.0, v25
    v_add_f32 v26, 1.0, v26
    v_add_f32 v27, 1.0, v27
    v_rcp_f32 v24, v24
    v_rcp_f32 v25, v25
    v_rcp_f32 v26, v26
    v_rcp_f32 v27, v27
    v_mul_f32 v24, v20, v24
    v_mul_f32 v25, v21, v25
    v_mul_f32 v26, v22, v26
    v_mul_f32 v27, v23, v27
    v_cvt_pk_bf16_f32 v40, v24, v25
    v_cvt_pk_bf16_f32 v41, v26, v27
    v_lshlrev_b32 v20, 16, v42
    v_and_b32 v21, 0xffff0000, v42
    v_lshlrev_b32 v22, 16, v43
    v_and_b32 v23, 0xffff0000, v43
    v_mul_f32 v24, s34, v20
    v_mul_f32 v25, s34, v21
    v_mul_f32 v26, s34, v22
    v_mul_f32 v27, s34, v23
    v_exp_f32 v24, v24
    v_exp_f32 v25, v25
    v_exp_f32 v26, v26
    v_exp_f32 v27, v27
    v_add_f32 v24, 1.0, v24
    v_add_f32 v25, 1.0, v25
    v_add_f32 v26, 1.0, v26
    v_add_f32 v27, 1.0, v27
    v_rcp_f32 v24, v24
    v_rcp_f32 v25, v25
    v_rcp_f32 v26, v26
    v_rcp_f32 v27, v27
    v_mul_f32 v24, v20, v24
    v_mul_f32 v25, v21, v25
    v_mul_f32 v26, v22, v26
    v_mul_f32 v27, v23, v27
    v_cvt_pk_bf16_f32 v42, v24, v25
    v_cvt_pk_bf16_f32 v43, v26, v27
    v_lshlrev_b32 v20, 16, v44
    v_and_b32 v21, 0xffff0000, v44
    v_lshlrev_b32 v22, 16, v45
    v_and_b32 v23, 0xffff0000, v45
    v_mul_f32 v24, s34, v20
    v_mul_f32 v25, s34, v21
    v_mul_f32 v26, s34, v22
    v_mul_f32 v27, s34, v23
    v_exp_f32 v24, v24
    v_exp_f32 v25, v25
    v_exp_f32 v26, v26
    v_exp_f32 v27, v27
    v_add_f32 v24, 1.0, v24
    v_add_f32 v25, 1.0, v25
    v_add_f32 v26, 1.0, v26
    v_add_f32 v27, 1.0, v27
    v_rcp_f32 v24, v24
    v_rcp_f32 v25, v25
    v_rcp_f32 v26, v26
    v_rcp_f32 v27, v27
    v_mul_f32 v24, v20, v24
    v_mul_f32 v25, v21, v25
    v_mul_f32 v26, v22, v26
    v_mul_f32 v27, v23, v27
    v_cvt_pk_bf16_f32 v44, v24, v25
    v_cvt_pk_bf16_f32 v45, v26, v27
    v_lshlrev_b32 v20, 16, v46
    v_and_b32 v21, 0xffff0000, v46
    v_lshlrev_b32 v22, 16, v47
    v_and_b32 v23, 0xffff0000, v47
    v_mul_f32 v24, s34, v20
    v_mul_f32 v25, s34, v21
    v_mul_f32 v26, s34, v22
    v_mul_f32 v27, s34, v23
    v_exp_f32 v24, v24
    v_exp_f32 v25, v25
    v_exp_f32 v26, v26
    v_exp_f32 v27, v27
    v_add_f32 v24, 1.0, v24
    v_add_f32 v25, 1.0, v25
    v_add_f32 v26, 1.0, v26
    v_add_f32 v27, 1.0, v27
    v_rcp_f32 v24, v24
    v_rcp_f32 v25, v25
    v_rcp_f32 v26, v26
    v_rcp_f32 v27, v27
    v_mul_f32 v24, v20, v24
    v_mul_f32 v25, v21, v25
    v_mul_f32 v26, v22, v26
    v_mul_f32 v27, v23, v27
    v_cvt_pk_bf16_f32 v46, v24, v25
    v_cvt_pk_bf16_f32 v47, v26, v27
    v_lshlrev_b32 v20, 16, v48
    v_and_b32 v21, 0xffff0000, v48
    v_lshlrev_b32 v22, 16, v49
    v_and_b32 v23, 0xffff0000, v49
    v_mul_f32 v24, s34, v20
    v_mul_f32 v25, s34, v21
    v_mul_f32 v26, s34, v22
    v_mul_f32 v27, s34, v23
    v_exp_f32 v24, v24
    v_exp_f32 v25, v25
    v_exp_f32 v26, v26
    v_exp_f32 v27, v27
    v_add_f32 v24, 1.0, v24
    v_add_f32 v25, 1.0, v25
    v_add_f32 v26, 1.0, v26
    v_add_f32 v27, 1.0, v27
    v_rcp_f32 v24, v24
    v_rcp_f32 v25, v25
    v_rcp_f32 v26, v26
    v_rcp_f32 v27, v27
    v_mul_f32 v24, v20, v24
    v_mul_f32 v25, v21, v25
    v_mul_f32 v26, v22, v26
    v_mul_f32 v27, v23, v27
    v_cvt_pk_bf16_f32 v48, v24, v25
    v_cvt_pk_bf16_f32 v49, v26, v27
    v_lshlrev_b32 v20, 16, v50
    v_and_b32 v21, 0xffff0000, v50
    v_lshlrev_b32 v22, 16, v51
    v_and_b32 v23, 0xffff0000, v51
    v_mul_f32 v24, s34, v20
    v_mul_f32 v25, s34, v21
    v_mul_f32 v26, s34, v22
    v_mul_f32 v27, s34, v23
    v_exp_f32 v24, v24
    v_exp_f32 v25, v25
    v_exp_f32 v26, v26
    v_exp_f32 v27, v27
    v_add_f32 v24, 1.0, v24
    v_add_f32 v25, 1.0, v25
    v_add_f32 v26, 1.0, v26
    v_add_f32 v27, 1.0, v27
    v_rcp_f32 v24, v24
    v_rcp_f32 v25, v25
    v_rcp_f32 v26, v26
    v_rcp_f32 v27, v27
    v_mul_f32 v24, v20, v24
    v_mul_f32 v25, v21, v25
    v_mul_f32 v26, v22, v26
    v_mul_f32 v27, v23, v27
    v_cvt_pk_bf16_f32 v50, v24, v25
    v_cvt_pk_bf16_f32 v51, v26, v27
    s_cmp_ge_u32 s52, 10
    s_cbranch_scc1 L_nostats
    v_mov_b32 v20, 0
    v_mov_b32 v21, 0
    v_mov_b32 v22, 0x3f803f80
    v_dot2c_f32_bf16 v20, v52, v22
    v_dot2c_f32_bf16 v21, v52, v52
    v_dot2c_f32_bf16 v20, v53, v22
    v_dot2c_f32_bf16 v21, v53, v53
    v_dot2c_f32_bf16 v20, v54, v22
    v_dot2c_f32_bf16 v21, v54, v54
    v_dot2c_f32_bf16 v20, v55, v22
    v_dot2c_f32_bf16 v21, v55, v55
    v_dot2c_f32_bf16 v20, v56, v22
    v_dot2c_f32_bf16 v21, v56, v56
    v_dot2c_f32_bf16 v20, v57, v22
    v_dot2c_f32_bf16 v21, v57, v57
    v_dot2c_f32_bf16 v20, v58, v22
    v_dot2c_f32_bf16 v21, v58, v58
    v_dot2c_f32_bf16 v20, v59, v22
    v_dot2c_f32_bf16 v21, v59, v59
    v_dot2c_f32_bf16 v20, v60, v22
    v_dot2c_f32_bf16 v21, v60, v60
    v_dot2c_f32_bf16 v20, v61, v22
    v_dot2c_f32_bf16 v21, v61, v61
    v_dot2c_f32_bf16 v20, v62, v22
    v_dot2c_f32_bf16 v21, v62, v62
    v_dot2c_f32_bf16 v20, v63, v22
    v_dot2c_f32_bf16 v21, v63, v63
    v_dot2c_f32_bf16 v20, v64, v22
    v_dot2c_f32_bf16 v21, v64, v64
    v_dot2c_f32_bf16 v20, v65, v22
    v_dot2c_f32_bf16 v21, v65, v65
    v_dot2c_f32_bf16 v20, v66, v22
    v_dot2c_f32_bf16 v21, v66, v66
    v_dot2c_f32_bf16 v20, v67, v22
    v_dot2c_f32_bf16 v21, v67, v67
    v_dot2c_f32_bf16 v20, v68, v22
    v_dot2c_f32_bf16 v21, v68, v68
    v_dot2c_f32_bf16 v20, v69, v22
    v_dot2c_f32_bf16 v21, v69, v69
    v_dot2c_f32_bf16 v20, v70, v22
    v_dot2c_f32_bf16 v21, v70, v70
    v_dot2c_f32_bf16 v20, v71, v22
    v_dot2c_f32_bf16 v21, v71, v71
    s_nop 1
    v_add_f32_dpp v20, v20, v20 row_ror:4 row_mask:0xf bank_mask:0xf
    v_add_f32_dpp v21, v21, v21 row_ror:4 row_mask:0xf bank_mask:0xf
    s_nop 0
    v_add_f32_dpp v20, v20, v20 row_ror:8 row_mask:0xf bank_mask:0xf
    v_add_f32_dpp v21, v21, v21 row_ror:8 row_mask:0xf bank_mask:0xf
    v_mov_b32 v22, v20
    v_mov_b32 v23, v21
    s_nop 0
    v_permlane16_swap_b32 v20, v22
    v_permlane16_swap_b32 v21, v23
    v_add_f32 v20, v20, v22
    v_add_f32 v21, v21, v23
    v_mov_b32 v22, v20
    v_mov_b32 v23, v21
    s_nop 0
    v_permlane32_swap_b32 v20, v22
    v_permlane32_swap_b32 v21, v23
    v_add_f32 v20, v20, v22
    v_add_f32 v21, v21, v23
    v_mul_f32 v22, 0x3acccccd, v20
    v_mul_f32 v21, 0x3acccccd, v21
    v_fma_f32 v21, -v22, v22, v21
    v_max_f32 v21, 0, v21
    v_add_f32 v21, 0x3727c5ac, v21
    v_rsq_f32 v20, v21
    s_nop 0
    v_mul_f32_e64 v21, -v22, v20
    v_lshlrev_b32 v24, 16, v72
    v_and_b32 v25, 0xffff0000, v72
    v_lshlrev_b32 v26, 16, v73
    v_and_b32 v27, 0xffff0000, v73
    v_fma_f32 v24, v24, v20, v21
    v_fma_f32 v25, v25, v20, v21
    v_fma_f32 v26, v26, v20, v21
    v_fma_f32 v27, v27, v20, v21
L_nostats:
    s_waitcnt vmcnt(20)
    ds_read_b64_tr_b16 v[96:97], v15 offset:0
    ds_read_b64_tr_b16 v[98:99], v15 offset:512
    ds_read_b64_tr_b16 v[100:101], v15 offset:32
    ds_read_b64_tr_b16 v[102:103], v15 offset:544
    ds_read_b64_tr_b16 v[104:105], v15 offset:64
    ds_read_b64_tr_b16 v[106:107], v15 offset:576
    ds_read_b64_tr_b16 v[108:109], v15 offset:96
    ds_read_b64_tr_b16 v[110:111], v15 offset:608
    s_waitcnt lgkmcnt(7)
    ds_read_b64_tr_b16 v[112:113], v15 offset:4096
    ds_read_b64_tr_b16 v[114:115], v15 offset:4608
    ds_read_b64_tr_b16 v[116:117], v15 offset:4128
    ds_read_b64_tr_b16 v[118:119], v15 offset:4640
    ds_read_b64_tr_b16 v[120:121], v15 offset:4160
    ds_read_b64_tr_b16 v[122:123], v15 offset:4672
    ds_read_b64_tr_b16 v[124:125], v15 offset:4192
    ds_read_b64_tr_b16 v[126:127], v15 offset:4704
    s_waitcnt lgkmcnt(7)
    ds_read_b64_tr_b16 v[128:129], v15 offset:8192
    ds_read_b64_tr_b16 v[130:131], v15 offset:8704
    ds_read_b64_tr_b16 v[132:133], v15 offset:8224
    ds_read_b64_tr_b16 v[134:135], v15 offset:8736
    ds_read_b64_tr_b16 v[136:137], v15 offset:8256
    ds_read_b64_tr_b16 v[138:139], v15 offset:8768
    ds_read_b64_tr_b16 v[140:141], v15 offset:8288
    ds_read_b64_tr_b16 v[142:143], v15 offset:8800
    s_waitcnt lgkmcnt(7)
    ds_read_b64_tr_b16 v[144:145], v15 offset:12288
    ds_read_b64_tr_b16 v[146:147], v15 offset:12800
    ds_read_b64_tr_b16 v[148:149], v15 offset:12320
    ds_read_b64_tr_b16 v[150:151], v15 offset:12832
    ds_read_b64_tr_b16 v[152:153], v15 offset:12352
    ds_read_b64_tr_b16 v[154:155], v15 offset:12864
    ds_read_b64_tr_b16 v[156:157], v15 offset:12384
    ds_read_b64_tr_b16 v[158:159], v15 offset:12896
    s_waitcnt lgkmcnt(7)
    ds_read_b64_tr_b16 v[160:161], v15 offset:16384
    ds_read_b64_tr_b16 v[162:163], v15 offset:16896
    ds_read_b64_tr_b16 v[164:165], v15 offset:16416
    ds_read_b64_tr_b16 v[166:167], v15 offset:16928
    ds_read_b64_tr_b16 v[168:169], v15 offset:16448
    ds_read_b64_tr_b16 v[170:171], v15 offset:16960
    ds_read_b64_tr_b16 v[172:173], v15 offset:16480
    ds_read_b64_tr_b16 v[174:175], v15 offset:16992
    s_waitcnt lgkmcnt(0)
    v_mfma_f32_16x16x32_bf16 v[80:83], v[96:99], v[32:35], 0
    v_mfma_f32_16x16x32_bf16 v[84:87], v[100:103], v[32:35], 0
    v_mfma_f32_16x16x32_bf16 v[88:91], v[104:107], v[32:35], 0
    v_mfma_f32_16x16x32_bf16 v[92:95], v[108:111], v[32:35], 0
    v_mfma_f32_16x16x32_bf16 v[80:83], v[112:115], v[36:39], v[80:83]
    v_mfma_f32_16x16x32_bf16 v[84:87], v[116:119], v[36:39], v[84:87]
    v_mfma_f32_16x16x32_bf16 v[88:91], v[120:123], v[36:39], v[88:91]
    v_mfma_f32_16x16x32_bf16 v[92:95], v[124:127], v[36:39], v[92:95]
    v_mfma_f32_16x16x32_bf16 v[80:83], v[128:131], v[40:43], v[80:83]
    v_mfma_f32_16x16x32_bf16 v[84:87], v[132:135], v[40:43], v[84:87]
    v_mfma_f32_16x16x32_bf16 v[88:91], v[136:139], v[40:43], v[88:91]
    v_mfma_f32_16x16x32_bf16 v[92:95], v[140:143], v[40:43], v[92:95]
    v_mfma_f32_16x16x32_bf16 v[80:83], v[144:147], v[44:47], v[80:83]
    v_mfma_f32_16x16x32_bf16 v[84:87], v[148:151], v[44:47], v[84:87]
    v_mfma_f32_16x16x32_bf16 v[88:91], v[152:155], v[44:47], v[88:91]
    v_mfma_f32_16x16x32_bf16 v[92:95], v[156:159], v[44:47], v[92:95]
    v_mfma_f32_16x16x32_bf16 v[80:83], v[160:163], v[48:51], v[80:83]
    v_mfma_f32_16x16x32_bf16 v[84:87], v[164:167], v[48:51], v[84:87]
    v_mfma_f32_16x16x32_bf16 v[88:91], v[168:171], v[48:51], v[88:91]
    v_mfma_f32_16x16x32_bf16 v[92:95], v[172:175], v[48:51], v[92:95]
    s_cmp_ge_u32 s50, 20
    s_cbranch_scc1 L_adr_rest
    s_cmp_lt_u32 s50, 10
    s_cselect_b32 s34, 5120, 0
    s_cselect_b32 s35, s50, s52
    s_lshl_b32 s35, s35, 9
    s_add_u32 s34, s34, s35
    s_lshl_b32 s35, s51, 15
    s_add_u32 s34, s34, s35
    v_lshrrev_b32 v19, 1, v14
    v_lshl_add_u32 v19, v13, 1, v19
    v_lshlrev_b32 v19, 6, v19
    v_lshl_add_u32 v19, v12, 4, v19
    v_and_b32 v20, 1, v14
    v_lshl_add_u32 v19, v20, 3, v19
    s_branch L_adr_done
L_adr_rest:
    s_lshl_b32 s34, s51, 15
    s_lshl_b32 s35, s50, 9
    s_add_u32 s34, s34, s35
    s_add_u32 s34, s34, 0
    v_lshlrev_b32 v19, 7, v12
    v_lshl_add_u32 v19, v13, 5, v19
    v_lshl_add_u32 v19, v14, 3, v19
    s_nop 3
L_adr_done:
    v_add_u32 v19, s34, v19
    v_mov_b32_dpp v80, v84 quad_perm:[0,1,2,3] row_mask:0xf bank_mask:0x2
    v_mov_b32_dpp v81, v85 quad_perm:[0,1,2,3] row_mask:0xf bank_mask:0x2
    v_mov_b32_dpp v82, v86 quad_perm:[0,1,2,3] row_mask:0xf bank_mask:0x2
    v_mov_b32_dpp v83, v87 quad_perm:[0,1,2,3] row_mask:0xf bank_mask:0x2
    v_mov_b32_dpp v80, v88 quad_perm:[0,1,2,3] row_mask:0xf bank_mask:0x4
    v_mov_b32_dpp v81, v89 quad_perm:[0,1,2,3] row_mask:0xf bank_mask:0x4
    v_mov_b32_dpp v82, v90 quad_perm:[0,1,2,3] row_mask:0xf bank_mask:0x4
    v_mov_b32_dpp v83, v91 quad_perm:[0,1,2,3] row_mask:0xf bank_mask:0x4
    v_mov_b32_dpp v80, v92 quad_perm:[0,1,2,3] row_mask:0xf bank_mask:0x8
    v_mov_b32_dpp v81, v93 quad_perm:[0,1,2,3] row_mask:0xf bank_mask:0x8
    v_mov_b32_dpp v82, v94 quad_perm:[0,1,2,3] row_mask:0xf bank_mask:0x8
    v_mov_b32_dpp v83, v95 quad_perm:[0,1,2,3] row_mask:0xf bank_mask:0x8
    s_cmp_ge_u32 s52, 10
    s_cbranch_scc1 L_noz
    v_add_f32 v80, 0x3e800000, v80
    v_add_f32 v81, 0x3e800000, v81
    v_add_f32 v82, 0x3e800000, v82
    v_add_f32 v83, 0x3e800000, v83
    v_mul_f32 v80, v80, v24
    v_mul_f32 v81, v81, v25
    v_mul_f32 v82, v82, v26
    v_mul_f32 v83, v83, v27
L_noz:
    v_cvt_pk_bf16_f32 v20, v80, v81
    v_cvt_pk_bf16_f32 v21, v82, v83
    v_min_u32 v20, -2, v20
    v_min_u32 v21, -2, v21
    v_and_b32 v22, 15, v0
    v_lshlrev_b32 v22, 2, v22
    s_mov_b32 s35, 0
L_poll3:
    global_load_dword v23, v22, s[30:31] offset:128 sc1
    s_add_u32 s35, s35, 1
    s_waitcnt vmcnt(0)
    v_cmp_eq_u32 vcc, 0, v23
    s_cbranch_vccz L_done4
    s_sleep 8
    s_cmp_lt_u32 s35, 60000
    s_cbranch_scc1 L_poll3
L_done4:
    s_getreg_b32 s97, hwreg(HW_REG_XCC_ID, 0, 4)
    s_sub_u32 s97, s97, s2
    s_and_b32 s97, s97, 7
    s_add_u32 s97, s97, 1
    v_cmp_ne_u32 vcc, s97, v23
    s_nop 0
    s_mov_b32 s97, vcc_lo
    buffer_store_dwordx2 v[20:21], v19, s[44:47], 0 offen sc1
    s_branch L_p2
L_clear:
    s_sub_u32 s55, s2, 240
    s_lshr_b32 s34, s55, 2
    s_lshl_b32 s35, s34, 3
    s_lshr_b32 s54, 538910750, s35
    s_and_b32 s54, s54, 0xff
    s_lshl_b32 s54, s54, 10
    s_mul_i32 s34, s34, 393216
    s_lshl_b32 s35, s51, 15
    s_add_u32 s34, s34, s35
    v_lshl_add_u32 v19, v0, 4, s34
    v_mov_b32 v20, -1
    v_mov_b32 v21, -1
    v_mov_b32 v22, -1
    v_mov_b32 v23, -1
    s_mov_b32 s34, 0
L_clrloop:
    buffer_store_dwordx4 v[20:23], v19, s[44:47], s34 offen offset:0 sc1
    s_add_u32 s34, s34, 1024
    s_cmp_lt_u32 s34, s54
    s_cbranch_scc1 L_clrloop
L_clrend:
    s_cmp_ge_u32 s55, 4
    s_cbranch_scc1 L_clrend2
    s_mov_b32 s34, 1572864
    buffer_store_dwordx4 v[20:23], v19, s[44:47], s34 offen sc1
    s_mov_b32 s34, 1573888
    buffer_store_dwordx4 v[20:23], v19, s[44:47], s34 offen sc1
    s_mov_b32 s34, 1574912
    buffer_store_dwordx4 v[20:23], v19, s[44:47], s34 offen sc1
    s_mov_b32 s34, 1575936
    buffer_store_dwordx4 v[20:23], v19, s[44:47], s34 offen sc1
    s_mov_b32 s34, 1576960
    buffer_store_dwordx4 v[20:23], v19, s[44:47], s34 offen sc1
L_clrend2:
    v_lshlrev_b32 v1, 2, v0
    v_add_u32 v1, 98304, v1
    v_mov_b32 v2, -1
    v_mov_b32 v3, 0
    ds_write_b32 v1, v2
    ds_write_b32 v1, v2 offset:256
    ds_write_b32 v1, v3 offset:512
    ds_write_b32 v1, v3 offset:768
    s_waitcnt lgkmcnt(0)
    s_barrier
    s_lshl_b32 s34, s55, 2
    v_mov_b32 v24, s34
    s_getreg_b32 s97, hwreg(HW_REG_XCC_ID, 0, 4)
    s_sub_u32 s97, s97, s2
    s_and_b32 s97, s97, 7
    s_add_u32 s97, s97, 1
    v_mov_b32 v25, s97
    v_readfirstlane_b32 s90, v19
    s_mov_b32 s91, 0
    s_waitcnt vmcnt(0)
    s_mov_b64 exec, 1
    global_store_dword v24, v25, s[30:31] offset:128 sc1
    s_mov_b64 exec, -1
    s_and_b32 s34, s2, 31
    s_lshl_b32 s34, s34, 8
    s_lshr_b32 s35, s2, 7
    s_lshl_b32 s35, s35, 7
    s_add_u32 s49, s34, s35
    s_bfe_u32 s53, s2, 0x20005
    s_mul_i32 s34, s53, 1310720
    s_add_u32 s34, s34, s49
    v_lshl_add_u32 v16, v10, 13, v11
    v_add_u32 v16, s34, v16
    s_mov_b32 s36, s10
    s_mov_b32 s37, s11
    s_mov_b32 s38, 5242880
    s_mov_b32 m0, 20480
    s_mov_b32 s34, 0
L_dma6:
    buffer_load_dwordx4 v16, s[36:39], s34 offen  lds
    s_add_u32 m0, m0, 1024
    s_add_u32 s34, s34, 65536
    buffer_load_dwordx4 v16, s[36:39], s34 offen  lds
    s_add_u32 m0, m0, 1024
    s_add_u32 s34, s34, 65536
    buffer_load_dwordx4 v16, s[36:39], s34 offen  lds
    s_add_u32 m0, m0, 1024
    s_add_u32 s34, s34, 65536
    buffer_load_dwordx4 v16, s[36:39], s34 offen  lds
    s_add_u32 m0, m0, 1024
    s_add_u32 s34, s34, 65536
    s_cmp_lt_u32 s34, 1310720
    s_cbranch_scc1 L_dma6
    v_lshl_add_u32 v15, v14, 3, v13
    v_lshlrev_b32 v15, 7, v15
    v_lshl_add_u32 v15, v12, 3, v15
    s_add_u32 s34, s90, 0
    s_add_u32 s35, s90, 8192
    s_mov_b64 s[88:89], 0
    s_load_dword s88, s[44:45], s34
    s_load_dword s89, s[44:45], s35
    s_waitcnt lgkmcnt(1)
    s_cmp_lg_u32 s89, 0
    s_addc_u32 s91, s91, 0
    s_waitcnt lgkmcnt(0)
    s_add_u32 s34, s90, 1024
    s_add_u32 s35, s90, 9216
    s_mov_b64 s[88:89], 0
    s_load_dword s89, s[44:45], s35
    s_load_dword s88, s[44:45], s34
    s_waitcnt lgkmcnt(1)
    s_cmp_eq_u32 s88, 0
    s_addc_u32 s91, s91, 0
    s_waitcnt lgkmcnt(0)
    s_add_u32 s34, s90, 2048
    s_add_u32 s35, s90, 10240
    s_mov_b64 s[88:89], 0
    s_load_dword s88, s[44:45], s34
    s_load_dword s89, s[44:45], s35
    s_waitcnt lgkmcnt(1)
    s_cmp_lg_u32 s89, 0
    s_addc_u32 s91, s91, 0
    s_waitcnt lgkmcnt(0)
    s_add_u32 s34, s90, 3072
    s_add_u32 s35, s90, 11264
    s_mov_b64 s[88:89], 0
    s_load_dword s89, s[44:45], s35
    s_load_dword s88, s[44:45], s34
    s_waitcnt lgkmcnt(1)
    s_cmp_eq_u32 s88, 0
    s_addc_u32 s91, s91, 0
    s_waitcnt lgkmcnt(0)
    s_getreg_b32 s34, hwreg(HW_REG_XCC_ID, 2, 1)
    s_sub_u32 s35, 2, s91
    s_sub_u32 s91, s91, 2
    s_cmp_eq_u32 s34, 0
    s_cselect_b32 s91, s91, s35
    v_mov_b32 v25, s91
    s_mov_b64 exec, 1
    global_store_dword v24, v25, s[30:31] sc1
    s_mov_b64 exec, -1
    v_and_b32 v22, 15, v0
    v_lshlrev_b32 v22, 2, v22
    s_mov_b32 s35, 0
L_poll7:
    global_load_dword v23, v22, s[30:31] offset:128 sc1
    s_add_u32 s35, s35, 1
    s_waitcnt vmcnt(0)
    v_cmp_eq_u32 vcc, 0, v23
    s_cbranch_vccz L_done8
    s_sleep 8
    s_cmp_lt_u32 s35, 60000
    s_cbranch_scc1 L_poll7
L_done8:
    s_getreg_b32 s97, hwreg(HW_REG_XCC_ID, 0, 4)
    s_sub_u32 s97, s97, s2
    s_and_b32 s97, s97, 7
    s_add_u32 s97, s97, 1
    v_cmp_ne_u32 vcc, s97, v23
    s_nop 0
    s_mov_b32 s97, vcc_lo
L_p2:
    v_mov_b32 v199, v19
    ds_read_b64_tr_b16 v[96:97], v15 offset:20480
    ds_read_b64_tr_b16 v[98:99], v15 offset:20992
    ds_read_b64_tr_b16 v[100:101], v15 offset:20512
    ds_read_b64_tr_b16 v[102:103], v15 offset:21024
    ds_read_b64_tr_b16 v[104:105], v15 offset:20544
    ds_read_b64_tr_b16 v[106:107], v15 offset:21056
    ds_read_b64_tr_b16 v[108:109], v15 offset:20576
    ds_read_b64_tr_b16 v[110:111], v15 offset:21088
    s_waitcnt lgkmcnt(7)
    ds_read_b64_tr_b16 v[112:113], v15 offset:24576
    ds_read_b64_tr_b16 v[114:115], v15 offset:25088
    ds_read_b64_tr_b16 v[116:117], v15 offset:24608
    ds_read_b64_tr_b16 v[118:119], v15 offset:25120
    ds_read_b64_tr_b16 v[120:121], v15 offset:24640
    ds_read_b64_tr_b16 v[122:123], v15 offset:25152
    ds_read_b64_tr_b16 v[124:125], v15 offset:24672
    ds_read_b64_tr_b16 v[126:127], v15 offset:25184
    s_waitcnt lgkmcnt(7)
    ds_read_b64_tr_b16 v[128:129], v15 offset:28672
    ds_read_b64_tr_b16 v[130:131], v15 offset:29184
    ds_read_b64_tr_b16 v[132:133], v15 offset:28704
    ds_read_b64_tr_b16 v[134:135], v15 offset:29216
    ds_read_b64_tr_b16 v[136:137], v15 offset:28736
    ds_read_b64_tr_b16 v[138:139], v15 offset:29248
    ds_read_b64_tr_b16 v[140:141], v15 offset:28768
    ds_read_b64_tr_b16 v[142:143], v15 offset:29280
    s_waitcnt lgkmcnt(7)
    ds_read_b64_tr_b16 v[144:145], v15 offset:32768
    ds_read_b64_tr_b16 v[146:147], v15 offset:33280
    ds_read_b64_tr_b16 v[148:149], v15 offset:32800
    ds_read_b64_tr_b16 v[150:151], v15 offset:33312
    ds_read_b64_tr_b16 v[152:153], v15 offset:32832
    ds_read_b64_tr_b16 v[154:155], v15 offset:33344
    ds_read_b64_tr_b16 v[156:157], v15 offset:32864
    ds_read_b64_tr_b16 v[158:159], v15 offset:33376
    s_waitcnt lgkmcnt(7)
    ds_read_b64_tr_b16 v[160:161], v15 offset:36864
    ds_read_b64_tr_b16 v[162:163], v15 offset:37376
    ds_read_b64_tr_b16 v[164:165], v15 offset:36896
    ds_read_b64_tr_b16 v[166:167], v15 offset:37408
    ds_read_b64_tr_b16 v[168:169], v15 offset:36928
    ds_read_b64_tr_b16 v[170:171], v15 offset:37440
    ds_read_b64_tr_b16 v[172:173], v15 offset:36960
    ds_read_b64_tr_b16 v[174:175], v15 offset:37472
    s_waitcnt lgkmcnt(0)
    s_mul_i32 s34, s53, 1280
    v_lshlrev_b32 v19, 15, v13
    v_lshl_add_u32 v19, v14, 6, v19
    v_lshl_add_u32 v19, v12, 4, v19
    v_add_u32 v19, s34, v19
    s_movk_i32 s48, 5120
    s_mov_b32 s56, 32768
    s_mov_b32 s57, 65536
    s_mov_b32 s58, 98304
    s_sub_u32 s34, s2, 80
    s_cmp_lt_u32 s34, 160
    s_cselect_b32 s54, 1, 0
    s_and_b32 s34, s2, 3
    s_cselect_b32 s54, 0, s54
    v_mov_b32 v180, 0
    v_mov_b32 v181, 0
    v_mov_b32 v182, 0
    v_mov_b32 v183, 0
    v_mov_b32 v184, 0
    v_mov_b32 v185, 0
    v_mov_b32 v186, 0
    v_mov_b32 v187, 0
    v_mov_b32 v22, 99072
    s_mov_b32 s35, 0
L_poll10:
    ds_read_b32 v23, v22
    s_add_u32 s35, s35, 1
    s_waitcnt lgkmcnt(0)
    v_cmp_gt_u32 vcc, 21, v23
    s_cbranch_vccz L_done11
    s_sleep 2
    s_cmp_lt_u32 s35, 60000
    s_cbranch_scc1 L_poll10
L_done11:
    s_mov_b32 s35, 0
L_poll13:
    buffer_load_dwordx4 v[32:35], v19, s[44:47], 0 offen offset:0 sc1
    buffer_load_dwordx4 v[36:39], v19, s[44:47], s48 offen offset:0 sc1
    buffer_load_dwordx4 v[40:43], v19, s[44:47], 0 offen offset:256 sc1
    buffer_load_dwordx4 v[44:47], v19, s[44:47], s48 offen offset:256 sc1
    buffer_load_dwordx4 v[48:51], v19, s[44:47], 0 offen offset:512 sc1
    buffer_load_dwordx4 v[52:55], v19, s[44:47], s48 offen offset:512 sc1
    buffer_load_dwordx4 v[56:59], v19, s[44:47], 0 offen offset:768 sc1
    buffer_load_dwordx4 v[60:63], v19, s[44:47], s48 offen offset:768 sc1
    buffer_load_dwordx4 v[64:67], v19, s[44:47], 0 offen offset:1024 sc1
    buffer_load_dwordx4 v[68:71], v19, s[44:47], s48 offen offset:1024 sc1
    s_cmp_eq_u32 s54, 0
    s_cbranch_scc1 L_hskip
    buffer_load_dwordx2 v[180:181], v199, s[44:47], 0 offen sc1
    buffer_load_dwordx2 v[182:183], v199, s[44:47], s56 offen sc1
    buffer_load_dwordx2 v[184:185], v199, s[44:47], s57 offen sc1
    buffer_load_dwordx2 v[186:187], v199, s[44:47], s58 offen sc1
L_hskip:
    s_add_u32 s35, s35, 1
    s_waitcnt vmcnt(0)
    v_max3_u32 v20, v32, v33, v34
    v_max3_u32 v20, v20, v35, v36
    v_max3_u32 v20, v20, v37, v38
    v_max3_u32 v20, v20, v39, v40
    v_max3_u32 v20, v20, v41, v42
    v_max3_u32 v20, v20, v43, v44
    v_max3_u32 v20, v20, v45, v46
    v_max3_u32 v20, v20, v47, v48
    v_max3_u32 v20, v20, v49, v50
    v_max3_u32 v20, v20, v51, v52
    v_max3_u32 v20, v20, v53, v54
    v_max3_u32 v20, v20, v55, v56
    v_max3_u32 v20, v20, v57, v58
    v_max3_u32 v20, v20, v59, v60
    v_max3_u32 v20, v20, v61, v62
    v_max3_u32 v20, v20, v63, v64
    v_max3_u32 v20, v20, v65, v66
    v_max3_u32 v20, v20, v67, v68
    v_max3_u32 v20, v20, v69, v70
    v_max3_u32 v20, v20, v71, v180
    v_max3_u32 v20, v20, v181, v182
    v_max3_u32 v20, v20, v183, v184
    v_max3_u32 v20, v20, v185, v186
    v_max_u32 v20, v20, v187
    v_cmp_eq_u32 vcc, -1, v20
    s_cbranch_vccz L_done14
    s_sleep 16
    s_cmp_lt_u32 s35, 60000
    s_cbranch_scc1 L_poll13
L_done14:
    v_mfma_f32_16x16x32_bf16 v[80:83], v[96:99], v[32:35], 0
    v_mfma_f32_16x16x32_bf16 v[84:87], v[100:103], v[32:35], 0
    v_mfma_f32_16x16x32_bf16 v[88:91], v[104:107], v[32:35], 0
    v_mfma_f32_16x16x32_bf16 v[92:95], v[108:111], v[32:35], 0
    v_mfma_f32_16x16x32_bf16 v[80:83], v[96:99], v[36:39], v[80:83]
    v_mfma_f32_16x16x32_bf16 v[84:87], v[100:103], v[36:39], v[84:87]
    v_mfma_f32_16x16x32_bf16 v[88:91], v[104:107], v[36:39], v[88:91]
    v_mfma_f32_16x16x32_bf16 v[92:95], v[108:111], v[36:39], v[92:95]
    v_mfma_f32_16x16x32_bf16 v[80:83], v[112:115], v[40:43], v[80:83]
    v_mfma_f32_16x16x32_bf16 v[84:87], v[116:119], v[40:43], v[84:87]
    v_mfma_f32_16x16x32_bf16 v[88:91], v[120:123], v[40:43], v[88:91]
    v_mfma_f32_16x16x32_bf16 v[92:95], v[124:127], v[40:43], v[92:95]
    v_mfma_f32_16x16x32_bf16 v[80:83], v[112:115], v[44:47], v[80:83]
    v_mfma_f32_16x16x32_bf16 v[84:87], v[116:119], v[44:47], v[84:87]
    v_mfma_f32_16x16x32_bf16 v[88:91], v[120:123], v[44:47], v[88:91]
    v_mfma_f32_16x16x32_bf16 v[92:95], v[124:127], v[44:47], v[92:95]
    v_mfma_f32_16x16x32_bf16 v[80:83], v[128:131], v[48:51], v[80:83]
    v_mfma_f32_16x16x32_bf16 v[84:87], v[132:135], v[48:51], v[84:87]
    v_mfma_f32_16x16x32_bf16 v[88:91], v[136:139], v[48:51], v[88:91]
    v_mfma_f32_16x16x32_bf16 v[92:95], v[140:143], v[48:51], v[92:95]
    v_mfma_f32_16x16x32_bf16 v[80:83], v[128:131], v[52:55], v[80:83]
    v_mfma_f32_16x16x32_bf16 v[84:87], v[132:135], v[52:55], v[84:87]
    v_mfma_f32_16x16x32_bf16 v[88:91], v[136:139], v[52:55], v[88:91]
    v_mfma_f32_16x16x32_bf16 v[92:95], v[140:143], v[52:55], v[92:95]
    v_mfma_f32_16x16x32_bf16 v[80:83], v[144:147], v[56:59], v[80:83]
    v_mfma_f32_16x16x32_bf16 v[84:87], v[148:151], v[56:59], v[84:87]
    v_mfma_f32_16x16x32_bf16 v[88:91], v[152:155], v[56:59], v[88:91]
    v_mfma_f32_16x16x32_bf16 v[92:95], v[156:159], v[56:59], v[92:95]
    v_mfma_f32_16x16x32_bf16 v[80:83], v[144:147], v[60:63], v[80:83]
    v_mfma_f32_16x16x32_bf16 v[84:87], v[148:151], v[60:63], v[84:87]
    v_mfma_f32_16x16x32_bf16 v[88:91], v[152:155], v[60:63], v[88:91]
    v_mfma_f32_16x16x32_bf16 v[92:95], v[156:159], v[60:63], v[92:95]
    v_mfma_f32_16x16x32_bf16 v[80:83], v[160:163], v[64:67], v[80:83]
    v_mfma_f32_16x16x32_bf16 v[84:87], v[164:167], v[64:67], v[84:87]
    v_mfma_f32_16x16x32_bf16 v[88:91], v[168:171], v[64:67], v[88:91]
    v_mfma_f32_16x16x32_bf16 v[92:95], v[172:175], v[64:67], v[92:95]
    v_mfma_f32_16x16x32_bf16 v[80:83], v[160:163], v[68:71], v[80:83]
    v_mfma_f32_16x16x32_bf16 v[84:87], v[164:167], v[68:71], v[84:87]
    v_mfma_f32_16x16x32_bf16 v[88:91], v[168:171], v[68:71], v[88:91]
    v_mfma_f32_16x16x32_bf16 v[92:95], v[172:175], v[68:71], v[92:95]
    s_lshl_b32 s34, s53, 15
    s_lshl_b32 s35, s49, 2
    s_add_u32 s34, s34, s35
    s_add_u32 s34, s34, 393216
    v_lshlrev_b32 v19, 7, v12
    v_lshl_add_u32 v19, v13, 5, v19
    v_lshl_add_u32 v19, v14, 3, v19
    v_add_u32 v19, s34, v19
    v_add_f32_dpp v20, v80, v80 row_ror:8 row_mask:0xf bank_mask:0x3
    v_add_f32_dpp v24, v84, v84 row_ror:8 row_mask:0xf bank_mask:0x3
    v_add_f32_dpp v21, v81, v81 row_ror:8 row_mask:0xf bank_mask:0x3
    v_add_f32_dpp v25, v85, v85 row_ror:8 row_mask:0xf bank_mask:0x3
    v_add_f32_dpp v22, v82, v82 row_ror:8 row_mask:0xf bank_mask:0x3
    v_add_f32_dpp v26, v86, v86 row_ror:8 row_mask:0xf bank_mask:0x3
    v_add_f32_dpp v23, v83, v83 row_ror:8 row_mask:0xf bank_mask:0x3
    v_add_f32_dpp v27, v87, v87 row_ror:8 row_mask:0xf bank_mask:0x3
    v_add_f32_dpp v20, v88, v88 row_ror:8 row_mask:0xf bank_mask:0xc
    v_add_f32_dpp v24, v92, v92 row_ror:8 row_mask:0xf bank_mask:0xc
    v_add_f32_dpp v21, v89, v89 row_ror:8 row_mask:0xf bank_mask:0xc
    v_add_f32_dpp v25, v93, v93 row_ror:8 row_mask:0xf bank_mask:0xc
    v_add_f32_dpp v22, v90, v90 row_ror:8 row_mask:0xf bank_mask:0xc
    v_add_f32_dpp v26, v94, v94 row_ror:8 row_mask:0xf bank_mask:0xc
    v_add_f32_dpp v23, v91, v91 row_ror:8 row_mask:0xf bank_mask:0xc
    v_add_f32_dpp v27, v95, v95 row_ror:8 row_mask:0xf bank_mask:0xc
    v_add_f32_dpp v28, v20, v20 row_shl:4 row_mask:0xf bank_mask:0x5
    v_add_f32_dpp v29, v21, v21 row_shl:4 row_mask:0xf bank_mask:0x5
    v_add_f32_dpp v30, v22, v22 row_shl:4 row_mask:0xf bank_mask:0x5
    v_add_f32_dpp v31, v23, v23 row_shl:4 row_mask:0xf bank_mask:0x5
    v_add_f32_dpp v28, v24, v24 row_shr:4 row_mask:0xf bank_mask:0xa
    v_add_f32_dpp v29, v25, v25 row_shr:4 row_mask:0xf bank_mask:0xa
    v_add_f32_dpp v30, v26, v26 row_shr:4 row_mask:0xf bank_mask:0xa
    v_add_f32_dpp v31, v27, v27 row_shr:4 row_mask:0xf bank_mask:0xa
    v_cvt_pk_bf16_f32 v20, v28, v29
    v_cvt_pk_bf16_f32 v21, v30, v31
    v_min_u32 v20, -2, v20
    v_min_u32 v21, -2, v21
    buffer_store_dwordx2 v[20:21], v19, s[44:47], 0 offen sc1
    s_cmp_eq_u32 s54, 0
    s_cbranch_scc1 L_nomf
    v_lshlrev_b32 v24, 16, v180
    v_and_b32 v25, 0xffff0000, v180
    v_lshlrev_b32 v26, 16, v181
    v_and_b32 v27, 0xffff0000, v181
    v_lshlrev_b32 v28, 16, v182
    v_and_b32 v29, 0xffff0000, v182
    v_lshlrev_b32 v30, 16, v183
    v_and_b32 v31, 0xffff0000, v183
    v_add_f32 v24, v24, v28
    v_add_f32 v25, v25, v29
    v_add_f32 v26, v26, v30
    v_add_f32 v27, v27, v31
    v_lshlrev_b32 v28, 16, v184
    v_and_b32 v29, 0xffff0000, v184
    v_lshlrev_b32 v30, 16, v185
    v_and_b32 v31, 0xffff0000, v185
    v_add_f32 v24, v24, v28
    v_add_f32 v25, v25, v29
    v_add_f32 v26, v26, v30
    v_add_f32 v27, v27, v31
    v_lshlrev_b32 v28, 16, v186
    v_and_b32 v29, 0xffff0000, v186
    v_lshlrev_b32 v30, 16, v187
    v_and_b32 v31, 0xffff0000, v187
    v_add_f32 v24, v24, v28
    v_add_f32 v25, v25, v29
    v_add_f32 v26, v26, v30
    v_add_f32 v27, v27, v31
    v_cvt_pk_bf16_f32 v22, v24, v25
    v_cvt_pk_bf16_f32 v23, v26, v27
    v_min_u32 v22, -2, v22
    v_min_u32 v23, -2, v23
    s_sub_u32 s34, s50, 20
    s_lshl_b32 s35, s34, 9
    v_subrev_u32 v199, s35, v199
    s_lshr_b32 s35, s34, 2
    s_lshl_b32 s35, s35, 9
    s_and_b32 s34, s34, 3
    s_lshl_b32 s34, s34, 15
    s_add_u32 s34, s34, s35
    s_add_u32 s34, s34, 1562624
    v_add_u32 v199, s34, v199
    buffer_store_dwordx2 v[22:23], v199, s[44:47], 0 offen sc1
L_nomf:
    s_and_b32 s34, s2, 127
    s_lshl_b32 s34, s34, 21
    s_lshr_b32 s35, s2, 7
    s_lshl_b32 s35, s35, 18
    s_add_u32 s34, s34, s35
    s_add_u32 s34, s34, 1572864
    s_mov_b32 s38, 0x40000
    s_mov_b32 s42, 0x40000
    s_waitcnt lgkmcnt(0)
    s_add_u32 s36, s6, s34
    s_addc_u32 s37, s7, 0
    s_add_u32 s40, s8, s34
    s_addc_u32 s41, s9, 0
    v_lshlrev_b32 v18, 4, v0
    s_mov_b32 s34, 258048
    buffer_load_dwordx4 v[128:131], v18, s[36:39], s34 offen offset:0 nt
    buffer_load_dwordx4 v[132:135], v18, s[36:39], s34 offen offset:1024 nt
    buffer_load_dwordx4 v[136:139], v18, s[36:39], s34 offen offset:2048 nt
    buffer_load_dwordx4 v[140:143], v18, s[36:39], s34 offen offset:3072 nt
    s_and_b32 s34, s2, 31
    s_lshl_b32 s34, s34, 10
    s_lshl_b32 s35, s53, 7
    s_add_u32 s34, s34, s35
    s_add_u32 s34, s34, 393216
    v_lshrrev_b32 v19, 5, v0
    v_mul_u32_u24 v19, 384, v19
    v_lshl_add_u32 v19, v0, 2, v19
    v_add_u32 v19, s34, v19
    v_mov_b32 v22, 99072
    s_and_b32 s34, s60, 3
    s_lshl_b32 s34, s34, 15
    s_lshr_b32 s35, s60, 2
    s_lshl_b32 s35, s35, 7
    s_add_u32 s34, s34, s35
    s_add_u32 s34, s34, 793344
    v_and_b32 v252, 31, v0
    v_lshl_add_u32 v252, v252, 2, s34
    v_mov_b32 v253, 0
    s_mov_b32 s35, 0
L_poll16:
    ds_read_b32 v23, v22
    s_add_u32 s35, s35, 1
    s_waitcnt lgkmcnt(0)
    v_cmp_gt_u32 vcc, 33, v23
    s_cbranch_vccz L_done17
    s_sleep 2
    s_cmp_lt_u32 s35, 60000
    s_cbranch_scc1 L_poll16
L_done17:
    buffer_load_dword v251, v252, s[44:47], 0 offen sc1
    s_lshl_b64 exec, 1, s61
    buffer_store_dword v253, v252, s[44:47], 0 offen
    s_mov_b64 exec, -1
    v_and_b32 v44, 15, v0
    v_lshlrev_b32 v44, 2, v44
    global_load_dword v44, v44, s[30:31] sc1
    s_mov_b32 s35, 0
L_poll19:
    buffer_load_dword v32, v19, s[44:47], 0 offen sc1
    buffer_load_dword v33, v19, s[44:47], s56 offen sc1
    buffer_load_dword v34, v19, s[44:47], s57 offen sc1
    buffer_load_dword v35, v19, s[44:47], s58 offen sc1
    s_add_u32 s35, s35, 1
    s_waitcnt vmcnt(0)
    v_max3_u32 v22, v32, v33, v34
    v_max_u32 v22, v22, v35
    v_cmp_eq_u32 vcc, -1, v22
    s_cbranch_vccz L_done20
    s_sleep 16
    s_cmp_lt_u32 s35, 60000
    s_cbranch_scc1 L_poll19
L_done20:
    v_cmp_ne_u32 vcc, -1, v251
    v_mov_b32 v252, 99076
    s_bcnt1_i32_b32 s34, vcc_lo
    v_mov_b32 v251, s34
    s_mov_b64 exec, 1
    ds_write_b32 v252, v251
    s_mov_b64 exec, -1
    v_add_u32_dpp v44, v44, v44 row_ror:8 row_mask:0xf bank_mask:0xf
    s_nop 1
    v_add_u32_dpp v44, v44, v44 row_ror:4 row_mask:0xf bank_mask:0xf
    s_nop 1
    v_add_u32_dpp v44, v44, v44 row_ror:2 row_mask:0xf bank_mask:0xf
    s_nop 1
    v_add_u32_dpp v44, v44, v44 row_ror:1 row_mask:0xf bank_mask:0xf
    s_nop 0
    v_readfirstlane_b32 s99, v44
    s_nop 0
    s_cmp_gt_i32 s99, 0
    s_cselect_b32 s99, 1, 0
    s_getreg_b32 s34, hwreg(HW_REG_XCC_ID, 2, 1)
    s_xor_b32 s99, s99, s34
    s_lshl_b32 s99, s99, 13
    v_mov_b32 v45, 99080
    v_mov_b32 v44, s99
    ds_write_b32 v45, v44
    v_lshlrev_b32 v36, 16, v32
    v_and_b32 v37, 0xffff0000, v32
    v_lshlrev_b32 v38, 16, v33
    v_and_b32 v39, 0xffff0000, v33
    v_lshlrev_b32 v40, 16, v34
    v_and_b32 v41, 0xffff0000, v34
    v_lshlrev_b32 v42, 16, v35
    v_and_b32 v43, 0xffff0000, v35
    v_pk_add_f32 v[36:37], v[36:37], v[38:39]
    v_pk_add_f32 v[40:41], v[40:41], v[42:43]
    v_pk_add_f32 v[36:37], v[36:37], v[40:41]
    v_cvt_pk_bf16_f32 v32, v36, v37
    v_min_u32 v32, -2, v32
    ds_write_b32 v1, v32
    s_mov_b32 s34, 258048
    buffer_load_dwordx4 v[144:147], v18, s[40:43], s34 offen offset:0 nt
    buffer_load_dwordx4 v[148:151], v18, s[40:43], s34 offen offset:1024 nt
    buffer_load_dwordx4 v[152:155], v18, s[40:43], s34 offen offset:2048 nt
    buffer_load_dwordx4 v[156:159], v18, s[40:43], s34 offen offset:3072 nt
    v_and_b32 v2, 15, v0
    v_lshlrev_b32 v2, 4, v2
    v_add_u32 v2, 98304, v2
    ds_read_b128 v[4:7], v2
    s_waitcnt lgkmcnt(0)
    v_dot2_f32_bf16 v8, v128, v4, 0
    v_dot2_f32_bf16 v9, v132, v4, 0
    v_dot2_f32_bf16 v10, v136, v4, 0
    v_dot2_f32_bf16 v11, v140, v4, 0
    v_dot2c_f32_bf16 v8, v129, v5
    v_dot2c_f32_bf16 v9, v133, v5
    v_dot2c_f32_bf16 v10, v137, v5
    v_dot2c_f32_bf16 v11, v141, v5
    v_dot2c_f32_bf16 v8, v130, v6
    v_dot2c_f32_bf16 v9, v134, v6
    v_dot2c_f32_bf16 v10, v138, v6
    v_dot2c_f32_bf16 v11, v142, v6
    v_dot2c_f32_bf16 v8, v131, v7
    v_dot2c_f32_bf16 v9, v135, v7
    v_dot2c_f32_bf16 v10, v139, v7
    v_dot2c_f32_bf16 v11, v143, v7
    v_add_f32_dpp v16, v8, v8 row_ror:8 row_mask:0xf bank_mask:0x3
    v_add_f32_dpp v16, v9, v9 row_ror:8 row_mask:0xf bank_mask:0xc
    v_add_f32_dpp v17, v10, v10 row_ror:8 row_mask:0xf bank_mask:0x3
    v_add_f32_dpp v17, v11, v11 row_ror:8 row_mask:0xf bank_mask:0xc
    v_add_f32_dpp v16, v16, v16 row_half_mirror row_mask:0xf bank_mask:0xf
    s_nop 0
    v_add_f32_dpp v17, v17, v17 row_half_mirror row_mask:0xf bank_mask:0xf
    v_add_f32_dpp v16, v16, v16 quad_perm:[1,0,3,2] row_mask:0xf bank_mask:0xf
    s_nop 0
    v_add_f32_dpp v17, v17, v17 quad_perm:[1,0,3,2] row_mask:0xf bank_mask:0xf
    v_add_f32_dpp v16, v16, v16 quad_perm:[2,3,0,1] row_mask:0xf bank_mask:0xf
    s_nop 0
    v_add_f32_dpp v17, v17, v17 quad_perm:[2,3,0,1] row_mask:0xf bank_mask:0xf
    v_max_f32 v8, v16, v17
    s_mov_b32 s34, 0x3e0293ee
    s_nop 0
    v_max_f32_dpp v8, v8, v8 row_ror:8 row_mask:0xf bank_mask:0xf
    v_mov_b32 v9, v8
    s_nop 1
    v_permlane16_swap_b32 v8, v9
    v_max_f32 v8, v8, v9
    v_mov_b32 v9, v8
    s_nop 1
    v_permlane32_swap_b32 v8, v9
    v_max_f32 v8, v8, v9
    v_mul_f32 v8, s34, v8
    v_fma_f32 v16, v16, s34, -v8
    v_fma_f32 v17, v17, s34, -v8
    v_exp_f32 v16, v16
    v_exp_f32 v17, v17
    s_nop 0
    v_add_f32 v9, v16, v17
    v_and_b32 v10, 1, v0
    v_lshlrev_b32 v10, 4, v10
    v_mov_b32 v11, 0xffff
    v_lshlrev_b32 v10, v10, v11
    v_bfe_u32 v11, v0, 1, 2
    v_cmp_eq_u32 vcc, 0, v11
    s_nop 1
    v_cndmask_b32 v20, 0, v10, vcc
    v_cmp_eq_u32 vcc, 1, v11
    s_nop 1
    v_cndmask_b32 v21, 0, v10, vcc
    v_cmp_eq_u32 vcc, 2, v11
    s_nop 1
    v_cndmask_b32 v22, 0, v10, vcc
    v_cmp_eq_u32 vcc, 3, v11
    s_nop 1
    v_cndmask_b32 v23, 0, v10, vcc
    v_add_f32_dpp v9, v9, v9 row_ror:8 row_mask:0xf bank_mask:0xf
    v_mov_b32 v10, v9
    s_nop 1
    v_permlane16_swap_b32 v9, v10
    v_add_f32 v9, v9, v10
    v_mov_b32 v10, v9
    s_nop 1
    v_permlane32_swap_b32 v9, v10
    v_add_f32 v9, v9, v10
    v_mov_b32 v10, 98616
    s_mov_b64 exec, 1
    ds_write_b64 v10, v[8:9]
    s_mov_b64 exec, -1
    s_waitcnt vmcnt(0)
    v_cvt_pk_bf16_f32 v10, v16, v16
    v_and_b32 v24, v10, v20
    v_and_b32 v25, v10, v21
    v_and_b32 v26, v10, v22
    v_and_b32 v27, v10, v23
    s_nop 1
    v_mfma_f32_16x16x32_bf16 v[116:119], v[144:147], v[24:27], 0
    v_mfma_f32_16x16x32_bf16 v[120:123], v[148:151], v[24:27], 0
    v_cvt_pk_bf16_f32 v10, v17, v17
    v_and_b32 v28, v10, v20
    v_and_b32 v29, v10, v21
    v_and_b32 v30, v10, v22
    v_and_b32 v31, v10, v23
    s_nop 1
    v_mfma_f32_16x16x32_bf16 v[116:119], v[152:155], v[28:31], v[116:119]
    v_mfma_f32_16x16x32_bf16 v[120:123], v[156:159], v[28:31], v[120:123]
    s_mov_b32 s34, 106496
    v_lshrrev_b32 v16, 4, v0
    v_and_b32 v17, 7, v0
    v_lshl_add_u32 v16, v16, 3, v17
    v_bfe_u32 v17, v0, 3, 1
    v_lshl_add_u32 v16, v17, 5, v16
    v_lshl_add_u32 v16, v16, 4, s34
    s_nop 0
    v_add_f32_dpp v116, v120, v116 row_ror:8 row_mask:0xf bank_mask:0xf
    v_add_f32_dpp v117, v121, v117 row_ror:8 row_mask:0xf bank_mask:0xf
    v_add_f32_dpp v118, v122, v118 row_ror:8 row_mask:0xf bank_mask:0xf
    v_add_f32_dpp v119, v123, v119 row_ror:8 row_mask:0xf bank_mask:0xf
    ds_write_b128 v16, v[116:119]
    v_lshl_add_u32 v16, v0, 3, s34
    ds_read_b64 v[116:117], v16
    s_waitcnt lgkmcnt(0)
    s_mov_b32 s63, 0
    s_mov_b32 s62, s61
    s_cmp_lt_u32 s61, 20
    s_cbranch_scc1 L_rd22
    s_mul_i32 s62, s60, 12
    s_add_u32 s62, s62, s61
    s_sub_u32 s62, s62, 20
    s_mov_b32 s63, 1
    s_cmp_lt_u32 s62, 54
    s_cbranch_scc1 L_rd22
    s_cmp_lt_u32 s62, 56
    s_cselect_b32 s63, 3, 2
    s_sub_u32 s62, s62, 56
L_rd22:
    v_and_b32 v8, 3, v0
    v_bfe_u32 v9, v0, 2, 2
    v_lshrrev_b32 v10, 4, v0
    s_mov_b32 s55, 0x20000
    s_lshl_b32 s35, s62, 6
    s_and_b32 s49, s62, 1
    s_cmp_eq_u32 s63, 0
    s_cbranch_scc1 L_dp24
    s_cmp_eq_u32 s63, 1
    s_cbranch_scc1 L_dp25
    s_mov_b32 s52, s20
    s_mov_b32 s53, s21
    s_mov_b32 s54, 2211840
    v_mov_b32 v15, 0
    s_branch L_dp26
L_dp25:
    s_mov_b32 s52, s16
    s_mov_b32 s53, s17
    s_mov_b32 s54, 2211840
    v_lshl_add_u32 v15, v9, 3, v10
    v_mul_u32_u24 v15, 3456, v15
    v_lshl_add_u32 v15, v8, 4, v15
    v_add_u32 v15, s35, v15
    s_bfe_u32 s50, s3, 0x10001
    s_lshl_b32 s50, s50, 7
    s_and_b32 s34, s3, 1
    s_lshl_b32 s34, s34, 2
    s_add_u32 s50, s50, s34
    s_and_b32 s51, s3, 3
    s_lshl_b32 s51, s51, 5
    s_add_u32 s51, s51, 512
    s_mul_i32 s50, s50, 3456
    s_mul_i32 s51, s51, 3456
    s_branch L_dp26
L_dp24:
    s_mov_b32 s52, s12
    s_mov_b32 s53, s13
    s_mov_b32 s54, 5242880
    s_lshr_b32 s50, s3, 1
    s_lshl_b32 s50, s50, 3
    s_add_u32 s50, s50, s60
    s_and_b32 s51, s3, 1
    s_lshl_b32 s34, s50, 1
    s_add_u32 s34, s34, s51
    s_mul_i32 s34, s34, 81920
    s_add_u32 s34, s34, s35
    v_lshl_add_u32 v15, v9, 2, v10
    v_mul_u32_u24 v15, 2560, v15
    v_lshl_add_u32 v15, v8, 4, v15
    v_add_u32 v15, s34, v15
    s_lshl_b32 s56, s3, 12
    s_lshl_b32 s34, s49, 11
    s_add_u32 s56, s56, s34
    s_add_u32 s56, s56, 40960
    s_add_u32 s58, s56, 1024
    s_mul_i32 s57, s49, 40960
    s_add_u32 s59, s57, 1280
L_dp26:
    v_and_b32 v200, 3, v0
    v_bfe_u32 v201, v0, 2, 2
    v_lshrrev_b32 v202, 4, v0
    s_lshl_b32 s34, s3, 10
    s_add_u32 s34, s34, 122112
    v_mul_u32_u24 v203, 320, v201
    v_min_u32 v203, 704, v203
    v_lshl_add_u32 v203, v202, 6, v203
    v_lshl_add_u32 v203, v200, 4, v203
    v_add_u32 v203, s34, v203
    s_movk_i32 s48, 16384
    v_mov_b32 v197, 0
    s_mov_b32 s40, 0
    s_mov_b32 s41, 0
    s_mov_b32 s42, 0
    s_cmp_eq_u32 s63, 0
    s_cbranch_scc1 L_d_wo
    s_cmp_eq_u32 s63, 2
    s_cbranch_scc1 L_d_w2
    s_cmp_eq_u32 s63, 3
    s_cbranch_scc1 L_d_none
    v_and_b32 v205, 15, v0
    v_lshlrev_b32 v205, 4, v205
    s_and_b32 s49, s3, 3
    s_mul_i32 s34, s49, 1280
    s_add_u32 s34, s34, s99
    s_add_u32 s34, s34, 786432
    v_lshl_add_u32 v206, v202, 15, v205
    v_add_u32 v206, s34, v206
    s_mul_i32 s34, s49, 3840
    v_add_u32 v205, s34, v205
    s_lshl_b32 s34, s62, 6
    v_lshlrev_b32 v5, 4, v14
    v_lshl_add_u32 v5, v12, 2, v5
    v_add_u32 v5, s34, v5
    global_load_dword v6, v5, s[18:19]
    v_and_b32 v7, 15, v0
    v_lshlrev_b32 v7, 4, v7
    v_mul_u32_u24 v8, 1280, v14
    v_add_u32 v8, v8, v7
    v_bfe_u32 v9, v0, 3, 1
    v_lshlrev_b32 v9, 15, v9
    v_lshl_add_u32 v9, v14, 7, v9
    v_and_b32 v10, 7, v0
    v_lshl_add_u32 v9, v10, 4, v9
    v_add_u32 v9, 1572864, v9
    s_mov_b32 s57, 65536
    v_mul_u32_u24 v5, 3840, v14
    v_add_u32 v5, v5, v7
    global_load_dwordx4 v[32:35], v8, s[4:5] offset:0
    global_load_dwordx4 v[36:39], v8, s[4:5] offset:256
    global_load_dwordx4 v[40:43], v8, s[4:5] offset:512
    global_load_dwordx4 v[44:47], v8, s[4:5] offset:768
    global_load_dwordx4 v[48:51], v8, s[4:5] offset:1024
    s_mov_b32 s35, 0
L_poll27:
    buffer_load_dwordx4 v[52:55], v9, s[44:47], s57 offen offset:1024 sc1
    buffer_load_dwordx4 v[56:59], v9, s[44:47], 0 offen offset:1536 sc1
    buffer_load_dwordx4 v[60:63], v9, s[44:47], s57 offen offset:1536 sc1
    buffer_load_dwordx4 v[64:67], v9, s[44:47], 0 offen offset:2048 sc1
    buffer_load_dwordx4 v[68:71], v9, s[44:47], s57 offen offset:2048 sc1
    buffer_load_dwordx4 v[72:75], v9, s[44:47], 0 offen offset:2560 sc1
    buffer_load_dwordx4 v[76:79], v9, s[44:47], s57 offen offset:2560 sc1
    buffer_load_dwordx4 v[80:83], v9, s[44:47], 0 offen offset:3072 sc1
    buffer_load_dwordx4 v[84:87], v9, s[44:47], s57 offen offset:3072 sc1
    buffer_load_dwordx4 v[88:91], v9, s[44:47], 0 offen offset:3584 sc1
    s_add_u32 s35, s35, 1
    s_waitcnt vmcnt(0)
    v_max3_u32 v28, v52, v53, v54
    v_max3_u32 v28, v28, v55, v56
    v_max3_u32 v28, v28, v57, v58
    v_max3_u32 v28, v28, v59, v60
    v_max3_u32 v28, v28, v61, v62
    v_max3_u32 v28, v28, v63, v64
    v_max3_u32 v28, v28, v65, v66
    v_max3_u32 v28, v28, v67, v68
    v_max3_u32 v28, v28, v69, v70
    v_max3_u32 v28, v28, v71, v72
    v_max3_u32 v28, v28, v73, v74
    v_max3_u32 v28, v28, v75, v76
    v_max3_u32 v28, v28, v77, v78
    v_max3_u32 v28, v28, v79, v80
    v_max3_u32 v28, v28, v81, v82
    v_max3_u32 v28, v28, v83, v84
    v_max3_u32 v28, v28, v85, v86
    v_max3_u32 v28, v28, v87, v88
    v_max3_u32 v28, v28, v89, v90
    v_max_u32 v28, v28, v91
    v_cmp_eq_u32 vcc, -1, v28
    s_cbranch_vccz L_done28
    s_sleep 16
    s_cmp_lt_u32 s35, 60000
    s_cbranch_scc1 L_poll27
L_done28:
    ds_write_b128 v5, v[32:35] offset:0
    ds_write_b128 v5, v[36:39] offset:256
    ds_write_b128 v5, v[40:43] offset:512
    ds_write_b128 v5, v[44:47] offset:768
    ds_write_b128 v5, v[48:51] offset:1024
    ds_write_b128 v5, v[52:55] offset:1280
    ds_write_b128 v5, v[56:59] offset:1536
    ds_write_b128 v5, v[60:63] offset:1792
    ds_write_b128 v5, v[64:67] offset:2048
    ds_write_b128 v5, v[68:71] offset:2304
    ds_write_b128 v5, v[72:75] offset:2560
    ds_write_b128 v5, v[76:79] offset:2816
    ds_write_b128 v5, v[80:83] offset:3072
    ds_write_b128 v5, v[84:87] offset:3328
    ds_write_b128 v5, v[88:91] offset:3584
    s_waitcnt lgkmcnt(0)
    v_lshlrev_b32 v100, 16, v6
    v_and_b32 v101, 0xffff0000, v6
    s_cmp_eq_u32 s60, 4
    s_cselect_b32 s40, 6, 12
    s_mov_b32 s41, 5462
    s_cmov_b32 s41, 10923
    s_cselect_b32 s34, 20, 20
    s_mov_b32 s49, 17280
    s_cmov_b32 s49, 34560
    v_min_u32 v196, 59, v0
    v_mul_u32_u24 v197, s41, v196
    v_lshrrev_b32 v197, 16, v197
    v_mul_u32_u24 v194, s40, v197
    v_sub_u32 v196, v196, v194
    v_mul_u32_u24 v197, 3456, v197
    v_lshl_add_u32 v197, v196, 6, v197
    s_mul_i32 s35, s60, 768
    s_add_i32 s35, s35, 0
    s_cmp_eq_u32 s60, 4
    s_cselect_b32 s35, 3072, s35
    s_sub_u32 s34, s61, s34
    s_mul_i32 s34, s34, s49
    s_mul_i32 s34, s34, 11
    s_add_u32 s34, s34, s35
    v_add_u32 v197, s34, v197
    s_mov_b32 s40, s49
    s_mov_b32 s41, s49
    s_branch L_d_none
L_d_w2:
    s_lshl_b32 s34, s62, 5
    v_lshl_add_u32 v3, v14, 3, s34
    global_load_dwordx2 v[20:21], v3, s[22:23]
    v_mul_u32_u24 v112, 1280, v12
    v_add_u32 v112, v112, v3
    global_load_dwordx2 v[22:23], v112, s[4:5]
    s_lshr_b32 s34, s62, 2
    s_add_u32 s34, s34, 30
    s_lshr_b32 s35, s34, 2
    s_lshl_b32 s35, s35, 9
    s_and_b32 s34, s34, 3
    s_lshl_b32 s34, s34, 15
    s_add_u32 s34, s34, s35
    s_and_b32 s35, s62, 3
    s_mul_i32 s35, s35, 32
    s_add_u32 s34, s34, s35
    s_add_u32 s34, s34, 1572864
    v_lshlrev_b32 v5, 7, v12
    v_lshl_add_u32 v5, v14, 3, v5
    v_add_u32 v5, s34, v5
    s_waitcnt vmcnt(0)
    v_lshlrev_b32 v32, 16, v20
    v_and_b32 v33, 0xffff0000, v20
    v_lshlrev_b32 v34, 16, v21
    v_and_b32 v35, 0xffff0000, v21
    v_lshlrev_b32 v108, 16, v22
    v_and_b32 v109, 0xffff0000, v22
    v_lshlrev_b32 v110, 16, v23
    v_and_b32 v111, 0xffff0000, v23
    s_mov_b32 s35, 0
L_poll30:
    buffer_load_dwordx2 v[24:25], v5, s[44:47], 0 offen sc1
    s_add_u32 s35, s35, 1
    s_waitcnt vmcnt(0)
    v_max_u32 v28, v24, v25
    v_cmp_eq_u32 vcc, -1, v28
    s_cbranch_vccz L_done31
    s_sleep 16
    s_cmp_lt_u32 s35, 60000
    s_cbranch_scc1 L_poll30
L_done31:
    v_lshlrev_b32 v104, 16, v24
    v_and_b32 v105, 0xffff0000, v24
    v_lshlrev_b32 v106, 16, v25
    v_and_b32 v107, 0xffff0000, v25
    v_fma_f32 v108, v104, v32, v108
    v_fma_f32 v109, v105, v33, v109
    v_fma_f32 v110, v106, v34, v110
    v_fma_f32 v111, v107, v35, v111
    v_mul_f32 v108, 0x3e800000, v108
    v_mul_f32 v109, 0x3e800000, v109
    v_mul_f32 v110, 0x3e800000, v110
    v_mul_f32 v111, 0x3e800000, v111
    v_lshl_add_u32 v204, v13, 15, v112
    s_add_u32 s34, s99, 786432
    v_add_u32 v204, s34, v204
    s_cmp_eq_u32 s60, 4
    s_cselect_b32 s40, 2, 6
    s_mov_b32 s41, 10923
    s_cmov_b32 s41, 32769
    s_cselect_b32 s34, 28, 20
    s_mov_b32 s49, 12800
    s_cmov_b32 s49, 38400
    v_min_u32 v196, 59, v0
    v_mul_u32_u24 v197, s41, v196
    v_lshrrev_b32 v197, 16, v197
    v_mul_u32_u24 v194, s40, v197
    v_sub_u32 v196, v196, v194
    v_mul_u32_u24 v197, 1280, v197
    v_lshl_add_u32 v197, v196, 6, v197
    s_mul_i32 s35, s60, 384
    s_add_i32 s35, s35, -1792
    s_cmp_eq_u32 s60, 4
    s_cselect_b32 s35, 0, s35
    s_sub_u32 s34, s61, s34
    s_mul_i32 s34, s34, s49
    s_mul_i32 s34, s34, 15
    s_add_u32 s34, s34, s35
    v_add_u32 v197, s34, v197
    s_mov_b32 s40, s49
    s_mov_b32 s41, s49
    s_branch L_d_none
L_d_wo:
    s_lshr_b32 s49, s3, 1
    s_lshl_b32 s49, s49, 15
    v_and_b32 v210, 7, v0
    s_mul_i32 s34, s60, 4096
    s_add_u32 s34, s34, s49
    s_add_u32 s34, s34, 1179904
    v_lshrrev_b32 v211, 3, v0
    v_mul_u32_u24 v205, 512, v211
    v_add_u32 v204, s34, v205
    s_lshl_b32 s35, s51, 7
    s_add_u32 s34, s34, s35
    s_sub_u32 s34, s34, 256
    v_lshl_add_u32 v205, v210, 4, v205
    v_add_u32 v205, s34, v205
    s_lshl_b32 s34, s3, 12
    s_add_u32 s34, s34, 40960
    v_lshrrev_b32 v206, 2, v0
    v_lshlrev_b32 v206, 6, v206
    v_lshl_add_u32 v206, v200, 3, v206
    v_add_u32 v206, s34, v206
    s_mul_i32 s34, s3, 1152
    s_add_u32 s34, s34, 107520
    v_mul_u32_u24 v207, 144, v211
    v_lshl_add_u32 v207, v210, 4, v207
    v_add_u32 v207, s34, v207
    v_mul_u32_u24 v208, 144, v210
    v_lshl_add_u32 v208, v202, 4, v208
    v_add_u32 v208, s34, v208
    v_mul_u32_u24 v212, 144, v211
    v_add_u32 v212, s34, v212
    v_mul_u32_u24 v213, 144, v210
    v_add_u32 v213, s34, v213
    v_and_b32 v211, 1, v211
    v_bfe_u32 v203, v0, 1, 2
    v_mul_u32_u24 v203, 144, v203
    v_and_b32 v214, 1, v0
    v_mul_u32_u24 v214, 576, v214
    v_lshl_add_u32 v214, v211, 6, v214
    v_lshl_add_u32 v214, v202, 4, v214
    s_add_u32 s34, s34, 14592
    v_add3_u32 v203, v203, v214, s34
    v_mov_b32 v210, 98816
    v_cmp_eq_u32 vcc, 0, v211
    s_nop 1
    v_cndmask_b32 v209, v208, v210, vcc
    v_cndmask_b32 v208, v210, v208, vcc
    v_and_b32 v8, 15, v0
    s_lshr_b32 s34, s62, 1
    s_add_u32 s34, s34, 0
    s_lshr_b32 s35, s34, 2
    s_lshl_b32 s35, s35, 9
    s_and_b32 s34, s34, 3
    s_lshl_b32 s34, s34, 15
    s_add_u32 s34, s34, s35
    s_and_b32 s35, s62, 1
    s_mul_i32 s35, s35, 64
    s_add_u32 s34, s34, s35
    s_add_u32 s34, s34, 1572864
    v_lshlrev_b32 v9, 2, v8
    v_lshl_add_u32 v9, v14, 7, v9
    v_add_u32 v9, s34, v9
    s_lshr_b32 s34, s60, 2
    s_lshl_b32 s34, s34, 14
    s_and_b32 s35, s60, 3
    s_lshl_b32 s35, s35, 15
    s_add_u32 s34, s34, s35
    s_lshl_b32 s35, s62, 6
    s_add_u32 s34, s34, s35
    s_add_u32 s34, s34, 786432
    v_mul_u32_u24 v112, 1280, v14
    v_lshl_add_u32 v112, v8, 2, v112
    v_add_u32 v112, s34, v112
    v_mul_u32_u24 v113, 144, v14
    v_lshl_add_u32 v113, v8, 3, v113
    v_add_u32 v113, 122112, v113
    s_bfe_u32 s35, s60, 0x10002
    s_lshl_b32 s35, s35, 13
    s_xor_b32 s101, s99, s35
    s_xor_b32 s93, s101, 8192
    s_mul_i32 s34, s62, 52
    s_lshr_b32 s34, s34, 8
    s_mul_i32 s35, s34, 5
    s_sub_u32 s35, s62, s35
    s_mul_i32 s34, s34, 1310720
    s_lshl_b32 s35, s35, 15
    s_add_u32 s34, s34, s35
    s_mul_i32 s35, s60, 163840
    s_add_u32 s34, s34, s35
    v_lshl_add_u32 v197, v0, 6, s34
    s_movk_i32 s40, 4096
    s_movk_i32 s41, 4096
    s_mov_b32 s35, 0
L_poll33:
    buffer_load_dword v32, v9, s[44:47], 0 offen sc1
    s_add_u32 s35, s35, 1
    s_waitcnt vmcnt(0)
    v_mov_b32 v22, v32
    v_cmp_eq_u32 vcc, -1, v22
    s_cbranch_vccz L_done34
    s_sleep 16
    s_cmp_lt_u32 s35, 60000
    s_cbranch_scc1 L_poll33
L_done34:
    v_lshlrev_b32 v100, 16, v32
    v_and_b32 v101, 0xffff0000, v32
L_d_none:
    v_mov_b32 v22, 99072
    s_and_b32 s34, s60, 3
    s_lshl_b32 s34, s34, 15
    s_lshr_b32 s35, s60, 2
    s_lshl_b32 s35, s35, 7
    s_add_u32 s34, s34, s35
    s_add_u32 s34, s34, 793600
    v_and_b32 v252, 31, v0
    v_lshl_add_u32 v252, v252, 2, s34
    v_mov_b32 v253, 0
    s_mov_b32 s35, 0
L_poll36:
    ds_read_b32 v23, v22
    s_add_u32 s35, s35, 1
    s_waitcnt lgkmcnt(0)
    v_cmp_gt_u32 vcc, 47, v23
    s_cbranch_vccz L_done37
    s_sleep 2
    s_cmp_lt_u32 s35, 60000
    s_cbranch_scc1 L_poll36
L_done37:
    buffer_load_dword v251, v252, s[44:47], 0 offen sc1
    s_lshl_b64 exec, 1, s61
    buffer_store_dword v253, v252, s[44:47], 0 offen
    s_mov_b64 exec, -1
    s_waitcnt vmcnt(0)
    v_cmp_ne_u32 vcc, -1, v251
    v_mov_b32 v252, 99076
    s_bcnt1_i32_b32 s34, vcc_lo
    v_mov_b32 v251, s34
    s_mov_b64 exec, 1
    ds_write_b32 v252, v251
    s_mov_b64 exec, -1
    v_and_b32 v19, 7, v0
    v_lshlrev_b32 v19, 3, v19
    v_add_u32 v19, 98560, v19
    s_mov_b32 s35, 0
L_poll39:
    ds_read_b64 v[20:21], v19
    s_add_u32 s35, s35, 1
    s_waitcnt lgkmcnt(0)
    v_max_u32 v22, v20, v21
    v_cmp_eq_u32 vcc, -1, v22
    s_cbranch_vccz L_done40
    s_sleep 2
    s_cmp_lt_u32 s35, 60000
    s_cbranch_scc1 L_poll39
L_done40:
    v_max_f32_dpp v22, v20, v20 row_half_mirror row_mask:0xf bank_mask:0xf
    s_nop 1
    v_max_f32_dpp v22, v22, v22 quad_perm:[1,0,3,2] row_mask:0xf bank_mask:0xf
    s_nop 1
    v_max_f32_dpp v22, v22, v22 quad_perm:[2,3,0,1] row_mask:0xf bank_mask:0xf
    v_sub_f32 v20, v20, v22
    v_exp_f32 v20, v20
    s_nop 0
    v_mul_f32 v21, v21, v20
    s_nop 1
    v_add_f32_dpp v21, v21, v21 row_half_mirror row_mask:0xf bank_mask:0xf
    s_nop 1
    v_add_f32_dpp v21, v21, v21 quad_perm:[1,0,3,2] row_mask:0xf bank_mask:0xf
    s_nop 1
    v_add_f32_dpp v21, v21, v21 quad_perm:[2,3,0,1] row_mask:0xf bank_mask:0xf
    v_rcp_f32 v23, v21
    v_log_f32 v21, v21
    v_mul_f32 v20, v20, v23
    v_add_f32 v21, v21, v22
    v_min_u32 v21, -2, v21
    v_readlane_b32 s88, v20, 0
    v_readlane_b32 s90, v20, 1
    v_readlane_b32 s92, v20, 2
    v_readlane_b32 s94, v20, 3
    v_readlane_b32 s96, v20, 4
    v_readlane_b32 s98, v20, 5
    v_readlane_b32 s100, v20, 6
    v_readlane_b32 s89, v20, 7
    s_and_b32 s95, s61, 3
    s_lshl_b32 s95, s95, 15
    s_bfe_u32 s35, s2, 0x20005
    s_lshl_b32 s35, s35, 1
    s_lshr_b32 s91, s2, 7
    s_add_u32 s35, s35, s91
    s_getreg_b32 s91, hwreg(HW_REG_XCC_ID, 0, 4)
    v_and_b32 v24, 1, v0
    v_cmp_eq_u32 vcc, 0, v24
    v_mov_b32 v25, s91
    s_nop 0
    v_cndmask_b32 v25, v25, v21, vcc
    v_mul_f32 v20, s89, v116
    v_mul_f32 v21, s89, v117
    s_mul_i32 s34, s60, 4096
    s_mul_i32 s35, s35, 512
    s_add_u32 s34, s34, s35
    s_add_u32 s34, s34, s95
    s_add_u32 s34, s34, 1179648
    v_lshl_add_u32 v26, v0, 2, s34
    v_lshlrev_b32 v19, 3, v0
    v_add_u32 v19, 99328, v19
    v_lshlrev_b32 v18, 4, v0
    v_add_u32 v18, 131328, v18
    s_mov_b32 s36, s12
    s_mov_b32 s37, s13
    s_mov_b32 s38, 5242880
    s_and_b32 s34, s61, 24
    s_add_u32 s34, s34, s60
    s_mul_i32 s34, s34, 163840
    s_and_b32 s35, s61, 7
    s_mul_i32 s35, s35, 20480
    s_add_u32 s34, s34, s35
    v_lshl_add_u32 v195, v0, 6, s34
    s_mov_b32 s34, 0
    s_barrier
    buffer_load_dword v250, v195, s[36:39], s34 offen
    s_add_u32 s34, s34, 4096
    buffer_load_dword v250, v195, s[36:39], s34 offen
    s_add_u32 s34, s34, 4096
    buffer_load_dword v250, v195, s[36:39], s34 offen
    s_add_u32 s34, s34, 4096
    buffer_load_dword v250, v195, s[36:39], s34 offen
    s_add_u32 s34, s34, 4096
    buffer_load_dword v250, v195, s[36:39], s34 offen
    s_add_u32 s34, s34, 4096
    s_cmp_lt_u32 s63, 1
    s_cbranch_scc1 L_nopf
    buffer_load_dword v250, v197, s[52:55], s42 offen
    s_add_u32 s42, s42, s40
    buffer_load_dword v250, v197, s[52:55], s42 offen
    s_add_u32 s42, s42, s41
L_nopf:
    s_cmp_eq_u32 s97, 0
    s_barrier
    ds_read_b64 v[32:33], v19 offset:0
    ds_read_b64 v[34:35], v19 offset:1024
    ds_read_b64 v[36:37], v19 offset:2048
    ds_read_b64 v[38:39], v19 offset:3072
    ds_read_b64 v[40:41], v19 offset:4096
    ds_read_b64 v[42:43], v19 offset:5120
    ds_read_b64 v[44:45], v19 offset:6144
    buffer_store_dword v25, v26, s[44:47], 0 offen offset:256
    s_waitcnt lgkmcnt(6)
    v_pk_fma_f32 v[20:21], v[32:33], s[88:89], v[20:21] op_sel_hi:[1,0,1]
    s_waitcnt lgkmcnt(5)
    v_pk_fma_f32 v[20:21], v[34:35], s[90:91], v[20:21] op_sel_hi:[1,0,1]
    s_waitcnt lgkmcnt(4)
    v_pk_fma_f32 v[20:21], v[36:37], s[92:93], v[20:21] op_sel_hi:[1,0,1]
    s_waitcnt lgkmcnt(3)
    v_pk_fma_f32 v[20:21], v[38:39], s[94:95], v[20:21] op_sel_hi:[1,0,1]
    s_waitcnt lgkmcnt(2)
    v_pk_fma_f32 v[20:21], v[40:41], s[96:97], v[20:21] op_sel_hi:[1,0,1]
    s_waitcnt lgkmcnt(1)
    v_pk_fma_f32 v[20:21], v[42:43], s[98:99], v[20:21] op_sel_hi:[1,0,1]
    s_waitcnt lgkmcnt(0)
    v_pk_fma_f32 v[20:21], v[44:45], s[100:101], v[20:21] op_sel_hi:[1,0,1]
    v_cvt_pk_bf16_f32 v24, v20, v21
    v_min_u32 v24, -2, v24
    buffer_store_dword v24, v26, s[44:47], 0 offen
    s_cbranch_scc1 L_ostd
    buffer_store_dword v24, v26, s[44:47], 0 offen sc1
    buffer_store_dword v25, v26, s[44:47], 0 offen offset:256 sc1
L_ostd:
    ds_write_b96 v18, v[24:26]
    s_waitcnt lgkmcnt(0)
    s_cmp_lt_u32 s63, 1
    s_cbranch_scc1 L_nopf2
    buffer_load_dword v250, v197, s[52:55], s42 offen
    s_add_u32 s42, s42, s40
    buffer_load_dword v250, v197, s[52:55], s42 offen
    s_add_u32 s42, s42, s41
    buffer_load_dword v250, v197, s[52:55], s42 offen
    s_add_u32 s42, s42, s40
    buffer_load_dword v250, v197, s[52:55], s42 offen
    s_add_u32 s42, s42, s41
    buffer_load_dword v250, v197, s[52:55], s42 offen
    s_add_u32 s42, s42, s40
    buffer_load_dword v250, v197, s[52:55], s42 offen
    s_add_u32 s42, s42, s41
    buffer_load_dword v250, v197, s[52:55], s42 offen
    s_add_u32 s42, s42, s40
    buffer_load_dword v250, v197, s[52:55], s42 offen
    s_add_u32 s42, s42, s41
L_nopf2:
    s_barrier
    s_cmp_eq_u32 s63, 0
    s_cbranch_scc1 L_r_wo2
    buffer_load_dword v250, v197, s[52:55], s42 offen
    s_add_u32 s42, s42, s40
    s_cmp_eq_u32 s63, 1
    s_cbranch_scc1 L_r_w1
    buffer_load_dword v250, v197, s[52:55], s42 offen
    s_add_u32 s42, s42, s40
    buffer_load_dword v250, v197, s[52:55], s42 offen
    s_add_u32 s42, s42, s41
    buffer_load_dword v250, v197, s[52:55], s42 offen
    s_add_u32 s42, s42, s40
    buffer_load_dword v250, v197, s[52:55], s42 offen
    s_add_u32 s42, s42, s41
    s_cmp_eq_u32 s63, 2
    s_cbranch_scc1 L_w2_red
    s_waitcnt vmcnt(0)
    s_mov_b64 exec, -1
    v_lshlrev_b32 v243, 4, v0
    v_add_u32 v243, 131328, v243
    ds_read_b96 v[240:242], v243
    s_waitcnt lgkmcnt(0)
    buffer_store_dword v240, v242, s[44:47], 0 offen sc1
    buffer_store_dword v241, v242, s[44:47], 0 offen offset:256 sc1
    s_branch L_fin
L_stream:
    s_sub_u32 s49, s3, 1
    s_lshl_b32 s49, s49, 12
    v_lshl_add_u32 v1, v0, 4, s49
    s_and_b32 s34, s2, 127
    s_lshl_b32 s34, s34, 21
    s_lshr_b32 s35, s2, 7
    s_lshl_b32 s35, s35, 18
    s_add_u32 s34, s34, s35
    s_add_u32 s34, s34, 1572864
    s_mov_b32 s38, 0x40000
    s_mov_b32 s42, 0x40000
    s_waitcnt lgkmcnt(0)
    s_add_u32 s36, s6, s34
    s_addc_u32 s37, s7, 0
    s_add_u32 s40, s8, s34
    s_addc_u32 s41, s9, 0
    s_barrier
    s_waitcnt vmcnt(2)
    s_mov_b32 s49, 0
    buffer_load_dwordx4 v[28:31], v1, s[36:39], s49 offen offset:3072 nt
    s_waitcnt vmcnt(2)
    s_mov_b32 s49, 28672
    buffer_load_dwordx4 v[32:35], v1, s[36:39], s49 offen offset:0 nt
    s_waitcnt vmcnt(2)
    buffer_load_dwordx4 v[36:39], v1, s[36:39], s49 offen offset:1024 nt
    s_waitcnt vmcnt(2)
    buffer_load_dwordx4 v[40:43], v1, s[36:39], s49 offen offset:2048 nt
    s_waitcnt vmcnt(2)
    buffer_load_dwordx4 v[44:47], v1, s[36:39], s49 offen offset:3072 nt
    s_add_u32 s44, s32, 0
    s_addc_u32 s45, s33, 0
    s_mov_b32 s63, 0
    s_mov_b32 s62, s61
    s_cmp_lt_u32 s61, 20
    s_cbranch_scc1 L_rd42
    s_mul_i32 s62, s60, 12
    s_add_u32 s62, s62, s61
    s_sub_u32 s62, s62, 20
    s_mov_b32 s63, 1
    s_cmp_lt_u32 s62, 54
    s_cbranch_scc1 L_rd42
    s_cmp_lt_u32 s62, 56
    s_cselect_b32 s63, 3, 2
    s_sub_u32 s62, s62, 56
L_rd42:
    v_and_b32 v8, 3, v0
    v_bfe_u32 v9, v0, 2, 2
    v_lshrrev_b32 v10, 4, v0
    s_mov_b32 s55, 0x20000
    s_lshl_b32 s35, s62, 6
    s_and_b32 s49, s62, 1
    s_cmp_eq_u32 s63, 0
    s_cbranch_scc1 L_dp44
    s_cmp_eq_u32 s63, 1
    s_cbranch_scc1 L_dp45
    s_mov_b32 s52, s20
    s_mov_b32 s53, s21
    s_mov_b32 s54, 2211840
    v_mov_b32 v15, 0
    s_branch L_dp46
L_dp45:
    s_mov_b32 s52, s16
    s_mov_b32 s53, s17
    s_mov_b32 s54, 2211840
    v_lshl_add_u32 v15, v9, 3, v10
    v_mul_u32_u24 v15, 3456, v15
    v_lshl_add_u32 v15, v8, 4, v15
    v_add_u32 v15, s35, v15
    s_bfe_u32 s50, s3, 0x10001
    s_lshl_b32 s50, s50, 7
    s_and_b32 s34, s3, 1
    s_lshl_b32 s34, s34, 2
    s_add_u32 s50, s50, s34
    s_and_b32 s51, s3, 3
    s_lshl_b32 s51, s51, 5
    s_add_u32 s51, s51, 512
    s_mul_i32 s50, s50, 3456
    s_mul_i32 s51, s51, 3456
    s_branch L_dp46
L_dp44:
    s_mov_b32 s52, s12
    s_mov_b32 s53, s13
    s_mov_b32 s54, 5242880
    s_lshr_b32 s50, s3, 1
    s_lshl_b32 s50, s50, 3
    s_add_u32 s50, s50, s60
    s_and_b32 s51, s3, 1
    s_lshl_b32 s34, s50, 1
    s_add_u32 s34, s34, s51
    s_mul_i32 s34, s34, 81920
    s_add_u32 s34, s34, s35
    v_lshl_add_u32 v15, v9, 2, v10
    v_mul_u32_u24 v15, 2560, v15
    v_lshl_add_u32 v15, v8, 4, v15
    v_add_u32 v15, s34, v15
    s_lshl_b32 s56, s3, 12
    s_lshl_b32 s34, s49, 11
    s_add_u32 s56, s56, s34
    s_add_u32 s56, s56, 40960
    s_add_u32 s58, s56, 1024
    s_mul_i32 s57, s49, 40960
    s_add_u32 s59, s57, 1280
L_dp46:
    v_and_b32 v2, 15, v0
    v_lshlrev_b32 v2, 4, v2
    v_add_u32 v2, 98304, v2
    s_waitcnt vmcnt(2)
    s_mov_b32 s49, 57344
    buffer_load_dwordx4 v[48:51], v1, s[36:39], s49 offen offset:0 nt
    s_waitcnt vmcnt(2)
    buffer_load_dwordx4 v[52:55], v1, s[36:39], s49 offen offset:1024 nt
    s_waitcnt vmcnt(2)
    s_cmp_ge_u32 s3, 4
    s_cbranch_scc1 L_sl47
    s_waitcnt vmcnt(1)
L_sl47:
    buffer_load_dwordx4 v[56:59], v1, s[36:39], s49 offen offset:2048 nt
    s_waitcnt vmcnt(2)
    s_cmp_ge_u32 s3, 4
    s_cbranch_scc1 L_sl48
    s_waitcnt vmcnt(1)
L_sl48:
    buffer_load_dwordx4 v[60:63], v1, s[36:39], s49 offen offset:3072 nt
    s_waitcnt vmcnt(2)
    s_cmp_ge_u32 s3, 4
    s_cbranch_scc1 L_sl49
    s_waitcnt vmcnt(1)
L_sl49:
    s_mov_b32 s49, 86016
    buffer_load_dwordx4 v[64:67], v1, s[36:39], s49 offen offset:0 nt
    s_waitcnt vmcnt(2)
    buffer_load_dwordx4 v[68:71], v1, s[36:39], s49 offen offset:1024 nt
    s_waitcnt vmcnt(2)
    buffer_load_dwordx4 v[72:75], v1, s[36:39], s49 offen offset:2048 nt
    s_waitcnt vmcnt(2)
    buffer_load_dwordx4 v[76:79], v1, s[36:39], s49 offen offset:3072 nt
    s_waitcnt vmcnt(2)
    s_mov_b32 s49, 114688
    buffer_load_dwordx4 v[80:83], v1, s[36:39], s49 offen offset:0 nt
    s_waitcnt vmcnt(2)
    buffer_load_dwordx4 v[84:87], v1, s[36:39], s49 offen offset:1024 nt
    s_waitcnt vmcnt(2)
    buffer_load_dwordx4 v[88:91], v1, s[36:39], s49 offen offset:2048 nt
    s_waitcnt vmcnt(2)
    buffer_load_dwordx4 v[92:95], v1, s[36:39], s49 offen offset:3072 nt
    s_waitcnt vmcnt(2)
    s_mov_b32 s49, 143360
    buffer_load_dwordx4 v[96:99], v1, s[36:39], s49 offen offset:0 nt
    v_mov_b32 v3, 21
    v_mov_b32 v14, 99072
    s_mov_b64 exec, 1
    ds_write_b32 v14, v3
    s_mov_b64 exec, -1
    s_waitcnt vmcnt(2)
    buffer_load_dwordx4 v[100:103], v1, s[36:39], s49 offen offset:1024 nt
    s_waitcnt vmcnt(2)
    buffer_load_dwordx4 v[104:107], v1, s[36:39], s49 offen offset:2048 nt
    s_waitcnt vmcnt(2)
    buffer_load_dwordx4 v[108:111], v1, s[36:39], s49 offen offset:3072 nt
    s_waitcnt vmcnt(2)
    s_mov_b32 s49, 172032
    buffer_load_dwordx4 v[112:115], v1, s[36:39], s49 offen offset:0 nt
    s_waitcnt vmcnt(2)
    buffer_load_dwordx4 v[116:119], v1, s[36:39], s49 offen offset:1024 nt
    s_waitcnt vmcnt(2)
    buffer_load_dwordx4 v[120:123], v1, s[36:39], s49 offen offset:2048 nt
    s_waitcnt vmcnt(2)
    buffer_load_dwordx4 v[124:127], v1, s[36:39], s49 offen offset:3072 nt
    s_waitcnt vmcnt(2)
    s_mov_b32 s49, 200704
    buffer_load_dwordx4 v[128:131], v1, s[36:39], s49 offen offset:0 nt
    s_waitcnt vmcnt(2)
    buffer_load_dwordx4 v[132:135], v1, s[36:39], s49 offen offset:1024 nt
    s_waitcnt vmcnt(2)
    buffer_load_dwordx4 v[136:139], v1, s[36:39], s49 offen offset:2048 nt
    s_waitcnt vmcnt(2)
    buffer_load_dwordx4 v[140:143], v1, s[36:39], s49 offen offset:3072 nt
    s_waitcnt vmcnt(2)
    s_mov_b32 s49, 229376
    buffer_load_dwordx4 v[144:147], v1, s[36:39], s49 offen offset:0 nt
    v_mov_b32 v3, 33
    v_mov_b32 v14, 99072
    s_mov_b64 exec, 1
    ds_write_b32 v14, v3
    s_mov_b64 exec, -1
    s_waitcnt vmcnt(2)
    buffer_load_dwordx4 v[148:151], v1, s[36:39], s49 offen offset:1024 nt
    s_waitcnt vmcnt(2)
    buffer_load_dwordx4 v[152:155], v1, s[36:39], s49 offen offset:2048 nt
    s_waitcnt vmcnt(2)
    buffer_load_dwordx4 v[156:159], v1, s[36:39], s49 offen offset:3072 nt
    s_waitcnt vmcnt(2)
    s_mov_b32 s49, 0
    buffer_load_dwordx4 v[160:163], v1, s[40:43], s49 offen offset:0 nt
    s_waitcnt vmcnt(2)
    buffer_load_dwordx4 v[164:167], v1, s[40:43], s49 offen offset:1024 nt
    v_mov_b32 v3, 99076
    ds_read_b32 v3, v3
    s_waitcnt vmcnt(2)
    s_waitcnt lgkmcnt(0)
    v_readfirstlane_b32 s48, v3
    buffer_load_dwordx4 v[168:171], v1, s[40:43], s49 offen offset:2048 nt
    s_cmp_ge_u32 s48, 22
    s_cbranch_scc1 L_bo50
    s_waitcnt vmcnt(2)
L_bo50:
    buffer_load_dwordx4 v[172:175], v1, s[40:43], s49 offen offset:3072 nt
    s_waitcnt vmcnt(3)
    s_cmp_ge_u32 s48, 23
    s_cbranch_scc1 L_bo51
    s_waitcnt vmcnt(2)
L_bo51:
    s_mov_b32 s49, 28672
    buffer_load_dwordx4 v[176:179], v1, s[40:43], s49 offen offset:0 nt
    s_waitcnt vmcnt(3)
    s_cmp_ge_u32 s48, 24
    s_cbranch_scc1 L_bo52
    s_waitcnt vmcnt(2)
L_bo52:
    buffer_load_dwordx4 v[180:183], v1, s[40:43], s49 offen offset:1024 nt
    s_waitcnt vmcnt(3)
    s_cmp_ge_u32 s48, 25
    s_cbranch_scc1 L_bo53
    s_waitcnt vmcnt(2)
L_bo53:
    buffer_load_dwordx4 v[184:187], v1, s[40:43], s49 offen offset:2048 nt
    s_waitcnt vmcnt(3)
    s_cmp_ge_u32 s48, 26
    s_cbranch_scc1 L_bo54
    s_waitcnt vmcnt(2)
L_bo54:
    buffer_load_dwordx4 v[188:191], v1, s[40:43], s49 offen offset:3072 nt
    s_waitcnt vmcnt(3)
    s_cmp_ge_u32 s48, 27
    s_cbranch_scc1 L_bo55
    s_waitcnt vmcnt(2)
L_bo55:
    s_mov_b32 s49, 57344
    buffer_load_dwordx4 v[192:195], v1, s[40:43], s49 offen offset:0 nt
    s_waitcnt vmcnt(3)
    s_cmp_ge_u32 s48, 28
    s_cbranch_scc1 L_bo56
    s_waitcnt vmcnt(2)
L_bo56:
    buffer_load_dwordx4 v[196:199], v1, s[40:43], s49 offen offset:1024 nt
    s_waitcnt vmcnt(3)
    s_cmp_ge_u32 s48, 28
    s_cbranch_scc1 L_bo57
    s_waitcnt vmcnt(2)
L_bo57:
    buffer_load_dwordx4 v[200:203], v1, s[40:43], s49 offen offset:2048 nt
    v_mov_b32 v3, 47
    v_mov_b32 v14, 99072
    s_mov_b64 exec, 1
    ds_write_b32 v14, v3
    s_mov_b64 exec, -1
    s_waitcnt vmcnt(3)
    s_cmp_ge_u32 s48, 29
    s_cbranch_scc1 L_bo58
    s_waitcnt vmcnt(2)
L_bo58:
    buffer_load_dwordx4 v[204:207], v1, s[40:43], s49 offen offset:3072 nt
    s_waitcnt vmcnt(3)
    s_cmp_ge_u32 s48, 29
    s_cbranch_scc1 L_bo59
    s_waitcnt vmcnt(2)
L_bo59:
    s_mov_b32 s49, 86016
    buffer_load_dwordx4 v[208:211], v1, s[40:43], s49 offen offset:0 nt
    s_waitcnt vmcnt(3)
    s_cmp_ge_u32 s48, 30
    s_cbranch_scc1 L_bo60
    s_waitcnt vmcnt(2)
L_bo60:
    buffer_load_dwordx4 v[212:215], v1, s[40:43], s49 offen offset:1024 nt
    s_waitcnt vmcnt(3)
    s_cmp_ge_u32 s48, 30
    s_cbranch_scc1 L_bo61
    s_waitcnt vmcnt(2)
L_bo61:
    buffer_load_dwordx4 v[216:219], v1, s[40:43], s49 offen offset:2048 nt
    s_waitcnt vmcnt(3)
    s_cmp_ge_u32 s48, 31
    s_cbranch_scc1 L_bo62
    s_waitcnt vmcnt(2)
L_bo62:
    buffer_load_dwordx4 v[220:223], v1, s[40:43], s49 offen offset:3072 nt
    v_mov_b32 v3, 99076
    ds_read_b32 v3, v3
    s_waitcnt vmcnt(3)
    s_cmp_ge_u32 s48, 31
    s_cbranch_scc1 L_bo63
    s_waitcnt vmcnt(2)
L_bo63:
    s_waitcnt lgkmcnt(0)
    v_readfirstlane_b32 s48, v3
    s_mov_b32 s49, 114688
    buffer_load_dwordx4 v[224:227], v1, s[40:43], s49 offen offset:0 nt
    s_waitcnt vmcnt(3)
    s_cmp_ge_u32 s48, 22
    s_cbranch_scc1 L_bo64
    s_waitcnt vmcnt(2)
L_bo64:
    buffer_load_dwordx4 v[228:231], v1, s[40:43], s49 offen offset:1024 nt
    s_waitcnt vmcnt(3)
    s_cmp_ge_u32 s48, 23
    s_cbranch_scc1 L_bo65
    s_waitcnt vmcnt(2)
L_bo65:
    buffer_load_dwordx4 v[232:235], v1, s[40:43], s49 offen offset:2048 nt
    s_waitcnt vmcnt(3)
    s_cmp_ge_u32 s48, 24
    s_cbranch_scc1 L_bo66
    s_waitcnt vmcnt(2)
L_bo66:
    buffer_load_dwordx4 v[236:239], v1, s[40:43], s49 offen offset:3072 nt
    v_mov_b32 v14, 99080
    s_mov_b32 s35, 0
L_poll67:
    ds_read_b128 v[4:7], v2
    ds_read_b32 v8, v14
    s_add_u32 s35, s35, 1
    s_waitcnt lgkmcnt(0)
    v_max3_u32 v3, v4, v5, v6
    v_max_u32 v3, v3, v7
    v_cmp_eq_u32 vcc, -1, v3
    s_cbranch_vccz L_done68
    s_sleep 2
    s_cmp_lt_u32 s35, 60000
    s_cbranch_scc1 L_poll67
L_done68:
    v_readfirstlane_b32 s99, v8
    s_waitcnt vmcnt(3)
    s_cmp_ge_u32 s48, 25
    s_cbranch_scc1 L_bo70
    s_waitcnt vmcnt(2)
L_bo70:
    s_mov_b32 s49, 143360
    buffer_load_dwordx4 v[240:243], v1, s[40:43], s49 offen offset:0 nt
    v_dot2_f32_bf16 v8, v16, v4, 0
    v_dot2_f32_bf16 v9, v20, v4, 0
    v_dot2_f32_bf16 v10, v24, v4, 0
    v_dot2_f32_bf16 v11, v28, v4, 0
    v_dot2c_f32_bf16 v8, v17, v5
    v_dot2c_f32_bf16 v9, v21, v5
    v_dot2c_f32_bf16 v10, v25, v5
    v_dot2c_f32_bf16 v11, v29, v5
    v_dot2c_f32_bf16 v8, v18, v6
    v_dot2c_f32_bf16 v9, v22, v6
    v_dot2c_f32_bf16 v10, v26, v6
    v_dot2c_f32_bf16 v11, v30, v6
    v_dot2c_f32_bf16 v8, v19, v7
    v_dot2c_f32_bf16 v9, v23, v7
    v_dot2c_f32_bf16 v10, v27, v7
    v_dot2c_f32_bf16 v11, v31, v7
    v_add_f32_dpp v12, v8, v8 row_ror:8 row_mask:0xf bank_mask:0x3
    v_add_f32_dpp v12, v9, v9 row_ror:8 row_mask:0xf bank_mask:0xc
    v_add_f32_dpp v13, v10, v10 row_ror:8 row_mask:0xf bank_mask:0x3
    v_add_f32_dpp v13, v11, v11 row_ror:8 row_mask:0xf bank_mask:0xc
    v_dot2_f32_bf16 v8, v32, v4, 0
    v_dot2_f32_bf16 v9, v36, v4, 0
    v_dot2_f32_bf16 v10, v40, v4, 0
    v_dot2_f32_bf16 v11, v44, v4, 0
    v_add_f32_dpp v12, v12, v12 row_half_mirror row_mask:0xf bank_mask:0xf
    v_add_f32_dpp v13, v13, v13 row_half_mirror row_mask:0xf bank_mask:0xf
    v_dot2c_f32_bf16 v8, v33, v5
    v_dot2c_f32_bf16 v9, v37, v5
    v_dot2c_f32_bf16 v10, v41, v5
    v_dot2c_f32_bf16 v11, v45, v5
    v_add_f32_dpp v12, v12, v12 quad_perm:[1,0,3,2] row_mask:0xf bank_mask:0xf
    v_add_f32_dpp v13, v13, v13 quad_perm:[1,0,3,2] row_mask:0xf bank_mask:0xf
    v_dot2c_f32_bf16 v8, v34, v6
    v_dot2c_f32_bf16 v9, v38, v6
    v_dot2c_f32_bf16 v10, v42, v6
    v_dot2c_f32_bf16 v11, v46, v6
    s_waitcnt vmcnt(3)
    s_cmp_ge_u32 s48, 26
    s_cbranch_scc1 L_bo71
    s_waitcnt vmcnt(2)
L_bo71:
    buffer_load_dwordx4 v[244:247], v1, s[40:43], s49 offen offset:1024 nt
    v_add_f32_dpp v12, v12, v12 quad_perm:[2,3,0,1] row_mask:0xf bank_mask:0xf
    v_add_f32_dpp v13, v13, v13 quad_perm:[2,3,0,1] row_mask:0xf bank_mask:0xf
    v_dot2c_f32_bf16 v8, v35, v7
    v_dot2c_f32_bf16 v9, v39, v7
    v_dot2c_f32_bf16 v10, v43, v7
    v_dot2c_f32_bf16 v11, v47, v7
    v_add_f32_dpp v16, v8, v8 row_ror:8 row_mask:0xf bank_mask:0x3
    v_add_f32_dpp v16, v9, v9 row_ror:8 row_mask:0xf bank_mask:0xc
    v_add_f32_dpp v17, v10, v10 row_ror:8 row_mask:0xf bank_mask:0x3
    v_add_f32_dpp v17, v11, v11 row_ror:8 row_mask:0xf bank_mask:0xc
    v_dot2_f32_bf16 v8, v48, v4, 0
    v_dot2_f32_bf16 v9, v52, v4, 0
    v_dot2_f32_bf16 v10, v56, v4, 0
    v_dot2_f32_bf16 v11, v60, v4, 0
    v_add_f32_dpp v16, v16, v16 row_half_mirror row_mask:0xf bank_mask:0xf
    v_add_f32_dpp v17, v17, v17 row_half_mirror row_mask:0xf bank_mask:0xf
    v_dot2c_f32_bf16 v8, v49, v5
    v_dot2c_f32_bf16 v9, v53, v5
    v_dot2c_f32_bf16 v10, v57, v5
    v_dot2c_f32_bf16 v11, v61, v5
    v_add_f32_dpp v16, v16, v16 quad_perm:[1,0,3,2] row_mask:0xf bank_mask:0xf
    v_add_f32_dpp v17, v17, v17 quad_perm:[1,0,3,2] row_mask:0xf bank_mask:0xf
    v_dot2c_f32_bf16 v8, v50, v6
    v_dot2c_f32_bf16 v9, v54, v6
    v_dot2c_f32_bf16 v10, v58, v6
    v_dot2c_f32_bf16 v11, v62, v6
    v_add_f32_dpp v16, v16, v16 quad_perm:[2,3,0,1] row_mask:0xf bank_mask:0xf
    v_add_f32_dpp v17, v17, v17 quad_perm:[2,3,0,1] row_mask:0xf bank_mask:0xf
    v_dot2c_f32_bf16 v8, v51, v7
    v_dot2c_f32_bf16 v9, v55, v7
    v_dot2c_f32_bf16 v10, v59, v7
    v_dot2c_f32_bf16 v11, v63, v7
    v_add_f32_dpp v18, v8, v8 row_ror:8 row_mask:0xf bank_mask:0x3
    v_add_f32_dpp v18, v9, v9 row_ror:8 row_mask:0xf bank_mask:0xc
    v_add_f32_dpp v19, v10, v10 row_ror:8 row_mask:0xf bank_mask:0x3
    v_add_f32_dpp v19, v11, v11 row_ror:8 row_mask:0xf bank_mask:0xc
    s_waitcnt vmcnt(3)
    s_cmp_ge_u32 s48, 27
    s_cbranch_scc1 L_bo72
    s_waitcnt vmcnt(2)
L_bo72:
    buffer_load_dwordx4 v[248:251], v1, s[40:43], s49 offen offset:2048 nt
    v_dot2_f32_bf16 v8, v64, v4, 0
    v_dot2_f32_bf16 v9, v68, v4, 0
    v_dot2_f32_bf16 v10, v72, v4, 0
    v_dot2_f32_bf16 v11, v76, v4, 0
    v_add_f32_dpp v18, v18, v18 row_half_mirror row_mask:0xf bank_mask:0xf
    v_add_f32_dpp v19, v19, v19 row_half_mirror row_mask:0xf bank_mask:0xf
    v_dot2c_f32_bf16 v8, v65, v5
    v_dot2c_f32_bf16 v9, v69, v5
    v_dot2c_f32_bf16 v10, v73, v5
    v_dot2c_f32_bf16 v11, v77, v5
    v_add_f32_dpp v18, v18, v18 quad_perm:[1,0,3,2] row_mask:0xf bank_mask:0xf
    v_add_f32_dpp v19, v19, v19 quad_perm:[1,0,3,2] row_mask:0xf bank_mask:0xf
    v_dot2c_f32_bf16 v8, v66, v6
    v_dot2c_f32_bf16 v9, v70, v6
    v_dot2c_f32_bf16 v10, v74, v6
    v_dot2c_f32_bf16 v11, v78, v6
    v_add_f32_dpp v18, v18, v18 quad_perm:[2,3,0,1] row_mask:0xf bank_mask:0xf
    v_add_f32_dpp v19, v19, v19 quad_perm:[2,3,0,1] row_mask:0xf bank_mask:0xf
    v_dot2c_f32_bf16 v8, v67, v7
    v_dot2c_f32_bf16 v9, v71, v7
    v_dot2c_f32_bf16 v10, v75, v7
    v_dot2c_f32_bf16 v11, v79, v7
    v_add_f32_dpp v20, v8, v8 row_ror:8 row_mask:0xf bank_mask:0x3
    v_add_f32_dpp v20, v9, v9 row_ror:8 row_mask:0xf bank_mask:0xc
    v_add_f32_dpp v21, v10, v10 row_ror:8 row_mask:0xf bank_mask:0x3
    v_add_f32_dpp v21, v11, v11 row_ror:8 row_mask:0xf bank_mask:0xc
    v_dot2_f32_bf16 v8, v80, v4, 0
    v_dot2_f32_bf16 v9, v84, v4, 0
    v_dot2_f32_bf16 v10, v88, v4, 0
    v_dot2_f32_bf16 v11, v92, v4, 0
    v_add_f32_dpp v20, v20, v20 row_half_mirror row_mask:0xf bank_mask:0xf
    v_add_f32_dpp v21, v21, v21 row_half_mirror row_mask:0xf bank_mask:0xf
    v_dot2c_f32_bf16 v8, v81, v5
    v_dot2c_f32_bf16 v9, v85, v5
    v_dot2c_f32_bf16 v10, v89, v5
    v_dot2c_f32_bf16 v11, v93, v5
    s_waitcnt vmcnt(3)
    s_cmp_ge_u32 s48, 28
    s_cbranch_scc1 L_bo73
    s_waitcnt vmcnt(2)
L_bo73:
    buffer_load_dwordx4 v[252:255], v1, s[40:43], s49 offen offset:3072 nt
    v_add_f32_dpp v20, v20, v20 quad_perm:[1,0,3,2] row_mask:0xf bank_mask:0xf
    v_add_f32_dpp v21, v21, v21 quad_perm:[1,0,3,2] row_mask:0xf bank_mask:0xf
    v_dot2c_f32_bf16 v8, v82, v6
    v_dot2c_f32_bf16 v9, v86, v6
    v_dot2c_f32_bf16 v10, v90, v6
    v_dot2c_f32_bf16 v11, v94, v6
    v_add_f32_dpp v20, v20, v20 quad_perm:[2,3,0,1] row_mask:0xf bank_mask:0xf
    v_add_f32_dpp v21, v21, v21 quad_perm:[2,3,0,1] row_mask:0xf bank_mask:0xf
    v_dot2c_f32_bf16 v8, v83, v7
    v_dot2c_f32_bf16 v9, v87, v7
    v_dot2c_f32_bf16 v10, v91, v7
    v_dot2c_f32_bf16 v11, v95, v7
    v_add_f32_dpp v22, v8, v8 row_ror:8 row_mask:0xf bank_mask:0x3
    v_add_f32_dpp v22, v9, v9 row_ror:8 row_mask:0xf bank_mask:0xc
    v_add_f32_dpp v23, v10, v10 row_ror:8 row_mask:0xf bank_mask:0x3
    v_add_f32_dpp v23, v11, v11 row_ror:8 row_mask:0xf bank_mask:0xc
    v_dot2_f32_bf16 v8, v96, v4, 0
    v_dot2_f32_bf16 v9, v100, v4, 0
    v_dot2_f32_bf16 v10, v104, v4, 0
    v_dot2_f32_bf16 v11, v108, v4, 0
    v_add_f32_dpp v22, v22, v22 row_half_mirror row_mask:0xf bank_mask:0xf
    v_add_f32_dpp v23, v23, v23 row_half_mirror row_mask:0xf bank_mask:0xf
    v_dot2c_f32_bf16 v8, v97, v5
    v_dot2c_f32_bf16 v9, v101, v5
    v_dot2c_f32_bf16 v10, v105, v5
    v_dot2c_f32_bf16 v11, v109, v5
    v_add_f32_dpp v22, v22, v22 quad_perm:[1,0,3,2] row_mask:0xf bank_mask:0xf
    v_add_f32_dpp v23, v23, v23 quad_perm:[1,0,3,2] row_mask:0xf bank_mask:0xf
    v_dot2c_f32_bf16 v8, v98, v6
    v_dot2c_f32_bf16 v9, v102, v6
    v_dot2c_f32_bf16 v10, v106, v6
    v_dot2c_f32_bf16 v11, v110, v6
    v_add_f32_dpp v22, v22, v22 quad_perm:[2,3,0,1] row_mask:0xf bank_mask:0xf
    v_add_f32_dpp v23, v23, v23 quad_perm:[2,3,0,1] row_mask:0xf bank_mask:0xf
    v_dot2c_f32_bf16 v8, v99, v7
    v_dot2c_f32_bf16 v9, v103, v7
    s_waitcnt vmcnt(3)
    s_cmp_ge_u32 s48, 28
    s_cbranch_scc1 L_bo74
    s_waitcnt vmcnt(2)
L_bo74:
    s_mov_b32 s49, 172032
    buffer_load_dwordx4 v[32:35], v1, s[40:43], s49 offen offset:0 nt
    v_dot2c_f32_bf16 v10, v107, v7
    v_dot2c_f32_bf16 v11, v111, v7
    v_add_f32_dpp v24, v8, v8 row_ror:8 row_mask:0xf bank_mask:0x3
    v_add_f32_dpp v24, v9, v9 row_ror:8 row_mask:0xf bank_mask:0xc
    v_add_f32_dpp v25, v10, v10 row_ror:8 row_mask:0xf bank_mask:0x3
    v_add_f32_dpp v25, v11, v11 row_ror:8 row_mask:0xf bank_mask:0xc
    v_dot2_f32_bf16 v8, v112, v4, 0
    v_dot2_f32_bf16 v9, v116, v4, 0
    v_dot2_f32_bf16 v10, v120, v4, 0
    v_dot2_f32_bf16 v11, v124, v4, 0
    v_add_f32_dpp v24, v24, v24 row_half_mirror row_mask:0xf bank_mask:0xf
    v_add_f32_dpp v25, v25, v25 row_half_mirror row_mask:0xf bank_mask:0xf
    v_dot2c_f32_bf16 v8, v113, v5
    v_dot2c_f32_bf16 v9, v117, v5
    v_dot2c_f32_bf16 v10, v121, v5
    v_dot2c_f32_bf16 v11, v125, v5
    v_add_f32_dpp v24, v24, v24 quad_perm:[1,0,3,2] row_mask:0xf bank_mask:0xf
    v_add_f32_dpp v25, v25, v25 quad_perm:[1,0,3,2] row_mask:0xf bank_mask:0xf
    v_dot2c_f32_bf16 v8, v114, v6
    v_dot2c_f32_bf16 v9, v118, v6
    v_dot2c_f32_bf16 v10, v122, v6
    v_dot2c_f32_bf16 v11, v126, v6
    v_add_f32_dpp v24, v24, v24 quad_perm:[2,3,0,1] row_mask:0xf bank_mask:0xf
    v_add_f32_dpp v25, v25, v25 quad_perm:[2,3,0,1] row_mask:0xf bank_mask:0xf
    v_dot2c_f32_bf16 v8, v115, v7
    v_dot2c_f32_bf16 v9, v119, v7
    v_dot2c_f32_bf16 v10, v123, v7
    v_dot2c_f32_bf16 v11, v127, v7
    v_add_f32_dpp v26, v8, v8 row_ror:8 row_mask:0xf bank_mask:0x3
    v_add_f32_dpp v26, v9, v9 row_ror:8 row_mask:0xf bank_mask:0xc
    v_add_f32_dpp v27, v10, v10 row_ror:8 row_mask:0xf bank_mask:0x3
    v_add_f32_dpp v27, v11, v11 row_ror:8 row_mask:0xf bank_mask:0xc
    v_dot2_f32_bf16 v8, v128, v4, 0
    v_dot2_f32_bf16 v9, v132, v4, 0
    v_dot2_f32_bf16 v10, v136, v4, 0
    v_dot2_f32_bf16 v11, v140, v4, 0
    s_waitcnt vmcnt(3)
    s_cmp_ge_u32 s48, 29
    s_cbranch_scc1 L_bo75
    s_waitcnt vmcnt(2)
L_bo75:
    buffer_load_dwordx4 v[36:39], v1, s[40:43], s49 offen offset:1024 nt
    v_add_f32_dpp v26, v26, v26 row_half_mirror row_mask:0xf bank_mask:0xf
    v_add_f32_dpp v27, v27, v27 row_half_mirror row_mask:0xf bank_mask:0xf
    v_dot2c_f32_bf16 v8, v129, v5
    v_dot2c_f32_bf16 v9, v133, v5
    v_dot2c_f32_bf16 v10, v137, v5
    v_dot2c_f32_bf16 v11, v141, v5
    v_add_f32_dpp v26, v26, v26 quad_perm:[1,0,3,2] row_mask:0xf bank_mask:0xf
    v_add_f32_dpp v27, v27, v27 quad_perm:[1,0,3,2] row_mask:0xf bank_mask:0xf
    v_dot2c_f32_bf16 v8, v130, v6
    v_dot2c_f32_bf16 v9, v134, v6
    v_dot2c_f32_bf16 v10, v138, v6
    v_dot2c_f32_bf16 v11, v142, v6
    v_add_f32_dpp v26, v26, v26 quad_perm:[2,3,0,1] row_mask:0xf bank_mask:0xf
    v_add_f32_dpp v27, v27, v27 quad_perm:[2,3,0,1] row_mask:0xf bank_mask:0xf
    v_dot2c_f32_bf16 v8, v131, v7
    v_dot2c_f32_bf16 v9, v135, v7
    v_dot2c_f32_bf16 v10, v139, v7
    v_dot2c_f32_bf16 v11, v143, v7
    v_add_f32_dpp v28, v8, v8 row_ror:8 row_mask:0xf bank_mask:0x3
    v_add_f32_dpp v28, v9, v9 row_ror:8 row_mask:0xf bank_mask:0xc
    v_add_f32_dpp v29, v10, v10 row_ror:8 row_mask:0xf bank_mask:0x3
    v_add_f32_dpp v29, v11, v11 row_ror:8 row_mask:0xf bank_mask:0xc
    v_dot2_f32_bf16 v8, v144, v4, 0
    v_dot2_f32_bf16 v9, v148, v4, 0
    v_dot2_f32_bf16 v10, v152, v4, 0
    v_dot2_f32_bf16 v11, v156, v4, 0
    v_add_f32_dpp v28, v28, v28 row_half_mirror row_mask:0xf bank_mask:0xf
    v_add_f32_dpp v29, v29, v29 row_half_mirror row_mask:0xf bank_mask:0xf
    v_dot2c_f32_bf16 v8, v145, v5
    v_dot2c_f32_bf16 v9, v149, v5
    v_dot2c_f32_bf16 v10, v153, v5
    v_dot2c_f32_bf16 v11, v157, v5
    v_add_f32_dpp v28, v28, v28 quad_perm:[1,0,3,2] row_mask:0xf bank_mask:0xf
    v_add_f32_dpp v29, v29, v29 quad_perm:[1,0,3,2] row_mask:0xf bank_mask:0xf
    v_dot2c_f32_bf16 v8, v146, v6
    v_dot2c_f32_bf16 v9, v150, v6
    s_waitcnt vmcnt(3)
    s_cmp_ge_u32 s48, 29
    s_cbranch_scc1 L_bo76
    s_waitcnt vmcnt(2)
L_bo76:
    buffer_load_dwordx4 v[40:43], v1, s[40:43], s49 offen offset:2048 nt
    v_dot2c_f32_bf16 v10, v154, v6
    v_dot2c_f32_bf16 v11, v158, v6
    v_add_f32_dpp v28, v28, v28 quad_perm:[2,3,0,1] row_mask:0xf bank_mask:0xf
    v_add_f32_dpp v29, v29, v29 quad_perm:[2,3,0,1] row_mask:0xf bank_mask:0xf
    v_dot2c_f32_bf16 v8, v147, v7
    v_dot2c_f32_bf16 v9, v151, v7
    v_dot2c_f32_bf16 v10, v155, v7
    v_dot2c_f32_bf16 v11, v159, v7
    v_add_f32_dpp v30, v8, v8 row_ror:8 row_mask:0xf bank_mask:0x3
    v_add_f32_dpp v30, v9, v9 row_ror:8 row_mask:0xf bank_mask:0xc
    v_add_f32_dpp v31, v10, v10 row_ror:8 row_mask:0xf bank_mask:0x3
    v_add_f32_dpp v31, v11, v11 row_ror:8 row_mask:0xf bank_mask:0xc
    v_add_f32_dpp v30, v30, v30 row_half_mirror row_mask:0xf bank_mask:0xf
    s_nop 0
    v_add_f32_dpp v31, v31, v31 row_half_mirror row_mask:0xf bank_mask:0xf
    v_add_f32_dpp v30, v30, v30 quad_perm:[1,0,3,2] row_mask:0xf bank_mask:0xf
    s_nop 0
    v_add_f32_dpp v31, v31, v31 quad_perm:[1,0,3,2] row_mask:0xf bank_mask:0xf
    v_add_f32_dpp v30, v30, v30 quad_perm:[2,3,0,1] row_mask:0xf bank_mask:0xf
    s_nop 0
    v_add_f32_dpp v31, v31, v31 quad_perm:[2,3,0,1] row_mask:0xf bank_mask:0xf
    v_max3_f32 v8, v12, v13, v16
    v_max3_f32 v8, v8, v17, v18
    v_max3_f32 v8, v8, v19, v20
    v_max3_f32 v8, v8, v21, v22
    v_max3_f32 v8, v8, v23, v24
    v_max3_f32 v8, v8, v25, v26
    v_max3_f32 v8, v8, v27, v28
    v_max3_f32 v8, v8, v29, v30
    v_max_f32 v8, v8, v31
    s_mov_b32 s34, 0x3e0293ee
    s_nop 0
    v_max_f32_dpp v8, v8, v8 row_ror:8 row_mask:0xf bank_mask:0xf
    v_mov_b32 v9, v8
    s_nop 1
    v_permlane16_swap_b32 v8, v9
    v_max_f32 v8, v8, v9
    v_mov_b32 v9, v8
    s_nop 1
    v_permlane32_swap_b32 v8, v9
    v_max_f32 v8, v8, v9
    v_mul_f32 v8, s34, v8
    s_waitcnt vmcnt(3)
    s_cmp_ge_u32 s48, 30
    s_cbranch_scc1 L_bo77
    s_waitcnt vmcnt(2)
L_bo77:
    buffer_load_dwordx4 v[44:47], v1, s[40:43], s49 offen offset:3072 nt
    v_fma_f32 v12, v12, s34, -v8
    v_fma_f32 v13, v13, s34, -v8
    v_fma_f32 v16, v16, s34, -v8
    v_fma_f32 v17, v17, s34, -v8
    v_fma_f32 v18, v18, s34, -v8
    v_fma_f32 v19, v19, s34, -v8
    v_fma_f32 v20, v20, s34, -v8
    v_fma_f32 v21, v21, s34, -v8
    v_fma_f32 v22, v22, s34, -v8
    v_fma_f32 v23, v23, s34, -v8
    v_fma_f32 v24, v24, s34, -v8
    v_fma_f32 v25, v25, s34, -v8
    v_fma_f32 v26, v26, s34, -v8
    v_fma_f32 v27, v27, s34, -v8
    v_fma_f32 v28, v28, s34, -v8
    v_fma_f32 v29, v29, s34, -v8
    v_fma_f32 v30, v30, s34, -v8
    v_fma_f32 v31, v31, s34, -v8
    v_exp_f32 v12, v12
    v_exp_f32 v13, v13
    v_exp_f32 v16, v16
    v_exp_f32 v17, v17
    v_exp_f32 v18, v18
    v_exp_f32 v19, v19
    v_exp_f32 v20, v20
    v_exp_f32 v21, v21
    v_exp_f32 v22, v22
    v_exp_f32 v23, v23
    v_exp_f32 v24, v24
    v_exp_f32 v25, v25
    v_exp_f32 v26, v26
    v_exp_f32 v27, v27
    v_exp_f32 v28, v28
    v_exp_f32 v29, v29
    v_exp_f32 v30, v30
    v_exp_f32 v31, v31
    s_waitcnt vmcnt(3)
    s_cmp_ge_u32 s48, 30
    s_cbranch_scc1 L_bo78
    s_waitcnt vmcnt(2)
L_bo78:
    s_mov_b32 s49, 200704
    buffer_load_dwordx4 v[48:51], v1, s[40:43], s49 offen offset:0 nt
    v_add_f32 v9, v12, v13
    v_add_f32 v9, v9, v16
    v_add_f32 v9, v9, v17
    v_add_f32 v9, v9, v18
    v_add_f32 v9, v9, v19
    v_add_f32 v9, v9, v20
    v_add_f32 v9, v9, v21
    v_add_f32 v9, v9, v22
    v_add_f32 v9, v9, v23
    v_add_f32 v9, v9, v24
    v_add_f32 v9, v9, v25
    v_add_f32 v9, v9, v26
    v_add_f32 v9, v9, v27
    v_add_f32 v9, v9, v28
    v_add_f32 v9, v9, v29
    v_add_f32 v9, v9, v30
    v_add_f32 v9, v9, v31
    v_and_b32 v10, 1, v0
    v_lshlrev_b32 v10, 4, v10
    v_mov_b32 v11, 0xffff
    v_lshlrev_b32 v10, v10, v11
    v_bfe_u32 v11, v0, 1, 2
    v_cmp_eq_u32 vcc, 0, v11
    s_nop 1
    v_cndmask_b32 v144, 0, v10, vcc
    v_cmp_eq_u32 vcc, 1, v11
    s_nop 1
    v_cndmask_b32 v145, 0, v10, vcc
    v_cmp_eq_u32 vcc, 2, v11
    s_nop 1
    v_cndmask_b32 v146, 0, v10, vcc
    v_cmp_eq_u32 vcc, 3, v11
    s_nop 1
    v_cndmask_b32 v147, 0, v10, vcc
    v_add_f32_dpp v9, v9, v9 row_ror:8 row_mask:0xf bank_mask:0xf
    v_mov_b32 v10, v9
    s_nop 1
    v_permlane16_swap_b32 v9, v10
    v_add_f32 v9, v9, v10
    v_mov_b32 v10, v9
    s_nop 1
    v_permlane32_swap_b32 v9, v10
    s_waitcnt vmcnt(3)
    s_cmp_ge_u32 s48, 31
    s_cbranch_scc1 L_bo79
    s_waitcnt vmcnt(2)
L_bo79:
    buffer_load_dwordx4 v[52:55], v1, s[40:43], s49 offen offset:1024 nt
    v_add_f32 v9, v9, v10
    s_lshl_b32 s34, s3, 3
    s_add_u32 s34, s34, 98552
    v_mov_b32 v10, s34
    s_mov_b64 exec, 1
    ds_write_b64 v10, v[8:9]
    s_mov_b64 exec, -1
    s_lshl_b32 s34, s3, 10
    s_add_u32 s34, s34, 98304
    v_lshrrev_b32 v2, 4, v0
    v_and_b32 v11, 7, v0
    v_lshl_add_u32 v2, v2, 3, v11
    v_bfe_u32 v11, v0, 3, 1
    v_lshl_add_u32 v2, v11, 5, v2
    v_lshl_add_u32 v2, v2, 4, s34
    v_cvt_pk_bf16_f32 v10, v12, v12
    v_and_b32 v128, v10, v144
    v_and_b32 v129, v10, v145
    v_and_b32 v130, v10, v146
    v_and_b32 v131, v10, v147
    s_nop 1
    v_mfma_f32_16x16x32_bf16 v[148:151], v[160:163], v[128:131], 0
    v_mfma_f32_16x16x32_bf16 v[152:155], v[164:167], v[128:131], 0
    v_cvt_pk_bf16_f32 v10, v13, v13
    v_and_b32 v132, v10, v144
    v_and_b32 v133, v10, v145
    v_and_b32 v134, v10, v146
    v_and_b32 v135, v10, v147
    s_nop 1
    v_mfma_f32_16x16x32_bf16 v[148:151], v[168:171], v[132:135], v[148:151]
    v_mfma_f32_16x16x32_bf16 v[152:155], v[172:175], v[132:135], v[152:155]
    v_cvt_pk_bf16_f32 v10, v16, v16
    v_and_b32 v128, v10, v144
    v_and_b32 v129, v10, v145
    v_and_b32 v130, v10, v146
    v_and_b32 v131, v10, v147
    s_nop 1
    v_mfma_f32_16x16x32_bf16 v[148:151], v[176:179], v[128:131], v[148:151]
    v_mfma_f32_16x16x32_bf16 v[152:155], v[180:183], v[128:131], v[152:155]
    v_cvt_pk_bf16_f32 v10, v17, v17
    v_and_b32 v132, v10, v144
    s_waitcnt vmcnt(3)
    buffer_load_dwordx4 v[56:59], v1, s[40:43], s49 offen offset:2048 nt
    v_and_b32 v133, v10, v145
    v_and_b32 v134, v10, v146
    v_and_b32 v135, v10, v147
    s_nop 1
    v_mfma_f32_16x16x32_bf16 v[148:151], v[184:187], v[132:135], v[148:151]
    v_mfma_f32_16x16x32_bf16 v[152:155], v[188:191], v[132:135], v[152:155]
    v_cvt_pk_bf16_f32 v10, v18, v18
    v_and_b32 v128, v10, v144
    v_and_b32 v129, v10, v145
    v_and_b32 v130, v10, v146
    v_and_b32 v131, v10, v147
    s_nop 1
    v_mfma_f32_16x16x32_bf16 v[148:151], v[192:195], v[128:131], v[148:151]
    v_mfma_f32_16x16x32_bf16 v[152:155], v[196:199], v[128:131], v[152:155]
    v_cvt_pk_bf16_f32 v10, v19, v19
    v_and_b32 v132, v10, v144
    v_and_b32 v133, v10, v145
    v_and_b32 v134, v10, v146
    v_and_b32 v135, v10, v147
    s_nop 1
    v_mfma_f32_16x16x32_bf16 v[148:151], v[200:203], v[132:135], v[148:151]
    v_mfma_f32_16x16x32_bf16 v[152:155], v[204:207], v[132:135], v[152:155]
    v_cvt_pk_bf16_f32 v10, v20, v20
    v_and_b32 v128, v10, v144
    v_and_b32 v129, v10, v145
    v_and_b32 v130, v10, v146
    v_and_b32 v131, v10, v147
    s_nop 1
    v_mfma_f32_16x16x32_bf16 v[148:151], v[208:211], v[128:131], v[148:151]
    v_mfma_f32_16x16x32_bf16 v[152:155], v[212:215], v[128:131], v[152:155]
    v_cvt_pk_bf16_f32 v10, v21, v21
    v_and_b32 v132, v10, v144
    v_and_b32 v133, v10, v145
    v_and_b32 v134, v10, v146
    v_and_b32 v135, v10, v147
    s_nop 1
    v_mfma_f32_16x16x32_bf16 v[148:151], v[216:219], v[132:135], v[148:151]
    v_mfma_f32_16x16x32_bf16 v[152:155], v[220:223], v[132:135], v[152:155]
    v_cvt_pk_bf16_f32 v10, v22, v22
    v_and_b32 v128, v10, v144
    v_and_b32 v129, v10, v145
    s_waitcnt vmcnt(3)
    buffer_load_dwordx4 v[60:63], v1, s[40:43], s49 offen offset:3072 nt
    v_and_b32 v130, v10, v146
    v_and_b32 v131, v10, v147
    s_nop 1
    v_mfma_f32_16x16x32_bf16 v[148:151], v[224:227], v[128:131], v[148:151]
    v_mfma_f32_16x16x32_bf16 v[152:155], v[228:231], v[128:131], v[152:155]
    v_cvt_pk_bf16_f32 v10, v23, v23
    v_and_b32 v132, v10, v144
    v_and_b32 v133, v10, v145
    v_and_b32 v134, v10, v146
    v_and_b32 v135, v10, v147
    s_nop 1
    v_mfma_f32_16x16x32_bf16 v[148:151], v[232:235], v[132:135], v[148:151]
    v_mfma_f32_16x16x32_bf16 v[152:155], v[236:239], v[132:135], v[152:155]
    v_cvt_pk_bf16_f32 v10, v24, v24
    v_and_b32 v128, v10, v144
    v_and_b32 v129, v10, v145
    v_and_b32 v130, v10, v146
    v_and_b32 v131, v10, v147
    s_nop 1
    v_mfma_f32_16x16x32_bf16 v[148:151], v[240:243], v[128:131], v[148:151]
    v_mfma_f32_16x16x32_bf16 v[152:155], v[244:247], v[128:131], v[152:155]
    v_cvt_pk_bf16_f32 v10, v25, v25
    v_and_b32 v132, v10, v144
    v_and_b32 v133, v10, v145
    v_and_b32 v134, v10, v146
    v_and_b32 v135, v10, v147
    s_nop 1
    v_mfma_f32_16x16x32_bf16 v[148:151], v[248:251], v[132:135], v[148:151]
    v_mfma_f32_16x16x32_bf16 v[152:155], v[252:255], v[132:135], v[152:155]
    v_cvt_pk_bf16_f32 v10, v26, v26
    v_and_b32 v128, v10, v144
    v_and_b32 v129, v10, v145
    v_and_b32 v130, v10, v146
    v_and_b32 v131, v10, v147
    s_nop 1
    v_mfma_f32_16x16x32_bf16 v[148:151], v[32:35], v[128:131], v[148:151]
    v_mfma_f32_16x16x32_bf16 v[152:155], v[36:39], v[128:131], v[152:155]
    v_cvt_pk_bf16_f32 v10, v27, v27
    v_and_b32 v132, v10, v144
    v_and_b32 v133, v10, v145
    v_and_b32 v134, v10, v146
    s_waitcnt vmcnt(3)
    s_mov_b32 s49, 229376
    buffer_load_dwordx4 v[64:67], v1, s[40:43], s49 offen offset:0 nt
    v_and_b32 v135, v10, v147
    s_nop 1
    v_mfma_f32_16x16x32_bf16 v[148:151], v[40:43], v[132:135], v[148:151]
    v_mfma_f32_16x16x32_bf16 v[152:155], v[44:47], v[132:135], v[152:155]
    v_cvt_pk_bf16_f32 v10, v28, v28
    v_and_b32 v128, v10, v144
    v_and_b32 v129, v10, v145
    v_and_b32 v130, v10, v146
    v_and_b32 v131, v10, v147
    s_waitcnt vmcnt(3)
    buffer_load_dwordx4 v[68:71], v1, s[40:43], s49 offen offset:1024 nt
    buffer_load_dwordx4 v[72:75], v1, s[40:43], s49 offen offset:2048 nt
    buffer_load_dwordx4 v[76:79], v1, s[40:43], s49 offen offset:3072 nt
    s_barrier
    v_and_b32 v200, 3, v0
    v_bfe_u32 v201, v0, 2, 2
    v_lshrrev_b32 v202, 4, v0
    s_lshl_b32 s34, s3, 10
    s_add_u32 s34, s34, 122112
    v_mul_u32_u24 v203, 320, v201
    v_min_u32 v203, 704, v203
    v_lshl_add_u32 v203, v202, 6, v203
    v_lshl_add_u32 v203, v200, 4, v203
    v_add_u32 v203, s34, v203
    s_movk_i32 s48, 16384
    s_cmp_eq_u32 s63, 0
    s_cbranch_scc1 L_tp_wo
    s_cmp_eq_u32 s63, 1
    s_cbranch_scc1 L_tp_w1
    v_bfe_u32 v205, v0, 3, 2
    v_lshlrev_b32 v204, 3, v205
    v_lshrrev_b32 v205, 5, v0
    v_lshl_add_u32 v204, v205, 2, v204
    v_bfe_u32 v205, v0, 1, 2
    v_add_u32 v204, v204, v205
    v_and_b32 v205, 1, v0
    s_sub_u32 s49, s3, 1
    v_mul_u32_u24 v204, 1280, v204
    v_lshl_add_u32 v204, v205, 4, v204
    s_lshl_b32 s34, s62, 5
    s_mul_i32 s35, s49, 327680
    s_add_u32 s34, s34, s35
    v_add_u32 v204, s34, v204
    s_lshl_b32 s50, s49, 13
    s_add_u32 s50, s50, 40960
    v_lshl_add_u32 v205, v0, 3, s50
    s_lshl_b32 s34, s49, 8
    s_add_u32 s34, s34, s99
    s_add_u32 s34, s34, 791552
    s_cmp_eq_u32 s49, 6
    s_cselect_b32 s35, 1, 3
    v_lshlrev_b32 v6, 6, v202
    v_lshl_add_u32 v6, v200, 4, v6
    v_add_u32 v6, s34, v6
    v_lshl_add_u32 v4, v201, 15, v6
    v_min_u32 v5, s35, v201
    v_lshl_add_u32 v5, v5, 15, v6
    v_mov_b32 v7, 99084
    s_lshl_b32 s40, s62, 1
    s_add_u32 s41, s40, 8
    s_add_u32 s42, s40, 2
    s_branch L_tp_e
L_tp_w1:
    v_and_b32 v205, 15, v0
    v_lshlrev_b32 v205, 4, v205
    s_and_b32 s49, s3, 3
    s_mul_i32 s34, s49, 1280
    s_add_u32 s34, s34, s99
    s_add_u32 s34, s34, 786432
    v_lshl_add_u32 v206, v202, 15, v205
    v_add_u32 v206, s34, v206
    s_mul_i32 s34, s49, 3840
    v_add_u32 v205, s34, v205
    s_branch L_tp_e
L_tp_wo:
    s_lshr_b32 s49, s3, 1
    s_lshl_b32 s49, s49, 15
    v_and_b32 v210, 7, v0
    s_mul_i32 s34, s60, 4096
    s_add_u32 s34, s34, s49
    s_add_u32 s34, s34, 1179904
    v_lshrrev_b32 v211, 3, v0
    v_mul_u32_u24 v205, 512, v211
    v_add_u32 v204, s34, v205
    s_lshl_b32 s35, s51, 7
    s_add_u32 s34, s34, s35
    s_sub_u32 s34, s34, 256
    v_lshl_add_u32 v205, v210, 4, v205
    v_add_u32 v205, s34, v205
    s_lshl_b32 s34, s3, 12
    s_add_u32 s34, s34, 40960
    v_lshrrev_b32 v206, 2, v0
    v_lshlrev_b32 v206, 6, v206
    v_lshl_add_u32 v206, v200, 3, v206
    v_add_u32 v206, s34, v206
    s_mul_i32 s34, s3, 1152
    s_add_u32 s34, s34, 107520
    v_mul_u32_u24 v207, 144, v211
    v_lshl_add_u32 v207, v210, 4, v207
    v_add_u32 v207, s34, v207
    v_mul_u32_u24 v208, 144, v210
    v_lshl_add_u32 v208, v202, 4, v208
    v_add_u32 v208, s34, v208
    v_mul_u32_u24 v212, 144, v211
    v_add_u32 v212, s34, v212
    v_mul_u32_u24 v213, 144, v210
    v_add_u32 v213, s34, v213
    v_and_b32 v211, 1, v211
    v_bfe_u32 v203, v0, 1, 2
    v_mul_u32_u24 v203, 144, v203
    v_and_b32 v214, 1, v0
    v_mul_u32_u24 v214, 576, v214
    v_lshl_add_u32 v214, v211, 6, v214
    v_lshl_add_u32 v214, v202, 4, v214
    s_add_u32 s34, s34, 14592
    v_add3_u32 v203, v203, v214, s34
    v_mov_b32 v210, 98816
    v_cmp_eq_u32 vcc, 0, v211
    s_nop 1
    v_cndmask_b32 v209, v208, v210, vcc
    v_cndmask_b32 v208, v210, v208, vcc
L_tp_e:
    v_mfma_f32_16x16x32_bf16 v[148:151], v[48:51], v[128:131], v[148:151]
    v_mfma_f32_16x16x32_bf16 v[152:155], v[52:55], v[128:131], v[152:155]
    v_cvt_pk_bf16_f32 v10, v29, v29
    v_and_b32 v132, v10, v144
    v_and_b32 v133, v10, v145
    v_and_b32 v134, v10, v146
    v_and_b32 v135, v10, v147
    s_waitcnt vmcnt(4)
    s_nop 0
    v_mfma_f32_16x16x32_bf16 v[148:151], v[56:59], v[132:135], v[148:151]
    v_mfma_f32_16x16x32_bf16 v[152:155], v[60:63], v[132:135], v[152:155]
    v_cvt_pk_bf16_f32 v10, v30, v30
    v_and_b32 v128, v10, v144
    v_and_b32 v129, v10, v145
    v_and_b32 v130, v10, v146
    v_and_b32 v131, v10, v147
    s_waitcnt vmcnt(2)
    s_nop 0
    v_mfma_f32_16x16x32_bf16 v[148:151], v[64:67], v[128:131], v[148:151]
    v_mfma_f32_16x16x32_bf16 v[152:155], v[68:71], v[128:131], v[152:155]
    v_cvt_pk_bf16_f32 v10, v31, v31
    v_and_b32 v132, v10, v144
    v_and_b32 v133, v10, v145
    v_and_b32 v134, v10, v146
    v_and_b32 v135, v10, v147
    s_waitcnt vmcnt(0)
    s_nop 0
    v_mfma_f32_16x16x32_bf16 v[148:151], v[72:75], v[132:135], v[148:151]
    v_mfma_f32_16x16x32_bf16 v[152:155], v[76:79], v[132:135], v[152:155]
    s_nop 7
    v_add_f32_dpp v148, v152, v148 row_ror:8 row_mask:0xf bank_mask:0xf
    v_add_f32_dpp v149, v153, v149 row_ror:8 row_mask:0xf bank_mask:0xf
    v_add_f32_dpp v150, v154, v150 row_ror:8 row_mask:0xf bank_mask:0xf
    v_add_f32_dpp v151, v155, v151 row_ror:8 row_mask:0xf bank_mask:0xf
    ds_write_b128 v2, v[148:151]
    s_waitcnt lgkmcnt(0)
    s_barrier
    s_cmp_eq_u32 s63, 0
    s_cbranch_scc1 L_t_wo
    s_cmp_eq_u32 s63, 2
    s_cbranch_scc1 L_t_w2
    s_cmp_eq_u32 s63, 3
    s_cbranch_scc1 L_fin
    s_barrier
L_r_w1:
    s_cmp_lt_u32 s3, 4
    s_cbranch_scc1 L_w1_ln
    s_and_b32 s49, s3, 3
    s_lshl_b32 s42, s49, 11
    s_add_u32 s42, s42, 40960
    s_bitcmp1_b32 s62, 0
    s_cbranch_scc1 L_rot1
    s_add_u32 m0, s42, 0
    s_add_u32 s34, s50, 0
    buffer_load_dwordx4 v15, s[52:55], s34 offen  lds
    s_add_u32 m0, s42, 1024
    s_add_u32 s34, s50, 884736
    buffer_load_dwordx4 v15, s[52:55], s34 offen  lds
    s_add_u32 m0, s42, 8192
    s_add_u32 s34, s50, 110592
    buffer_load_dwordx4 v15, s[52:55], s34 offen  lds
    s_add_u32 m0, s42, 9216
    s_add_u32 s34, s50, 995328
    buffer_load_dwordx4 v15, s[52:55], s34 offen  lds
    s_add_u32 m0, s42, 32768
    s_add_u32 s34, s51, 0
    buffer_load_dwordx4 v15, s[52:55], s34 offen  lds
    s_add_u32 m0, s42, 33792
    s_add_u32 s34, s51, 13824
    buffer_load_dwordx4 v15, s[52:55], s34 offen  lds
    s_add_u32 m0, s42, 16384
    s_add_u32 s34, s50, 221184
    buffer_load_dwordx4 v15, s[52:55], s34 offen  lds
    s_add_u32 m0, s42, 17408
    s_add_u32 s34, s50, 1105920
    buffer_load_dwordx4 v15, s[52:55], s34 offen  lds
    s_add_u32 m0, s42, 24576
    s_add_u32 s34, s50, 331776
    buffer_load_dwordx4 v15, s[52:55], s34 offen  lds
    s_add_u32 m0, s42, 25600
    s_add_u32 s34, s50, 1216512
    buffer_load_dwordx4 v15, s[52:55], s34 offen  lds
    s_branch L_rot2
L_rot1:
    s_add_u32 m0, s42, 16384
    s_add_u32 s34, s50, 221184
    buffer_load_dwordx4 v15, s[52:55], s34 offen  lds
    s_add_u32 m0, s42, 17408
    s_add_u32 s34, s50, 1105920
    buffer_load_dwordx4 v15, s[52:55], s34 offen  lds
    s_add_u32 m0, s42, 24576
    s_add_u32 s34, s50, 331776
    buffer_load_dwordx4 v15, s[52:55], s34 offen  lds
    s_add_u32 m0, s42, 25600
    s_add_u32 s34, s50, 1216512
    buffer_load_dwordx4 v15, s[52:55], s34 offen  lds
    s_add_u32 m0, s42, 32768
    s_add_u32 s34, s51, 0
    buffer_load_dwordx4 v15, s[52:55], s34 offen  lds
    s_add_u32 m0, s42, 33792
    s_add_u32 s34, s51, 13824
    buffer_load_dwordx4 v15, s[52:55], s34 offen  lds
    s_add_u32 m0, s42, 0
    s_add_u32 s34, s50, 0
    buffer_load_dwordx4 v15, s[52:55], s34 offen  lds
    s_add_u32 m0, s42, 1024
    s_add_u32 s34, s50, 884736
    buffer_load_dwordx4 v15, s[52:55], s34 offen  lds
    s_add_u32 m0, s42, 8192
    s_add_u32 s34, s50, 110592
    buffer_load_dwordx4 v15, s[52:55], s34 offen  lds
    s_add_u32 m0, s42, 9216
    s_add_u32 s34, s50, 995328
    buffer_load_dwordx4 v15, s[52:55], s34 offen  lds
L_rot2:
    v_lshrrev_b32 v3, 2, v0
    v_lshlrev_b32 v3, 6, v3
    v_lshl_add_u32 v3, v200, 3, v3
    v_add_u32 v3, s42, v3
    s_lshl_b32 s35, s49, 6
    s_add_u32 s35, s35, 116736
    v_mul_u32_u24 v4, 1344, v200
    v_lshl_add_u32 v4, v202, 4, v4
    v_add_u32 v4, s35, v4
    s_lshl_b32 s35, s49, 10
    s_sub_u32 s35, s35, 4096
    v_add_u32 v5, s35, v203
    v_and_b32 v6, 1, v201
    v_mul_u32_u24 v6, 5376, v6
    v_add_u32 v6, v6, v4
    v_subrev_u32 v6, 90112, v6
    v_subrev_u32 v7, 22784, v5
    s_waitcnt vmcnt(0)
    s_barrier
    ds_read_b64_tr_b16 v[32:33], v3 offset:0
    ds_read_b64_tr_b16 v[34:35], v3 offset:1024
    ds_read_b64_tr_b16 v[36:37], v3 offset:32
    ds_read_b64_tr_b16 v[38:39], v3 offset:1056
    ds_read_b64_tr_b16 v[40:41], v3 offset:8192
    ds_read_b64_tr_b16 v[42:43], v3 offset:9216
    ds_read_b64_tr_b16 v[44:45], v3 offset:8224
    ds_read_b64_tr_b16 v[46:47], v3 offset:9248
    ds_read_b64_tr_b16 v[48:49], v3 offset:16384
    ds_read_b64_tr_b16 v[50:51], v3 offset:17408
    ds_read_b64_tr_b16 v[52:53], v3 offset:16416
    ds_read_b64_tr_b16 v[54:55], v3 offset:17440
    s_waitcnt lgkmcnt(4)
    ds_read_b64_tr_b16 v[56:57], v3 offset:24576
    ds_read_b64_tr_b16 v[58:59], v3 offset:25600
    ds_read_b64_tr_b16 v[60:61], v3 offset:24608
    ds_read_b64_tr_b16 v[62:63], v3 offset:25632
    ds_read_b64_tr_b16 v[64:65], v3 offset:32768
    ds_read_b64_tr_b16 v[66:67], v3 offset:33792
    ds_read_b64_tr_b16 v[68:69], v3 offset:32800
    ds_read_b64_tr_b16 v[70:71], v3 offset:33824
    s_waitcnt lgkmcnt(0)
    ds_read_b128 v[140:143], v6 offset:0
    ds_read_b128 v[144:147], v6 offset:256
    ds_read_b128 v[148:151], v6 offset:512
    ds_read_b128 v[152:155], v6 offset:768
    ds_read_b128 v[156:159], v6 offset:1024
    s_waitcnt lgkmcnt(4)
    v_mfma_f32_16x16x32_bf16 v[20:23], v[32:35], v[140:143], 0
    v_mfma_f32_16x16x32_bf16 v[24:27], v[36:39], v[140:143], 0
    s_waitcnt lgkmcnt(3)
    v_mfma_f32_16x16x32_bf16 v[20:23], v[40:43], v[144:147], v[20:23]
    v_mfma_f32_16x16x32_bf16 v[24:27], v[44:47], v[144:147], v[24:27]
    s_waitcnt lgkmcnt(2)
    v_mfma_f32_16x16x32_bf16 v[20:23], v[48:51], v[148:151], v[20:23]
    v_mfma_f32_16x16x32_bf16 v[24:27], v[52:55], v[148:151], v[24:27]
    s_waitcnt lgkmcnt(1)
    v_mfma_f32_16x16x32_bf16 v[20:23], v[56:59], v[152:155], v[20:23]
    v_mfma_f32_16x16x32_bf16 v[24:27], v[60:63], v[152:155], v[24:27]
    s_waitcnt lgkmcnt(0)
    v_mfma_f32_16x16x32_bf16 v[20:23], v[64:67], v[156:159], v[20:23]
    v_mfma_f32_16x16x32_bf16 v[24:27], v[68:71], v[156:159], v[24:27]
    s_nop 6
    ds_write_b128 v7, v[20:23]
    ds_write_b128 v7, v[24:27] offset:1024
    s_waitcnt lgkmcnt(0)
    s_setprio 3
    s_barrier
    ds_read_b128 v[140:143], v4 offset:0
    ds_read_b128 v[144:147], v4 offset:256
    ds_read_b128 v[148:151], v4 offset:512
    ds_read_b128 v[152:155], v4 offset:768
    ds_read_b128 v[156:159], v4 offset:1024
    s_waitcnt lgkmcnt(4)
    v_mfma_f32_16x16x32_bf16 v[20:23], v[32:35], v[140:143], 0
    v_mfma_f32_16x16x32_bf16 v[24:27], v[36:39], v[140:143], 0
    s_waitcnt lgkmcnt(3)
    v_mfma_f32_16x16x32_bf16 v[20:23], v[40:43], v[144:147], v[20:23]
    v_mfma_f32_16x16x32_bf16 v[24:27], v[44:47], v[144:147], v[24:27]
    s_waitcnt lgkmcnt(2)
    v_mfma_f32_16x16x32_bf16 v[20:23], v[48:51], v[148:151], v[20:23]
    v_mfma_f32_16x16x32_bf16 v[24:27], v[52:55], v[148:151], v[24:27]
    s_waitcnt lgkmcnt(1)
    v_mfma_f32_16x16x32_bf16 v[20:23], v[56:59], v[152:155], v[20:23]
    v_mfma_f32_16x16x32_bf16 v[24:27], v[60:63], v[152:155], v[24:27]
    s_waitcnt lgkmcnt(0)
    v_mfma_f32_16x16x32_bf16 v[20:23], v[64:67], v[156:159], v[20:23]
    v_mfma_f32_16x16x32_bf16 v[24:27], v[68:71], v[156:159], v[24:27]
    s_nop 6
    ds_write_b128 v5, v[20:23]
    ds_write_b128 v5, v[24:27] offset:1024
    s_waitcnt lgkmcnt(0)
    s_barrier
    s_branch L_fin
L_w1_ln:
    s_setprio 1
    ds_read_b128 v[140:143], v205 offset:0
    ds_read_b128 v[144:147], v205 offset:256
    ds_read_b128 v[148:151], v205 offset:512
    ds_read_b128 v[152:155], v205 offset:768
    ds_read_b128 v[156:159], v205 offset:1024
    ds_read_b128 v[160:163], v205 offset:1280
    ds_read_b128 v[164:167], v205 offset:1536
    ds_read_b128 v[168:171], v205 offset:1792
    ds_read_b128 v[172:175], v205 offset:2048
    ds_read_b128 v[176:179], v205 offset:2304
    ds_read_b128 v[180:183], v205 offset:2560
    ds_read_b128 v[184:187], v205 offset:2816
    ds_read_b128 v[188:191], v205 offset:3072
    ds_read_b128 v[192:195], v205 offset:3328
    ds_read_b128 v[196:199], v205 offset:3584
    v_and_b32 v8, 1, v0
    v_lshlrev_b32 v8, 4, v8
    v_mov_b32 v9, 0xffff
    v_lshlrev_b32 v8, v8, v9
    v_bfe_u32 v9, v0, 1, 2
    v_cmp_eq_u32 vcc, 0, v9
    s_nop 1
    v_cndmask_b32 v16, 0, v8, vcc
    v_cmp_eq_u32 vcc, 1, v9
    s_nop 1
    v_cndmask_b32 v17, 0, v8, vcc
    v_cmp_eq_u32 vcc, 2, v9
    s_nop 1
    v_cndmask_b32 v18, 0, v8, vcc
    v_cmp_eq_u32 vcc, 3, v9
    s_nop 1
    v_cndmask_b32 v19, 0, v8, vcc
    v_bfe_u32 v8, v0, 3, 1
    v_cmp_eq_u32 vcc, 0, v8
    s_nop 1
    v_cndmask_b32 v20, 0, v16, vcc
    v_xor_b32 v24, v20, v16
    v_cndmask_b32 v21, 0, v17, vcc
    v_xor_b32 v25, v21, v17
    v_cndmask_b32 v22, 0, v18, vcc
    v_xor_b32 v26, v22, v18
    v_cndmask_b32 v23, 0, v19, vcc
    v_xor_b32 v27, v23, v19
    v_and_b32 v52, 0x3f803f80, v20
    v_and_b32 v60, 0x3e803e80, v20
    v_and_b32 v53, 0x3f803f80, v21
    v_and_b32 v61, 0x3e803e80, v21
    v_and_b32 v54, 0x3f803f80, v22
    v_and_b32 v62, 0x3e803e80, v22
    v_and_b32 v55, 0x3f803f80, v23
    v_and_b32 v63, 0x3e803e80, v23
    v_and_b32 v56, 0x3f803f80, v24
    v_and_b32 v64, 0x3e803e80, v24
    v_and_b32 v57, 0x3f803f80, v25
    v_and_b32 v65, 0x3e803e80, v25
    v_and_b32 v58, 0x3f803f80, v26
    v_and_b32 v66, 0x3e803e80, v26
    v_and_b32 v59, 0x3f803f80, v27
    v_and_b32 v67, 0x3e803e80, v27
    s_waitcnt lgkmcnt(0)
    v_mfma_f32_16x16x32_bf16 v[68:71], v[140:143], v[60:63], 0
    v_mfma_f32_16x16x32_bf16 v[68:71], v[144:147], v[64:67], v[68:71]
    v_mfma_f32_16x16x32_bf16 v[72:75], v[148:151], v[60:63], 0
    v_mfma_f32_16x16x32_bf16 v[72:75], v[152:155], v[64:67], v[72:75]
    v_mfma_f32_16x16x32_bf16 v[76:79], v[156:159], v[60:63], 0
    v_mfma_f32_16x16x32_bf16 v[116:119], v[160:163], v[60:63], 0
    v_mfma_f32_16x16x32_bf16 v[116:119], v[164:167], v[64:67], v[116:119]
    v_mfma_f32_16x16x32_bf16 v[120:123], v[168:171], v[60:63], 0
    v_mfma_f32_16x16x32_bf16 v[120:123], v[172:175], v[64:67], v[120:123]
    v_mfma_f32_16x16x32_bf16 v[124:127], v[176:179], v[60:63], 0
    v_mfma_f32_16x16x32_bf16 v[80:83], v[180:183], v[60:63], 1.0
    v_mfma_f32_16x16x32_bf16 v[80:83], v[184:187], v[64:67], v[80:83]
    v_mfma_f32_16x16x32_bf16 v[84:87], v[188:191], v[60:63], 1.0
    v_mfma_f32_16x16x32_bf16 v[84:87], v[192:195], v[64:67], v[84:87]
    v_mfma_f32_16x16x32_bf16 v[88:91], v[196:199], v[60:63], 1.0
    s_mul_i32 s34, s3, 1344
    s_add_u32 s34, s34, 116736
    v_lshl_add_u32 v7, v0, 4, s34
    v_lshlrev_b32 v8, 6, v202
    v_lshl_add_u32 v8, v200, 4, v8
    v_and_b32 v9, 1, v201
    v_lshl_add_u32 v8, v9, 3, v8
    v_add_u32 v8, s34, v8
    v_bfe_u32 v9, v0, 3, 1
    v_mul_u32_u24 v9, 6144, v9
    v_sub_u32 v8, v8, v9
    v_lshrrev_b32 v9, 5, v0
    v_lshlrev_b32 v9, 10, v9
    v_and_b32 v6, 1, v202
    v_lshl_add_u32 v9, v6, 7, v9
    v_bfe_u32 v6, v0, 1, 1
    v_lshl_add_u32 v9, v6, 6, v9
    v_lshl_add_u32 v9, v201, 4, v9
    v_and_b32 v6, 1, v0
    v_lshl_add_u32 v9, v6, 3, v9
    v_add_u32 v9, 122112, v9
    s_lshr_b32 s34, s62, 3
    s_lshl_b32 s34, s34, 8
    s_and_b32 s49, s62, 3
    s_lshl_b32 s49, s49, 15
    s_add_u32 s34, s34, s49
    s_bfe_u32 s49, s62, 0x10002
    s_lshl_b32 s49, s49, 14
    s_add_u32 s34, s34, s49
    s_add_u32 s34, s34, 791552
    v_lshl_add_u32 v5, v0, 2, s34
    s_bfe_u32 s49, s60, 0x10002
    s_lshl_b32 s49, s49, 13
    s_xor_b32 s53, s99, s49
    s_xor_b32 s52, s53, 8192
    v_subrev_u32 v10, 90112, v7
    v_subrev_u32 v11, 90112, v8
    v_cvt_pk_bf16_f32 v32, v116, v117
    v_cvt_pk_bf16_f32 v33, v118, v119
    v_cvt_pk_bf16_f32 v34, v120, v121
    v_cvt_pk_bf16_f32 v35, v122, v123
    v_cvt_pk_bf16_f32 v36, v124, v125
    v_cvt_pk_bf16_f32 v37, v126, v127
    s_mov_b32 exec_lo, 0x00ff00ff
    s_mov_b32 exec_hi, 0x00ff00ff
    ds_write_b64 v11, v[36:37] offset:6400
    s_mov_b64 exec, -1
    ds_write_b128 v10, v[32:35] offset:5376
    v_cvt_pk_bf16_f32 v20, v80, v81
    v_cvt_pk_bf16_f32 v21, v82, v83
    v_cvt_pk_bf16_f32 v22, v84, v85
    v_cvt_pk_bf16_f32 v23, v86, v87
    v_cvt_pk_bf16_f32 v24, v88, v89
    v_cvt_pk_bf16_f32 v25, v90, v91
    ds_write_b128 v10, v[20:23]
    ds_write_b64 v11, v[24:25] offset:1024
    v_lshlrev_b32 v80, 16, v20
    v_and_b32 v81, 0xffff0000, v20
    v_lshlrev_b32 v82, 16, v21
    v_and_b32 v83, 0xffff0000, v21
    v_lshlrev_b32 v84, 16, v22
    v_and_b32 v85, 0xffff0000, v22
    v_lshlrev_b32 v86, 16, v23
    v_and_b32 v87, 0xffff0000, v23
    v_lshlrev_b32 v88, 16, v24
    v_and_b32 v89, 0xffff0000, v24
    v_lshlrev_b32 v90, 16, v25
    v_and_b32 v91, 0xffff0000, v25
    v_subrev_u32 v11, 22784, v9
    s_lshl_b32 s34, s3, 3
    s_add_u32 s34, s34, 99136
    v_mov_b32 v12, s34
    v_lshlrev_b32 v13, 3, v201
    v_add_u32 v13, 99136, v13
    s_mov_b32 s54, 0
    s_brev_b32 s55, 1
    s_waitcnt lgkmcnt(0)
    s_barrier
    s_mov_b32 s35, 0
    s_mov_b64 s[40:41], -1
    s_mov_b64 s[42:43], -1
L_pb:
    s_mov_b64 exec, s[40:41]
    s_cbranch_execz L_pbs0
    buffer_load_dwordx4 v[140:143], v206, s[44:47], 0 offen offset:0 sc1
    buffer_load_dwordx4 v[148:151], v206, s[44:47], 0 offen offset:256 sc1
    buffer_load_dwordx4 v[156:159], v206, s[44:47], 0 offen offset:512 sc1
    buffer_load_dwordx4 v[164:167], v206, s[44:47], 0 offen offset:768 sc1
    buffer_load_dwordx4 v[172:175], v206, s[44:47], 0 offen offset:1024 sc1
L_pbs0:
    s_mov_b64 exec, s[42:43]
    s_cbranch_execz L_pbs1
    buffer_load_dwordx4 v[144:147], v206, s[44:47], s48 offen offset:0 sc1
    buffer_load_dwordx4 v[152:155], v206, s[44:47], s48 offen offset:256 sc1
    buffer_load_dwordx4 v[160:163], v206, s[44:47], s48 offen offset:512 sc1
    buffer_load_dwordx4 v[168:171], v206, s[44:47], s48 offen offset:768 sc1
    buffer_load_dwordx4 v[176:179], v206, s[44:47], s48 offen offset:1024 sc1
L_pbs1:
    s_mov_b64 exec, -1
    s_add_u32 s35, s35, 1
    s_waitcnt vmcnt(0)
    v_mfma_f32_16x16x32_bf16 v[128:131], v[140:143], v[52:55], v[68:71]
    v_max3_u32 v28, v140, v141, v142
    v_max3_u32 v29, v144, v145, v146
    v_mfma_f32_16x16x32_bf16 v[128:131], v[144:147], v[52:55], v[128:131]
    v_max3_u32 v28, v28, v143, v148
    v_max3_u32 v29, v29, v147, v152
    v_mfma_f32_16x16x32_bf16 v[128:131], v[148:151], v[56:59], v[128:131]
    v_max3_u32 v28, v28, v149, v150
    v_max3_u32 v29, v29, v153, v154
    v_mfma_f32_16x16x32_bf16 v[128:131], v[152:155], v[56:59], v[128:131]
    v_max3_u32 v28, v28, v151, v156
    v_max3_u32 v29, v29, v155, v160
    v_mfma_f32_16x16x32_bf16 v[132:135], v[156:159], v[52:55], v[72:75]
    v_max3_u32 v28, v28, v157, v158
    v_max3_u32 v29, v29, v161, v162
    v_mfma_f32_16x16x32_bf16 v[132:135], v[160:163], v[52:55], v[132:135]
    v_max3_u32 v28, v28, v159, v164
    v_max3_u32 v29, v29, v163, v168
    v_mfma_f32_16x16x32_bf16 v[132:135], v[164:167], v[56:59], v[132:135]
    v_max3_u32 v28, v28, v165, v166
    v_max3_u32 v29, v29, v169, v170
    v_mfma_f32_16x16x32_bf16 v[132:135], v[168:171], v[56:59], v[132:135]
    v_max3_u32 v28, v28, v167, v172
    v_max3_u32 v29, v29, v171, v176
    v_mfma_f32_16x16x32_bf16 v[136:139], v[172:175], v[52:55], v[76:79]
    v_max3_u32 v28, v28, v173, v174
    v_max3_u32 v29, v29, v177, v178
    v_mfma_f32_16x16x32_bf16 v[136:139], v[176:179], v[52:55], v[136:139]
    v_max_u32 v28, v28, v175
    v_max_u32 v29, v29, v179
    v_cmp_eq_u32 s[40:41], -1, v28
    v_cmp_eq_u32 s[42:43], -1, v29
    s_nop 0
    s_or_b64 vcc, s[40:41], s[42:43]
    s_cbranch_scc0 L_pbd
    s_cmp_lg_u32 s35, 64
    s_cbranch_scc1 L_tmo80
    s_mov_b64 exec, -1
    v_lshlrev_b32 v243, 4, v0
    v_add_u32 v243, 131328, v243
    ds_read_b96 v[240:242], v243
    s_waitcnt lgkmcnt(0)
    buffer_store_dword v240, v242, s[44:47], 0 offen sc1
    buffer_store_dword v241, v242, s[44:47], 0 offen offset:256 sc1
L_tmo80:
    s_cmp_lt_u32 s35, 60000
    s_cbranch_scc1 L_pb
L_pbd:
    v_pk_mul_f32 v[32:33], v[128:129], v[80:81]
    v_pk_mul_f32 v[34:35], v[130:131], v[82:83]
    v_pk_mul_f32 v[36:37], v[132:133], v[84:85]
    v_pk_mul_f32 v[38:39], v[134:135], v[86:87]
    v_cvt_pk_bf16_f32 v24, v32, v33
    v_cvt_pk_bf16_f32 v25, v34, v35
    v_cvt_pk_bf16_f32 v26, v36, v37
    v_cvt_pk_bf16_f32 v27, v38, v39
    ds_write_b128 v7, v[24:27]
    v_pk_mul_f32 v[40:41], v[136:137], v[88:89]
    v_pk_mul_f32 v[42:43], v[138:139], v[90:91]
    v_cvt_pk_bf16_f32 v28, v40, v41
    v_cvt_pk_bf16_f32 v29, v42, v43
    ds_write_b64 v8, v[28:29] offset:1024
    v_pk_add_f32 v[20:21], v[128:129], v[130:131]
    v_pk_mul_f32 v[22:23], v[128:129], v[128:129]
    v_pk_add_f32 v[20:21], v[20:21], v[132:133]
    v_pk_fma_f32 v[22:23], v[130:131], v[130:131], v[22:23]
    v_pk_add_f32 v[20:21], v[20:21], v[134:135]
    v_pk_fma_f32 v[22:23], v[132:133], v[132:133], v[22:23]
    v_pk_add_f32 v[20:21], v[20:21], v[136:137]
    v_pk_fma_f32 v[22:23], v[134:135], v[134:135], v[22:23]
    v_pk_add_f32 v[20:21], v[20:21], v[138:139]
    v_pk_fma_f32 v[22:23], v[136:137], v[136:137], v[22:23]
    v_pk_fma_f32 v[22:23], v[138:139], v[138:139], v[22:23]
    s_waitcnt lgkmcnt(0)
    s_barrier
    v_add_f32 v20, v20, v21
    v_add_f32 v21, v22, v23
    s_nop 0
    v_add_f32_dpp v20, v20, v20 row_ror:8 row_mask:0xf bank_mask:0xf
    v_add_f32_dpp v21, v21, v21 row_ror:8 row_mask:0xf bank_mask:0xf
    s_nop 0
    v_add_f32_dpp v20, v20, v20 row_ror:4 row_mask:0xf bank_mask:0xf
    v_add_f32_dpp v21, v21, v21 row_ror:4 row_mask:0xf bank_mask:0xf
    s_nop 0
    v_add_f32_dpp v20, v20, v20 row_ror:2 row_mask:0xf bank_mask:0xf
    v_add_f32_dpp v21, v21, v21 row_ror:2 row_mask:0xf bank_mask:0xf
    s_nop 0
    v_add_f32_dpp v20, v20, v20 row_ror:1 row_mask:0xf bank_mask:0xf
    v_add_f32_dpp v21, v21, v21 row_ror:1 row_mask:0xf bank_mask:0xf
    s_nop 0
    v_add_f32_dpp v20, v20, v20 row_bcast:15 row_mask:0xa bank_mask:0xf
    v_add_f32_dpp v21, v21, v21 row_bcast:15 row_mask:0xa bank_mask:0xf
    s_nop 0
    v_add_f32_dpp v20, v20, v20 row_bcast:31 row_mask:0xc bank_mask:0xf
    v_add_f32_dpp v21, v21, v21 row_bcast:31 row_mask:0xc bank_mask:0xf
    v_mul_f32 v22, 0x3acccccd, v20
    v_mul_f32 v21, 0x3acccccd, v21
    v_fma_f32 v21, -v22, v22, v21
    v_max_f32 v21, 0, v21
    v_add_f32 v21, 0x3727c5ac, v21
    v_rsq_f32 v20, v21
    s_nop 0
    v_mul_f32_e64 v21, -v22, v20
    s_mov_b64 exec, s[54:55]
    ds_write_b64 v12, v[20:21]
    s_mov_b64 exec, -1
    s_cmp_lg_u32 s3, 0
    s_cbranch_scc1 L_w1_x
    ds_read_b64 v[32:33], v11 offset:0
    ds_read_b64 v[40:41], v11 offset:320
    ds_read_b64 v[34:35], v11 offset:2048
    ds_read_b64 v[42:43], v11 offset:2368
    ds_read_b64 v[36:37], v11 offset:4096
    ds_read_b64 v[44:45], v11 offset:4416
    ds_read_b64 v[38:39], v11 offset:6144
    ds_read_b64 v[46:47], v11 offset:6464
    s_mov_b32 s34, 0xbdd2d3e8
    v_mov_b32 v10, 0xc0135761
    s_waitcnt lgkmcnt(8)
    s_barrier
    ds_read_b64 v[28:29], v13
    ds_read_b64 v[20:21], v9 offset:0
    ds_read_b64 v[22:23], v9 offset:2048
    ds_read_b64 v[24:25], v9 offset:4096
    ds_read_b64 v[26:27], v9 offset:6144
    s_waitcnt lgkmcnt(5)
    v_pk_add_f32 v[100:101], v[100:101], v[40:41]
    v_pk_add_f32 v[100:101], v[100:101], v[42:43]
    v_pk_add_f32 v[32:33], v[32:33], v[34:35]
    v_pk_add_f32 v[100:101], v[100:101], v[44:45]
    v_pk_add_f32 v[32:33], v[32:33], v[36:37]
    v_pk_add_f32 v[100:101], v[100:101], v[46:47]
    v_pk_add_f32 v[32:33], v[32:33], v[38:39]
    s_waitcnt lgkmcnt(4)
    v_pk_fma_f32 v[100:101], v[32:33], v[28:29], v[100:101] op_sel:[0,1,0] op_sel_hi:[1,1,1]
    s_waitcnt lgkmcnt(3)
    v_pk_fma_f32 v[100:101], v[20:21], v[28:29], v[100:101] op_sel_hi:[1,0,1]
    s_waitcnt lgkmcnt(2)
    v_pk_fma_f32 v[100:101], v[22:23], v[28:29], v[100:101] op_sel_hi:[1,0,1]
    s_waitcnt lgkmcnt(1)
    v_pk_fma_f32 v[100:101], v[24:25], v[28:29], v[100:101] op_sel_hi:[1,0,1]
    s_waitcnt lgkmcnt(0)
    v_pk_fma_f32 v[100:101], v[26:27], v[28:29], v[100:101] op_sel_hi:[1,0,1]
    v_pk_mul_f32 v[20:21], v[100:101], v[100:101]
    v_fma_f32 v20, v20, s34, v10
    v_fma_f32 v21, v21, s34, v10
    v_pk_mul_f32 v[20:21], v[20:21], v[100:101]
    v_exp_f32 v20, v20
    v_exp_f32 v21, v21
    v_add_f32 v20, 1.0, v20
    v_add_f32 v21, 1.0, v21
    v_rcp_f32 v20, v20
    v_rcp_f32 v21, v21
    s_nop 0
    v_pk_mul_f32 v[20:21], v[20:21], v[100:101]
    v_cvt_pk_bf16_f32 v20, v20, v21
    v_min_u32 v20, -2, v20
    buffer_store_dword v20, v5, s[44:47], s52 offen sc1
    buffer_store_dword v20, v5, s[44:47], s53 offen sc1
    s_branch L_fin
L_w1_x:
    s_waitcnt lgkmcnt(0)
    s_barrier
    s_branch L_fin
L_t_w2:
    s_barrier
L_w2_dma:
    s_and_b32 s34, s40, 7
    s_lshl_b32 s35, s34, 10
    s_add_u32 m0, s50, s35
    s_mul_i32 s34, s34, 40960
    buffer_load_dwordx4 v204, s[52:55], s34 offen  lds
    s_add_u32 s40, s40, 1
    s_cmp_lg_u32 s40, s42
    s_cbranch_scc1 L_w2_nw
L_w2_nw:
    s_cmp_lt_u32 s40, s41
    s_cbranch_scc1 L_w2_dma
    ds_read_b32 v8, v7
    s_waitcnt lgkmcnt(0)
    v_cmp_eq_u32 vcc, 0, v8
    s_cbranch_vccnz L_w2_slow
    s_mov_b32 s35, 0
    buffer_load_dwordx4 v[64:67], v4, s[44:47], 0 offen sc1
    buffer_load_dwordx4 v[68:71], v5, s[44:47], s48 offen sc1
    s_waitcnt vmcnt(2)
    ds_read_b64_tr_b16 v[32:33], v205 offset:0
    ds_read_b64_tr_b16 v[34:35], v205 offset:512
    ds_read_b64_tr_b16 v[36:37], v205 offset:1024
    ds_read_b64_tr_b16 v[38:39], v205 offset:1536
    ds_read_b64_tr_b16 v[40:41], v205 offset:2048
    ds_read_b64_tr_b16 v[42:43], v205 offset:2560
    ds_read_b64_tr_b16 v[44:45], v205 offset:3072
    ds_read_b64_tr_b16 v[46:47], v205 offset:3584
    s_waitcnt lgkmcnt(0)
    ds_read_b64_tr_b16 v[48:49], v205 offset:4096
    ds_read_b64_tr_b16 v[50:51], v205 offset:4608
    ds_read_b64_tr_b16 v[52:53], v205 offset:5120
    ds_read_b64_tr_b16 v[54:55], v205 offset:5632
    ds_read_b64_tr_b16 v[56:57], v205 offset:6144
    ds_read_b64_tr_b16 v[58:59], v205 offset:6656
    ds_read_b64_tr_b16 v[60:61], v205 offset:7168
    ds_read_b64_tr_b16 v[62:63], v205 offset:7680
    s_waitcnt lgkmcnt(0)
    s_branch L_w2_mid
L_w2_slow:
    s_waitcnt vmcnt(0)
    ds_read_b64_tr_b16 v[32:33], v205 offset:0
    ds_read_b64_tr_b16 v[34:35], v205 offset:512
    ds_read_b64_tr_b16 v[36:37], v205 offset:1024
    ds_read_b64_tr_b16 v[38:39], v205 offset:1536
    ds_read_b64_tr_b16 v[40:41], v205 offset:2048
    ds_read_b64_tr_b16 v[42:43], v205 offset:2560
    ds_read_b64_tr_b16 v[44:45], v205 offset:3072
    ds_read_b64_tr_b16 v[46:47], v205 offset:3584
    s_waitcnt lgkmcnt(0)
    ds_read_b64_tr_b16 v[48:49], v205 offset:4096
    ds_read_b64_tr_b16 v[50:51], v205 offset:4608
    ds_read_b64_tr_b16 v[52:53], v205 offset:5120
    ds_read_b64_tr_b16 v[54:55], v205 offset:5632
    ds_read_b64_tr_b16 v[56:57], v205 offset:6144
    ds_read_b64_tr_b16 v[58:59], v205 offset:6656
    ds_read_b64_tr_b16 v[60:61], v205 offset:7168
    ds_read_b64_tr_b16 v[62:63], v205 offset:7680
    s_waitcnt lgkmcnt(0)
    s_mov_b32 s35, 0
L_poll81:
    ds_read_b32 v8, v7
    s_add_u32 s35, s35, 1
    s_waitcnt lgkmcnt(0)
    v_cmp_eq_u32 vcc, 0, v8
    s_cbranch_vccz L_done82
    s_sleep 1
    s_cmp_lt_u32 s35, 60000
    s_cbranch_scc1 L_poll81
L_done82:
    s_mov_b32 s35, 0
L_poll84:
    buffer_load_dwordx4 v[64:67], v4, s[44:47], 0 offen sc1
    buffer_load_dwordx4 v[68:71], v5, s[44:47], s48 offen sc1
L_w2_mid:
    s_add_u32 s35, s35, 1
    s_waitcnt vmcnt(0)
    v_max3_u32 v28, v64, v65, v66
    v_max3_u32 v28, v28, v67, v68
    v_max3_u32 v28, v28, v69, v70
    v_max_u32 v28, v28, v71
    v_cmp_eq_u32 vcc, -1, v28
    s_cbranch_vccz L_done85
    s_cmp_lg_u32 s35, 64
    s_cbranch_scc1 L_tmo87
    s_mov_b64 exec, -1
    v_lshlrev_b32 v243, 4, v0
    v_add_u32 v243, 131328, v243
    ds_read_b96 v[240:242], v243
    s_waitcnt lgkmcnt(0)
    buffer_store_dword v240, v242, s[44:47], 0 offen sc1
    buffer_store_dword v241, v242, s[44:47], 0 offen offset:256 sc1
L_tmo87:
    s_cmp_lt_u32 s35, 60000
    s_cbranch_scc1 L_poll84
L_done85:
    v_mfma_f32_16x16x32_bf16 v[80:83], v[32:35], v[64:67], 0
    v_mfma_f32_16x16x32_bf16 v[80:83], v[48:51], v[68:71], v[80:83]
    v_mfma_f32_16x16x32_bf16 v[84:87], v[36:39], v[64:67], 0
    v_mfma_f32_16x16x32_bf16 v[84:87], v[52:55], v[68:71], v[84:87]
    v_mfma_f32_16x16x32_bf16 v[88:91], v[40:43], v[64:67], 0
    v_mfma_f32_16x16x32_bf16 v[88:91], v[56:59], v[68:71], v[88:91]
    v_mfma_f32_16x16x32_bf16 v[92:95], v[44:47], v[64:67], 0
    v_mfma_f32_16x16x32_bf16 v[92:95], v[60:63], v[68:71], v[92:95]
    s_nop 3
    v_add_f32_dpp v80, v84, v80 row_shl:4 row_mask:0xf bank_mask:0x1
    v_add_f32_dpp v81, v85, v81 row_shl:4 row_mask:0xf bank_mask:0x1
    v_add_f32_dpp v82, v86, v82 row_shl:4 row_mask:0xf bank_mask:0x1
    v_add_f32_dpp v83, v87, v83 row_shl:4 row_mask:0xf bank_mask:0x1
    v_add_f32_dpp v80, v88, v80 row_shl:8 row_mask:0xf bank_mask:0x1
    v_add_f32_dpp v81, v89, v81 row_shl:8 row_mask:0xf bank_mask:0x1
    v_add_f32_dpp v82, v90, v82 row_shl:8 row_mask:0xf bank_mask:0x1
    v_add_f32_dpp v83, v91, v83 row_shl:8 row_mask:0xf bank_mask:0x1
    v_add_f32_dpp v80, v92, v80 row_shl:12 row_mask:0xf bank_mask:0x1
    v_add_f32_dpp v81, v93, v81 row_shl:12 row_mask:0xf bank_mask:0x1
    v_add_f32_dpp v82, v94, v82 row_shl:12 row_mask:0xf bank_mask:0x1
    v_add_f32_dpp v83, v95, v83 row_shl:12 row_mask:0xf bank_mask:0x1
    ds_write_b128 v203, v[80:83]
    s_waitcnt lgkmcnt(0)
    s_barrier
    s_branch L_fin
L_w2_red:
    s_mov_b32 s35, 0
L_poll88:
    buffer_load_dwordx2 v[20:21], v204, s[44:47], 0 offen sc1
    buffer_load_dwordx2 v[22:23], v204, s[44:47], s48 offen sc1
    s_add_u32 s35, s35, 1
    s_waitcnt vmcnt(0)
    v_max3_u32 v28, v20, v21, v22
    v_max_u32 v28, v28, v23
    v_cmp_eq_u32 vcc, -1, v28
    s_cbranch_vccz L_done89
    s_cmp_lg_u32 s35, 21
    s_cbranch_scc1 L_tmo91
    s_mov_b64 exec, -1
    v_lshlrev_b32 v243, 4, v0
    v_add_u32 v243, 131328, v243
    ds_read_b96 v[240:242], v243
    s_waitcnt lgkmcnt(0)
    buffer_store_dword v240, v242, s[44:47], 0 offen sc1
    buffer_store_dword v241, v242, s[44:47], 0 offen offset:256 sc1
L_tmo91:
    s_sleep 6
    s_cmp_lt_u32 s35, 60000
    s_cbranch_scc1 L_poll88
L_done89:
    v_mov_b32 v7, 99084
    ds_write_b32 v7, v7
    v_lshlrev_b32 v44, 16, v20
    v_and_b32 v45, 0xffff0000, v20
    v_lshlrev_b32 v46, 16, v21
    v_and_b32 v47, 0xffff0000, v21
    v_lshlrev_b32 v48, 16, v22
    v_and_b32 v49, 0xffff0000, v22
    v_lshlrev_b32 v50, 16, v23
    v_and_b32 v51, 0xffff0000, v23
    v_add_f32 v108, v108, v44
    v_add_f32 v109, v109, v45
    v_add_f32 v110, v110, v46
    v_add_f32 v111, v111, v47
    v_add_f32 v108, v108, v48
    v_add_f32 v109, v109, v49
    v_add_f32 v110, v110, v50
    v_add_f32 v111, v111, v51
    s_mov_b32 s36, s28
    s_mov_b32 s37, s29
    s_movk_i32 s38, 5120
    v_add_f32_dpp v108, v108, v108 row_ror:4 row_mask:0xf bank_mask:0xf
    v_add_f32_dpp v109, v109, v109 row_ror:4 row_mask:0xf bank_mask:0xf
    v_add_f32_dpp v110, v110, v110 row_ror:4 row_mask:0xf bank_mask:0xf
    v_add_f32_dpp v111, v111, v111 row_ror:4 row_mask:0xf bank_mask:0xf
    v_add_f32_dpp v108, v108, v108 row_ror:8 row_mask:0xf bank_mask:0xf
    v_add_f32_dpp v109, v109, v109 row_ror:8 row_mask:0xf bank_mask:0xf
    v_add_f32_dpp v110, v110, v110 row_ror:8 row_mask:0xf bank_mask:0xf
    v_add_f32_dpp v111, v111, v111 row_ror:8 row_mask:0xf bank_mask:0xf
    v_mov_b32_dpp v108, v104 quad_perm:[0,1,2,3] row_mask:0xf bank_mask:0x2
    v_mov_b32_dpp v109, v105 quad_perm:[0,1,2,3] row_mask:0xf bank_mask:0x2
    v_mov_b32_dpp v110, v106 quad_perm:[0,1,2,3] row_mask:0xf bank_mask:0x2
    v_mov_b32_dpp v111, v107 quad_perm:[0,1,2,3] row_mask:0xf bank_mask:0x2
    ds_write_b128 v203, v[108:111]
    v_and_b32 v6, 31, v0
    v_lshlrev_b32 v6, 3, v6
    v_add_u32 v6, 122112, v6
    ds_read_b64 v[108:109], v6
    ds_read_b64 v[104:105], v6 offset:320
    v_bfe_u32 v112, v0, 1, 2
    v_mul_u32_u24 v112, 1280, v112
    v_bfe_u32 v7, v0, 3, 2
    v_lshl_add_u32 v112, v7, 3, v112
    v_and_b32 v7, 1, v0
    v_lshl_add_u32 v112, v7, 2, v112
    v_lshrrev_b32 v7, 5, v0
    v_lshl_add_u32 v112, v7, 28, v112
    s_lshl_b32 s34, s62, 5
    s_waitcnt lgkmcnt(0)
    s_barrier
    ds_read_b64 v[64:65], v6 offset:1024
    ds_read_b64 v[66:67], v6 offset:2048
    ds_read_b64 v[68:69], v6 offset:3072
    ds_read_b64 v[70:71], v6 offset:4096
    ds_read_b64 v[72:73], v6 offset:5120
    ds_read_b64 v[74:75], v6 offset:6144
    ds_read_b64 v[76:77], v6 offset:7168
    s_waitcnt lgkmcnt(6)
    v_pk_fma_f32 v[108:109], v[64:65], v[104:105], v[108:109]
    s_waitcnt lgkmcnt(5)
    v_pk_fma_f32 v[108:109], v[66:67], v[104:105], v[108:109]
    s_waitcnt lgkmcnt(4)
    v_pk_fma_f32 v[108:109], v[68:69], v[104:105], v[108:109]
    s_waitcnt lgkmcnt(3)
    v_pk_fma_f32 v[108:109], v[70:71], v[104:105], v[108:109]
    s_waitcnt lgkmcnt(2)
    v_pk_fma_f32 v[108:109], v[72:73], v[104:105], v[108:109]
    s_waitcnt lgkmcnt(1)
    v_pk_fma_f32 v[108:109], v[74:75], v[104:105], v[108:109]
    s_waitcnt lgkmcnt(0)
    v_pk_fma_f32 v[108:109], v[76:77], v[104:105], v[108:109]
    v_cvt_pk_bf16_f32 v20, v108, v109
    buffer_store_dword v20, v112, s[36:39], s34 offen
    s_branch L_fin
L_t_wo:
    s_barrier
L_r_wo2:
    s_mov_b32 m0, s56
    s_nop 0
    buffer_load_dwordx4 v15, s[52:55], s57 offen  lds
    s_mov_b32 m0, s58
    s_nop 0
    buffer_load_dwordx4 v15, s[52:55], s59 offen  lds
    s_xor_b32 m0, s56, 2048
    s_sub_u32 s34, 40960, s57
    buffer_load_dwordx4 v15, s[52:55], s34 offen  lds
    s_xor_b32 m0, s58, 2048
    s_sub_u32 s34, 42240, s57
    buffer_load_dwordx4 v15, s[52:55], s34 offen  lds
L_r_wo3:
    s_mov_b32 s35, 0
    s_mov_b32 s48, 0
    buffer_load_dwordx4 v[64:67], v205, s[44:47], 0 offen sc1
    buffer_load_dwordx2 v[26:27], v204, s[44:47], 0 offen sc1
    s_waitcnt vmcnt(2)
    ds_read_b64_tr_b16 v[32:33], v206 offset:0
    ds_read_b64_tr_b16 v[34:35], v206 offset:1024
    ds_read_b64_tr_b16 v[36:37], v206 offset:32
    ds_read_b64_tr_b16 v[38:39], v206 offset:1056
    ds_read_b64_tr_b16 v[40:41], v206 offset:2048
    ds_read_b64_tr_b16 v[42:43], v206 offset:3072
    ds_read_b64_tr_b16 v[44:45], v206 offset:2080
    ds_read_b64_tr_b16 v[46:47], v206 offset:3104
    s_branch L_pam
L_pa:
    buffer_load_dwordx4 v[64:67], v205, s[44:47], 0 offen sc1
    buffer_load_dwordx2 v[26:27], v204, s[44:47], 0 offen sc1
L_pam:
    s_add_u32 s35, s35, 1
    s_waitcnt vmcnt(0)
    ds_write_b128 v207, v[64:67]
    ds_write_b32 v212, v26 offset:128
    v_max3_u32 v28, v64, v65, v66
    v_max3_u32 v28, v28, v67, v26
    v_cmp_eq_u32 vcc, -1, v28
    s_cbranch_vccz L_pad
    s_cmp_lg_u32 s35, 64
    s_cbranch_scc1 L_tmo92
    s_mov_b64 exec, -1
    v_lshlrev_b32 v243, 4, v0
    v_add_u32 v243, 131328, v243
    ds_read_b96 v[240:242], v243
    s_waitcnt lgkmcnt(0)
    buffer_store_dword v240, v242, s[44:47], 0 offen sc1
    buffer_store_dword v241, v242, s[44:47], 0 offen offset:256 sc1
L_tmo92:
    s_mov_b64 exec, vcc
    s_cmp_lt_u32 s35, 60000
    s_cbranch_scc1 L_pa
L_pad:
    s_mov_b64 exec, -1
    ds_read_b32 v26, v213 offset:128
    ds_read_b128 v[68:71], v208 offset:0
    ds_read_b128 v[72:75], v209 offset:0
    ds_read_b128 v[76:79], v208 offset:64
    ds_read_b128 v[80:83], v209 offset:64
    s_waitcnt lgkmcnt(3)
    v_mfma_f32_16x16x32_bf16 v[20:23], v[32:35], v[68:71], 0
    s_waitcnt lgkmcnt(2)
    v_mfma_f32_16x16x32_bf16 v[20:23], v[36:39], v[72:75], v[20:23]
    s_waitcnt lgkmcnt(1)
    v_mfma_f32_16x16x32_bf16 v[20:23], v[40:43], v[76:79], v[20:23]
    s_waitcnt lgkmcnt(0)
    v_mfma_f32_16x16x32_bf16 v[20:23], v[44:47], v[80:83], v[20:23]
    v_sub_f32_dpp v26, v26, v26 quad_perm:[1,0,3,2] row_mask:0xf bank_mask:0xf
    v_exp_f32 v26, v26
    s_nop 0
    v_add_f32 v26, 1.0, v26
    v_rcp_f32 v26, v26
    s_nop 0
    v_sub_f32 v30, 1.0, v26
    s_nop 0
    v_pk_mul_f32 v[48:49], v[20:21], v[26:27] op_sel_hi:[1,0]
    v_pk_mul_f32 v[50:51], v[22:23], v[26:27] op_sel_hi:[1,0]
    v_fmac_f32_dpp v48, v20, v30 quad_perm:[1,0,3,2] row_mask:0xf bank_mask:0xf
    v_fmac_f32_dpp v49, v21, v30 quad_perm:[1,0,3,2] row_mask:0xf bank_mask:0xf
    v_fmac_f32_dpp v50, v22, v30 quad_perm:[1,0,3,2] row_mask:0xf bank_mask:0xf
    v_fmac_f32_dpp v51, v23, v30 quad_perm:[1,0,3,2] row_mask:0xf bank_mask:0xf
    ds_write_b128 v203, v[48:51]
    s_cmp_lg_u32 s3, 0
    s_waitcnt lgkmcnt(0)
    s_barrier
    s_cbranch_scc1 L_wo_x
    ds_read_b64 v[64:65], v113 offset:0
    ds_read_b64 v[66:67], v113 offset:1152
    ds_read_b64 v[68:69], v113 offset:2304
    ds_read_b64 v[70:71], v113 offset:3456
    ds_read_b64 v[72:73], v113 offset:4608
    ds_read_b64 v[74:75], v113 offset:5760
    ds_read_b64 v[76:77], v113 offset:6912
    ds_read_b64 v[78:79], v113 offset:8064
    s_waitcnt lgkmcnt(6)
    v_pk_add_f32 v[64:65], v[64:65], v[66:67]
    s_waitcnt lgkmcnt(5)
    v_pk_add_f32 v[64:65], v[64:65], v[68:69]
    s_waitcnt lgkmcnt(4)
    v_pk_add_f32 v[64:65], v[64:65], v[70:71]
    s_waitcnt lgkmcnt(3)
    v_pk_add_f32 v[64:65], v[64:65], v[72:73]
    s_waitcnt lgkmcnt(2)
    v_pk_add_f32 v[64:65], v[64:65], v[74:75]
    s_waitcnt lgkmcnt(1)
    v_pk_add_f32 v[64:65], v[64:65], v[76:77]
    s_waitcnt lgkmcnt(0)
    v_pk_add_f32 v[64:65], v[64:65], v[78:79]
    v_pk_mul_f32 v[64:65], v[64:65], v[100:101]
    v_cvt_pk_bf16_f32 v28, v64, v65
    v_min_u32 v28, -2, v28
    buffer_store_dword v28, v112, s[44:47], s101 offen sc1
    buffer_store_dword v28, v112, s[44:47], s93 offen sc1
L_wo_x:
    s_getreg_b32 s34, hwreg(HW_REG_XCC_ID, 0, 4)
    v_cmp_ne_u32 vcc, s34, v27
    s_cbranch_vccz L_fin
    s_mov_b64 exec, -1
    v_lshlrev_b32 v243, 4, v0
    v_add_u32 v243, 131328, v243
    ds_read_b96 v[240:242], v243
    s_waitcnt lgkmcnt(0)
    buffer_store_dword v240, v242, s[44:47], 0 offen sc1
    buffer_store_dword v241, v242, s[44:47], 0 offen offset:256 sc1
L_fin:
L_exit:
    s_endpgm
L_codeend:
.section .rodata,"a"
.p2align 6
.amdhsa_kernel adaLN_cond__sliding_block_cached__dense_activation_gelu__decode_kernel
  .amdhsa_next_free_vgpr 256
  .amdhsa_next_free_sgpr 102
  .amdhsa_accum_offset 256
  .amdhsa_group_segment_fixed_size 0
  .amdhsa_kernarg_size 120
  .amdhsa_user_sgpr_count 2
  .amdhsa_user_sgpr_kernarg_segment_ptr 1
  .amdhsa_system_sgpr_workgroup_id_x 1
  .amdhsa_float_denorm_mode_32 3
.end_amdhsa_kernel
```

```asm
; @launch grid=(256,1,1) block=(512,1,1) lds=132352
.amdgcn_target "amdgcn-amd-amdhsa--gfx950"
.text
.globl adaLN_cond__sliding_block_cached__dense_activation_gelu__decode_kernel
.p2align 8
.type adaLN_cond__sliding_block_cached__dense_activation_gelu__decode_kernel,@function
adaLN_cond__sliding_block_cached__dense_activation_gelu__decode_kernel:
    s_cmp_ge_u32 s2, 256
    s_cbranch_scc1 L_exit
    s_load_dwordx4 s[4:7], s[0:1], 0
    v_lshrrev_b32 v1, 6, v0
    v_and_b32 v0, 63, v0
    v_readfirstlane_b32 s3, v1
    s_and_b32 s34, s2, 127
    s_lshl_b32 s34, s34, 21
    s_lshr_b32 s35, s2, 7
    s_lshl_b32 s35, s35, 18
    s_add_u32 s34, s34, s35
    s_add_u32 s34, s34, 1572864
    s_mov_b32 s38, 0x40000
    s_mov_b32 s39, 0x20000
    s_sub_u32 s49, s3, 1
    s_cbranch_scc1 L_nohead
    s_lshl_b32 s49, s49, 12
    v_lshl_add_u32 v1, v0, 4, s49
    s_waitcnt lgkmcnt(0)
    s_add_u32 s36, s6, s34
    s_addc_u32 s37, s7, 0
    buffer_load_dwordx4 v[16:19], v1, s[36:39], 0 offen offset:0 nt
    buffer_load_dwordx4 v[20:23], v1, s[36:39], 0 offen offset:1024 nt
    buffer_load_dwordx4 v[24:27], v1, s[36:39], 0 offen offset:2048 nt
L_nohead:
    s_load_dwordx8 s[8:15], s[0:1], 16
    s_load_dwordx4 s[16:19], s[0:1], 48
    s_load_dwordx8 s[20:27], s[0:1], 64
    s_load_dwordx4 s[28:31], s[0:1], 96
    s_load_dwordx2 s[32:33], s[0:1], 112
    s_and_b32 s60, s2, 7
    s_lshr_b32 s61, s2, 3
    s_mov_b32 s39, 0x20000
    s_mov_b32 s43, 0x20000
    s_mov_b32 s46, 1703936
    s_mov_b32 s47, 0x20000
    s_cmp_lg_u32 s3, 0
    s_cbranch_scc1 L_stream
    s_setprio 3
    v_and_b32 v12, 3, v0
    v_bfe_u32 v13, v0, 2, 2
    v_lshrrev_b32 v14, 4, v0
    v_lshrrev_b32 v10, 3, v0
    v_and_b32 v11, 7, v0
    v_lshlrev_b32 v11, 4, v11
    s_lshr_b32 s50, s2, 2
    s_and_b32 s51, s2, 3
    s_mul_i32 s34, s51, 1228800
    s_lshl_b32 s35, s50, 7
    s_add_u32 s34, s34, s35
    v_mul_u32_u24 v17, 7680, v10
    v_add3_u32 v17, v17, v11, s34
    v_mul_u32_u24 v16, 1280, v12
    v_lshl_add_u32 v18, v14, 4, v16
    s_mul_i32 s34, s51, 320
    v_add_u32 v19, s34, v18
    s_mov_b32 s38, 4915200
    s_sub_u32 s52, s50, 10
    s_waitcnt lgkmcnt(0)
    s_add_u32 s44, s32, 0
    s_addc_u32 s45, s33, 0
    s_cmp_ge_u32 s2, 240
    s_cbranch_scc1 L_clear
    s_cmp_ge_u32 s52, 10
    s_cbranch_scc1 L_nox
    v_lshl_add_u32 v18, v13, 6, v18
    global_load_dwordx4 v[52:55], v18, s[4:5] offset:0
    global_load_dwordx4 v[56:59], v18, s[4:5] offset:256
    global_load_dwordx4 v[60:63], v18, s[4:5] offset:512
    global_load_dwordx4 v[64:67], v18, s[4:5] offset:768
    global_load_dwordx4 v[68:71], v18, s[4:5] offset:1024
    s_lshl_b32 s34, s52, 7
    v_lshl_add_u32 v16, v13, 5, v16
    v_lshl_add_u32 v16, v14, 3, v16
    v_add_u32 v16, s34, v16
    global_load_dwordx2 v[72:73], v16, s[4:5]
L_nox:
    global_load_dwordx4 v[32:35], v19, s[24:25] offset:0
    global_load_dwordx4 v[36:39], v19, s[24:25] offset:64
    global_load_dwordx4 v[40:43], v19, s[24:25] offset:128
    global_load_dwordx4 v[44:47], v19, s[24:25] offset:192
    global_load_dwordx4 v[48:51], v19, s[24:25] offset:256
    s_mov_b32 s36, s26
    s_mov_b32 s37, s27
    s_mov_b32 m0, 0
    s_mov_b32 s34, 0
L_dma1:
    buffer_load_dwordx4 v17, s[36:39], s34 offen  lds
    s_add_u32 m0, m0, 1024
    s_add_u32 s34, s34, 61440
    buffer_load_dwordx4 v17, s[36:39], s34 offen  lds
    s_add_u32 m0, m0, 1024
    s_add_u32 s34, s34, 61440
    buffer_load_dwordx4 v17, s[36:39], s34 offen  lds
    s_add_u32 m0, m0, 1024
    s_add_u32 s34, s34, 61440
    buffer_load_dwordx4 v17, s[36:39], s34 offen  lds
    s_add_u32 m0, m0, 1024
    s_add_u32 s34, s34, 61440
    s_cmp_lt_u32 s34, 1228800
    s_cbranch_scc1 L_dma1
    v_lshlrev_b32 v1, 2, v0
    v_add_u32 v1, 98304, v1
    v_mov_b32 v2, -1
    v_mov_b32 v3, 0
    ds_write_b32 v1, v2
    ds_write_b32 v1, v2 offset:256
    ds_write_b32 v1, v3 offset:512
    ds_write_b32 v1, v3 offset:768
    s_waitcnt lgkmcnt(0)
    s_barrier
    s_and_b32 s34, s2, 31
    s_lshl_b32 s34, s34, 8
    s_lshr_b32 s35, s2, 7
    s_lshl_b32 s35, s35, 7
    s_add_u32 s49, s34, s35
    s_bfe_u32 s53, s2, 0x20005
    s_mul_i32 s34, s53, 1310720
    s_add_u32 s34, s34, s49
    v_lshl_add_u32 v16, v10, 13, v11
    v_add_u32 v16, s34, v16
    s_mov_b32 s36, s10
    s_mov_b32 s37, s11
    s_mov_b32 s38, 5242880
    s_mov_b32 m0, 20480
    s_mov_b32 s34, 0
L_dma2:
    buffer_load_dwordx4 v16, s[36:39], s34 offen  lds
    s_add_u32 m0, m0, 1024
    s_add_u32 s34, s34, 65536
    buffer_load_dwordx4 v16, s[36:39], s34 offen  lds
    s_add_u32 m0, m0, 1024
    s_add_u32 s34, s34, 65536
    buffer_load_dwordx4 v16, s[36:39], s34 offen  lds
    s_add_u32 m0, m0, 1024
    s_add_u32 s34, s34, 65536
    buffer_load_dwordx4 v16, s[36:39], s34 offen  lds
    s_add_u32 m0, m0, 1024
    s_add_u32 s34, s34, 65536
    s_cmp_lt_u32 s34, 1310720
    s_cbranch_scc1 L_dma2
    v_lshl_add_u32 v15, v14, 3, v13
    v_lshlrev_b32 v15, 7, v15
    v_lshl_add_u32 v15, v12, 3, v15
    s_waitcnt vmcnt(40)
    s_mov_b32 s34, 0xbfb8aa3b
    v_lshlrev_b32 v20, 16, v32
    v_and_b32 v21, 0xffff0000, v32
    v_lshlrev_b32 v22, 16, v33
    v_and_b32 v23, 0xffff0000, v33
    v_mul_f32 v24, s34, v20
    v_mul_f32 v25, s34, v21
    v_mul_f32 v26, s34, v22
    v_mul_f32 v27, s34, v23
    v_exp_f32 v24, v24
    v_exp_f32 v25, v25
    v_exp_f32 v26, v26
    v_exp_f32 v27, v27
    v_add_f32 v24, 1.0, v24
    v_add_f32 v25, 1.0, v25
    v_add_f32 v26, 1.0, v26
    v_add_f32 v27, 1.0, v27
    v_rcp_f32 v24, v24
    v_rcp_f32 v25, v25
    v_rcp_f32 v26, v26
    v_rcp_f32 v27, v27
    v_mul_f32 v24, v20, v24
    v_mul_f32 v25, v21, v25
    v_mul_f32 v26, v22, v26
    v_mul_f32 v27, v23, v27
    v_cvt_pk_bf16_f32 v32, v24, v25
    v_cvt_pk_bf16_f32 v33, v26, v27
    v_lshlrev_b32 v20, 16, v34
    v_and_b32 v21, 0xffff0000, v34
    v_lshlrev_b32 v22, 16, v35
    v_and_b32 v23, 0xffff0000, v35
    v_mul_f32 v24, s34, v20
    v_mul_f32 v25, s34, v21
    v_mul_f32 v26, s34, v22
    v_mul_f32 v27, s34, v23
    v_exp_f32 v24, v24
    v_exp_f32 v25, v25
    v_exp_f32 v26, v26
    v_exp_f32 v27, v27
    v_add_f32 v24, 1.0, v24
    v_add_f32 v25, 1.0, v25
    v_add_f32 v26, 1.0, v26
    v_add_f32 v27, 1.0, v27
    v_rcp_f32 v24, v24
    v_rcp_f32 v25, v25
    v_rcp_f32 v26, v26
    v_rcp_f32 v27, v27
    v_mul_f32 v24, v20, v24
    v_mul_f32 v25, v21, v25
    v_mul_f32 v26, v22, v26
    v_mul_f32 v27, v23, v27
    v_cvt_pk_bf16_f32 v34, v24, v25
    v_cvt_pk_bf16_f32 v35, v26, v27
    v_lshlrev_b32 v20, 16, v36
    v_and_b32 v21, 0xffff0000, v36
    v_lshlrev_b32 v22, 16, v37
    v_and_b32 v23, 0xffff0000, v37
    v_mul_f32 v24, s34, v20
    v_mul_f32 v25, s34, v21
    v_mul_f32 v26, s34, v22
    v_mul_f32 v27, s34, v23
    v_exp_f32 v24, v24
    v_exp_f32 v25, v25
    v_exp_f32 v26, v26
    v_exp_f32 v27, v27
    v_add_f32 v24, 1.0, v24
    v_add_f32 v25, 1.0, v25
    v_add_f32 v26, 1.0, v26
    v_add_f32 v27, 1.0, v27
    v_rcp_f32 v24, v24
    v_rcp_f32 v25, v25
    v_rcp_f32 v26, v26
    v_rcp_f32 v27, v27
    v_mul_f32 v24, v20, v24
    v_mul_f32 v25, v21, v25
    v_mul_f32 v26, v22, v26
    v_mul_f32 v27, v23, v27
    v_cvt_pk_bf16_f32 v36, v24, v25
    v_cvt_pk_bf16_f32 v37, v26, v27
    v_lshlrev_b32 v20, 16, v38
    v_and_b32 v21, 0xffff0000, v38
    v_lshlrev_b32 v22, 16, v39
    v_and_b32 v23, 0xffff0000, v39
    v_mul_f32 v24, s34, v20
    v_mul_f32 v25, s34, v21
    v_mul_f32 v26, s34, v22
    v_mul_f32 v27, s34, v23
    v_exp_f32 v24, v24
    v_exp_f32 v25, v25
    v_exp_f32 v26, v26
    v_exp_f32 v27, v27
    v_add_f32 v24, 1.0, v24
    v_add_f32 v25, 1.0, v25
    v_add_f32 v26, 1.0, v26
    v_add_f32 v27, 1.0, v27
    v_rcp_f32 v24, v24
    v_rcp_f32 v25, v25
    v_rcp_f32 v26, v26
    v_rcp_f32 v27, v27
    v_mul_f32 v24, v20, v24
    v_mul_f32 v25, v21, v25
    v_mul_f32 v26, v22, v26
    v_mul_f32 v27, v23, v27
    v_cvt_pk_bf16_f32 v38, v24, v25
    v_cvt_pk_bf16_f32 v39, v26, v27
    v_lshlrev_b32 v20, 16, v40
    v_and_b32 v21, 0xffff0000, v40
    v_lshlrev_b32 v22, 16, v41
    v_and_b32 v23, 0xffff0000, v41
    v_mul_f32 v24, s34, v20
    v_mul_f32 v25, s34, v21
    v_mul_f32 v26, s34, v22
    v_mul_f32 v27, s34, v23
    v_exp_f32 v24, v24
    v_exp_f32 v25, v25
    v_exp_f32 v26, v26
    v_exp_f32 v27, v27
    v_add_f32 v24, 1.0, v24
    v_add_f32 v25, 1.0, v25
    v_add_f32 v26, 1.0, v26
    v_add_f32 v27, 1.0, v27
    v_rcp_f32 v24, v24
    v_rcp_f32 v25, v25
    v_rcp_f32 v26, v26
    v_rcp_f32 v27, v27
    v_mul_f32 v24, v20, v24
    v_mul_f32 v25, v21, v25
    v_mul_f32 v26, v22, v26
    v_mul_f32 v27, v23, v27
    v_cvt_pk_bf16_f32 v40, v24, v25
    v_cvt_pk_bf16_f32 v41, v26, v27
    v_lshlrev_b32 v20, 16, v42
    v_and_b32 v21, 0xffff0000, v42
    v_lshlrev_b32 v22, 16, v43
    v_and_b32 v23, 0xffff0000, v43
    v_mul_f32 v24, s34, v20
    v_mul_f32 v25, s34, v21
    v_mul_f32 v26, s34, v22
    v_mul_f32 v27, s34, v23
    v_exp_f32 v24, v24
    v_exp_f32 v25, v25
    v_exp_f32 v26, v26
    v_exp_f32 v27, v27
    v_add_f32 v24, 1.0, v24
    v_add_f32 v25, 1.0, v25
    v_add_f32 v26, 1.0, v26
    v_add_f32 v27, 1.0, v27
    v_rcp_f32 v24, v24
    v_rcp_f32 v25, v25
    v_rcp_f32 v26, v26
    v_rcp_f32 v27, v27
    v_mul_f32 v24, v20, v24
    v_mul_f32 v25, v21, v25
    v_mul_f32 v26, v22, v26
    v_mul_f32 v27, v23, v27
    v_cvt_pk_bf16_f32 v42, v24, v25
    v_cvt_pk_bf16_f32 v43, v26, v27
    v_lshlrev_b32 v20, 16, v44
    v_and_b32 v21, 0xffff0000, v44
    v_lshlrev_b32 v22, 16, v45
    v_and_b32 v23, 0xffff0000, v45
    v_mul_f32 v24, s34, v20
    v_mul_f32 v25, s34, v21
    v_mul_f32 v26, s34, v22
    v_mul_f32 v27, s34, v23
    v_exp_f32 v24, v24
    v_exp_f32 v25, v25
    v_exp_f32 v26, v26
    v_exp_f32 v27, v27
    v_add_f32 v24, 1.0, v24
    v_add_f32 v25, 1.0, v25
    v_add_f32 v26, 1.0, v26
    v_add_f32 v27, 1.0, v27
    v_rcp_f32 v24, v24
    v_rcp_f32 v25, v25
    v_rcp_f32 v26, v26
    v_rcp_f32 v27, v27
    v_mul_f32 v24, v20, v24
    v_mul_f32 v25, v21, v25
    v_mul_f32 v26, v22, v26
    v_mul_f32 v27, v23, v27
    v_cvt_pk_bf16_f32 v44, v24, v25
    v_cvt_pk_bf16_f32 v45, v26, v27
    v_lshlrev_b32 v20, 16, v46
    v_and_b32 v21, 0xffff0000, v46
    v_lshlrev_b32 v22, 16, v47
    v_and_b32 v23, 0xffff0000, v47
    v_mul_f32 v24, s34, v20
    v_mul_f32 v25, s34, v21
    v_mul_f32 v26, s34, v22
    v_mul_f32 v27, s34, v23
    v_exp_f32 v24, v24
    v_exp_f32 v25, v25
    v_exp_f32 v26, v26
    v_exp_f32 v27, v27
    v_add_f32 v24, 1.0, v24
    v_add_f32 v25, 1.0, v25
    v_add_f32 v26, 1.0, v26
    v_add_f32 v27, 1.0, v27
    v_rcp_f32 v24, v24
    v_rcp_f32 v25, v25
    v_rcp_f32 v26, v26
    v_rcp_f32 v27, v27
    v_mul_f32 v24, v20, v24
    v_mul_f32 v25, v21, v25
    v_mul_f32 v26, v22, v26
    v_mul_f32 v27, v23, v27
    v_cvt_pk_bf16_f32 v46, v24, v25
    v_cvt_pk_bf16_f32 v47, v26, v27
    v_lshlrev_b32 v20, 16, v48
    v_and_b32 v21, 0xffff0000, v48
    v_lshlrev_b32 v22, 16, v49
    v_and_b32 v23, 0xffff0000, v49
    v_mul_f32 v24, s34, v20
    v_mul_f32 v25, s34, v21
    v_mul_f32 v26, s34, v22
    v_mul_f32 v27, s34, v23
    v_exp_f32 v24, v24
    v_exp_f32 v25, v25
    v_exp_f32 v26, v26
    v_exp_f32 v27, v27
    v_add_f32 v24, 1.0, v24
    v_add_f32 v25, 1.0, v25
    v_add_f32 v26, 1.0, v26
    v_add_f32 v27, 1.0, v27
    v_rcp_f32 v24, v24
    v_rcp_f32 v25, v25
    v_rcp_f32 v26, v26
    v_rcp_f32 v27, v27
    v_mul_f32 v24, v20, v24
    v_mul_f32 v25, v21, v25
    v_mul_f32 v26, v22, v26
    v_mul_f32 v27, v23, v27
    v_cvt_pk_bf16_f32 v48, v24, v25
    v_cvt_pk_bf16_f32 v49, v26, v27
    v_lshlrev_b32 v20, 16, v50
    v_and_b32 v21, 0xffff0000, v50
    v_lshlrev_b32 v22, 16, v51
    v_and_b32 v23, 0xffff0000, v51
    v_mul_f32 v24, s34, v20
    v_mul_f32 v25, s34, v21
    v_mul_f32 v26, s34, v22
    v_mul_f32 v27, s34, v23
    v_exp_f32 v24, v24
    v_exp_f32 v25, v25
    v_exp_f32 v26, v26
    v_exp_f32 v27, v27
    v_add_f32 v24, 1.0, v24
    v_add_f32 v25, 1.0, v25
    v_add_f32 v26, 1.0, v26
    v_add_f32 v27, 1.0, v27
    v_rcp_f32 v24, v24
    v_rcp_f32 v25, v25
    v_rcp_f32 v26, v26
    v_rcp_f32 v27, v27
    v_mul_f32 v24, v20, v24
    v_mul_f32 v25, v21, v25
    v_mul_f32 v26, v22, v26
    v_mul_f32 v27, v23, v27
    v_cvt_pk_bf16_f32 v50, v24, v25
    v_cvt_pk_bf16_f32 v51, v26, v27
    s_cmp_ge_u32 s52, 10
    s_cbranch_scc1 L_nostats
    v_mov_b32 v20, 0
    v_mov_b32 v21, 0
    v_mov_b32 v22, 0x3f803f80
    v_dot2c_f32_bf16 v20, v52, v22
    v_dot2c_f32_bf16 v21, v52, v52
    v_dot2c_f32_bf16 v20, v53, v22
    v_dot2c_f32_bf16 v21, v53, v53
    v_dot2c_f32_bf16 v20, v54, v22
    v_dot2c_f32_bf16 v21, v54, v54
    v_dot2c_f32_bf16 v20, v55, v22
    v_dot2c_f32_bf16 v21, v55, v55
    v_dot2c_f32_bf16 v20, v56, v22
    v_dot2c_f32_bf16 v21, v56, v56
    v_dot2c_f32_bf16 v20, v57, v22
    v_dot2c_f32_bf16 v21, v57, v57
    v_dot2c_f32_bf16 v20, v58, v22
    v_dot2c_f32_bf16 v21, v58, v58
    v_dot2c_f32_bf16 v20, v59, v22
    v_dot2c_f32_bf16 v21, v59, v59
    v_dot2c_f32_bf16 v20, v60, v22
    v_dot2c_f32_bf16 v21, v60, v60
    v_dot2c_f32_bf16 v20, v61, v22
    v_dot2c_f32_bf16 v21, v61, v61
    v_dot2c_f32_bf16 v20, v62, v22
    v_dot2c_f32_bf16 v21, v62, v62
    v_dot2c_f32_bf16 v20, v63, v22
    v_dot2c_f32_bf16 v21, v63, v63
    v_dot2c_f32_bf16 v20, v64, v22
    v_dot2c_f32_bf16 v21, v64, v64
    v_dot2c_f32_bf16 v20, v65, v22
    v_dot2c_f32_bf16 v21, v65, v65
    v_dot2c_f32_bf16 v20, v66, v22
    v_dot2c_f32_bf16 v21, v66, v66
    v_dot2c_f32_bf16 v20, v67, v22
    v_dot2c_f32_bf16 v21, v67, v67
    v_dot2c_f32_bf16 v20, v68, v22
    v_dot2c_f32_bf16 v21, v68, v68
    v_dot2c_f32_bf16 v20, v69, v22
    v_dot2c_f32_bf16 v21, v69, v69
    v_dot2c_f32_bf16 v20, v70, v22
    v_dot2c_f32_bf16 v21, v70, v70
    v_dot2c_f32_bf16 v20, v71, v22
    v_dot2c_f32_bf16 v21, v71, v71
    s_nop 1
    v_add_f32_dpp v20, v20, v20 row_ror:4 row_mask:0xf bank_mask:0xf
    v_add_f32_dpp v21, v21, v21 row_ror:4 row_mask:0xf bank_mask:0xf
    s_nop 0
    v_add_f32_dpp v20, v20, v20 row_ror:8 row_mask:0xf bank_mask:0xf
    v_add_f32_dpp v21, v21, v21 row_ror:8 row_mask:0xf bank_mask:0xf
    v_mov_b32 v22, v20
    v_mov_b32 v23, v21
    s_nop 0
    v_permlane16_swap_b32 v20, v22
    v_permlane16_swap_b32 v21, v23
    v_add_f32 v20, v20, v22
    v_add_f32 v21, v21, v23
    v_mov_b32 v22, v20
    v_mov_b32 v23, v21
    s_nop 0
    v_permlane32_swap_b32 v20, v22
    v_permlane32_swap_b32 v21, v23
    v_add_f32 v20, v20, v22
    v_add_f32 v21, v21, v23
    v_mul_f32 v22, 0x3acccccd, v20
    v_mul_f32 v21, 0x3acccccd, v21
    v_fma_f32 v21, -v22, v22, v21
    v_max_f32 v21, 0, v21
    v_add_f32 v21, 0x3727c5ac, v21
    v_rsq_f32 v20, v21
    s_nop 0
    v_mul_f32_e64 v21, -v22, v20
    v_lshlrev_b32 v24, 16, v72
    v_and_b32 v25, 0xffff0000, v72
    v_lshlrev_b32 v26, 16, v73
    v_and_b32 v27, 0xffff0000, v73
    v_fma_f32 v24, v24, v20, v21
    v_fma_f32 v25, v25, v20, v21
    v_fma_f32 v26, v26, v20, v21
    v_fma_f32 v27, v27, v20, v21
L_nostats:
    s_waitcnt vmcnt(20)
    ds_read_b64_tr_b16 v[96:97], v15 offset:0
    ds_read_b64_tr_b16 v[98:99], v15 offset:512
    ds_read_b64_tr_b16 v[100:101], v15 offset:32
    ds_read_b64_tr_b16 v[102:103], v15 offset:544
    ds_read_b64_tr_b16 v[104:105], v15 offset:64
    ds_read_b64_tr_b16 v[106:107], v15 offset:576
    ds_read_b64_tr_b16 v[108:109], v15 offset:96
    ds_read_b64_tr_b16 v[110:111], v15 offset:608
    s_waitcnt lgkmcnt(7)
    ds_read_b64_tr_b16 v[112:113], v15 offset:4096
    ds_read_b64_tr_b16 v[114:115], v15 offset:4608
    ds_read_b64_tr_b16 v[116:117], v15 offset:4128
    ds_read_b64_tr_b16 v[118:119], v15 offset:4640
    ds_read_b64_tr_b16 v[120:121], v15 offset:4160
    ds_read_b64_tr_b16 v[122:123], v15 offset:4672
    ds_read_b64_tr_b16 v[124:125], v15 offset:4192
    ds_read_b64_tr_b16 v[126:127], v15 offset:4704
    s_waitcnt lgkmcnt(7)
    ds_read_b64_tr_b16 v[128:129], v15 offset:8192
    ds_read_b64_tr_b16 v[130:131], v15 offset:8704
    ds_read_b64_tr_b16 v[132:133], v15 offset:8224
    ds_read_b64_tr_b16 v[134:135], v15 offset:8736
    ds_read_b64_tr_b16 v[136:137], v15 offset:8256
    ds_read_b64_tr_b16 v[138:139], v15 offset:8768
    ds_read_b64_tr_b16 v[140:141], v15 offset:8288
    ds_read_b64_tr_b16 v[142:143], v15 offset:8800
    s_waitcnt lgkmcnt(7)
    ds_read_b64_tr_b16 v[144:145], v15 offset:12288
    ds_read_b64_tr_b16 v[146:147], v15 offset:12800
    ds_read_b64_tr_b16 v[148:149], v15 offset:12320
    ds_read_b64_tr_b16 v[150:151], v15 offset:12832
    ds_read_b64_tr_b16 v[152:153], v15 offset:12352
    ds_read_b64_tr_b16 v[154:155], v15 offset:12864
    ds_read_b64_tr_b16 v[156:157], v15 offset:12384
    ds_read_b64_tr_b16 v[158:159], v15 offset:12896
    s_waitcnt lgkmcnt(7)
    ds_read_b64_tr_b16 v[160:161], v15 offset:16384
    ds_read_b64_tr_b16 v[162:163], v15 offset:16896
    ds_read_b64_tr_b16 v[164:165], v15 offset:16416
    ds_read_b64_tr_b16 v[166:167], v15 offset:16928
    ds_read_b64_tr_b16 v[168:169], v15 offset:16448
    ds_read_b64_tr_b16 v[170:171], v15 offset:16960
    ds_read_b64_tr_b16 v[172:173], v15 offset:16480
    ds_read_b64_tr_b16 v[174:175], v15 offset:16992
    s_waitcnt lgkmcnt(0)
    v_mfma_f32_16x16x32_bf16 v[80:83], v[96:99], v[32:35], 0
    v_mfma_f32_16x16x32_bf16 v[84:87], v[100:103], v[32:35], 0
    v_mfma_f32_16x16x32_bf16 v[88:91], v[104:107], v[32:35], 0
    v_mfma_f32_16x16x32_bf16 v[92:95], v[108:111], v[32:35], 0
    v_mfma_f32_16x16x32_bf16 v[80:83], v[112:115], v[36:39], v[80:83]
    v_mfma_f32_16x16x32_bf16 v[84:87], v[116:119], v[36:39], v[84:87]
    v_mfma_f32_16x16x32_bf16 v[88:91], v[120:123], v[36:39], v[88:91]
    v_mfma_f32_16x16x32_bf16 v[92:95], v[124:127], v[36:39], v[92:95]
    v_mfma_f32_16x16x32_bf16 v[80:83], v[128:131], v[40:43], v[80:83]
    v_mfma_f32_16x16x32_bf16 v[84:87], v[132:135], v[40:43], v[84:87]
    v_mfma_f32_16x16x32_bf16 v[88:91], v[136:139], v[40:43], v[88:91]
    v_mfma_f32_16x16x32_bf16 v[92:95], v[140:143], v[40:43], v[92:95]
    v_mfma_f32_16x16x32_bf16 v[80:83], v[144:147], v[44:47], v[80:83]
    v_mfma_f32_16x16x32_bf16 v[84:87], v[148:151], v[44:47], v[84:87]
    v_mfma_f32_16x16x32_bf16 v[88:91], v[152:155], v[44:47], v[88:91]
    v_mfma_f32_16x16x32_bf16 v[92:95], v[156:159], v[44:47], v[92:95]
    v_mfma_f32_16x16x32_bf16 v[80:83], v[160:163], v[48:51], v[80:83]
    v_mfma_f32_16x16x32_bf16 v[84:87], v[164:167], v[48:51], v[84:87]
    v_mfma_f32_16x16x32_bf16 v[88:91], v[168:171], v[48:51], v[88:91]
    v_mfma_f32_16x16x32_bf16 v[92:95], v[172:175], v[48:51], v[92:95]
    s_cmp_ge_u32 s50, 20
    s_cbranch_scc1 L_adr_rest
    s_cmp_lt_u32 s50, 10
    s_cselect_b32 s34, 5120, 0
    s_cselect_b32 s35, s50, s52
    s_lshl_b32 s35, s35, 9
    s_add_u32 s34, s34, s35
    s_lshl_b32 s35, s51, 15
    s_add_u32 s34, s34, s35
    v_lshrrev_b32 v19, 1, v14
    v_lshl_add_u32 v19, v13, 1, v19
    v_lshlrev_b32 v19, 6, v19
    v_lshl_add_u32 v19, v12, 4, v19
    v_and_b32 v20, 1, v14
    v_lshl_add_u32 v19, v20, 3, v19
    s_branch L_adr_done
L_adr_rest:
    s_lshl_b32 s34, s51, 15
    s_lshl_b32 s35, s50, 9
    s_add_u32 s34, s34, s35
    s_add_u32 s34, s34, 0
    v_lshlrev_b32 v19, 7, v12
    v_lshl_add_u32 v19, v13, 5, v19
    v_lshl_add_u32 v19, v14, 3, v19
    s_nop 3
L_adr_done:
    v_add_u32 v19, s34, v19
    v_mov_b32_dpp v80, v84 quad_perm:[0,1,2,3] row_mask:0xf bank_mask:0x2
    v_mov_b32_dpp v81, v85 quad_perm:[0,1,2,3] row_mask:0xf bank_mask:0x2
    v_mov_b32_dpp v82, v86 quad_perm:[0,1,2,3] row_mask:0xf bank_mask:0x2
    v_mov_b32_dpp v83, v87 quad_perm:[0,1,2,3] row_mask:0xf bank_mask:0x2
    v_mov_b32_dpp v80, v88 quad_perm:[0,1,2,3] row_mask:0xf bank_mask:0x4
    v_mov_b32_dpp v81, v89 quad_perm:[0,1,2,3] row_mask:0xf bank_mask:0x4
    v_mov_b32_dpp v82, v90 quad_perm:[0,1,2,3] row_mask:0xf bank_mask:0x4
    v_mov_b32_dpp v83, v91 quad_perm:[0,1,2,3] row_mask:0xf bank_mask:0x4
    v_mov_b32_dpp v80, v92 quad_perm:[0,1,2,3] row_mask:0xf bank_mask:0x8
    v_mov_b32_dpp v81, v93 quad_perm:[0,1,2,3] row_mask:0xf bank_mask:0x8
    v_mov_b32_dpp v82, v94 quad_perm:[0,1,2,3] row_mask:0xf bank_mask:0x8
    v_mov_b32_dpp v83, v95 quad_perm:[0,1,2,3] row_mask:0xf bank_mask:0x8
    s_cmp_ge_u32 s52, 10
    s_cbranch_scc1 L_noz
    v_add_f32 v80, 0x3e800000, v80
    v_add_f32 v81, 0x3e800000, v81
    v_add_f32 v82, 0x3e800000, v82
    v_add_f32 v83, 0x3e800000, v83
    v_mul_f32 v80, v80, v24
    v_mul_f32 v81, v81, v25
    v_mul_f32 v82, v82, v26
    v_mul_f32 v83, v83, v27
L_noz:
    v_cvt_pk_bf16_f32 v20, v80, v81
    v_cvt_pk_bf16_f32 v21, v82, v83
    v_min_u32 v20, -2, v20
    v_min_u32 v21, -2, v21
    v_and_b32 v22, 15, v0
    v_lshlrev_b32 v22, 2, v22
    s_mov_b32 s35, 0
L_poll3:
    global_load_dword v23, v22, s[30:31] offset:128 sc1
    s_add_u32 s35, s35, 1
    s_waitcnt vmcnt(0)
    v_cmp_eq_u32 vcc, 0, v23
    s_cbranch_vccz L_done4
    s_sleep 8
    s_cmp_lt_u32 s35, 60000
    s_cbranch_scc1 L_poll3
L_done4:
    s_getreg_b32 s97, hwreg(HW_REG_XCC_ID, 0, 4)
    s_sub_u32 s97, s97, s2
    s_and_b32 s97, s97, 7
    s_add_u32 s97, s97, 1
    v_cmp_ne_u32 vcc, s97, v23
    s_nop 0
    s_mov_b32 s97, vcc_lo
    buffer_store_dwordx2 v[20:21], v19, s[44:47], 0 offen sc1
    s_branch L_p2
L_clear:
    s_sub_u32 s55, s2, 240
    s_lshr_b32 s34, s55, 2
    s_lshl_b32 s35, s34, 3
    s_lshr_b32 s54, 538910750, s35
    s_and_b32 s54, s54, 0xff
    s_lshl_b32 s54, s54, 10
    s_mul_i32 s34, s34, 393216
    s_lshl_b32 s35, s51, 15
    s_add_u32 s34, s34, s35
    v_lshl_add_u32 v19, v0, 4, s34
    v_mov_b32 v20, -1
    v_mov_b32 v21, -1
    v_mov_b32 v22, -1
    v_mov_b32 v23, -1
    s_mov_b32 s34, 0
L_clrloop:
    buffer_store_dwordx4 v[20:23], v19, s[44:47], s34 offen offset:0 sc1
    s_add_u32 s34, s34, 1024
    s_cmp_lt_u32 s34, s54
    s_cbranch_scc1 L_clrloop
L_clrend:
    s_cmp_ge_u32 s55, 4
    s_cbranch_scc1 L_clrend2
    s_mov_b32 s34, 1572864
    buffer_store_dwordx4 v[20:23], v19, s[44:47], s34 offen sc1
    s_mov_b32 s34, 1573888
    buffer_store_dwordx4 v[20:23], v19, s[44:47], s34 offen sc1
    s_mov_b32 s34, 1574912
    buffer_store_dwordx4 v[20:23], v19, s[44:47], s34 offen sc1
    s_mov_b32 s34, 1575936
    buffer_store_dwordx4 v[20:23], v19, s[44:47], s34 offen sc1
    s_mov_b32 s34, 1576960
    buffer_store_dwordx4 v[20:23], v19, s[44:47], s34 offen sc1
L_clrend2:
    v_lshlrev_b32 v1, 2, v0
    v_add_u32 v1, 98304, v1
    v_mov_b32 v2, -1
    v_mov_b32 v3, 0
    ds_write_b32 v1, v2
    ds_write_b32 v1, v2 offset:256
    ds_write_b32 v1, v3 offset:512
    ds_write_b32 v1, v3 offset:768
    s_waitcnt lgkmcnt(0)
    s_barrier
    s_lshl_b32 s34, s55, 2
    v_mov_b32 v24, s34
    s_getreg_b32 s97, hwreg(HW_REG_XCC_ID, 0, 4)
    s_sub_u32 s97, s97, s2
    s_and_b32 s97, s97, 7
    s_add_u32 s97, s97, 1
    v_mov_b32 v25, s97
    v_readfirstlane_b32 s90, v19
    s_mov_b32 s91, 0
    s_waitcnt vmcnt(0)
    s_mov_b64 exec, 1
    global_store_dword v24, v25, s[30:31] offset:128 sc1
    s_mov_b64 exec, -1
    s_and_b32 s34, s2, 31
    s_lshl_b32 s34, s34, 8
    s_lshr_b32 s35, s2, 7
    s_lshl_b32 s35, s35, 7
    s_add_u32 s49, s34, s35
    s_bfe_u32 s53, s2, 0x20005
    s_mul_i32 s34, s53, 1310720
    s_add_u32 s34, s34, s49
    v_lshl_add_u32 v16, v10, 13, v11
    v_add_u32 v16, s34, v16
    s_mov_b32 s36, s10
    s_mov_b32 s37, s11
    s_mov_b32 s38, 5242880
    s_mov_b32 m0, 20480
    s_mov_b32 s34, 0
L_dma6:
    buffer_load_dwordx4 v16, s[36:39], s34 offen  lds
    s_add_u32 m0, m0, 1024
    s_add_u32 s34, s34, 65536
    buffer_load_dwordx4 v16, s[36:39], s34 offen  lds
    s_add_u32 m0, m0, 1024
    s_add_u32 s34, s34, 65536
    buffer_load_dwordx4 v16, s[36:39], s34 offen  lds
    s_add_u32 m0, m0, 1024
    s_add_u32 s34, s34, 65536
    buffer_load_dwordx4 v16, s[36:39], s34 offen  lds
    s_add_u32 m0, m0, 1024
    s_add_u32 s34, s34, 65536
    s_cmp_lt_u32 s34, 1310720
    s_cbranch_scc1 L_dma6
    v_lshl_add_u32 v15, v14, 3, v13
    v_lshlrev_b32 v15, 7, v15
    v_lshl_add_u32 v15, v12, 3, v15
    s_add_u32 s34, s90, 0
    s_add_u32 s35, s90, 8192
    s_mov_b64 s[88:89], 0
    s_load_dword s88, s[44:45], s34
    s_load_dword s89, s[44:45], s35
    s_waitcnt lgkmcnt(1)
    s_cmp_lg_u32 s89, 0
    s_addc_u32 s91, s91, 0
    s_waitcnt lgkmcnt(0)
    s_add_u32 s34, s90, 1024
    s_add_u32 s35, s90, 9216
    s_mov_b64 s[88:89], 0
    s_load_dword s89, s[44:45], s35
    s_load_dword s88, s[44:45], s34
    s_waitcnt lgkmcnt(1)
    s_cmp_eq_u32 s88, 0
    s_addc_u32 s91, s91, 0
    s_waitcnt lgkmcnt(0)
    s_add_u32 s34, s90, 2048
    s_add_u32 s35, s90, 10240
    s_mov_b64 s[88:89], 0
    s_load_dword s88, s[44:45], s34
    s_load_dword s89, s[44:45], s35
    s_waitcnt lgkmcnt(1)
    s_cmp_lg_u32 s89, 0
    s_addc_u32 s91, s91, 0
    s_waitcnt lgkmcnt(0)
    s_add_u32 s34, s90, 3072
    s_add_u32 s35, s90, 11264
    s_mov_b64 s[88:89], 0
    s_load_dword s89, s[44:45], s35
    s_load_dword s88, s[44:45], s34
    s_waitcnt lgkmcnt(1)
    s_cmp_eq_u32 s88, 0
    s_addc_u32 s91, s91, 0
    s_waitcnt lgkmcnt(0)
    s_getreg_b32 s34, hwreg(HW_REG_XCC_ID, 2, 1)
    s_sub_u32 s35, 2, s91
    s_sub_u32 s91, s91, 2
    s_cmp_eq_u32 s34, 0
    s_cselect_b32 s91, s91, s35
    v_mov_b32 v25, s91
    s_mov_b64 exec, 1
    global_store_dword v24, v25, s[30:31] sc1
    s_mov_b64 exec, -1
    v_and_b32 v22, 15, v0
    v_lshlrev_b32 v22, 2, v22
    s_mov_b32 s35, 0
L_poll7:
    global_load_dword v23, v22, s[30:31] offset:128 sc1
    s_add_u32 s35, s35, 1
    s_waitcnt vmcnt(0)
    v_cmp_eq_u32 vcc, 0, v23
    s_cbranch_vccz L_done8
    s_sleep 8
    s_cmp_lt_u32 s35, 60000
    s_cbranch_scc1 L_poll7
L_done8:
    s_getreg_b32 s97, hwreg(HW_REG_XCC_ID, 0, 4)
    s_sub_u32 s97, s97, s2
    s_and_b32 s97, s97, 7
    s_add_u32 s97, s97, 1
    v_cmp_ne_u32 vcc, s97, v23
    s_nop 0
    s_mov_b32 s97, vcc_lo
L_p2:
    v_mov_b32 v199, v19
    ds_read_b64_tr_b16 v[96:97], v15 offset:20480
    ds_read_b64_tr_b16 v[98:99], v15 offset:20992
    ds_read_b64_tr_b16 v[100:101], v15 offset:20512
    ds_read_b64_tr_b16 v[102:103], v15 offset:21024
    ds_read_b64_tr_b16 v[104:105], v15 offset:20544
    ds_read_b64_tr_b16 v[106:107], v15 offset:21056
    ds_read_b64_tr_b16 v[108:109], v15 offset:20576
    ds_read_b64_tr_b16 v[110:111], v15 offset:21088
    s_waitcnt lgkmcnt(7)
    ds_read_b64_tr_b16 v[112:113], v15 offset:24576
    ds_read_b64_tr_b16 v[114:115], v15 offset:25088
    ds_read_b64_tr_b16 v[116:117], v15 offset:24608
    ds_read_b64_tr_b16 v[118:119], v15 offset:25120
    ds_read_b64_tr_b16 v[120:121], v15 offset:24640
    ds_read_b64_tr_b16 v[122:123], v15 offset:25152
    ds_read_b64_tr_b16 v[124:125], v15 offset:24672
    ds_read_b64_tr_b16 v[126:127], v15 offset:25184
    s_waitcnt lgkmcnt(7)
    ds_read_b64_tr_b16 v[128:129], v15 offset:28672
    ds_read_b64_tr_b16 v[130:131], v15 offset:29184
    ds_read_b64_tr_b16 v[132:133], v15 offset:28704
    ds_read_b64_tr_b16 v[134:135], v15 offset:29216
    ds_read_b64_tr_b16 v[136:137], v15 offset:28736
    ds_read_b64_tr_b16 v[138:139], v15 offset:29248
    ds_read_b64_tr_b16 v[140:141], v15 offset:28768
    ds_read_b64_tr_b16 v[142:143], v15 offset:29280
    s_waitcnt lgkmcnt(7)
    ds_read_b64_tr_b16 v[144:145], v15 offset:32768
    ds_read_b64_tr_b16 v[146:147], v15 offset:33280
    ds_read_b64_tr_b16 v[148:149], v15 offset:32800
    ds_read_b64_tr_b16 v[150:151], v15 offset:33312
    ds_read_b64_tr_b16 v[152:153], v15 offset:32832
    ds_read_b64_tr_b16 v[154:155], v15 offset:33344
    ds_read_b64_tr_b16 v[156:157], v15 offset:32864
    ds_read_b64_tr_b16 v[158:159], v15 offset:33376
    s_waitcnt lgkmcnt(7)
    ds_read_b64_tr_b16 v[160:161], v15 offset:36864
    ds_read_b64_tr_b16 v[162:163], v15 offset:37376
    ds_read_b64_tr_b16 v[164:165], v15 offset:36896
    ds_read_b64_tr_b16 v[166:167], v15 offset:37408
    ds_read_b64_tr_b16 v[168:169], v15 offset:36928
    ds_read_b64_tr_b16 v[170:171], v15 offset:37440
    ds_read_b64_tr_b16 v[172:173], v15 offset:36960
    ds_read_b64_tr_b16 v[174:175], v15 offset:37472
    s_waitcnt lgkmcnt(0)
    s_mul_i32 s34, s53, 1280
    v_lshlrev_b32 v19, 15, v13
    v_lshl_add_u32 v19, v14, 6, v19
    v_lshl_add_u32 v19, v12, 4, v19
    v_add_u32 v19, s34, v19
    s_movk_i32 s48, 5120
    s_mov_b32 s56, 32768
    s_mov_b32 s57, 65536
    s_mov_b32 s58, 98304
    s_sub_u32 s34, s2, 80
    s_cmp_lt_u32 s34, 160
    s_cselect_b32 s54, 1, 0
    s_and_b32 s34, s2, 3
    s_cselect_b32 s54, 0, s54
    v_mov_b32 v180, 0
    v_mov_b32 v181, 0
    v_mov_b32 v182, 0
    v_mov_b32 v183, 0
    v_mov_b32 v184, 0
    v_mov_b32 v185, 0
    v_mov_b32 v186, 0
    v_mov_b32 v187, 0
    v_mov_b32 v22, 99072
    s_mov_b32 s35, 0
L_poll10:
    ds_read_b32 v23, v22
    s_add_u32 s35, s35, 1
    s_waitcnt lgkmcnt(0)
    v_cmp_gt_u32 vcc, 21, v23
    s_cbranch_vccz L_done11
    s_sleep 2
    s_cmp_lt_u32 s35, 60000
    s_cbranch_scc1 L_poll10
L_done11:
    s_mov_b32 s35, 0
L_poll13:
    buffer_load_dwordx4 v[32:35], v19, s[44:47], 0 offen offset:0 sc1
    buffer_load_dwordx4 v[36:39], v19, s[44:47], s48 offen offset:0 sc1
    buffer_load_dwordx4 v[40:43], v19, s[44:47], 0 offen offset:256 sc1
    buffer_load_dwordx4 v[44:47], v19, s[44:47], s48 offen offset:256 sc1
    buffer_load_dwordx4 v[48:51], v19, s[44:47], 0 offen offset:512 sc1
    buffer_load_dwordx4 v[52:55], v19, s[44:47], s48 offen offset:512 sc1
    buffer_load_dwordx4 v[56:59], v19, s[44:47], 0 offen offset:768 sc1
    buffer_load_dwordx4 v[60:63], v19, s[44:47], s48 offen offset:768 sc1
    buffer_load_dwordx4 v[64:67], v19, s[44:47], 0 offen offset:1024 sc1
    buffer_load_dwordx4 v[68:71], v19, s[44:47], s48 offen offset:1024 sc1
    s_cmp_eq_u32 s54, 0
    s_cbranch_scc1 L_hskip
    buffer_load_dwordx2 v[180:181], v199, s[44:47], 0 offen sc1
    buffer_load_dwordx2 v[182:183], v199, s[44:47], s56 offen sc1
    buffer_load_dwordx2 v[184:185], v199, s[44:47], s57 offen sc1
    buffer_load_dwordx2 v[186:187], v199, s[44:47], s58 offen sc1
L_hskip:
    s_add_u32 s35, s35, 1
    s_waitcnt vmcnt(0)
    v_max3_u32 v20, v32, v33, v34
    v_max3_u32 v20, v20, v35, v36
    v_max3_u32 v20, v20, v37, v38
    v_max3_u32 v20, v20, v39, v40
    v_max3_u32 v20, v20, v41, v42
    v_max3_u32 v20, v20, v43, v44
    v_max3_u32 v20, v20, v45, v46
    v_max3_u32 v20, v20, v47, v48
    v_max3_u32 v20, v20, v49, v50
    v_max3_u32 v20, v20, v51, v52
    v_max3_u32 v20, v20, v53, v54
    v_max3_u32 v20, v20, v55, v56
    v_max3_u32 v20, v20, v57, v58
    v_max3_u32 v20, v20, v59, v60
    v_max3_u32 v20, v20, v61, v62
    v_max3_u32 v20, v20, v63, v64
    v_max3_u32 v20, v20, v65, v66
    v_max3_u32 v20, v20, v67, v68
    v_max3_u32 v20, v20, v69, v70
    v_max3_u32 v20, v20, v71, v180
    v_max3_u32 v20, v20, v181, v182
    v_max3_u32 v20, v20, v183, v184
    v_max3_u32 v20, v20, v185, v186
    v_max_u32 v20, v20, v187
    v_cmp_eq_u32 vcc, -1, v20
    s_cbranch_vccz L_done14
    s_sleep 16
    s_cmp_lt_u32 s35, 60000
    s_cbranch_scc1 L_poll13
L_done14:
    v_mfma_f32_16x16x32_bf16 v[80:83], v[96:99], v[32:35], 0
    v_mfma_f32_16x16x32_bf16 v[84:87], v[100:103], v[32:35], 0
    v_mfma_f32_16x16x32_bf16 v[88:91], v[104:107], v[32:35], 0
    v_mfma_f32_16x16x32_bf16 v[92:95], v[108:111], v[32:35], 0
    v_mfma_f32_16x16x32_bf16 v[80:83], v[96:99], v[36:39], v[80:83]
    v_mfma_f32_16x16x32_bf16 v[84:87], v[100:103], v[36:39], v[84:87]
    v_mfma_f32_16x16x32_bf16 v[88:91], v[104:107], v[36:39], v[88:91]
    v_mfma_f32_16x16x32_bf16 v[92:95], v[108:111], v[36:39], v[92:95]
    v_mfma_f32_16x16x32_bf16 v[80:83], v[112:115], v[40:43], v[80:83]
    v_mfma_f32_16x16x32_bf16 v[84:87], v[116:119], v[40:43], v[84:87]
    v_mfma_f32_16x16x32_bf16 v[88:91], v[120:123], v[40:43], v[88:91]
    v_mfma_f32_16x16x32_bf16 v[92:95], v[124:127], v[40:43], v[92:95]
    v_mfma_f32_16x16x32_bf16 v[80:83], v[112:115], v[44:47], v[80:83]
    v_mfma_f32_16x16x32_bf16 v[84:87], v[116:119], v[44:47], v[84:87]
    v_mfma_f32_16x16x32_bf16 v[88:91], v[120:123], v[44:47], v[88:91]
    v_mfma_f32_16x16x32_bf16 v[92:95], v[124:127], v[44:47], v[92:95]
    v_mfma_f32_16x16x32_bf16 v[80:83], v[128:131], v[48:51], v[80:83]
    v_mfma_f32_16x16x32_bf16 v[84:87], v[132:135], v[48:51], v[84:87]
    v_mfma_f32_16x16x32_bf16 v[88:91], v[136:139], v[48:51], v[88:91]
    v_mfma_f32_16x16x32_bf16 v[92:95], v[140:143], v[48:51], v[92:95]
    v_mfma_f32_16x16x32_bf16 v[80:83], v[128:131], v[52:55], v[80:83]
    v_mfma_f32_16x16x32_bf16 v[84:87], v[132:135], v[52:55], v[84:87]
    v_mfma_f32_16x16x32_bf16 v[88:91], v[136:139], v[52:55], v[88:91]
    v_mfma_f32_16x16x32_bf16 v[92:95], v[140:143], v[52:55], v[92:95]
    v_mfma_f32_16x16x32_bf16 v[80:83], v[144:147], v[56:59], v[80:83]
    v_mfma_f32_16x16x32_bf16 v[84:87], v[148:151], v[56:59], v[84:87]
    v_mfma_f32_16x16x32_bf16 v[88:91], v[152:155], v[56:59], v[88:91]
    v_mfma_f32_16x16x32_bf16 v[92:95], v[156:159], v[56:59], v[92:95]
    v_mfma_f32_16x16x32_bf16 v[80:83], v[144:147], v[60:63], v[80:83]
    v_mfma_f32_16x16x32_bf16 v[84:87], v[148:151], v[60:63], v[84:87]
    v_mfma_f32_16x16x32_bf16 v[88:91], v[152:155], v[60:63], v[88:91]
    v_mfma_f32_16x16x32_bf16 v[92:95], v[156:159], v[60:63], v[92:95]
    v_mfma_f32_16x16x32_bf16 v[80:83], v[160:163], v[64:67], v[80:83]
    v_mfma_f32_16x16x32_bf16 v[84:87], v[164:167], v[64:67], v[84:87]
    v_mfma_f32_16x16x32_bf16 v[88:91], v[168:171], v[64:67], v[88:91]
    v_mfma_f32_16x16x32_bf16 v[92:95], v[172:175], v[64:67], v[92:95]
    v_mfma_f32_16x16x32_bf16 v[80:83], v[160:163], v[68:71], v[80:83]
    v_mfma_f32_16x16x32_bf16 v[84:87], v[164:167], v[68:71], v[84:87]
    v_mfma_f32_16x16x32_bf16 v[88:91], v[168:171], v[68:71], v[88:91]
    v_mfma_f32_16x16x32_bf16 v[92:95], v[172:175], v[68:71], v[92:95]
    s_lshl_b32 s34, s53, 15
    s_lshl_b32 s35, s49, 2
    s_add_u32 s34, s34, s35
    s_add_u32 s34, s34, 393216
    v_lshlrev_b32 v19, 7, v12
    v_lshl_add_u32 v19, v13, 5, v19
    v_lshl_add_u32 v19, v14, 3, v19
    v_add_u32 v19, s34, v19
    v_add_f32_dpp v20, v80, v80 row_ror:8 row_mask:0xf bank_mask:0x3
    v_add_f32_dpp v24, v84, v84 row_ror:8 row_mask:0xf bank_mask:0x3
    v_add_f32_dpp v21, v81, v81 row_ror:8 row_mask:0xf bank_mask:0x3
    v_add_f32_dpp v25, v85, v85 row_ror:8 row_mask:0xf bank_mask:0x3
    v_add_f32_dpp v22, v82, v82 row_ror:8 row_mask:0xf bank_mask:0x3
    v_add_f32_dpp v26, v86, v86 row_ror:8 row_mask:0xf bank_mask:0x3
    v_add_f32_dpp v23, v83, v83 row_ror:8 row_mask:0xf bank_mask:0x3
    v_add_f32_dpp v27, v87, v87 row_ror:8 row_mask:0xf bank_mask:0x3
    v_add_f32_dpp v20, v88, v88 row_ror:8 row_mask:0xf bank_mask:0xc
    v_add_f32_dpp v24, v92, v92 row_ror:8 row_mask:0xf bank_mask:0xc
    v_add_f32_dpp v21, v89, v89 row_ror:8 row_mask:0xf bank_mask:0xc
    v_add_f32_dpp v25, v93, v93 row_ror:8 row_mask:0xf bank_mask:0xc
    v_add_f32_dpp v22, v90, v90 row_ror:8 row_mask:0xf bank_mask:0xc
    v_add_f32_dpp v26, v94, v94 row_ror:8 row_mask:0xf bank_mask:0xc
    v_add_f32_dpp v23, v91, v91 row_ror:8 row_mask:0xf bank_mask:0xc
    v_add_f32_dpp v27, v95, v95 row_ror:8 row_mask:0xf bank_mask:0xc
    v_add_f32_dpp v28, v20, v20 row_shl:4 row_mask:0xf bank_mask:0x5
    v_add_f32_dpp v29, v21, v21 row_shl:4 row_mask:0xf bank_mask:0x5
    v_add_f32_dpp v30, v22, v22 row_shl:4 row_mask:0xf bank_mask:0x5
    v_add_f32_dpp v31, v23, v23 row_shl:4 row_mask:0xf bank_mask:0x5
    v_add_f32_dpp v28, v24, v24 row_shr:4 row_mask:0xf bank_mask:0xa
    v_add_f32_dpp v29, v25, v25 row_shr:4 row_mask:0xf bank_mask:0xa
    v_add_f32_dpp v30, v26, v26 row_shr:4 row_mask:0xf bank_mask:0xa
    v_add_f32_dpp v31, v27, v27 row_shr:4 row_mask:0xf bank_mask:0xa
    v_cvt_pk_bf16_f32 v20, v28, v29
    v_cvt_pk_bf16_f32 v21, v30, v31
    v_min_u32 v20, -2, v20
    v_min_u32 v21, -2, v21
    buffer_store_dwordx2 v[20:21], v19, s[44:47], 0 offen sc1
    s_cmp_eq_u32 s54, 0
    s_cbranch_scc1 L_nomf
    v_lshlrev_b32 v24, 16, v180
    v_and_b32 v25, 0xffff0000, v180
    v_lshlrev_b32 v26, 16, v181
    v_and_b32 v27, 0xffff0000, v181
    v_lshlrev_b32 v28, 16, v182
    v_and_b32 v29, 0xffff0000, v182
    v_lshlrev_b32 v30, 16, v183
    v_and_b32 v31, 0xffff0000, v183
    v_add_f32 v24, v24, v28
    v_add_f32 v25, v25, v29
    v_add_f32 v26, v26, v30
    v_add_f32 v27, v27, v31
    v_lshlrev_b32 v28, 16, v184
    v_and_b32 v29, 0xffff0000, v184
    v_lshlrev_b32 v30, 16, v185
    v_and_b32 v31, 0xffff0000, v185
    v_add_f32 v24, v24, v28
    v_add_f32 v25, v25, v29
    v_add_f32 v26, v26, v30
    v_add_f32 v27, v27, v31
    v_lshlrev_b32 v28, 16, v186
    v_and_b32 v29, 0xffff0000, v186
    v_lshlrev_b32 v30, 16, v187
    v_and_b32 v31, 0xffff0000, v187
    v_add_f32 v24, v24, v28
    v_add_f32 v25, v25, v29
    v_add_f32 v26, v26, v30
    v_add_f32 v27, v27, v31
    v_cvt_pk_bf16_f32 v22, v24, v25
    v_cvt_pk_bf16_f32 v23, v26, v27
    v_min_u32 v22, -2, v22
    v_min_u32 v23, -2, v23
    s_sub_u32 s34, s50, 20
    s_lshl_b32 s35, s34, 9
    v_subrev_u32 v199, s35, v199
    s_lshr_b32 s35, s34, 2
    s_lshl_b32 s35, s35, 9
    s_and_b32 s34, s34, 3
    s_lshl_b32 s34, s34, 15
    s_add_u32 s34, s34, s35
    s_add_u32 s34, s34, 1562624
    v_add_u32 v199, s34, v199
    buffer_store_dwordx2 v[22:23], v199, s[44:47], 0 offen sc1
L_nomf:
    s_and_b32 s34, s2, 127
    s_lshl_b32 s34, s34, 21
    s_lshr_b32 s35, s2, 7
    s_lshl_b32 s35, s35, 18
    s_add_u32 s34, s34, s35
    s_add_u32 s34, s34, 1572864
    s_mov_b32 s38, 0x40000
    s_mov_b32 s42, 0x40000
    s_waitcnt lgkmcnt(0)
    s_add_u32 s36, s6, s34
    s_addc_u32 s37, s7, 0
    s_add_u32 s40, s8, s34
    s_addc_u32 s41, s9, 0
    v_lshlrev_b32 v18, 4, v0
    s_mov_b32 s34, 258048
    buffer_load_dwordx4 v[128:131], v18, s[36:39], s34 offen offset:0 nt
    buffer_load_dwordx4 v[132:135], v18, s[36:39], s34 offen offset:1024 nt
    buffer_load_dwordx4 v[136:139], v18, s[36:39], s34 offen offset:2048 nt
    buffer_load_dwordx4 v[140:143], v18, s[36:39], s34 offen offset:3072 nt
    s_and_b32 s34, s2, 31
    s_lshl_b32 s34, s34, 10
    s_lshl_b32 s35, s53, 7
    s_add_u32 s34, s34, s35
    s_add_u32 s34, s34, 393216
    v_lshrrev_b32 v19, 5, v0
    v_mul_u32_u24 v19, 384, v19
    v_lshl_add_u32 v19, v0, 2, v19
    v_add_u32 v19, s34, v19
    v_mov_b32 v22, 99072
    s_and_b32 s34, s60, 3
    s_lshl_b32 s34, s34, 15
    s_lshr_b32 s35, s60, 2
    s_lshl_b32 s35, s35, 7
    s_add_u32 s34, s34, s35
    s_add_u32 s34, s34, 793344
    v_and_b32 v252, 31, v0
    v_lshl_add_u32 v252, v252, 2, s34
    v_mov_b32 v253, 0
    s_mov_b32 s35, 0
L_poll16:
    ds_read_b32 v23, v22
    s_add_u32 s35, s35, 1
    s_waitcnt lgkmcnt(0)
    v_cmp_gt_u32 vcc, 33, v23
    s_cbranch_vccz L_done17
    s_sleep 2
    s_cmp_lt_u32 s35, 60000
    s_cbranch_scc1 L_poll16
L_done17:
    buffer_load_dword v251, v252, s[44:47], 0 offen sc1
    s_lshl_b64 exec, 1, s61
    buffer_store_dword v253, v252, s[44:47], 0 offen
    s_mov_b64 exec, -1
    v_and_b32 v44, 15, v0
    v_lshlrev_b32 v44, 2, v44
    global_load_dword v44, v44, s[30:31] sc1
    s_mov_b32 s35, 0
L_poll19:
    buffer_load_dword v32, v19, s[44:47], 0 offen sc1
    buffer_load_dword v33, v19, s[44:47], s56 offen sc1
    buffer_load_dword v34, v19, s[44:47], s57 offen sc1
    buffer_load_dword v35, v19, s[44:47], s58 offen sc1
    s_add_u32 s35, s35, 1
    s_waitcnt vmcnt(0)
    v_max3_u32 v22, v32, v33, v34
    v_max_u32 v22, v22, v35
    v_cmp_eq_u32 vcc, -1, v22
    s_cbranch_vccz L_done20
    s_sleep 16
    s_cmp_lt_u32 s35, 60000
    s_cbranch_scc1 L_poll19
L_done20:
    v_cmp_ne_u32 vcc, -1, v251
    v_mov_b32 v252, 99076
    s_bcnt1_i32_b32 s34, vcc_lo
    v_mov_b32 v251, s34
    s_mov_b64 exec, 1
    ds_write_b32 v252, v251
    s_mov_b64 exec, -1
    v_add_u32_dpp v44, v44, v44 row_ror:8 row_mask:0xf bank_mask:0xf
    s_nop 1
    v_add_u32_dpp v44, v44, v44 row_ror:4 row_mask:0xf bank_mask:0xf
    s_nop 1
    v_add_u32_dpp v44, v44, v44 row_ror:2 row_mask:0xf bank_mask:0xf
    s_nop 1
    v_add_u32_dpp v44, v44, v44 row_ror:1 row_mask:0xf bank_mask:0xf
    s_nop 0
    v_readfirstlane_b32 s99, v44
    s_nop 0
    s_cmp_gt_i32 s99, 0
    s_cselect_b32 s99, 1, 0
    s_getreg_b32 s34, hwreg(HW_REG_XCC_ID, 2, 1)
    s_xor_b32 s99, s99, s34
    s_lshl_b32 s99, s99, 13
    v_mov_b32 v45, 99080
    v_mov_b32 v44, s99
    ds_write_b32 v45, v44
    v_lshlrev_b32 v36, 16, v32
    v_and_b32 v37, 0xffff0000, v32
    v_lshlrev_b32 v38, 16, v33
    v_and_b32 v39, 0xffff0000, v33
    v_lshlrev_b32 v40, 16, v34
    v_and_b32 v41, 0xffff0000, v34
    v_lshlrev_b32 v42, 16, v35
    v_and_b32 v43, 0xffff0000, v35
    v_pk_add_f32 v[36:37], v[36:37], v[38:39]
    v_pk_add_f32 v[40:41], v[40:41], v[42:43]
    v_pk_add_f32 v[36:37], v[36:37], v[40:41]
    v_cvt_pk_bf16_f32 v32, v36, v37
    v_min_u32 v32, -2, v32
    ds_write_b32 v1, v32
    s_mov_b32 s34, 258048
    buffer_load_dwordx4 v[144:147], v18, s[40:43], s34 offen offset:0 nt
    buffer_load_dwordx4 v[148:151], v18, s[40:43], s34 offen offset:1024 nt
    buffer_load_dwordx4 v[152:155], v18, s[40:43], s34 offen offset:2048 nt
    buffer_load_dwordx4 v[156:159], v18, s[40:43], s34 offen offset:3072 nt
    v_and_b32 v2, 15, v0
    v_lshlrev_b32 v2, 4, v2
    v_add_u32 v2, 98304, v2
    ds_read_b128 v[4:7], v2
    s_waitcnt lgkmcnt(0)
    v_dot2_f32_bf16 v8, v128, v4, 0
    v_dot2_f32_bf16 v9, v132, v4, 0
    v_dot2_f32_bf16 v10, v136, v4, 0
    v_dot2_f32_bf16 v11, v140, v4, 0
    v_dot2c_f32_bf16 v8, v129, v5
    v_dot2c_f32_bf16 v9, v133, v5
    v_dot2c_f32_bf16 v10, v137, v5
    v_dot2c_f32_bf16 v11, v141, v5
    v_dot2c_f32_bf16 v8, v130, v6
    v_dot2c_f32_bf16 v9, v134, v6
    v_dot2c_f32_bf16 v10, v138, v6
    v_dot2c_f32_bf16 v11, v142, v6
    v_dot2c_f32_bf16 v8, v131, v7
    v_dot2c_f32_bf16 v9, v135, v7
    v_dot2c_f32_bf16 v10, v139, v7
    v_dot2c_f32_bf16 v11, v143, v7
    v_add_f32_dpp v16, v8, v8 row_ror:8 row_mask:0xf bank_mask:0x3
    v_add_f32_dpp v16, v9, v9 row_ror:8 row_mask:0xf bank_mask:0xc
    v_add_f32_dpp v17, v10, v10 row_ror:8 row_mask:0xf bank_mask:0x3
    v_add_f32_dpp v17, v11, v11 row_ror:8 row_mask:0xf bank_mask:0xc
    v_add_f32_dpp v16, v16, v16 row_half_mirror row_mask:0xf bank_mask:0xf
    s_nop 0
    v_add_f32_dpp v17, v17, v17 row_half_mirror row_mask:0xf bank_mask:0xf
    v_add_f32_dpp v16, v16, v16 quad_perm:[1,0,3,2] row_mask:0xf bank_mask:0xf
    s_nop 0
    v_add_f32_dpp v17, v17, v17 quad_perm:[1,0,3,2] row_mask:0xf bank_mask:0xf
    v_add_f32_dpp v16, v16, v16 quad_perm:[2,3,0,1] row_mask:0xf bank_mask:0xf
    s_nop 0
    v_add_f32_dpp v17, v17, v17 quad_perm:[2,3,0,1] row_mask:0xf bank_mask:0xf
    v_max_f32 v8, v16, v17
    s_mov_b32 s34, 0x3e0293ee
    s_nop 0
    v_max_f32_dpp v8, v8, v8 row_ror:8 row_mask:0xf bank_mask:0xf
    v_mov_b32 v9, v8
    s_nop 1
    v_permlane16_swap_b32 v8, v9
    v_max_f32 v8, v8, v9
    v_mov_b32 v9, v8
    s_nop 1
    v_permlane32_swap_b32 v8, v9
    v_max_f32 v8, v8, v9
    v_mul_f32 v8, s34, v8
    v_fma_f32 v16, v16, s34, -v8
    v_fma_f32 v17, v17, s34, -v8
    v_exp_f32 v16, v16
    v_exp_f32 v17, v17
    s_nop 0
    v_add_f32 v9, v16, v17
    v_and_b32 v10, 1, v0
    v_lshlrev_b32 v10, 4, v10
    v_mov_b32 v11, 0xffff
    v_lshlrev_b32 v10, v10, v11
    v_bfe_u32 v11, v0, 1, 2
    v_cmp_eq_u32 vcc, 0, v11
    s_nop 1
    v_cndmask_b32 v20, 0, v10, vcc
    v_cmp_eq_u32 vcc, 1, v11
    s_nop 1
    v_cndmask_b32 v21, 0, v10, vcc
    v_cmp_eq_u32 vcc, 2, v11
    s_nop 1
    v_cndmask_b32 v22, 0, v10, vcc
    v_cmp_eq_u32 vcc, 3, v11
    s_nop 1
    v_cndmask_b32 v23, 0, v10, vcc
    v_add_f32_dpp v9, v9, v9 row_ror:8 row_mask:0xf bank_mask:0xf
    v_mov_b32 v10, v9
    s_nop 1
    v_permlane16_swap_b32 v9, v10
    v_add_f32 v9, v9, v10
    v_mov_b32 v10, v9
    s_nop 1
    v_permlane32_swap_b32 v9, v10
    v_add_f32 v9, v9, v10
    v_mov_b32 v10, 98616
    s_mov_b64 exec, 1
    ds_write_b64 v10, v[8:9]
    s_mov_b64 exec, -1
    s_waitcnt vmcnt(0)
    v_cvt_pk_bf16_f32 v10, v16, v16
    v_and_b32 v24, v10, v20
    v_and_b32 v25, v10, v21
    v_and_b32 v26, v10, v22
    v_and_b32 v27, v10, v23
    s_nop 1
    v_mfma_f32_16x16x32_bf16 v[116:119], v[144:147], v[24:27], 0
    v_mfma_f32_16x16x32_bf16 v[120:123], v[148:151], v[24:27], 0
    v_cvt_pk_bf16_f32 v10, v17, v17
    v_and_b32 v28, v10, v20
    v_and_b32 v29, v10, v21
    v_and_b32 v30, v10, v22
    v_and_b32 v31, v10, v23
    s_nop 1
    v_mfma_f32_16x16x32_bf16 v[116:119], v[152:155], v[28:31], v[116:119]
    v_mfma_f32_16x16x32_bf16 v[120:123], v[156:159], v[28:31], v[120:123]
    s_mov_b32 s34, 106496
    v_lshrrev_b32 v16, 4, v0
    v_and_b32 v17, 7, v0
    v_lshl_add_u32 v16, v16, 3, v17
    v_bfe_u32 v17, v0, 3, 1
    v_lshl_add_u32 v16, v17, 5, v16
    v_lshl_add_u32 v16, v16, 4, s34
    s_nop 0
    v_add_f32_dpp v116, v120, v116 row_ror:8 row_mask:0xf bank_mask:0xf
    v_add_f32_dpp v117, v121, v117 row_ror:8 row_mask:0xf bank_mask:0xf
    v_add_f32_dpp v118, v122, v118 row_ror:8 row_mask:0xf bank_mask:0xf
    v_add_f32_dpp v119, v123, v119 row_ror:8 row_mask:0xf bank_mask:0xf
    ds_write_b128 v16, v[116:119]
    v_lshl_add_u32 v16, v0, 3, s34
    ds_read_b64 v[116:117], v16
    s_waitcnt lgkmcnt(0)
    s_mov_b32 s63, 0
    s_mov_b32 s62, s61
    s_cmp_lt_u32 s61, 20
    s_cbranch_scc1 L_rd22
    s_mul_i32 s62, s60, 12
    s_add_u32 s62, s62, s61
    s_sub_u32 s62, s62, 20
    s_mov_b32 s63, 1
    s_cmp_lt_u32 s62, 54
    s_cbranch_scc1 L_rd22
    s_cmp_lt_u32 s62, 56
    s_cselect_b32 s63, 3, 2
    s_sub_u32 s62, s62, 56
L_rd22:
    v_and_b32 v8, 3, v0
    v_bfe_u32 v9, v0, 2, 2
    v_lshrrev_b32 v10, 4, v0
    s_mov_b32 s55, 0x20000
    s_lshl_b32 s35, s62, 6
    s_and_b32 s49, s62, 1
    s_cmp_eq_u32 s63, 0
    s_cbranch_scc1 L_dp24
    s_cmp_eq_u32 s63, 1
    s_cbranch_scc1 L_dp25
    s_mov_b32 s52, s20
    s_mov_b32 s53, s21
    s_mov_b32 s54, 2211840
    v_mov_b32 v15, 0
    s_branch L_dp26
L_dp25:
    s_mov_b32 s52, s16
    s_mov_b32 s53, s17
    s_mov_b32 s54, 2211840
    v_lshl_add_u32 v15, v9, 3, v10
    v_mul_u32_u24 v15, 3456, v15
    v_lshl_add_u32 v15, v8, 4, v15
    v_add_u32 v15, s35, v15
    s_bfe_u32 s50, s3, 0x10001
    s_lshl_b32 s50, s50, 7
    s_and_b32 s34, s3, 1
    s_lshl_b32 s34, s34, 2
    s_add_u32 s50, s50, s34
    s_and_b32 s51, s3, 3
    s_lshl_b32 s51, s51, 5
    s_add_u32 s51, s51, 512
    s_mul_i32 s50, s50, 3456
    s_mul_i32 s51, s51, 3456
    s_branch L_dp26
L_dp24:
    s_mov_b32 s52, s12
    s_mov_b32 s53, s13
    s_mov_b32 s54, 5242880
    s_lshr_b32 s50, s3, 1
    s_lshl_b32 s50, s50, 3
    s_add_u32 s50, s50, s60
    s_and_b32 s51, s3, 1
    s_lshl_b32 s34, s50, 1
    s_add_u32 s34, s34, s51
    s_mul_i32 s34, s34, 81920
    s_add_u32 s34, s34, s35
    v_lshl_add_u32 v15, v9, 2, v10
    v_mul_u32_u24 v15, 2560, v15
    v_lshl_add_u32 v15, v8, 4, v15
    v_add_u32 v15, s34, v15
    s_lshl_b32 s56, s3, 12
    s_lshl_b32 s34, s49, 11
    s_add_u32 s56, s56, s34
    s_add_u32 s56, s56, 40960
    s_add_u32 s58, s56, 1024
    s_mul_i32 s57, s49, 40960
    s_add_u32 s59, s57, 1280
L_dp26:
    v_and_b32 v200, 3, v0
    v_bfe_u32 v201, v0, 2, 2
    v_lshrrev_b32 v202, 4, v0
    s_lshl_b32 s34, s3, 10
    s_add_u32 s34, s34, 122112
    v_mul_u32_u24 v203, 320, v201
    v_min_u32 v203, 704, v203
    v_lshl_add_u32 v203, v202, 6, v203
    v_lshl_add_u32 v203, v200, 4, v203
    v_add_u32 v203, s34, v203
    s_movk_i32 s48, 16384
    v_mov_b32 v197, 0
    s_mov_b32 s40, 0
    s_mov_b32 s41, 0
    s_mov_b32 s42, 0
    s_cmp_eq_u32 s63, 0
    s_cbranch_scc1 L_d_wo
    s_cmp_eq_u32 s63, 2
    s_cbranch_scc1 L_d_w2
    s_cmp_eq_u32 s63, 3
    s_cbranch_scc1 L_d_none
    v_and_b32 v205, 15, v0
    v_lshlrev_b32 v205, 4, v205
    s_and_b32 s49, s3, 3
    s_mul_i32 s34, s49, 1280
    s_add_u32 s34, s34, s99
    s_add_u32 s34, s34, 786432
    v_lshl_add_u32 v206, v202, 15, v205
    v_add_u32 v206, s34, v206
    s_mul_i32 s34, s49, 3840
    v_add_u32 v205, s34, v205
    s_lshl_b32 s34, s62, 6
    v_lshlrev_b32 v5, 4, v14
    v_lshl_add_u32 v5, v12, 2, v5
    v_add_u32 v5, s34, v5
    global_load_dword v6, v5, s[18:19]
    v_and_b32 v7, 15, v0
    v_lshlrev_b32 v7, 4, v7
    v_mul_u32_u24 v8, 1280, v14
    v_add_u32 v8, v8, v7
    v_bfe_u32 v9, v0, 3, 1
    v_lshlrev_b32 v9, 15, v9
    v_lshl_add_u32 v9, v14, 7, v9
    v_and_b32 v10, 7, v0
    v_lshl_add_u32 v9, v10, 4, v9
    v_add_u32 v9, 1572864, v9
    s_mov_b32 s57, 65536
    v_mul_u32_u24 v5, 3840, v14
    v_add_u32 v5, v5, v7
    global_load_dwordx4 v[32:35], v8, s[4:5] offset:0
    global_load_dwordx4 v[36:39], v8, s[4:5] offset:256
    global_load_dwordx4 v[40:43], v8, s[4:5] offset:512
    global_load_dwordx4 v[44:47], v8, s[4:5] offset:768
    global_load_dwordx4 v[48:51], v8, s[4:5] offset:1024
    s_mov_b32 s35, 0
L_poll27:
    buffer_load_dwordx4 v[52:55], v9, s[44:47], s57 offen offset:1024 sc1
    buffer_load_dwordx4 v[56:59], v9, s[44:47], 0 offen offset:1536 sc1
    buffer_load_dwordx4 v[60:63], v9, s[44:47], s57 offen offset:1536 sc1
    buffer_load_dwordx4 v[64:67], v9, s[44:47], 0 offen offset:2048 sc1
    buffer_load_dwordx4 v[68:71], v9, s[44:47], s57 offen offset:2048 sc1
    buffer_load_dwordx4 v[72:75], v9, s[44:47], 0 offen offset:2560 sc1
    buffer_load_dwordx4 v[76:79], v9, s[44:47], s57 offen offset:2560 sc1
    buffer_load_dwordx4 v[80:83], v9, s[44:47], 0 offen offset:3072 sc1
    buffer_load_dwordx4 v[84:87], v9, s[44:47], s57 offen offset:3072 sc1
    buffer_load_dwordx4 v[88:91], v9, s[44:47], 0 offen offset:3584 sc1
    s_add_u32 s35, s35, 1
    s_waitcnt vmcnt(0)
    v_max3_u32 v28, v52, v53, v54
    v_max3_u32 v28, v28, v55, v56
    v_max3_u32 v28, v28, v57, v58
    v_max3_u32 v28, v28, v59, v60
    v_max3_u32 v28, v28, v61, v62
    v_max3_u32 v28, v28, v63, v64
    v_max3_u32 v28, v28, v65, v66
    v_max3_u32 v28, v28, v67, v68
    v_max3_u32 v28, v28, v69, v70
    v_max3_u32 v28, v28, v71, v72
    v_max3_u32 v28, v28, v73, v74
    v_max3_u32 v28, v28, v75, v76
    v_max3_u32 v28, v28, v77, v78
    v_max3_u32 v28, v28, v79, v80
    v_max3_u32 v28, v28, v81, v82
    v_max3_u32 v28, v28, v83, v84
    v_max3_u32 v28, v28, v85, v86
    v_max3_u32 v28, v28, v87, v88
    v_max3_u32 v28, v28, v89, v90
    v_max_u32 v28, v28, v91
    v_cmp_eq_u32 vcc, -1, v28
    s_cbranch_vccz L_done28
    s_sleep 16
    s_cmp_lt_u32 s35, 60000
    s_cbranch_scc1 L_poll27
L_done28:
    ds_write_b128 v5, v[32:35] offset:0
    ds_write_b128 v5, v[36:39] offset:256
    ds_write_b128 v5, v[40:43] offset:512
    ds_write_b128 v5, v[44:47] offset:768
    ds_write_b128 v5, v[48:51] offset:1024
    ds_write_b128 v5, v[52:55] offset:1280
    ds_write_b128 v5, v[56:59] offset:1536
    ds_write_b128 v5, v[60:63] offset:1792
    ds_write_b128 v5, v[64:67] offset:2048
    ds_write_b128 v5, v[68:71] offset:2304
    ds_write_b128 v5, v[72:75] offset:2560
    ds_write_b128 v5, v[76:79] offset:2816
    ds_write_b128 v5, v[80:83] offset:3072
    ds_write_b128 v5, v[84:87] offset:3328
    ds_write_b128 v5, v[88:91] offset:3584
    s_waitcnt lgkmcnt(0)
    v_lshlrev_b32 v100, 16, v6
    v_and_b32 v101, 0xffff0000, v6
    s_cmp_eq_u32 s60, 4
    s_cselect_b32 s40, 6, 12
    s_mov_b32 s41, 5462
    s_cmov_b32 s41, 10923
    s_cselect_b32 s34, 20, 20
    s_mov_b32 s49, 17280
    s_cmov_b32 s49, 34560
    v_min_u32 v196, 59, v0
    v_mul_u32_u24 v197, s41, v196
    v_lshrrev_b32 v197, 16, v197
    v_mul_u32_u24 v194, s40, v197
    v_sub_u32 v196, v196, v194
    v_mul_u32_u24 v197, 3456, v197
    v_lshl_add_u32 v197, v196, 6, v197
    s_mul_i32 s35, s60, 768
    s_add_i32 s35, s35, 0
    s_cmp_eq_u32 s60, 4
    s_cselect_b32 s35, 3072, s35
    s_sub_u32 s34, s61, s34
    s_mul_i32 s34, s34, s49
    s_mul_i32 s34, s34, 11
    s_add_u32 s34, s34, s35
    v_add_u32 v197, s34, v197
    s_mov_b32 s40, s49
    s_mov_b32 s41, s49
    s_branch L_d_none
L_d_w2:
    s_lshl_b32 s34, s62, 5
    v_lshl_add_u32 v3, v14, 3, s34
    global_load_dwordx2 v[20:21], v3, s[22:23]
    v_mul_u32_u24 v112, 1280, v12
    v_add_u32 v112, v112, v3
    global_load_dwordx2 v[22:23], v112, s[4:5]
    s_lshr_b32 s34, s62, 2
    s_add_u32 s34, s34, 30
    s_lshr_b32 s35, s34, 2
    s_lshl_b32 s35, s35, 9
    s_and_b32 s34, s34, 3
    s_lshl_b32 s34, s34, 15
    s_add_u32 s34, s34, s35
    s_and_b32 s35, s62, 3
    s_mul_i32 s35, s35, 32
    s_add_u32 s34, s34, s35
    s_add_u32 s34, s34, 1572864
    v_lshlrev_b32 v5, 7, v12
    v_lshl_add_u32 v5, v14, 3, v5
    v_add_u32 v5, s34, v5
    s_waitcnt vmcnt(0)
    v_lshlrev_b32 v32, 16, v20
    v_and_b32 v33, 0xffff0000, v20
    v_lshlrev_b32 v34, 16, v21
    v_and_b32 v35, 0xffff0000, v21
    v_lshlrev_b32 v108, 16, v22
    v_and_b32 v109, 0xffff0000, v22
    v_lshlrev_b32 v110, 16, v23
    v_and_b32 v111, 0xffff0000, v23
    s_mov_b32 s35, 0
L_poll30:
    buffer_load_dwordx2 v[24:25], v5, s[44:47], 0 offen sc1
    s_add_u32 s35, s35, 1
    s_waitcnt vmcnt(0)
    v_max_u32 v28, v24, v25
    v_cmp_eq_u32 vcc, -1, v28
    s_cbranch_vccz L_done31
    s_sleep 16
    s_cmp_lt_u32 s35, 60000
    s_cbranch_scc1 L_poll30
L_done31:
    v_lshlrev_b32 v104, 16, v24
    v_and_b32 v105, 0xffff0000, v24
    v_lshlrev_b32 v106, 16, v25
    v_and_b32 v107, 0xffff0000, v25
    v_fma_f32 v108, v104, v32, v108
    v_fma_f32 v109, v105, v33, v109
    v_fma_f32 v110, v106, v34, v110
    v_fma_f32 v111, v107, v35, v111
    v_mul_f32 v108, 0x3e800000, v108
    v_mul_f32 v109, 0x3e800000, v109
    v_mul_f32 v110, 0x3e800000, v110
    v_mul_f32 v111, 0x3e800000, v111
    v_lshl_add_u32 v204, v13, 15, v112
    s_add_u32 s34, s99, 786432
    v_add_u32 v204, s34, v204
    s_cmp_eq_u32 s60, 4
    s_cselect_b32 s40, 2, 6
    s_mov_b32 s41, 10923
    s_cmov_b32 s41, 32769
    s_cselect_b32 s34, 28, 20
    s_mov_b32 s49, 12800
    s_cmov_b32 s49, 38400
    v_min_u32 v196, 59, v0
    v_mul_u32_u24 v197, s41, v196
    v_lshrrev_b32 v197, 16, v197
    v_mul_u32_u24 v194, s40, v197
    v_sub_u32 v196, v196, v194
    v_mul_u32_u24 v197, 1280, v197
    v_lshl_add_u32 v197, v196, 6, v197
    s_mul_i32 s35, s60, 384
    s_add_i32 s35, s35, -1792
    s_cmp_eq_u32 s60, 4
    s_cselect_b32 s35, 0, s35
    s_sub_u32 s34, s61, s34
    s_mul_i32 s34, s34, s49
    s_mul_i32 s34, s34, 15
    s_add_u32 s34, s34, s35
    v_add_u32 v197, s34, v197
    s_mov_b32 s40, s49
    s_mov_b32 s41, s49
    s_branch L_d_none
L_d_wo:
    s_lshr_b32 s49, s3, 1
    s_lshl_b32 s49, s49, 15
    v_and_b32 v210, 7, v0
    s_mul_i32 s34, s60, 4096
    s_add_u32 s34, s34, s49
    s_add_u32 s34, s34, 1179904
    v_lshrrev_b32 v211, 3, v0
    v_mul_u32_u24 v205, 512, v211
    v_add_u32 v204, s34, v205
    s_lshl_b32 s35, s51, 7
    s_add_u32 s34, s34, s35
    s_sub_u32 s34, s34, 256
    v_lshl_add_u32 v205, v210, 4, v205
    v_add_u32 v205, s34, v205
    s_lshl_b32 s34, s3, 12
    s_add_u32 s34, s34, 40960
    v_lshrrev_b32 v206, 2, v0
    v_lshlrev_b32 v206, 6, v206
    v_lshl_add_u32 v206, v200, 3, v206
    v_add_u32 v206, s34, v206
    s_mul_i32 s34, s3, 1152
    s_add_u32 s34, s34, 107520
    v_mul_u32_u24 v207, 144, v211
    v_lshl_add_u32 v207, v210, 4, v207
    v_add_u32 v207, s34, v207
    v_mul_u32_u24 v208, 144, v210
    v_lshl_add_u32 v208, v202, 4, v208
    v_add_u32 v208, s34, v208
    v_mul_u32_u24 v212, 144, v211
    v_add_u32 v212, s34, v212
    v_mul_u32_u24 v213, 144, v210
    v_add_u32 v213, s34, v213
    v_and_b32 v211, 1, v211
    v_bfe_u32 v203, v0, 1, 2
    v_mul_u32_u24 v203, 144, v203
    v_and_b32 v214, 1, v0
    v_mul_u32_u24 v214, 576, v214
    v_lshl_add_u32 v214, v211, 6, v214
    v_lshl_add_u32 v214, v202, 4, v214
    s_add_u32 s34, s34, 14592
    v_add3_u32 v203, v203, v214, s34
    v_mov_b32 v210, 98816
    v_cmp_eq_u32 vcc, 0, v211
    s_nop 1
    v_cndmask_b32 v209, v208, v210, vcc
    v_cndmask_b32 v208, v210, v208, vcc
    v_and_b32 v8, 15, v0
    s_lshr_b32 s34, s62, 1
    s_add_u32 s34, s34, 0
    s_lshr_b32 s35, s34, 2
    s_lshl_b32 s35, s35, 9
    s_and_b32 s34, s34, 3
    s_lshl_b32 s34, s34, 15
    s_add_u32 s34, s34, s35
    s_and_b32 s35, s62, 1
    s_mul_i32 s35, s35, 64
    s_add_u32 s34, s34, s35
    s_add_u32 s34, s34, 1572864
    v_lshlrev_b32 v9, 2, v8
    v_lshl_add_u32 v9, v14, 7, v9
    v_add_u32 v9, s34, v9
    s_lshr_b32 s34, s60, 2
    s_lshl_b32 s34, s34, 14
    s_and_b32 s35, s60, 3
    s_lshl_b32 s35, s35, 15
    s_add_u32 s34, s34, s35
    s_lshl_b32 s35, s62, 6
    s_add_u32 s34, s34, s35
    s_add_u32 s34, s34, 786432
    v_mul_u32_u24 v112, 1280, v14
    v_lshl_add_u32 v112, v8, 2, v112
    v_add_u32 v112, s34, v112
    v_mul_u32_u24 v113, 144, v14
    v_lshl_add_u32 v113, v8, 3, v113
    v_add_u32 v113, 122112, v113
    s_bfe_u32 s35, s60, 0x10002
    s_lshl_b32 s35, s35, 13
    s_xor_b32 s101, s99, s35
    s_xor_b32 s93, s101, 8192
    s_mul_i32 s34, s62, 52
    s_lshr_b32 s34, s34, 8
    s_mul_i32 s35, s34, 5
    s_sub_u32 s35, s62, s35
    s_mul_i32 s34, s34, 1310720
    s_lshl_b32 s35, s35, 15
    s_add_u32 s34, s34, s35
    s_mul_i32 s35, s60, 163840
    s_add_u32 s34, s34, s35
    v_lshl_add_u32 v197, v0, 6, s34
    s_movk_i32 s40, 4096
    s_movk_i32 s41, 4096
    s_mov_b32 s35, 0
L_poll33:
    buffer_load_dword v32, v9, s[44:47], 0 offen sc1
    s_add_u32 s35, s35, 1
    s_waitcnt vmcnt(0)
    v_mov_b32 v22, v32
    v_cmp_eq_u32 vcc, -1, v22
    s_cbranch_vccz L_done34
    s_sleep 16
    s_cmp_lt_u32 s35, 60000
    s_cbranch_scc1 L_poll33
L_done34:
    v_lshlrev_b32 v100, 16, v32
    v_and_b32 v101, 0xffff0000, v32
L_d_none:
    v_mov_b32 v22, 99072
    s_and_b32 s34, s60, 3
    s_lshl_b32 s34, s34, 15
    s_lshr_b32 s35, s60, 2
    s_lshl_b32 s35, s35, 7
    s_add_u32 s34, s34, s35
    s_add_u32 s34, s34, 793600
    v_and_b32 v252, 31, v0
    v_lshl_add_u32 v252, v252, 2, s34
    v_mov_b32 v253, 0
    s_mov_b32 s35, 0
L_poll36:
    ds_read_b32 v23, v22
    s_add_u32 s35, s35, 1
    s_waitcnt lgkmcnt(0)
    v_cmp_gt_u32 vcc, 46, v23
    s_cbranch_vccz L_done37
    s_sleep 2
    s_cmp_lt_u32 s35, 60000
    s_cbranch_scc1 L_poll36
L_done37:
    buffer_load_dword v251, v252, s[44:47], 0 offen sc1
    s_lshl_b64 exec, 1, s61
    buffer_store_dword v253, v252, s[44:47], 0 offen
    s_mov_b64 exec, -1
    s_waitcnt vmcnt(0)
    v_cmp_ne_u32 vcc, -1, v251
    v_mov_b32 v252, 99076
    s_bcnt1_i32_b32 s34, vcc_lo
    v_mov_b32 v251, s34
    s_mov_b64 exec, 1
    ds_write_b32 v252, v251
    s_mov_b64 exec, -1
    v_mov_b32 v22, 99072
    s_and_b32 s34, s60, 3
    s_lshl_b32 s34, s34, 15
    s_lshr_b32 s35, s60, 2
    s_lshl_b32 s35, s35, 7
    s_add_u32 s34, s34, s35
    s_add_u32 s34, s34, 793856
    v_and_b32 v252, 31, v0
    v_lshl_add_u32 v252, v252, 2, s34
    v_mov_b32 v253, 0
    s_mov_b32 s35, 0
L_poll39:
    ds_read_b32 v23, v22
    s_add_u32 s35, s35, 1
    s_waitcnt lgkmcnt(0)
    v_cmp_gt_u32 vcc, 57, v23
    s_cbranch_vccz L_done40
    s_sleep 2
    s_cmp_lt_u32 s35, 60000
    s_cbranch_scc1 L_poll39
L_done40:
    buffer_load_dword v251, v252, s[44:47], 0 offen sc1
    s_lshl_b64 exec, 1, s61
    buffer_store_dword v253, v252, s[44:47], 0 offen
    s_mov_b64 exec, -1
    s_waitcnt vmcnt(0)
    v_cmp_ne_u32 vcc, -1, v251
    v_mov_b32 v252, 99076
    s_bcnt1_i32_b32 s34, vcc_lo
    v_mov_b32 v251, s34
    s_mov_b64 exec, 1
    ds_write_b32 v252, v251
    s_mov_b64 exec, -1
    v_and_b32 v19, 7, v0
    v_lshlrev_b32 v19, 3, v19
    v_add_u32 v19, 98560, v19
    s_mov_b32 s35, 0
L_poll42:
    ds_read_b64 v[20:21], v19
    s_add_u32 s35, s35, 1
    s_waitcnt lgkmcnt(0)
    v_max_u32 v22, v20, v21
    v_cmp_eq_u32 vcc, -1, v22
    s_cbranch_vccz L_done43
    s_sleep 2
    s_cmp_lt_u32 s35, 60000
    s_cbranch_scc1 L_poll42
L_done43:
    v_max_f32_dpp v22, v20, v20 row_half_mirror row_mask:0xf bank_mask:0xf
    s_nop 1
    v_max_f32_dpp v22, v22, v22 quad_perm:[1,0,3,2] row_mask:0xf bank_mask:0xf
    s_nop 1
    v_max_f32_dpp v22, v22, v22 quad_perm:[2,3,0,1] row_mask:0xf bank_mask:0xf
    v_sub_f32 v20, v20, v22
    v_exp_f32 v20, v20
    s_nop 0
    v_mul_f32 v21, v21, v20
    s_nop 1
    v_add_f32_dpp v21, v21, v21 row_half_mirror row_mask:0xf bank_mask:0xf
    s_nop 1
    v_add_f32_dpp v21, v21, v21 quad_perm:[1,0,3,2] row_mask:0xf bank_mask:0xf
    s_nop 1
    v_add_f32_dpp v21, v21, v21 quad_perm:[2,3,0,1] row_mask:0xf bank_mask:0xf
    v_rcp_f32 v23, v21
    v_log_f32 v21, v21
    v_mul_f32 v20, v20, v23
    v_add_f32 v21, v21, v22
    v_min_u32 v21, -2, v21
    v_readlane_b32 s88, v20, 0
    v_readlane_b32 s90, v20, 1
    v_readlane_b32 s92, v20, 2
    v_readlane_b32 s94, v20, 3
    v_readlane_b32 s96, v20, 4
    v_readlane_b32 s98, v20, 5
    v_readlane_b32 s100, v20, 6
    v_readlane_b32 s89, v20, 7
    s_and_b32 s95, s61, 3
    s_lshl_b32 s95, s95, 15
    s_bfe_u32 s35, s2, 0x20005
    s_lshl_b32 s35, s35, 1
    s_lshr_b32 s91, s2, 7
    s_add_u32 s35, s35, s91
    s_getreg_b32 s91, hwreg(HW_REG_XCC_ID, 0, 4)
    v_and_b32 v24, 1, v0
    v_cmp_eq_u32 vcc, 0, v24
    v_mov_b32 v25, s91
    s_nop 0
    v_cndmask_b32 v25, v25, v21, vcc
    v_mul_f32 v20, s89, v116
    v_mul_f32 v21, s89, v117
    s_mul_i32 s34, s60, 4096
    s_mul_i32 s35, s35, 512
    s_add_u32 s34, s34, s35
    s_add_u32 s34, s34, s95
    s_add_u32 s34, s34, 1179648
    v_lshl_add_u32 v26, v0, 2, s34
    v_lshlrev_b32 v19, 3, v0
    v_add_u32 v19, 99328, v19
    v_lshlrev_b32 v18, 4, v0
    v_add_u32 v18, 131328, v18
    s_mov_b32 s36, s12
    s_mov_b32 s37, s13
    s_mov_b32 s38, 5242880
    s_and_b32 s34, s61, 24
    s_add_u32 s34, s34, s60
    s_mul_i32 s34, s34, 163840
    s_and_b32 s35, s61, 7
    s_mul_i32 s35, s35, 20480
    s_add_u32 s34, s34, s35
    v_lshl_add_u32 v195, v0, 6, s34
    s_mov_b32 s34, 0
    s_barrier
    buffer_load_dword v250, v195, s[36:39], s34 offen
    s_add_u32 s34, s34, 4096
    buffer_load_dword v250, v195, s[36:39], s34 offen
    s_add_u32 s34, s34, 4096
    buffer_load_dword v250, v195, s[36:39], s34 offen
    s_add_u32 s34, s34, 4096
    buffer_load_dword v250, v195, s[36:39], s34 offen
    s_add_u32 s34, s34, 4096
    buffer_load_dword v250, v195, s[36:39], s34 offen
    s_add_u32 s34, s34, 4096
    s_cmp_lt_u32 s63, 1
    s_cbranch_scc1 L_nopf
    buffer_load_dword v250, v197, s[52:55], s42 offen
    s_add_u32 s42, s42, s40
    buffer_load_dword v250, v197, s[52:55], s42 offen
    s_add_u32 s42, s42, s41
L_nopf:
    s_cmp_eq_u32 s97, 0
    s_barrier
    ds_read_b64 v[32:33], v19 offset:0
    ds_read_b64 v[34:35], v19 offset:1024
    ds_read_b64 v[36:37], v19 offset:2048
    ds_read_b64 v[38:39], v19 offset:3072
    ds_read_b64 v[40:41], v19 offset:4096
    ds_read_b64 v[42:43], v19 offset:5120
    ds_read_b64 v[44:45], v19 offset:6144
    buffer_store_dword v25, v26, s[44:47], 0 offen offset:256
    s_waitcnt lgkmcnt(6)
    v_pk_fma_f32 v[20:21], v[32:33], s[88:89], v[20:21] op_sel_hi:[1,0,1]
    s_waitcnt lgkmcnt(5)
    v_pk_fma_f32 v[20:21], v[34:35], s[90:91], v[20:21] op_sel_hi:[1,0,1]
    s_waitcnt lgkmcnt(4)
    v_pk_fma_f32 v[20:21], v[36:37], s[92:93], v[20:21] op_sel_hi:[1,0,1]
    s_waitcnt lgkmcnt(3)
    v_pk_fma_f32 v[20:21], v[38:39], s[94:95], v[20:21] op_sel_hi:[1,0,1]
    s_waitcnt lgkmcnt(2)
    v_pk_fma_f32 v[20:21], v[40:41], s[96:97], v[20:21] op_sel_hi:[1,0,1]
    s_waitcnt lgkmcnt(1)
    v_pk_fma_f32 v[20:21], v[42:43], s[98:99], v[20:21] op_sel_hi:[1,0,1]
    s_waitcnt lgkmcnt(0)
    v_pk_fma_f32 v[20:21], v[44:45], s[100:101], v[20:21] op_sel_hi:[1,0,1]
    v_cvt_pk_bf16_f32 v24, v20, v21
    v_min_u32 v24, -2, v24
    buffer_store_dword v24, v26, s[44:47], 0 offen
    s_cbranch_scc1 L_ostd
    buffer_store_dword v24, v26, s[44:47], 0 offen sc1
    buffer_store_dword v25, v26, s[44:47], 0 offen offset:256 sc1
L_ostd:
    ds_write_b96 v18, v[24:26]
    s_waitcnt lgkmcnt(0)
    s_cmp_lt_u32 s63, 1
    s_cbranch_scc1 L_nopf2
    buffer_load_dword v250, v197, s[52:55], s42 offen
    s_add_u32 s42, s42, s40
    buffer_load_dword v250, v197, s[52:55], s42 offen
    s_add_u32 s42, s42, s41
    buffer_load_dword v250, v197, s[52:55], s42 offen
    s_add_u32 s42, s42, s40
    buffer_load_dword v250, v197, s[52:55], s42 offen
    s_add_u32 s42, s42, s41
    buffer_load_dword v250, v197, s[52:55], s42 offen
    s_add_u32 s42, s42, s40
    buffer_load_dword v250, v197, s[52:55], s42 offen
    s_add_u32 s42, s42, s41
    buffer_load_dword v250, v197, s[52:55], s42 offen
    s_add_u32 s42, s42, s40
    buffer_load_dword v250, v197, s[52:55], s42 offen
    s_add_u32 s42, s42, s41
L_nopf2:
    s_barrier
    s_cmp_eq_u32 s63, 0
    s_cbranch_scc1 L_r_wo2
    buffer_load_dword v250, v197, s[52:55], s42 offen
    s_add_u32 s42, s42, s40
    s_cmp_eq_u32 s63, 1
    s_cbranch_scc1 L_r_w1
    buffer_load_dword v250, v197, s[52:55], s42 offen
    s_add_u32 s42, s42, s40
    buffer_load_dword v250, v197, s[52:55], s42 offen
    s_add_u32 s42, s42, s41
    buffer_load_dword v250, v197, s[52:55], s42 offen
    s_add_u32 s42, s42, s40
    buffer_load_dword v250, v197, s[52:55], s42 offen
    s_add_u32 s42, s42, s41
    s_cmp_eq_u32 s63, 2
    s_cbranch_scc1 L_w2_red
    s_waitcnt vmcnt(0)
    s_mov_b64 exec, -1
    v_lshlrev_b32 v243, 4, v0
    v_add_u32 v243, 131328, v243
    ds_read_b96 v[240:242], v243
    s_waitcnt lgkmcnt(0)
    buffer_store_dword v240, v242, s[44:47], 0 offen sc1
    buffer_store_dword v241, v242, s[44:47], 0 offen offset:256 sc1
    s_branch L_fin
L_stream:
    s_sub_u32 s49, s3, 1
    s_lshl_b32 s49, s49, 12
    v_lshl_add_u32 v1, v0, 4, s49
    s_and_b32 s34, s2, 127
    s_lshl_b32 s34, s34, 21
    s_lshr_b32 s35, s2, 7
    s_lshl_b32 s35, s35, 18
    s_add_u32 s34, s34, s35
    s_add_u32 s34, s34, 1572864
    s_mov_b32 s38, 0x40000
    s_mov_b32 s42, 0x40000
    s_waitcnt lgkmcnt(0)
    s_add_u32 s36, s6, s34
    s_addc_u32 s37, s7, 0
    s_add_u32 s40, s8, s34
    s_addc_u32 s41, s9, 0
    s_barrier
    s_waitcnt vmcnt(2)
    s_mov_b32 s49, 0
    buffer_load_dwordx4 v[28:31], v1, s[36:39], s49 offen offset:3072 nt
    s_waitcnt vmcnt(2)
    s_mov_b32 s49, 28672
    buffer_load_dwordx4 v[32:35], v1, s[36:39], s49 offen offset:0 nt
    s_waitcnt vmcnt(2)
    buffer_load_dwordx4 v[36:39], v1, s[36:39], s49 offen offset:1024 nt
    s_waitcnt vmcnt(2)
    buffer_load_dwordx4 v[40:43], v1, s[36:39], s49 offen offset:2048 nt
    s_waitcnt vmcnt(2)
    buffer_load_dwordx4 v[44:47], v1, s[36:39], s49 offen offset:3072 nt
    s_add_u32 s44, s32, 0
    s_addc_u32 s45, s33, 0
    s_mov_b32 s63, 0
    s_mov_b32 s62, s61
    s_cmp_lt_u32 s61, 20
    s_cbranch_scc1 L_rd45
    s_mul_i32 s62, s60, 12
    s_add_u32 s62, s62, s61
    s_sub_u32 s62, s62, 20
    s_mov_b32 s63, 1
    s_cmp_lt_u32 s62, 54
    s_cbranch_scc1 L_rd45
    s_cmp_lt_u32 s62, 56
    s_cselect_b32 s63, 3, 2
    s_sub_u32 s62, s62, 56
L_rd45:
    v_and_b32 v8, 3, v0
    v_bfe_u32 v9, v0, 2, 2
    v_lshrrev_b32 v10, 4, v0
    s_mov_b32 s55, 0x20000
    s_lshl_b32 s35, s62, 6
    s_and_b32 s49, s62, 1
    s_cmp_eq_u32 s63, 0
    s_cbranch_scc1 L_dp47
    s_cmp_eq_u32 s63, 1
    s_cbranch_scc1 L_dp48
    s_mov_b32 s52, s20
    s_mov_b32 s53, s21
    s_mov_b32 s54, 2211840
    v_mov_b32 v15, 0
    s_branch L_dp49
L_dp48:
    s_mov_b32 s52, s16
    s_mov_b32 s53, s17
    s_mov_b32 s54, 2211840
    v_lshl_add_u32 v15, v9, 3, v10
    v_mul_u32_u24 v15, 3456, v15
    v_lshl_add_u32 v15, v8, 4, v15
    v_add_u32 v15, s35, v15
    s_bfe_u32 s50, s3, 0x10001
    s_lshl_b32 s50, s50, 7
    s_and_b32 s34, s3, 1
    s_lshl_b32 s34, s34, 2
    s_add_u32 s50, s50, s34
    s_and_b32 s51, s3, 3
    s_lshl_b32 s51, s51, 5
    s_add_u32 s51, s51, 512
    s_mul_i32 s50, s50, 3456
    s_mul_i32 s51, s51, 3456
    s_branch L_dp49
L_dp47:
    s_mov_b32 s52, s12
    s_mov_b32 s53, s13
    s_mov_b32 s54, 5242880
    s_lshr_b32 s50, s3, 1
    s_lshl_b32 s50, s50, 3
    s_add_u32 s50, s50, s60
    s_and_b32 s51, s3, 1
    s_lshl_b32 s34, s50, 1
    s_add_u32 s34, s34, s51
    s_mul_i32 s34, s34, 81920
    s_add_u32 s34, s34, s35
    v_lshl_add_u32 v15, v9, 2, v10
    v_mul_u32_u24 v15, 2560, v15
    v_lshl_add_u32 v15, v8, 4, v15
    v_add_u32 v15, s34, v15
    s_lshl_b32 s56, s3, 12
    s_lshl_b32 s34, s49, 11
    s_add_u32 s56, s56, s34
    s_add_u32 s56, s56, 40960
    s_add_u32 s58, s56, 1024
    s_mul_i32 s57, s49, 40960
    s_add_u32 s59, s57, 1280
L_dp49:
    v_and_b32 v2, 15, v0
    v_lshlrev_b32 v2, 4, v2
    v_add_u32 v2, 98304, v2
    s_waitcnt vmcnt(2)
    s_mov_b32 s49, 57344
    buffer_load_dwordx4 v[48:51], v1, s[36:39], s49 offen offset:0 nt
    s_waitcnt vmcnt(2)
    buffer_load_dwordx4 v[52:55], v1, s[36:39], s49 offen offset:1024 nt
    s_waitcnt vmcnt(2)
    s_cmp_ge_u32 s3, 4
    s_cbranch_scc1 L_sl50
    s_waitcnt vmcnt(1)
L_sl50:
    buffer_load_dwordx4 v[56:59], v1, s[36:39], s49 offen offset:2048 nt
    s_waitcnt vmcnt(2)
    s_cmp_ge_u32 s3, 4
    s_cbranch_scc1 L_sl51
    s_waitcnt vmcnt(1)
L_sl51:
    buffer_load_dwordx4 v[60:63], v1, s[36:39], s49 offen offset:3072 nt
    s_waitcnt vmcnt(2)
    s_cmp_ge_u32 s3, 4
    s_cbranch_scc1 L_sl52
    s_waitcnt vmcnt(1)
L_sl52:
    s_mov_b32 s49, 86016
    buffer_load_dwordx4 v[64:67], v1, s[36:39], s49 offen offset:0 nt
    s_waitcnt vmcnt(2)
    buffer_load_dwordx4 v[68:71], v1, s[36:39], s49 offen offset:1024 nt
    s_waitcnt vmcnt(2)
    buffer_load_dwordx4 v[72:75], v1, s[36:39], s49 offen offset:2048 nt
    s_waitcnt vmcnt(2)
    buffer_load_dwordx4 v[76:79], v1, s[36:39], s49 offen offset:3072 nt
    s_waitcnt vmcnt(2)
    s_mov_b32 s49, 114688
    buffer_load_dwordx4 v[80:83], v1, s[36:39], s49 offen offset:0 nt
    s_waitcnt vmcnt(2)
    buffer_load_dwordx4 v[84:87], v1, s[36:39], s49 offen offset:1024 nt
    s_waitcnt vmcnt(2)
    buffer_load_dwordx4 v[88:91], v1, s[36:39], s49 offen offset:2048 nt
    s_waitcnt vmcnt(2)
    buffer_load_dwordx4 v[92:95], v1, s[36:39], s49 offen offset:3072 nt
    s_waitcnt vmcnt(2)
    s_mov_b32 s49, 143360
    buffer_load_dwordx4 v[96:99], v1, s[36:39], s49 offen offset:0 nt
    v_mov_b32 v3, 21
    v_mov_b32 v14, 99072
    s_mov_b64 exec, 1
    ds_write_b32 v14, v3
    s_mov_b64 exec, -1
    s_waitcnt vmcnt(2)
    buffer_load_dwordx4 v[100:103], v1, s[36:39], s49 offen offset:1024 nt
    s_waitcnt vmcnt(2)
    buffer_load_dwordx4 v[104:107], v1, s[36:39], s49 offen offset:2048 nt
    s_waitcnt vmcnt(2)
    buffer_load_dwordx4 v[108:111], v1, s[36:39], s49 offen offset:3072 nt
    s_waitcnt vmcnt(2)
    s_mov_b32 s49, 172032
    buffer_load_dwordx4 v[112:115], v1, s[36:39], s49 offen offset:0 nt
    s_waitcnt vmcnt(2)
    buffer_load_dwordx4 v[116:119], v1, s[36:39], s49 offen offset:1024 nt
    s_waitcnt vmcnt(2)
    buffer_load_dwordx4 v[120:123], v1, s[36:39], s49 offen offset:2048 nt
    s_waitcnt vmcnt(2)
    buffer_load_dwordx4 v[124:127], v1, s[36:39], s49 offen offset:3072 nt
    s_waitcnt vmcnt(2)
    s_mov_b32 s49, 200704
    buffer_load_dwordx4 v[128:131], v1, s[36:39], s49 offen offset:0 nt
    s_waitcnt vmcnt(2)
    buffer_load_dwordx4 v[132:135], v1, s[36:39], s49 offen offset:1024 nt
    s_waitcnt vmcnt(2)
    buffer_load_dwordx4 v[136:139], v1, s[36:39], s49 offen offset:2048 nt
    s_waitcnt vmcnt(2)
    buffer_load_dwordx4 v[140:143], v1, s[36:39], s49 offen offset:3072 nt
    s_waitcnt vmcnt(2)
    s_mov_b32 s49, 229376
    buffer_load_dwordx4 v[144:147], v1, s[36:39], s49 offen offset:0 nt
    v_mov_b32 v3, 33
    v_mov_b32 v14, 99072
    s_mov_b64 exec, 1
    ds_write_b32 v14, v3
    s_mov_b64 exec, -1
    s_waitcnt vmcnt(2)
    buffer_load_dwordx4 v[148:151], v1, s[36:39], s49 offen offset:1024 nt
    s_waitcnt vmcnt(2)
    buffer_load_dwordx4 v[152:155], v1, s[36:39], s49 offen offset:2048 nt
    s_waitcnt vmcnt(2)
    buffer_load_dwordx4 v[156:159], v1, s[36:39], s49 offen offset:3072 nt
    s_waitcnt vmcnt(2)
    s_mov_b32 s49, 0
    buffer_load_dwordx4 v[160:163], v1, s[40:43], s49 offen offset:0 nt
    v_mov_b32 v3, 99076
    ds_read_b32 v3, v3
    s_waitcnt vmcnt(2)
    s_waitcnt lgkmcnt(0)
    v_readfirstlane_b32 s48, v3
    buffer_load_dwordx4 v[164:167], v1, s[40:43], s49 offen offset:1024 nt
    s_cmp_ge_u32 s48, 22
    s_cbranch_scc1 L_bo53
    s_waitcnt vmcnt(2)
L_bo53:
    buffer_load_dwordx4 v[168:171], v1, s[40:43], s49 offen offset:2048 nt
    s_waitcnt vmcnt(3)
    s_cmp_ge_u32 s48, 23
    s_cbranch_scc1 L_bo54
    s_waitcnt vmcnt(2)
L_bo54:
    buffer_load_dwordx4 v[172:175], v1, s[40:43], s49 offen offset:3072 nt
    s_waitcnt vmcnt(3)
    s_cmp_ge_u32 s48, 24
    s_cbranch_scc1 L_bo55
    s_waitcnt vmcnt(2)
L_bo55:
    s_mov_b32 s49, 28672
    buffer_load_dwordx4 v[176:179], v1, s[40:43], s49 offen offset:0 nt
    s_waitcnt vmcnt(3)
    s_cmp_ge_u32 s48, 25
    s_cbranch_scc1 L_bo56
    s_waitcnt vmcnt(2)
L_bo56:
    buffer_load_dwordx4 v[180:183], v1, s[40:43], s49 offen offset:1024 nt
    s_waitcnt vmcnt(3)
    s_cmp_ge_u32 s48, 26
    s_cbranch_scc1 L_bo57
    s_waitcnt vmcnt(2)
L_bo57:
    buffer_load_dwordx4 v[184:187], v1, s[40:43], s49 offen offset:2048 nt
    s_waitcnt vmcnt(3)
    s_cmp_ge_u32 s48, 27
    s_cbranch_scc1 L_bo58
    s_waitcnt vmcnt(2)
L_bo58:
    buffer_load_dwordx4 v[188:191], v1, s[40:43], s49 offen offset:3072 nt
    s_waitcnt vmcnt(3)
    s_cmp_ge_u32 s48, 28
    s_cbranch_scc1 L_bo59
    s_waitcnt vmcnt(2)
L_bo59:
    s_mov_b32 s49, 57344
    buffer_load_dwordx4 v[192:195], v1, s[40:43], s49 offen offset:0 nt
    s_waitcnt vmcnt(3)
    s_cmp_ge_u32 s48, 28
    s_cbranch_scc1 L_bo60
    s_waitcnt vmcnt(2)
L_bo60:
    buffer_load_dwordx4 v[196:199], v1, s[40:43], s49 offen offset:1024 nt
    v_mov_b32 v3, 46
    v_mov_b32 v14, 99072
    s_mov_b64 exec, 1
    ds_write_b32 v14, v3
    s_mov_b64 exec, -1
    s_waitcnt vmcnt(3)
    s_cmp_ge_u32 s48, 29
    s_cbranch_scc1 L_bo61
    s_waitcnt vmcnt(2)
L_bo61:
    buffer_load_dwordx4 v[200:203], v1, s[40:43], s49 offen offset:2048 nt
    s_waitcnt vmcnt(3)
    s_cmp_ge_u32 s48, 29
    s_cbranch_scc1 L_bo62
    s_waitcnt vmcnt(2)
L_bo62:
    buffer_load_dwordx4 v[204:207], v1, s[40:43], s49 offen offset:3072 nt
    s_waitcnt vmcnt(3)
    s_cmp_ge_u32 s48, 30
    s_cbranch_scc1 L_bo63
    s_waitcnt vmcnt(2)
L_bo63:
    s_mov_b32 s49, 86016
    buffer_load_dwordx4 v[208:211], v1, s[40:43], s49 offen offset:0 nt
    s_waitcnt vmcnt(3)
    s_cmp_ge_u32 s48, 30
    s_cbranch_scc1 L_bo64
    s_waitcnt vmcnt(2)
L_bo64:
    buffer_load_dwordx4 v[212:215], v1, s[40:43], s49 offen offset:1024 nt
    v_mov_b32 v3, 99076
    ds_read_b32 v3, v3
    s_waitcnt vmcnt(3)
    s_cmp_ge_u32 s48, 31
    s_cbranch_scc1 L_bo65
    s_waitcnt vmcnt(2)
L_bo65:
    s_waitcnt lgkmcnt(0)
    v_readfirstlane_b32 s48, v3
    buffer_load_dwordx4 v[216:219], v1, s[40:43], s49 offen offset:2048 nt
    s_waitcnt vmcnt(3)
    s_cmp_ge_u32 s48, 22
    s_cbranch_scc1 L_bo66
    s_waitcnt vmcnt(2)
L_bo66:
    buffer_load_dwordx4 v[220:223], v1, s[40:43], s49 offen offset:3072 nt
    s_waitcnt vmcnt(3)
    s_cmp_ge_u32 s48, 23
    s_cbranch_scc1 L_bo67
    s_waitcnt vmcnt(2)
L_bo67:
    s_mov_b32 s49, 114688
    buffer_load_dwordx4 v[224:227], v1, s[40:43], s49 offen offset:0 nt
    s_waitcnt vmcnt(3)
    s_cmp_ge_u32 s48, 24
    s_cbranch_scc1 L_bo68
    s_waitcnt vmcnt(2)
L_bo68:
    buffer_load_dwordx4 v[228:231], v1, s[40:43], s49 offen offset:1024 nt
    s_waitcnt vmcnt(3)
    s_cmp_ge_u32 s48, 25
    s_cbranch_scc1 L_bo69
    s_waitcnt vmcnt(2)
L_bo69:
    buffer_load_dwordx4 v[232:235], v1, s[40:43], s49 offen offset:2048 nt
    s_waitcnt vmcnt(3)
    s_cmp_ge_u32 s48, 26
    s_cbranch_scc1 L_bo70
    s_waitcnt vmcnt(2)
L_bo70:
    buffer_load_dwordx4 v[236:239], v1, s[40:43], s49 offen offset:3072 nt
    v_mov_b32 v14, 99080
    s_mov_b32 s35, 0
L_poll71:
    ds_read_b128 v[4:7], v2
    ds_read_b32 v8, v14
    s_add_u32 s35, s35, 1
    s_waitcnt lgkmcnt(0)
    v_max3_u32 v3, v4, v5, v6
    v_max_u32 v3, v3, v7
    v_cmp_eq_u32 vcc, -1, v3
    s_cbranch_vccz L_done72
    s_sleep 2
    s_cmp_lt_u32 s35, 60000
    s_cbranch_scc1 L_poll71
L_done72:
    v_readfirstlane_b32 s99, v8
    s_waitcnt vmcnt(3)
    s_cmp_ge_u32 s48, 27
    s_cbranch_scc1 L_bo74
    s_waitcnt vmcnt(2)
L_bo74:
    s_mov_b32 s49, 143360
    buffer_load_dwordx4 v[240:243], v1, s[40:43], s49 offen offset:0 nt
    v_mov_b32 v3, 57
    v_mov_b32 v14, 99072
    s_mov_b64 exec, 1
    ds_write_b32 v14, v3
    s_mov_b64 exec, -1
    v_dot2_f32_bf16 v8, v16, v4, 0
    v_dot2_f32_bf16 v9, v20, v4, 0
    v_dot2_f32_bf16 v10, v24, v4, 0
    v_dot2_f32_bf16 v11, v28, v4, 0
    v_dot2c_f32_bf16 v8, v17, v5
    v_dot2c_f32_bf16 v9, v21, v5
    v_dot2c_f32_bf16 v10, v25, v5
    v_dot2c_f32_bf16 v11, v29, v5
    v_dot2c_f32_bf16 v8, v18, v6
    v_dot2c_f32_bf16 v9, v22, v6
    v_dot2c_f32_bf16 v10, v26, v6
    v_dot2c_f32_bf16 v11, v30, v6
    v_dot2c_f32_bf16 v8, v19, v7
    v_dot2c_f32_bf16 v9, v23, v7
    v_dot2c_f32_bf16 v10, v27, v7
    v_dot2c_f32_bf16 v11, v31, v7
    v_add_f32_dpp v12, v8, v8 row_ror:8 row_mask:0xf bank_mask:0x3
    v_add_f32_dpp v12, v9, v9 row_ror:8 row_mask:0xf bank_mask:0xc
    v_add_f32_dpp v13, v10, v10 row_ror:8 row_mask:0xf bank_mask:0x3
    v_add_f32_dpp v13, v11, v11 row_ror:8 row_mask:0xf bank_mask:0xc
    v_dot2_f32_bf16 v8, v32, v4, 0
    v_dot2_f32_bf16 v9, v36, v4, 0
    v_dot2_f32_bf16 v10, v40, v4, 0
    v_dot2_f32_bf16 v11, v44, v4, 0
    v_add_f32_dpp v12, v12, v12 row_half_mirror row_mask:0xf bank_mask:0xf
    v_add_f32_dpp v13, v13, v13 row_half_mirror row_mask:0xf bank_mask:0xf
    v_dot2c_f32_bf16 v8, v33, v5
    v_dot2c_f32_bf16 v9, v37, v5
    v_dot2c_f32_bf16 v10, v41, v5
    v_dot2c_f32_bf16 v11, v45, v5
    v_add_f32_dpp v12, v12, v12 quad_perm:[1,0,3,2] row_mask:0xf bank_mask:0xf
    v_add_f32_dpp v13, v13, v13 quad_perm:[1,0,3,2] row_mask:0xf bank_mask:0xf
    v_dot2c_f32_bf16 v8, v34, v6
    v_dot2c_f32_bf16 v9, v38, v6
    v_dot2c_f32_bf16 v10, v42, v6
    v_dot2c_f32_bf16 v11, v46, v6
    s_waitcnt vmcnt(3)
    s_cmp_ge_u32 s48, 28
    s_cbranch_scc1 L_bo75
    s_waitcnt vmcnt(2)
L_bo75:
    buffer_load_dwordx4 v[244:247], v1, s[40:43], s49 offen offset:1024 nt
    v_add_f32_dpp v12, v12, v12 quad_perm:[2,3,0,1] row_mask:0xf bank_mask:0xf
    v_add_f32_dpp v13, v13, v13 quad_perm:[2,3,0,1] row_mask:0xf bank_mask:0xf
    v_dot2c_f32_bf16 v8, v35, v7
    v_dot2c_f32_bf16 v9, v39, v7
    v_dot2c_f32_bf16 v10, v43, v7
    v_dot2c_f32_bf16 v11, v47, v7
    v_add_f32_dpp v16, v8, v8 row_ror:8 row_mask:0xf bank_mask:0x3
    v_add_f32_dpp v16, v9, v9 row_ror:8 row_mask:0xf bank_mask:0xc
    v_add_f32_dpp v17, v10, v10 row_ror:8 row_mask:0xf bank_mask:0x3
    v_add_f32_dpp v17, v11, v11 row_ror:8 row_mask:0xf bank_mask:0xc
    v_dot2_f32_bf16 v8, v48, v4, 0
    v_dot2_f32_bf16 v9, v52, v4, 0
    v_dot2_f32_bf16 v10, v56, v4, 0
    v_dot2_f32_bf16 v11, v60, v4, 0
    v_add_f32_dpp v16, v16, v16 row_half_mirror row_mask:0xf bank_mask:0xf
    v_add_f32_dpp v17, v17, v17 row_half_mirror row_mask:0xf bank_mask:0xf
    v_dot2c_f32_bf16 v8, v49, v5
    v_dot2c_f32_bf16 v9, v53, v5
    v_dot2c_f32_bf16 v10, v57, v5
    v_dot2c_f32_bf16 v11, v61, v5
    v_add_f32_dpp v16, v16, v16 quad_perm:[1,0,3,2] row_mask:0xf bank_mask:0xf
    v_add_f32_dpp v17, v17, v17 quad_perm:[1,0,3,2] row_mask:0xf bank_mask:0xf
    v_dot2c_f32_bf16 v8, v50, v6
    v_dot2c_f32_bf16 v9, v54, v6
    v_dot2c_f32_bf16 v10, v58, v6
    v_dot2c_f32_bf16 v11, v62, v6
    v_add_f32_dpp v16, v16, v16 quad_perm:[2,3,0,1] row_mask:0xf bank_mask:0xf
    v_add_f32_dpp v17, v17, v17 quad_perm:[2,3,0,1] row_mask:0xf bank_mask:0xf
    v_dot2c_f32_bf16 v8, v51, v7
    v_dot2c_f32_bf16 v9, v55, v7
    v_dot2c_f32_bf16 v10, v59, v7
    v_dot2c_f32_bf16 v11, v63, v7
    v_add_f32_dpp v18, v8, v8 row_ror:8 row_mask:0xf bank_mask:0x3
    v_add_f32_dpp v18, v9, v9 row_ror:8 row_mask:0xf bank_mask:0xc
    v_add_f32_dpp v19, v10, v10 row_ror:8 row_mask:0xf bank_mask:0x3
    v_add_f32_dpp v19, v11, v11 row_ror:8 row_mask:0xf bank_mask:0xc
    s_waitcnt vmcnt(3)
    s_cmp_ge_u32 s48, 28
    s_cbranch_scc1 L_bo76
    s_waitcnt vmcnt(2)
L_bo76:
    buffer_load_dwordx4 v[248:251], v1, s[40:43], s49 offen offset:2048 nt
    v_dot2_f32_bf16 v8, v64, v4, 0
    v_dot2_f32_bf16 v9, v68, v4, 0
    v_dot2_f32_bf16 v10, v72, v4, 0
    v_dot2_f32_bf16 v11, v76, v4, 0
    v_add_f32_dpp v18, v18, v18 row_half_mirror row_mask:0xf bank_mask:0xf
    v_add_f32_dpp v19, v19, v19 row_half_mirror row_mask:0xf bank_mask:0xf
    v_dot2c_f32_bf16 v8, v65, v5
    v_dot2c_f32_bf16 v9, v69, v5
    v_dot2c_f32_bf16 v10, v73, v5
    v_dot2c_f32_bf16 v11, v77, v5
    v_add_f32_dpp v18, v18, v18 quad_perm:[1,0,3,2] row_mask:0xf bank_mask:0xf
    v_add_f32_dpp v19, v19, v19 quad_perm:[1,0,3,2] row_mask:0xf bank_mask:0xf
    v_dot2c_f32_bf16 v8, v66, v6
    v_dot2c_f32_bf16 v9, v70, v6
    v_dot2c_f32_bf16 v10, v74, v6
    v_dot2c_f32_bf16 v11, v78, v6
    v_add_f32_dpp v18, v18, v18 quad_perm:[2,3,0,1] row_mask:0xf bank_mask:0xf
    v_add_f32_dpp v19, v19, v19 quad_perm:[2,3,0,1] row_mask:0xf bank_mask:0xf
    v_dot2c_f32_bf16 v8, v67, v7
    v_dot2c_f32_bf16 v9, v71, v7
    v_dot2c_f32_bf16 v10, v75, v7
    v_dot2c_f32_bf16 v11, v79, v7
    v_add_f32_dpp v20, v8, v8 row_ror:8 row_mask:0xf bank_mask:0x3
    v_add_f32_dpp v20, v9, v9 row_ror:8 row_mask:0xf bank_mask:0xc
    v_add_f32_dpp v21, v10, v10 row_ror:8 row_mask:0xf bank_mask:0x3
    v_add_f32_dpp v21, v11, v11 row_ror:8 row_mask:0xf bank_mask:0xc
    v_dot2_f32_bf16 v8, v80, v4, 0
    v_dot2_f32_bf16 v9, v84, v4, 0
    v_dot2_f32_bf16 v10, v88, v4, 0
    v_dot2_f32_bf16 v11, v92, v4, 0
    v_add_f32_dpp v20, v20, v20 row_half_mirror row_mask:0xf bank_mask:0xf
    v_add_f32_dpp v21, v21, v21 row_half_mirror row_mask:0xf bank_mask:0xf
    v_dot2c_f32_bf16 v8, v81, v5
    v_dot2c_f32_bf16 v9, v85, v5
    v_dot2c_f32_bf16 v10, v89, v5
    v_dot2c_f32_bf16 v11, v93, v5
    s_waitcnt vmcnt(3)
    s_cmp_ge_u32 s48, 29
    s_cbranch_scc1 L_bo77
    s_waitcnt vmcnt(2)
L_bo77:
    buffer_load_dwordx4 v[252:255], v1, s[40:43], s49 offen offset:3072 nt
    v_add_f32_dpp v20, v20, v20 quad_perm:[1,0,3,2] row_mask:0xf bank_mask:0xf
    v_add_f32_dpp v21, v21, v21 quad_perm:[1,0,3,2] row_mask:0xf bank_mask:0xf
    v_dot2c_f32_bf16 v8, v82, v6
    v_dot2c_f32_bf16 v9, v86, v6
    v_dot2c_f32_bf16 v10, v90, v6
    v_dot2c_f32_bf16 v11, v94, v6
    v_add_f32_dpp v20, v20, v20 quad_perm:[2,3,0,1] row_mask:0xf bank_mask:0xf
    v_add_f32_dpp v21, v21, v21 quad_perm:[2,3,0,1] row_mask:0xf bank_mask:0xf
    v_dot2c_f32_bf16 v8, v83, v7
    v_dot2c_f32_bf16 v9, v87, v7
    v_dot2c_f32_bf16 v10, v91, v7
    v_dot2c_f32_bf16 v11, v95, v7
    v_add_f32_dpp v22, v8, v8 row_ror:8 row_mask:0xf bank_mask:0x3
    v_add_f32_dpp v22, v9, v9 row_ror:8 row_mask:0xf bank_mask:0xc
    v_add_f32_dpp v23, v10, v10 row_ror:8 row_mask:0xf bank_mask:0x3
    v_add_f32_dpp v23, v11, v11 row_ror:8 row_mask:0xf bank_mask:0xc
    v_dot2_f32_bf16 v8, v96, v4, 0
    v_dot2_f32_bf16 v9, v100, v4, 0
    v_dot2_f32_bf16 v10, v104, v4, 0
    v_dot2_f32_bf16 v11, v108, v4, 0
    v_add_f32_dpp v22, v22, v22 row_half_mirror row_mask:0xf bank_mask:0xf
    v_add_f32_dpp v23, v23, v23 row_half_mirror row_mask:0xf bank_mask:0xf
    v_dot2c_f32_bf16 v8, v97, v5
    v_dot2c_f32_bf16 v9, v101, v5
    v_dot2c_f32_bf16 v10, v105, v5
    v_dot2c_f32_bf16 v11, v109, v5
    v_add_f32_dpp v22, v22, v22 quad_perm:[1,0,3,2] row_mask:0xf bank_mask:0xf
    v_add_f32_dpp v23, v23, v23 quad_perm:[1,0,3,2] row_mask:0xf bank_mask:0xf
    v_dot2c_f32_bf16 v8, v98, v6
    v_dot2c_f32_bf16 v9, v102, v6
    v_dot2c_f32_bf16 v10, v106, v6
    v_dot2c_f32_bf16 v11, v110, v6
    v_add_f32_dpp v22, v22, v22 quad_perm:[2,3,0,1] row_mask:0xf bank_mask:0xf
    v_add_f32_dpp v23, v23, v23 quad_perm:[2,3,0,1] row_mask:0xf bank_mask:0xf
    v_dot2c_f32_bf16 v8, v99, v7
    v_dot2c_f32_bf16 v9, v103, v7
    s_waitcnt vmcnt(3)
    s_cmp_ge_u32 s48, 29
    s_cbranch_scc1 L_bo78
    s_waitcnt vmcnt(2)
L_bo78:
    s_mov_b32 s49, 172032
    buffer_load_dwordx4 v[32:35], v1, s[40:43], s49 offen offset:0 nt
    v_dot2c_f32_bf16 v10, v107, v7
    v_dot2c_f32_bf16 v11, v111, v7
    v_add_f32_dpp v24, v8, v8 row_ror:8 row_mask:0xf bank_mask:0x3
    v_add_f32_dpp v24, v9, v9 row_ror:8 row_mask:0xf bank_mask:0xc
    v_add_f32_dpp v25, v10, v10 row_ror:8 row_mask:0xf bank_mask:0x3
    v_add_f32_dpp v25, v11, v11 row_ror:8 row_mask:0xf bank_mask:0xc
    v_dot2_f32_bf16 v8, v112, v4, 0
    v_dot2_f32_bf16 v9, v116, v4, 0
    v_dot2_f32_bf16 v10, v120, v4, 0
    v_dot2_f32_bf16 v11, v124, v4, 0
    v_add_f32_dpp v24, v24, v24 row_half_mirror row_mask:0xf bank_mask:0xf
    v_add_f32_dpp v25, v25, v25 row_half_mirror row_mask:0xf bank_mask:0xf
    v_dot2c_f32_bf16 v8, v113, v5
    v_dot2c_f32_bf16 v9, v117, v5
    v_dot2c_f32_bf16 v10, v121, v5
    v_dot2c_f32_bf16 v11, v125, v5
    v_add_f32_dpp v24, v24, v24 quad_perm:[1,0,3,2] row_mask:0xf bank_mask:0xf
    v_add_f32_dpp v25, v25, v25 quad_perm:[1,0,3,2] row_mask:0xf bank_mask:0xf
    v_dot2c_f32_bf16 v8, v114, v6
    v_dot2c_f32_bf16 v9, v118, v6
    v_dot2c_f32_bf16 v10, v122, v6
    v_dot2c_f32_bf16 v11, v126, v6
    v_add_f32_dpp v24, v24, v24 quad_perm:[2,3,0,1] row_mask:0xf bank_mask:0xf
    v_add_f32_dpp v25, v25, v25 quad_perm:[2,3,0,1] row_mask:0xf bank_mask:0xf
    v_dot2c_f32_bf16 v8, v115, v7
    v_dot2c_f32_bf16 v9, v119, v7
    v_dot2c_f32_bf16 v10, v123, v7
    v_dot2c_f32_bf16 v11, v127, v7
    v_add_f32_dpp v26, v8, v8 row_ror:8 row_mask:0xf bank_mask:0x3
    v_add_f32_dpp v26, v9, v9 row_ror:8 row_mask:0xf bank_mask:0xc
    v_add_f32_dpp v27, v10, v10 row_ror:8 row_mask:0xf bank_mask:0x3
    v_add_f32_dpp v27, v11, v11 row_ror:8 row_mask:0xf bank_mask:0xc
    v_dot2_f32_bf16 v8, v128, v4, 0
    v_dot2_f32_bf16 v9, v132, v4, 0
    v_dot2_f32_bf16 v10, v136, v4, 0
    v_dot2_f32_bf16 v11, v140, v4, 0
    v_mov_b32 v3, 99076
    ds_read_b32 v3, v3
    s_waitcnt vmcnt(3)
    s_cmp_ge_u32 s48, 30
    s_cbranch_scc1 L_bo79
    s_waitcnt vmcnt(2)
L_bo79:
    s_waitcnt lgkmcnt(0)
    v_readfirstlane_b32 s48, v3
    buffer_load_dwordx4 v[36:39], v1, s[40:43], s49 offen offset:1024 nt
    v_add_f32_dpp v26, v26, v26 row_half_mirror row_mask:0xf bank_mask:0xf
    v_add_f32_dpp v27, v27, v27 row_half_mirror row_mask:0xf bank_mask:0xf
    v_dot2c_f32_bf16 v8, v129, v5
    v_dot2c_f32_bf16 v9, v133, v5
    v_dot2c_f32_bf16 v10, v137, v5
    v_dot2c_f32_bf16 v11, v141, v5
    v_add_f32_dpp v26, v26, v26 quad_perm:[1,0,3,2] row_mask:0xf bank_mask:0xf
    v_add_f32_dpp v27, v27, v27 quad_perm:[1,0,3,2] row_mask:0xf bank_mask:0xf
    v_dot2c_f32_bf16 v8, v130, v6
    v_dot2c_f32_bf16 v9, v134, v6
    v_dot2c_f32_bf16 v10, v138, v6
    v_dot2c_f32_bf16 v11, v142, v6
    v_add_f32_dpp v26, v26, v26 quad_perm:[2,3,0,1] row_mask:0xf bank_mask:0xf
    v_add_f32_dpp v27, v27, v27 quad_perm:[2,3,0,1] row_mask:0xf bank_mask:0xf
    v_dot2c_f32_bf16 v8, v131, v7
    v_dot2c_f32_bf16 v9, v135, v7
    v_dot2c_f32_bf16 v10, v139, v7
    v_dot2c_f32_bf16 v11, v143, v7
    v_add_f32_dpp v28, v8, v8 row_ror:8 row_mask:0xf bank_mask:0x3
    v_add_f32_dpp v28, v9, v9 row_ror:8 row_mask:0xf bank_mask:0xc
    v_add_f32_dpp v29, v10, v10 row_ror:8 row_mask:0xf bank_mask:0x3
    v_add_f32_dpp v29, v11, v11 row_ror:8 row_mask:0xf bank_mask:0xc
    v_dot2_f32_bf16 v8, v144, v4, 0
    v_dot2_f32_bf16 v9, v148, v4, 0
    v_dot2_f32_bf16 v10, v152, v4, 0
    v_dot2_f32_bf16 v11, v156, v4, 0
    v_add_f32_dpp v28, v28, v28 row_half_mirror row_mask:0xf bank_mask:0xf
    v_add_f32_dpp v29, v29, v29 row_half_mirror row_mask:0xf bank_mask:0xf
    v_dot2c_f32_bf16 v8, v145, v5
    v_dot2c_f32_bf16 v9, v149, v5
    v_dot2c_f32_bf16 v10, v153, v5
    v_dot2c_f32_bf16 v11, v157, v5
    v_add_f32_dpp v28, v28, v28 quad_perm:[1,0,3,2] row_mask:0xf bank_mask:0xf
    v_add_f32_dpp v29, v29, v29 quad_perm:[1,0,3,2] row_mask:0xf bank_mask:0xf
    v_dot2c_f32_bf16 v8, v146, v6
    v_dot2c_f32_bf16 v9, v150, v6
    s_waitcnt vmcnt(3)
    s_cmp_ge_u32 s48, 19
    s_cbranch_scc1 L_bo80
    s_waitcnt vmcnt(2)
L_bo80:
    buffer_load_dwordx4 v[40:43], v1, s[40:43], s49 offen offset:2048 nt
    v_dot2c_f32_bf16 v10, v154, v6
    v_dot2c_f32_bf16 v11, v158, v6
    v_add_f32_dpp v28, v28, v28 quad_perm:[2,3,0,1] row_mask:0xf bank_mask:0xf
    v_add_f32_dpp v29, v29, v29 quad_perm:[2,3,0,1] row_mask:0xf bank_mask:0xf
    v_dot2c_f32_bf16 v8, v147, v7
    v_dot2c_f32_bf16 v9, v151, v7
    v_dot2c_f32_bf16 v10, v155, v7
    v_dot2c_f32_bf16 v11, v159, v7
    v_add_f32_dpp v30, v8, v8 row_ror:8 row_mask:0xf bank_mask:0x3
    v_add_f32_dpp v30, v9, v9 row_ror:8 row_mask:0xf bank_mask:0xc
    v_add_f32_dpp v31, v10, v10 row_ror:8 row_mask:0xf bank_mask:0x3
    v_add_f32_dpp v31, v11, v11 row_ror:8 row_mask:0xf bank_mask:0xc
    v_add_f32_dpp v30, v30, v30 row_half_mirror row_mask:0xf bank_mask:0xf
    s_nop 0
    v_add_f32_dpp v31, v31, v31 row_half_mirror row_mask:0xf bank_mask:0xf
    v_add_f32_dpp v30, v30, v30 quad_perm:[1,0,3,2] row_mask:0xf bank_mask:0xf
    s_nop 0
    v_add_f32_dpp v31, v31, v31 quad_perm:[1,0,3,2] row_mask:0xf bank_mask:0xf
    v_add_f32_dpp v30, v30, v30 quad_perm:[2,3,0,1] row_mask:0xf bank_mask:0xf
    s_nop 0
    v_add_f32_dpp v31, v31, v31 quad_perm:[2,3,0,1] row_mask:0xf bank_mask:0xf
    v_max3_f32 v8, v12, v13, v16
    v_max3_f32 v8, v8, v17, v18
    v_max3_f32 v8, v8, v19, v20
    v_max3_f32 v8, v8, v21, v22
    v_max3_f32 v8, v8, v23, v24
    v_max3_f32 v8, v8, v25, v26
    v_max3_f32 v8, v8, v27, v28
    v_max3_f32 v8, v8, v29, v30
    v_max_f32 v8, v8, v31
    s_mov_b32 s34, 0x3e0293ee
    s_nop 0
    v_max_f32_dpp v8, v8, v8 row_ror:8 row_mask:0xf bank_mask:0xf
    v_mov_b32 v9, v8
    s_nop 1
    v_permlane16_swap_b32 v8, v9
    v_max_f32 v8, v8, v9
    v_mov_b32 v9, v8
    s_nop 1
    v_permlane32_swap_b32 v8, v9
    v_max_f32 v8, v8, v9
    v_mul_f32 v8, s34, v8
    s_waitcnt vmcnt(3)
    s_cmp_ge_u32 s48, 20
    s_cbranch_scc1 L_bo81
    s_waitcnt vmcnt(2)
L_bo81:
    buffer_load_dwordx4 v[44:47], v1, s[40:43], s49 offen offset:3072 nt
    v_fma_f32 v12, v12, s34, -v8
    v_fma_f32 v13, v13, s34, -v8
    v_fma_f32 v16, v16, s34, -v8
    v_fma_f32 v17, v17, s34, -v8
    v_fma_f32 v18, v18, s34, -v8
    v_fma_f32 v19, v19, s34, -v8
    v_fma_f32 v20, v20, s34, -v8
    v_fma_f32 v21, v21, s34, -v8
    v_fma_f32 v22, v22, s34, -v8
    v_fma_f32 v23, v23, s34, -v8
    v_fma_f32 v24, v24, s34, -v8
    v_fma_f32 v25, v25, s34, -v8
    v_fma_f32 v26, v26, s34, -v8
    v_fma_f32 v27, v27, s34, -v8
    v_fma_f32 v28, v28, s34, -v8
    v_fma_f32 v29, v29, s34, -v8
    v_fma_f32 v30, v30, s34, -v8
    v_fma_f32 v31, v31, s34, -v8
    v_exp_f32 v12, v12
    v_exp_f32 v13, v13
    v_exp_f32 v16, v16
    v_exp_f32 v17, v17
    v_exp_f32 v18, v18
    v_exp_f32 v19, v19
    v_exp_f32 v20, v20
    v_exp_f32 v21, v21
    v_exp_f32 v22, v22
    v_exp_f32 v23, v23
    v_exp_f32 v24, v24
    v_exp_f32 v25, v25
    v_exp_f32 v26, v26
    v_exp_f32 v27, v27
    v_exp_f32 v28, v28
    v_exp_f32 v29, v29
    v_exp_f32 v30, v30
    v_exp_f32 v31, v31
    s_waitcnt vmcnt(3)
    s_cmp_ge_u32 s48, 21
    s_cbranch_scc1 L_bo82
    s_waitcnt vmcnt(2)
L_bo82:
    s_mov_b32 s49, 200704
    buffer_load_dwordx4 v[48:51], v1, s[40:43], s49 offen offset:0 nt
    v_add_f32 v9, v12, v13
    v_add_f32 v9, v9, v16
    v_add_f32 v9, v9, v17
    v_add_f32 v9, v9, v18
    v_add_f32 v9, v9, v19
    v_add_f32 v9, v9, v20
    v_add_f32 v9, v9, v21
    v_add_f32 v9, v9, v22
    v_add_f32 v9, v9, v23
    v_add_f32 v9, v9, v24
    v_add_f32 v9, v9, v25
    v_add_f32 v9, v9, v26
    v_add_f32 v9, v9, v27
    v_add_f32 v9, v9, v28
    v_add_f32 v9, v9, v29
    v_add_f32 v9, v9, v30
    v_add_f32 v9, v9, v31
    v_and_b32 v10, 1, v0
    v_lshlrev_b32 v10, 4, v10
    v_mov_b32 v11, 0xffff
    v_lshlrev_b32 v10, v10, v11
    v_bfe_u32 v11, v0, 1, 2
    v_cmp_eq_u32 vcc, 0, v11
    s_nop 1
    v_cndmask_b32 v144, 0, v10, vcc
    v_cmp_eq_u32 vcc, 1, v11
    s_nop 1
    v_cndmask_b32 v145, 0, v10, vcc
    v_cmp_eq_u32 vcc, 2, v11
    s_nop 1
    v_cndmask_b32 v146, 0, v10, vcc
    v_cmp_eq_u32 vcc, 3, v11
    s_nop 1
    v_cndmask_b32 v147, 0, v10, vcc
    v_add_f32_dpp v9, v9, v9 row_ror:8 row_mask:0xf bank_mask:0xf
    v_mov_b32 v10, v9
    s_nop 1
    v_permlane16_swap_b32 v9, v10
    v_add_f32 v9, v9, v10
    v_mov_b32 v10, v9
    s_nop 1
    v_permlane32_swap_b32 v9, v10
    s_waitcnt vmcnt(3)
    s_cmp_ge_u32 s48, 23
    s_cbranch_scc1 L_bo83
    s_waitcnt vmcnt(2)
L_bo83:
    buffer_load_dwordx4 v[52:55], v1, s[40:43], s49 offen offset:1024 nt
    v_add_f32 v9, v9, v10
    s_lshl_b32 s34, s3, 3
    s_add_u32 s34, s34, 98552
    v_mov_b32 v10, s34
    s_mov_b64 exec, 1
    ds_write_b64 v10, v[8:9]
    s_mov_b64 exec, -1
    s_lshl_b32 s34, s3, 10
    s_add_u32 s34, s34, 98304
    v_lshrrev_b32 v2, 4, v0
    v_and_b32 v11, 7, v0
    v_lshl_add_u32 v2, v2, 3, v11
    v_bfe_u32 v11, v0, 3, 1
    v_lshl_add_u32 v2, v11, 5, v2
    v_lshl_add_u32 v2, v2, 4, s34
    v_cvt_pk_bf16_f32 v10, v12, v12
    v_and_b32 v128, v10, v144
    v_and_b32 v129, v10, v145
    v_and_b32 v130, v10, v146
    v_and_b32 v131, v10, v147
    s_nop 1
    v_mfma_f32_16x16x32_bf16 v[148:151], v[160:163], v[128:131], 0
    v_mfma_f32_16x16x32_bf16 v[152:155], v[164:167], v[128:131], 0
    v_cvt_pk_bf16_f32 v10, v13, v13
    v_and_b32 v132, v10, v144
    v_and_b32 v133, v10, v145
    v_and_b32 v134, v10, v146
    v_and_b32 v135, v10, v147
    s_nop 1
    v_mfma_f32_16x16x32_bf16 v[148:151], v[168:171], v[132:135], v[148:151]
    v_mfma_f32_16x16x32_bf16 v[152:155], v[172:175], v[132:135], v[152:155]
    v_cvt_pk_bf16_f32 v10, v16, v16
    v_and_b32 v128, v10, v144
    v_and_b32 v129, v10, v145
    v_and_b32 v130, v10, v146
    v_and_b32 v131, v10, v147
    s_nop 1
    v_mfma_f32_16x16x32_bf16 v[148:151], v[176:179], v[128:131], v[148:151]
    v_mfma_f32_16x16x32_bf16 v[152:155], v[180:183], v[128:131], v[152:155]
    v_cvt_pk_bf16_f32 v10, v17, v17
    v_and_b32 v132, v10, v144
    s_cmp_ge_u32 s48, 24
    s_cbranch_scc1 L_bo84
    s_waitcnt vmcnt(3)
L_bo84:
    buffer_load_dwordx4 v[56:59], v1, s[40:43], s49 offen offset:2048 nt
    v_and_b32 v133, v10, v145
    v_and_b32 v134, v10, v146
    v_and_b32 v135, v10, v147
    s_nop 1
    v_mfma_f32_16x16x32_bf16 v[148:151], v[184:187], v[132:135], v[148:151]
    v_mfma_f32_16x16x32_bf16 v[152:155], v[188:191], v[132:135], v[152:155]
    v_cvt_pk_bf16_f32 v10, v18, v18
    v_and_b32 v128, v10, v144
    v_and_b32 v129, v10, v145
    v_and_b32 v130, v10, v146
    v_and_b32 v131, v10, v147
    s_nop 1
    v_mfma_f32_16x16x32_bf16 v[148:151], v[192:195], v[128:131], v[148:151]
    v_mfma_f32_16x16x32_bf16 v[152:155], v[196:199], v[128:131], v[152:155]
    v_cvt_pk_bf16_f32 v10, v19, v19
    v_and_b32 v132, v10, v144
    v_and_b32 v133, v10, v145
    v_and_b32 v134, v10, v146
    v_and_b32 v135, v10, v147
    s_nop 1
    v_mfma_f32_16x16x32_bf16 v[148:151], v[200:203], v[132:135], v[148:151]
    v_mfma_f32_16x16x32_bf16 v[152:155], v[204:207], v[132:135], v[152:155]
    v_cvt_pk_bf16_f32 v10, v20, v20
    v_and_b32 v128, v10, v144
    v_and_b32 v129, v10, v145
    v_and_b32 v130, v10, v146
    v_and_b32 v131, v10, v147
    s_nop 1
    v_mfma_f32_16x16x32_bf16 v[148:151], v[208:211], v[128:131], v[148:151]
    v_mfma_f32_16x16x32_bf16 v[152:155], v[212:215], v[128:131], v[152:155]
    v_cvt_pk_bf16_f32 v10, v21, v21
    v_and_b32 v132, v10, v144
    v_and_b32 v133, v10, v145
    v_and_b32 v134, v10, v146
    v_and_b32 v135, v10, v147
    s_nop 1
    v_mfma_f32_16x16x32_bf16 v[148:151], v[216:219], v[132:135], v[148:151]
    v_mfma_f32_16x16x32_bf16 v[152:155], v[220:223], v[132:135], v[152:155]
    v_cvt_pk_bf16_f32 v10, v22, v22
    v_and_b32 v128, v10, v144
    v_and_b32 v129, v10, v145
    s_waitcnt vmcnt(4)
    s_cmp_ge_u32 s48, 25
    s_cbranch_scc1 L_bo85
    s_waitcnt vmcnt(3)
L_bo85:
    buffer_load_dwordx4 v[60:63], v1, s[40:43], s49 offen offset:3072 nt
    v_and_b32 v130, v10, v146
    v_and_b32 v131, v10, v147
    s_nop 1
    v_mfma_f32_16x16x32_bf16 v[148:151], v[224:227], v[128:131], v[148:151]
    v_mfma_f32_16x16x32_bf16 v[152:155], v[228:231], v[128:131], v[152:155]
    v_cvt_pk_bf16_f32 v10, v23, v23
    v_and_b32 v132, v10, v144
    v_and_b32 v133, v10, v145
    v_and_b32 v134, v10, v146
    v_and_b32 v135, v10, v147
    s_nop 1
    v_mfma_f32_16x16x32_bf16 v[148:151], v[232:235], v[132:135], v[148:151]
    v_mfma_f32_16x16x32_bf16 v[152:155], v[236:239], v[132:135], v[152:155]
    v_cvt_pk_bf16_f32 v10, v24, v24
    v_and_b32 v128, v10, v144
    v_and_b32 v129, v10, v145
    v_and_b32 v130, v10, v146
    v_and_b32 v131, v10, v147
    s_nop 1
    v_mfma_f32_16x16x32_bf16 v[148:151], v[240:243], v[128:131], v[148:151]
    v_mfma_f32_16x16x32_bf16 v[152:155], v[244:247], v[128:131], v[152:155]
    v_cvt_pk_bf16_f32 v10, v25, v25
    v_and_b32 v132, v10, v144
    v_and_b32 v133, v10, v145
    v_and_b32 v134, v10, v146
    v_and_b32 v135, v10, v147
    s_nop 1
    v_mfma_f32_16x16x32_bf16 v[148:151], v[248:251], v[132:135], v[148:151]
    v_mfma_f32_16x16x32_bf16 v[152:155], v[252:255], v[132:135], v[152:155]
    v_cvt_pk_bf16_f32 v10, v26, v26
    v_and_b32 v128, v10, v144
    v_and_b32 v129, v10, v145
    v_and_b32 v130, v10, v146
    v_and_b32 v131, v10, v147
    s_nop 1
    v_mfma_f32_16x16x32_bf16 v[148:151], v[32:35], v[128:131], v[148:151]
    v_mfma_f32_16x16x32_bf16 v[152:155], v[36:39], v[128:131], v[152:155]
    v_cvt_pk_bf16_f32 v10, v27, v27
    v_and_b32 v132, v10, v144
    v_and_b32 v133, v10, v145
    v_and_b32 v134, v10, v146
    s_waitcnt vmcnt(4)
    s_cmp_ge_u32 s48, 26
    s_cbranch_scc1 L_bo86
    s_waitcnt vmcnt(3)
L_bo86:
    s_mov_b32 s49, 229376
    buffer_load_dwordx4 v[64:67], v1, s[40:43], s49 offen offset:0 nt
    v_and_b32 v135, v10, v147
    s_nop 1
    v_mfma_f32_16x16x32_bf16 v[148:151], v[40:43], v[132:135], v[148:151]
    v_mfma_f32_16x16x32_bf16 v[152:155], v[44:47], v[132:135], v[152:155]
    v_cvt_pk_bf16_f32 v10, v28, v28
    v_and_b32 v128, v10, v144
    v_and_b32 v129, v10, v145
    v_and_b32 v130, v10, v146
    v_and_b32 v131, v10, v147
    s_waitcnt vmcnt(4)
    s_cmp_ge_u32 s48, 27
    s_cbranch_scc1 L_bo87
    s_waitcnt vmcnt(3)
L_bo87:
    buffer_load_dwordx4 v[68:71], v1, s[40:43], s49 offen offset:1024 nt
    buffer_load_dwordx4 v[72:75], v1, s[40:43], s49 offen offset:2048 nt
    s_waitcnt vmcnt(5)
    buffer_load_dwordx4 v[76:79], v1, s[40:43], s49 offen offset:3072 nt
    s_barrier
    v_and_b32 v200, 3, v0
    v_bfe_u32 v201, v0, 2, 2
    v_lshrrev_b32 v202, 4, v0
    s_lshl_b32 s34, s3, 10
    s_add_u32 s34, s34, 122112
    v_mul_u32_u24 v203, 320, v201
    v_min_u32 v203, 704, v203
    v_lshl_add_u32 v203, v202, 6, v203
    v_lshl_add_u32 v203, v200, 4, v203
    v_add_u32 v203, s34, v203
    s_movk_i32 s48, 16384
    s_cmp_eq_u32 s63, 0
    s_cbranch_scc1 L_tp_wo
    s_cmp_eq_u32 s63, 1
    s_cbranch_scc1 L_tp_w1
    v_bfe_u32 v205, v0, 3, 2
    v_lshlrev_b32 v204, 3, v205
    v_lshrrev_b32 v205, 5, v0
    v_lshl_add_u32 v204, v205, 2, v204
    v_bfe_u32 v205, v0, 1, 2
    v_add_u32 v204, v204, v205
    v_and_b32 v205, 1, v0
    s_sub_u32 s49, s3, 1
    v_mul_u32_u24 v204, 1280, v204
    v_lshl_add_u32 v204, v205, 4, v204
    s_lshl_b32 s34, s62, 5
    s_mul_i32 s35, s49, 327680
    s_add_u32 s34, s34, s35
    v_add_u32 v204, s34, v204
    s_lshl_b32 s50, s49, 13
    s_add_u32 s50, s50, 40960
    v_lshl_add_u32 v205, v0, 3, s50
    s_lshl_b32 s34, s49, 8
    s_add_u32 s34, s34, s99
    s_add_u32 s34, s34, 791552
    s_cmp_eq_u32 s49, 6
    s_cselect_b32 s35, 1, 3
    v_lshlrev_b32 v6, 6, v202
    v_lshl_add_u32 v6, v200, 4, v6
    v_add_u32 v6, s34, v6
    v_lshl_add_u32 v4, v201, 15, v6
    v_min_u32 v5, s35, v201
    v_lshl_add_u32 v5, v5, 15, v6
    v_mov_b32 v7, 99084
    s_lshl_b32 s40, s62, 1
    s_add_u32 s41, s40, 8
    s_add_u32 s42, s40, 2
    s_branch L_tp_e
L_tp_w1:
    v_and_b32 v205, 15, v0
    v_lshlrev_b32 v205, 4, v205
    s_and_b32 s49, s3, 3
    s_mul_i32 s34, s49, 1280
    s_add_u32 s34, s34, s99
    s_add_u32 s34, s34, 786432
    v_lshl_add_u32 v206, v202, 15, v205
    v_add_u32 v206, s34, v206
    s_mul_i32 s34, s49, 3840
    v_add_u32 v205, s34, v205
    s_branch L_tp_e
L_tp_wo:
    s_lshr_b32 s49, s3, 1
    s_lshl_b32 s49, s49, 15
    v_and_b32 v210, 7, v0
    s_mul_i32 s34, s60, 4096
    s_add_u32 s34, s34, s49
    s_add_u32 s34, s34, 1179904
    v_lshrrev_b32 v211, 3, v0
    v_mul_u32_u24 v205, 512, v211
    v_add_u32 v204, s34, v205
    s_lshl_b32 s35, s51, 7
    s_add_u32 s34, s34, s35
    s_sub_u32 s34, s34, 256
    v_lshl_add_u32 v205, v210, 4, v205
    v_add_u32 v205, s34, v205
    s_lshl_b32 s34, s3, 12
    s_add_u32 s34, s34, 40960
    v_lshrrev_b32 v206, 2, v0
    v_lshlrev_b32 v206, 6, v206
    v_lshl_add_u32 v206, v200, 3, v206
    v_add_u32 v206, s34, v206
    s_mul_i32 s34, s3, 1152
    s_add_u32 s34, s34, 107520
    v_mul_u32_u24 v207, 144, v211
    v_lshl_add_u32 v207, v210, 4, v207
    v_add_u32 v207, s34, v207
    v_mul_u32_u24 v208, 144, v210
    v_lshl_add_u32 v208, v202, 4, v208
    v_add_u32 v208, s34, v208
    v_mul_u32_u24 v212, 144, v211
    v_add_u32 v212, s34, v212
    v_mul_u32_u24 v213, 144, v210
    v_add_u32 v213, s34, v213
    v_and_b32 v211, 1, v211
    v_bfe_u32 v203, v0, 1, 2
    v_mul_u32_u24 v203, 144, v203
    v_and_b32 v214, 1, v0
    v_mul_u32_u24 v214, 576, v214
    v_lshl_add_u32 v214, v211, 6, v214
    v_lshl_add_u32 v214, v202, 4, v214
    s_add_u32 s34, s34, 14592
    v_add3_u32 v203, v203, v214, s34
    v_mov_b32 v210, 98816
    v_cmp_eq_u32 vcc, 0, v211
    s_nop 1
    v_cndmask_b32 v209, v208, v210, vcc
    v_cndmask_b32 v208, v210, v208, vcc
L_tp_e:
    v_mfma_f32_16x16x32_bf16 v[148:151], v[48:51], v[128:131], v[148:151]
    v_mfma_f32_16x16x32_bf16 v[152:155], v[52:55], v[128:131], v[152:155]
    v_cvt_pk_bf16_f32 v10, v29, v29
    v_and_b32 v132, v10, v144
    v_and_b32 v133, v10, v145
    v_and_b32 v134, v10, v146
    v_and_b32 v135, v10, v147
    s_waitcnt vmcnt(4)
    s_nop 0
    v_mfma_f32_16x16x32_bf16 v[148:151], v[56:59], v[132:135], v[148:151]
    v_mfma_f32_16x16x32_bf16 v[152:155], v[60:63], v[132:135], v[152:155]
    v_cvt_pk_bf16_f32 v10, v30, v30
    v_and_b32 v128, v10, v144
    v_and_b32 v129, v10, v145
    v_and_b32 v130, v10, v146
    v_and_b32 v131, v10, v147
    s_waitcnt vmcnt(2)
    s_nop 0
    v_mfma_f32_16x16x32_bf16 v[148:151], v[64:67], v[128:131], v[148:151]
    v_mfma_f32_16x16x32_bf16 v[152:155], v[68:71], v[128:131], v[152:155]
    v_cvt_pk_bf16_f32 v10, v31, v31
    v_and_b32 v132, v10, v144
    v_and_b32 v133, v10, v145
    v_and_b32 v134, v10, v146
    v_and_b32 v135, v10, v147
    s_waitcnt vmcnt(0)
    s_nop 0
    v_mfma_f32_16x16x32_bf16 v[148:151], v[72:75], v[132:135], v[148:151]
    v_mfma_f32_16x16x32_bf16 v[152:155], v[76:79], v[132:135], v[152:155]
    s_nop 7
    v_add_f32_dpp v148, v152, v148 row_ror:8 row_mask:0xf bank_mask:0xf
    v_add_f32_dpp v149, v153, v149 row_ror:8 row_mask:0xf bank_mask:0xf
    v_add_f32_dpp v150, v154, v150 row_ror:8 row_mask:0xf bank_mask:0xf
    v_add_f32_dpp v151, v155, v151 row_ror:8 row_mask:0xf bank_mask:0xf
    ds_write_b128 v2, v[148:151]
    s_waitcnt lgkmcnt(0)
    s_barrier
    s_cmp_eq_u32 s63, 0
    s_cbranch_scc1 L_t_wo
    s_cmp_eq_u32 s63, 2
    s_cbranch_scc1 L_t_w2
    s_cmp_eq_u32 s63, 3
    s_cbranch_scc1 L_fin
    s_barrier
L_r_w1:
    s_cmp_lt_u32 s3, 4
    s_cbranch_scc1 L_w1_ln
    s_and_b32 s49, s3, 3
    s_lshl_b32 s42, s49, 11
    s_add_u32 s42, s42, 40960
    s_bitcmp1_b32 s62, 0
    s_cbranch_scc1 L_rot1
    s_add_u32 m0, s42, 0
    s_add_u32 s34, s50, 0
    buffer_load_dwordx4 v15, s[52:55], s34 offen  lds
    s_add_u32 m0, s42, 1024
    s_add_u32 s34, s50, 884736
    buffer_load_dwordx4 v15, s[52:55], s34 offen  lds
    s_add_u32 m0, s42, 8192
    s_add_u32 s34, s50, 110592
    buffer_load_dwordx4 v15, s[52:55], s34 offen  lds
    s_add_u32 m0, s42, 9216
    s_add_u32 s34, s50, 995328
    buffer_load_dwordx4 v15, s[52:55], s34 offen  lds
    s_add_u32 m0, s42, 32768
    s_add_u32 s34, s51, 0
    buffer_load_dwordx4 v15, s[52:55], s34 offen  lds
    s_add_u32 m0, s42, 33792
    s_add_u32 s34, s51, 13824
    buffer_load_dwordx4 v15, s[52:55], s34 offen  lds
    s_add_u32 m0, s42, 16384
    s_add_u32 s34, s50, 221184
    buffer_load_dwordx4 v15, s[52:55], s34 offen  lds
    s_add_u32 m0, s42, 17408
    s_add_u32 s34, s50, 1105920
    buffer_load_dwordx4 v15, s[52:55], s34 offen  lds
    s_add_u32 m0, s42, 24576
    s_add_u32 s34, s50, 331776
    buffer_load_dwordx4 v15, s[52:55], s34 offen  lds
    s_add_u32 m0, s42, 25600
    s_add_u32 s34, s50, 1216512
    buffer_load_dwordx4 v15, s[52:55], s34 offen  lds
    s_branch L_rot2
L_rot1:
    s_add_u32 m0, s42, 16384
    s_add_u32 s34, s50, 221184
    buffer_load_dwordx4 v15, s[52:55], s34 offen  lds
    s_add_u32 m0, s42, 17408
    s_add_u32 s34, s50, 1105920
    buffer_load_dwordx4 v15, s[52:55], s34 offen  lds
    s_add_u32 m0, s42, 24576
    s_add_u32 s34, s50, 331776
    buffer_load_dwordx4 v15, s[52:55], s34 offen  lds
    s_add_u32 m0, s42, 25600
    s_add_u32 s34, s50, 1216512
    buffer_load_dwordx4 v15, s[52:55], s34 offen  lds
    s_add_u32 m0, s42, 32768
    s_add_u32 s34, s51, 0
    buffer_load_dwordx4 v15, s[52:55], s34 offen  lds
    s_add_u32 m0, s42, 33792
    s_add_u32 s34, s51, 13824
    buffer_load_dwordx4 v15, s[52:55], s34 offen  lds
    s_add_u32 m0, s42, 0
    s_add_u32 s34, s50, 0
    buffer_load_dwordx4 v15, s[52:55], s34 offen  lds
    s_add_u32 m0, s42, 1024
    s_add_u32 s34, s50, 884736
    buffer_load_dwordx4 v15, s[52:55], s34 offen  lds
    s_add_u32 m0, s42, 8192
    s_add_u32 s34, s50, 110592
    buffer_load_dwordx4 v15, s[52:55], s34 offen  lds
    s_add_u32 m0, s42, 9216
    s_add_u32 s34, s50, 995328
    buffer_load_dwordx4 v15, s[52:55], s34 offen  lds
L_rot2:
    v_lshrrev_b32 v3, 2, v0
    v_lshlrev_b32 v3, 6, v3
    v_lshl_add_u32 v3, v200, 3, v3
    v_add_u32 v3, s42, v3
    s_lshl_b32 s35, s49, 6
    s_add_u32 s35, s35, 116736
    v_mul_u32_u24 v4, 1344, v200
    v_lshl_add_u32 v4, v202, 4, v4
    v_add_u32 v4, s35, v4
    s_lshl_b32 s35, s49, 10
    s_sub_u32 s35, s35, 4096
    v_add_u32 v5, s35, v203
    v_and_b32 v6, 1, v201
    v_mul_u32_u24 v6, 5376, v6
    v_add_u32 v6, v6, v4
    v_subrev_u32 v6, 90112, v6
    v_subrev_u32 v7, 22784, v5
    s_waitcnt vmcnt(0)
    s_barrier
    ds_read_b64_tr_b16 v[32:33], v3 offset:0
    ds_read_b64_tr_b16 v[34:35], v3 offset:1024
    ds_read_b64_tr_b16 v[36:37], v3 offset:32
    ds_read_b64_tr_b16 v[38:39], v3 offset:1056
    ds_read_b64_tr_b16 v[40:41], v3 offset:8192
    ds_read_b64_tr_b16 v[42:43], v3 offset:9216
    ds_read_b64_tr_b16 v[44:45], v3 offset:8224
    ds_read_b64_tr_b16 v[46:47], v3 offset:9248
    ds_read_b64_tr_b16 v[48:49], v3 offset:16384
    ds_read_b64_tr_b16 v[50:51], v3 offset:17408
    ds_read_b64_tr_b16 v[52:53], v3 offset:16416
    ds_read_b64_tr_b16 v[54:55], v3 offset:17440
    s_waitcnt lgkmcnt(4)
    ds_read_b64_tr_b16 v[56:57], v3 offset:24576
    ds_read_b64_tr_b16 v[58:59], v3 offset:25600
    ds_read_b64_tr_b16 v[60:61], v3 offset:24608
    ds_read_b64_tr_b16 v[62:63], v3 offset:25632
    ds_read_b64_tr_b16 v[64:65], v3 offset:32768
    ds_read_b64_tr_b16 v[66:67], v3 offset:33792
    ds_read_b64_tr_b16 v[68:69], v3 offset:32800
    ds_read_b64_tr_b16 v[70:71], v3 offset:33824
    s_waitcnt lgkmcnt(0)
    ds_read_b128 v[140:143], v6 offset:0
    ds_read_b128 v[144:147], v6 offset:256
    ds_read_b128 v[148:151], v6 offset:512
    ds_read_b128 v[152:155], v6 offset:768
    ds_read_b128 v[156:159], v6 offset:1024
    s_waitcnt lgkmcnt(4)
    v_mfma_f32_16x16x32_bf16 v[20:23], v[32:35], v[140:143], 0
    v_mfma_f32_16x16x32_bf16 v[24:27], v[36:39], v[140:143], 0
    s_waitcnt lgkmcnt(3)
    v_mfma_f32_16x16x32_bf16 v[20:23], v[40:43], v[144:147], v[20:23]
    v_mfma_f32_16x16x32_bf16 v[24:27], v[44:47], v[144:147], v[24:27]
    s_waitcnt lgkmcnt(2)
    v_mfma_f32_16x16x32_bf16 v[20:23], v[48:51], v[148:151], v[20:23]
    v_mfma_f32_16x16x32_bf16 v[24:27], v[52:55], v[148:151], v[24:27]
    s_waitcnt lgkmcnt(1)
    v_mfma_f32_16x16x32_bf16 v[20:23], v[56:59], v[152:155], v[20:23]
    v_mfma_f32_16x16x32_bf16 v[24:27], v[60:63], v[152:155], v[24:27]
    s_waitcnt lgkmcnt(0)
    v_mfma_f32_16x16x32_bf16 v[20:23], v[64:67], v[156:159], v[20:23]
    v_mfma_f32_16x16x32_bf16 v[24:27], v[68:71], v[156:159], v[24:27]
    s_nop 6
    ds_write_b128 v7, v[20:23]
    ds_write_b128 v7, v[24:27] offset:1024
    s_waitcnt lgkmcnt(0)
    s_setprio 3
    s_barrier
    ds_read_b128 v[140:143], v4 offset:0
    ds_read_b128 v[144:147], v4 offset:256
    ds_read_b128 v[148:151], v4 offset:512
    ds_read_b128 v[152:155], v4 offset:768
    ds_read_b128 v[156:159], v4 offset:1024
    s_waitcnt lgkmcnt(4)
    v_mfma_f32_16x16x32_bf16 v[20:23], v[32:35], v[140:143], 0
    v_mfma_f32_16x16x32_bf16 v[24:27], v[36:39], v[140:143], 0
    s_waitcnt lgkmcnt(3)
    v_mfma_f32_16x16x32_bf16 v[20:23], v[40:43], v[144:147], v[20:23]
    v_mfma_f32_16x16x32_bf16 v[24:27], v[44:47], v[144:147], v[24:27]
    s_waitcnt lgkmcnt(2)
    v_mfma_f32_16x16x32_bf16 v[20:23], v[48:51], v[148:151], v[20:23]
    v_mfma_f32_16x16x32_bf16 v[24:27], v[52:55], v[148:151], v[24:27]
    s_waitcnt lgkmcnt(1)
    v_mfma_f32_16x16x32_bf16 v[20:23], v[56:59], v[152:155], v[20:23]
    v_mfma_f32_16x16x32_bf16 v[24:27], v[60:63], v[152:155], v[24:27]
    s_waitcnt lgkmcnt(0)
    v_mfma_f32_16x16x32_bf16 v[20:23], v[64:67], v[156:159], v[20:23]
    v_mfma_f32_16x16x32_bf16 v[24:27], v[68:71], v[156:159], v[24:27]
    s_nop 6
    ds_write_b128 v5, v[20:23]
    ds_write_b128 v5, v[24:27] offset:1024
    s_waitcnt lgkmcnt(0)
    s_barrier
    s_branch L_fin
L_w1_ln:
    s_setprio 1
    ds_read_b128 v[140:143], v205 offset:0
    ds_read_b128 v[144:147], v205 offset:256
    ds_read_b128 v[148:151], v205 offset:512
    ds_read_b128 v[152:155], v205 offset:768
    ds_read_b128 v[156:159], v205 offset:1024
    ds_read_b128 v[160:163], v205 offset:1280
    ds_read_b128 v[164:167], v205 offset:1536
    ds_read_b128 v[168:171], v205 offset:1792
    ds_read_b128 v[172:175], v205 offset:2048
    ds_read_b128 v[176:179], v205 offset:2304
    ds_read_b128 v[180:183], v205 offset:2560
    ds_read_b128 v[184:187], v205 offset:2816
    ds_read_b128 v[188:191], v205 offset:3072
    ds_read_b128 v[192:195], v205 offset:3328
    ds_read_b128 v[196:199], v205 offset:3584
    v_and_b32 v8, 1, v0
    v_lshlrev_b32 v8, 4, v8
    v_mov_b32 v9, 0xffff
    v_lshlrev_b32 v8, v8, v9
    v_bfe_u32 v9, v0, 1, 2
    v_cmp_eq_u32 vcc, 0, v9
    s_nop 1
    v_cndmask_b32 v16, 0, v8, vcc
    v_cmp_eq_u32 vcc, 1, v9
    s_nop 1
    v_cndmask_b32 v17, 0, v8, vcc
    v_cmp_eq_u32 vcc, 2, v9
    s_nop 1
    v_cndmask_b32 v18, 0, v8, vcc
    v_cmp_eq_u32 vcc, 3, v9
    s_nop 1
    v_cndmask_b32 v19, 0, v8, vcc
    v_bfe_u32 v8, v0, 3, 1
    v_cmp_eq_u32 vcc, 0, v8
    s_nop 1
    v_cndmask_b32 v20, 0, v16, vcc
    v_xor_b32 v24, v20, v16
    v_cndmask_b32 v21, 0, v17, vcc
    v_xor_b32 v25, v21, v17
    v_cndmask_b32 v22, 0, v18, vcc
    v_xor_b32 v26, v22, v18
    v_cndmask_b32 v23, 0, v19, vcc
    v_xor_b32 v27, v23, v19
    v_and_b32 v52, 0x3f803f80, v20
    v_and_b32 v60, 0x3e803e80, v20
    v_and_b32 v53, 0x3f803f80, v21
    v_and_b32 v61, 0x3e803e80, v21
    v_and_b32 v54, 0x3f803f80, v22
    v_and_b32 v62, 0x3e803e80, v22
    v_and_b32 v55, 0x3f803f80, v23
    v_and_b32 v63, 0x3e803e80, v23
    v_and_b32 v56, 0x3f803f80, v24
    v_and_b32 v64, 0x3e803e80, v24
    v_and_b32 v57, 0x3f803f80, v25
    v_and_b32 v65, 0x3e803e80, v25
    v_and_b32 v58, 0x3f803f80, v26
    v_and_b32 v66, 0x3e803e80, v26
    v_and_b32 v59, 0x3f803f80, v27
    v_and_b32 v67, 0x3e803e80, v27
    s_waitcnt lgkmcnt(0)
    v_mfma_f32_16x16x32_bf16 v[68:71], v[140:143], v[60:63], 0
    v_mfma_f32_16x16x32_bf16 v[68:71], v[144:147], v[64:67], v[68:71]
    v_mfma_f32_16x16x32_bf16 v[72:75], v[148:151], v[60:63], 0
    v_mfma_f32_16x16x32_bf16 v[72:75], v[152:155], v[64:67], v[72:75]
    v_mfma_f32_16x16x32_bf16 v[76:79], v[156:159], v[60:63], 0
    v_mfma_f32_16x16x32_bf16 v[116:119], v[160:163], v[60:63], 0
    v_mfma_f32_16x16x32_bf16 v[116:119], v[164:167], v[64:67], v[116:119]
    v_mfma_f32_16x16x32_bf16 v[120:123], v[168:171], v[60:63], 0
    v_mfma_f32_16x16x32_bf16 v[120:123], v[172:175], v[64:67], v[120:123]
    v_mfma_f32_16x16x32_bf16 v[124:127], v[176:179], v[60:63], 0
    v_mfma_f32_16x16x32_bf16 v[80:83], v[180:183], v[60:63], 1.0
    v_mfma_f32_16x16x32_bf16 v[80:83], v[184:187], v[64:67], v[80:83]
    v_mfma_f32_16x16x32_bf16 v[84:87], v[188:191], v[60:63], 1.0
    v_mfma_f32_16x16x32_bf16 v[84:87], v[192:195], v[64:67], v[84:87]
    v_mfma_f32_16x16x32_bf16 v[88:91], v[196:199], v[60:63], 1.0
    s_mul_i32 s34, s3, 1344
    s_add_u32 s34, s34, 116736
    v_lshl_add_u32 v7, v0, 4, s34
    v_lshlrev_b32 v8, 6, v202
    v_lshl_add_u32 v8, v200, 4, v8
    v_and_b32 v9, 1, v201
    v_lshl_add_u32 v8, v9, 3, v8
    v_add_u32 v8, s34, v8
    v_bfe_u32 v9, v0, 3, 1
    v_mul_u32_u24 v9, 6144, v9
    v_sub_u32 v8, v8, v9
    v_lshrrev_b32 v9, 5, v0
    v_lshlrev_b32 v9, 10, v9
    v_and_b32 v6, 1, v202
    v_lshl_add_u32 v9, v6, 7, v9
    v_bfe_u32 v6, v0, 1, 1
    v_lshl_add_u32 v9, v6, 6, v9
    v_lshl_add_u32 v9, v201, 4, v9
    v_and_b32 v6, 1, v0
    v_lshl_add_u32 v9, v6, 3, v9
    v_add_u32 v9, 122112, v9
    s_lshr_b32 s34, s62, 3
    s_lshl_b32 s34, s34, 8
    s_and_b32 s49, s62, 3
    s_lshl_b32 s49, s49, 15
    s_add_u32 s34, s34, s49
    s_bfe_u32 s49, s62, 0x10002
    s_lshl_b32 s49, s49, 14
    s_add_u32 s34, s34, s49
    s_add_u32 s34, s34, 791552
    v_lshl_add_u32 v5, v0, 2, s34
    s_bfe_u32 s49, s60, 0x10002
    s_lshl_b32 s49, s49, 13
    s_xor_b32 s53, s99, s49
    s_xor_b32 s52, s53, 8192
    v_subrev_u32 v10, 90112, v7
    v_subrev_u32 v11, 90112, v8
    v_cvt_pk_bf16_f32 v32, v116, v117
    v_cvt_pk_bf16_f32 v33, v118, v119
    v_cvt_pk_bf16_f32 v34, v120, v121
    v_cvt_pk_bf16_f32 v35, v122, v123
    v_cvt_pk_bf16_f32 v36, v124, v125
    v_cvt_pk_bf16_f32 v37, v126, v127
    s_mov_b32 exec_lo, 0x00ff00ff
    s_mov_b32 exec_hi, 0x00ff00ff
    ds_write_b64 v11, v[36:37] offset:6400
    s_mov_b64 exec, -1
    ds_write_b128 v10, v[32:35] offset:5376
    v_cvt_pk_bf16_f32 v20, v80, v81
    v_cvt_pk_bf16_f32 v21, v82, v83
    v_cvt_pk_bf16_f32 v22, v84, v85
    v_cvt_pk_bf16_f32 v23, v86, v87
    v_cvt_pk_bf16_f32 v24, v88, v89
    v_cvt_pk_bf16_f32 v25, v90, v91
    ds_write_b128 v10, v[20:23]
    ds_write_b64 v11, v[24:25] offset:1024
    v_lshlrev_b32 v80, 16, v20
    v_and_b32 v81, 0xffff0000, v20
    v_lshlrev_b32 v82, 16, v21
    v_and_b32 v83, 0xffff0000, v21
    v_lshlrev_b32 v84, 16, v22
    v_and_b32 v85, 0xffff0000, v22
    v_lshlrev_b32 v86, 16, v23
    v_and_b32 v87, 0xffff0000, v23
    v_lshlrev_b32 v88, 16, v24
    v_and_b32 v89, 0xffff0000, v24
    v_lshlrev_b32 v90, 16, v25
    v_and_b32 v91, 0xffff0000, v25
    v_subrev_u32 v11, 22784, v9
    s_lshl_b32 s34, s3, 3
    s_add_u32 s34, s34, 99136
    v_mov_b32 v12, s34
    v_lshlrev_b32 v13, 3, v201
    v_add_u32 v13, 99136, v13
    s_mov_b32 s54, 0
    s_brev_b32 s55, 1
    s_waitcnt lgkmcnt(0)
    s_barrier
    s_mov_b32 s35, 0
    s_mov_b64 s[40:41], -1
    s_mov_b64 s[42:43], -1
L_pb:
    s_mov_b64 exec, s[40:41]
    s_cbranch_execz L_pbs0
    buffer_load_dwordx4 v[140:143], v206, s[44:47], 0 offen offset:0 sc1
    buffer_load_dwordx4 v[148:151], v206, s[44:47], 0 offen offset:256 sc1
    buffer_load_dwordx4 v[156:159], v206, s[44:47], 0 offen offset:512 sc1
    buffer_load_dwordx4 v[164:167], v206, s[44:47], 0 offen offset:768 sc1
    buffer_load_dwordx4 v[172:175], v206, s[44:47], 0 offen offset:1024 sc1
L_pbs0:
    s_mov_b64 exec, s[42:43]
    s_cbranch_execz L_pbs1
    buffer_load_dwordx4 v[144:147], v206, s[44:47], s48 offen offset:0 sc1
    buffer_load_dwordx4 v[152:155], v206, s[44:47], s48 offen offset:256 sc1
    buffer_load_dwordx4 v[160:163], v206, s[44:47], s48 offen offset:512 sc1
    buffer_load_dwordx4 v[168:171], v206, s[44:47], s48 offen offset:768 sc1
    buffer_load_dwordx4 v[176:179], v206, s[44:47], s48 offen offset:1024 sc1
L_pbs1:
    s_mov_b64 exec, -1
    s_add_u32 s35, s35, 1
    s_waitcnt vmcnt(0)
    v_mfma_f32_16x16x32_bf16 v[128:131], v[140:143], v[52:55], v[68:71]
    v_max3_u32 v28, v140, v141, v142
    v_max3_u32 v29, v144, v145, v146
    v_mfma_f32_16x16x32_bf16 v[128:131], v[144:147], v[52:55], v[128:131]
    v_max3_u32 v28, v28, v143, v148
    v_max3_u32 v29, v29, v147, v152
    v_mfma_f32_16x16x32_bf16 v[128:131], v[148:151], v[56:59], v[128:131]
    v_max3_u32 v28, v28, v149, v150
    v_max3_u32 v29, v29, v153, v154
    v_mfma_f32_16x16x32_bf16 v[128:131], v[152:155], v[56:59], v[128:131]
    v_max3_u32 v28, v28, v151, v156
    v_max3_u32 v29, v29, v155, v160
    v_mfma_f32_16x16x32_bf16 v[132:135], v[156:159], v[52:55], v[72:75]
    v_max3_u32 v28, v28, v157, v158
    v_max3_u32 v29, v29, v161, v162
    v_mfma_f32_16x16x32_bf16 v[132:135], v[160:163], v[52:55], v[132:135]
    v_max3_u32 v28, v28, v159, v164
    v_max3_u32 v29, v29, v163, v168
    v_mfma_f32_16x16x32_bf16 v[132:135], v[164:167], v[56:59], v[132:135]
    v_max3_u32 v28, v28, v165, v166
    v_max3_u32 v29, v29, v169, v170
    v_mfma_f32_16x16x32_bf16 v[132:135], v[168:171], v[56:59], v[132:135]
    v_max3_u32 v28, v28, v167, v172
    v_max3_u32 v29, v29, v171, v176
    v_mfma_f32_16x16x32_bf16 v[136:139], v[172:175], v[52:55], v[76:79]
    v_max3_u32 v28, v28, v173, v174
    v_max3_u32 v29, v29, v177, v178
    v_mfma_f32_16x16x32_bf16 v[136:139], v[176:179], v[52:55], v[136:139]
    v_max_u32 v28, v28, v175
    v_max_u32 v29, v29, v179
    v_cmp_eq_u32 s[40:41], -1, v28
    v_cmp_eq_u32 s[42:43], -1, v29
    s_nop 0
    s_or_b64 vcc, s[40:41], s[42:43]
    s_cbranch_scc0 L_pbd
    s_cmp_lg_u32 s35, 64
    s_cbranch_scc1 L_tmo88
    s_mov_b64 exec, -1
    v_lshlrev_b32 v243, 4, v0
    v_add_u32 v243, 131328, v243
    ds_read_b96 v[240:242], v243
    s_waitcnt lgkmcnt(0)
    buffer_store_dword v240, v242, s[44:47], 0 offen sc1
    buffer_store_dword v241, v242, s[44:47], 0 offen offset:256 sc1
L_tmo88:
    s_cmp_lt_u32 s35, 60000
    s_cbranch_scc1 L_pb
L_pbd:
    v_pk_mul_f32 v[32:33], v[128:129], v[80:81]
    v_pk_mul_f32 v[34:35], v[130:131], v[82:83]
    v_pk_mul_f32 v[36:37], v[132:133], v[84:85]
    v_pk_mul_f32 v[38:39], v[134:135], v[86:87]
    v_cvt_pk_bf16_f32 v24, v32, v33
    v_cvt_pk_bf16_f32 v25, v34, v35
    v_cvt_pk_bf16_f32 v26, v36, v37
    v_cvt_pk_bf16_f32 v27, v38, v39
    ds_write_b128 v7, v[24:27]
    v_pk_mul_f32 v[40:41], v[136:137], v[88:89]
    v_pk_mul_f32 v[42:43], v[138:139], v[90:91]
    v_cvt_pk_bf16_f32 v28, v40, v41
    v_cvt_pk_bf16_f32 v29, v42, v43
    ds_write_b64 v8, v[28:29] offset:1024
    v_pk_add_f32 v[20:21], v[128:129], v[130:131]
    v_pk_mul_f32 v[22:23], v[128:129], v[128:129]
    v_pk_add_f32 v[20:21], v[20:21], v[132:133]
    v_pk_fma_f32 v[22:23], v[130:131], v[130:131], v[22:23]
    v_pk_add_f32 v[20:21], v[20:21], v[134:135]
    v_pk_fma_f32 v[22:23], v[132:133], v[132:133], v[22:23]
    v_pk_add_f32 v[20:21], v[20:21], v[136:137]
    v_pk_fma_f32 v[22:23], v[134:135], v[134:135], v[22:23]
    v_pk_add_f32 v[20:21], v[20:21], v[138:139]
    v_pk_fma_f32 v[22:23], v[136:137], v[136:137], v[22:23]
    v_pk_fma_f32 v[22:23], v[138:139], v[138:139], v[22:23]
    s_waitcnt lgkmcnt(0)
    s_barrier
    v_add_f32 v20, v20, v21
    v_add_f32 v21, v22, v23
    s_nop 0
    v_add_f32_dpp v20, v20, v20 row_ror:8 row_mask:0xf bank_mask:0xf
    v_add_f32_dpp v21, v21, v21 row_ror:8 row_mask:0xf bank_mask:0xf
    s_nop 0
    v_add_f32_dpp v20, v20, v20 row_ror:4 row_mask:0xf bank_mask:0xf
    v_add_f32_dpp v21, v21, v21 row_ror:4 row_mask:0xf bank_mask:0xf
    s_nop 0
    v_add_f32_dpp v20, v20, v20 row_ror:2 row_mask:0xf bank_mask:0xf
    v_add_f32_dpp v21, v21, v21 row_ror:2 row_mask:0xf bank_mask:0xf
    s_nop 0
    v_add_f32_dpp v20, v20, v20 row_ror:1 row_mask:0xf bank_mask:0xf
    v_add_f32_dpp v21, v21, v21 row_ror:1 row_mask:0xf bank_mask:0xf
    s_nop 0
    v_add_f32_dpp v20, v20, v20 row_bcast:15 row_mask:0xa bank_mask:0xf
    v_add_f32_dpp v21, v21, v21 row_bcast:15 row_mask:0xa bank_mask:0xf
    s_nop 0
    v_add_f32_dpp v20, v20, v20 row_bcast:31 row_mask:0xc bank_mask:0xf
    v_add_f32_dpp v21, v21, v21 row_bcast:31 row_mask:0xc bank_mask:0xf
    v_mul_f32 v22, 0x3acccccd, v20
    v_mul_f32 v21, 0x3acccccd, v21
    v_fma_f32 v21, -v22, v22, v21
    v_max_f32 v21, 0, v21
    v_add_f32 v21, 0x3727c5ac, v21
    v_rsq_f32 v20, v21
    s_nop 0
    v_mul_f32_e64 v21, -v22, v20
    s_mov_b64 exec, s[54:55]
    ds_write_b64 v12, v[20:21]
    s_mov_b64 exec, -1
    s_cmp_lg_u32 s3, 0
    s_cbranch_scc1 L_w1_x
    ds_read_b64 v[32:33], v11 offset:0
    ds_read_b64 v[40:41], v11 offset:320
    ds_read_b64 v[34:35], v11 offset:2048
    ds_read_b64 v[42:43], v11 offset:2368
    ds_read_b64 v[36:37], v11 offset:4096
    ds_read_b64 v[44:45], v11 offset:4416
    ds_read_b64 v[38:39], v11 offset:6144
    ds_read_b64 v[46:47], v11 offset:6464
    s_mov_b32 s34, 0xbdd2d3e8
    v_mov_b32 v10, 0xc0135761
    s_waitcnt lgkmcnt(8)
    s_barrier
    ds_read_b64 v[28:29], v13
    ds_read_b64 v[20:21], v9 offset:0
    ds_read_b64 v[22:23], v9 offset:2048
    ds_read_b64 v[24:25], v9 offset:4096
    ds_read_b64 v[26:27], v9 offset:6144
    s_waitcnt lgkmcnt(5)
    v_pk_add_f32 v[100:101], v[100:101], v[40:41]
    v_pk_add_f32 v[100:101], v[100:101], v[42:43]
    v_pk_add_f32 v[32:33], v[32:33], v[34:35]
    v_pk_add_f32 v[100:101], v[100:101], v[44:45]
    v_pk_add_f32 v[32:33], v[32:33], v[36:37]
    v_pk_add_f32 v[100:101], v[100:101], v[46:47]
    v_pk_add_f32 v[32:33], v[32:33], v[38:39]
    s_waitcnt lgkmcnt(4)
    v_pk_fma_f32 v[100:101], v[32:33], v[28:29], v[100:101] op_sel:[0,1,0] op_sel_hi:[1,1,1]
    s_waitcnt lgkmcnt(3)
    v_pk_fma_f32 v[100:101], v[20:21], v[28:29], v[100:101] op_sel_hi:[1,0,1]
    s_waitcnt lgkmcnt(2)
    v_pk_fma_f32 v[100:101], v[22:23], v[28:29], v[100:101] op_sel_hi:[1,0,1]
    s_waitcnt lgkmcnt(1)
    v_pk_fma_f32 v[100:101], v[24:25], v[28:29], v[100:101] op_sel_hi:[1,0,1]
    s_waitcnt lgkmcnt(0)
    v_pk_fma_f32 v[100:101], v[26:27], v[28:29], v[100:101] op_sel_hi:[1,0,1]
    v_pk_mul_f32 v[20:21], v[100:101], v[100:101]
    v_fma_f32 v20, v20, s34, v10
    v_fma_f32 v21, v21, s34, v10
    v_pk_mul_f32 v[20:21], v[20:21], v[100:101]
    v_exp_f32 v20, v20
    v_exp_f32 v21, v21
    v_add_f32 v20, 1.0, v20
    v_add_f32 v21, 1.0, v21
    v_rcp_f32 v20, v20
    v_rcp_f32 v21, v21
    s_nop 0
    v_pk_mul_f32 v[20:21], v[20:21], v[100:101]
    v_cvt_pk_bf16_f32 v20, v20, v21
    v_min_u32 v20, -2, v20
    buffer_store_dword v20, v5, s[44:47], s52 offen sc1
    buffer_store_dword v20, v5, s[44:47], s53 offen sc1
    s_branch L_fin
L_w1_x:
    s_waitcnt lgkmcnt(0)
    s_barrier
    s_branch L_fin
L_t_w2:
    s_barrier
L_w2_dma:
    s_and_b32 s34, s40, 7
    s_lshl_b32 s35, s34, 10
    s_add_u32 m0, s50, s35
    s_mul_i32 s34, s34, 40960
    buffer_load_dwordx4 v204, s[52:55], s34 offen  lds
    s_add_u32 s40, s40, 1
    s_cmp_lg_u32 s40, s42
    s_cbranch_scc1 L_w2_nw
L_w2_nw:
    s_cmp_lt_u32 s40, s41
    s_cbranch_scc1 L_w2_dma
    ds_read_b32 v8, v7
    s_waitcnt lgkmcnt(0)
    v_cmp_eq_u32 vcc, 0, v8
    s_cbranch_vccnz L_w2_slow
    s_mov_b32 s35, 0
    buffer_load_dwordx4 v[64:67], v4, s[44:47], 0 offen sc1
    buffer_load_dwordx4 v[68:71], v5, s[44:47], s48 offen sc1
    s_waitcnt vmcnt(2)
    ds_read_b64_tr_b16 v[32:33], v205 offset:0
    ds_read_b64_tr_b16 v[34:35], v205 offset:512
    ds_read_b64_tr_b16 v[36:37], v205 offset:1024
    ds_read_b64_tr_b16 v[38:39], v205 offset:1536
    ds_read_b64_tr_b16 v[40:41], v205 offset:2048
    ds_read_b64_tr_b16 v[42:43], v205 offset:2560
    ds_read_b64_tr_b16 v[44:45], v205 offset:3072
    ds_read_b64_tr_b16 v[46:47], v205 offset:3584
    s_waitcnt lgkmcnt(0)
    ds_read_b64_tr_b16 v[48:49], v205 offset:4096
    ds_read_b64_tr_b16 v[50:51], v205 offset:4608
    ds_read_b64_tr_b16 v[52:53], v205 offset:5120
    ds_read_b64_tr_b16 v[54:55], v205 offset:5632
    ds_read_b64_tr_b16 v[56:57], v205 offset:6144
    ds_read_b64_tr_b16 v[58:59], v205 offset:6656
    ds_read_b64_tr_b16 v[60:61], v205 offset:7168
    ds_read_b64_tr_b16 v[62:63], v205 offset:7680
    s_waitcnt lgkmcnt(0)
    s_branch L_w2_mid
L_w2_slow:
    s_waitcnt vmcnt(0)
    ds_read_b64_tr_b16 v[32:33], v205 offset:0
    ds_read_b64_tr_b16 v[34:35], v205 offset:512
    ds_read_b64_tr_b16 v[36:37], v205 offset:1024
    ds_read_b64_tr_b16 v[38:39], v205 offset:1536
    ds_read_b64_tr_b16 v[40:41], v205 offset:2048
    ds_read_b64_tr_b16 v[42:43], v205 offset:2560
    ds_read_b64_tr_b16 v[44:45], v205 offset:3072
    ds_read_b64_tr_b16 v[46:47], v205 offset:3584
    s_waitcnt lgkmcnt(0)
    ds_read_b64_tr_b16 v[48:49], v205 offset:4096
    ds_read_b64_tr_b16 v[50:51], v205 offset:4608
    ds_read_b64_tr_b16 v[52:53], v205 offset:5120
    ds_read_b64_tr_b16 v[54:55], v205 offset:5632
    ds_read_b64_tr_b16 v[56:57], v205 offset:6144
    ds_read_b64_tr_b16 v[58:59], v205 offset:6656
    ds_read_b64_tr_b16 v[60:61], v205 offset:7168
    ds_read_b64_tr_b16 v[62:63], v205 offset:7680
    s_waitcnt lgkmcnt(0)
    s_mov_b32 s35, 0
L_poll89:
    ds_read_b32 v8, v7
    s_add_u32 s35, s35, 1
    s_waitcnt lgkmcnt(0)
    v_cmp_eq_u32 vcc, 0, v8
    s_cbranch_vccz L_done90
    s_sleep 1
    s_cmp_lt_u32 s35, 60000
    s_cbranch_scc1 L_poll89
L_done90:
    s_mov_b32 s35, 0
L_poll92:
    buffer_load_dwordx4 v[64:67], v4, s[44:47], 0 offen sc1
    buffer_load_dwordx4 v[68:71], v5, s[44:47], s48 offen sc1
L_w2_mid:
    s_add_u32 s35, s35, 1
    s_waitcnt vmcnt(0)
    v_max3_u32 v28, v64, v65, v66
    v_max3_u32 v28, v28, v67, v68
    v_max3_u32 v28, v28, v69, v70
    v_max_u32 v28, v28, v71
    v_cmp_eq_u32 vcc, -1, v28
    s_cbranch_vccz L_done93
    s_cmp_lg_u32 s35, 64
    s_cbranch_scc1 L_tmo95
    s_mov_b64 exec, -1
    v_lshlrev_b32 v243, 4, v0
    v_add_u32 v243, 131328, v243
    ds_read_b96 v[240:242], v243
    s_waitcnt lgkmcnt(0)
    buffer_store_dword v240, v242, s[44:47], 0 offen sc1
    buffer_store_dword v241, v242, s[44:47], 0 offen offset:256 sc1
L_tmo95:
    s_cmp_lt_u32 s35, 60000
    s_cbranch_scc1 L_poll92
L_done93:
    v_mfma_f32_16x16x32_bf16 v[80:83], v[32:35], v[64:67], 0
    v_mfma_f32_16x16x32_bf16 v[80:83], v[48:51], v[68:71], v[80:83]
    v_mfma_f32_16x16x32_bf16 v[84:87], v[36:39], v[64:67], 0
    v_mfma_f32_16x16x32_bf16 v[84:87], v[52:55], v[68:71], v[84:87]
    v_mfma_f32_16x16x32_bf16 v[88:91], v[40:43], v[64:67], 0
    v_mfma_f32_16x16x32_bf16 v[88:91], v[56:59], v[68:71], v[88:91]
    v_mfma_f32_16x16x32_bf16 v[92:95], v[44:47], v[64:67], 0
    v_mfma_f32_16x16x32_bf16 v[92:95], v[60:63], v[68:71], v[92:95]
    s_nop 3
    v_add_f32_dpp v80, v84, v80 row_shl:4 row_mask:0xf bank_mask:0x1
    v_add_f32_dpp v81, v85, v81 row_shl:4 row_mask:0xf bank_mask:0x1
    v_add_f32_dpp v82, v86, v82 row_shl:4 row_mask:0xf bank_mask:0x1
    v_add_f32_dpp v83, v87, v83 row_shl:4 row_mask:0xf bank_mask:0x1
    v_add_f32_dpp v80, v88, v80 row_shl:8 row_mask:0xf bank_mask:0x1
    v_add_f32_dpp v81, v89, v81 row_shl:8 row_mask:0xf bank_mask:0x1
    v_add_f32_dpp v82, v90, v82 row_shl:8 row_mask:0xf bank_mask:0x1
    v_add_f32_dpp v83, v91, v83 row_shl:8 row_mask:0xf bank_mask:0x1
    v_add_f32_dpp v80, v92, v80 row_shl:12 row_mask:0xf bank_mask:0x1
    v_add_f32_dpp v81, v93, v81 row_shl:12 row_mask:0xf bank_mask:0x1
    v_add_f32_dpp v82, v94, v82 row_shl:12 row_mask:0xf bank_mask:0x1
    v_add_f32_dpp v83, v95, v83 row_shl:12 row_mask:0xf bank_mask:0x1
    ds_write_b128 v203, v[80:83]
    s_waitcnt lgkmcnt(0)
    s_barrier
    s_branch L_fin
L_w2_red:
    s_mov_b32 s35, 0
L_poll96:
    buffer_load_dwordx2 v[20:21], v204, s[44:47], 0 offen sc1
    buffer_load_dwordx2 v[22:23], v204, s[44:47], s48 offen sc1
    s_add_u32 s35, s35, 1
    s_waitcnt vmcnt(0)
    v_max3_u32 v28, v20, v21, v22
    v_max_u32 v28, v28, v23
    v_cmp_eq_u32 vcc, -1, v28
    s_cbranch_vccz L_done97
    s_cmp_lg_u32 s35, 21
    s_cbranch_scc1 L_tmo99
    s_mov_b64 exec, -1
    v_lshlrev_b32 v243, 4, v0
    v_add_u32 v243, 131328, v243
    ds_read_b96 v[240:242], v243
    s_waitcnt lgkmcnt(0)
    buffer_store_dword v240, v242, s[44:47], 0 offen sc1
    buffer_store_dword v241, v242, s[44:47], 0 offen offset:256 sc1
L_tmo99:
    s_sleep 6
    s_cmp_lt_u32 s35, 60000
    s_cbranch_scc1 L_poll96
L_done97:
    v_mov_b32 v7, 99084
    ds_write_b32 v7, v7
    v_lshlrev_b32 v44, 16, v20
    v_and_b32 v45, 0xffff0000, v20
    v_lshlrev_b32 v46, 16, v21
    v_and_b32 v47, 0xffff0000, v21
    v_lshlrev_b32 v48, 16, v22
    v_and_b32 v49, 0xffff0000, v22
    v_lshlrev_b32 v50, 16, v23
    v_and_b32 v51, 0xffff0000, v23
    v_add_f32 v108, v108, v44
    v_add_f32 v109, v109, v45
    v_add_f32 v110, v110, v46
    v_add_f32 v111, v111, v47
    v_add_f32 v108, v108, v48
    v_add_f32 v109, v109, v49
    v_add_f32 v110, v110, v50
    v_add_f32 v111, v111, v51
    s_mov_b32 s36, s28
    s_mov_b32 s37, s29
    s_movk_i32 s38, 5120
    v_add_f32_dpp v108, v108, v108 row_ror:4 row_mask:0xf bank_mask:0xf
    v_add_f32_dpp v109, v109, v109 row_ror:4 row_mask:0xf bank_mask:0xf
    v_add_f32_dpp v110, v110, v110 row_ror:4 row_mask:0xf bank_mask:0xf
    v_add_f32_dpp v111, v111, v111 row_ror:4 row_mask:0xf bank_mask:0xf
    v_add_f32_dpp v108, v108, v108 row_ror:8 row_mask:0xf bank_mask:0xf
    v_add_f32_dpp v109, v109, v109 row_ror:8 row_mask:0xf bank_mask:0xf
    v_add_f32_dpp v110, v110, v110 row_ror:8 row_mask:0xf bank_mask:0xf
    v_add_f32_dpp v111, v111, v111 row_ror:8 row_mask:0xf bank_mask:0xf
    v_mov_b32_dpp v108, v104 quad_perm:[0,1,2,3] row_mask:0xf bank_mask:0x2
    v_mov_b32_dpp v109, v105 quad_perm:[0,1,2,3] row_mask:0xf bank_mask:0x2
    v_mov_b32_dpp v110, v106 quad_perm:[0,1,2,3] row_mask:0xf bank_mask:0x2
    v_mov_b32_dpp v111, v107 quad_perm:[0,1,2,3] row_mask:0xf bank_mask:0x2
    ds_write_b128 v203, v[108:111]
    v_and_b32 v6, 31, v0
    v_lshlrev_b32 v6, 3, v6
    v_add_u32 v6, 122112, v6
    ds_read_b64 v[108:109], v6
    ds_read_b64 v[104:105], v6 offset:320
    v_bfe_u32 v112, v0, 1, 2
    v_mul_u32_u24 v112, 1280, v112
    v_bfe_u32 v7, v0, 3, 2
    v_lshl_add_u32 v112, v7, 3, v112
    v_and_b32 v7, 1, v0
    v_lshl_add_u32 v112, v7, 2, v112
    v_lshrrev_b32 v7, 5, v0
    v_lshl_add_u32 v112, v7, 28, v112
    s_lshl_b32 s34, s62, 5
    s_waitcnt lgkmcnt(0)
    s_barrier
    ds_read_b64 v[64:65], v6 offset:1024
    ds_read_b64 v[66:67], v6 offset:2048
    ds_read_b64 v[68:69], v6 offset:3072
    ds_read_b64 v[70:71], v6 offset:4096
    ds_read_b64 v[72:73], v6 offset:5120
    ds_read_b64 v[74:75], v6 offset:6144
    ds_read_b64 v[76:77], v6 offset:7168
    s_waitcnt lgkmcnt(6)
    v_pk_fma_f32 v[108:109], v[64:65], v[104:105], v[108:109]
    s_waitcnt lgkmcnt(5)
    v_pk_fma_f32 v[108:109], v[66:67], v[104:105], v[108:109]
    s_waitcnt lgkmcnt(4)
    v_pk_fma_f32 v[108:109], v[68:69], v[104:105], v[108:109]
    s_waitcnt lgkmcnt(3)
    v_pk_fma_f32 v[108:109], v[70:71], v[104:105], v[108:109]
    s_waitcnt lgkmcnt(2)
    v_pk_fma_f32 v[108:109], v[72:73], v[104:105], v[108:109]
    s_waitcnt lgkmcnt(1)
    v_pk_fma_f32 v[108:109], v[74:75], v[104:105], v[108:109]
    s_waitcnt lgkmcnt(0)
    v_pk_fma_f32 v[108:109], v[76:77], v[104:105], v[108:109]
    v_cvt_pk_bf16_f32 v20, v108, v109
    buffer_store_dword v20, v112, s[36:39], s34 offen
    s_branch L_fin
L_t_wo:
    s_barrier
L_r_wo2:
    s_mov_b32 m0, s56
    s_nop 0
    buffer_load_dwordx4 v15, s[52:55], s57 offen  lds
    s_mov_b32 m0, s58
    s_nop 0
    buffer_load_dwordx4 v15, s[52:55], s59 offen  lds
    s_xor_b32 m0, s56, 2048
    s_sub_u32 s34, 40960, s57
    buffer_load_dwordx4 v15, s[52:55], s34 offen  lds
    s_xor_b32 m0, s58, 2048
    s_sub_u32 s34, 42240, s57
    buffer_load_dwordx4 v15, s[52:55], s34 offen  lds
L_r_wo3:
    s_mov_b32 s35, 0
    s_mov_b32 s48, 0
    buffer_load_dwordx4 v[64:67], v205, s[44:47], 0 offen sc1
    buffer_load_dwordx2 v[26:27], v204, s[44:47], 0 offen sc1
    s_waitcnt vmcnt(2)
    ds_read_b64_tr_b16 v[32:33], v206 offset:0
    ds_read_b64_tr_b16 v[34:35], v206 offset:1024
    ds_read_b64_tr_b16 v[36:37], v206 offset:32
    ds_read_b64_tr_b16 v[38:39], v206 offset:1056
    ds_read_b64_tr_b16 v[40:41], v206 offset:2048
    ds_read_b64_tr_b16 v[42:43], v206 offset:3072
    ds_read_b64_tr_b16 v[44:45], v206 offset:2080
    ds_read_b64_tr_b16 v[46:47], v206 offset:3104
    s_branch L_pam
L_pa:
    buffer_load_dwordx4 v[64:67], v205, s[44:47], 0 offen sc1
    buffer_load_dwordx2 v[26:27], v204, s[44:47], 0 offen sc1
L_pam:
    s_add_u32 s35, s35, 1
    s_waitcnt vmcnt(0)
    ds_write_b128 v207, v[64:67]
    ds_write_b32 v212, v26 offset:128
    v_max3_u32 v28, v64, v65, v66
    v_max3_u32 v28, v28, v67, v26
    v_cmp_eq_u32 vcc, -1, v28
    s_cbranch_vccz L_pad
    s_cmp_lg_u32 s35, 64
    s_cbranch_scc1 L_tmo100
    s_mov_b64 exec, -1
    v_lshlrev_b32 v243, 4, v0
    v_add_u32 v243, 131328, v243
    ds_read_b96 v[240:242], v243
    s_waitcnt lgkmcnt(0)
    buffer_store_dword v240, v242, s[44:47], 0 offen sc1
    buffer_store_dword v241, v242, s[44:47], 0 offen offset:256 sc1
L_tmo100:
    s_mov_b64 exec, vcc
    s_cmp_lt_u32 s35, 60000
    s_cbranch_scc1 L_pa
L_pad:
    s_mov_b64 exec, -1
    ds_read_b32 v26, v213 offset:128
    ds_read_b128 v[68:71], v208 offset:0
    ds_read_b128 v[72:75], v209 offset:0
    ds_read_b128 v[76:79], v208 offset:64
    ds_read_b128 v[80:83], v209 offset:64
    s_waitcnt lgkmcnt(3)
    v_mfma_f32_16x16x32_bf16 v[20:23], v[32:35], v[68:71], 0
    s_waitcnt lgkmcnt(2)
    v_mfma_f32_16x16x32_bf16 v[20:23], v[36:39], v[72:75], v[20:23]
    s_waitcnt lgkmcnt(1)
    v_mfma_f32_16x16x32_bf16 v[20:23], v[40:43], v[76:79], v[20:23]
    s_waitcnt lgkmcnt(0)
    v_mfma_f32_16x16x32_bf16 v[20:23], v[44:47], v[80:83], v[20:23]
    v_sub_f32_dpp v26, v26, v26 quad_perm:[1,0,3,2] row_mask:0xf bank_mask:0xf
    v_exp_f32 v26, v26
    s_nop 0
    v_add_f32 v26, 1.0, v26
    v_rcp_f32 v26, v26
    s_nop 0
    v_sub_f32 v30, 1.0, v26
    s_nop 0
    v_pk_mul_f32 v[48:49], v[20:21], v[26:27] op_sel_hi:[1,0]
    v_pk_mul_f32 v[50:51], v[22:23], v[26:27] op_sel_hi:[1,0]
    v_fmac_f32_dpp v48, v20, v30 quad_perm:[1,0,3,2] row_mask:0xf bank_mask:0xf
    v_fmac_f32_dpp v49, v21, v30 quad_perm:[1,0,3,2] row_mask:0xf bank_mask:0xf
    v_fmac_f32_dpp v50, v22, v30 quad_perm:[1,0,3,2] row_mask:0xf bank_mask:0xf
    v_fmac_f32_dpp v51, v23, v30 quad_perm:[1,0,3,2] row_mask:0xf bank_mask:0xf
    ds_write_b128 v203, v[48:51]
    s_cmp_lg_u32 s3, 0
    s_waitcnt lgkmcnt(0)
    s_barrier
    s_cbranch_scc1 L_wo_x
    ds_read_b64 v[64:65], v113 offset:0
    ds_read_b64 v[66:67], v113 offset:1152
    ds_read_b64 v[68:69], v113 offset:2304
    ds_read_b64 v[70:71], v113 offset:3456
    ds_read_b64 v[72:73], v113 offset:4608
    ds_read_b64 v[74:75], v113 offset:5760
    ds_read_b64 v[76:77], v113 offset:6912
    ds_read_b64 v[78:79], v113 offset:8064
    s_waitcnt lgkmcnt(6)
    v_pk_add_f32 v[64:65], v[64:65], v[66:67]
    s_waitcnt lgkmcnt(5)
    v_pk_add_f32 v[64:65], v[64:65], v[68:69]
    s_waitcnt lgkmcnt(4)
    v_pk_add_f32 v[64:65], v[64:65], v[70:71]
    s_waitcnt lgkmcnt(3)
    v_pk_add_f32 v[64:65], v[64:65], v[72:73]
    s_waitcnt lgkmcnt(2)
    v_pk_add_f32 v[64:65], v[64:65], v[74:75]
    s_waitcnt lgkmcnt(1)
    v_pk_add_f32 v[64:65], v[64:65], v[76:77]
    s_waitcnt lgkmcnt(0)
    v_pk_add_f32 v[64:65], v[64:65], v[78:79]
    v_pk_mul_f32 v[64:65], v[64:65], v[100:101]
    v_cvt_pk_bf16_f32 v28, v64, v65
    v_min_u32 v28, -2, v28
    buffer_store_dword v28, v112, s[44:47], s101 offen sc1
    buffer_store_dword v28, v112, s[44:47], s93 offen sc1
L_wo_x:
    s_getreg_b32 s34, hwreg(HW_REG_XCC_ID, 0, 4)
    v_cmp_ne_u32 vcc, s34, v27
    s_cbranch_vccz L_fin
    s_mov_b64 exec, -1
    v_lshlrev_b32 v243, 4, v0
    v_add_u32 v243, 131328, v243
    ds_read_b96 v[240:242], v243
    s_waitcnt lgkmcnt(0)
    buffer_store_dword v240, v242, s[44:47], 0 offen sc1
    buffer_store_dword v241, v242, s[44:47], 0 offen offset:256 sc1
L_fin:
L_exit:
    s_endpgm
L_codeend:
.section .rodata,"a"
.p2align 6
.amdhsa_kernel adaLN_cond__sliding_block_cached__dense_activation_gelu__decode_kernel
  .amdhsa_next_free_vgpr 256
  .amdhsa_next_free_sgpr 102
  .amdhsa_accum_offset 256
  .amdhsa_group_segment_fixed_size 0
  .amdhsa_kernarg_size 120
  .amdhsa_user_sgpr_count 2
  .amdhsa_user_sgpr_kernarg_segment_ptr 1
  .amdhsa_system_sgpr_workgroup_id_x 1
  .amdhsa_float_denorm_mode_32 3
.end_amdhsa_kernel
```

```asm
; @launch grid=(256,1,1) block=(512,1,1) lds=132352
.amdgcn_target "amdgcn-amd-amdhsa--gfx950"
.text
.globl adaLN_cond__sliding_block_cached__dense_activation_gelu__decode_kernel
.p2align 8
.type adaLN_cond__sliding_block_cached__dense_activation_gelu__decode_kernel,@function
adaLN_cond__sliding_block_cached__dense_activation_gelu__decode_kernel:
    s_cmp_ge_u32 s2, 256
    s_cbranch_scc1 L_exit
    s_load_dwordx4 s[4:7], s[0:1], 0
    v_lshrrev_b32 v1, 6, v0
    v_and_b32 v0, 63, v0
    v_readfirstlane_b32 s3, v1
    s_and_b32 s34, s2, 127
    s_lshl_b32 s34, s34, 21
    s_lshr_b32 s35, s2, 7
    s_lshl_b32 s35, s35, 18
    s_add_u32 s34, s34, s35
    s_add_u32 s34, s34, 1572864
    s_mov_b32 s38, 0x40000
    s_mov_b32 s39, 0x20000
    s_sub_u32 s49, s3, 1
    s_cbranch_scc1 L_nohead
    s_lshl_b32 s49, s49, 12
    v_lshl_add_u32 v1, v0, 4, s49
    s_lshr_b32 s98, s2, 7
    s_mul_i32 s98, s98, 57344
    s_waitcnt lgkmcnt(0)
    s_add_u32 s36, s6, s34
    s_addc_u32 s37, s7, 0
    buffer_load_dwordx4 v[16:19], v1, s[36:39], s98 offen offset:0 nt
    buffer_load_dwordx4 v[20:23], v1, s[36:39], s98 offen offset:1024 nt
    buffer_load_dwordx4 v[24:27], v1, s[36:39], s98 offen offset:2048 nt
L_nohead:
    s_load_dwordx8 s[8:15], s[0:1], 16
    s_load_dwordx4 s[16:19], s[0:1], 48
    s_load_dwordx8 s[20:27], s[0:1], 64
    s_load_dwordx4 s[28:31], s[0:1], 96
    s_load_dwordx2 s[32:33], s[0:1], 112
    s_and_b32 s60, s2, 7
    s_lshr_b32 s61, s2, 3
    s_mov_b32 s39, 0x20000
    s_mov_b32 s43, 0x20000
    s_mov_b32 s46, 1703936
    s_mov_b32 s47, 0x20000
    s_cmp_lg_u32 s3, 0
    s_cbranch_scc1 L_stream
    s_setprio 3
    v_and_b32 v12, 3, v0
    v_bfe_u32 v13, v0, 2, 2
    v_lshrrev_b32 v14, 4, v0
    v_lshrrev_b32 v10, 3, v0
    v_and_b32 v11, 7, v0
    v_lshlrev_b32 v11, 4, v11
    s_lshr_b32 s50, s2, 2
    s_and_b32 s51, s2, 3
    s_mul_i32 s34, s51, 1228800
    s_lshl_b32 s35, s50, 7
    s_add_u32 s34, s34, s35
    v_mul_u32_u24 v17, 7680, v10
    v_add3_u32 v17, v17, v11, s34
    v_mul_u32_u24 v16, 1280, v12
    v_lshl_add_u32 v18, v14, 4, v16
    s_mul_i32 s34, s51, 320
    v_add_u32 v19, s34, v18
    s_mov_b32 s38, 4915200
    s_sub_u32 s52, s50, 10
    s_waitcnt lgkmcnt(0)
    s_add_u32 s44, s32, 0
    s_addc_u32 s45, s33, 0
    s_cmp_ge_u32 s2, 240
    s_cbranch_scc1 L_clear
    s_mov_b32 s36, s26
    s_mov_b32 s37, s27
    s_mov_b32 m0, 0
    s_mov_b32 s34, 0
L_dma1:
    buffer_load_dwordx4 v17, s[36:39], s34 offen  lds
    s_add_u32 m0, m0, 1024
    s_add_u32 s34, s34, 61440
    buffer_load_dwordx4 v17, s[36:39], s34 offen  lds
    s_add_u32 m0, m0, 1024
    s_add_u32 s34, s34, 61440
    buffer_load_dwordx4 v17, s[36:39], s34 offen  lds
    s_add_u32 m0, m0, 1024
    s_add_u32 s34, s34, 61440
    buffer_load_dwordx4 v17, s[36:39], s34 offen  lds
    s_add_u32 m0, m0, 1024
    s_add_u32 s34, s34, 61440
    s_cmp_lt_u32 s34, 1228800
    s_cbranch_scc1 L_dma1
    v_lshlrev_b32 v1, 2, v0
    v_add_u32 v1, 98304, v1
    v_mov_b32 v2, -1
    v_mov_b32 v3, 0
    ds_write_b32 v1, v2
    ds_write_b32 v1, v2 offset:256
    ds_write_b32 v1, v3 offset:512
    ds_write_b32 v1, v3 offset:768
    s_waitcnt lgkmcnt(0)
    s_barrier
    s_cmp_ge_u32 s52, 10
    s_cbranch_scc1 L_nox
    v_lshl_add_u32 v18, v13, 6, v18
    global_load_dwordx4 v[52:55], v18, s[4:5] offset:0
    global_load_dwordx4 v[56:59], v18, s[4:5] offset:256
    global_load_dwordx4 v[60:63], v18, s[4:5] offset:512
    global_load_dwordx4 v[64:67], v18, s[4:5] offset:768
    global_load_dwordx4 v[68:71], v18, s[4:5] offset:1024
    s_lshl_b32 s34, s52, 7
    v_lshl_add_u32 v16, v13, 5, v16
    v_lshl_add_u32 v16, v14, 3, v16
    v_add_u32 v16, s34, v16
    global_load_dwordx2 v[72:73], v16, s[4:5]
L_nox:
    global_load_dwordx4 v[32:35], v19, s[24:25] offset:0
    global_load_dwordx4 v[36:39], v19, s[24:25] offset:64
    global_load_dwordx4 v[40:43], v19, s[24:25] offset:128
    global_load_dwordx4 v[44:47], v19, s[24:25] offset:192
    global_load_dwordx4 v[48:51], v19, s[24:25] offset:256
    s_and_b32 s34, s2, 31
    s_lshl_b32 s34, s34, 8
    s_lshr_b32 s35, s2, 7
    s_lshl_b32 s35, s35, 7
    s_add_u32 s49, s34, s35
    s_bfe_u32 s53, s2, 0x20005
    s_mul_i32 s34, s53, 1310720
    s_add_u32 s34, s34, s49
    v_lshl_add_u32 v16, v10, 13, v11
    v_add_u32 v16, s34, v16
    s_mov_b32 s36, s10
    s_mov_b32 s37, s11
    s_mov_b32 s38, 5242880
    s_mov_b32 m0, 20480
    s_mov_b32 s34, 0
L_dma2:
    buffer_load_dwordx4 v16, s[36:39], s34 offen  lds
    s_add_u32 m0, m0, 1024
    s_add_u32 s34, s34, 65536
    buffer_load_dwordx4 v16, s[36:39], s34 offen  lds
    s_add_u32 m0, m0, 1024
    s_add_u32 s34, s34, 65536
    buffer_load_dwordx4 v16, s[36:39], s34 offen  lds
    s_add_u32 m0, m0, 1024
    s_add_u32 s34, s34, 65536
    buffer_load_dwordx4 v16, s[36:39], s34 offen  lds
    s_add_u32 m0, m0, 1024
    s_add_u32 s34, s34, 65536
    s_cmp_lt_u32 s34, 1310720
    s_cbranch_scc1 L_dma2
    v_lshl_add_u32 v15, v14, 3, v13
    v_lshlrev_b32 v15, 7, v15
    v_lshl_add_u32 v15, v12, 3, v15
    s_waitcnt vmcnt(20)
    s_mov_b32 s34, 0xbfb8aa3b
    v_lshlrev_b32 v20, 16, v32
    v_and_b32 v21, 0xffff0000, v32
    v_lshlrev_b32 v22, 16, v33
    v_and_b32 v23, 0xffff0000, v33
    v_mul_f32 v24, s34, v20
    v_mul_f32 v25, s34, v21
    v_mul_f32 v26, s34, v22
    v_mul_f32 v27, s34, v23
    v_exp_f32 v24, v24
    v_exp_f32 v25, v25
    v_exp_f32 v26, v26
    v_exp_f32 v27, v27
    v_add_f32 v24, 1.0, v24
    v_add_f32 v25, 1.0, v25
    v_add_f32 v26, 1.0, v26
    v_add_f32 v27, 1.0, v27
    v_rcp_f32 v24, v24
    v_rcp_f32 v25, v25
    v_rcp_f32 v26, v26
    v_rcp_f32 v27, v27
    v_mul_f32 v24, v20, v24
    v_mul_f32 v25, v21, v25
    v_mul_f32 v26, v22, v26
    v_mul_f32 v27, v23, v27
    v_cvt_pk_bf16_f32 v32, v24, v25
    v_cvt_pk_bf16_f32 v33, v26, v27
    v_lshlrev_b32 v20, 16, v34
    v_and_b32 v21, 0xffff0000, v34
    v_lshlrev_b32 v22, 16, v35
    v_and_b32 v23, 0xffff0000, v35
    v_mul_f32 v24, s34, v20
    v_mul_f32 v25, s34, v21
    v_mul_f32 v26, s34, v22
    v_mul_f32 v27, s34, v23
    v_exp_f32 v24, v24
    v_exp_f32 v25, v25
    v_exp_f32 v26, v26
    v_exp_f32 v27, v27
    v_add_f32 v24, 1.0, v24
    v_add_f32 v25, 1.0, v25
    v_add_f32 v26, 1.0, v26
    v_add_f32 v27, 1.0, v27
    v_rcp_f32 v24, v24
    v_rcp_f32 v25, v25
    v_rcp_f32 v26, v26
    v_rcp_f32 v27, v27
    v_mul_f32 v24, v20, v24
    v_mul_f32 v25, v21, v25
    v_mul_f32 v26, v22, v26
    v_mul_f32 v27, v23, v27
    v_cvt_pk_bf16_f32 v34, v24, v25
    v_cvt_pk_bf16_f32 v35, v26, v27
    v_lshlrev_b32 v20, 16, v36
    v_and_b32 v21, 0xffff0000, v36
    v_lshlrev_b32 v22, 16, v37
    v_and_b32 v23, 0xffff0000, v37
    v_mul_f32 v24, s34, v20
    v_mul_f32 v25, s34, v21
    v_mul_f32 v26, s34, v22
    v_mul_f32 v27, s34, v23
    v_exp_f32 v24, v24
    v_exp_f32 v25, v25
    v_exp_f32 v26, v26
    v_exp_f32 v27, v27
    v_add_f32 v24, 1.0, v24
    v_add_f32 v25, 1.0, v25
    v_add_f32 v26, 1.0, v26
    v_add_f32 v27, 1.0, v27
    v_rcp_f32 v24, v24
    v_rcp_f32 v25, v25
    v_rcp_f32 v26, v26
    v_rcp_f32 v27, v27
    v_mul_f32 v24, v20, v24
    v_mul_f32 v25, v21, v25
    v_mul_f32 v26, v22, v26
    v_mul_f32 v27, v23, v27
    v_cvt_pk_bf16_f32 v36, v24, v25
    v_cvt_pk_bf16_f32 v37, v26, v27
    v_lshlrev_b32 v20, 16, v38
    v_and_b32 v21, 0xffff0000, v38
    v_lshlrev_b32 v22, 16, v39
    v_and_b32 v23, 0xffff0000, v39
    v_mul_f32 v24, s34, v20
    v_mul_f32 v25, s34, v21
    v_mul_f32 v26, s34, v22
    v_mul_f32 v27, s34, v23
    v_exp_f32 v24, v24
    v_exp_f32 v25, v25
    v_exp_f32 v26, v26
    v_exp_f32 v27, v27
    v_add_f32 v24, 1.0, v24
    v_add_f32 v25, 1.0, v25
    v_add_f32 v26, 1.0, v26
    v_add_f32 v27, 1.0, v27
    v_rcp_f32 v24, v24
    v_rcp_f32 v25, v25
    v_rcp_f32 v26, v26
    v_rcp_f32 v27, v27
    v_mul_f32 v24, v20, v24
    v_mul_f32 v25, v21, v25
    v_mul_f32 v26, v22, v26
    v_mul_f32 v27, v23, v27
    v_cvt_pk_bf16_f32 v38, v24, v25
    v_cvt_pk_bf16_f32 v39, v26, v27
    v_lshlrev_b32 v20, 16, v40
    v_and_b32 v21, 0xffff0000, v40
    v_lshlrev_b32 v22, 16, v41
    v_and_b32 v23, 0xffff0000, v41
    v_mul_f32 v24, s34, v20
    v_mul_f32 v25, s34, v21
    v_mul_f32 v26, s34, v22
    v_mul_f32 v27, s34, v23
    v_exp_f32 v24, v24
    v_exp_f32 v25, v25
    v_exp_f32 v26, v26
    v_exp_f32 v27, v27
    v_add_f32 v24, 1.0, v24
    v_add_f32 v25, 1.0, v25
    v_add_f32 v26, 1.0, v26
    v_add_f32 v27, 1.0, v27
    v_rcp_f32 v24, v24
    v_rcp_f32 v25, v25
    v_rcp_f32 v26, v26
    v_rcp_f32 v27, v27
    v_mul_f32 v24, v20, v24
    v_mul_f32 v25, v21, v25
    v_mul_f32 v26, v22, v26
    v_mul_f32 v27, v23, v27
    v_cvt_pk_bf16_f32 v40, v24, v25
    v_cvt_pk_bf16_f32 v41, v26, v27
    v_lshlrev_b32 v20, 16, v42
    v_and_b32 v21, 0xffff0000, v42
    v_lshlrev_b32 v22, 16, v43
    v_and_b32 v23, 0xffff0000, v43
    v_mul_f32 v24, s34, v20
    v_mul_f32 v25, s34, v21
    v_mul_f32 v26, s34, v22
    v_mul_f32 v27, s34, v23
    v_exp_f32 v24, v24
    v_exp_f32 v25, v25
    v_exp_f32 v26, v26
    v_exp_f32 v27, v27
    v_add_f32 v24, 1.0, v24
    v_add_f32 v25, 1.0, v25
    v_add_f32 v26, 1.0, v26
    v_add_f32 v27, 1.0, v27
    v_rcp_f32 v24, v24
    v_rcp_f32 v25, v25
    v_rcp_f32 v26, v26
    v_rcp_f32 v27, v27
    v_mul_f32 v24, v20, v24
    v_mul_f32 v25, v21, v25
    v_mul_f32 v26, v22, v26
    v_mul_f32 v27, v23, v27
    v_cvt_pk_bf16_f32 v42, v24, v25
    v_cvt_pk_bf16_f32 v43, v26, v27
    v_lshlrev_b32 v20, 16, v44
    v_and_b32 v21, 0xffff0000, v44
    v_lshlrev_b32 v22, 16, v45
    v_and_b32 v23, 0xffff0000, v45
    v_mul_f32 v24, s34, v20
    v_mul_f32 v25, s34, v21
    v_mul_f32 v26, s34, v22
    v_mul_f32 v27, s34, v23
    v_exp_f32 v24, v24
    v_exp_f32 v25, v25
    v_exp_f32 v26, v26
    v_exp_f32 v27, v27
    v_add_f32 v24, 1.0, v24
    v_add_f32 v25, 1.0, v25
    v_add_f32 v26, 1.0, v26
    v_add_f32 v27, 1.0, v27
    v_rcp_f32 v24, v24
    v_rcp_f32 v25, v25
    v_rcp_f32 v26, v26
    v_rcp_f32 v27, v27
    v_mul_f32 v24, v20, v24
    v_mul_f32 v25, v21, v25
    v_mul_f32 v26, v22, v26
    v_mul_f32 v27, v23, v27
    v_cvt_pk_bf16_f32 v44, v24, v25
    v_cvt_pk_bf16_f32 v45, v26, v27
    v_lshlrev_b32 v20, 16, v46
    v_and_b32 v21, 0xffff0000, v46
    v_lshlrev_b32 v22, 16, v47
    v_and_b32 v23, 0xffff0000, v47
    v_mul_f32 v24, s34, v20
    v_mul_f32 v25, s34, v21
    v_mul_f32 v26, s34, v22
    v_mul_f32 v27, s34, v23
    v_exp_f32 v24, v24
    v_exp_f32 v25, v25
    v_exp_f32 v26, v26
    v_exp_f32 v27, v27
    v_add_f32 v24, 1.0, v24
    v_add_f32 v25, 1.0, v25
    v_add_f32 v26, 1.0, v26
    v_add_f32 v27, 1.0, v27
    v_rcp_f32 v24, v24
    v_rcp_f32 v25, v25
    v_rcp_f32 v26, v26
    v_rcp_f32 v27, v27
    v_mul_f32 v24, v20, v24
    v_mul_f32 v25, v21, v25
    v_mul_f32 v26, v22, v26
    v_mul_f32 v27, v23, v27
    v_cvt_pk_bf16_f32 v46, v24, v25
    v_cvt_pk_bf16_f32 v47, v26, v27
    v_lshlrev_b32 v20, 16, v48
    v_and_b32 v21, 0xffff0000, v48
    v_lshlrev_b32 v22, 16, v49
    v_and_b32 v23, 0xffff0000, v49
    v_mul_f32 v24, s34, v20
    v_mul_f32 v25, s34, v21
    v_mul_f32 v26, s34, v22
    v_mul_f32 v27, s34, v23
    v_exp_f32 v24, v24
    v_exp_f32 v25, v25
    v_exp_f32 v26, v26
    v_exp_f32 v27, v27
    v_add_f32 v24, 1.0, v24
    v_add_f32 v25, 1.0, v25
    v_add_f32 v26, 1.0, v26
    v_add_f32 v27, 1.0, v27
    v_rcp_f32 v24, v24
    v_rcp_f32 v25, v25
    v_rcp_f32 v26, v26
    v_rcp_f32 v27, v27
    v_mul_f32 v24, v20, v24
    v_mul_f32 v25, v21, v25
    v_mul_f32 v26, v22, v26
    v_mul_f32 v27, v23, v27
    v_cvt_pk_bf16_f32 v48, v24, v25
    v_cvt_pk_bf16_f32 v49, v26, v27
    v_lshlrev_b32 v20, 16, v50
    v_and_b32 v21, 0xffff0000, v50
    v_lshlrev_b32 v22, 16, v51
    v_and_b32 v23, 0xffff0000, v51
    v_mul_f32 v24, s34, v20
    v_mul_f32 v25, s34, v21
    v_mul_f32 v26, s34, v22
    v_mul_f32 v27, s34, v23
    v_exp_f32 v24, v24
    v_exp_f32 v25, v25
    v_exp_f32 v26, v26
    v_exp_f32 v27, v27
    v_add_f32 v24, 1.0, v24
    v_add_f32 v25, 1.0, v25
    v_add_f32 v26, 1.0, v26
    v_add_f32 v27, 1.0, v27
    v_rcp_f32 v24, v24
    v_rcp_f32 v25, v25
    v_rcp_f32 v26, v26
    v_rcp_f32 v27, v27
    v_mul_f32 v24, v20, v24
    v_mul_f32 v25, v21, v25
    v_mul_f32 v26, v22, v26
    v_mul_f32 v27, v23, v27
    v_cvt_pk_bf16_f32 v50, v24, v25
    v_cvt_pk_bf16_f32 v51, v26, v27
    s_cmp_ge_u32 s52, 10
    s_cbranch_scc1 L_nostats
    v_mov_b32 v20, 0
    v_mov_b32 v21, 0
    v_mov_b32 v22, 0x3f803f80
    v_dot2c_f32_bf16 v20, v52, v22
    v_dot2c_f32_bf16 v21, v52, v52
    v_dot2c_f32_bf16 v20, v53, v22
    v_dot2c_f32_bf16 v21, v53, v53
    v_dot2c_f32_bf16 v20, v54, v22
    v_dot2c_f32_bf16 v21, v54, v54
    v_dot2c_f32_bf16 v20, v55, v22
    v_dot2c_f32_bf16 v21, v55, v55
    v_dot2c_f32_bf16 v20, v56, v22
    v_dot2c_f32_bf16 v21, v56, v56
    v_dot2c_f32_bf16 v20, v57, v22
    v_dot2c_f32_bf16 v21, v57, v57
    v_dot2c_f32_bf16 v20, v58, v22
    v_dot2c_f32_bf16 v21, v58, v58
    v_dot2c_f32_bf16 v20, v59, v22
    v_dot2c_f32_bf16 v21, v59, v59
    v_dot2c_f32_bf16 v20, v60, v22
    v_dot2c_f32_bf16 v21, v60, v60
    v_dot2c_f32_bf16 v20, v61, v22
    v_dot2c_f32_bf16 v21, v61, v61
    v_dot2c_f32_bf16 v20, v62, v22
    v_dot2c_f32_bf16 v21, v62, v62
    v_dot2c_f32_bf16 v20, v63, v22
    v_dot2c_f32_bf16 v21, v63, v63
    v_dot2c_f32_bf16 v20, v64, v22
    v_dot2c_f32_bf16 v21, v64, v64
    v_dot2c_f32_bf16 v20, v65, v22
    v_dot2c_f32_bf16 v21, v65, v65
    v_dot2c_f32_bf16 v20, v66, v22
    v_dot2c_f32_bf16 v21, v66, v66
    v_dot2c_f32_bf16 v20, v67, v22
    v_dot2c_f32_bf16 v21, v67, v67
    v_dot2c_f32_bf16 v20, v68, v22
    v_dot2c_f32_bf16 v21, v68, v68
    v_dot2c_f32_bf16 v20, v69, v22
    v_dot2c_f32_bf16 v21, v69, v69
    v_dot2c_f32_bf16 v20, v70, v22
    v_dot2c_f32_bf16 v21, v70, v70
    v_dot2c_f32_bf16 v20, v71, v22
    v_dot2c_f32_bf16 v21, v71, v71
    s_nop 1
    v_add_f32_dpp v20, v20, v20 row_ror:4 row_mask:0xf bank_mask:0xf
    v_add_f32_dpp v21, v21, v21 row_ror:4 row_mask:0xf bank_mask:0xf
    s_nop 0
    v_add_f32_dpp v20, v20, v20 row_ror:8 row_mask:0xf bank_mask:0xf
    v_add_f32_dpp v21, v21, v21 row_ror:8 row_mask:0xf bank_mask:0xf
    v_mov_b32 v22, v20
    v_mov_b32 v23, v21
    s_nop 0
    v_permlane16_swap_b32 v20, v22
    v_permlane16_swap_b32 v21, v23
    v_add_f32 v20, v20, v22
    v_add_f32 v21, v21, v23
    v_mov_b32 v22, v20
    v_mov_b32 v23, v21
    s_nop 0
    v_permlane32_swap_b32 v20, v22
    v_permlane32_swap_b32 v21, v23
    v_add_f32 v20, v20, v22
    v_add_f32 v21, v21, v23
    v_mul_f32 v22, 0x3acccccd, v20
    v_mul_f32 v21, 0x3acccccd, v21
    v_fma_f32 v21, -v22, v22, v21
    v_max_f32 v21, 0, v21
    v_add_f32 v21, 0x3727c5ac, v21
    v_rsq_f32 v20, v21
    s_nop 0
    v_mul_f32_e64 v21, -v22, v20
    v_lshlrev_b32 v24, 16, v72
    v_and_b32 v25, 0xffff0000, v72
    v_lshlrev_b32 v26, 16, v73
    v_and_b32 v27, 0xffff0000, v73
    v_fma_f32 v24, v24, v20, v21
    v_fma_f32 v25, v25, v20, v21
    v_fma_f32 v26, v26, v20, v21
    v_fma_f32 v27, v27, v20, v21
L_nostats:
    s_waitcnt vmcnt(20)
    ds_read_b64_tr_b16 v[96:97], v15 offset:0
    ds_read_b64_tr_b16 v[98:99], v15 offset:512
    ds_read_b64_tr_b16 v[100:101], v15 offset:32
    ds_read_b64_tr_b16 v[102:103], v15 offset:544
    ds_read_b64_tr_b16 v[104:105], v15 offset:64
    ds_read_b64_tr_b16 v[106:107], v15 offset:576
    ds_read_b64_tr_b16 v[108:109], v15 offset:96
    ds_read_b64_tr_b16 v[110:111], v15 offset:608
    s_waitcnt lgkmcnt(7)
    ds_read_b64_tr_b16 v[112:113], v15 offset:4096
    ds_read_b64_tr_b16 v[114:115], v15 offset:4608
    ds_read_b64_tr_b16 v[116:117], v15 offset:4128
    ds_read_b64_tr_b16 v[118:119], v15 offset:4640
    ds_read_b64_tr_b16 v[120:121], v15 offset:4160
    ds_read_b64_tr_b16 v[122:123], v15 offset:4672
    ds_read_b64_tr_b16 v[124:125], v15 offset:4192
    ds_read_b64_tr_b16 v[126:127], v15 offset:4704
    s_waitcnt lgkmcnt(7)
    ds_read_b64_tr_b16 v[128:129], v15 offset:8192
    ds_read_b64_tr_b16 v[130:131], v15 offset:8704
    ds_read_b64_tr_b16 v[132:133], v15 offset:8224
    ds_read_b64_tr_b16 v[134:135], v15 offset:8736
    ds_read_b64_tr_b16 v[136:137], v15 offset:8256
    ds_read_b64_tr_b16 v[138:139], v15 offset:8768
    ds_read_b64_tr_b16 v[140:141], v15 offset:8288
    ds_read_b64_tr_b16 v[142:143], v15 offset:8800
    s_waitcnt lgkmcnt(7)
    ds_read_b64_tr_b16 v[144:145], v15 offset:12288
    ds_read_b64_tr_b16 v[146:147], v15 offset:12800
    ds_read_b64_tr_b16 v[148:149], v15 offset:12320
    ds_read_b64_tr_b16 v[150:151], v15 offset:12832
    ds_read_b64_tr_b16 v[152:153], v15 offset:12352
    ds_read_b64_tr_b16 v[154:155], v15 offset:12864
    ds_read_b64_tr_b16 v[156:157], v15 offset:12384
    ds_read_b64_tr_b16 v[158:159], v15 offset:12896
    s_waitcnt lgkmcnt(7)
    ds_read_b64_tr_b16 v[160:161], v15 offset:16384
    ds_read_b64_tr_b16 v[162:163], v15 offset:16896
    ds_read_b64_tr_b16 v[164:165], v15 offset:16416
    ds_read_b64_tr_b16 v[166:167], v15 offset:16928
    ds_read_b64_tr_b16 v[168:169], v15 offset:16448
    ds_read_b64_tr_b16 v[170:171], v15 offset:16960
    ds_read_b64_tr_b16 v[172:173], v15 offset:16480
    ds_read_b64_tr_b16 v[174:175], v15 offset:16992
    s_waitcnt lgkmcnt(0)
    v_mfma_f32_16x16x32_bf16 v[80:83], v[96:99], v[32:35], 0
    v_mfma_f32_16x16x32_bf16 v[84:87], v[100:103], v[32:35], 0
    v_mfma_f32_16x16x32_bf16 v[88:91], v[104:107], v[32:35], 0
    v_mfma_f32_16x16x32_bf16 v[92:95], v[108:111], v[32:35], 0
    v_mfma_f32_16x16x32_bf16 v[80:83], v[112:115], v[36:39], v[80:83]
    v_mfma_f32_16x16x32_bf16 v[84:87], v[116:119], v[36:39], v[84:87]
    v_mfma_f32_16x16x32_bf16 v[88:91], v[120:123], v[36:39], v[88:91]
    v_mfma_f32_16x16x32_bf16 v[92:95], v[124:127], v[36:39], v[92:95]
    v_mfma_f32_16x16x32_bf16 v[80:83], v[128:131], v[40:43], v[80:83]
    v_mfma_f32_16x16x32_bf16 v[84:87], v[132:135], v[40:43], v[84:87]
    v_mfma_f32_16x16x32_bf16 v[88:91], v[136:139], v[40:43], v[88:91]
    v_mfma_f32_16x16x32_bf16 v[92:95], v[140:143], v[40:43], v[92:95]
    v_mfma_f32_16x16x32_bf16 v[80:83], v[144:147], v[44:47], v[80:83]
    v_mfma_f32_16x16x32_bf16 v[84:87], v[148:151], v[44:47], v[84:87]
    v_mfma_f32_16x16x32_bf16 v[88:91], v[152:155], v[44:47], v[88:91]
    v_mfma_f32_16x16x32_bf16 v[92:95], v[156:159], v[44:47], v[92:95]
    v_mfma_f32_16x16x32_bf16 v[80:83], v[160:163], v[48:51], v[80:83]
    v_mfma_f32_16x16x32_bf16 v[84:87], v[164:167], v[48:51], v[84:87]
    v_mfma_f32_16x16x32_bf16 v[88:91], v[168:171], v[48:51], v[88:91]
    v_mfma_f32_16x16x32_bf16 v[92:95], v[172:175], v[48:51], v[92:95]
    s_cmp_ge_u32 s50, 20
    s_cbranch_scc1 L_adr_rest
    s_cmp_lt_u32 s50, 10
    s_cselect_b32 s34, 5120, 0
    s_cselect_b32 s35, s50, s52
    s_lshl_b32 s35, s35, 9
    s_add_u32 s34, s34, s35
    s_lshl_b32 s35, s51, 15
    s_add_u32 s34, s34, s35
    v_lshrrev_b32 v19, 1, v14
    v_lshl_add_u32 v19, v13, 1, v19
    v_lshlrev_b32 v19, 6, v19
    v_lshl_add_u32 v19, v12, 4, v19
    v_and_b32 v20, 1, v14
    v_lshl_add_u32 v19, v20, 3, v19
    s_branch L_adr_done
L_adr_rest:
    s_lshl_b32 s34, s51, 15
    s_lshl_b32 s35, s50, 9
    s_add_u32 s34, s34, s35
    s_add_u32 s34, s34, 0
    v_lshlrev_b32 v19, 7, v12
    v_lshl_add_u32 v19, v13, 5, v19
    v_lshl_add_u32 v19, v14, 3, v19
    s_nop 3
L_adr_done:
    v_add_u32 v19, s34, v19
    v_mov_b32_dpp v80, v84 quad_perm:[0,1,2,3] row_mask:0xf bank_mask:0x2
    v_mov_b32_dpp v81, v85 quad_perm:[0,1,2,3] row_mask:0xf bank_mask:0x2
    v_mov_b32_dpp v82, v86 quad_perm:[0,1,2,3] row_mask:0xf bank_mask:0x2
    v_mov_b32_dpp v83, v87 quad_perm:[0,1,2,3] row_mask:0xf bank_mask:0x2
    v_mov_b32_dpp v80, v88 quad_perm:[0,1,2,3] row_mask:0xf bank_mask:0x4
    v_mov_b32_dpp v81, v89 quad_perm:[0,1,2,3] row_mask:0xf bank_mask:0x4
    v_mov_b32_dpp v82, v90 quad_perm:[0,1,2,3] row_mask:0xf bank_mask:0x4
    v_mov_b32_dpp v83, v91 quad_perm:[0,1,2,3] row_mask:0xf bank_mask:0x4
    v_mov_b32_dpp v80, v92 quad_perm:[0,1,2,3] row_mask:0xf bank_mask:0x8
    v_mov_b32_dpp v81, v93 quad_perm:[0,1,2,3] row_mask:0xf bank_mask:0x8
    v_mov_b32_dpp v82, v94 quad_perm:[0,1,2,3] row_mask:0xf bank_mask:0x8
    v_mov_b32_dpp v83, v95 quad_perm:[0,1,2,3] row_mask:0xf bank_mask:0x8
    s_cmp_ge_u32 s52, 10
    s_cbranch_scc1 L_noz
    v_add_f32 v80, 0x3e800000, v80
    v_add_f32 v81, 0x3e800000, v81
    v_add_f32 v82, 0x3e800000, v82
    v_add_f32 v83, 0x3e800000, v83
    v_mul_f32 v80, v80, v24
    v_mul_f32 v81, v81, v25
    v_mul_f32 v82, v82, v26
    v_mul_f32 v83, v83, v27
L_noz:
    v_cvt_pk_bf16_f32 v20, v80, v81
    v_cvt_pk_bf16_f32 v21, v82, v83
    v_min_u32 v20, -2, v20
    v_min_u32 v21, -2, v21
    v_and_b32 v22, 15, v0
    v_lshlrev_b32 v22, 2, v22
    s_mov_b32 s35, 0
L_poll3:
    global_load_dword v23, v22, s[30:31] offset:128 sc1
    s_add_u32 s35, s35, 1
    s_waitcnt vmcnt(0)
    v_cmp_eq_u32 vcc, 0, v23
    s_cbranch_vccz L_done4
    s_sleep 8
    s_cmp_lt_u32 s35, 60000
    s_cbranch_scc1 L_poll3
L_done4:
    s_getreg_b32 s97, hwreg(HW_REG_XCC_ID, 0, 4)
    s_sub_u32 s97, s97, s2
    s_and_b32 s97, s97, 7
    s_add_u32 s97, s97, 1
    v_cmp_ne_u32 vcc, s97, v23
    s_nop 0
    s_mov_b32 s97, vcc_lo
    buffer_store_dwordx2 v[20:21], v19, s[44:47], 0 offen sc1
    s_branch L_p2
L_clear:
    s_sub_u32 s55, s2, 240
    s_lshr_b32 s34, s55, 2
    s_lshl_b32 s35, s34, 3
    s_lshr_b32 s54, 538910750, s35
    s_and_b32 s54, s54, 0xff
    s_lshl_b32 s54, s54, 10
    s_mul_i32 s34, s34, 393216
    s_lshl_b32 s35, s51, 15
    s_add_u32 s34, s34, s35
    v_lshl_add_u32 v19, v0, 4, s34
    v_mov_b32 v20, -1
    v_mov_b32 v21, -1
    v_mov_b32 v22, -1
    v_mov_b32 v23, -1
    s_mov_b32 s34, 0
L_clrloop:
    buffer_store_dwordx4 v[20:23], v19, s[44:47], s34 offen offset:0 sc1
    s_add_u32 s34, s34, 1024
    s_cmp_lt_u32 s34, s54
    s_cbranch_scc1 L_clrloop
L_clrend:
    s_cmp_ge_u32 s55, 4
    s_cbranch_scc1 L_clrend2
    s_mov_b32 s34, 1572864
    buffer_store_dwordx4 v[20:23], v19, s[44:47], s34 offen sc1
    s_mov_b32 s34, 1573888
    buffer_store_dwordx4 v[20:23], v19, s[44:47], s34 offen sc1
    s_mov_b32 s34, 1574912
    buffer_store_dwordx4 v[20:23], v19, s[44:47], s34 offen sc1
    s_mov_b32 s34, 1575936
    buffer_store_dwordx4 v[20:23], v19, s[44:47], s34 offen sc1
    s_mov_b32 s34, 1576960
    buffer_store_dwordx4 v[20:23], v19, s[44:47], s34 offen sc1
L_clrend2:
    v_lshlrev_b32 v1, 2, v0
    v_add_u32 v1, 98304, v1
    v_mov_b32 v2, -1
    v_mov_b32 v3, 0
    ds_write_b32 v1, v2
    ds_write_b32 v1, v2 offset:256
    ds_write_b32 v1, v3 offset:512
    ds_write_b32 v1, v3 offset:768
    s_waitcnt lgkmcnt(0)
    s_barrier
    s_lshl_b32 s34, s55, 2
    v_mov_b32 v24, s34
    s_getreg_b32 s97, hwreg(HW_REG_XCC_ID, 0, 4)
    s_sub_u32 s97, s97, s2
    s_and_b32 s97, s97, 7
    s_add_u32 s97, s97, 1
    v_mov_b32 v25, s97
    v_readfirstlane_b32 s90, v19
    s_mov_b32 s91, 0
    s_waitcnt vmcnt(0)
    s_mov_b64 exec, 1
    global_store_dword v24, v25, s[30:31] offset:128 sc1
    s_mov_b64 exec, -1
    s_and_b32 s34, s2, 31
    s_lshl_b32 s34, s34, 8
    s_lshr_b32 s35, s2, 7
    s_lshl_b32 s35, s35, 7
    s_add_u32 s49, s34, s35
    s_bfe_u32 s53, s2, 0x20005
    s_mul_i32 s34, s53, 1310720
    s_add_u32 s34, s34, s49
    v_lshl_add_u32 v16, v10, 13, v11
    v_add_u32 v16, s34, v16
    s_mov_b32 s36, s10
    s_mov_b32 s37, s11
    s_mov_b32 s38, 5242880
    s_mov_b32 m0, 20480
    s_mov_b32 s34, 0
L_dma6:
    buffer_load_dwordx4 v16, s[36:39], s34 offen  lds
    s_add_u32 m0, m0, 1024
    s_add_u32 s34, s34, 65536
    buffer_load_dwordx4 v16, s[36:39], s34 offen  lds
    s_add_u32 m0, m0, 1024
    s_add_u32 s34, s34, 65536
    buffer_load_dwordx4 v16, s[36:39], s34 offen  lds
    s_add_u32 m0, m0, 1024
    s_add_u32 s34, s34, 65536
    buffer_load_dwordx4 v16, s[36:39], s34 offen  lds
    s_add_u32 m0, m0, 1024
    s_add_u32 s34, s34, 65536
    s_cmp_lt_u32 s34, 1310720
    s_cbranch_scc1 L_dma6
    v_lshl_add_u32 v15, v14, 3, v13
    v_lshlrev_b32 v15, 7, v15
    v_lshl_add_u32 v15, v12, 3, v15
    s_add_u32 s34, s90, 0
    s_add_u32 s35, s90, 8192
    s_mov_b64 s[88:89], 0
    s_load_dword s88, s[44:45], s34
    s_load_dword s89, s[44:45], s35
    s_waitcnt lgkmcnt(1)
    s_cmp_lg_u32 s89, 0
    s_addc_u32 s91, s91, 0
    s_waitcnt lgkmcnt(0)
    s_add_u32 s34, s90, 1024
    s_add_u32 s35, s90, 9216
    s_mov_b64 s[88:89], 0
    s_load_dword s89, s[44:45], s35
    s_load_dword s88, s[44:45], s34
    s_waitcnt lgkmcnt(1)
    s_cmp_eq_u32 s88, 0
    s_addc_u32 s91, s91, 0
    s_waitcnt lgkmcnt(0)
    s_add_u32 s34, s90, 2048
    s_add_u32 s35, s90, 10240
    s_mov_b64 s[88:89], 0
    s_load_dword s88, s[44:45], s34
    s_load_dword s89, s[44:45], s35
    s_waitcnt lgkmcnt(1)
    s_cmp_lg_u32 s89, 0
    s_addc_u32 s91, s91, 0
    s_waitcnt lgkmcnt(0)
    s_add_u32 s34, s90, 3072
    s_add_u32 s35, s90, 11264
    s_mov_b64 s[88:89], 0
    s_load_dword s89, s[44:45], s35
    s_load_dword s88, s[44:45], s34
    s_waitcnt lgkmcnt(1)
    s_cmp_eq_u32 s88, 0
    s_addc_u32 s91, s91, 0
    s_waitcnt lgkmcnt(0)
    s_getreg_b32 s34, hwreg(HW_REG_XCC_ID, 2, 1)
    s_sub_u32 s35, 2, s91
    s_sub_u32 s91, s91, 2
    s_cmp_eq_u32 s34, 0
    s_cselect_b32 s91, s91, s35
    v_mov_b32 v25, s91
    s_mov_b64 exec, 1
    global_store_dword v24, v25, s[30:31] sc1
    s_mov_b64 exec, -1
    v_and_b32 v22, 15, v0
    v_lshlrev_b32 v22, 2, v22
    s_mov_b32 s35, 0
L_poll7:
    global_load_dword v23, v22, s[30:31] offset:128 sc1
    s_add_u32 s35, s35, 1
    s_waitcnt vmcnt(0)
    v_cmp_eq_u32 vcc, 0, v23
    s_cbranch_vccz L_done8
    s_sleep 8
    s_cmp_lt_u32 s35, 60000
    s_cbranch_scc1 L_poll7
L_done8:
    s_getreg_b32 s97, hwreg(HW_REG_XCC_ID, 0, 4)
    s_sub_u32 s97, s97, s2
    s_and_b32 s97, s97, 7
    s_add_u32 s97, s97, 1
    v_cmp_ne_u32 vcc, s97, v23
    s_nop 0
    s_mov_b32 s97, vcc_lo
L_p2:
    v_mov_b32 v199, v19
    ds_read_b64_tr_b16 v[96:97], v15 offset:20480
    ds_read_b64_tr_b16 v[98:99], v15 offset:20992
    ds_read_b64_tr_b16 v[100:101], v15 offset:20512
    ds_read_b64_tr_b16 v[102:103], v15 offset:21024
    ds_read_b64_tr_b16 v[104:105], v15 offset:20544
    ds_read_b64_tr_b16 v[106:107], v15 offset:21056
    ds_read_b64_tr_b16 v[108:109], v15 offset:20576
    ds_read_b64_tr_b16 v[110:111], v15 offset:21088
    s_waitcnt lgkmcnt(7)
    ds_read_b64_tr_b16 v[112:113], v15 offset:24576
    ds_read_b64_tr_b16 v[114:115], v15 offset:25088
    ds_read_b64_tr_b16 v[116:117], v15 offset:24608
    ds_read_b64_tr_b16 v[118:119], v15 offset:25120
    ds_read_b64_tr_b16 v[120:121], v15 offset:24640
    ds_read_b64_tr_b16 v[122:123], v15 offset:25152
    ds_read_b64_tr_b16 v[124:125], v15 offset:24672
    ds_read_b64_tr_b16 v[126:127], v15 offset:25184
    s_waitcnt lgkmcnt(7)
    ds_read_b64_tr_b16 v[128:129], v15 offset:28672
    ds_read_b64_tr_b16 v[130:131], v15 offset:29184
    ds_read_b64_tr_b16 v[132:133], v15 offset:28704
    ds_read_b64_tr_b16 v[134:135], v15 offset:29216
    ds_read_b64_tr_b16 v[136:137], v15 offset:28736
    ds_read_b64_tr_b16 v[138:139], v15 offset:29248
    ds_read_b64_tr_b16 v[140:141], v15 offset:28768
    ds_read_b64_tr_b16 v[142:143], v15 offset:29280
    s_waitcnt lgkmcnt(7)
    ds_read_b64_tr_b16 v[144:145], v15 offset:32768
    ds_read_b64_tr_b16 v[146:147], v15 offset:33280
    ds_read_b64_tr_b16 v[148:149], v15 offset:32800
    ds_read_b64_tr_b16 v[150:151], v15 offset:33312
    ds_read_b64_tr_b16 v[152:153], v15 offset:32832
    ds_read_b64_tr_b16 v[154:155], v15 offset:33344
    ds_read_b64_tr_b16 v[156:157], v15 offset:32864
    ds_read_b64_tr_b16 v[158:159], v15 offset:33376
    s_waitcnt lgkmcnt(7)
    ds_read_b64_tr_b16 v[160:161], v15 offset:36864
    ds_read_b64_tr_b16 v[162:163], v15 offset:37376
    ds_read_b64_tr_b16 v[164:165], v15 offset:36896
    ds_read_b64_tr_b16 v[166:167], v15 offset:37408
    ds_read_b64_tr_b16 v[168:169], v15 offset:36928
    ds_read_b64_tr_b16 v[170:171], v15 offset:37440
    ds_read_b64_tr_b16 v[172:173], v15 offset:36960
    ds_read_b64_tr_b16 v[174:175], v15 offset:37472
    s_waitcnt lgkmcnt(0)
    s_mul_i32 s34, s53, 1280
    v_lshlrev_b32 v19, 15, v13
    v_lshl_add_u32 v19, v14, 6, v19
    v_lshl_add_u32 v19, v12, 4, v19
    v_add_u32 v19, s34, v19
    s_movk_i32 s48, 5120
    s_mov_b32 s56, 32768
    s_mov_b32 s57, 65536
    s_mov_b32 s58, 98304
    s_sub_u32 s34, s2, 80
    s_cmp_lt_u32 s34, 160
    s_cselect_b32 s54, 1, 0
    s_and_b32 s34, s2, 3
    s_cselect_b32 s54, 0, s54
    v_mov_b32 v180, 0
    v_mov_b32 v181, 0
    v_mov_b32 v182, 0
    v_mov_b32 v183, 0
    v_mov_b32 v184, 0
    v_mov_b32 v185, 0
    v_mov_b32 v186, 0
    v_mov_b32 v187, 0
    v_mov_b32 v22, 99072
    s_mov_b32 s35, 0
L_poll10:
    ds_read_b32 v23, v22
    s_add_u32 s35, s35, 1
    s_waitcnt lgkmcnt(0)
    v_cmp_gt_u32 vcc, 21, v23
    s_cbranch_vccz L_done11
    s_sleep 2
    s_cmp_lt_u32 s35, 60000
    s_cbranch_scc1 L_poll10
L_done11:
    s_mov_b32 s35, 0
L_poll13:
    buffer_load_dwordx4 v[32:35], v19, s[44:47], 0 offen offset:0 sc1
    buffer_load_dwordx4 v[36:39], v19, s[44:47], s48 offen offset:0 sc1
    buffer_load_dwordx4 v[40:43], v19, s[44:47], 0 offen offset:256 sc1
    buffer_load_dwordx4 v[44:47], v19, s[44:47], s48 offen offset:256 sc1
    buffer_load_dwordx4 v[48:51], v19, s[44:47], 0 offen offset:512 sc1
    buffer_load_dwordx4 v[52:55], v19, s[44:47], s48 offen offset:512 sc1
    buffer_load_dwordx4 v[56:59], v19, s[44:47], 0 offen offset:768 sc1
    buffer_load_dwordx4 v[60:63], v19, s[44:47], s48 offen offset:768 sc1
    buffer_load_dwordx4 v[64:67], v19, s[44:47], 0 offen offset:1024 sc1
    buffer_load_dwordx4 v[68:71], v19, s[44:47], s48 offen offset:1024 sc1
    s_cmp_eq_u32 s54, 0
    s_cbranch_scc1 L_hskip
    buffer_load_dwordx2 v[180:181], v199, s[44:47], 0 offen sc1
    buffer_load_dwordx2 v[182:183], v199, s[44:47], s56 offen sc1
    buffer_load_dwordx2 v[184:185], v199, s[44:47], s57 offen sc1
    buffer_load_dwordx2 v[186:187], v199, s[44:47], s58 offen sc1
L_hskip:
    s_add_u32 s35, s35, 1
    s_waitcnt vmcnt(0)
    v_max3_u32 v20, v32, v33, v34
    v_max3_u32 v20, v20, v35, v36
    v_max3_u32 v20, v20, v37, v38
    v_max3_u32 v20, v20, v39, v40
    v_max3_u32 v20, v20, v41, v42
    v_max3_u32 v20, v20, v43, v44
    v_max3_u32 v20, v20, v45, v46
    v_max3_u32 v20, v20, v47, v48
    v_max3_u32 v20, v20, v49, v50
    v_max3_u32 v20, v20, v51, v52
    v_max3_u32 v20, v20, v53, v54
    v_max3_u32 v20, v20, v55, v56
    v_max3_u32 v20, v20, v57, v58
    v_max3_u32 v20, v20, v59, v60
    v_max3_u32 v20, v20, v61, v62
    v_max3_u32 v20, v20, v63, v64
    v_max3_u32 v20, v20, v65, v66
    v_max3_u32 v20, v20, v67, v68
    v_max3_u32 v20, v20, v69, v70
    v_max3_u32 v20, v20, v71, v180
    v_max3_u32 v20, v20, v181, v182
    v_max3_u32 v20, v20, v183, v184
    v_max3_u32 v20, v20, v185, v186
    v_max_u32 v20, v20, v187
    v_cmp_eq_u32 vcc, -1, v20
    s_cbranch_vccz L_done14
    s_sleep 16
    s_cmp_lt_u32 s35, 60000
    s_cbranch_scc1 L_poll13
L_done14:
    v_mfma_f32_16x16x32_bf16 v[80:83], v[96:99], v[32:35], 0
    v_mfma_f32_16x16x32_bf16 v[84:87], v[100:103], v[32:35], 0
    v_mfma_f32_16x16x32_bf16 v[88:91], v[104:107], v[32:35], 0
    v_mfma_f32_16x16x32_bf16 v[92:95], v[108:111], v[32:35], 0
    v_mfma_f32_16x16x32_bf16 v[80:83], v[96:99], v[36:39], v[80:83]
    v_mfma_f32_16x16x32_bf16 v[84:87], v[100:103], v[36:39], v[84:87]
    v_mfma_f32_16x16x32_bf16 v[88:91], v[104:107], v[36:39], v[88:91]
    v_mfma_f32_16x16x32_bf16 v[92:95], v[108:111], v[36:39], v[92:95]
    v_mfma_f32_16x16x32_bf16 v[80:83], v[112:115], v[40:43], v[80:83]
    v_mfma_f32_16x16x32_bf16 v[84:87], v[116:119], v[40:43], v[84:87]
    v_mfma_f32_16x16x32_bf16 v[88:91], v[120:123], v[40:43], v[88:91]
    v_mfma_f32_16x16x32_bf16 v[92:95], v[124:127], v[40:43], v[92:95]
    v_mfma_f32_16x16x32_bf16 v[80:83], v[112:115], v[44:47], v[80:83]
    v_mfma_f32_16x16x32_bf16 v[84:87], v[116:119], v[44:47], v[84:87]
    v_mfma_f32_16x16x32_bf16 v[88:91], v[120:123], v[44:47], v[88:91]
    v_mfma_f32_16x16x32_bf16 v[92:95], v[124:127], v[44:47], v[92:95]
    v_mfma_f32_16x16x32_bf16 v[80:83], v[128:131], v[48:51], v[80:83]
    v_mfma_f32_16x16x32_bf16 v[84:87], v[132:135], v[48:51], v[84:87]
    v_mfma_f32_16x16x32_bf16 v[88:91], v[136:139], v[48:51], v[88:91]
    v_mfma_f32_16x16x32_bf16 v[92:95], v[140:143], v[48:51], v[92:95]
    v_mfma_f32_16x16x32_bf16 v[80:83], v[128:131], v[52:55], v[80:83]
    v_mfma_f32_16x16x32_bf16 v[84:87], v[132:135], v[52:55], v[84:87]
    v_mfma_f32_16x16x32_bf16 v[88:91], v[136:139], v[52:55], v[88:91]
    v_mfma_f32_16x16x32_bf16 v[92:95], v[140:143], v[52:55], v[92:95]
    v_mfma_f32_16x16x32_bf16 v[80:83], v[144:147], v[56:59], v[80:83]
    v_mfma_f32_16x16x32_bf16 v[84:87], v[148:151], v[56:59], v[84:87]
    v_mfma_f32_16x16x32_bf16 v[88:91], v[152:155], v[56:59], v[88:91]
    v_mfma_f32_16x16x32_bf16 v[92:95], v[156:159], v[56:59], v[92:95]
    v_mfma_f32_16x16x32_bf16 v[80:83], v[144:147], v[60:63], v[80:83]
    v_mfma_f32_16x16x32_bf16 v[84:87], v[148:151], v[60:63], v[84:87]
    v_mfma_f32_16x16x32_bf16 v[88:91], v[152:155], v[60:63], v[88:91]
    v_mfma_f32_16x16x32_bf16 v[92:95], v[156:159], v[60:63], v[92:95]
    v_mfma_f32_16x16x32_bf16 v[80:83], v[160:163], v[64:67], v[80:83]
    v_mfma_f32_16x16x32_bf16 v[84:87], v[164:167], v[64:67], v[84:87]
    v_mfma_f32_16x16x32_bf16 v[88:91], v[168:171], v[64:67], v[88:91]
    v_mfma_f32_16x16x32_bf16 v[92:95], v[172:175], v[64:67], v[92:95]
    v_mfma_f32_16x16x32_bf16 v[80:83], v[160:163], v[68:71], v[80:83]
    v_mfma_f32_16x16x32_bf16 v[84:87], v[164:167], v[68:71], v[84:87]
    v_mfma_f32_16x16x32_bf16 v[88:91], v[168:171], v[68:71], v[88:91]
    v_mfma_f32_16x16x32_bf16 v[92:95], v[172:175], v[68:71], v[92:95]
    s_lshl_b32 s34, s53, 15
    s_lshl_b32 s35, s49, 2
    s_add_u32 s34, s34, s35
    s_add_u32 s34, s34, 393216
    v_lshlrev_b32 v19, 7, v12
    v_lshl_add_u32 v19, v13, 5, v19
    v_lshl_add_u32 v19, v14, 3, v19
    v_add_u32 v19, s34, v19
    v_add_f32_dpp v20, v80, v80 row_ror:8 row_mask:0xf bank_mask:0x3
    v_add_f32_dpp v24, v84, v84 row_ror:8 row_mask:0xf bank_mask:0x3
    v_add_f32_dpp v21, v81, v81 row_ror:8 row_mask:0xf bank_mask:0x3
    v_add_f32_dpp v25, v85, v85 row_ror:8 row_mask:0xf bank_mask:0x3
    v_add_f32_dpp v22, v82, v82 row_ror:8 row_mask:0xf bank_mask:0x3
    v_add_f32_dpp v26, v86, v86 row_ror:8 row_mask:0xf bank_mask:0x3
    v_add_f32_dpp v23, v83, v83 row_ror:8 row_mask:0xf bank_mask:0x3
    v_add_f32_dpp v27, v87, v87 row_ror:8 row_mask:0xf bank_mask:0x3
    v_add_f32_dpp v20, v88, v88 row_ror:8 row_mask:0xf bank_mask:0xc
    v_add_f32_dpp v24, v92, v92 row_ror:8 row_mask:0xf bank_mask:0xc
    v_add_f32_dpp v21, v89, v89 row_ror:8 row_mask:0xf bank_mask:0xc
    v_add_f32_dpp v25, v93, v93 row_ror:8 row_mask:0xf bank_mask:0xc
    v_add_f32_dpp v22, v90, v90 row_ror:8 row_mask:0xf bank_mask:0xc
    v_add_f32_dpp v26, v94, v94 row_ror:8 row_mask:0xf bank_mask:0xc
    v_add_f32_dpp v23, v91, v91 row_ror:8 row_mask:0xf bank_mask:0xc
    v_add_f32_dpp v27, v95, v95 row_ror:8 row_mask:0xf bank_mask:0xc
    v_add_f32_dpp v28, v20, v20 row_shl:4 row_mask:0xf bank_mask:0x5
    v_add_f32_dpp v29, v21, v21 row_shl:4 row_mask:0xf bank_mask:0x5
    v_add_f32_dpp v30, v22, v22 row_shl:4 row_mask:0xf bank_mask:0x5
    v_add_f32_dpp v31, v23, v23 row_shl:4 row_mask:0xf bank_mask:0x5
    v_add_f32_dpp v28, v24, v24 row_shr:4 row_mask:0xf bank_mask:0xa
    v_add_f32_dpp v29, v25, v25 row_shr:4 row_mask:0xf bank_mask:0xa
    v_add_f32_dpp v30, v26, v26 row_shr:4 row_mask:0xf bank_mask:0xa
    v_add_f32_dpp v31, v27, v27 row_shr:4 row_mask:0xf bank_mask:0xa
    v_cvt_pk_bf16_f32 v20, v28, v29
    v_cvt_pk_bf16_f32 v21, v30, v31
    v_min_u32 v20, -2, v20
    v_min_u32 v21, -2, v21
    buffer_store_dwordx2 v[20:21], v19, s[44:47], 0 offen sc1
    s_cmp_eq_u32 s54, 0
    s_cbranch_scc1 L_nomf
    v_lshlrev_b32 v24, 16, v180
    v_and_b32 v25, 0xffff0000, v180
    v_lshlrev_b32 v26, 16, v181
    v_and_b32 v27, 0xffff0000, v181
    v_lshlrev_b32 v28, 16, v182
    v_and_b32 v29, 0xffff0000, v182
    v_lshlrev_b32 v30, 16, v183
    v_and_b32 v31, 0xffff0000, v183
    v_add_f32 v24, v24, v28
    v_add_f32 v25, v25, v29
    v_add_f32 v26, v26, v30
    v_add_f32 v27, v27, v31
    v_lshlrev_b32 v28, 16, v184
    v_and_b32 v29, 0xffff0000, v184
    v_lshlrev_b32 v30, 16, v185
    v_and_b32 v31, 0xffff0000, v185
    v_add_f32 v24, v24, v28
    v_add_f32 v25, v25, v29
    v_add_f32 v26, v26, v30
    v_add_f32 v27, v27, v31
    v_lshlrev_b32 v28, 16, v186
    v_and_b32 v29, 0xffff0000, v186
    v_lshlrev_b32 v30, 16, v187
    v_and_b32 v31, 0xffff0000, v187
    v_add_f32 v24, v24, v28
    v_add_f32 v25, v25, v29
    v_add_f32 v26, v26, v30
    v_add_f32 v27, v27, v31
    v_cvt_pk_bf16_f32 v22, v24, v25
    v_cvt_pk_bf16_f32 v23, v26, v27
    v_min_u32 v22, -2, v22
    v_min_u32 v23, -2, v23
    s_sub_u32 s34, s50, 20
    s_lshl_b32 s35, s34, 9
    v_subrev_u32 v199, s35, v199
    s_lshr_b32 s35, s34, 2
    s_lshl_b32 s35, s35, 9
    s_and_b32 s34, s34, 3
    s_lshl_b32 s34, s34, 15
    s_add_u32 s34, s34, s35
    s_add_u32 s34, s34, 1562624
    v_add_u32 v199, s34, v199
    buffer_store_dwordx2 v[22:23], v199, s[44:47], 0 offen sc1
L_nomf:
    s_and_b32 s34, s2, 127
    s_lshl_b32 s34, s34, 21
    s_lshr_b32 s35, s2, 7
    s_lshl_b32 s35, s35, 18
    s_add_u32 s34, s34, s35
    s_add_u32 s34, s34, 1572864
    s_mov_b32 s38, 0x40000
    s_mov_b32 s42, 0x40000
    s_waitcnt lgkmcnt(0)
    s_add_u32 s36, s6, s34
    s_addc_u32 s37, s7, 0
    s_add_u32 s40, s8, s34
    s_addc_u32 s41, s9, 0
    v_lshlrev_b32 v18, 4, v0
    s_mov_b32 s34, 258048
    buffer_load_dwordx4 v[128:131], v18, s[36:39], s34 offen offset:0 nt
    buffer_load_dwordx4 v[132:135], v18, s[36:39], s34 offen offset:1024 nt
    buffer_load_dwordx4 v[136:139], v18, s[36:39], s34 offen offset:2048 nt
    buffer_load_dwordx4 v[140:143], v18, s[36:39], s34 offen offset:3072 nt
    s_and_b32 s34, s2, 31
    s_lshl_b32 s34, s34, 10
    s_lshl_b32 s35, s53, 7
    s_add_u32 s34, s34, s35
    s_add_u32 s34, s34, 393216
    v_lshrrev_b32 v19, 5, v0
    v_mul_u32_u24 v19, 384, v19
    v_lshl_add_u32 v19, v0, 2, v19
    v_add_u32 v19, s34, v19
    v_mov_b32 v22, 99072
    s_and_b32 s34, s60, 3
    s_lshl_b32 s34, s34, 15
    s_lshr_b32 s35, s60, 2
    s_lshl_b32 s35, s35, 7
    s_add_u32 s34, s34, s35
    s_add_u32 s34, s34, 793344
    v_and_b32 v252, 31, v0
    v_lshl_add_u32 v252, v252, 2, s34
    v_mov_b32 v253, 0
    s_mov_b32 s35, 0
L_poll16:
    ds_read_b32 v23, v22
    s_add_u32 s35, s35, 1
    s_waitcnt lgkmcnt(0)
    v_cmp_gt_u32 vcc, 33, v23
    s_cbranch_vccz L_done17
    s_sleep 2
    s_cmp_lt_u32 s35, 60000
    s_cbranch_scc1 L_poll16
L_done17:
    buffer_load_dword v251, v252, s[44:47], 0 offen sc1
    s_lshl_b64 exec, 1, s61
    buffer_store_dword v253, v252, s[44:47], 0 offen
    s_mov_b64 exec, -1
    v_and_b32 v44, 15, v0
    v_lshlrev_b32 v44, 2, v44
    global_load_dword v44, v44, s[30:31] sc1
    s_mov_b32 s35, 0
L_poll19:
    buffer_load_dword v32, v19, s[44:47], 0 offen sc1
    buffer_load_dword v33, v19, s[44:47], s56 offen sc1
    buffer_load_dword v34, v19, s[44:47], s57 offen sc1
    buffer_load_dword v35, v19, s[44:47], s58 offen sc1
    s_add_u32 s35, s35, 1
    s_waitcnt vmcnt(0)
    v_max3_u32 v22, v32, v33, v34
    v_max_u32 v22, v22, v35
    v_cmp_eq_u32 vcc, -1, v22
    s_cbranch_vccz L_done20
    s_sleep 16
    s_cmp_lt_u32 s35, 60000
    s_cbranch_scc1 L_poll19
L_done20:
    v_cmp_ne_u32 vcc, -1, v251
    v_mov_b32 v252, 99076
    s_bcnt1_i32_b32 s34, vcc_lo
    v_mov_b32 v251, s34
    s_mov_b64 exec, 1
    ds_write_b32 v252, v251
    s_mov_b64 exec, -1
    v_add_u32_dpp v44, v44, v44 row_ror:8 row_mask:0xf bank_mask:0xf
    s_nop 1
    v_add_u32_dpp v44, v44, v44 row_ror:4 row_mask:0xf bank_mask:0xf
    s_nop 1
    v_add_u32_dpp v44, v44, v44 row_ror:2 row_mask:0xf bank_mask:0xf
    s_nop 1
    v_add_u32_dpp v44, v44, v44 row_ror:1 row_mask:0xf bank_mask:0xf
    s_nop 0
    v_readfirstlane_b32 s99, v44
    s_nop 0
    s_cmp_gt_i32 s99, 0
    s_cselect_b32 s99, 1, 0
    s_getreg_b32 s34, hwreg(HW_REG_XCC_ID, 2, 1)
    s_xor_b32 s99, s99, s34
    s_lshl_b32 s99, s99, 13
    v_mov_b32 v45, 99080
    v_mov_b32 v44, s99
    ds_write_b32 v45, v44
    v_lshlrev_b32 v36, 16, v32
    v_and_b32 v37, 0xffff0000, v32
    v_lshlrev_b32 v38, 16, v33
    v_and_b32 v39, 0xffff0000, v33
    v_lshlrev_b32 v40, 16, v34
    v_and_b32 v41, 0xffff0000, v34
    v_lshlrev_b32 v42, 16, v35
    v_and_b32 v43, 0xffff0000, v35
    v_pk_add_f32 v[36:37], v[36:37], v[38:39]
    v_pk_add_f32 v[40:41], v[40:41], v[42:43]
    v_pk_add_f32 v[36:37], v[36:37], v[40:41]
    v_cvt_pk_bf16_f32 v32, v36, v37
    v_min_u32 v32, -2, v32
    ds_write_b32 v1, v32
    s_mov_b32 s34, 258048
    buffer_load_dwordx4 v[144:147], v18, s[40:43], s34 offen offset:0 nt
    buffer_load_dwordx4 v[148:151], v18, s[40:43], s34 offen offset:1024 nt
    buffer_load_dwordx4 v[152:155], v18, s[40:43], s34 offen offset:2048 nt
    buffer_load_dwordx4 v[156:159], v18, s[40:43], s34 offen offset:3072 nt
    v_and_b32 v2, 15, v0
    v_lshlrev_b32 v2, 4, v2
    v_add_u32 v2, 98304, v2
    ds_read_b128 v[4:7], v2
    s_waitcnt lgkmcnt(0)
    v_dot2_f32_bf16 v8, v128, v4, 0
    v_dot2_f32_bf16 v9, v132, v4, 0
    v_dot2_f32_bf16 v10, v136, v4, 0
    v_dot2_f32_bf16 v11, v140, v4, 0
    v_dot2c_f32_bf16 v8, v129, v5
    v_dot2c_f32_bf16 v9, v133, v5
    v_dot2c_f32_bf16 v10, v137, v5
    v_dot2c_f32_bf16 v11, v141, v5
    v_dot2c_f32_bf16 v8, v130, v6
    v_dot2c_f32_bf16 v9, v134, v6
    v_dot2c_f32_bf16 v10, v138, v6
    v_dot2c_f32_bf16 v11, v142, v6
    v_dot2c_f32_bf16 v8, v131, v7
    v_dot2c_f32_bf16 v9, v135, v7
    v_dot2c_f32_bf16 v10, v139, v7
    v_dot2c_f32_bf16 v11, v143, v7
    v_add_f32_dpp v16, v8, v8 row_ror:8 row_mask:0xf bank_mask:0x3
    v_add_f32_dpp v16, v9, v9 row_ror:8 row_mask:0xf bank_mask:0xc
    v_add_f32_dpp v17, v10, v10 row_ror:8 row_mask:0xf bank_mask:0x3
    v_add_f32_dpp v17, v11, v11 row_ror:8 row_mask:0xf bank_mask:0xc
    v_add_f32_dpp v16, v16, v16 row_half_mirror row_mask:0xf bank_mask:0xf
    s_nop 0
    v_add_f32_dpp v17, v17, v17 row_half_mirror row_mask:0xf bank_mask:0xf
    v_add_f32_dpp v16, v16, v16 quad_perm:[1,0,3,2] row_mask:0xf bank_mask:0xf
    s_nop 0
    v_add_f32_dpp v17, v17, v17 quad_perm:[1,0,3,2] row_mask:0xf bank_mask:0xf
    v_add_f32_dpp v16, v16, v16 quad_perm:[2,3,0,1] row_mask:0xf bank_mask:0xf
    s_nop 0
    v_add_f32_dpp v17, v17, v17 quad_perm:[2,3,0,1] row_mask:0xf bank_mask:0xf
    v_max_f32 v8, v16, v17
    s_mov_b32 s34, 0x3e0293ee
    s_nop 0
    v_max_f32_dpp v8, v8, v8 row_ror:8 row_mask:0xf bank_mask:0xf
    v_mov_b32 v9, v8
    s_nop 1
    v_permlane16_swap_b32 v8, v9
    v_max_f32 v8, v8, v9
    v_mov_b32 v9, v8
    s_nop 1
    v_permlane32_swap_b32 v8, v9
    v_max_f32 v8, v8, v9
    v_mul_f32 v8, s34, v8
    v_fma_f32 v16, v16, s34, -v8
    v_fma_f32 v17, v17, s34, -v8
    v_exp_f32 v16, v16
    v_exp_f32 v17, v17
    s_nop 0
    v_add_f32 v9, v16, v17
    v_and_b32 v10, 1, v0
    v_lshlrev_b32 v10, 4, v10
    v_mov_b32 v11, 0xffff
    v_lshlrev_b32 v10, v10, v11
    v_bfe_u32 v11, v0, 1, 2
    v_cmp_eq_u32 vcc, 0, v11
    s_nop 1
    v_cndmask_b32 v20, 0, v10, vcc
    v_cmp_eq_u32 vcc, 1, v11
    s_nop 1
    v_cndmask_b32 v21, 0, v10, vcc
    v_cmp_eq_u32 vcc, 2, v11
    s_nop 1
    v_cndmask_b32 v22, 0, v10, vcc
    v_cmp_eq_u32 vcc, 3, v11
    s_nop 1
    v_cndmask_b32 v23, 0, v10, vcc
    v_add_f32_dpp v9, v9, v9 row_ror:8 row_mask:0xf bank_mask:0xf
    v_mov_b32 v10, v9
    s_nop 1
    v_permlane16_swap_b32 v9, v10
    v_add_f32 v9, v9, v10
    v_mov_b32 v10, v9
    s_nop 1
    v_permlane32_swap_b32 v9, v10
    v_add_f32 v9, v9, v10
    v_mov_b32 v10, 98616
    s_mov_b64 exec, 1
    ds_write_b64 v10, v[8:9]
    s_mov_b64 exec, -1
    s_waitcnt vmcnt(0)
    v_cvt_pk_bf16_f32 v10, v16, v16
    v_and_b32 v24, v10, v20
    v_and_b32 v25, v10, v21
    v_and_b32 v26, v10, v22
    v_and_b32 v27, v10, v23
    s_nop 1
    v_mfma_f32_16x16x32_bf16 v[116:119], v[144:147], v[24:27], 0
    v_mfma_f32_16x16x32_bf16 v[120:123], v[148:151], v[24:27], 0
    v_cvt_pk_bf16_f32 v10, v17, v17
    v_and_b32 v28, v10, v20
    v_and_b32 v29, v10, v21
    v_and_b32 v30, v10, v22
    v_and_b32 v31, v10, v23
    s_nop 1
    v_mfma_f32_16x16x32_bf16 v[116:119], v[152:155], v[28:31], v[116:119]
    v_mfma_f32_16x16x32_bf16 v[120:123], v[156:159], v[28:31], v[120:123]
    s_mov_b32 s34, 106496
    v_lshrrev_b32 v16, 4, v0
    v_and_b32 v17, 7, v0
    v_lshl_add_u32 v16, v16, 3, v17
    v_bfe_u32 v17, v0, 3, 1
    v_lshl_add_u32 v16, v17, 5, v16
    v_lshl_add_u32 v16, v16, 4, s34
    s_nop 0
    v_add_f32_dpp v116, v120, v116 row_ror:8 row_mask:0xf bank_mask:0xf
    v_add_f32_dpp v117, v121, v117 row_ror:8 row_mask:0xf bank_mask:0xf
    v_add_f32_dpp v118, v122, v118 row_ror:8 row_mask:0xf bank_mask:0xf
    v_add_f32_dpp v119, v123, v119 row_ror:8 row_mask:0xf bank_mask:0xf
    ds_write_b128 v16, v[116:119]
    v_lshl_add_u32 v16, v0, 3, s34
    ds_read_b64 v[116:117], v16
    s_waitcnt lgkmcnt(0)
    s_mov_b32 s63, 0
    s_mov_b32 s62, s61
    s_cmp_lt_u32 s61, 20
    s_cbranch_scc1 L_rd22
    s_mul_i32 s62, s60, 12
    s_add_u32 s62, s62, s61
    s_sub_u32 s62, s62, 20
    s_mov_b32 s63, 1
    s_cmp_lt_u32 s62, 54
    s_cbranch_scc1 L_rd22
    s_cmp_lt_u32 s62, 56
    s_cselect_b32 s63, 3, 2
    s_sub_u32 s62, s62, 56
L_rd22:
    v_and_b32 v8, 3, v0
    v_bfe_u32 v9, v0, 2, 2
    v_lshrrev_b32 v10, 4, v0
    s_mov_b32 s55, 0x20000
    s_lshl_b32 s35, s62, 6
    s_and_b32 s49, s62, 1
    s_cmp_eq_u32 s63, 0
    s_cbranch_scc1 L_dp24
    s_cmp_eq_u32 s63, 1
    s_cbranch_scc1 L_dp25
    s_mov_b32 s52, s20
    s_mov_b32 s53, s21
    s_mov_b32 s54, 2211840
    v_mov_b32 v15, 0
    s_branch L_dp26
L_dp25:
    s_mov_b32 s52, s16
    s_mov_b32 s53, s17
    s_mov_b32 s54, 2211840
    v_lshl_add_u32 v15, v9, 3, v10
    v_mul_u32_u24 v15, 3456, v15
    v_lshl_add_u32 v15, v8, 4, v15
    v_add_u32 v15, s35, v15
    s_bfe_u32 s50, s3, 0x10001
    s_lshl_b32 s50, s50, 7
    s_and_b32 s34, s3, 1
    s_lshl_b32 s34, s34, 2
    s_add_u32 s50, s50, s34
    s_and_b32 s51, s3, 3
    s_lshl_b32 s51, s51, 5
    s_add_u32 s51, s51, 512
    s_mul_i32 s50, s50, 3456
    s_mul_i32 s51, s51, 3456
    s_branch L_dp26
L_dp24:
    s_mov_b32 s52, s12
    s_mov_b32 s53, s13
    s_mov_b32 s54, 5242880
    s_lshr_b32 s50, s3, 1
    s_lshl_b32 s50, s50, 3
    s_add_u32 s50, s50, s60
    s_and_b32 s51, s3, 1
    s_lshl_b32 s34, s50, 1
    s_add_u32 s34, s34, s51
    s_mul_i32 s34, s34, 81920
    s_add_u32 s34, s34, s35
    v_lshl_add_u32 v15, v9, 2, v10
    v_mul_u32_u24 v15, 2560, v15
    v_lshl_add_u32 v15, v8, 4, v15
    v_add_u32 v15, s34, v15
    s_lshl_b32 s56, s3, 12
    s_lshl_b32 s34, s49, 11
    s_add_u32 s56, s56, s34
    s_add_u32 s56, s56, 40960
    s_add_u32 s58, s56, 1024
    s_mul_i32 s57, s49, 40960
    s_add_u32 s59, s57, 1280
L_dp26:
    v_and_b32 v200, 3, v0
    v_bfe_u32 v201, v0, 2, 2
    v_lshrrev_b32 v202, 4, v0
    s_lshl_b32 s34, s3, 10
    s_add_u32 s34, s34, 122112
    v_mul_u32_u24 v203, 320, v201
    v_min_u32 v203, 704, v203
    v_lshl_add_u32 v203, v202, 6, v203
    v_lshl_add_u32 v203, v200, 4, v203
    v_add_u32 v203, s34, v203
    s_movk_i32 s48, 16384
    v_mov_b32 v197, 0
    s_mov_b32 s40, 0
    s_mov_b32 s41, 0
    s_mov_b32 s42, 0
    s_cmp_eq_u32 s63, 0
    s_cbranch_scc1 L_d_wo
    s_cmp_eq_u32 s63, 2
    s_cbranch_scc1 L_d_w2
    s_cmp_eq_u32 s63, 3
    s_cbranch_scc1 L_d_none
    v_and_b32 v205, 15, v0
    v_lshlrev_b32 v205, 4, v205
    s_and_b32 s49, s3, 3
    s_mul_i32 s34, s49, 1280
    s_add_u32 s34, s34, s99
    s_add_u32 s34, s34, 786432
    v_lshl_add_u32 v206, v202, 15, v205
    v_add_u32 v206, s34, v206
    s_mul_i32 s34, s49, 3840
    v_add_u32 v205, s34, v205
    s_lshl_b32 s34, s62, 6
    v_lshlrev_b32 v5, 4, v14
    v_lshl_add_u32 v5, v12, 2, v5
    v_add_u32 v5, s34, v5
    global_load_dword v6, v5, s[18:19]
    v_and_b32 v7, 15, v0
    v_lshlrev_b32 v7, 4, v7
    v_mul_u32_u24 v8, 1280, v14
    v_add_u32 v8, v8, v7
    v_bfe_u32 v9, v0, 3, 1
    v_lshlrev_b32 v9, 15, v9
    v_lshl_add_u32 v9, v14, 7, v9
    v_and_b32 v10, 7, v0
    v_lshl_add_u32 v9, v10, 4, v9
    v_add_u32 v9, 1572864, v9
    s_mov_b32 s57, 65536
    v_mul_u32_u24 v5, 3840, v14
    v_add_u32 v5, v5, v7
    global_load_dwordx4 v[32:35], v8, s[4:5] offset:0
    global_load_dwordx4 v[36:39], v8, s[4:5] offset:256
    global_load_dwordx4 v[40:43], v8, s[4:5] offset:512
    global_load_dwordx4 v[44:47], v8, s[4:5] offset:768
    global_load_dwordx4 v[48:51], v8, s[4:5] offset:1024
    s_mov_b32 s35, 0
L_poll27:
    buffer_load_dwordx4 v[52:55], v9, s[44:47], s57 offen offset:1024 sc1
    buffer_load_dwordx4 v[56:59], v9, s[44:47], 0 offen offset:1536 sc1
    buffer_load_dwordx4 v[60:63], v9, s[44:47], s57 offen offset:1536 sc1
    buffer_load_dwordx4 v[64:67], v9, s[44:47], 0 offen offset:2048 sc1
    buffer_load_dwordx4 v[68:71], v9, s[44:47], s57 offen offset:2048 sc1
    buffer_load_dwordx4 v[72:75], v9, s[44:47], 0 offen offset:2560 sc1
    buffer_load_dwordx4 v[76:79], v9, s[44:47], s57 offen offset:2560 sc1
    buffer_load_dwordx4 v[80:83], v9, s[44:47], 0 offen offset:3072 sc1
    buffer_load_dwordx4 v[84:87], v9, s[44:47], s57 offen offset:3072 sc1
    buffer_load_dwordx4 v[88:91], v9, s[44:47], 0 offen offset:3584 sc1
    s_add_u32 s35, s35, 1
    s_waitcnt vmcnt(0)
    v_max3_u32 v28, v52, v53, v54
    v_max3_u32 v28, v28, v55, v56
    v_max3_u32 v28, v28, v57, v58
    v_max3_u32 v28, v28, v59, v60
    v_max3_u32 v28, v28, v61, v62
    v_max3_u32 v28, v28, v63, v64
    v_max3_u32 v28, v28, v65, v66
    v_max3_u32 v28, v28, v67, v68
    v_max3_u32 v28, v28, v69, v70
    v_max3_u32 v28, v28, v71, v72
    v_max3_u32 v28, v28, v73, v74
    v_max3_u32 v28, v28, v75, v76
    v_max3_u32 v28, v28, v77, v78
    v_max3_u32 v28, v28, v79, v80
    v_max3_u32 v28, v28, v81, v82
    v_max3_u32 v28, v28, v83, v84
    v_max3_u32 v28, v28, v85, v86
    v_max3_u32 v28, v28, v87, v88
    v_max3_u32 v28, v28, v89, v90
    v_max_u32 v28, v28, v91
    v_cmp_eq_u32 vcc, -1, v28
    s_cbranch_vccz L_done28
    s_sleep 16
    s_cmp_lt_u32 s35, 60000
    s_cbranch_scc1 L_poll27
L_done28:
    ds_write_b128 v5, v[32:35] offset:0
    ds_write_b128 v5, v[36:39] offset:256
    ds_write_b128 v5, v[40:43] offset:512
    ds_write_b128 v5, v[44:47] offset:768
    ds_write_b128 v5, v[48:51] offset:1024
    ds_write_b128 v5, v[52:55] offset:1280
    ds_write_b128 v5, v[56:59] offset:1536
    ds_write_b128 v5, v[60:63] offset:1792
    ds_write_b128 v5, v[64:67] offset:2048
    ds_write_b128 v5, v[68:71] offset:2304
    ds_write_b128 v5, v[72:75] offset:2560
    ds_write_b128 v5, v[76:79] offset:2816
    ds_write_b128 v5, v[80:83] offset:3072
    ds_write_b128 v5, v[84:87] offset:3328
    ds_write_b128 v5, v[88:91] offset:3584
    s_waitcnt lgkmcnt(0)
    v_lshlrev_b32 v100, 16, v6
    v_and_b32 v101, 0xffff0000, v6
    s_cmp_eq_u32 s60, 4
    s_cselect_b32 s40, 6, 12
    s_mov_b32 s41, 5462
    s_cmov_b32 s41, 10923
    s_cselect_b32 s34, 20, 20
    s_mov_b32 s49, 17280
    s_cmov_b32 s49, 34560
    v_min_u32 v196, 59, v0
    v_mul_u32_u24 v197, s41, v196
    v_lshrrev_b32 v197, 16, v197
    v_mul_u32_u24 v194, s40, v197
    v_sub_u32 v196, v196, v194
    v_mul_u32_u24 v197, 3456, v197
    v_lshl_add_u32 v197, v196, 6, v197
    s_mul_i32 s35, s60, 768
    s_add_i32 s35, s35, 0
    s_cmp_eq_u32 s60, 4
    s_cselect_b32 s35, 3072, s35
    s_sub_u32 s34, s61, s34
    s_mul_i32 s34, s34, s49
    s_mul_i32 s34, s34, 11
    s_add_u32 s34, s34, s35
    v_add_u32 v197, s34, v197
    s_mov_b32 s40, s49
    s_mov_b32 s41, s49
    s_branch L_d_none
L_d_w2:
    s_lshl_b32 s34, s62, 5
    v_lshl_add_u32 v3, v14, 3, s34
    global_load_dwordx2 v[20:21], v3, s[22:23]
    v_mul_u32_u24 v112, 1280, v12
    v_add_u32 v112, v112, v3
    global_load_dwordx2 v[22:23], v112, s[4:5]
    s_lshr_b32 s34, s62, 2
    s_add_u32 s34, s34, 30
    s_lshr_b32 s35, s34, 2
    s_lshl_b32 s35, s35, 9
    s_and_b32 s34, s34, 3
    s_lshl_b32 s34, s34, 15
    s_add_u32 s34, s34, s35
    s_and_b32 s35, s62, 3
    s_mul_i32 s35, s35, 32
    s_add_u32 s34, s34, s35
    s_add_u32 s34, s34, 1572864
    v_lshlrev_b32 v5, 7, v12
    v_lshl_add_u32 v5, v14, 3, v5
    v_add_u32 v5, s34, v5
    s_waitcnt vmcnt(0)
    v_lshlrev_b32 v32, 16, v20
    v_and_b32 v33, 0xffff0000, v20
    v_lshlrev_b32 v34, 16, v21
    v_and_b32 v35, 0xffff0000, v21
    v_lshlrev_b32 v108, 16, v22
    v_and_b32 v109, 0xffff0000, v22
    v_lshlrev_b32 v110, 16, v23
    v_and_b32 v111, 0xffff0000, v23
    s_mov_b32 s35, 0
L_poll30:
    buffer_load_dwordx2 v[24:25], v5, s[44:47], 0 offen sc1
    s_add_u32 s35, s35, 1
    s_waitcnt vmcnt(0)
    v_max_u32 v28, v24, v25
    v_cmp_eq_u32 vcc, -1, v28
    s_cbranch_vccz L_done31
    s_sleep 16
    s_cmp_lt_u32 s35, 60000
    s_cbranch_scc1 L_poll30
L_done31:
    v_lshlrev_b32 v104, 16, v24
    v_and_b32 v105, 0xffff0000, v24
    v_lshlrev_b32 v106, 16, v25
    v_and_b32 v107, 0xffff0000, v25
    v_fma_f32 v108, v104, v32, v108
    v_fma_f32 v109, v105, v33, v109
    v_fma_f32 v110, v106, v34, v110
    v_fma_f32 v111, v107, v35, v111
    v_mul_f32 v108, 0x3e800000, v108
    v_mul_f32 v109, 0x3e800000, v109
    v_mul_f32 v110, 0x3e800000, v110
    v_mul_f32 v111, 0x3e800000, v111
    v_lshl_add_u32 v204, v13, 15, v112
    s_add_u32 s34, s99, 786432
    v_add_u32 v204, s34, v204
    s_cmp_eq_u32 s60, 4
    s_cselect_b32 s40, 2, 6
    s_mov_b32 s41, 10923
    s_cmov_b32 s41, 32769
    s_cselect_b32 s34, 28, 20
    s_mov_b32 s49, 12800
    s_cmov_b32 s49, 38400
    v_min_u32 v196, 59, v0
    v_mul_u32_u24 v197, s41, v196
    v_lshrrev_b32 v197, 16, v197
    v_mul_u32_u24 v194, s40, v197
    v_sub_u32 v196, v196, v194
    v_mul_u32_u24 v197, 1280, v197
    v_lshl_add_u32 v197, v196, 6, v197
    s_mul_i32 s35, s60, 384
    s_add_i32 s35, s35, -1792
    s_cmp_eq_u32 s60, 4
    s_cselect_b32 s35, 0, s35
    s_sub_u32 s34, s61, s34
    s_mul_i32 s34, s34, s49
    s_mul_i32 s34, s34, 15
    s_add_u32 s34, s34, s35
    v_add_u32 v197, s34, v197
    s_mov_b32 s40, s49
    s_mov_b32 s41, s49
    s_branch L_d_none
L_d_wo:
    s_lshr_b32 s49, s3, 1
    s_lshl_b32 s49, s49, 15
    v_and_b32 v210, 7, v0
    s_mul_i32 s34, s60, 4096
    s_add_u32 s34, s34, s49
    s_add_u32 s34, s34, 1179904
    v_lshrrev_b32 v211, 3, v0
    v_mul_u32_u24 v205, 512, v211
    v_add_u32 v204, s34, v205
    s_lshl_b32 s35, s51, 7
    s_add_u32 s34, s34, s35
    s_sub_u32 s34, s34, 256
    v_lshl_add_u32 v205, v210, 4, v205
    v_add_u32 v205, s34, v205
    s_lshl_b32 s34, s3, 12
    s_add_u32 s34, s34, 40960
    v_lshrrev_b32 v206, 2, v0
    v_lshlrev_b32 v206, 6, v206
    v_lshl_add_u32 v206, v200, 3, v206
    v_add_u32 v206, s34, v206
    s_mul_i32 s34, s3, 1152
    s_add_u32 s34, s34, 107520
    v_mul_u32_u24 v207, 144, v211
    v_lshl_add_u32 v207, v210, 4, v207
    v_add_u32 v207, s34, v207
    v_mul_u32_u24 v208, 144, v210
    v_lshl_add_u32 v208, v202, 4, v208
    v_add_u32 v208, s34, v208
    v_mul_u32_u24 v212, 144, v211
    v_add_u32 v212, s34, v212
    v_mul_u32_u24 v213, 144, v210
    v_add_u32 v213, s34, v213
    v_and_b32 v211, 1, v211
    v_bfe_u32 v203, v0, 1, 2
    v_mul_u32_u24 v203, 144, v203
    v_and_b32 v214, 1, v0
    v_mul_u32_u24 v214, 576, v214
    v_lshl_add_u32 v214, v211, 6, v214
    v_lshl_add_u32 v214, v202, 4, v214
    s_add_u32 s34, s34, 14592
    v_add3_u32 v203, v203, v214, s34
    v_mov_b32 v210, 98816
    v_cmp_eq_u32 vcc, 0, v211
    s_nop 1
    v_cndmask_b32 v209, v208, v210, vcc
    v_cndmask_b32 v208, v210, v208, vcc
    v_and_b32 v8, 15, v0
    s_lshr_b32 s34, s62, 1
    s_add_u32 s34, s34, 0
    s_lshr_b32 s35, s34, 2
    s_lshl_b32 s35, s35, 9
    s_and_b32 s34, s34, 3
    s_lshl_b32 s34, s34, 15
    s_add_u32 s34, s34, s35
    s_and_b32 s35, s62, 1
    s_mul_i32 s35, s35, 64
    s_add_u32 s34, s34, s35
    s_add_u32 s34, s34, 1572864
    v_lshlrev_b32 v9, 2, v8
    v_lshl_add_u32 v9, v14, 7, v9
    v_add_u32 v9, s34, v9
    s_lshr_b32 s34, s60, 2
    s_lshl_b32 s34, s34, 14
    s_and_b32 s35, s60, 3
    s_lshl_b32 s35, s35, 15
    s_add_u32 s34, s34, s35
    s_lshl_b32 s35, s62, 6
    s_add_u32 s34, s34, s35
    s_add_u32 s34, s34, 786432
    v_mul_u32_u24 v112, 1280, v14
    v_lshl_add_u32 v112, v8, 2, v112
    v_add_u32 v112, s34, v112
    v_mul_u32_u24 v113, 144, v14
    v_lshl_add_u32 v113, v8, 3, v113
    v_add_u32 v113, 122112, v113
    s_bfe_u32 s35, s60, 0x10002
    s_lshl_b32 s35, s35, 13
    s_xor_b32 s101, s99, s35
    s_xor_b32 s93, s101, 8192
    s_mul_i32 s34, s62, 52
    s_lshr_b32 s34, s34, 8
    s_mul_i32 s35, s34, 5
    s_sub_u32 s35, s62, s35
    s_mul_i32 s34, s34, 1310720
    s_lshl_b32 s35, s35, 15
    s_add_u32 s34, s34, s35
    s_mul_i32 s35, s60, 163840
    s_add_u32 s34, s34, s35
    v_lshl_add_u32 v197, v0, 6, s34
    s_movk_i32 s40, 4096
    s_movk_i32 s41, 4096
    s_mov_b32 s35, 0
L_poll33:
    buffer_load_dword v32, v9, s[44:47], 0 offen sc1
    s_add_u32 s35, s35, 1
    s_waitcnt vmcnt(0)
    v_mov_b32 v22, v32
    v_cmp_eq_u32 vcc, -1, v22
    s_cbranch_vccz L_done34
    s_sleep 16
    s_cmp_lt_u32 s35, 60000
    s_cbranch_scc1 L_poll33
L_done34:
    v_lshlrev_b32 v100, 16, v32
    v_and_b32 v101, 0xffff0000, v32
L_d_none:
    v_mov_b32 v22, 99072
    s_and_b32 s34, s60, 3
    s_lshl_b32 s34, s34, 15
    s_lshr_b32 s35, s60, 2
    s_lshl_b32 s35, s35, 7
    s_add_u32 s34, s34, s35
    s_add_u32 s34, s34, 793600
    v_and_b32 v252, 31, v0
    v_lshl_add_u32 v252, v252, 2, s34
    v_mov_b32 v253, 0
    s_mov_b32 s35, 0
L_poll36:
    ds_read_b32 v23, v22
    s_add_u32 s35, s35, 1
    s_waitcnt lgkmcnt(0)
    v_cmp_gt_u32 vcc, 46, v23
    s_cbranch_vccz L_done37
    s_sleep 2
    s_cmp_lt_u32 s35, 60000
    s_cbranch_scc1 L_poll36
L_done37:
    buffer_load_dword v251, v252, s[44:47], 0 offen sc1
    s_lshl_b64 exec, 1, s61
    buffer_store_dword v253, v252, s[44:47], 0 offen
    s_mov_b64 exec, -1
    s_waitcnt vmcnt(0)
    v_cmp_ne_u32 vcc, -1, v251
    v_mov_b32 v252, 99076
    s_bcnt1_i32_b32 s34, vcc_lo
    v_mov_b32 v251, s34
    s_mov_b64 exec, 1
    ds_write_b32 v252, v251
    s_mov_b64 exec, -1
    v_mov_b32 v22, 99072
    s_and_b32 s34, s60, 3
    s_lshl_b32 s34, s34, 15
    s_lshr_b32 s35, s60, 2
    s_lshl_b32 s35, s35, 7
    s_add_u32 s34, s34, s35
    s_add_u32 s34, s34, 793856
    v_and_b32 v252, 31, v0
    v_lshl_add_u32 v252, v252, 2, s34
    v_mov_b32 v253, 0
    s_mov_b32 s35, 0
L_poll39:
    ds_read_b32 v23, v22
    s_add_u32 s35, s35, 1
    s_waitcnt lgkmcnt(0)
    v_cmp_gt_u32 vcc, 57, v23
    s_cbranch_vccz L_done40
    s_sleep 2
    s_cmp_lt_u32 s35, 60000
    s_cbranch_scc1 L_poll39
L_done40:
    buffer_load_dword v251, v252, s[44:47], 0 offen sc1
    s_lshl_b64 exec, 1, s61
    buffer_store_dword v253, v252, s[44:47], 0 offen
    s_mov_b64 exec, -1
    s_waitcnt vmcnt(0)
    v_cmp_ne_u32 vcc, -1, v251
    v_mov_b32 v252, 99076
    s_bcnt1_i32_b32 s34, vcc_lo
    v_mov_b32 v251, s34
    s_mov_b64 exec, 1
    ds_write_b32 v252, v251
    s_mov_b64 exec, -1
    v_and_b32 v19, 7, v0
    v_lshlrev_b32 v19, 3, v19
    v_add_u32 v19, 98560, v19
    s_mov_b32 s35, 0
L_poll42:
    ds_read_b64 v[20:21], v19
    s_add_u32 s35, s35, 1
    s_waitcnt lgkmcnt(0)
    v_max_u32 v22, v20, v21
    v_cmp_eq_u32 vcc, -1, v22
    s_cbranch_vccz L_done43
    s_sleep 2
    s_cmp_lt_u32 s35, 60000
    s_cbranch_scc1 L_poll42
L_done43:
    v_max_f32_dpp v22, v20, v20 row_half_mirror row_mask:0xf bank_mask:0xf
    s_nop 1
    v_max_f32_dpp v22, v22, v22 quad_perm:[1,0,3,2] row_mask:0xf bank_mask:0xf
    s_nop 1
    v_max_f32_dpp v22, v22, v22 quad_perm:[2,3,0,1] row_mask:0xf bank_mask:0xf
    v_sub_f32 v20, v20, v22
    v_exp_f32 v20, v20
    s_nop 0
    v_mul_f32 v21, v21, v20
    s_nop 1
    v_add_f32_dpp v21, v21, v21 row_half_mirror row_mask:0xf bank_mask:0xf
    s_nop 1
    v_add_f32_dpp v21, v21, v21 quad_perm:[1,0,3,2] row_mask:0xf bank_mask:0xf
    s_nop 1
    v_add_f32_dpp v21, v21, v21 quad_perm:[2,3,0,1] row_mask:0xf bank_mask:0xf
    v_rcp_f32 v23, v21
    v_log_f32 v21, v21
    v_mul_f32 v20, v20, v23
    v_add_f32 v21, v21, v22
    v_min_u32 v21, -2, v21
    v_readlane_b32 s88, v20, 0
    v_readlane_b32 s90, v20, 1
    v_readlane_b32 s92, v20, 2
    v_readlane_b32 s94, v20, 3
    v_readlane_b32 s96, v20, 4
    v_readlane_b32 s98, v20, 5
    v_readlane_b32 s100, v20, 6
    v_readlane_b32 s89, v20, 7
    s_and_b32 s95, s61, 3
    s_lshl_b32 s95, s95, 15
    s_bfe_u32 s35, s2, 0x20005
    s_lshl_b32 s35, s35, 1
    s_lshr_b32 s91, s2, 7
    s_add_u32 s35, s35, s91
    s_getreg_b32 s91, hwreg(HW_REG_XCC_ID, 0, 4)
    v_and_b32 v24, 1, v0
    v_cmp_eq_u32 vcc, 0, v24
    v_mov_b32 v25, s91
    s_nop 0
    v_cndmask_b32 v25, v25, v21, vcc
    v_mul_f32 v20, s89, v116
    v_mul_f32 v21, s89, v117
    s_mul_i32 s34, s60, 4096
    s_mul_i32 s35, s35, 512
    s_add_u32 s34, s34, s35
    s_add_u32 s34, s34, s95
    s_add_u32 s34, s34, 1179648
    v_lshl_add_u32 v26, v0, 2, s34
    v_lshlrev_b32 v19, 3, v0
    v_add_u32 v19, 99328, v19
    v_lshlrev_b32 v18, 4, v0
    v_add_u32 v18, 131328, v18
    s_mov_b32 s36, s12
    s_mov_b32 s37, s13
    s_mov_b32 s38, 5242880
    s_and_b32 s34, s61, 24
    s_add_u32 s34, s34, s60
    s_mul_i32 s34, s34, 163840
    s_and_b32 s35, s61, 7
    s_mul_i32 s35, s35, 20480
    s_add_u32 s34, s34, s35
    v_lshl_add_u32 v195, v0, 6, s34
    s_mov_b32 s34, 0
    s_barrier
    buffer_load_dword v250, v195, s[36:39], s34 offen
    s_add_u32 s34, s34, 4096
    buffer_load_dword v250, v195, s[36:39], s34 offen
    s_add_u32 s34, s34, 4096
    buffer_load_dword v250, v195, s[36:39], s34 offen
    s_add_u32 s34, s34, 4096
    buffer_load_dword v250, v195, s[36:39], s34 offen
    s_add_u32 s34, s34, 4096
    buffer_load_dword v250, v195, s[36:39], s34 offen
    s_add_u32 s34, s34, 4096
    s_cmp_lt_u32 s63, 1
    s_cbranch_scc1 L_nopf
    buffer_load_dword v250, v197, s[52:55], s42 offen
    s_add_u32 s42, s42, s40
    buffer_load_dword v250, v197, s[52:55], s42 offen
    s_add_u32 s42, s42, s41
L_nopf:
    s_cmp_eq_u32 s97, 0
    s_barrier
    ds_read_b64 v[32:33], v19 offset:0
    ds_read_b64 v[34:35], v19 offset:1024
    ds_read_b64 v[36:37], v19 offset:2048
    ds_read_b64 v[38:39], v19 offset:3072
    ds_read_b64 v[40:41], v19 offset:4096
    ds_read_b64 v[42:43], v19 offset:5120
    ds_read_b64 v[44:45], v19 offset:6144
    buffer_store_dword v25, v26, s[44:47], 0 offen offset:256
    s_waitcnt lgkmcnt(6)
    v_pk_fma_f32 v[20:21], v[32:33], s[88:89], v[20:21] op_sel_hi:[1,0,1]
    s_waitcnt lgkmcnt(5)
    v_pk_fma_f32 v[20:21], v[34:35], s[90:91], v[20:21] op_sel_hi:[1,0,1]
    s_waitcnt lgkmcnt(4)
    v_pk_fma_f32 v[20:21], v[36:37], s[92:93], v[20:21] op_sel_hi:[1,0,1]
    s_waitcnt lgkmcnt(3)
    v_pk_fma_f32 v[20:21], v[38:39], s[94:95], v[20:21] op_sel_hi:[1,0,1]
    s_waitcnt lgkmcnt(2)
    v_pk_fma_f32 v[20:21], v[40:41], s[96:97], v[20:21] op_sel_hi:[1,0,1]
    s_waitcnt lgkmcnt(1)
    v_pk_fma_f32 v[20:21], v[42:43], s[98:99], v[20:21] op_sel_hi:[1,0,1]
    s_waitcnt lgkmcnt(0)
    v_pk_fma_f32 v[20:21], v[44:45], s[100:101], v[20:21] op_sel_hi:[1,0,1]
    v_cvt_pk_bf16_f32 v24, v20, v21
    v_min_u32 v24, -2, v24
    buffer_store_dword v24, v26, s[44:47], 0 offen
    s_cbranch_scc1 L_ostd
    buffer_store_dword v24, v26, s[44:47], 0 offen sc1
    buffer_store_dword v25, v26, s[44:47], 0 offen offset:256 sc1
L_ostd:
    ds_write_b96 v18, v[24:26]
    s_waitcnt lgkmcnt(0)
    s_cmp_lt_u32 s63, 1
    s_cbranch_scc1 L_nopf2
    buffer_load_dword v250, v197, s[52:55], s42 offen
    s_add_u32 s42, s42, s40
    buffer_load_dword v250, v197, s[52:55], s42 offen
    s_add_u32 s42, s42, s41
    buffer_load_dword v250, v197, s[52:55], s42 offen
    s_add_u32 s42, s42, s40
    buffer_load_dword v250, v197, s[52:55], s42 offen
    s_add_u32 s42, s42, s41
    buffer_load_dword v250, v197, s[52:55], s42 offen
    s_add_u32 s42, s42, s40
    buffer_load_dword v250, v197, s[52:55], s42 offen
    s_add_u32 s42, s42, s41
    buffer_load_dword v250, v197, s[52:55], s42 offen
    s_add_u32 s42, s42, s40
    buffer_load_dword v250, v197, s[52:55], s42 offen
    s_add_u32 s42, s42, s41
L_nopf2:
    s_barrier
    s_cmp_eq_u32 s63, 0
    s_cbranch_scc1 L_r_wo2
    buffer_load_dword v250, v197, s[52:55], s42 offen
    s_add_u32 s42, s42, s40
    s_cmp_eq_u32 s63, 1
    s_cbranch_scc1 L_r_w1
    buffer_load_dword v250, v197, s[52:55], s42 offen
    s_add_u32 s42, s42, s40
    buffer_load_dword v250, v197, s[52:55], s42 offen
    s_add_u32 s42, s42, s41
    buffer_load_dword v250, v197, s[52:55], s42 offen
    s_add_u32 s42, s42, s40
    buffer_load_dword v250, v197, s[52:55], s42 offen
    s_add_u32 s42, s42, s41
    s_cmp_eq_u32 s63, 2
    s_cbranch_scc1 L_w2_red
    s_waitcnt vmcnt(0)
    s_mov_b64 exec, -1
    v_lshlrev_b32 v243, 4, v0
    v_add_u32 v243, 131328, v243
    ds_read_b96 v[240:242], v243
    s_waitcnt lgkmcnt(0)
    buffer_store_dword v240, v242, s[44:47], 0 offen sc1
    buffer_store_dword v241, v242, s[44:47], 0 offen offset:256 sc1
    s_branch L_fin
L_stream:
    s_sub_u32 s49, s3, 1
    s_lshl_b32 s49, s49, 12
    v_lshl_add_u32 v1, v0, 4, s49
    s_and_b32 s34, s2, 127
    s_lshl_b32 s34, s34, 21
    s_lshr_b32 s35, s2, 7
    s_lshl_b32 s35, s35, 18
    s_add_u32 s34, s34, s35
    s_add_u32 s34, s34, 1572864
    s_mov_b32 s38, 0x40000
    s_mov_b32 s42, 0x40000
    s_waitcnt lgkmcnt(0)
    s_add_u32 s36, s6, s34
    s_addc_u32 s37, s7, 0
    s_add_u32 s40, s8, s34
    s_addc_u32 s41, s9, 0
    s_barrier
    s_waitcnt vmcnt(2)
    buffer_load_dwordx4 v[28:31], v1, s[36:39], s98 offen offset:3072 nt
    s_waitcnt vmcnt(2)
    s_add_u32 s98, s98, 28672
    s_cmp_eq_u32 s98, 258048
    s_cselect_b32 s98, 0, s98
    buffer_load_dwordx4 v[32:35], v1, s[36:39], s98 offen offset:0 nt
    s_waitcnt vmcnt(2)
    buffer_load_dwordx4 v[36:39], v1, s[36:39], s98 offen offset:1024 nt
    s_waitcnt vmcnt(2)
    buffer_load_dwordx4 v[40:43], v1, s[36:39], s98 offen offset:2048 nt
    s_waitcnt vmcnt(2)
    buffer_load_dwordx4 v[44:47], v1, s[36:39], s98 offen offset:3072 nt
    s_add_u32 s44, s32, 0
    s_addc_u32 s45, s33, 0
    s_mov_b32 s63, 0
    s_mov_b32 s62, s61
    s_cmp_lt_u32 s61, 20
    s_cbranch_scc1 L_rd45
    s_mul_i32 s62, s60, 12
    s_add_u32 s62, s62, s61
    s_sub_u32 s62, s62, 20
    s_mov_b32 s63, 1
    s_cmp_lt_u32 s62, 54
    s_cbranch_scc1 L_rd45
    s_cmp_lt_u32 s62, 56
    s_cselect_b32 s63, 3, 2
    s_sub_u32 s62, s62, 56
L_rd45:
    v_and_b32 v8, 3, v0
    v_bfe_u32 v9, v0, 2, 2
    v_lshrrev_b32 v10, 4, v0
    s_mov_b32 s55, 0x20000
    s_lshl_b32 s35, s62, 6
    s_and_b32 s49, s62, 1
    s_cmp_eq_u32 s63, 0
    s_cbranch_scc1 L_dp47
    s_cmp_eq_u32 s63, 1
    s_cbranch_scc1 L_dp48
    s_mov_b32 s52, s20
    s_mov_b32 s53, s21
    s_mov_b32 s54, 2211840
    v_mov_b32 v15, 0
    s_branch L_dp49
L_dp48:
    s_mov_b32 s52, s16
    s_mov_b32 s53, s17
    s_mov_b32 s54, 2211840
    v_lshl_add_u32 v15, v9, 3, v10
    v_mul_u32_u24 v15, 3456, v15
    v_lshl_add_u32 v15, v8, 4, v15
    v_add_u32 v15, s35, v15
    s_bfe_u32 s50, s3, 0x10001
    s_lshl_b32 s50, s50, 7
    s_and_b32 s34, s3, 1
    s_lshl_b32 s34, s34, 2
    s_add_u32 s50, s50, s34
    s_and_b32 s51, s3, 3
    s_lshl_b32 s51, s51, 5
    s_add_u32 s51, s51, 512
    s_mul_i32 s50, s50, 3456
    s_mul_i32 s51, s51, 3456
    s_branch L_dp49
L_dp47:
    s_mov_b32 s52, s12
    s_mov_b32 s53, s13
    s_mov_b32 s54, 5242880
    s_lshr_b32 s50, s3, 1
    s_lshl_b32 s50, s50, 3
    s_add_u32 s50, s50, s60
    s_and_b32 s51, s3, 1
    s_lshl_b32 s34, s50, 1
    s_add_u32 s34, s34, s51
    s_mul_i32 s34, s34, 81920
    s_add_u32 s34, s34, s35
    v_lshl_add_u32 v15, v9, 2, v10
    v_mul_u32_u24 v15, 2560, v15
    v_lshl_add_u32 v15, v8, 4, v15
    v_add_u32 v15, s34, v15
    s_lshl_b32 s56, s3, 12
    s_lshl_b32 s34, s49, 11
    s_add_u32 s56, s56, s34
    s_add_u32 s56, s56, 40960
    s_add_u32 s58, s56, 1024
    s_mul_i32 s57, s49, 40960
    s_add_u32 s59, s57, 1280
L_dp49:
    v_and_b32 v2, 15, v0
    v_lshlrev_b32 v2, 4, v2
    v_add_u32 v2, 98304, v2
    s_waitcnt vmcnt(2)
    s_add_u32 s98, s98, 28672
    s_cmp_eq_u32 s98, 258048
    s_cselect_b32 s98, 0, s98
    buffer_load_dwordx4 v[48:51], v1, s[36:39], s98 offen offset:0 nt
    s_waitcnt vmcnt(2)
    buffer_load_dwordx4 v[52:55], v1, s[36:39], s98 offen offset:1024 nt
    s_waitcnt vmcnt(2)
    s_cmp_ge_u32 s3, 4
    s_cbranch_scc1 L_sl50
    s_waitcnt vmcnt(1)
L_sl50:
    buffer_load_dwordx4 v[56:59], v1, s[36:39], s98 offen offset:2048 nt
    s_waitcnt vmcnt(2)
    s_cmp_ge_u32 s3, 4
    s_cbranch_scc1 L_sl51
    s_waitcnt vmcnt(1)
L_sl51:
    buffer_load_dwordx4 v[60:63], v1, s[36:39], s98 offen offset:3072 nt
    s_waitcnt vmcnt(2)
    s_cmp_ge_u32 s3, 4
    s_cbranch_scc1 L_sl52
    s_waitcnt vmcnt(1)
L_sl52:
    s_add_u32 s98, s98, 28672
    s_cmp_eq_u32 s98, 258048
    s_cselect_b32 s98, 0, s98
    buffer_load_dwordx4 v[64:67], v1, s[36:39], s98 offen offset:0 nt
    s_waitcnt vmcnt(2)
    buffer_load_dwordx4 v[68:71], v1, s[36:39], s98 offen offset:1024 nt
    s_waitcnt vmcnt(2)
    buffer_load_dwordx4 v[72:75], v1, s[36:39], s98 offen offset:2048 nt
    s_waitcnt vmcnt(2)
    buffer_load_dwordx4 v[76:79], v1, s[36:39], s98 offen offset:3072 nt
    s_waitcnt vmcnt(2)
    s_add_u32 s98, s98, 28672
    s_cmp_eq_u32 s98, 258048
    s_cselect_b32 s98, 0, s98
    buffer_load_dwordx4 v[80:83], v1, s[36:39], s98 offen offset:0 nt
    s_waitcnt vmcnt(2)
    buffer_load_dwordx4 v[84:87], v1, s[36:39], s98 offen offset:1024 nt
    s_waitcnt vmcnt(2)
    buffer_load_dwordx4 v[88:91], v1, s[36:39], s98 offen offset:2048 nt
    s_waitcnt vmcnt(2)
    buffer_load_dwordx4 v[92:95], v1, s[36:39], s98 offen offset:3072 nt
    s_waitcnt vmcnt(2)
    s_add_u32 s98, s98, 28672
    s_cmp_eq_u32 s98, 258048
    s_cselect_b32 s98, 0, s98
    buffer_load_dwordx4 v[96:99], v1, s[36:39], s98 offen offset:0 nt
    v_mov_b32 v3, 21
    v_mov_b32 v14, 99072
    s_mov_b64 exec, 1
    ds_write_b32 v14, v3
    s_mov_b64 exec, -1
    s_waitcnt vmcnt(2)
    buffer_load_dwordx4 v[100:103], v1, s[36:39], s98 offen offset:1024 nt
    s_waitcnt vmcnt(2)
    buffer_load_dwordx4 v[104:107], v1, s[36:39], s98 offen offset:2048 nt
    s_waitcnt vmcnt(2)
    buffer_load_dwordx4 v[108:111], v1, s[36:39], s98 offen offset:3072 nt
    s_waitcnt vmcnt(2)
    s_add_u32 s98, s98, 28672
    s_cmp_eq_u32 s98, 258048
    s_cselect_b32 s98, 0, s98
    buffer_load_dwordx4 v[112:115], v1, s[36:39], s98 offen offset:0 nt
    s_waitcnt vmcnt(2)
    buffer_load_dwordx4 v[116:119], v1, s[36:39], s98 offen offset:1024 nt
    s_waitcnt vmcnt(2)
    buffer_load_dwordx4 v[120:123], v1, s[36:39], s98 offen offset:2048 nt
    s_waitcnt vmcnt(2)
    buffer_load_dwordx4 v[124:127], v1, s[36:39], s98 offen offset:3072 nt
    s_waitcnt vmcnt(2)
    s_add_u32 s98, s98, 28672
    s_cmp_eq_u32 s98, 258048
    s_cselect_b32 s98, 0, s98
    buffer_load_dwordx4 v[128:131], v1, s[36:39], s98 offen offset:0 nt
    s_waitcnt vmcnt(2)
    buffer_load_dwordx4 v[132:135], v1, s[36:39], s98 offen offset:1024 nt
    s_waitcnt vmcnt(2)
    buffer_load_dwordx4 v[136:139], v1, s[36:39], s98 offen offset:2048 nt
    s_waitcnt vmcnt(2)
    buffer_load_dwordx4 v[140:143], v1, s[36:39], s98 offen offset:3072 nt
    s_waitcnt vmcnt(2)
    s_add_u32 s98, s98, 28672
    s_cmp_eq_u32 s98, 258048
    s_cselect_b32 s98, 0, s98
    buffer_load_dwordx4 v[144:147], v1, s[36:39], s98 offen offset:0 nt
    v_mov_b32 v3, 33
    v_mov_b32 v14, 99072
    s_mov_b64 exec, 1
    ds_write_b32 v14, v3
    s_mov_b64 exec, -1
    s_waitcnt vmcnt(2)
    buffer_load_dwordx4 v[148:151], v1, s[36:39], s98 offen offset:1024 nt
    s_waitcnt vmcnt(2)
    buffer_load_dwordx4 v[152:155], v1, s[36:39], s98 offen offset:2048 nt
    s_waitcnt vmcnt(2)
    buffer_load_dwordx4 v[156:159], v1, s[36:39], s98 offen offset:3072 nt
    s_waitcnt vmcnt(2)
    s_add_u32 s98, s98, 28672
    s_cmp_eq_u32 s98, 258048
    s_cselect_b32 s98, 0, s98
    buffer_load_dwordx4 v[160:163], v1, s[40:43], s98 offen offset:0 nt
    v_mov_b32 v3, 99076
    ds_read_b32 v3, v3
    s_waitcnt vmcnt(2)
    s_waitcnt lgkmcnt(0)
    v_readfirstlane_b32 s48, v3
    buffer_load_dwordx4 v[164:167], v1, s[40:43], s98 offen offset:1024 nt
    s_cmp_ge_u32 s48, 22
    s_cbranch_scc1 L_bo53
    s_waitcnt vmcnt(2)
L_bo53:
    buffer_load_dwordx4 v[168:171], v1, s[40:43], s98 offen offset:2048 nt
    s_waitcnt vmcnt(3)
    s_cmp_ge_u32 s48, 23
    s_cbranch_scc1 L_bo54
    s_waitcnt vmcnt(2)
L_bo54:
    buffer_load_dwordx4 v[172:175], v1, s[40:43], s98 offen offset:3072 nt
    s_waitcnt vmcnt(3)
    s_cmp_ge_u32 s48, 24
    s_cbranch_scc1 L_bo55
    s_waitcnt vmcnt(2)
L_bo55:
    s_add_u32 s98, s98, 28672
    s_cmp_eq_u32 s98, 258048
    s_cselect_b32 s98, 0, s98
    buffer_load_dwordx4 v[176:179], v1, s[40:43], s98 offen offset:0 nt
    s_waitcnt vmcnt(3)
    s_cmp_ge_u32 s48, 25
    s_cbranch_scc1 L_bo56
    s_waitcnt vmcnt(2)
L_bo56:
    buffer_load_dwordx4 v[180:183], v1, s[40:43], s98 offen offset:1024 nt
    s_waitcnt vmcnt(3)
    s_cmp_ge_u32 s48, 26
    s_cbranch_scc1 L_bo57
    s_waitcnt vmcnt(2)
L_bo57:
    buffer_load_dwordx4 v[184:187], v1, s[40:43], s98 offen offset:2048 nt
    s_waitcnt vmcnt(3)
    s_cmp_ge_u32 s48, 27
    s_cbranch_scc1 L_bo58
    s_waitcnt vmcnt(2)
L_bo58:
    buffer_load_dwordx4 v[188:191], v1, s[40:43], s98 offen offset:3072 nt
    s_waitcnt vmcnt(3)
    s_cmp_ge_u32 s48, 28
    s_cbranch_scc1 L_bo59
    s_waitcnt vmcnt(2)
L_bo59:
    s_add_u32 s98, s98, 28672
    s_cmp_eq_u32 s98, 258048
    s_cselect_b32 s98, 0, s98
    buffer_load_dwordx4 v[192:195], v1, s[40:43], s98 offen offset:0 nt
    s_waitcnt vmcnt(3)
    s_cmp_ge_u32 s48, 28
    s_cbranch_scc1 L_bo60
    s_waitcnt vmcnt(2)
L_bo60:
    buffer_load_dwordx4 v[196:199], v1, s[40:43], s98 offen offset:1024 nt
    v_mov_b32 v3, 46
    v_mov_b32 v14, 99072
    s_mov_b64 exec, 1
    ds_write_b32 v14, v3
    s_mov_b64 exec, -1
    s_waitcnt vmcnt(3)
    s_cmp_ge_u32 s48, 29
    s_cbranch_scc1 L_bo61
    s_waitcnt vmcnt(2)
L_bo61:
    buffer_load_dwordx4 v[200:203], v1, s[40:43], s98 offen offset:2048 nt
    s_waitcnt vmcnt(3)
    s_cmp_ge_u32 s48, 29
    s_cbranch_scc1 L_bo62
    s_waitcnt vmcnt(2)
L_bo62:
    buffer_load_dwordx4 v[204:207], v1, s[40:43], s98 offen offset:3072 nt
    s_waitcnt vmcnt(3)
    s_cmp_ge_u32 s48, 30
    s_cbranch_scc1 L_bo63
    s_waitcnt vmcnt(2)
L_bo63:
    s_add_u32 s98, s98, 28672
    s_cmp_eq_u32 s98, 258048
    s_cselect_b32 s98, 0, s98
    buffer_load_dwordx4 v[208:211], v1, s[40:43], s98 offen offset:0 nt
    s_waitcnt vmcnt(3)
    s_cmp_ge_u32 s48, 30
    s_cbranch_scc1 L_bo64
    s_waitcnt vmcnt(2)
L_bo64:
    buffer_load_dwordx4 v[212:215], v1, s[40:43], s98 offen offset:1024 nt
    v_mov_b32 v3, 99076
    ds_read_b32 v3, v3
    s_waitcnt vmcnt(3)
    s_cmp_ge_u32 s48, 31
    s_cbranch_scc1 L_bo65
    s_waitcnt vmcnt(2)
L_bo65:
    s_waitcnt lgkmcnt(0)
    v_readfirstlane_b32 s48, v3
    buffer_load_dwordx4 v[216:219], v1, s[40:43], s98 offen offset:2048 nt
    s_waitcnt vmcnt(3)
    s_cmp_ge_u32 s48, 22
    s_cbranch_scc1 L_bo66
    s_waitcnt vmcnt(2)
L_bo66:
    buffer_load_dwordx4 v[220:223], v1, s[40:43], s98 offen offset:3072 nt
    s_waitcnt vmcnt(3)
    s_cmp_ge_u32 s48, 23
    s_cbranch_scc1 L_bo67
    s_waitcnt vmcnt(2)
L_bo67:
    s_add_u32 s98, s98, 28672
    s_cmp_eq_u32 s98, 258048
    s_cselect_b32 s98, 0, s98
    buffer_load_dwordx4 v[224:227], v1, s[40:43], s98 offen offset:0 nt
    s_waitcnt vmcnt(3)
    s_cmp_ge_u32 s48, 24
    s_cbranch_scc1 L_bo68
    s_waitcnt vmcnt(2)
L_bo68:
    buffer_load_dwordx4 v[228:231], v1, s[40:43], s98 offen offset:1024 nt
    s_waitcnt vmcnt(3)
    s_cmp_ge_u32 s48, 25
    s_cbranch_scc1 L_bo69
    s_waitcnt vmcnt(2)
L_bo69:
    buffer_load_dwordx4 v[232:235], v1, s[40:43], s98 offen offset:2048 nt
    s_waitcnt vmcnt(3)
    s_cmp_ge_u32 s48, 26
    s_cbranch_scc1 L_bo70
    s_waitcnt vmcnt(2)
L_bo70:
    buffer_load_dwordx4 v[236:239], v1, s[40:43], s98 offen offset:3072 nt
    v_mov_b32 v14, 99080
    s_mov_b32 s35, 0
L_poll71:
    ds_read_b128 v[4:7], v2
    ds_read_b32 v8, v14
    s_add_u32 s35, s35, 1
    s_waitcnt lgkmcnt(0)
    v_max3_u32 v3, v4, v5, v6
    v_max_u32 v3, v3, v7
    v_cmp_eq_u32 vcc, -1, v3
    s_cbranch_vccz L_done72
    s_sleep 2
    s_cmp_lt_u32 s35, 60000
    s_cbranch_scc1 L_poll71
L_done72:
    v_readfirstlane_b32 s99, v8
    s_waitcnt vmcnt(3)
    s_cmp_ge_u32 s48, 27
    s_cbranch_scc1 L_bo74
    s_waitcnt vmcnt(2)
L_bo74:
    s_add_u32 s98, s98, 28672
    s_cmp_eq_u32 s98, 258048
    s_cselect_b32 s98, 0, s98
    buffer_load_dwordx4 v[240:243], v1, s[40:43], s98 offen offset:0 nt
    v_mov_b32 v3, 57
    v_mov_b32 v14, 99072
    s_mov_b64 exec, 1
    ds_write_b32 v14, v3
    s_mov_b64 exec, -1
    v_dot2_f32_bf16 v8, v16, v4, 0
    v_dot2_f32_bf16 v9, v20, v4, 0
    v_dot2_f32_bf16 v10, v24, v4, 0
    v_dot2_f32_bf16 v11, v28, v4, 0
    v_dot2c_f32_bf16 v8, v17, v5
    v_dot2c_f32_bf16 v9, v21, v5
    v_dot2c_f32_bf16 v10, v25, v5
    v_dot2c_f32_bf16 v11, v29, v5
    v_dot2c_f32_bf16 v8, v18, v6
    v_dot2c_f32_bf16 v9, v22, v6
    v_dot2c_f32_bf16 v10, v26, v6
    v_dot2c_f32_bf16 v11, v30, v6
    v_dot2c_f32_bf16 v8, v19, v7
    v_dot2c_f32_bf16 v9, v23, v7
    v_dot2c_f32_bf16 v10, v27, v7
    v_dot2c_f32_bf16 v11, v31, v7
    v_add_f32_dpp v12, v8, v8 row_ror:8 row_mask:0xf bank_mask:0x3
    v_add_f32_dpp v12, v9, v9 row_ror:8 row_mask:0xf bank_mask:0xc
    v_add_f32_dpp v13, v10, v10 row_ror:8 row_mask:0xf bank_mask:0x3
    v_add_f32_dpp v13, v11, v11 row_ror:8 row_mask:0xf bank_mask:0xc
    v_dot2_f32_bf16 v8, v32, v4, 0
    v_dot2_f32_bf16 v9, v36, v4, 0
    v_dot2_f32_bf16 v10, v40, v4, 0
    v_dot2_f32_bf16 v11, v44, v4, 0
    v_add_f32_dpp v12, v12, v12 row_half_mirror row_mask:0xf bank_mask:0xf
    v_add_f32_dpp v13, v13, v13 row_half_mirror row_mask:0xf bank_mask:0xf
    v_dot2c_f32_bf16 v8, v33, v5
    v_dot2c_f32_bf16 v9, v37, v5
    v_dot2c_f32_bf16 v10, v41, v5
    v_dot2c_f32_bf16 v11, v45, v5
    v_add_f32_dpp v12, v12, v12 quad_perm:[1,0,3,2] row_mask:0xf bank_mask:0xf
    v_add_f32_dpp v13, v13, v13 quad_perm:[1,0,3,2] row_mask:0xf bank_mask:0xf
    v_dot2c_f32_bf16 v8, v34, v6
    v_dot2c_f32_bf16 v9, v38, v6
    v_dot2c_f32_bf16 v10, v42, v6
    v_dot2c_f32_bf16 v11, v46, v6
    s_waitcnt vmcnt(3)
    s_cmp_ge_u32 s48, 28
    s_cbranch_scc1 L_bo75
    s_waitcnt vmcnt(2)
L_bo75:
    buffer_load_dwordx4 v[244:247], v1, s[40:43], s98 offen offset:1024 nt
    v_add_f32_dpp v12, v12, v12 quad_perm:[2,3,0,1] row_mask:0xf bank_mask:0xf
    v_add_f32_dpp v13, v13, v13 quad_perm:[2,3,0,1] row_mask:0xf bank_mask:0xf
    v_dot2c_f32_bf16 v8, v35, v7
    v_dot2c_f32_bf16 v9, v39, v7
    v_dot2c_f32_bf16 v10, v43, v7
    v_dot2c_f32_bf16 v11, v47, v7
    v_add_f32_dpp v16, v8, v8 row_ror:8 row_mask:0xf bank_mask:0x3
    v_add_f32_dpp v16, v9, v9 row_ror:8 row_mask:0xf bank_mask:0xc
    v_add_f32_dpp v17, v10, v10 row_ror:8 row_mask:0xf bank_mask:0x3
    v_add_f32_dpp v17, v11, v11 row_ror:8 row_mask:0xf bank_mask:0xc
    v_dot2_f32_bf16 v8, v48, v4, 0
    v_dot2_f32_bf16 v9, v52, v4, 0
    v_dot2_f32_bf16 v10, v56, v4, 0
    v_dot2_f32_bf16 v11, v60, v4, 0
    v_add_f32_dpp v16, v16, v16 row_half_mirror row_mask:0xf bank_mask:0xf
    v_add_f32_dpp v17, v17, v17 row_half_mirror row_mask:0xf bank_mask:0xf
    v_dot2c_f32_bf16 v8, v49, v5
    v_dot2c_f32_bf16 v9, v53, v5
    v_dot2c_f32_bf16 v10, v57, v5
    v_dot2c_f32_bf16 v11, v61, v5
    v_add_f32_dpp v16, v16, v16 quad_perm:[1,0,3,2] row_mask:0xf bank_mask:0xf
    v_add_f32_dpp v17, v17, v17 quad_perm:[1,0,3,2] row_mask:0xf bank_mask:0xf
    v_dot2c_f32_bf16 v8, v50, v6
    v_dot2c_f32_bf16 v9, v54, v6
    v_dot2c_f32_bf16 v10, v58, v6
    v_dot2c_f32_bf16 v11, v62, v6
    v_add_f32_dpp v16, v16, v16 quad_perm:[2,3,0,1] row_mask:0xf bank_mask:0xf
    v_add_f32_dpp v17, v17, v17 quad_perm:[2,3,0,1] row_mask:0xf bank_mask:0xf
    v_dot2c_f32_bf16 v8, v51, v7
    v_dot2c_f32_bf16 v9, v55, v7
    v_dot2c_f32_bf16 v10, v59, v7
    v_dot2c_f32_bf16 v11, v63, v7
    v_add_f32_dpp v18, v8, v8 row_ror:8 row_mask:0xf bank_mask:0x3
    v_add_f32_dpp v18, v9, v9 row_ror:8 row_mask:0xf bank_mask:0xc
    v_add_f32_dpp v19, v10, v10 row_ror:8 row_mask:0xf bank_mask:0x3
    v_add_f32_dpp v19, v11, v11 row_ror:8 row_mask:0xf bank_mask:0xc
    s_waitcnt vmcnt(3)
    s_cmp_ge_u32 s48, 28
    s_cbranch_scc1 L_bo76
    s_waitcnt vmcnt(2)
L_bo76:
    buffer_load_dwordx4 v[248:251], v1, s[40:43], s98 offen offset:2048 nt
    v_dot2_f32_bf16 v8, v64, v4, 0
    v_dot2_f32_bf16 v9, v68, v4, 0
    v_dot2_f32_bf16 v10, v72, v4, 0
    v_dot2_f32_bf16 v11, v76, v4, 0
    v_add_f32_dpp v18, v18, v18 row_half_mirror row_mask:0xf bank_mask:0xf
    v_add_f32_dpp v19, v19, v19 row_half_mirror row_mask:0xf bank_mask:0xf
    v_dot2c_f32_bf16 v8, v65, v5
    v_dot2c_f32_bf16 v9, v69, v5
    v_dot2c_f32_bf16 v10, v73, v5
    v_dot2c_f32_bf16 v11, v77, v5
    v_add_f32_dpp v18, v18, v18 quad_perm:[1,0,3,2] row_mask:0xf bank_mask:0xf
    v_add_f32_dpp v19, v19, v19 quad_perm:[1,0,3,2] row_mask:0xf bank_mask:0xf
    v_dot2c_f32_bf16 v8, v66, v6
    v_dot2c_f32_bf16 v9, v70, v6
    v_dot2c_f32_bf16 v10, v74, v6
    v_dot2c_f32_bf16 v11, v78, v6
    v_add_f32_dpp v18, v18, v18 quad_perm:[2,3,0,1] row_mask:0xf bank_mask:0xf
    v_add_f32_dpp v19, v19, v19 quad_perm:[2,3,0,1] row_mask:0xf bank_mask:0xf
    v_dot2c_f32_bf16 v8, v67, v7
    v_dot2c_f32_bf16 v9, v71, v7
    v_dot2c_f32_bf16 v10, v75, v7
    v_dot2c_f32_bf16 v11, v79, v7
    v_add_f32_dpp v20, v8, v8 row_ror:8 row_mask:0xf bank_mask:0x3
    v_add_f32_dpp v20, v9, v9 row_ror:8 row_mask:0xf bank_mask:0xc
    v_add_f32_dpp v21, v10, v10 row_ror:8 row_mask:0xf bank_mask:0x3
    v_add_f32_dpp v21, v11, v11 row_ror:8 row_mask:0xf bank_mask:0xc
    v_dot2_f32_bf16 v8, v80, v4, 0
    v_dot2_f32_bf16 v9, v84, v4, 0
    v_dot2_f32_bf16 v10, v88, v4, 0
    v_dot2_f32_bf16 v11, v92, v4, 0
    v_add_f32_dpp v20, v20, v20 row_half_mirror row_mask:0xf bank_mask:0xf
    v_add_f32_dpp v21, v21, v21 row_half_mirror row_mask:0xf bank_mask:0xf
    v_dot2c_f32_bf16 v8, v81, v5
    v_dot2c_f32_bf16 v9, v85, v5
    v_dot2c_f32_bf16 v10, v89, v5
    v_dot2c_f32_bf16 v11, v93, v5
    s_waitcnt vmcnt(3)
    s_cmp_ge_u32 s48, 29
    s_cbranch_scc1 L_bo77
    s_waitcnt vmcnt(2)
L_bo77:
    buffer_load_dwordx4 v[252:255], v1, s[40:43], s98 offen offset:3072 nt
    v_add_f32_dpp v20, v20, v20 quad_perm:[1,0,3,2] row_mask:0xf bank_mask:0xf
    v_add_f32_dpp v21, v21, v21 quad_perm:[1,0,3,2] row_mask:0xf bank_mask:0xf
    v_dot2c_f32_bf16 v8, v82, v6
    v_dot2c_f32_bf16 v9, v86, v6
    v_dot2c_f32_bf16 v10, v90, v6
    v_dot2c_f32_bf16 v11, v94, v6
    v_add_f32_dpp v20, v20, v20 quad_perm:[2,3,0,1] row_mask:0xf bank_mask:0xf
    v_add_f32_dpp v21, v21, v21 quad_perm:[2,3,0,1] row_mask:0xf bank_mask:0xf
    v_dot2c_f32_bf16 v8, v83, v7
    v_dot2c_f32_bf16 v9, v87, v7
    v_dot2c_f32_bf16 v10, v91, v7
    v_dot2c_f32_bf16 v11, v95, v7
    v_add_f32_dpp v22, v8, v8 row_ror:8 row_mask:0xf bank_mask:0x3
    v_add_f32_dpp v22, v9, v9 row_ror:8 row_mask:0xf bank_mask:0xc
    v_add_f32_dpp v23, v10, v10 row_ror:8 row_mask:0xf bank_mask:0x3
    v_add_f32_dpp v23, v11, v11 row_ror:8 row_mask:0xf bank_mask:0xc
    v_dot2_f32_bf16 v8, v96, v4, 0
    v_dot2_f32_bf16 v9, v100, v4, 0
    v_dot2_f32_bf16 v10, v104, v4, 0
    v_dot2_f32_bf16 v11, v108, v4, 0
    v_add_f32_dpp v22, v22, v22 row_half_mirror row_mask:0xf bank_mask:0xf
    v_add_f32_dpp v23, v23, v23 row_half_mirror row_mask:0xf bank_mask:0xf
    v_dot2c_f32_bf16 v8, v97, v5
    v_dot2c_f32_bf16 v9, v101, v5
    v_dot2c_f32_bf16 v10, v105, v5
    v_dot2c_f32_bf16 v11, v109, v5
    v_add_f32_dpp v22, v22, v22 quad_perm:[1,0,3,2] row_mask:0xf bank_mask:0xf
    v_add_f32_dpp v23, v23, v23 quad_perm:[1,0,3,2] row_mask:0xf bank_mask:0xf
    v_dot2c_f32_bf16 v8, v98, v6
    v_dot2c_f32_bf16 v9, v102, v6
    v_dot2c_f32_bf16 v10, v106, v6
    v_dot2c_f32_bf16 v11, v110, v6
    v_add_f32_dpp v22, v22, v22 quad_perm:[2,3,0,1] row_mask:0xf bank_mask:0xf
    v_add_f32_dpp v23, v23, v23 quad_perm:[2,3,0,1] row_mask:0xf bank_mask:0xf
    v_dot2c_f32_bf16 v8, v99, v7
    v_dot2c_f32_bf16 v9, v103, v7
    s_waitcnt vmcnt(3)
    s_cmp_ge_u32 s48, 29
    s_cbranch_scc1 L_bo78
    s_waitcnt vmcnt(2)
L_bo78:
    s_add_u32 s98, s98, 28672
    s_cmp_eq_u32 s98, 258048
    s_cselect_b32 s98, 0, s98
    buffer_load_dwordx4 v[32:35], v1, s[40:43], s98 offen offset:0 nt
    v_dot2c_f32_bf16 v10, v107, v7
    v_dot2c_f32_bf16 v11, v111, v7
    v_add_f32_dpp v24, v8, v8 row_ror:8 row_mask:0xf bank_mask:0x3
    v_add_f32_dpp v24, v9, v9 row_ror:8 row_mask:0xf bank_mask:0xc
    v_add_f32_dpp v25, v10, v10 row_ror:8 row_mask:0xf bank_mask:0x3
    v_add_f32_dpp v25, v11, v11 row_ror:8 row_mask:0xf bank_mask:0xc
    v_dot2_f32_bf16 v8, v112, v4, 0
    v_dot2_f32_bf16 v9, v116, v4, 0
    v_dot2_f32_bf16 v10, v120, v4, 0
    v_dot2_f32_bf16 v11, v124, v4, 0
    v_add_f32_dpp v24, v24, v24 row_half_mirror row_mask:0xf bank_mask:0xf
    v_add_f32_dpp v25, v25, v25 row_half_mirror row_mask:0xf bank_mask:0xf
    v_dot2c_f32_bf16 v8, v113, v5
    v_dot2c_f32_bf16 v9, v117, v5
    v_dot2c_f32_bf16 v10, v121, v5
    v_dot2c_f32_bf16 v11, v125, v5
    v_add_f32_dpp v24, v24, v24 quad_perm:[1,0,3,2] row_mask:0xf bank_mask:0xf
    v_add_f32_dpp v25, v25, v25 quad_perm:[1,0,3,2] row_mask:0xf bank_mask:0xf
    v_dot2c_f32_bf16 v8, v114, v6
    v_dot2c_f32_bf16 v9, v118, v6
    v_dot2c_f32_bf16 v10, v122, v6
    v_dot2c_f32_bf16 v11, v126, v6
    v_add_f32_dpp v24, v24, v24 quad_perm:[2,3,0,1] row_mask:0xf bank_mask:0xf
    v_add_f32_dpp v25, v25, v25 quad_perm:[2,3,0,1] row_mask:0xf bank_mask:0xf
    v_dot2c_f32_bf16 v8, v115, v7
    v_dot2c_f32_bf16 v9, v119, v7
    v_dot2c_f32_bf16 v10, v123, v7
    v_dot2c_f32_bf16 v11, v127, v7
    v_add_f32_dpp v26, v8, v8 row_ror:8 row_mask:0xf bank_mask:0x3
    v_add_f32_dpp v26, v9, v9 row_ror:8 row_mask:0xf bank_mask:0xc
    v_add_f32_dpp v27, v10, v10 row_ror:8 row_mask:0xf bank_mask:0x3
    v_add_f32_dpp v27, v11, v11 row_ror:8 row_mask:0xf bank_mask:0xc
    v_dot2_f32_bf16 v8, v128, v4, 0
    v_dot2_f32_bf16 v9, v132, v4, 0
    v_dot2_f32_bf16 v10, v136, v4, 0
    v_dot2_f32_bf16 v11, v140, v4, 0
    v_mov_b32 v3, 99076
    ds_read_b32 v3, v3
    s_waitcnt vmcnt(3)
    s_cmp_ge_u32 s48, 30
    s_cbranch_scc1 L_bo79
    s_waitcnt vmcnt(2)
L_bo79:
    s_waitcnt lgkmcnt(0)
    v_readfirstlane_b32 s48, v3
    buffer_load_dwordx4 v[36:39], v1, s[40:43], s98 offen offset:1024 nt
    v_add_f32_dpp v26, v26, v26 row_half_mirror row_mask:0xf bank_mask:0xf
    v_add_f32_dpp v27, v27, v27 row_half_mirror row_mask:0xf bank_mask:0xf
    v_dot2c_f32_bf16 v8, v129, v5
    v_dot2c_f32_bf16 v9, v133, v5
    v_dot2c_f32_bf16 v10, v137, v5
    v_dot2c_f32_bf16 v11, v141, v5
    v_add_f32_dpp v26, v26, v26 quad_perm:[1,0,3,2] row_mask:0xf bank_mask:0xf
    v_add_f32_dpp v27, v27, v27 quad_perm:[1,0,3,2] row_mask:0xf bank_mask:0xf
    v_dot2c_f32_bf16 v8, v130, v6
    v_dot2c_f32_bf16 v9, v134, v6
    v_dot2c_f32_bf16 v10, v138, v6
    v_dot2c_f32_bf16 v11, v142, v6
    v_add_f32_dpp v26, v26, v26 quad_perm:[2,3,0,1] row_mask:0xf bank_mask:0xf
    v_add_f32_dpp v27, v27, v27 quad_perm:[2,3,0,1] row_mask:0xf bank_mask:0xf
    v_dot2c_f32_bf16 v8, v131, v7
    v_dot2c_f32_bf16 v9, v135, v7
    v_dot2c_f32_bf16 v10, v139, v7
    v_dot2c_f32_bf16 v11, v143, v7
    v_add_f32_dpp v28, v8, v8 row_ror:8 row_mask:0xf bank_mask:0x3
    v_add_f32_dpp v28, v9, v9 row_ror:8 row_mask:0xf bank_mask:0xc
    v_add_f32_dpp v29, v10, v10 row_ror:8 row_mask:0xf bank_mask:0x3
    v_add_f32_dpp v29, v11, v11 row_ror:8 row_mask:0xf bank_mask:0xc
    v_dot2_f32_bf16 v8, v144, v4, 0
    v_dot2_f32_bf16 v9, v148, v4, 0
    v_dot2_f32_bf16 v10, v152, v4, 0
    v_dot2_f32_bf16 v11, v156, v4, 0
    v_add_f32_dpp v28, v28, v28 row_half_mirror row_mask:0xf bank_mask:0xf
    v_add_f32_dpp v29, v29, v29 row_half_mirror row_mask:0xf bank_mask:0xf
    v_dot2c_f32_bf16 v8, v145, v5
    v_dot2c_f32_bf16 v9, v149, v5
    v_dot2c_f32_bf16 v10, v153, v5
    v_dot2c_f32_bf16 v11, v157, v5
    v_add_f32_dpp v28, v28, v28 quad_perm:[1,0,3,2] row_mask:0xf bank_mask:0xf
    v_add_f32_dpp v29, v29, v29 quad_perm:[1,0,3,2] row_mask:0xf bank_mask:0xf
    v_dot2c_f32_bf16 v8, v146, v6
    v_dot2c_f32_bf16 v9, v150, v6
    s_waitcnt vmcnt(3)
    s_cmp_ge_u32 s48, 19
    s_cbranch_scc1 L_bo80
    s_waitcnt vmcnt(2)
L_bo80:
    buffer_load_dwordx4 v[40:43], v1, s[40:43], s98 offen offset:2048 nt
    v_dot2c_f32_bf16 v10, v154, v6
    v_dot2c_f32_bf16 v11, v158, v6
    v_add_f32_dpp v28, v28, v28 quad_perm:[2,3,0,1] row_mask:0xf bank_mask:0xf
    v_add_f32_dpp v29, v29, v29 quad_perm:[2,3,0,1] row_mask:0xf bank_mask:0xf
    v_dot2c_f32_bf16 v8, v147, v7
    v_dot2c_f32_bf16 v9, v151, v7
    v_dot2c_f32_bf16 v10, v155, v7
    v_dot2c_f32_bf16 v11, v159, v7
    v_add_f32_dpp v30, v8, v8 row_ror:8 row_mask:0xf bank_mask:0x3
    v_add_f32_dpp v30, v9, v9 row_ror:8 row_mask:0xf bank_mask:0xc
    v_add_f32_dpp v31, v10, v10 row_ror:8 row_mask:0xf bank_mask:0x3
    v_add_f32_dpp v31, v11, v11 row_ror:8 row_mask:0xf bank_mask:0xc
    v_add_f32_dpp v30, v30, v30 row_half_mirror row_mask:0xf bank_mask:0xf
    s_nop 0
    v_add_f32_dpp v31, v31, v31 row_half_mirror row_mask:0xf bank_mask:0xf
    v_add_f32_dpp v30, v30, v30 quad_perm:[1,0,3,2] row_mask:0xf bank_mask:0xf
    s_nop 0
    v_add_f32_dpp v31, v31, v31 quad_perm:[1,0,3,2] row_mask:0xf bank_mask:0xf
    v_add_f32_dpp v30, v30, v30 quad_perm:[2,3,0,1] row_mask:0xf bank_mask:0xf
    s_nop 0
    v_add_f32_dpp v31, v31, v31 quad_perm:[2,3,0,1] row_mask:0xf bank_mask:0xf
    v_max3_f32 v8, v12, v13, v16
    v_max3_f32 v8, v8, v17, v18
    v_max3_f32 v8, v8, v19, v20
    v_max3_f32 v8, v8, v21, v22
    v_max3_f32 v8, v8, v23, v24
    v_max3_f32 v8, v8, v25, v26
    v_max3_f32 v8, v8, v27, v28
    v_max3_f32 v8, v8, v29, v30
    v_max_f32 v8, v8, v31
    s_mov_b32 s34, 0x3e0293ee
    s_nop 0
    v_max_f32_dpp v8, v8, v8 row_ror:8 row_mask:0xf bank_mask:0xf
    v_mov_b32 v9, v8
    s_nop 1
    v_permlane16_swap_b32 v8, v9
    v_max_f32 v8, v8, v9
    v_mov_b32 v9, v8
    s_nop 1
    v_permlane32_swap_b32 v8, v9
    v_max_f32 v8, v8, v9
    v_mul_f32 v8, s34, v8
    s_waitcnt vmcnt(3)
    s_cmp_ge_u32 s48, 20
    s_cbranch_scc1 L_bo81
    s_waitcnt vmcnt(2)
L_bo81:
    buffer_load_dwordx4 v[44:47], v1, s[40:43], s98 offen offset:3072 nt
    v_fma_f32 v12, v12, s34, -v8
    v_fma_f32 v13, v13, s34, -v8
    v_fma_f32 v16, v16, s34, -v8
    v_fma_f32 v17, v17, s34, -v8
    v_fma_f32 v18, v18, s34, -v8
    v_fma_f32 v19, v19, s34, -v8
    v_fma_f32 v20, v20, s34, -v8
    v_fma_f32 v21, v21, s34, -v8
    v_fma_f32 v22, v22, s34, -v8
    v_fma_f32 v23, v23, s34, -v8
    v_fma_f32 v24, v24, s34, -v8
    v_fma_f32 v25, v25, s34, -v8
    v_fma_f32 v26, v26, s34, -v8
    v_fma_f32 v27, v27, s34, -v8
    v_fma_f32 v28, v28, s34, -v8
    v_fma_f32 v29, v29, s34, -v8
    v_fma_f32 v30, v30, s34, -v8
    v_fma_f32 v31, v31, s34, -v8
    v_exp_f32 v12, v12
    v_exp_f32 v13, v13
    v_exp_f32 v16, v16
    v_exp_f32 v17, v17
    v_exp_f32 v18, v18
    v_exp_f32 v19, v19
    v_exp_f32 v20, v20
    v_exp_f32 v21, v21
    v_exp_f32 v22, v22
    v_exp_f32 v23, v23
    v_exp_f32 v24, v24
    v_exp_f32 v25, v25
    v_exp_f32 v26, v26
    v_exp_f32 v27, v27
    v_exp_f32 v28, v28
    v_exp_f32 v29, v29
    v_exp_f32 v30, v30
    v_exp_f32 v31, v31
    s_waitcnt vmcnt(3)
    s_cmp_ge_u32 s48, 21
    s_cbranch_scc1 L_bo82
    s_waitcnt vmcnt(2)
L_bo82:
    s_add_u32 s98, s98, 28672
    s_cmp_eq_u32 s98, 258048
    s_cselect_b32 s98, 0, s98
    buffer_load_dwordx4 v[48:51], v1, s[40:43], s98 offen offset:0 nt
    v_add_f32 v9, v12, v13
    v_add_f32 v9, v9, v16
    v_add_f32 v9, v9, v17
    v_add_f32 v9, v9, v18
    v_add_f32 v9, v9, v19
    v_add_f32 v9, v9, v20
    v_add_f32 v9, v9, v21
    v_add_f32 v9, v9, v22
    v_add_f32 v9, v9, v23
    v_add_f32 v9, v9, v24
    v_add_f32 v9, v9, v25
    v_add_f32 v9, v9, v26
    v_add_f32 v9, v9, v27
    v_add_f32 v9, v9, v28
    v_add_f32 v9, v9, v29
    v_add_f32 v9, v9, v30
    v_add_f32 v9, v9, v31
    v_and_b32 v10, 1, v0
    v_lshlrev_b32 v10, 4, v10
    v_mov_b32 v11, 0xffff
    v_lshlrev_b32 v10, v10, v11
    v_bfe_u32 v11, v0, 1, 2
    v_cmp_eq_u32 vcc, 0, v11
    s_nop 1
    v_cndmask_b32 v144, 0, v10, vcc
    v_cmp_eq_u32 vcc, 1, v11
    s_nop 1
    v_cndmask_b32 v145, 0, v10, vcc
    v_cmp_eq_u32 vcc, 2, v11
    s_nop 1
    v_cndmask_b32 v146, 0, v10, vcc
    v_cmp_eq_u32 vcc, 3, v11
    s_nop 1
    v_cndmask_b32 v147, 0, v10, vcc
    v_add_f32_dpp v9, v9, v9 row_ror:8 row_mask:0xf bank_mask:0xf
    v_mov_b32 v10, v9
    s_nop 1
    v_permlane16_swap_b32 v9, v10
    v_add_f32 v9, v9, v10
    v_mov_b32 v10, v9
    s_nop 1
    v_permlane32_swap_b32 v9, v10
    s_waitcnt vmcnt(3)
    s_cmp_ge_u32 s48, 23
    s_cbranch_scc1 L_bo83
    s_waitcnt vmcnt(2)
L_bo83:
    buffer_load_dwordx4 v[52:55], v1, s[40:43], s98 offen offset:1024 nt
    v_add_f32 v9, v9, v10
    s_lshl_b32 s34, s3, 3
    s_add_u32 s34, s34, 98552
    v_mov_b32 v10, s34
    s_mov_b64 exec, 1
    ds_write_b64 v10, v[8:9]
    s_mov_b64 exec, -1
    s_lshl_b32 s34, s3, 10
    s_add_u32 s34, s34, 98304
    v_lshrrev_b32 v2, 4, v0
    v_and_b32 v11, 7, v0
    v_lshl_add_u32 v2, v2, 3, v11
    v_bfe_u32 v11, v0, 3, 1
    v_lshl_add_u32 v2, v11, 5, v2
    v_lshl_add_u32 v2, v2, 4, s34
    v_cvt_pk_bf16_f32 v10, v12, v12
    v_and_b32 v128, v10, v144
    v_and_b32 v129, v10, v145
    v_and_b32 v130, v10, v146
    v_and_b32 v131, v10, v147
    s_nop 1
    v_mfma_f32_16x16x32_bf16 v[148:151], v[160:163], v[128:131], 0
    v_mfma_f32_16x16x32_bf16 v[152:155], v[164:167], v[128:131], 0
    v_cvt_pk_bf16_f32 v10, v13, v13
    v_and_b32 v132, v10, v144
    v_and_b32 v133, v10, v145
    v_and_b32 v134, v10, v146
    v_and_b32 v135, v10, v147
    s_nop 1
    v_mfma_f32_16x16x32_bf16 v[148:151], v[168:171], v[132:135], v[148:151]
    v_mfma_f32_16x16x32_bf16 v[152:155], v[172:175], v[132:135], v[152:155]
    v_cvt_pk_bf16_f32 v10, v16, v16
    v_and_b32 v128, v10, v144
    v_and_b32 v129, v10, v145
    v_and_b32 v130, v10, v146
    v_and_b32 v131, v10, v147
    s_nop 1
    v_mfma_f32_16x16x32_bf16 v[148:151], v[176:179], v[128:131], v[148:151]
    v_mfma_f32_16x16x32_bf16 v[152:155], v[180:183], v[128:131], v[152:155]
    v_cvt_pk_bf16_f32 v10, v17, v17
    v_and_b32 v132, v10, v144
    s_cmp_ge_u32 s48, 24
    s_cbranch_scc1 L_bo84
    s_waitcnt vmcnt(3)
L_bo84:
    buffer_load_dwordx4 v[56:59], v1, s[40:43], s98 offen offset:2048 nt
    v_and_b32 v133, v10, v145
    v_and_b32 v134, v10, v146
    v_and_b32 v135, v10, v147
    s_nop 1
    v_mfma_f32_16x16x32_bf16 v[148:151], v[184:187], v[132:135], v[148:151]
    v_mfma_f32_16x16x32_bf16 v[152:155], v[188:191], v[132:135], v[152:155]
    v_cvt_pk_bf16_f32 v10, v18, v18
    v_and_b32 v128, v10, v144
    v_and_b32 v129, v10, v145
    v_and_b32 v130, v10, v146
    v_and_b32 v131, v10, v147
    s_nop 1
    v_mfma_f32_16x16x32_bf16 v[148:151], v[192:195], v[128:131], v[148:151]
    v_mfma_f32_16x16x32_bf16 v[152:155], v[196:199], v[128:131], v[152:155]
    v_cvt_pk_bf16_f32 v10, v19, v19
    v_and_b32 v132, v10, v144
    v_and_b32 v133, v10, v145
    v_and_b32 v134, v10, v146
    v_and_b32 v135, v10, v147
    s_nop 1
    v_mfma_f32_16x16x32_bf16 v[148:151], v[200:203], v[132:135], v[148:151]
    v_mfma_f32_16x16x32_bf16 v[152:155], v[204:207], v[132:135], v[152:155]
    v_cvt_pk_bf16_f32 v10, v20, v20
    v_and_b32 v128, v10, v144
    v_and_b32 v129, v10, v145
    v_and_b32 v130, v10, v146
    v_and_b32 v131, v10, v147
    s_nop 1
    v_mfma_f32_16x16x32_bf16 v[148:151], v[208:211], v[128:131], v[148:151]
    v_mfma_f32_16x16x32_bf16 v[152:155], v[212:215], v[128:131], v[152:155]
    v_cvt_pk_bf16_f32 v10, v21, v21
    v_and_b32 v132, v10, v144
    v_and_b32 v133, v10, v145
    v_and_b32 v134, v10, v146
    v_and_b32 v135, v10, v147
    s_nop 1
    v_mfma_f32_16x16x32_bf16 v[148:151], v[216:219], v[132:135], v[148:151]
    v_mfma_f32_16x16x32_bf16 v[152:155], v[220:223], v[132:135], v[152:155]
    v_cvt_pk_bf16_f32 v10, v22, v22
    v_and_b32 v128, v10, v144
    v_and_b32 v129, v10, v145
    s_waitcnt vmcnt(4)
    s_cmp_ge_u32 s48, 25
    s_cbranch_scc1 L_bo85
    s_waitcnt vmcnt(3)
L_bo85:
    buffer_load_dwordx4 v[60:63], v1, s[40:43], s98 offen offset:3072 nt
    v_and_b32 v130, v10, v146
    v_and_b32 v131, v10, v147
    s_nop 1
    v_mfma_f32_16x16x32_bf16 v[148:151], v[224:227], v[128:131], v[148:151]
    v_mfma_f32_16x16x32_bf16 v[152:155], v[228:231], v[128:131], v[152:155]
    v_cvt_pk_bf16_f32 v10, v23, v23
    v_and_b32 v132, v10, v144
    v_and_b32 v133, v10, v145
    v_and_b32 v134, v10, v146
    v_and_b32 v135, v10, v147
    s_nop 1
    v_mfma_f32_16x16x32_bf16 v[148:151], v[232:235], v[132:135], v[148:151]
    v_mfma_f32_16x16x32_bf16 v[152:155], v[236:239], v[132:135], v[152:155]
    v_cvt_pk_bf16_f32 v10, v24, v24
    v_and_b32 v128, v10, v144
    v_and_b32 v129, v10, v145
    v_and_b32 v130, v10, v146
    v_and_b32 v131, v10, v147
    s_nop 1
    v_mfma_f32_16x16x32_bf16 v[148:151], v[240:243], v[128:131], v[148:151]
    v_mfma_f32_16x16x32_bf16 v[152:155], v[244:247], v[128:131], v[152:155]
    v_cvt_pk_bf16_f32 v10, v25, v25
    v_and_b32 v132, v10, v144
    v_and_b32 v133, v10, v145
    v_and_b32 v134, v10, v146
    v_and_b32 v135, v10, v147
    s_nop 1
    v_mfma_f32_16x16x32_bf16 v[148:151], v[248:251], v[132:135], v[148:151]
    v_mfma_f32_16x16x32_bf16 v[152:155], v[252:255], v[132:135], v[152:155]
    v_cvt_pk_bf16_f32 v10, v26, v26
    v_and_b32 v128, v10, v144
    v_and_b32 v129, v10, v145
    v_and_b32 v130, v10, v146
    v_and_b32 v131, v10, v147
    s_nop 1
    v_mfma_f32_16x16x32_bf16 v[148:151], v[32:35], v[128:131], v[148:151]
    v_mfma_f32_16x16x32_bf16 v[152:155], v[36:39], v[128:131], v[152:155]
    v_cvt_pk_bf16_f32 v10, v27, v27
    v_and_b32 v132, v10, v144
    v_and_b32 v133, v10, v145
    v_and_b32 v134, v10, v146
    s_waitcnt vmcnt(4)
    s_cmp_ge_u32 s48, 26
    s_cbranch_scc1 L_bo86
    s_waitcnt vmcnt(3)
L_bo86:
    s_add_u32 s98, s98, 28672
    s_cmp_eq_u32 s98, 258048
    s_cselect_b32 s98, 0, s98
    buffer_load_dwordx4 v[64:67], v1, s[40:43], s98 offen offset:0 nt
    v_and_b32 v135, v10, v147
    s_nop 1
    v_mfma_f32_16x16x32_bf16 v[148:151], v[40:43], v[132:135], v[148:151]
    v_mfma_f32_16x16x32_bf16 v[152:155], v[44:47], v[132:135], v[152:155]
    v_cvt_pk_bf16_f32 v10, v28, v28
    v_and_b32 v128, v10, v144
    v_and_b32 v129, v10, v145
    v_and_b32 v130, v10, v146
    v_and_b32 v131, v10, v147
    s_waitcnt vmcnt(4)
    s_cmp_ge_u32 s48, 27
    s_cbranch_scc1 L_bo87
    s_waitcnt vmcnt(3)
L_bo87:
    buffer_load_dwordx4 v[68:71], v1, s[40:43], s98 offen offset:1024 nt
    buffer_load_dwordx4 v[72:75], v1, s[40:43], s98 offen offset:2048 nt
    s_waitcnt vmcnt(5)
    buffer_load_dwordx4 v[76:79], v1, s[40:43], s98 offen offset:3072 nt
    s_barrier
    v_and_b32 v200, 3, v0
    v_bfe_u32 v201, v0, 2, 2
    v_lshrrev_b32 v202, 4, v0
    s_lshl_b32 s34, s3, 10
    s_add_u32 s34, s34, 122112
    v_mul_u32_u24 v203, 320, v201
    v_min_u32 v203, 704, v203
    v_lshl_add_u32 v203, v202, 6, v203
    v_lshl_add_u32 v203, v200, 4, v203
    v_add_u32 v203, s34, v203
    s_movk_i32 s48, 16384
    s_cmp_eq_u32 s63, 0
    s_cbranch_scc1 L_tp_wo
    s_cmp_eq_u32 s63, 1
    s_cbranch_scc1 L_tp_w1
    v_bfe_u32 v205, v0, 3, 2
    v_lshlrev_b32 v204, 3, v205
    v_lshrrev_b32 v205, 5, v0
    v_lshl_add_u32 v204, v205, 2, v204
    v_bfe_u32 v205, v0, 1, 2
    v_add_u32 v204, v204, v205
    v_and_b32 v205, 1, v0
    s_sub_u32 s49, s3, 1
    v_mul_u32_u24 v204, 1280, v204
    v_lshl_add_u32 v204, v205, 4, v204
    s_lshl_b32 s34, s62, 5
    s_mul_i32 s35, s49, 327680
    s_add_u32 s34, s34, s35
    v_add_u32 v204, s34, v204
    s_lshl_b32 s50, s49, 13
    s_add_u32 s50, s50, 40960
    v_lshl_add_u32 v205, v0, 3, s50
    s_lshl_b32 s34, s49, 8
    s_add_u32 s34, s34, s99
    s_add_u32 s34, s34, 791552
    s_cmp_eq_u32 s49, 6
    s_cselect_b32 s35, 1, 3
    v_lshlrev_b32 v6, 6, v202
    v_lshl_add_u32 v6, v200, 4, v6
    v_add_u32 v6, s34, v6
    v_lshl_add_u32 v4, v201, 15, v6
    v_min_u32 v5, s35, v201
    v_lshl_add_u32 v5, v5, 15, v6
    v_mov_b32 v7, 99084
    s_lshl_b32 s40, s62, 1
    s_add_u32 s41, s40, 8
    s_add_u32 s42, s40, 2
    s_branch L_tp_e
L_tp_w1:
    v_and_b32 v205, 15, v0
    v_lshlrev_b32 v205, 4, v205
    s_and_b32 s49, s3, 3
    s_mul_i32 s34, s49, 1280
    s_add_u32 s34, s34, s99
    s_add_u32 s34, s34, 786432
    v_lshl_add_u32 v206, v202, 15, v205
    v_add_u32 v206, s34, v206
    s_mul_i32 s34, s49, 3840
    v_add_u32 v205, s34, v205
    s_branch L_tp_e
L_tp_wo:
    s_lshr_b32 s49, s3, 1
    s_lshl_b32 s49, s49, 15
    v_and_b32 v210, 7, v0
    s_mul_i32 s34, s60, 4096
    s_add_u32 s34, s34, s49
    s_add_u32 s34, s34, 1179904
    v_lshrrev_b32 v211, 3, v0
    v_mul_u32_u24 v205, 512, v211
    v_add_u32 v204, s34, v205
    s_lshl_b32 s35, s51, 7
    s_add_u32 s34, s34, s35
    s_sub_u32 s34, s34, 256
    v_lshl_add_u32 v205, v210, 4, v205
    v_add_u32 v205, s34, v205
    s_lshl_b32 s34, s3, 12
    s_add_u32 s34, s34, 40960
    v_lshrrev_b32 v206, 2, v0
    v_lshlrev_b32 v206, 6, v206
    v_lshl_add_u32 v206, v200, 3, v206
    v_add_u32 v206, s34, v206
    s_mul_i32 s34, s3, 1152
    s_add_u32 s34, s34, 107520
    v_mul_u32_u24 v207, 144, v211
    v_lshl_add_u32 v207, v210, 4, v207
    v_add_u32 v207, s34, v207
    v_mul_u32_u24 v208, 144, v210
    v_lshl_add_u32 v208, v202, 4, v208
    v_add_u32 v208, s34, v208
    v_mul_u32_u24 v212, 144, v211
    v_add_u32 v212, s34, v212
    v_mul_u32_u24 v213, 144, v210
    v_add_u32 v213, s34, v213
    v_and_b32 v211, 1, v211
    v_bfe_u32 v203, v0, 1, 2
    v_mul_u32_u24 v203, 144, v203
    v_and_b32 v214, 1, v0
    v_mul_u32_u24 v214, 576, v214
    v_lshl_add_u32 v214, v211, 6, v214
    v_lshl_add_u32 v214, v202, 4, v214
    s_add_u32 s34, s34, 14592
    v_add3_u32 v203, v203, v214, s34
    v_mov_b32 v210, 98816
    v_cmp_eq_u32 vcc, 0, v211
    s_nop 1
    v_cndmask_b32 v209, v208, v210, vcc
    v_cndmask_b32 v208, v210, v208, vcc
L_tp_e:
    v_mfma_f32_16x16x32_bf16 v[148:151], v[48:51], v[128:131], v[148:151]
    v_mfma_f32_16x16x32_bf16 v[152:155], v[52:55], v[128:131], v[152:155]
    v_cvt_pk_bf16_f32 v10, v29, v29
    v_and_b32 v132, v10, v144
    v_and_b32 v133, v10, v145
    v_and_b32 v134, v10, v146
    v_and_b32 v135, v10, v147
    s_waitcnt vmcnt(4)
    s_nop 0
    v_mfma_f32_16x16x32_bf16 v[148:151], v[56:59], v[132:135], v[148:151]
    v_mfma_f32_16x16x32_bf16 v[152:155], v[60:63], v[132:135], v[152:155]
    v_cvt_pk_bf16_f32 v10, v30, v30
    v_and_b32 v128, v10, v144
    v_and_b32 v129, v10, v145
    v_and_b32 v130, v10, v146
    v_and_b32 v131, v10, v147
    s_waitcnt vmcnt(2)
    s_nop 0
    v_mfma_f32_16x16x32_bf16 v[148:151], v[64:67], v[128:131], v[148:151]
    v_mfma_f32_16x16x32_bf16 v[152:155], v[68:71], v[128:131], v[152:155]
    v_cvt_pk_bf16_f32 v10, v31, v31
    v_and_b32 v132, v10, v144
    v_and_b32 v133, v10, v145
    v_and_b32 v134, v10, v146
    v_and_b32 v135, v10, v147
    s_waitcnt vmcnt(0)
    s_nop 0
    v_mfma_f32_16x16x32_bf16 v[148:151], v[72:75], v[132:135], v[148:151]
    v_mfma_f32_16x16x32_bf16 v[152:155], v[76:79], v[132:135], v[152:155]
    s_nop 7
    v_add_f32_dpp v148, v152, v148 row_ror:8 row_mask:0xf bank_mask:0xf
    v_add_f32_dpp v149, v153, v149 row_ror:8 row_mask:0xf bank_mask:0xf
    v_add_f32_dpp v150, v154, v150 row_ror:8 row_mask:0xf bank_mask:0xf
    v_add_f32_dpp v151, v155, v151 row_ror:8 row_mask:0xf bank_mask:0xf
    ds_write_b128 v2, v[148:151]
    s_waitcnt lgkmcnt(0)
    s_barrier
    s_cmp_eq_u32 s63, 0
    s_cbranch_scc1 L_t_wo
    s_cmp_eq_u32 s63, 2
    s_cbranch_scc1 L_t_w2
    s_cmp_eq_u32 s63, 3
    s_cbranch_scc1 L_fin
    s_barrier
L_r_w1:
    s_cmp_lt_u32 s3, 4
    s_cbranch_scc1 L_w1_ln
    s_and_b32 s49, s3, 3
    s_lshl_b32 s42, s49, 11
    s_add_u32 s42, s42, 40960
    s_bitcmp1_b32 s62, 0
    s_cbranch_scc1 L_rot1
    s_add_u32 m0, s42, 0
    s_add_u32 s34, s50, 0
    buffer_load_dwordx4 v15, s[52:55], s34 offen  lds
    s_add_u32 m0, s42, 1024
    s_add_u32 s34, s50, 884736
    buffer_load_dwordx4 v15, s[52:55], s34 offen  lds
    s_add_u32 m0, s42, 8192
    s_add_u32 s34, s50, 110592
    buffer_load_dwordx4 v15, s[52:55], s34 offen  lds
    s_add_u32 m0, s42, 9216
    s_add_u32 s34, s50, 995328
    buffer_load_dwordx4 v15, s[52:55], s34 offen  lds
    s_add_u32 m0, s42, 32768
    s_add_u32 s34, s51, 0
    buffer_load_dwordx4 v15, s[52:55], s34 offen  lds
    s_add_u32 m0, s42, 33792
    s_add_u32 s34, s51, 13824
    buffer_load_dwordx4 v15, s[52:55], s34 offen  lds
    s_add_u32 m0, s42, 16384
    s_add_u32 s34, s50, 221184
    buffer_load_dwordx4 v15, s[52:55], s34 offen  lds
    s_add_u32 m0, s42, 17408
    s_add_u32 s34, s50, 1105920
    buffer_load_dwordx4 v15, s[52:55], s34 offen  lds
    s_add_u32 m0, s42, 24576
    s_add_u32 s34, s50, 331776
    buffer_load_dwordx4 v15, s[52:55], s34 offen  lds
    s_add_u32 m0, s42, 25600
    s_add_u32 s34, s50, 1216512
    buffer_load_dwordx4 v15, s[52:55], s34 offen  lds
    s_branch L_rot2
L_rot1:
    s_add_u32 m0, s42, 16384
    s_add_u32 s34, s50, 221184
    buffer_load_dwordx4 v15, s[52:55], s34 offen  lds
    s_add_u32 m0, s42, 17408
    s_add_u32 s34, s50, 1105920
    buffer_load_dwordx4 v15, s[52:55], s34 offen  lds
    s_add_u32 m0, s42, 24576
    s_add_u32 s34, s50, 331776
    buffer_load_dwordx4 v15, s[52:55], s34 offen  lds
    s_add_u32 m0, s42, 25600
    s_add_u32 s34, s50, 1216512
    buffer_load_dwordx4 v15, s[52:55], s34 offen  lds
    s_add_u32 m0, s42, 32768
    s_add_u32 s34, s51, 0
    buffer_load_dwordx4 v15, s[52:55], s34 offen  lds
    s_add_u32 m0, s42, 33792
    s_add_u32 s34, s51, 13824
    buffer_load_dwordx4 v15, s[52:55], s34 offen  lds
    s_add_u32 m0, s42, 0
    s_add_u32 s34, s50, 0
    buffer_load_dwordx4 v15, s[52:55], s34 offen  lds
    s_add_u32 m0, s42, 1024
    s_add_u32 s34, s50, 884736
    buffer_load_dwordx4 v15, s[52:55], s34 offen  lds
    s_add_u32 m0, s42, 8192
    s_add_u32 s34, s50, 110592
    buffer_load_dwordx4 v15, s[52:55], s34 offen  lds
    s_add_u32 m0, s42, 9216
    s_add_u32 s34, s50, 995328
    buffer_load_dwordx4 v15, s[52:55], s34 offen  lds
L_rot2:
    v_lshrrev_b32 v3, 2, v0
    v_lshlrev_b32 v3, 6, v3
    v_lshl_add_u32 v3, v200, 3, v3
    v_add_u32 v3, s42, v3
    s_lshl_b32 s35, s49, 6
    s_add_u32 s35, s35, 116736
    v_mul_u32_u24 v4, 1344, v200
    v_lshl_add_u32 v4, v202, 4, v4
    v_add_u32 v4, s35, v4
    s_lshl_b32 s35, s49, 10
    s_sub_u32 s35, s35, 4096
    v_add_u32 v5, s35, v203
    v_and_b32 v6, 1, v201
    v_mul_u32_u24 v6, 5376, v6
    v_add_u32 v6, v6, v4
    v_subrev_u32 v6, 90112, v6
    v_subrev_u32 v7, 22784, v5
    s_waitcnt vmcnt(0)
    s_barrier
    ds_read_b64_tr_b16 v[32:33], v3 offset:0
    ds_read_b64_tr_b16 v[34:35], v3 offset:1024
    ds_read_b64_tr_b16 v[36:37], v3 offset:32
    ds_read_b64_tr_b16 v[38:39], v3 offset:1056
    ds_read_b64_tr_b16 v[40:41], v3 offset:8192
    ds_read_b64_tr_b16 v[42:43], v3 offset:9216
    ds_read_b64_tr_b16 v[44:45], v3 offset:8224
    ds_read_b64_tr_b16 v[46:47], v3 offset:9248
    ds_read_b64_tr_b16 v[48:49], v3 offset:16384
    ds_read_b64_tr_b16 v[50:51], v3 offset:17408
    ds_read_b64_tr_b16 v[52:53], v3 offset:16416
    ds_read_b64_tr_b16 v[54:55], v3 offset:17440
    s_waitcnt lgkmcnt(4)
    ds_read_b64_tr_b16 v[56:57], v3 offset:24576
    ds_read_b64_tr_b16 v[58:59], v3 offset:25600
    ds_read_b64_tr_b16 v[60:61], v3 offset:24608
    ds_read_b64_tr_b16 v[62:63], v3 offset:25632
    ds_read_b64_tr_b16 v[64:65], v3 offset:32768
    ds_read_b64_tr_b16 v[66:67], v3 offset:33792
    ds_read_b64_tr_b16 v[68:69], v3 offset:32800
    ds_read_b64_tr_b16 v[70:71], v3 offset:33824
    s_waitcnt lgkmcnt(0)
    ds_read_b128 v[140:143], v6 offset:0
    ds_read_b128 v[144:147], v6 offset:256
    ds_read_b128 v[148:151], v6 offset:512
    ds_read_b128 v[152:155], v6 offset:768
    ds_read_b128 v[156:159], v6 offset:1024
    s_waitcnt lgkmcnt(4)
    v_mfma_f32_16x16x32_bf16 v[20:23], v[32:35], v[140:143], 0
    v_mfma_f32_16x16x32_bf16 v[24:27], v[36:39], v[140:143], 0
    s_waitcnt lgkmcnt(3)
    v_mfma_f32_16x16x32_bf16 v[20:23], v[40:43], v[144:147], v[20:23]
    v_mfma_f32_16x16x32_bf16 v[24:27], v[44:47], v[144:147], v[24:27]
    s_waitcnt lgkmcnt(2)
    v_mfma_f32_16x16x32_bf16 v[20:23], v[48:51], v[148:151], v[20:23]
    v_mfma_f32_16x16x32_bf16 v[24:27], v[52:55], v[148:151], v[24:27]
    s_waitcnt lgkmcnt(1)
    v_mfma_f32_16x16x32_bf16 v[20:23], v[56:59], v[152:155], v[20:23]
    v_mfma_f32_16x16x32_bf16 v[24:27], v[60:63], v[152:155], v[24:27]
    s_waitcnt lgkmcnt(0)
    v_mfma_f32_16x16x32_bf16 v[20:23], v[64:67], v[156:159], v[20:23]
    v_mfma_f32_16x16x32_bf16 v[24:27], v[68:71], v[156:159], v[24:27]
    s_nop 6
    ds_write_b128 v7, v[20:23]
    ds_write_b128 v7, v[24:27] offset:1024
    s_waitcnt lgkmcnt(0)
    s_setprio 3
    s_barrier
    ds_read_b128 v[140:143], v4 offset:0
    ds_read_b128 v[144:147], v4 offset:256
    ds_read_b128 v[148:151], v4 offset:512
    ds_read_b128 v[152:155], v4 offset:768
    ds_read_b128 v[156:159], v4 offset:1024
    s_waitcnt lgkmcnt(4)
    v_mfma_f32_16x16x32_bf16 v[20:23], v[32:35], v[140:143], 0
    v_mfma_f32_16x16x32_bf16 v[24:27], v[36:39], v[140:143], 0
    s_waitcnt lgkmcnt(3)
    v_mfma_f32_16x16x32_bf16 v[20:23], v[40:43], v[144:147], v[20:23]
    v_mfma_f32_16x16x32_bf16 v[24:27], v[44:47], v[144:147], v[24:27]
    s_waitcnt lgkmcnt(2)
    v_mfma_f32_16x16x32_bf16 v[20:23], v[48:51], v[148:151], v[20:23]
    v_mfma_f32_16x16x32_bf16 v[24:27], v[52:55], v[148:151], v[24:27]
    s_waitcnt lgkmcnt(1)
    v_mfma_f32_16x16x32_bf16 v[20:23], v[56:59], v[152:155], v[20:23]
    v_mfma_f32_16x16x32_bf16 v[24:27], v[60:63], v[152:155], v[24:27]
    s_waitcnt lgkmcnt(0)
    v_mfma_f32_16x16x32_bf16 v[20:23], v[64:67], v[156:159], v[20:23]
    v_mfma_f32_16x16x32_bf16 v[24:27], v[68:71], v[156:159], v[24:27]
    s_nop 6
    ds_write_b128 v5, v[20:23]
    ds_write_b128 v5, v[24:27] offset:1024
    s_waitcnt lgkmcnt(0)
    s_barrier
    s_branch L_fin
L_w1_ln:
    s_setprio 1
    ds_read_b128 v[140:143], v205 offset:0
    ds_read_b128 v[144:147], v205 offset:256
    ds_read_b128 v[148:151], v205 offset:512
    ds_read_b128 v[152:155], v205 offset:768
    ds_read_b128 v[156:159], v205 offset:1024
    ds_read_b128 v[160:163], v205 offset:1280
    ds_read_b128 v[164:167], v205 offset:1536
    ds_read_b128 v[168:171], v205 offset:1792
    ds_read_b128 v[172:175], v205 offset:2048
    ds_read_b128 v[176:179], v205 offset:2304
    ds_read_b128 v[180:183], v205 offset:2560
    ds_read_b128 v[184:187], v205 offset:2816
    ds_read_b128 v[188:191], v205 offset:3072
    ds_read_b128 v[192:195], v205 offset:3328
    ds_read_b128 v[196:199], v205 offset:3584
    v_and_b32 v8, 1, v0
    v_lshlrev_b32 v8, 4, v8
    v_mov_b32 v9, 0xffff
    v_lshlrev_b32 v8, v8, v9
    v_bfe_u32 v9, v0, 1, 2
    v_cmp_eq_u32 vcc, 0, v9
    s_nop 1
    v_cndmask_b32 v16, 0, v8, vcc
    v_cmp_eq_u32 vcc, 1, v9
    s_nop 1
    v_cndmask_b32 v17, 0, v8, vcc
    v_cmp_eq_u32 vcc, 2, v9
    s_nop 1
    v_cndmask_b32 v18, 0, v8, vcc
    v_cmp_eq_u32 vcc, 3, v9
    s_nop 1
    v_cndmask_b32 v19, 0, v8, vcc
    v_bfe_u32 v8, v0, 3, 1
    v_cmp_eq_u32 vcc, 0, v8
    s_nop 1
    v_cndmask_b32 v20, 0, v16, vcc
    v_xor_b32 v24, v20, v16
    v_cndmask_b32 v21, 0, v17, vcc
    v_xor_b32 v25, v21, v17
    v_cndmask_b32 v22, 0, v18, vcc
    v_xor_b32 v26, v22, v18
    v_cndmask_b32 v23, 0, v19, vcc
    v_xor_b32 v27, v23, v19
    v_and_b32 v52, 0x3f803f80, v20
    v_and_b32 v60, 0x3e803e80, v20
    v_and_b32 v53, 0x3f803f80, v21
    v_and_b32 v61, 0x3e803e80, v21
    v_and_b32 v54, 0x3f803f80, v22
    v_and_b32 v62, 0x3e803e80, v22
    v_and_b32 v55, 0x3f803f80, v23
    v_and_b32 v63, 0x3e803e80, v23
    v_and_b32 v56, 0x3f803f80, v24
    v_and_b32 v64, 0x3e803e80, v24
    v_and_b32 v57, 0x3f803f80, v25
    v_and_b32 v65, 0x3e803e80, v25
    v_and_b32 v58, 0x3f803f80, v26
    v_and_b32 v66, 0x3e803e80, v26
    v_and_b32 v59, 0x3f803f80, v27
    v_and_b32 v67, 0x3e803e80, v27
    s_waitcnt lgkmcnt(0)
    v_mfma_f32_16x16x32_bf16 v[68:71], v[140:143], v[60:63], 0
    v_mfma_f32_16x16x32_bf16 v[68:71], v[144:147], v[64:67], v[68:71]
    v_mfma_f32_16x16x32_bf16 v[72:75], v[148:151], v[60:63], 0
    v_mfma_f32_16x16x32_bf16 v[72:75], v[152:155], v[64:67], v[72:75]
    v_mfma_f32_16x16x32_bf16 v[76:79], v[156:159], v[60:63], 0
    v_mfma_f32_16x16x32_bf16 v[116:119], v[160:163], v[60:63], 0
    v_mfma_f32_16x16x32_bf16 v[116:119], v[164:167], v[64:67], v[116:119]
    v_mfma_f32_16x16x32_bf16 v[120:123], v[168:171], v[60:63], 0
    v_mfma_f32_16x16x32_bf16 v[120:123], v[172:175], v[64:67], v[120:123]
    v_mfma_f32_16x16x32_bf16 v[124:127], v[176:179], v[60:63], 0
    v_mfma_f32_16x16x32_bf16 v[80:83], v[180:183], v[60:63], 1.0
    v_mfma_f32_16x16x32_bf16 v[80:83], v[184:187], v[64:67], v[80:83]
    v_mfma_f32_16x16x32_bf16 v[84:87], v[188:191], v[60:63], 1.0
    v_mfma_f32_16x16x32_bf16 v[84:87], v[192:195], v[64:67], v[84:87]
    v_mfma_f32_16x16x32_bf16 v[88:91], v[196:199], v[60:63], 1.0
    s_mul_i32 s34, s3, 1344
    s_add_u32 s34, s34, 116736
    v_lshl_add_u32 v7, v0, 4, s34
    v_lshlrev_b32 v8, 6, v202
    v_lshl_add_u32 v8, v200, 4, v8
    v_and_b32 v9, 1, v201
    v_lshl_add_u32 v8, v9, 3, v8
    v_add_u32 v8, s34, v8
    v_bfe_u32 v9, v0, 3, 1
    v_mul_u32_u24 v9, 6144, v9
    v_sub_u32 v8, v8, v9
    v_lshrrev_b32 v9, 5, v0
    v_lshlrev_b32 v9, 10, v9
    v_and_b32 v6, 1, v202
    v_lshl_add_u32 v9, v6, 7, v9
    v_bfe_u32 v6, v0, 1, 1
    v_lshl_add_u32 v9, v6, 6, v9
    v_lshl_add_u32 v9, v201, 4, v9
    v_and_b32 v6, 1, v0
    v_lshl_add_u32 v9, v6, 3, v9
    v_add_u32 v9, 122112, v9
    s_lshr_b32 s34, s62, 3
    s_lshl_b32 s34, s34, 8
    s_and_b32 s49, s62, 3
    s_lshl_b32 s49, s49, 15
    s_add_u32 s34, s34, s49
    s_bfe_u32 s49, s62, 0x10002
    s_lshl_b32 s49, s49, 14
    s_add_u32 s34, s34, s49
    s_add_u32 s34, s34, 791552
    v_lshl_add_u32 v5, v0, 2, s34
    s_bfe_u32 s49, s60, 0x10002
    s_lshl_b32 s49, s49, 13
    s_xor_b32 s53, s99, s49
    s_xor_b32 s52, s53, 8192
    v_subrev_u32 v10, 90112, v7
    v_subrev_u32 v11, 90112, v8
    v_cvt_pk_bf16_f32 v32, v116, v117
    v_cvt_pk_bf16_f32 v33, v118, v119
    v_cvt_pk_bf16_f32 v34, v120, v121
    v_cvt_pk_bf16_f32 v35, v122, v123
    v_cvt_pk_bf16_f32 v36, v124, v125
    v_cvt_pk_bf16_f32 v37, v126, v127
    s_mov_b32 exec_lo, 0x00ff00ff
    s_mov_b32 exec_hi, 0x00ff00ff
    ds_write_b64 v11, v[36:37] offset:6400
    s_mov_b64 exec, -1
    ds_write_b128 v10, v[32:35] offset:5376
    v_cvt_pk_bf16_f32 v20, v80, v81
    v_cvt_pk_bf16_f32 v21, v82, v83
    v_cvt_pk_bf16_f32 v22, v84, v85
    v_cvt_pk_bf16_f32 v23, v86, v87
    v_cvt_pk_bf16_f32 v24, v88, v89
    v_cvt_pk_bf16_f32 v25, v90, v91
    ds_write_b128 v10, v[20:23]
    ds_write_b64 v11, v[24:25] offset:1024
    v_lshlrev_b32 v80, 16, v20
    v_and_b32 v81, 0xffff0000, v20
    v_lshlrev_b32 v82, 16, v21
    v_and_b32 v83, 0xffff0000, v21
    v_lshlrev_b32 v84, 16, v22
    v_and_b32 v85, 0xffff0000, v22
    v_lshlrev_b32 v86, 16, v23
    v_and_b32 v87, 0xffff0000, v23
    v_lshlrev_b32 v88, 16, v24
    v_and_b32 v89, 0xffff0000, v24
    v_lshlrev_b32 v90, 16, v25
    v_and_b32 v91, 0xffff0000, v25
    v_subrev_u32 v11, 22784, v9
    s_lshl_b32 s34, s3, 3
    s_add_u32 s34, s34, 99136
    v_mov_b32 v12, s34
    v_lshlrev_b32 v13, 3, v201
    v_add_u32 v13, 99136, v13
    s_mov_b32 s54, 0
    s_brev_b32 s55, 1
    s_waitcnt lgkmcnt(0)
    s_barrier
    s_mov_b32 s35, 0
    s_mov_b64 s[40:41], -1
    s_mov_b64 s[42:43], -1
L_pb:
    s_mov_b64 exec, s[40:41]
    s_cbranch_execz L_pbs0
    buffer_load_dwordx4 v[140:143], v206, s[44:47], 0 offen offset:0 sc1
    buffer_load_dwordx4 v[148:151], v206, s[44:47], 0 offen offset:256 sc1
    buffer_load_dwordx4 v[156:159], v206, s[44:47], 0 offen offset:512 sc1
    buffer_load_dwordx4 v[164:167], v206, s[44:47], 0 offen offset:768 sc1
    buffer_load_dwordx4 v[172:175], v206, s[44:47], 0 offen offset:1024 sc1
L_pbs0:
    s_mov_b64 exec, s[42:43]
    s_cbranch_execz L_pbs1
    buffer_load_dwordx4 v[144:147], v206, s[44:47], s48 offen offset:0 sc1
    buffer_load_dwordx4 v[152:155], v206, s[44:47], s48 offen offset:256 sc1
    buffer_load_dwordx4 v[160:163], v206, s[44:47], s48 offen offset:512 sc1
    buffer_load_dwordx4 v[168:171], v206, s[44:47], s48 offen offset:768 sc1
    buffer_load_dwordx4 v[176:179], v206, s[44:47], s48 offen offset:1024 sc1
L_pbs1:
    s_mov_b64 exec, -1
    s_add_u32 s35, s35, 1
    s_waitcnt vmcnt(0)
    v_mfma_f32_16x16x32_bf16 v[128:131], v[140:143], v[52:55], v[68:71]
    v_max3_u32 v28, v140, v141, v142
    v_max3_u32 v29, v144, v145, v146
    v_mfma_f32_16x16x32_bf16 v[128:131], v[144:147], v[52:55], v[128:131]
    v_max3_u32 v28, v28, v143, v148
    v_max3_u32 v29, v29, v147, v152
    v_mfma_f32_16x16x32_bf16 v[128:131], v[148:151], v[56:59], v[128:131]
    v_max3_u32 v28, v28, v149, v150
    v_max3_u32 v29, v29, v153, v154
    v_mfma_f32_16x16x32_bf16 v[128:131], v[152:155], v[56:59], v[128:131]
    v_max3_u32 v28, v28, v151, v156
    v_max3_u32 v29, v29, v155, v160
    v_mfma_f32_16x16x32_bf16 v[132:135], v[156:159], v[52:55], v[72:75]
    v_max3_u32 v28, v28, v157, v158
    v_max3_u32 v29, v29, v161, v162
    v_mfma_f32_16x16x32_bf16 v[132:135], v[160:163], v[52:55], v[132:135]
    v_max3_u32 v28, v28, v159, v164
    v_max3_u32 v29, v29, v163, v168
    v_mfma_f32_16x16x32_bf16 v[132:135], v[164:167], v[56:59], v[132:135]
    v_max3_u32 v28, v28, v165, v166
    v_max3_u32 v29, v29, v169, v170
    v_mfma_f32_16x16x32_bf16 v[132:135], v[168:171], v[56:59], v[132:135]
    v_max3_u32 v28, v28, v167, v172
    v_max3_u32 v29, v29, v171, v176
    v_mfma_f32_16x16x32_bf16 v[136:139], v[172:175], v[52:55], v[76:79]
    v_max3_u32 v28, v28, v173, v174
    v_max3_u32 v29, v29, v177, v178
    v_mfma_f32_16x16x32_bf16 v[136:139], v[176:179], v[52:55], v[136:139]
    v_max_u32 v28, v28, v175
    v_max_u32 v29, v29, v179
    v_cmp_eq_u32 s[40:41], -1, v28
    v_cmp_eq_u32 s[42:43], -1, v29
    s_nop 0
    s_or_b64 vcc, s[40:41], s[42:43]
    s_cbranch_scc0 L_pbd
    s_cmp_lg_u32 s35, 64
    s_cbranch_scc1 L_tmo88
    s_mov_b64 exec, -1
    v_lshlrev_b32 v243, 4, v0
    v_add_u32 v243, 131328, v243
    ds_read_b96 v[240:242], v243
    s_waitcnt lgkmcnt(0)
    buffer_store_dword v240, v242, s[44:47], 0 offen sc1
    buffer_store_dword v241, v242, s[44:47], 0 offen offset:256 sc1
L_tmo88:
    s_cmp_lt_u32 s35, 60000
    s_cbranch_scc1 L_pb
L_pbd:
    v_pk_mul_f32 v[32:33], v[128:129], v[80:81]
    v_pk_mul_f32 v[34:35], v[130:131], v[82:83]
    v_pk_mul_f32 v[36:37], v[132:133], v[84:85]
    v_pk_mul_f32 v[38:39], v[134:135], v[86:87]
    v_cvt_pk_bf16_f32 v24, v32, v33
    v_cvt_pk_bf16_f32 v25, v34, v35
    v_cvt_pk_bf16_f32 v26, v36, v37
    v_cvt_pk_bf16_f32 v27, v38, v39
    ds_write_b128 v7, v[24:27]
    v_pk_mul_f32 v[40:41], v[136:137], v[88:89]
    v_pk_mul_f32 v[42:43], v[138:139], v[90:91]
    v_cvt_pk_bf16_f32 v28, v40, v41
    v_cvt_pk_bf16_f32 v29, v42, v43
    ds_write_b64 v8, v[28:29] offset:1024
    v_pk_add_f32 v[20:21], v[128:129], v[130:131]
    v_pk_mul_f32 v[22:23], v[128:129], v[128:129]
    v_pk_add_f32 v[20:21], v[20:21], v[132:133]
    v_pk_fma_f32 v[22:23], v[130:131], v[130:131], v[22:23]
    v_pk_add_f32 v[20:21], v[20:21], v[134:135]
    v_pk_fma_f32 v[22:23], v[132:133], v[132:133], v[22:23]
    v_pk_add_f32 v[20:21], v[20:21], v[136:137]
    v_pk_fma_f32 v[22:23], v[134:135], v[134:135], v[22:23]
    v_pk_add_f32 v[20:21], v[20:21], v[138:139]
    v_pk_fma_f32 v[22:23], v[136:137], v[136:137], v[22:23]
    v_pk_fma_f32 v[22:23], v[138:139], v[138:139], v[22:23]
    s_waitcnt lgkmcnt(0)
    s_barrier
    v_add_f32 v20, v20, v21
    v_add_f32 v21, v22, v23
    s_nop 0
    v_add_f32_dpp v20, v20, v20 row_ror:8 row_mask:0xf bank_mask:0xf
    v_add_f32_dpp v21, v21, v21 row_ror:8 row_mask:0xf bank_mask:0xf
    s_nop 0
    v_add_f32_dpp v20, v20, v20 row_ror:4 row_mask:0xf bank_mask:0xf
    v_add_f32_dpp v21, v21, v21 row_ror:4 row_mask:0xf bank_mask:0xf
    s_nop 0
    v_add_f32_dpp v20, v20, v20 row_ror:2 row_mask:0xf bank_mask:0xf
    v_add_f32_dpp v21, v21, v21 row_ror:2 row_mask:0xf bank_mask:0xf
    s_nop 0
    v_add_f32_dpp v20, v20, v20 row_ror:1 row_mask:0xf bank_mask:0xf
    v_add_f32_dpp v21, v21, v21 row_ror:1 row_mask:0xf bank_mask:0xf
    s_nop 0
    v_add_f32_dpp v20, v20, v20 row_bcast:15 row_mask:0xa bank_mask:0xf
    v_add_f32_dpp v21, v21, v21 row_bcast:15 row_mask:0xa bank_mask:0xf
    s_nop 0
    v_add_f32_dpp v20, v20, v20 row_bcast:31 row_mask:0xc bank_mask:0xf
    v_add_f32_dpp v21, v21, v21 row_bcast:31 row_mask:0xc bank_mask:0xf
    v_mul_f32 v22, 0x3acccccd, v20
    v_mul_f32 v21, 0x3acccccd, v21
    v_fma_f32 v21, -v22, v22, v21
    v_max_f32 v21, 0, v21
    v_add_f32 v21, 0x3727c5ac, v21
    v_rsq_f32 v20, v21
    s_nop 0
    v_mul_f32_e64 v21, -v22, v20
    s_mov_b64 exec, s[54:55]
    ds_write_b64 v12, v[20:21]
    s_mov_b64 exec, -1
    s_cmp_lg_u32 s3, 0
    s_cbranch_scc1 L_w1_x
    ds_read_b64 v[32:33], v11 offset:0
    ds_read_b64 v[40:41], v11 offset:320
    ds_read_b64 v[34:35], v11 offset:2048
    ds_read_b64 v[42:43], v11 offset:2368
    ds_read_b64 v[36:37], v11 offset:4096
    ds_read_b64 v[44:45], v11 offset:4416
    ds_read_b64 v[38:39], v11 offset:6144
    ds_read_b64 v[46:47], v11 offset:6464
    s_mov_b32 s34, 0xbdd2d3e8
    v_mov_b32 v10, 0xc0135761
    s_waitcnt lgkmcnt(8)
    s_barrier
    ds_read_b64 v[28:29], v13
    ds_read_b64 v[20:21], v9 offset:0
    ds_read_b64 v[22:23], v9 offset:2048
    ds_read_b64 v[24:25], v9 offset:4096
    ds_read_b64 v[26:27], v9 offset:6144
    s_waitcnt lgkmcnt(5)
    v_pk_add_f32 v[100:101], v[100:101], v[40:41]
    v_pk_add_f32 v[100:101], v[100:101], v[42:43]
    v_pk_add_f32 v[32:33], v[32:33], v[34:35]
    v_pk_add_f32 v[100:101], v[100:101], v[44:45]
    v_pk_add_f32 v[32:33], v[32:33], v[36:37]
    v_pk_add_f32 v[100:101], v[100:101], v[46:47]
    v_pk_add_f32 v[32:33], v[32:33], v[38:39]
    s_waitcnt lgkmcnt(4)
    v_pk_fma_f32 v[100:101], v[32:33], v[28:29], v[100:101] op_sel:[0,1,0] op_sel_hi:[1,1,1]
    s_waitcnt lgkmcnt(3)
    v_pk_fma_f32 v[100:101], v[20:21], v[28:29], v[100:101] op_sel_hi:[1,0,1]
    s_waitcnt lgkmcnt(2)
    v_pk_fma_f32 v[100:101], v[22:23], v[28:29], v[100:101] op_sel_hi:[1,0,1]
    s_waitcnt lgkmcnt(1)
    v_pk_fma_f32 v[100:101], v[24:25], v[28:29], v[100:101] op_sel_hi:[1,0,1]
    s_waitcnt lgkmcnt(0)
    v_pk_fma_f32 v[100:101], v[26:27], v[28:29], v[100:101] op_sel_hi:[1,0,1]
    v_pk_mul_f32 v[20:21], v[100:101], v[100:101]
    v_fma_f32 v20, v20, s34, v10
    v_fma_f32 v21, v21, s34, v10
    v_pk_mul_f32 v[20:21], v[20:21], v[100:101]
    v_exp_f32 v20, v20
    v_exp_f32 v21, v21
    v_add_f32 v20, 1.0, v20
    v_add_f32 v21, 1.0, v21
    v_rcp_f32 v20, v20
    v_rcp_f32 v21, v21
    s_nop 0
    v_pk_mul_f32 v[20:21], v[20:21], v[100:101]
    v_cvt_pk_bf16_f32 v20, v20, v21
    v_min_u32 v20, -2, v20
    buffer_store_dword v20, v5, s[44:47], s52 offen sc1
    buffer_store_dword v20, v5, s[44:47], s53 offen sc1
    s_branch L_fin
L_w1_x:
    s_waitcnt lgkmcnt(0)
    s_barrier
    s_branch L_fin
L_t_w2:
    s_barrier
L_w2_dma:
    s_and_b32 s34, s40, 7
    s_lshl_b32 s35, s34, 10
    s_add_u32 m0, s50, s35
    s_mul_i32 s34, s34, 40960
    buffer_load_dwordx4 v204, s[52:55], s34 offen  lds
    s_add_u32 s40, s40, 1
    s_cmp_lg_u32 s40, s42
    s_cbranch_scc1 L_w2_nw
L_w2_nw:
    s_cmp_lt_u32 s40, s41
    s_cbranch_scc1 L_w2_dma
    ds_read_b32 v8, v7
    s_waitcnt lgkmcnt(0)
    v_cmp_eq_u32 vcc, 0, v8
    s_cbranch_vccnz L_w2_slow
    s_mov_b32 s35, 0
    buffer_load_dwordx4 v[64:67], v4, s[44:47], 0 offen sc1
    buffer_load_dwordx4 v[68:71], v5, s[44:47], s48 offen sc1
    s_waitcnt vmcnt(2)
    ds_read_b64_tr_b16 v[32:33], v205 offset:0
    ds_read_b64_tr_b16 v[34:35], v205 offset:512
    ds_read_b64_tr_b16 v[36:37], v205 offset:1024
    ds_read_b64_tr_b16 v[38:39], v205 offset:1536
    ds_read_b64_tr_b16 v[40:41], v205 offset:2048
    ds_read_b64_tr_b16 v[42:43], v205 offset:2560
    ds_read_b64_tr_b16 v[44:45], v205 offset:3072
    ds_read_b64_tr_b16 v[46:47], v205 offset:3584
    s_waitcnt lgkmcnt(0)
    ds_read_b64_tr_b16 v[48:49], v205 offset:4096
    ds_read_b64_tr_b16 v[50:51], v205 offset:4608
    ds_read_b64_tr_b16 v[52:53], v205 offset:5120
    ds_read_b64_tr_b16 v[54:55], v205 offset:5632
    ds_read_b64_tr_b16 v[56:57], v205 offset:6144
    ds_read_b64_tr_b16 v[58:59], v205 offset:6656
    ds_read_b64_tr_b16 v[60:61], v205 offset:7168
    ds_read_b64_tr_b16 v[62:63], v205 offset:7680
    s_waitcnt lgkmcnt(0)
    s_branch L_w2_mid
L_w2_slow:
    s_waitcnt vmcnt(0)
    ds_read_b64_tr_b16 v[32:33], v205 offset:0
    ds_read_b64_tr_b16 v[34:35], v205 offset:512
    ds_read_b64_tr_b16 v[36:37], v205 offset:1024
    ds_read_b64_tr_b16 v[38:39], v205 offset:1536
    ds_read_b64_tr_b16 v[40:41], v205 offset:2048
    ds_read_b64_tr_b16 v[42:43], v205 offset:2560
    ds_read_b64_tr_b16 v[44:45], v205 offset:3072
    ds_read_b64_tr_b16 v[46:47], v205 offset:3584
    s_waitcnt lgkmcnt(0)
    ds_read_b64_tr_b16 v[48:49], v205 offset:4096
    ds_read_b64_tr_b16 v[50:51], v205 offset:4608
    ds_read_b64_tr_b16 v[52:53], v205 offset:5120
    ds_read_b64_tr_b16 v[54:55], v205 offset:5632
    ds_read_b64_tr_b16 v[56:57], v205 offset:6144
    ds_read_b64_tr_b16 v[58:59], v205 offset:6656
    ds_read_b64_tr_b16 v[60:61], v205 offset:7168
    ds_read_b64_tr_b16 v[62:63], v205 offset:7680
    s_waitcnt lgkmcnt(0)
    s_mov_b32 s35, 0
L_poll89:
    ds_read_b32 v8, v7
    s_add_u32 s35, s35, 1
    s_waitcnt lgkmcnt(0)
    v_cmp_eq_u32 vcc, 0, v8
    s_cbranch_vccz L_done90
    s_sleep 1
    s_cmp_lt_u32 s35, 60000
    s_cbranch_scc1 L_poll89
L_done90:
    s_mov_b32 s35, 0
L_poll92:
    buffer_load_dwordx4 v[64:67], v4, s[44:47], 0 offen sc1
    buffer_load_dwordx4 v[68:71], v5, s[44:47], s48 offen sc1
L_w2_mid:
    s_add_u32 s35, s35, 1
    s_waitcnt vmcnt(0)
    v_max3_u32 v28, v64, v65, v66
    v_max3_u32 v28, v28, v67, v68
    v_max3_u32 v28, v28, v69, v70
    v_max_u32 v28, v28, v71
    v_cmp_eq_u32 vcc, -1, v28
    s_cbranch_vccz L_done93
    s_cmp_lg_u32 s35, 64
    s_cbranch_scc1 L_tmo95
    s_mov_b64 exec, -1
    v_lshlrev_b32 v243, 4, v0
    v_add_u32 v243, 131328, v243
    ds_read_b96 v[240:242], v243
    s_waitcnt lgkmcnt(0)
    buffer_store_dword v240, v242, s[44:47], 0 offen sc1
    buffer_store_dword v241, v242, s[44:47], 0 offen offset:256 sc1
L_tmo95:
    s_cmp_lt_u32 s35, 60000
    s_cbranch_scc1 L_poll92
L_done93:
    v_mfma_f32_16x16x32_bf16 v[80:83], v[32:35], v[64:67], 0
    v_mfma_f32_16x16x32_bf16 v[80:83], v[48:51], v[68:71], v[80:83]
    v_mfma_f32_16x16x32_bf16 v[84:87], v[36:39], v[64:67], 0
    v_mfma_f32_16x16x32_bf16 v[84:87], v[52:55], v[68:71], v[84:87]
    v_mfma_f32_16x16x32_bf16 v[88:91], v[40:43], v[64:67], 0
    v_mfma_f32_16x16x32_bf16 v[88:91], v[56:59], v[68:71], v[88:91]
    v_mfma_f32_16x16x32_bf16 v[92:95], v[44:47], v[64:67], 0
    v_mfma_f32_16x16x32_bf16 v[92:95], v[60:63], v[68:71], v[92:95]
    s_nop 3
    v_add_f32_dpp v80, v84, v80 row_shl:4 row_mask:0xf bank_mask:0x1
    v_add_f32_dpp v81, v85, v81 row_shl:4 row_mask:0xf bank_mask:0x1
    v_add_f32_dpp v82, v86, v82 row_shl:4 row_mask:0xf bank_mask:0x1
    v_add_f32_dpp v83, v87, v83 row_shl:4 row_mask:0xf bank_mask:0x1
    v_add_f32_dpp v80, v88, v80 row_shl:8 row_mask:0xf bank_mask:0x1
    v_add_f32_dpp v81, v89, v81 row_shl:8 row_mask:0xf bank_mask:0x1
    v_add_f32_dpp v82, v90, v82 row_shl:8 row_mask:0xf bank_mask:0x1
    v_add_f32_dpp v83, v91, v83 row_shl:8 row_mask:0xf bank_mask:0x1
    v_add_f32_dpp v80, v92, v80 row_shl:12 row_mask:0xf bank_mask:0x1
    v_add_f32_dpp v81, v93, v81 row_shl:12 row_mask:0xf bank_mask:0x1
    v_add_f32_dpp v82, v94, v82 row_shl:12 row_mask:0xf bank_mask:0x1
    v_add_f32_dpp v83, v95, v83 row_shl:12 row_mask:0xf bank_mask:0x1
    ds_write_b128 v203, v[80:83]
    s_waitcnt lgkmcnt(0)
    s_barrier
    s_branch L_fin
L_w2_red:
    s_mov_b32 s35, 0
L_poll96:
    buffer_load_dwordx2 v[20:21], v204, s[44:47], 0 offen sc1
    buffer_load_dwordx2 v[22:23], v204, s[44:47], s48 offen sc1
    s_add_u32 s35, s35, 1
    s_waitcnt vmcnt(0)
    v_max3_u32 v28, v20, v21, v22
    v_max_u32 v28, v28, v23
    v_cmp_eq_u32 vcc, -1, v28
    s_cbranch_vccz L_done97
    s_cmp_lg_u32 s35, 21
    s_cbranch_scc1 L_tmo99
    s_mov_b64 exec, -1
    v_lshlrev_b32 v243, 4, v0
    v_add_u32 v243, 131328, v243
    ds_read_b96 v[240:242], v243
    s_waitcnt lgkmcnt(0)
    buffer_store_dword v240, v242, s[44:47], 0 offen sc1
    buffer_store_dword v241, v242, s[44:47], 0 offen offset:256 sc1
L_tmo99:
    s_sleep 6
    s_cmp_lt_u32 s35, 60000
    s_cbranch_scc1 L_poll96
L_done97:
    v_mov_b32 v7, 99084
    ds_write_b32 v7, v7
    v_lshlrev_b32 v44, 16, v20
    v_and_b32 v45, 0xffff0000, v20
    v_lshlrev_b32 v46, 16, v21
    v_and_b32 v47, 0xffff0000, v21
    v_lshlrev_b32 v48, 16, v22
    v_and_b32 v49, 0xffff0000, v22
    v_lshlrev_b32 v50, 16, v23
    v_and_b32 v51, 0xffff0000, v23
    v_add_f32 v108, v108, v44
    v_add_f32 v109, v109, v45
    v_add_f32 v110, v110, v46
    v_add_f32 v111, v111, v47
    v_add_f32 v108, v108, v48
    v_add_f32 v109, v109, v49
    v_add_f32 v110, v110, v50
    v_add_f32 v111, v111, v51
    s_mov_b32 s36, s28
    s_mov_b32 s37, s29
    s_movk_i32 s38, 5120
    v_add_f32_dpp v108, v108, v108 row_ror:4 row_mask:0xf bank_mask:0xf
    v_add_f32_dpp v109, v109, v109 row_ror:4 row_mask:0xf bank_mask:0xf
    v_add_f32_dpp v110, v110, v110 row_ror:4 row_mask:0xf bank_mask:0xf
    v_add_f32_dpp v111, v111, v111 row_ror:4 row_mask:0xf bank_mask:0xf
    v_add_f32_dpp v108, v108, v108 row_ror:8 row_mask:0xf bank_mask:0xf
    v_add_f32_dpp v109, v109, v109 row_ror:8 row_mask:0xf bank_mask:0xf
    v_add_f32_dpp v110, v110, v110 row_ror:8 row_mask:0xf bank_mask:0xf
    v_add_f32_dpp v111, v111, v111 row_ror:8 row_mask:0xf bank_mask:0xf
    v_mov_b32_dpp v108, v104 quad_perm:[0,1,2,3] row_mask:0xf bank_mask:0x2
    v_mov_b32_dpp v109, v105 quad_perm:[0,1,2,3] row_mask:0xf bank_mask:0x2
    v_mov_b32_dpp v110, v106 quad_perm:[0,1,2,3] row_mask:0xf bank_mask:0x2
    v_mov_b32_dpp v111, v107 quad_perm:[0,1,2,3] row_mask:0xf bank_mask:0x2
    ds_write_b128 v203, v[108:111]
    v_and_b32 v6, 31, v0
    v_lshlrev_b32 v6, 3, v6
    v_add_u32 v6, 122112, v6
    ds_read_b64 v[108:109], v6
    ds_read_b64 v[104:105], v6 offset:320
    v_bfe_u32 v112, v0, 1, 2
    v_mul_u32_u24 v112, 1280, v112
    v_bfe_u32 v7, v0, 3, 2
    v_lshl_add_u32 v112, v7, 3, v112
    v_and_b32 v7, 1, v0
    v_lshl_add_u32 v112, v7, 2, v112
    v_lshrrev_b32 v7, 5, v0
    v_lshl_add_u32 v112, v7, 28, v112
    s_lshl_b32 s34, s62, 5
    s_waitcnt lgkmcnt(0)
    s_barrier
    ds_read_b64 v[64:65], v6 offset:1024
    ds_read_b64 v[66:67], v6 offset:2048
    ds_read_b64 v[68:69], v6 offset:3072
    ds_read_b64 v[70:71], v6 offset:4096
    ds_read_b64 v[72:73], v6 offset:5120
    ds_read_b64 v[74:75], v6 offset:6144
    ds_read_b64 v[76:77], v6 offset:7168
    s_waitcnt lgkmcnt(6)
    v_pk_fma_f32 v[108:109], v[64:65], v[104:105], v[108:109]
    s_waitcnt lgkmcnt(5)
    v_pk_fma_f32 v[108:109], v[66:67], v[104:105], v[108:109]
    s_waitcnt lgkmcnt(4)
    v_pk_fma_f32 v[108:109], v[68:69], v[104:105], v[108:109]
    s_waitcnt lgkmcnt(3)
    v_pk_fma_f32 v[108:109], v[70:71], v[104:105], v[108:109]
    s_waitcnt lgkmcnt(2)
    v_pk_fma_f32 v[108:109], v[72:73], v[104:105], v[108:109]
    s_waitcnt lgkmcnt(1)
    v_pk_fma_f32 v[108:109], v[74:75], v[104:105], v[108:109]
    s_waitcnt lgkmcnt(0)
    v_pk_fma_f32 v[108:109], v[76:77], v[104:105], v[108:109]
    v_cvt_pk_bf16_f32 v20, v108, v109
    buffer_store_dword v20, v112, s[36:39], s34 offen
    s_branch L_fin
L_t_wo:
    s_barrier
L_r_wo2:
    s_mov_b32 m0, s56
    s_nop 0
    buffer_load_dwordx4 v15, s[52:55], s57 offen  lds
    s_mov_b32 m0, s58
    s_nop 0
    buffer_load_dwordx4 v15, s[52:55], s59 offen  lds
    s_xor_b32 m0, s56, 2048
    s_sub_u32 s34, 40960, s57
    buffer_load_dwordx4 v15, s[52:55], s34 offen  lds
    s_xor_b32 m0, s58, 2048
    s_sub_u32 s34, 42240, s57
    buffer_load_dwordx4 v15, s[52:55], s34 offen  lds
L_r_wo3:
    s_mov_b32 s35, 0
    s_mov_b32 s48, 0
    buffer_load_dwordx4 v[64:67], v205, s[44:47], 0 offen sc1
    buffer_load_dwordx2 v[26:27], v204, s[44:47], 0 offen sc1
    s_waitcnt vmcnt(2)
    ds_read_b64_tr_b16 v[32:33], v206 offset:0
    ds_read_b64_tr_b16 v[34:35], v206 offset:1024
    ds_read_b64_tr_b16 v[36:37], v206 offset:32
    ds_read_b64_tr_b16 v[38:39], v206 offset:1056
    ds_read_b64_tr_b16 v[40:41], v206 offset:2048
    ds_read_b64_tr_b16 v[42:43], v206 offset:3072
    ds_read_b64_tr_b16 v[44:45], v206 offset:2080
    ds_read_b64_tr_b16 v[46:47], v206 offset:3104
    s_branch L_pam
L_pa:
    buffer_load_dwordx4 v[64:67], v205, s[44:47], 0 offen sc1
    buffer_load_dwordx2 v[26:27], v204, s[44:47], 0 offen sc1
L_pam:
    s_add_u32 s35, s35, 1
    s_waitcnt vmcnt(0)
    ds_write_b128 v207, v[64:67]
    ds_write_b32 v212, v26 offset:128
    v_max3_u32 v28, v64, v65, v66
    v_max3_u32 v28, v28, v67, v26
    v_cmp_eq_u32 vcc, -1, v28
    s_cbranch_vccz L_pad
    s_cmp_lg_u32 s35, 64
    s_cbranch_scc1 L_tmo100
    s_mov_b64 exec, -1
    v_lshlrev_b32 v243, 4, v0
    v_add_u32 v243, 131328, v243
    ds_read_b96 v[240:242], v243
    s_waitcnt lgkmcnt(0)
    buffer_store_dword v240, v242, s[44:47], 0 offen sc1
    buffer_store_dword v241, v242, s[44:47], 0 offen offset:256 sc1
L_tmo100:
    s_mov_b64 exec, vcc
    s_cmp_lt_u32 s35, 60000
    s_cbranch_scc1 L_pa
L_pad:
    s_mov_b64 exec, -1
    ds_read_b32 v26, v213 offset:128
    ds_read_b128 v[68:71], v208 offset:0
    ds_read_b128 v[72:75], v209 offset:0
    ds_read_b128 v[76:79], v208 offset:64
    ds_read_b128 v[80:83], v209 offset:64
    s_waitcnt lgkmcnt(3)
    v_mfma_f32_16x16x32_bf16 v[20:23], v[32:35], v[68:71], 0
    s_waitcnt lgkmcnt(2)
    v_mfma_f32_16x16x32_bf16 v[20:23], v[36:39], v[72:75], v[20:23]
    s_waitcnt lgkmcnt(1)
    v_mfma_f32_16x16x32_bf16 v[20:23], v[40:43], v[76:79], v[20:23]
    s_waitcnt lgkmcnt(0)
    v_mfma_f32_16x16x32_bf16 v[20:23], v[44:47], v[80:83], v[20:23]
    v_sub_f32_dpp v26, v26, v26 quad_perm:[1,0,3,2] row_mask:0xf bank_mask:0xf
    v_exp_f32 v26, v26
    s_nop 0
    v_add_f32 v26, 1.0, v26
    v_rcp_f32 v26, v26
    s_nop 0
    v_sub_f32 v30, 1.0, v26
    s_nop 0
    v_pk_mul_f32 v[48:49], v[20:21], v[26:27] op_sel_hi:[1,0]
    v_pk_mul_f32 v[50:51], v[22:23], v[26:27] op_sel_hi:[1,0]
    v_fmac_f32_dpp v48, v20, v30 quad_perm:[1,0,3,2] row_mask:0xf bank_mask:0xf
    v_fmac_f32_dpp v49, v21, v30 quad_perm:[1,0,3,2] row_mask:0xf bank_mask:0xf
    v_fmac_f32_dpp v50, v22, v30 quad_perm:[1,0,3,2] row_mask:0xf bank_mask:0xf
    v_fmac_f32_dpp v51, v23, v30 quad_perm:[1,0,3,2] row_mask:0xf bank_mask:0xf
    ds_write_b128 v203, v[48:51]
    s_cmp_lg_u32 s3, 0
    s_waitcnt lgkmcnt(0)
    s_barrier
    s_cbranch_scc1 L_wo_x
    ds_read_b64 v[64:65], v113 offset:0
    ds_read_b64 v[66:67], v113 offset:1152
    ds_read_b64 v[68:69], v113 offset:2304
    ds_read_b64 v[70:71], v113 offset:3456
    ds_read_b64 v[72:73], v113 offset:4608
    ds_read_b64 v[74:75], v113 offset:5760
    ds_read_b64 v[76:77], v113 offset:6912
    ds_read_b64 v[78:79], v113 offset:8064
    s_waitcnt lgkmcnt(6)
    v_pk_add_f32 v[64:65], v[64:65], v[66:67]
    s_waitcnt lgkmcnt(5)
    v_pk_add_f32 v[64:65], v[64:65], v[68:69]
    s_waitcnt lgkmcnt(4)
    v_pk_add_f32 v[64:65], v[64:65], v[70:71]
    s_waitcnt lgkmcnt(3)
    v_pk_add_f32 v[64:65], v[64:65], v[72:73]
    s_waitcnt lgkmcnt(2)
    v_pk_add_f32 v[64:65], v[64:65], v[74:75]
    s_waitcnt lgkmcnt(1)
    v_pk_add_f32 v[64:65], v[64:65], v[76:77]
    s_waitcnt lgkmcnt(0)
    v_pk_add_f32 v[64:65], v[64:65], v[78:79]
    v_pk_mul_f32 v[64:65], v[64:65], v[100:101]
    v_cvt_pk_bf16_f32 v28, v64, v65
    v_min_u32 v28, -2, v28
    buffer_store_dword v28, v112, s[44:47], s101 offen sc1
    buffer_store_dword v28, v112, s[44:47], s93 offen sc1
L_wo_x:
    s_getreg_b32 s34, hwreg(HW_REG_XCC_ID, 0, 4)
    v_cmp_ne_u32 vcc, s34, v27
    s_cbranch_vccz L_fin
    s_mov_b64 exec, -1
    v_lshlrev_b32 v243, 4, v0
    v_add_u32 v243, 131328, v243
    ds_read_b96 v[240:242], v243
    s_waitcnt lgkmcnt(0)
    buffer_store_dword v240, v242, s[44:47], 0 offen sc1
    buffer_store_dword v241, v242, s[44:47], 0 offen offset:256 sc1
L_fin:
L_exit:
    s_endpgm
L_codeend:
.section .rodata,"a"
.p2align 6
.amdhsa_kernel adaLN_cond__sliding_block_cached__dense_activation_gelu__decode_kernel
  .amdhsa_next_free_vgpr 256
  .amdhsa_next_free_sgpr 102
  .amdhsa_accum_offset 256
  .amdhsa_group_segment_fixed_size 0
  .amdhsa_kernarg_size 120
  .amdhsa_user_sgpr_count 2
  .amdhsa_user_sgpr_kernarg_segment_ptr 1
  .amdhsa_system_sgpr_workgroup_id_x 1
  .amdhsa_float_denorm_mode_32 3
.end_amdhsa_kernel
```

```asm
; @launch grid=(256,1,1) block=(512,1,1) lds=132352
.amdgcn_target "amdgcn-amd-amdhsa--gfx950"
.text
.globl adaLN_cond__sliding_block_cached__dense_activation_gelu__decode_kernel
.p2align 8
.type adaLN_cond__sliding_block_cached__dense_activation_gelu__decode_kernel,@function
adaLN_cond__sliding_block_cached__dense_activation_gelu__decode_kernel:
    s_cmp_ge_u32 s2, 256
    s_cbranch_scc1 L_exit
    s_load_dwordx4 s[4:7], s[0:1], 0
    v_lshrrev_b32 v1, 6, v0
    v_and_b32 v0, 63, v0
    v_readfirstlane_b32 s3, v1
    s_and_b32 s34, s2, 127
    s_lshl_b32 s34, s34, 21
    s_lshr_b32 s35, s2, 7
    s_lshl_b32 s35, s35, 18
    s_add_u32 s34, s34, s35
    s_add_u32 s34, s34, 1572864
    s_mov_b32 s38, 0x40000
    s_mov_b32 s39, 0x20000
    s_sub_u32 s49, s3, 1
    s_cbranch_scc1 L_nohead
    s_lshl_b32 s49, s49, 12
    v_lshl_add_u32 v1, v0, 4, s49
    s_lshr_b32 s98, s2, 7
    s_mul_i32 s98, s98, 57344
    s_waitcnt lgkmcnt(0)
    s_add_u32 s36, s6, s34
    s_addc_u32 s37, s7, 0
    buffer_load_dwordx4 v[16:19], v1, s[36:39], s98 offen offset:0 nt
    buffer_load_dwordx4 v[20:23], v1, s[36:39], s98 offen offset:1024 nt
    buffer_load_dwordx4 v[24:27], v1, s[36:39], s98 offen offset:2048 nt
L_nohead:
    s_load_dwordx8 s[8:15], s[0:1], 16
    s_load_dwordx4 s[16:19], s[0:1], 48
    s_load_dwordx8 s[20:27], s[0:1], 64
    s_load_dwordx4 s[28:31], s[0:1], 96
    s_load_dwordx2 s[32:33], s[0:1], 112
    s_and_b32 s60, s2, 7
    s_lshr_b32 s61, s2, 3
    s_mov_b32 s39, 0x20000
    s_mov_b32 s43, 0x20000
    s_mov_b32 s46, 1703936
    s_mov_b32 s47, 0x20000
    s_cmp_lg_u32 s3, 0
    s_cbranch_scc1 L_stream
    s_setprio 3
    v_and_b32 v12, 3, v0
    v_bfe_u32 v13, v0, 2, 2
    v_lshrrev_b32 v14, 4, v0
    v_lshrrev_b32 v10, 3, v0
    v_and_b32 v11, 7, v0
    v_lshlrev_b32 v11, 4, v11
    s_lshr_b32 s50, s2, 2
    s_and_b32 s51, s2, 3
    s_mul_i32 s34, s51, 1228800
    s_lshl_b32 s35, s50, 7
    s_add_u32 s34, s34, s35
    v_mul_u32_u24 v17, 7680, v10
    v_add3_u32 v17, v17, v11, s34
    v_mul_u32_u24 v16, 1280, v12
    v_lshl_add_u32 v18, v14, 4, v16
    s_mul_i32 s34, s51, 320
    v_add_u32 v19, s34, v18
    s_mov_b32 s38, 4915200
    s_sub_u32 s52, s50, 10
    s_waitcnt lgkmcnt(0)
    s_add_u32 s44, s32, 0
    s_addc_u32 s45, s33, 0
    s_cmp_ge_u32 s2, 240
    s_cbranch_scc1 L_clear
    s_mov_b32 s36, s26
    s_mov_b32 s37, s27
    s_mov_b32 m0, 0
    s_mov_b32 s34, 0
L_dma1:
    buffer_load_dwordx4 v17, s[36:39], s34 offen  lds
    s_add_u32 m0, m0, 1024
    s_add_u32 s34, s34, 61440
    buffer_load_dwordx4 v17, s[36:39], s34 offen  lds
    s_add_u32 m0, m0, 1024
    s_add_u32 s34, s34, 61440
    buffer_load_dwordx4 v17, s[36:39], s34 offen  lds
    s_add_u32 m0, m0, 1024
    s_add_u32 s34, s34, 61440
    buffer_load_dwordx4 v17, s[36:39], s34 offen  lds
    s_add_u32 m0, m0, 1024
    s_add_u32 s34, s34, 61440
    s_cmp_lt_u32 s34, 1228800
    s_cbranch_scc1 L_dma1
    v_lshlrev_b32 v1, 2, v0
    v_add_u32 v1, 98304, v1
    v_mov_b32 v2, -1
    v_mov_b32 v3, 0
    ds_write_b32 v1, v2
    ds_write_b32 v1, v2 offset:256
    ds_write_b32 v1, v3 offset:512
    ds_write_b32 v1, v3 offset:768
    s_waitcnt lgkmcnt(0)
    s_barrier
    s_cmp_ge_u32 s52, 10
    s_cbranch_scc1 L_nox
    v_lshl_add_u32 v18, v13, 6, v18
    global_load_dwordx4 v[52:55], v18, s[4:5] offset:0
    global_load_dwordx4 v[56:59], v18, s[4:5] offset:256
    global_load_dwordx4 v[60:63], v18, s[4:5] offset:512
    global_load_dwordx4 v[64:67], v18, s[4:5] offset:768
    global_load_dwordx4 v[68:71], v18, s[4:5] offset:1024
    s_lshl_b32 s34, s52, 7
    v_lshl_add_u32 v16, v13, 5, v16
    v_lshl_add_u32 v16, v14, 3, v16
    v_add_u32 v16, s34, v16
    global_load_dwordx2 v[72:73], v16, s[4:5]
L_nox:
    global_load_dwordx4 v[32:35], v19, s[24:25] offset:0
    global_load_dwordx4 v[36:39], v19, s[24:25] offset:64
    global_load_dwordx4 v[40:43], v19, s[24:25] offset:128
    global_load_dwordx4 v[44:47], v19, s[24:25] offset:192
    global_load_dwordx4 v[48:51], v19, s[24:25] offset:256
    s_and_b32 s34, s2, 31
    s_lshl_b32 s34, s34, 8
    s_lshr_b32 s35, s2, 7
    s_lshl_b32 s35, s35, 7
    s_add_u32 s49, s34, s35
    s_bfe_u32 s53, s2, 0x20005
    s_mul_i32 s34, s53, 1310720
    s_add_u32 s34, s34, s49
    v_lshl_add_u32 v16, v10, 13, v11
    v_add_u32 v16, s34, v16
    s_mov_b32 s36, s10
    s_mov_b32 s37, s11
    s_mov_b32 s38, 5242880
    s_mov_b32 m0, 20480
    s_mov_b32 s34, 0
L_dma2:
    buffer_load_dwordx4 v16, s[36:39], s34 offen  lds
    s_add_u32 m0, m0, 1024
    s_add_u32 s34, s34, 65536
    buffer_load_dwordx4 v16, s[36:39], s34 offen  lds
    s_add_u32 m0, m0, 1024
    s_add_u32 s34, s34, 65536
    buffer_load_dwordx4 v16, s[36:39], s34 offen  lds
    s_add_u32 m0, m0, 1024
    s_add_u32 s34, s34, 65536
    buffer_load_dwordx4 v16, s[36:39], s34 offen  lds
    s_add_u32 m0, m0, 1024
    s_add_u32 s34, s34, 65536
    s_cmp_lt_u32 s34, 1310720
    s_cbranch_scc1 L_dma2
    v_lshl_add_u32 v15, v14, 3, v13
    v_lshlrev_b32 v15, 7, v15
    v_lshl_add_u32 v15, v12, 3, v15
    s_waitcnt vmcnt(20)
    s_mov_b32 s34, 0xbfb8aa3b
    v_lshlrev_b32 v20, 16, v32
    v_and_b32 v21, 0xffff0000, v32
    v_lshlrev_b32 v22, 16, v33
    v_and_b32 v23, 0xffff0000, v33
    v_mul_f32 v24, s34, v20
    v_mul_f32 v25, s34, v21
    v_mul_f32 v26, s34, v22
    v_mul_f32 v27, s34, v23
    v_exp_f32 v24, v24
    v_exp_f32 v25, v25
    v_exp_f32 v26, v26
    v_exp_f32 v27, v27
    v_add_f32 v24, 1.0, v24
    v_add_f32 v25, 1.0, v25
    v_add_f32 v26, 1.0, v26
    v_add_f32 v27, 1.0, v27
    v_rcp_f32 v24, v24
    v_rcp_f32 v25, v25
    v_rcp_f32 v26, v26
    v_rcp_f32 v27, v27
    v_mul_f32 v24, v20, v24
    v_mul_f32 v25, v21, v25
    v_mul_f32 v26, v22, v26
    v_mul_f32 v27, v23, v27
    v_cvt_pk_bf16_f32 v32, v24, v25
    v_cvt_pk_bf16_f32 v33, v26, v27
    v_lshlrev_b32 v20, 16, v34
    v_and_b32 v21, 0xffff0000, v34
    v_lshlrev_b32 v22, 16, v35
    v_and_b32 v23, 0xffff0000, v35
    v_mul_f32 v24, s34, v20
    v_mul_f32 v25, s34, v21
    v_mul_f32 v26, s34, v22
    v_mul_f32 v27, s34, v23
    v_exp_f32 v24, v24
    v_exp_f32 v25, v25
    v_exp_f32 v26, v26
    v_exp_f32 v27, v27
    v_add_f32 v24, 1.0, v24
    v_add_f32 v25, 1.0, v25
    v_add_f32 v26, 1.0, v26
    v_add_f32 v27, 1.0, v27
    v_rcp_f32 v24, v24
    v_rcp_f32 v25, v25
    v_rcp_f32 v26, v26
    v_rcp_f32 v27, v27
    v_mul_f32 v24, v20, v24
    v_mul_f32 v25, v21, v25
    v_mul_f32 v26, v22, v26
    v_mul_f32 v27, v23, v27
    v_cvt_pk_bf16_f32 v34, v24, v25
    v_cvt_pk_bf16_f32 v35, v26, v27
    v_lshlrev_b32 v20, 16, v36
    v_and_b32 v21, 0xffff0000, v36
    v_lshlrev_b32 v22, 16, v37
    v_and_b32 v23, 0xffff0000, v37
    v_mul_f32 v24, s34, v20
    v_mul_f32 v25, s34, v21
    v_mul_f32 v26, s34, v22
    v_mul_f32 v27, s34, v23
    v_exp_f32 v24, v24
    v_exp_f32 v25, v25
    v_exp_f32 v26, v26
    v_exp_f32 v27, v27
    v_add_f32 v24, 1.0, v24
    v_add_f32 v25, 1.0, v25
    v_add_f32 v26, 1.0, v26
    v_add_f32 v27, 1.0, v27
    v_rcp_f32 v24, v24
    v_rcp_f32 v25, v25
    v_rcp_f32 v26, v26
    v_rcp_f32 v27, v27
    v_mul_f32 v24, v20, v24
    v_mul_f32 v25, v21, v25
    v_mul_f32 v26, v22, v26
    v_mul_f32 v27, v23, v27
    v_cvt_pk_bf16_f32 v36, v24, v25
    v_cvt_pk_bf16_f32 v37, v26, v27
    v_lshlrev_b32 v20, 16, v38
    v_and_b32 v21, 0xffff0000, v38
    v_lshlrev_b32 v22, 16, v39
    v_and_b32 v23, 0xffff0000, v39
    v_mul_f32 v24, s34, v20
    v_mul_f32 v25, s34, v21
    v_mul_f32 v26, s34, v22
    v_mul_f32 v27, s34, v23
    v_exp_f32 v24, v24
    v_exp_f32 v25, v25
    v_exp_f32 v26, v26
    v_exp_f32 v27, v27
    v_add_f32 v24, 1.0, v24
    v_add_f32 v25, 1.0, v25
    v_add_f32 v26, 1.0, v26
    v_add_f32 v27, 1.0, v27
    v_rcp_f32 v24, v24
    v_rcp_f32 v25, v25
    v_rcp_f32 v26, v26
    v_rcp_f32 v27, v27
    v_mul_f32 v24, v20, v24
    v_mul_f32 v25, v21, v25
    v_mul_f32 v26, v22, v26
    v_mul_f32 v27, v23, v27
    v_cvt_pk_bf16_f32 v38, v24, v25
    v_cvt_pk_bf16_f32 v39, v26, v27
    v_lshlrev_b32 v20, 16, v40
    v_and_b32 v21, 0xffff0000, v40
    v_lshlrev_b32 v22, 16, v41
    v_and_b32 v23, 0xffff0000, v41
    v_mul_f32 v24, s34, v20
    v_mul_f32 v25, s34, v21
    v_mul_f32 v26, s34, v22
    v_mul_f32 v27, s34, v23
    v_exp_f32 v24, v24
    v_exp_f32 v25, v25
    v_exp_f32 v26, v26
    v_exp_f32 v27, v27
    v_add_f32 v24, 1.0, v24
    v_add_f32 v25, 1.0, v25
    v_add_f32 v26, 1.0, v26
    v_add_f32 v27, 1.0, v27
    v_rcp_f32 v24, v24
    v_rcp_f32 v25, v25
    v_rcp_f32 v26, v26
    v_rcp_f32 v27, v27
    v_mul_f32 v24, v20, v24
    v_mul_f32 v25, v21, v25
    v_mul_f32 v26, v22, v26
    v_mul_f32 v27, v23, v27
    v_cvt_pk_bf16_f32 v40, v24, v25
    v_cvt_pk_bf16_f32 v41, v26, v27
    v_lshlrev_b32 v20, 16, v42
    v_and_b32 v21, 0xffff0000, v42
    v_lshlrev_b32 v22, 16, v43
    v_and_b32 v23, 0xffff0000, v43
    v_mul_f32 v24, s34, v20
    v_mul_f32 v25, s34, v21
    v_mul_f32 v26, s34, v22
    v_mul_f32 v27, s34, v23
    v_exp_f32 v24, v24
    v_exp_f32 v25, v25
    v_exp_f32 v26, v26
    v_exp_f32 v27, v27
    v_add_f32 v24, 1.0, v24
    v_add_f32 v25, 1.0, v25
    v_add_f32 v26, 1.0, v26
    v_add_f32 v27, 1.0, v27
    v_rcp_f32 v24, v24
    v_rcp_f32 v25, v25
    v_rcp_f32 v26, v26
    v_rcp_f32 v27, v27
    v_mul_f32 v24, v20, v24
    v_mul_f32 v25, v21, v25
    v_mul_f32 v26, v22, v26
    v_mul_f32 v27, v23, v27
    v_cvt_pk_bf16_f32 v42, v24, v25
    v_cvt_pk_bf16_f32 v43, v26, v27
    v_lshlrev_b32 v20, 16, v44
    v_and_b32 v21, 0xffff0000, v44
    v_lshlrev_b32 v22, 16, v45
    v_and_b32 v23, 0xffff0000, v45
    v_mul_f32 v24, s34, v20
    v_mul_f32 v25, s34, v21
    v_mul_f32 v26, s34, v22
    v_mul_f32 v27, s34, v23
    v_exp_f32 v24, v24
    v_exp_f32 v25, v25
    v_exp_f32 v26, v26
    v_exp_f32 v27, v27
    v_add_f32 v24, 1.0, v24
    v_add_f32 v25, 1.0, v25
    v_add_f32 v26, 1.0, v26
    v_add_f32 v27, 1.0, v27
    v_rcp_f32 v24, v24
    v_rcp_f32 v25, v25
    v_rcp_f32 v26, v26
    v_rcp_f32 v27, v27
    v_mul_f32 v24, v20, v24
    v_mul_f32 v25, v21, v25
    v_mul_f32 v26, v22, v26
    v_mul_f32 v27, v23, v27
    v_cvt_pk_bf16_f32 v44, v24, v25
    v_cvt_pk_bf16_f32 v45, v26, v27
    v_lshlrev_b32 v20, 16, v46
    v_and_b32 v21, 0xffff0000, v46
    v_lshlrev_b32 v22, 16, v47
    v_and_b32 v23, 0xffff0000, v47
    v_mul_f32 v24, s34, v20
    v_mul_f32 v25, s34, v21
    v_mul_f32 v26, s34, v22
    v_mul_f32 v27, s34, v23
    v_exp_f32 v24, v24
    v_exp_f32 v25, v25
    v_exp_f32 v26, v26
    v_exp_f32 v27, v27
    v_add_f32 v24, 1.0, v24
    v_add_f32 v25, 1.0, v25
    v_add_f32 v26, 1.0, v26
    v_add_f32 v27, 1.0, v27
    v_rcp_f32 v24, v24
    v_rcp_f32 v25, v25
    v_rcp_f32 v26, v26
    v_rcp_f32 v27, v27
    v_mul_f32 v24, v20, v24
    v_mul_f32 v25, v21, v25
    v_mul_f32 v26, v22, v26
    v_mul_f32 v27, v23, v27
    v_cvt_pk_bf16_f32 v46, v24, v25
    v_cvt_pk_bf16_f32 v47, v26, v27
    v_lshlrev_b32 v20, 16, v48
    v_and_b32 v21, 0xffff0000, v48
    v_lshlrev_b32 v22, 16, v49
    v_and_b32 v23, 0xffff0000, v49
    v_mul_f32 v24, s34, v20
    v_mul_f32 v25, s34, v21
    v_mul_f32 v26, s34, v22
    v_mul_f32 v27, s34, v23
    v_exp_f32 v24, v24
    v_exp_f32 v25, v25
    v_exp_f32 v26, v26
    v_exp_f32 v27, v27
    v_add_f32 v24, 1.0, v24
    v_add_f32 v25, 1.0, v25
    v_add_f32 v26, 1.0, v26
    v_add_f32 v27, 1.0, v27
    v_rcp_f32 v24, v24
    v_rcp_f32 v25, v25
    v_rcp_f32 v26, v26
    v_rcp_f32 v27, v27
    v_mul_f32 v24, v20, v24
    v_mul_f32 v25, v21, v25
    v_mul_f32 v26, v22, v26
    v_mul_f32 v27, v23, v27
    v_cvt_pk_bf16_f32 v48, v24, v25
    v_cvt_pk_bf16_f32 v49, v26, v27
    v_lshlrev_b32 v20, 16, v50
    v_and_b32 v21, 0xffff0000, v50
    v_lshlrev_b32 v22, 16, v51
    v_and_b32 v23, 0xffff0000, v51
    v_mul_f32 v24, s34, v20
    v_mul_f32 v25, s34, v21
    v_mul_f32 v26, s34, v22
    v_mul_f32 v27, s34, v23
    v_exp_f32 v24, v24
    v_exp_f32 v25, v25
    v_exp_f32 v26, v26
    v_exp_f32 v27, v27
    v_add_f32 v24, 1.0, v24
    v_add_f32 v25, 1.0, v25
    v_add_f32 v26, 1.0, v26
    v_add_f32 v27, 1.0, v27
    v_rcp_f32 v24, v24
    v_rcp_f32 v25, v25
    v_rcp_f32 v26, v26
    v_rcp_f32 v27, v27
    v_mul_f32 v24, v20, v24
    v_mul_f32 v25, v21, v25
    v_mul_f32 v26, v22, v26
    v_mul_f32 v27, v23, v27
    v_cvt_pk_bf16_f32 v50, v24, v25
    v_cvt_pk_bf16_f32 v51, v26, v27
    s_cmp_ge_u32 s52, 10
    s_cbranch_scc1 L_nostats
    v_mov_b32 v20, 0
    v_mov_b32 v21, 0
    v_mov_b32 v22, 0x3f803f80
    v_dot2c_f32_bf16 v20, v52, v22
    v_dot2c_f32_bf16 v21, v52, v52
    v_dot2c_f32_bf16 v20, v53, v22
    v_dot2c_f32_bf16 v21, v53, v53
    v_dot2c_f32_bf16 v20, v54, v22
    v_dot2c_f32_bf16 v21, v54, v54
    v_dot2c_f32_bf16 v20, v55, v22
    v_dot2c_f32_bf16 v21, v55, v55
    v_dot2c_f32_bf16 v20, v56, v22
    v_dot2c_f32_bf16 v21, v56, v56
    v_dot2c_f32_bf16 v20, v57, v22
    v_dot2c_f32_bf16 v21, v57, v57
    v_dot2c_f32_bf16 v20, v58, v22
    v_dot2c_f32_bf16 v21, v58, v58
    v_dot2c_f32_bf16 v20, v59, v22
    v_dot2c_f32_bf16 v21, v59, v59
    v_dot2c_f32_bf16 v20, v60, v22
    v_dot2c_f32_bf16 v21, v60, v60
    v_dot2c_f32_bf16 v20, v61, v22
    v_dot2c_f32_bf16 v21, v61, v61
    v_dot2c_f32_bf16 v20, v62, v22
    v_dot2c_f32_bf16 v21, v62, v62
    v_dot2c_f32_bf16 v20, v63, v22
    v_dot2c_f32_bf16 v21, v63, v63
    v_dot2c_f32_bf16 v20, v64, v22
    v_dot2c_f32_bf16 v21, v64, v64
    v_dot2c_f32_bf16 v20, v65, v22
    v_dot2c_f32_bf16 v21, v65, v65
    v_dot2c_f32_bf16 v20, v66, v22
    v_dot2c_f32_bf16 v21, v66, v66
    v_dot2c_f32_bf16 v20, v67, v22
    v_dot2c_f32_bf16 v21, v67, v67
    v_dot2c_f32_bf16 v20, v68, v22
    v_dot2c_f32_bf16 v21, v68, v68
    v_dot2c_f32_bf16 v20, v69, v22
    v_dot2c_f32_bf16 v21, v69, v69
    v_dot2c_f32_bf16 v20, v70, v22
    v_dot2c_f32_bf16 v21, v70, v70
    v_dot2c_f32_bf16 v20, v71, v22
    v_dot2c_f32_bf16 v21, v71, v71
    s_nop 1
    v_add_f32_dpp v20, v20, v20 row_ror:4 row_mask:0xf bank_mask:0xf
    v_add_f32_dpp v21, v21, v21 row_ror:4 row_mask:0xf bank_mask:0xf
    s_nop 0
    v_add_f32_dpp v20, v20, v20 row_ror:8 row_mask:0xf bank_mask:0xf
    v_add_f32_dpp v21, v21, v21 row_ror:8 row_mask:0xf bank_mask:0xf
    v_mov_b32 v22, v20
    v_mov_b32 v23, v21
    s_nop 0
    v_permlane16_swap_b32 v20, v22
    v_permlane16_swap_b32 v21, v23
    v_add_f32 v20, v20, v22
    v_add_f32 v21, v21, v23
    v_mov_b32 v22, v20
    v_mov_b32 v23, v21
    s_nop 0
    v_permlane32_swap_b32 v20, v22
    v_permlane32_swap_b32 v21, v23
    v_add_f32 v20, v20, v22
    v_add_f32 v21, v21, v23
    v_mul_f32 v22, 0x3acccccd, v20
    v_mul_f32 v21, 0x3acccccd, v21
    v_fma_f32 v21, -v22, v22, v21
    v_max_f32 v21, 0, v21
    v_add_f32 v21, 0x3727c5ac, v21
    v_rsq_f32 v20, v21
    s_nop 0
    v_mul_f32_e64 v21, -v22, v20
    v_lshlrev_b32 v24, 16, v72
    v_and_b32 v25, 0xffff0000, v72
    v_lshlrev_b32 v26, 16, v73
    v_and_b32 v27, 0xffff0000, v73
    v_fma_f32 v24, v24, v20, v21
    v_fma_f32 v25, v25, v20, v21
    v_fma_f32 v26, v26, v20, v21
    v_fma_f32 v27, v27, v20, v21
L_nostats:
    s_waitcnt vmcnt(20)
    ds_read_b64_tr_b16 v[96:97], v15 offset:0
    ds_read_b64_tr_b16 v[98:99], v15 offset:512
    ds_read_b64_tr_b16 v[100:101], v15 offset:32
    ds_read_b64_tr_b16 v[102:103], v15 offset:544
    ds_read_b64_tr_b16 v[104:105], v15 offset:64
    ds_read_b64_tr_b16 v[106:107], v15 offset:576
    ds_read_b64_tr_b16 v[108:109], v15 offset:96
    ds_read_b64_tr_b16 v[110:111], v15 offset:608
    s_waitcnt lgkmcnt(7)
    ds_read_b64_tr_b16 v[112:113], v15 offset:4096
    ds_read_b64_tr_b16 v[114:115], v15 offset:4608
    ds_read_b64_tr_b16 v[116:117], v15 offset:4128
    ds_read_b64_tr_b16 v[118:119], v15 offset:4640
    ds_read_b64_tr_b16 v[120:121], v15 offset:4160
    ds_read_b64_tr_b16 v[122:123], v15 offset:4672
    ds_read_b64_tr_b16 v[124:125], v15 offset:4192
    ds_read_b64_tr_b16 v[126:127], v15 offset:4704
    s_waitcnt lgkmcnt(7)
    ds_read_b64_tr_b16 v[128:129], v15 offset:8192
    ds_read_b64_tr_b16 v[130:131], v15 offset:8704
    ds_read_b64_tr_b16 v[132:133], v15 offset:8224
    ds_read_b64_tr_b16 v[134:135], v15 offset:8736
    ds_read_b64_tr_b16 v[136:137], v15 offset:8256
    ds_read_b64_tr_b16 v[138:139], v15 offset:8768
    ds_read_b64_tr_b16 v[140:141], v15 offset:8288
    ds_read_b64_tr_b16 v[142:143], v15 offset:8800
    s_waitcnt lgkmcnt(7)
    ds_read_b64_tr_b16 v[144:145], v15 offset:12288
    ds_read_b64_tr_b16 v[146:147], v15 offset:12800
    ds_read_b64_tr_b16 v[148:149], v15 offset:12320
    ds_read_b64_tr_b16 v[150:151], v15 offset:12832
    ds_read_b64_tr_b16 v[152:153], v15 offset:12352
    ds_read_b64_tr_b16 v[154:155], v15 offset:12864
    ds_read_b64_tr_b16 v[156:157], v15 offset:12384
    ds_read_b64_tr_b16 v[158:159], v15 offset:12896
    s_waitcnt lgkmcnt(7)
    ds_read_b64_tr_b16 v[160:161], v15 offset:16384
    ds_read_b64_tr_b16 v[162:163], v15 offset:16896
    ds_read_b64_tr_b16 v[164:165], v15 offset:16416
    ds_read_b64_tr_b16 v[166:167], v15 offset:16928
    ds_read_b64_tr_b16 v[168:169], v15 offset:16448
    ds_read_b64_tr_b16 v[170:171], v15 offset:16960
    ds_read_b64_tr_b16 v[172:173], v15 offset:16480
    ds_read_b64_tr_b16 v[174:175], v15 offset:16992
    s_waitcnt lgkmcnt(0)
    v_mfma_f32_16x16x32_bf16 v[80:83], v[96:99], v[32:35], 0
    v_mfma_f32_16x16x32_bf16 v[84:87], v[100:103], v[32:35], 0
    v_mfma_f32_16x16x32_bf16 v[88:91], v[104:107], v[32:35], 0
    v_mfma_f32_16x16x32_bf16 v[92:95], v[108:111], v[32:35], 0
    v_mfma_f32_16x16x32_bf16 v[80:83], v[112:115], v[36:39], v[80:83]
    v_mfma_f32_16x16x32_bf16 v[84:87], v[116:119], v[36:39], v[84:87]
    v_mfma_f32_16x16x32_bf16 v[88:91], v[120:123], v[36:39], v[88:91]
    v_mfma_f32_16x16x32_bf16 v[92:95], v[124:127], v[36:39], v[92:95]
    v_mfma_f32_16x16x32_bf16 v[80:83], v[128:131], v[40:43], v[80:83]
    v_mfma_f32_16x16x32_bf16 v[84:87], v[132:135], v[40:43], v[84:87]
    v_mfma_f32_16x16x32_bf16 v[88:91], v[136:139], v[40:43], v[88:91]
    v_mfma_f32_16x16x32_bf16 v[92:95], v[140:143], v[40:43], v[92:95]
    v_mfma_f32_16x16x32_bf16 v[80:83], v[144:147], v[44:47], v[80:83]
    v_mfma_f32_16x16x32_bf16 v[84:87], v[148:151], v[44:47], v[84:87]
    v_mfma_f32_16x16x32_bf16 v[88:91], v[152:155], v[44:47], v[88:91]
    v_mfma_f32_16x16x32_bf16 v[92:95], v[156:159], v[44:47], v[92:95]
    v_mfma_f32_16x16x32_bf16 v[80:83], v[160:163], v[48:51], v[80:83]
    v_mfma_f32_16x16x32_bf16 v[84:87], v[164:167], v[48:51], v[84:87]
    v_mfma_f32_16x16x32_bf16 v[88:91], v[168:171], v[48:51], v[88:91]
    v_mfma_f32_16x16x32_bf16 v[92:95], v[172:175], v[48:51], v[92:95]
    s_cmp_ge_u32 s50, 20
    s_cbranch_scc1 L_adr_rest
    s_cmp_lt_u32 s50, 10
    s_cselect_b32 s34, 5120, 0
    s_cselect_b32 s35, s50, s52
    s_lshl_b32 s35, s35, 9
    s_add_u32 s34, s34, s35
    s_lshl_b32 s35, s51, 15
    s_add_u32 s34, s34, s35
    v_lshrrev_b32 v19, 1, v14
    v_lshl_add_u32 v19, v13, 1, v19
    v_lshlrev_b32 v19, 6, v19
    v_lshl_add_u32 v19, v12, 4, v19
    v_and_b32 v20, 1, v14
    v_lshl_add_u32 v19, v20, 3, v19
    s_branch L_adr_done
L_adr_rest:
    s_lshl_b32 s34, s51, 15
    s_lshl_b32 s35, s50, 9
    s_add_u32 s34, s34, s35
    s_add_u32 s34, s34, 0
    v_lshlrev_b32 v19, 7, v12
    v_lshl_add_u32 v19, v13, 5, v19
    v_lshl_add_u32 v19, v14, 3, v19
    s_nop 3
L_adr_done:
    v_add_u32 v19, s34, v19
    v_mov_b32_dpp v80, v84 quad_perm:[0,1,2,3] row_mask:0xf bank_mask:0x2
    v_mov_b32_dpp v81, v85 quad_perm:[0,1,2,3] row_mask:0xf bank_mask:0x2
    v_mov_b32_dpp v82, v86 quad_perm:[0,1,2,3] row_mask:0xf bank_mask:0x2
    v_mov_b32_dpp v83, v87 quad_perm:[0,1,2,3] row_mask:0xf bank_mask:0x2
    v_mov_b32_dpp v80, v88 quad_perm:[0,1,2,3] row_mask:0xf bank_mask:0x4
    v_mov_b32_dpp v81, v89 quad_perm:[0,1,2,3] row_mask:0xf bank_mask:0x4
    v_mov_b32_dpp v82, v90 quad_perm:[0,1,2,3] row_mask:0xf bank_mask:0x4
    v_mov_b32_dpp v83, v91 quad_perm:[0,1,2,3] row_mask:0xf bank_mask:0x4
    v_mov_b32_dpp v80, v92 quad_perm:[0,1,2,3] row_mask:0xf bank_mask:0x8
    v_mov_b32_dpp v81, v93 quad_perm:[0,1,2,3] row_mask:0xf bank_mask:0x8
    v_mov_b32_dpp v82, v94 quad_perm:[0,1,2,3] row_mask:0xf bank_mask:0x8
    v_mov_b32_dpp v83, v95 quad_perm:[0,1,2,3] row_mask:0xf bank_mask:0x8
    s_cmp_ge_u32 s52, 10
    s_cbranch_scc1 L_noz
    v_add_f32 v80, 0x3e800000, v80
    v_add_f32 v81, 0x3e800000, v81
    v_add_f32 v82, 0x3e800000, v82
    v_add_f32 v83, 0x3e800000, v83
    v_mul_f32 v80, v80, v24
    v_mul_f32 v81, v81, v25
    v_mul_f32 v82, v82, v26
    v_mul_f32 v83, v83, v27
L_noz:
    v_cvt_pk_bf16_f32 v20, v80, v81
    v_cvt_pk_bf16_f32 v21, v82, v83
    v_min_u32 v20, -2, v20
    v_min_u32 v21, -2, v21
    v_and_b32 v22, 15, v0
    v_lshlrev_b32 v22, 2, v22
    s_mov_b32 s35, 0
L_poll3:
    global_load_dword v23, v22, s[30:31] offset:128 sc1
    s_add_u32 s35, s35, 1
    s_waitcnt vmcnt(0)
    v_cmp_eq_u32 vcc, 0, v23
    s_cbranch_vccz L_done4
    s_sleep 8
    s_cmp_lt_u32 s35, 60000
    s_cbranch_scc1 L_poll3
L_done4:
    s_getreg_b32 s97, hwreg(HW_REG_XCC_ID, 0, 4)
    s_sub_u32 s97, s97, s2
    s_and_b32 s97, s97, 7
    s_add_u32 s97, s97, 1
    v_cmp_ne_u32 vcc, s97, v23
    s_nop 0
    s_mov_b32 s97, vcc_lo
    buffer_store_dwordx2 v[20:21], v19, s[44:47], 0 offen sc1
    s_branch L_p2
L_clear:
    s_sub_u32 s55, s2, 240
    s_lshr_b32 s34, s55, 2
    s_lshl_b32 s35, s34, 3
    s_lshr_b32 s54, 538910750, s35
    s_and_b32 s54, s54, 0xff
    s_lshl_b32 s54, s54, 10
    s_mul_i32 s34, s34, 393216
    s_lshl_b32 s35, s51, 15
    s_add_u32 s34, s34, s35
    v_lshl_add_u32 v19, v0, 4, s34
    v_mov_b32 v20, -1
    v_mov_b32 v21, -1
    v_mov_b32 v22, -1
    v_mov_b32 v23, -1
    s_mov_b32 s34, 0
L_clrloop:
    buffer_store_dwordx4 v[20:23], v19, s[44:47], s34 offen offset:0 sc1
    s_add_u32 s34, s34, 1024
    s_cmp_lt_u32 s34, s54
    s_cbranch_scc1 L_clrloop
L_clrend:
    s_cmp_ge_u32 s55, 4
    s_cbranch_scc1 L_clrend2
    s_mov_b32 s34, 1572864
    buffer_store_dwordx4 v[20:23], v19, s[44:47], s34 offen sc1
    s_mov_b32 s34, 1573888
    buffer_store_dwordx4 v[20:23], v19, s[44:47], s34 offen sc1
    s_mov_b32 s34, 1574912
    buffer_store_dwordx4 v[20:23], v19, s[44:47], s34 offen sc1
    s_mov_b32 s34, 1575936
    buffer_store_dwordx4 v[20:23], v19, s[44:47], s34 offen sc1
    s_mov_b32 s34, 1576960
    buffer_store_dwordx4 v[20:23], v19, s[44:47], s34 offen sc1
L_clrend2:
    v_lshlrev_b32 v1, 2, v0
    v_add_u32 v1, 98304, v1
    v_mov_b32 v2, -1
    v_mov_b32 v3, 0
    ds_write_b32 v1, v2
    ds_write_b32 v1, v2 offset:256
    ds_write_b32 v1, v3 offset:512
    ds_write_b32 v1, v3 offset:768
    s_waitcnt lgkmcnt(0)
    s_barrier
    s_lshl_b32 s34, s55, 2
    v_mov_b32 v24, s34
    s_getreg_b32 s97, hwreg(HW_REG_XCC_ID, 0, 4)
    s_sub_u32 s97, s97, s2
    s_and_b32 s97, s97, 7
    s_add_u32 s97, s97, 1
    v_mov_b32 v25, s97
    v_readfirstlane_b32 s90, v19
    s_mov_b32 s91, 0
    s_waitcnt vmcnt(0)
    s_mov_b64 exec, 1
    global_store_dword v24, v25, s[30:31] offset:128 sc1
    s_mov_b64 exec, -1
    s_and_b32 s34, s2, 31
    s_lshl_b32 s34, s34, 8
    s_lshr_b32 s35, s2, 7
    s_lshl_b32 s35, s35, 7
    s_add_u32 s49, s34, s35
    s_bfe_u32 s53, s2, 0x20005
    s_mul_i32 s34, s53, 1310720
    s_add_u32 s34, s34, s49
    v_lshl_add_u32 v16, v10, 13, v11
    v_add_u32 v16, s34, v16
    s_mov_b32 s36, s10
    s_mov_b32 s37, s11
    s_mov_b32 s38, 5242880
    s_mov_b32 m0, 20480
    s_mov_b32 s34, 0
L_dma6:
    buffer_load_dwordx4 v16, s[36:39], s34 offen  lds
    s_add_u32 m0, m0, 1024
    s_add_u32 s34, s34, 65536
    buffer_load_dwordx4 v16, s[36:39], s34 offen  lds
    s_add_u32 m0, m0, 1024
    s_add_u32 s34, s34, 65536
    buffer_load_dwordx4 v16, s[36:39], s34 offen  lds
    s_add_u32 m0, m0, 1024
    s_add_u32 s34, s34, 65536
    buffer_load_dwordx4 v16, s[36:39], s34 offen  lds
    s_add_u32 m0, m0, 1024
    s_add_u32 s34, s34, 65536
    s_cmp_lt_u32 s34, 1310720
    s_cbranch_scc1 L_dma6
    v_lshl_add_u32 v15, v14, 3, v13
    v_lshlrev_b32 v15, 7, v15
    v_lshl_add_u32 v15, v12, 3, v15
    s_add_u32 s34, s90, 0
    s_add_u32 s35, s90, 8192
    s_mov_b64 s[88:89], 0
    s_load_dword s88, s[44:45], s34
    s_load_dword s89, s[44:45], s35
    s_waitcnt lgkmcnt(1)
    s_cmp_lg_u32 s89, 0
    s_addc_u32 s91, s91, 0
    s_waitcnt lgkmcnt(0)
    s_add_u32 s34, s90, 1024
    s_add_u32 s35, s90, 9216
    s_mov_b64 s[88:89], 0
    s_load_dword s89, s[44:45], s35
    s_load_dword s88, s[44:45], s34
    s_waitcnt lgkmcnt(1)
    s_cmp_eq_u32 s88, 0
    s_addc_u32 s91, s91, 0
    s_waitcnt lgkmcnt(0)
    s_add_u32 s34, s90, 2048
    s_add_u32 s35, s90, 10240
    s_mov_b64 s[88:89], 0
    s_load_dword s88, s[44:45], s34
    s_load_dword s89, s[44:45], s35
    s_waitcnt lgkmcnt(1)
    s_cmp_lg_u32 s89, 0
    s_addc_u32 s91, s91, 0
    s_waitcnt lgkmcnt(0)
    s_add_u32 s34, s90, 3072
    s_add_u32 s35, s90, 11264
    s_mov_b64 s[88:89], 0
    s_load_dword s89, s[44:45], s35
    s_load_dword s88, s[44:45], s34
    s_waitcnt lgkmcnt(1)
    s_cmp_eq_u32 s88, 0
    s_addc_u32 s91, s91, 0
    s_waitcnt lgkmcnt(0)
    s_getreg_b32 s34, hwreg(HW_REG_XCC_ID, 2, 1)
    s_sub_u32 s35, 2, s91
    s_sub_u32 s91, s91, 2
    s_cmp_eq_u32 s34, 0
    s_cselect_b32 s91, s91, s35
    v_mov_b32 v25, s91
    s_mov_b64 exec, 1
    global_store_dword v24, v25, s[30:31] sc1
    s_mov_b64 exec, -1
    v_and_b32 v22, 15, v0
    v_lshlrev_b32 v22, 2, v22
    s_mov_b32 s35, 0
L_poll7:
    global_load_dword v23, v22, s[30:31] offset:128 sc1
    s_add_u32 s35, s35, 1
    s_waitcnt vmcnt(0)
    v_cmp_eq_u32 vcc, 0, v23
    s_cbranch_vccz L_done8
    s_sleep 8
    s_cmp_lt_u32 s35, 60000
    s_cbranch_scc1 L_poll7
L_done8:
    s_getreg_b32 s97, hwreg(HW_REG_XCC_ID, 0, 4)
    s_sub_u32 s97, s97, s2
    s_and_b32 s97, s97, 7
    s_add_u32 s97, s97, 1
    v_cmp_ne_u32 vcc, s97, v23
    s_nop 0
    s_mov_b32 s97, vcc_lo
L_p2:
    v_mov_b32 v199, v19
    ds_read_b64_tr_b16 v[96:97], v15 offset:20480
    ds_read_b64_tr_b16 v[98:99], v15 offset:20992
    ds_read_b64_tr_b16 v[100:101], v15 offset:20512
    ds_read_b64_tr_b16 v[102:103], v15 offset:21024
    ds_read_b64_tr_b16 v[104:105], v15 offset:20544
    ds_read_b64_tr_b16 v[106:107], v15 offset:21056
    ds_read_b64_tr_b16 v[108:109], v15 offset:20576
    ds_read_b64_tr_b16 v[110:111], v15 offset:21088
    s_waitcnt lgkmcnt(7)
    ds_read_b64_tr_b16 v[112:113], v15 offset:24576
    ds_read_b64_tr_b16 v[114:115], v15 offset:25088
    ds_read_b64_tr_b16 v[116:117], v15 offset:24608
    ds_read_b64_tr_b16 v[118:119], v15 offset:25120
    ds_read_b64_tr_b16 v[120:121], v15 offset:24640
    ds_read_b64_tr_b16 v[122:123], v15 offset:25152
    ds_read_b64_tr_b16 v[124:125], v15 offset:24672
    ds_read_b64_tr_b16 v[126:127], v15 offset:25184
    s_waitcnt lgkmcnt(7)
    ds_read_b64_tr_b16 v[128:129], v15 offset:28672
    ds_read_b64_tr_b16 v[130:131], v15 offset:29184
    ds_read_b64_tr_b16 v[132:133], v15 offset:28704
    ds_read_b64_tr_b16 v[134:135], v15 offset:29216
    ds_read_b64_tr_b16 v[136:137], v15 offset:28736
    ds_read_b64_tr_b16 v[138:139], v15 offset:29248
    ds_read_b64_tr_b16 v[140:141], v15 offset:28768
    ds_read_b64_tr_b16 v[142:143], v15 offset:29280
    s_waitcnt lgkmcnt(7)
    ds_read_b64_tr_b16 v[144:145], v15 offset:32768
    ds_read_b64_tr_b16 v[146:147], v15 offset:33280
    ds_read_b64_tr_b16 v[148:149], v15 offset:32800
    ds_read_b64_tr_b16 v[150:151], v15 offset:33312
    ds_read_b64_tr_b16 v[152:153], v15 offset:32832
    ds_read_b64_tr_b16 v[154:155], v15 offset:33344
    ds_read_b64_tr_b16 v[156:157], v15 offset:32864
    ds_read_b64_tr_b16 v[158:159], v15 offset:33376
    s_waitcnt lgkmcnt(7)
    ds_read_b64_tr_b16 v[160:161], v15 offset:36864
    ds_read_b64_tr_b16 v[162:163], v15 offset:37376
    ds_read_b64_tr_b16 v[164:165], v15 offset:36896
    ds_read_b64_tr_b16 v[166:167], v15 offset:37408
    ds_read_b64_tr_b16 v[168:169], v15 offset:36928
    ds_read_b64_tr_b16 v[170:171], v15 offset:37440
    ds_read_b64_tr_b16 v[172:173], v15 offset:36960
    ds_read_b64_tr_b16 v[174:175], v15 offset:37472
    s_waitcnt lgkmcnt(0)
    s_mul_i32 s34, s53, 1280
    v_lshlrev_b32 v19, 15, v13
    v_lshl_add_u32 v19, v14, 6, v19
    v_lshl_add_u32 v19, v12, 4, v19
    v_add_u32 v19, s34, v19
    s_movk_i32 s48, 5120
    s_mov_b32 s56, 32768
    s_mov_b32 s57, 65536
    s_mov_b32 s58, 98304
    s_sub_u32 s34, s2, 80
    s_cmp_lt_u32 s34, 160
    s_cselect_b32 s54, 1, 0
    s_and_b32 s34, s2, 3
    s_cselect_b32 s54, 0, s54
    v_mov_b32 v180, 0
    v_mov_b32 v181, 0
    v_mov_b32 v182, 0
    v_mov_b32 v183, 0
    v_mov_b32 v184, 0
    v_mov_b32 v185, 0
    v_mov_b32 v186, 0
    v_mov_b32 v187, 0
    v_mov_b32 v22, 99072
    s_mov_b32 s35, 0
L_poll10:
    ds_read_b32 v23, v22
    s_add_u32 s35, s35, 1
    s_waitcnt lgkmcnt(0)
    v_cmp_gt_u32 vcc, 21, v23
    s_cbranch_vccz L_done11
    s_sleep 2
    s_cmp_lt_u32 s35, 60000
    s_cbranch_scc1 L_poll10
L_done11:
    s_mov_b32 s35, 0
L_poll13:
    buffer_load_dwordx4 v[32:35], v19, s[44:47], 0 offen offset:0 sc1
    buffer_load_dwordx4 v[36:39], v19, s[44:47], s48 offen offset:0 sc1
    buffer_load_dwordx4 v[40:43], v19, s[44:47], 0 offen offset:256 sc1
    buffer_load_dwordx4 v[44:47], v19, s[44:47], s48 offen offset:256 sc1
    buffer_load_dwordx4 v[48:51], v19, s[44:47], 0 offen offset:512 sc1
    buffer_load_dwordx4 v[52:55], v19, s[44:47], s48 offen offset:512 sc1
    buffer_load_dwordx4 v[56:59], v19, s[44:47], 0 offen offset:768 sc1
    buffer_load_dwordx4 v[60:63], v19, s[44:47], s48 offen offset:768 sc1
    buffer_load_dwordx4 v[64:67], v19, s[44:47], 0 offen offset:1024 sc1
    buffer_load_dwordx4 v[68:71], v19, s[44:47], s48 offen offset:1024 sc1
    s_cmp_eq_u32 s54, 0
    s_cbranch_scc1 L_hskip
    buffer_load_dwordx2 v[180:181], v199, s[44:47], 0 offen sc1
    buffer_load_dwordx2 v[182:183], v199, s[44:47], s56 offen sc1
    buffer_load_dwordx2 v[184:185], v199, s[44:47], s57 offen sc1
    buffer_load_dwordx2 v[186:187], v199, s[44:47], s58 offen sc1
L_hskip:
    s_add_u32 s35, s35, 1
    s_waitcnt vmcnt(0)
    v_max3_u32 v20, v32, v33, v34
    v_max3_u32 v20, v20, v35, v36
    v_max3_u32 v20, v20, v37, v38
    v_max3_u32 v20, v20, v39, v40
    v_max3_u32 v20, v20, v41, v42
    v_max3_u32 v20, v20, v43, v44
    v_max3_u32 v20, v20, v45, v46
    v_max3_u32 v20, v20, v47, v48
    v_max3_u32 v20, v20, v49, v50
    v_max3_u32 v20, v20, v51, v52
    v_max3_u32 v20, v20, v53, v54
    v_max3_u32 v20, v20, v55, v56
    v_max3_u32 v20, v20, v57, v58
    v_max3_u32 v20, v20, v59, v60
    v_max3_u32 v20, v20, v61, v62
    v_max3_u32 v20, v20, v63, v64
    v_max3_u32 v20, v20, v65, v66
    v_max3_u32 v20, v20, v67, v68
    v_max3_u32 v20, v20, v69, v70
    v_max3_u32 v20, v20, v71, v180
    v_max3_u32 v20, v20, v181, v182
    v_max3_u32 v20, v20, v183, v184
    v_max3_u32 v20, v20, v185, v186
    v_max_u32 v20, v20, v187
    v_cmp_eq_u32 vcc, -1, v20
    s_cbranch_vccz L_done14
    s_sleep 16
    s_cmp_lt_u32 s35, 60000
    s_cbranch_scc1 L_poll13
L_done14:
    v_mfma_f32_16x16x32_bf16 v[80:83], v[96:99], v[32:35], 0
    v_mfma_f32_16x16x32_bf16 v[84:87], v[100:103], v[32:35], 0
    v_mfma_f32_16x16x32_bf16 v[88:91], v[104:107], v[32:35], 0
    v_mfma_f32_16x16x32_bf16 v[92:95], v[108:111], v[32:35], 0
    v_mfma_f32_16x16x32_bf16 v[80:83], v[96:99], v[36:39], v[80:83]
    v_mfma_f32_16x16x32_bf16 v[84:87], v[100:103], v[36:39], v[84:87]
    v_mfma_f32_16x16x32_bf16 v[88:91], v[104:107], v[36:39], v[88:91]
    v_mfma_f32_16x16x32_bf16 v[92:95], v[108:111], v[36:39], v[92:95]
    v_mfma_f32_16x16x32_bf16 v[80:83], v[112:115], v[40:43], v[80:83]
    v_mfma_f32_16x16x32_bf16 v[84:87], v[116:119], v[40:43], v[84:87]
    v_mfma_f32_16x16x32_bf16 v[88:91], v[120:123], v[40:43], v[88:91]
    v_mfma_f32_16x16x32_bf16 v[92:95], v[124:127], v[40:43], v[92:95]
    v_mfma_f32_16x16x32_bf16 v[80:83], v[112:115], v[44:47], v[80:83]
    v_mfma_f32_16x16x32_bf16 v[84:87], v[116:119], v[44:47], v[84:87]
    v_mfma_f32_16x16x32_bf16 v[88:91], v[120:123], v[44:47], v[88:91]
    v_mfma_f32_16x16x32_bf16 v[92:95], v[124:127], v[44:47], v[92:95]
    v_mfma_f32_16x16x32_bf16 v[80:83], v[128:131], v[48:51], v[80:83]
    v_mfma_f32_16x16x32_bf16 v[84:87], v[132:135], v[48:51], v[84:87]
    v_mfma_f32_16x16x32_bf16 v[88:91], v[136:139], v[48:51], v[88:91]
    v_mfma_f32_16x16x32_bf16 v[92:95], v[140:143], v[48:51], v[92:95]
    v_mfma_f32_16x16x32_bf16 v[80:83], v[128:131], v[52:55], v[80:83]
    v_mfma_f32_16x16x32_bf16 v[84:87], v[132:135], v[52:55], v[84:87]
    v_mfma_f32_16x16x32_bf16 v[88:91], v[136:139], v[52:55], v[88:91]
    v_mfma_f32_16x16x32_bf16 v[92:95], v[140:143], v[52:55], v[92:95]
    v_mfma_f32_16x16x32_bf16 v[80:83], v[144:147], v[56:59], v[80:83]
    v_mfma_f32_16x16x32_bf16 v[84:87], v[148:151], v[56:59], v[84:87]
    v_mfma_f32_16x16x32_bf16 v[88:91], v[152:155], v[56:59], v[88:91]
    v_mfma_f32_16x16x32_bf16 v[92:95], v[156:159], v[56:59], v[92:95]
    v_mfma_f32_16x16x32_bf16 v[80:83], v[144:147], v[60:63], v[80:83]
    v_mfma_f32_16x16x32_bf16 v[84:87], v[148:151], v[60:63], v[84:87]
    v_mfma_f32_16x16x32_bf16 v[88:91], v[152:155], v[60:63], v[88:91]
    v_mfma_f32_16x16x32_bf16 v[92:95], v[156:159], v[60:63], v[92:95]
    v_mfma_f32_16x16x32_bf16 v[80:83], v[160:163], v[64:67], v[80:83]
    v_mfma_f32_16x16x32_bf16 v[84:87], v[164:167], v[64:67], v[84:87]
    v_mfma_f32_16x16x32_bf16 v[88:91], v[168:171], v[64:67], v[88:91]
    v_mfma_f32_16x16x32_bf16 v[92:95], v[172:175], v[64:67], v[92:95]
    v_mfma_f32_16x16x32_bf16 v[80:83], v[160:163], v[68:71], v[80:83]
    v_mfma_f32_16x16x32_bf16 v[84:87], v[164:167], v[68:71], v[84:87]
    v_mfma_f32_16x16x32_bf16 v[88:91], v[168:171], v[68:71], v[88:91]
    v_mfma_f32_16x16x32_bf16 v[92:95], v[172:175], v[68:71], v[92:95]
    s_lshl_b32 s34, s53, 15
    s_lshl_b32 s35, s49, 2
    s_add_u32 s34, s34, s35
    s_add_u32 s34, s34, 393216
    v_lshlrev_b32 v19, 7, v12
    v_lshl_add_u32 v19, v13, 5, v19
    v_lshl_add_u32 v19, v14, 3, v19
    v_add_u32 v19, s34, v19
    v_add_f32_dpp v20, v80, v80 row_ror:8 row_mask:0xf bank_mask:0x3
    v_add_f32_dpp v24, v84, v84 row_ror:8 row_mask:0xf bank_mask:0x3
    v_add_f32_dpp v21, v81, v81 row_ror:8 row_mask:0xf bank_mask:0x3
    v_add_f32_dpp v25, v85, v85 row_ror:8 row_mask:0xf bank_mask:0x3
    v_add_f32_dpp v22, v82, v82 row_ror:8 row_mask:0xf bank_mask:0x3
    v_add_f32_dpp v26, v86, v86 row_ror:8 row_mask:0xf bank_mask:0x3
    v_add_f32_dpp v23, v83, v83 row_ror:8 row_mask:0xf bank_mask:0x3
    v_add_f32_dpp v27, v87, v87 row_ror:8 row_mask:0xf bank_mask:0x3
    v_add_f32_dpp v20, v88, v88 row_ror:8 row_mask:0xf bank_mask:0xc
    v_add_f32_dpp v24, v92, v92 row_ror:8 row_mask:0xf bank_mask:0xc
    v_add_f32_dpp v21, v89, v89 row_ror:8 row_mask:0xf bank_mask:0xc
    v_add_f32_dpp v25, v93, v93 row_ror:8 row_mask:0xf bank_mask:0xc
    v_add_f32_dpp v22, v90, v90 row_ror:8 row_mask:0xf bank_mask:0xc
    v_add_f32_dpp v26, v94, v94 row_ror:8 row_mask:0xf bank_mask:0xc
    v_add_f32_dpp v23, v91, v91 row_ror:8 row_mask:0xf bank_mask:0xc
    v_add_f32_dpp v27, v95, v95 row_ror:8 row_mask:0xf bank_mask:0xc
    v_add_f32_dpp v28, v20, v20 row_shl:4 row_mask:0xf bank_mask:0x5
    v_add_f32_dpp v29, v21, v21 row_shl:4 row_mask:0xf bank_mask:0x5
    v_add_f32_dpp v30, v22, v22 row_shl:4 row_mask:0xf bank_mask:0x5
    v_add_f32_dpp v31, v23, v23 row_shl:4 row_mask:0xf bank_mask:0x5
    v_add_f32_dpp v28, v24, v24 row_shr:4 row_mask:0xf bank_mask:0xa
    v_add_f32_dpp v29, v25, v25 row_shr:4 row_mask:0xf bank_mask:0xa
    v_add_f32_dpp v30, v26, v26 row_shr:4 row_mask:0xf bank_mask:0xa
    v_add_f32_dpp v31, v27, v27 row_shr:4 row_mask:0xf bank_mask:0xa
    v_cvt_pk_bf16_f32 v20, v28, v29
    v_cvt_pk_bf16_f32 v21, v30, v31
    v_min_u32 v20, -2, v20
    v_min_u32 v21, -2, v21
    buffer_store_dwordx2 v[20:21], v19, s[44:47], 0 offen sc1
    s_cmp_eq_u32 s54, 0
    s_cbranch_scc1 L_nomf
    v_lshlrev_b32 v24, 16, v180
    v_and_b32 v25, 0xffff0000, v180
    v_lshlrev_b32 v26, 16, v181
    v_and_b32 v27, 0xffff0000, v181
    v_lshlrev_b32 v28, 16, v182
    v_and_b32 v29, 0xffff0000, v182
    v_lshlrev_b32 v30, 16, v183
    v_and_b32 v31, 0xffff0000, v183
    v_add_f32 v24, v24, v28
    v_add_f32 v25, v25, v29
    v_add_f32 v26, v26, v30
    v_add_f32 v27, v27, v31
    v_lshlrev_b32 v28, 16, v184
    v_and_b32 v29, 0xffff0000, v184
    v_lshlrev_b32 v30, 16, v185
    v_and_b32 v31, 0xffff0000, v185
    v_add_f32 v24, v24, v28
    v_add_f32 v25, v25, v29
    v_add_f32 v26, v26, v30
    v_add_f32 v27, v27, v31
    v_lshlrev_b32 v28, 16, v186
    v_and_b32 v29, 0xffff0000, v186
    v_lshlrev_b32 v30, 16, v187
    v_and_b32 v31, 0xffff0000, v187
    v_add_f32 v24, v24, v28
    v_add_f32 v25, v25, v29
    v_add_f32 v26, v26, v30
    v_add_f32 v27, v27, v31
    v_cvt_pk_bf16_f32 v22, v24, v25
    v_cvt_pk_bf16_f32 v23, v26, v27
    v_min_u32 v22, -2, v22
    v_min_u32 v23, -2, v23
    s_sub_u32 s34, s50, 20
    s_lshl_b32 s35, s34, 9
    v_subrev_u32 v199, s35, v199
    s_lshr_b32 s35, s34, 2
    s_lshl_b32 s35, s35, 9
    s_and_b32 s34, s34, 3
    s_lshl_b32 s34, s34, 15
    s_add_u32 s34, s34, s35
    s_add_u32 s34, s34, 1562624
    v_add_u32 v199, s34, v199
    buffer_store_dwordx2 v[22:23], v199, s[44:47], 0 offen sc1
L_nomf:
    s_and_b32 s34, s2, 127
    s_lshl_b32 s34, s34, 21
    s_lshr_b32 s35, s2, 7
    s_lshl_b32 s35, s35, 18
    s_add_u32 s34, s34, s35
    s_add_u32 s34, s34, 1572864
    s_mov_b32 s38, 0x40000
    s_mov_b32 s42, 0x40000
    s_waitcnt lgkmcnt(0)
    s_add_u32 s36, s6, s34
    s_addc_u32 s37, s7, 0
    s_add_u32 s40, s8, s34
    s_addc_u32 s41, s9, 0
    v_lshlrev_b32 v18, 4, v0
    s_mov_b32 s34, 258048
    buffer_load_dwordx4 v[128:131], v18, s[36:39], s34 offen offset:0 nt
    buffer_load_dwordx4 v[132:135], v18, s[36:39], s34 offen offset:1024 nt
    buffer_load_dwordx4 v[136:139], v18, s[36:39], s34 offen offset:2048 nt
    buffer_load_dwordx4 v[140:143], v18, s[36:39], s34 offen offset:3072 nt
    s_and_b32 s34, s2, 31
    s_lshl_b32 s34, s34, 10
    s_lshl_b32 s35, s53, 7
    s_add_u32 s34, s34, s35
    s_add_u32 s34, s34, 393216
    v_lshrrev_b32 v19, 5, v0
    v_mul_u32_u24 v19, 384, v19
    v_lshl_add_u32 v19, v0, 2, v19
    v_add_u32 v19, s34, v19
    v_mov_b32 v22, 99072
    s_and_b32 s34, s60, 3
    s_lshl_b32 s34, s34, 15
    s_lshr_b32 s35, s60, 2
    s_lshl_b32 s35, s35, 7
    s_add_u32 s34, s34, s35
    s_add_u32 s34, s34, 793344
    v_and_b32 v252, 31, v0
    v_lshl_add_u32 v252, v252, 2, s34
    v_mov_b32 v253, 0
    s_mov_b32 s35, 0
L_poll16:
    ds_read_b32 v23, v22
    s_add_u32 s35, s35, 1
    s_waitcnt lgkmcnt(0)
    v_cmp_gt_u32 vcc, 33, v23
    s_cbranch_vccz L_done17
    s_sleep 2
    s_cmp_lt_u32 s35, 60000
    s_cbranch_scc1 L_poll16
L_done17:
    buffer_load_dword v251, v252, s[44:47], 0 offen sc1
    s_lshl_b64 exec, 1, s61
    buffer_store_dword v253, v252, s[44:47], 0 offen
    s_mov_b64 exec, -1
    v_and_b32 v44, 15, v0
    v_lshlrev_b32 v44, 2, v44
    global_load_dword v44, v44, s[30:31] sc1
    s_mov_b32 s35, 0
L_poll19:
    buffer_load_dword v32, v19, s[44:47], 0 offen sc1
    buffer_load_dword v33, v19, s[44:47], s56 offen sc1
    buffer_load_dword v34, v19, s[44:47], s57 offen sc1
    buffer_load_dword v35, v19, s[44:47], s58 offen sc1
    s_add_u32 s35, s35, 1
    s_waitcnt vmcnt(0)
    v_max3_u32 v22, v32, v33, v34
    v_max_u32 v22, v22, v35
    v_cmp_eq_u32 vcc, -1, v22
    s_cbranch_vccz L_done20
    s_sleep 16
    s_cmp_lt_u32 s35, 60000
    s_cbranch_scc1 L_poll19
L_done20:
    v_cmp_ne_u32 vcc, -1, v251
    v_mov_b32 v252, 99076
    s_bcnt1_i32_b32 s34, vcc_lo
    v_mov_b32 v251, s34
    s_mov_b64 exec, 1
    ds_write_b32 v252, v251
    s_mov_b64 exec, -1
    v_add_u32_dpp v44, v44, v44 row_ror:8 row_mask:0xf bank_mask:0xf
    s_nop 1
    v_add_u32_dpp v44, v44, v44 row_ror:4 row_mask:0xf bank_mask:0xf
    s_nop 1
    v_add_u32_dpp v44, v44, v44 row_ror:2 row_mask:0xf bank_mask:0xf
    s_nop 1
    v_add_u32_dpp v44, v44, v44 row_ror:1 row_mask:0xf bank_mask:0xf
    s_nop 0
    v_readfirstlane_b32 s99, v44
    s_nop 0
    s_cmp_gt_i32 s99, 0
    s_cselect_b32 s99, 1, 0
    s_getreg_b32 s34, hwreg(HW_REG_XCC_ID, 2, 1)
    s_xor_b32 s99, s99, s34
    s_lshl_b32 s99, s99, 13
    v_mov_b32 v45, 99080
    v_mov_b32 v44, s99
    ds_write_b32 v45, v44
    v_lshlrev_b32 v36, 16, v32
    v_and_b32 v37, 0xffff0000, v32
    v_lshlrev_b32 v38, 16, v33
    v_and_b32 v39, 0xffff0000, v33
    v_lshlrev_b32 v40, 16, v34
    v_and_b32 v41, 0xffff0000, v34
    v_lshlrev_b32 v42, 16, v35
    v_and_b32 v43, 0xffff0000, v35
    v_pk_add_f32 v[36:37], v[36:37], v[38:39]
    v_pk_add_f32 v[40:41], v[40:41], v[42:43]
    v_pk_add_f32 v[36:37], v[36:37], v[40:41]
    v_cvt_pk_bf16_f32 v32, v36, v37
    v_min_u32 v32, -2, v32
    ds_write_b32 v1, v32
    s_mov_b32 s34, 258048
    buffer_load_dwordx4 v[144:147], v18, s[40:43], s34 offen offset:0 nt
    buffer_load_dwordx4 v[148:151], v18, s[40:43], s34 offen offset:1024 nt
    buffer_load_dwordx4 v[152:155], v18, s[40:43], s34 offen offset:2048 nt
    buffer_load_dwordx4 v[156:159], v18, s[40:43], s34 offen offset:3072 nt
    v_and_b32 v2, 15, v0
    v_lshlrev_b32 v2, 4, v2
    v_add_u32 v2, 98304, v2
    ds_read_b128 v[4:7], v2
    s_waitcnt lgkmcnt(0)
    v_dot2_f32_bf16 v8, v128, v4, 0
    v_dot2_f32_bf16 v9, v132, v4, 0
    v_dot2_f32_bf16 v10, v136, v4, 0
    v_dot2_f32_bf16 v11, v140, v4, 0
    v_dot2c_f32_bf16 v8, v129, v5
    v_dot2c_f32_bf16 v9, v133, v5
    v_dot2c_f32_bf16 v10, v137, v5
    v_dot2c_f32_bf16 v11, v141, v5
    v_dot2c_f32_bf16 v8, v130, v6
    v_dot2c_f32_bf16 v9, v134, v6
    v_dot2c_f32_bf16 v10, v138, v6
    v_dot2c_f32_bf16 v11, v142, v6
    v_dot2c_f32_bf16 v8, v131, v7
    v_dot2c_f32_bf16 v9, v135, v7
    v_dot2c_f32_bf16 v10, v139, v7
    v_dot2c_f32_bf16 v11, v143, v7
    v_add_f32_dpp v16, v8, v8 row_ror:8 row_mask:0xf bank_mask:0x3
    v_add_f32_dpp v16, v9, v9 row_ror:8 row_mask:0xf bank_mask:0xc
    v_add_f32_dpp v17, v10, v10 row_ror:8 row_mask:0xf bank_mask:0x3
    v_add_f32_dpp v17, v11, v11 row_ror:8 row_mask:0xf bank_mask:0xc
    v_add_f32_dpp v16, v16, v16 row_half_mirror row_mask:0xf bank_mask:0xf
    s_nop 0
    v_add_f32_dpp v17, v17, v17 row_half_mirror row_mask:0xf bank_mask:0xf
    v_add_f32_dpp v16, v16, v16 quad_perm:[1,0,3,2] row_mask:0xf bank_mask:0xf
    s_nop 0
    v_add_f32_dpp v17, v17, v17 quad_perm:[1,0,3,2] row_mask:0xf bank_mask:0xf
    v_add_f32_dpp v16, v16, v16 quad_perm:[2,3,0,1] row_mask:0xf bank_mask:0xf
    s_nop 0
    v_add_f32_dpp v17, v17, v17 quad_perm:[2,3,0,1] row_mask:0xf bank_mask:0xf
    v_max_f32 v8, v16, v17
    s_mov_b32 s34, 0x3e0293ee
    s_nop 0
    v_max_f32_dpp v8, v8, v8 row_ror:8 row_mask:0xf bank_mask:0xf
    v_mov_b32 v9, v8
    s_nop 1
    v_permlane16_swap_b32 v8, v9
    v_max_f32 v8, v8, v9
    v_mov_b32 v9, v8
    s_nop 1
    v_permlane32_swap_b32 v8, v9
    v_max_f32 v8, v8, v9
    v_mul_f32 v8, s34, v8
    v_fma_f32 v16, v16, s34, -v8
    v_fma_f32 v17, v17, s34, -v8
    v_exp_f32 v16, v16
    v_exp_f32 v17, v17
    s_nop 0
    v_add_f32 v9, v16, v17
    v_and_b32 v10, 1, v0
    v_lshlrev_b32 v10, 4, v10
    v_mov_b32 v11, 0xffff
    v_lshlrev_b32 v10, v10, v11
    v_bfe_u32 v11, v0, 1, 2
    v_cmp_eq_u32 vcc, 0, v11
    s_nop 1
    v_cndmask_b32 v20, 0, v10, vcc
    v_cmp_eq_u32 vcc, 1, v11
    s_nop 1
    v_cndmask_b32 v21, 0, v10, vcc
    v_cmp_eq_u32 vcc, 2, v11
    s_nop 1
    v_cndmask_b32 v22, 0, v10, vcc
    v_cmp_eq_u32 vcc, 3, v11
    s_nop 1
    v_cndmask_b32 v23, 0, v10, vcc
    v_add_f32_dpp v9, v9, v9 row_ror:8 row_mask:0xf bank_mask:0xf
    v_mov_b32 v10, v9
    s_nop 1
    v_permlane16_swap_b32 v9, v10
    v_add_f32 v9, v9, v10
    v_mov_b32 v10, v9
    s_nop 1
    v_permlane32_swap_b32 v9, v10
    v_add_f32 v9, v9, v10
    v_mov_b32 v10, 98616
    s_mov_b64 exec, 1
    ds_write_b64 v10, v[8:9]
    s_mov_b64 exec, -1
    s_waitcnt vmcnt(0)
    v_cvt_pk_bf16_f32 v10, v16, v16
    v_and_b32 v24, v10, v20
    v_and_b32 v25, v10, v21
    v_and_b32 v26, v10, v22
    v_and_b32 v27, v10, v23
    s_nop 1
    v_mfma_f32_16x16x32_bf16 v[116:119], v[144:147], v[24:27], 0
    v_mfma_f32_16x16x32_bf16 v[120:123], v[148:151], v[24:27], 0
    v_cvt_pk_bf16_f32 v10, v17, v17
    v_and_b32 v28, v10, v20
    v_and_b32 v29, v10, v21
    v_and_b32 v30, v10, v22
    v_and_b32 v31, v10, v23
    s_nop 1
    v_mfma_f32_16x16x32_bf16 v[116:119], v[152:155], v[28:31], v[116:119]
    v_mfma_f32_16x16x32_bf16 v[120:123], v[156:159], v[28:31], v[120:123]
    s_mov_b32 s34, 106496
    v_lshrrev_b32 v16, 4, v0
    v_and_b32 v17, 7, v0
    v_lshl_add_u32 v16, v16, 3, v17
    v_bfe_u32 v17, v0, 3, 1
    v_lshl_add_u32 v16, v17, 5, v16
    v_lshl_add_u32 v16, v16, 4, s34
    s_nop 0
    v_add_f32_dpp v116, v120, v116 row_ror:8 row_mask:0xf bank_mask:0xf
    v_add_f32_dpp v117, v121, v117 row_ror:8 row_mask:0xf bank_mask:0xf
    v_add_f32_dpp v118, v122, v118 row_ror:8 row_mask:0xf bank_mask:0xf
    v_add_f32_dpp v119, v123, v119 row_ror:8 row_mask:0xf bank_mask:0xf
    ds_write_b128 v16, v[116:119]
    v_lshl_add_u32 v16, v0, 3, s34
    ds_read_b64 v[116:117], v16
    s_waitcnt lgkmcnt(0)
    s_mov_b32 s63, 0
    s_mov_b32 s62, s61
    s_cmp_lt_u32 s61, 20
    s_cbranch_scc1 L_rd22
    s_mul_i32 s62, s60, 12
    s_add_u32 s62, s62, s61
    s_sub_u32 s62, s62, 20
    s_mov_b32 s63, 1
    s_cmp_lt_u32 s62, 54
    s_cbranch_scc1 L_rd22
    s_cmp_lt_u32 s62, 56
    s_cselect_b32 s63, 3, 2
    s_sub_u32 s62, s62, 56
L_rd22:
    v_and_b32 v8, 3, v0
    v_bfe_u32 v9, v0, 2, 2
    v_lshrrev_b32 v10, 4, v0
    s_mov_b32 s55, 0x20000
    s_lshl_b32 s35, s62, 6
    s_and_b32 s49, s62, 1
    s_cmp_eq_u32 s63, 0
    s_cbranch_scc1 L_dp24
    s_cmp_eq_u32 s63, 1
    s_cbranch_scc1 L_dp25
    s_mov_b32 s52, s20
    s_mov_b32 s53, s21
    s_mov_b32 s54, 2211840
    v_mov_b32 v15, 0
    s_branch L_dp26
L_dp25:
    s_mov_b32 s52, s16
    s_mov_b32 s53, s17
    s_mov_b32 s54, 2211840
    v_lshl_add_u32 v15, v9, 3, v10
    v_mul_u32_u24 v15, 3456, v15
    v_lshl_add_u32 v15, v8, 4, v15
    v_add_u32 v15, s35, v15
    s_bfe_u32 s50, s3, 0x10001
    s_lshl_b32 s50, s50, 7
    s_and_b32 s34, s3, 1
    s_lshl_b32 s34, s34, 2
    s_add_u32 s50, s50, s34
    s_and_b32 s51, s3, 3
    s_lshl_b32 s51, s51, 5
    s_add_u32 s51, s51, 512
    s_mul_i32 s50, s50, 3456
    s_mul_i32 s51, s51, 3456
    s_branch L_dp26
L_dp24:
    s_mov_b32 s52, s12
    s_mov_b32 s53, s13
    s_mov_b32 s54, 5242880
    s_lshr_b32 s50, s3, 1
    s_lshl_b32 s50, s50, 3
    s_add_u32 s50, s50, s60
    s_and_b32 s51, s3, 1
    s_lshl_b32 s34, s50, 1
    s_add_u32 s34, s34, s51
    s_mul_i32 s34, s34, 81920
    s_add_u32 s34, s34, s35
    v_lshl_add_u32 v15, v9, 2, v10
    v_mul_u32_u24 v15, 2560, v15
    v_lshl_add_u32 v15, v8, 4, v15
    v_add_u32 v15, s34, v15
    s_lshl_b32 s56, s3, 12
    s_lshl_b32 s34, s49, 11
    s_add_u32 s56, s56, s34
    s_add_u32 s56, s56, 40960
    s_add_u32 s58, s56, 1024
    s_mul_i32 s57, s49, 40960
    s_add_u32 s59, s57, 1280
L_dp26:
    v_and_b32 v200, 3, v0
    v_bfe_u32 v201, v0, 2, 2
    v_lshrrev_b32 v202, 4, v0
    s_lshl_b32 s34, s3, 10
    s_add_u32 s34, s34, 122112
    v_mul_u32_u24 v203, 320, v201
    v_min_u32 v203, 704, v203
    v_lshl_add_u32 v203, v202, 6, v203
    v_lshl_add_u32 v203, v200, 4, v203
    v_add_u32 v203, s34, v203
    s_movk_i32 s48, 16384
    v_mov_b32 v197, 0
    s_mov_b32 s40, 0
    s_mov_b32 s41, 0
    s_mov_b32 s42, 0
    s_cmp_eq_u32 s63, 0
    s_cbranch_scc1 L_d_wo
    s_cmp_eq_u32 s63, 2
    s_cbranch_scc1 L_d_w2
    s_cmp_eq_u32 s63, 3
    s_cbranch_scc1 L_d_none
    v_and_b32 v205, 15, v0
    v_lshlrev_b32 v205, 4, v205
    s_and_b32 s49, s3, 3
    s_mul_i32 s34, s49, 1280
    s_add_u32 s34, s34, s99
    s_add_u32 s34, s34, 786432
    v_lshl_add_u32 v206, v202, 15, v205
    v_add_u32 v206, s34, v206
    s_mul_i32 s34, s49, 3840
    v_add_u32 v205, s34, v205
    s_lshl_b32 s34, s62, 6
    v_lshlrev_b32 v5, 4, v14
    v_lshl_add_u32 v5, v12, 2, v5
    v_add_u32 v5, s34, v5
    global_load_dword v6, v5, s[18:19]
    v_and_b32 v7, 15, v0
    v_lshlrev_b32 v7, 4, v7
    v_mul_u32_u24 v8, 1280, v14
    v_add_u32 v8, v8, v7
    v_bfe_u32 v9, v0, 3, 1
    v_lshlrev_b32 v9, 15, v9
    v_lshl_add_u32 v9, v14, 7, v9
    v_and_b32 v10, 7, v0
    v_lshl_add_u32 v9, v10, 4, v9
    v_add_u32 v9, 1572864, v9
    s_mov_b32 s57, 65536
    v_mul_u32_u24 v5, 3840, v14
    v_add_u32 v5, v5, v7
    global_load_dwordx4 v[32:35], v8, s[4:5] offset:0
    global_load_dwordx4 v[36:39], v8, s[4:5] offset:256
    global_load_dwordx4 v[40:43], v8, s[4:5] offset:512
    global_load_dwordx4 v[44:47], v8, s[4:5] offset:768
    global_load_dwordx4 v[48:51], v8, s[4:5] offset:1024
    s_mov_b32 s35, 0
L_poll27:
    buffer_load_dwordx4 v[52:55], v9, s[44:47], s57 offen offset:1024 sc1
    buffer_load_dwordx4 v[56:59], v9, s[44:47], 0 offen offset:1536 sc1
    buffer_load_dwordx4 v[60:63], v9, s[44:47], s57 offen offset:1536 sc1
    buffer_load_dwordx4 v[64:67], v9, s[44:47], 0 offen offset:2048 sc1
    buffer_load_dwordx4 v[68:71], v9, s[44:47], s57 offen offset:2048 sc1
    buffer_load_dwordx4 v[72:75], v9, s[44:47], 0 offen offset:2560 sc1
    buffer_load_dwordx4 v[76:79], v9, s[44:47], s57 offen offset:2560 sc1
    buffer_load_dwordx4 v[80:83], v9, s[44:47], 0 offen offset:3072 sc1
    buffer_load_dwordx4 v[84:87], v9, s[44:47], s57 offen offset:3072 sc1
    buffer_load_dwordx4 v[88:91], v9, s[44:47], 0 offen offset:3584 sc1
    s_add_u32 s35, s35, 1
    s_waitcnt vmcnt(0)
    v_max3_u32 v28, v52, v53, v54
    v_max3_u32 v28, v28, v55, v56
    v_max3_u32 v28, v28, v57, v58
    v_max3_u32 v28, v28, v59, v60
    v_max3_u32 v28, v28, v61, v62
    v_max3_u32 v28, v28, v63, v64
    v_max3_u32 v28, v28, v65, v66
    v_max3_u32 v28, v28, v67, v68
    v_max3_u32 v28, v28, v69, v70
    v_max3_u32 v28, v28, v71, v72
    v_max3_u32 v28, v28, v73, v74
    v_max3_u32 v28, v28, v75, v76
    v_max3_u32 v28, v28, v77, v78
    v_max3_u32 v28, v28, v79, v80
    v_max3_u32 v28, v28, v81, v82
    v_max3_u32 v28, v28, v83, v84
    v_max3_u32 v28, v28, v85, v86
    v_max3_u32 v28, v28, v87, v88
    v_max3_u32 v28, v28, v89, v90
    v_max_u32 v28, v28, v91
    v_cmp_eq_u32 vcc, -1, v28
    s_cbranch_vccz L_done28
    s_sleep 16
    s_cmp_lt_u32 s35, 60000
    s_cbranch_scc1 L_poll27
L_done28:
    ds_write_b128 v5, v[32:35] offset:0
    ds_write_b128 v5, v[36:39] offset:256
    ds_write_b128 v5, v[40:43] offset:512
    ds_write_b128 v5, v[44:47] offset:768
    ds_write_b128 v5, v[48:51] offset:1024
    ds_write_b128 v5, v[52:55] offset:1280
    ds_write_b128 v5, v[56:59] offset:1536
    ds_write_b128 v5, v[60:63] offset:1792
    ds_write_b128 v5, v[64:67] offset:2048
    ds_write_b128 v5, v[68:71] offset:2304
    ds_write_b128 v5, v[72:75] offset:2560
    ds_write_b128 v5, v[76:79] offset:2816
    ds_write_b128 v5, v[80:83] offset:3072
    ds_write_b128 v5, v[84:87] offset:3328
    ds_write_b128 v5, v[88:91] offset:3584
    s_waitcnt lgkmcnt(0)
    v_lshlrev_b32 v100, 16, v6
    v_and_b32 v101, 0xffff0000, v6
    s_cmp_eq_u32 s60, 4
    s_cselect_b32 s40, 6, 12
    s_mov_b32 s41, 5462
    s_cmov_b32 s41, 10923
    s_cselect_b32 s34, 20, 20
    s_mov_b32 s49, 17280
    s_cmov_b32 s49, 34560
    v_min_u32 v196, 59, v0
    v_mul_u32_u24 v197, s41, v196
    v_lshrrev_b32 v197, 16, v197
    v_mul_u32_u24 v194, s40, v197
    v_sub_u32 v196, v196, v194
    v_mul_u32_u24 v197, 3456, v197
    v_lshl_add_u32 v197, v196, 6, v197
    s_mul_i32 s35, s60, 768
    s_add_i32 s35, s35, 0
    s_cmp_eq_u32 s60, 4
    s_cselect_b32 s35, 3072, s35
    s_sub_u32 s34, s61, s34
    s_mul_i32 s34, s34, s49
    s_mul_i32 s34, s34, 11
    s_add_u32 s34, s34, s35
    v_add_u32 v197, s34, v197
    s_mov_b32 s40, s49
    s_mov_b32 s41, s49
    s_branch L_d_none
L_d_w2:
    s_lshl_b32 s34, s62, 5
    v_lshl_add_u32 v3, v14, 3, s34
    global_load_dwordx2 v[20:21], v3, s[22:23]
    v_mul_u32_u24 v112, 1280, v12
    v_add_u32 v112, v112, v3
    global_load_dwordx2 v[22:23], v112, s[4:5]
    s_lshr_b32 s34, s62, 2
    s_add_u32 s34, s34, 30
    s_lshr_b32 s35, s34, 2
    s_lshl_b32 s35, s35, 9
    s_and_b32 s34, s34, 3
    s_lshl_b32 s34, s34, 15
    s_add_u32 s34, s34, s35
    s_and_b32 s35, s62, 3
    s_mul_i32 s35, s35, 32
    s_add_u32 s34, s34, s35
    s_add_u32 s34, s34, 1572864
    v_lshlrev_b32 v5, 7, v12
    v_lshl_add_u32 v5, v14, 3, v5
    v_add_u32 v5, s34, v5
    s_waitcnt vmcnt(0)
    v_lshlrev_b32 v32, 16, v20
    v_and_b32 v33, 0xffff0000, v20
    v_lshlrev_b32 v34, 16, v21
    v_and_b32 v35, 0xffff0000, v21
    v_lshlrev_b32 v108, 16, v22
    v_and_b32 v109, 0xffff0000, v22
    v_lshlrev_b32 v110, 16, v23
    v_and_b32 v111, 0xffff0000, v23
    s_mov_b32 s35, 0
L_poll30:
    buffer_load_dwordx2 v[24:25], v5, s[44:47], 0 offen sc1
    s_add_u32 s35, s35, 1
    s_waitcnt vmcnt(0)
    v_max_u32 v28, v24, v25
    v_cmp_eq_u32 vcc, -1, v28
    s_cbranch_vccz L_done31
    s_sleep 16
    s_cmp_lt_u32 s35, 60000
    s_cbranch_scc1 L_poll30
L_done31:
    v_lshlrev_b32 v104, 16, v24
    v_and_b32 v105, 0xffff0000, v24
    v_lshlrev_b32 v106, 16, v25
    v_and_b32 v107, 0xffff0000, v25
    v_fma_f32 v108, v104, v32, v108
    v_fma_f32 v109, v105, v33, v109
    v_fma_f32 v110, v106, v34, v110
    v_fma_f32 v111, v107, v35, v111
    v_mul_f32 v108, 0x3e800000, v108
    v_mul_f32 v109, 0x3e800000, v109
    v_mul_f32 v110, 0x3e800000, v110
    v_mul_f32 v111, 0x3e800000, v111
    v_lshl_add_u32 v204, v13, 15, v112
    s_add_u32 s34, s99, 786432
    v_add_u32 v204, s34, v204
    s_cmp_eq_u32 s60, 4
    s_cselect_b32 s40, 2, 6
    s_mov_b32 s41, 10923
    s_cmov_b32 s41, 32769
    s_cselect_b32 s34, 28, 20
    s_mov_b32 s49, 12800
    s_cmov_b32 s49, 38400
    v_min_u32 v196, 59, v0
    v_mul_u32_u24 v197, s41, v196
    v_lshrrev_b32 v197, 16, v197
    v_mul_u32_u24 v194, s40, v197
    v_sub_u32 v196, v196, v194
    v_mul_u32_u24 v197, 1280, v197
    v_lshl_add_u32 v197, v196, 6, v197
    s_mul_i32 s35, s60, 384
    s_add_i32 s35, s35, -1792
    s_cmp_eq_u32 s60, 4
    s_cselect_b32 s35, 0, s35
    s_sub_u32 s34, s61, s34
    s_mul_i32 s34, s34, s49
    s_mul_i32 s34, s34, 15
    s_add_u32 s34, s34, s35
    v_add_u32 v197, s34, v197
    s_mov_b32 s40, s49
    s_mov_b32 s41, s49
    s_branch L_d_none
L_d_wo:
    s_lshr_b32 s49, s3, 1
    s_lshl_b32 s49, s49, 15
    v_and_b32 v210, 7, v0
    s_mul_i32 s34, s60, 4096
    s_add_u32 s34, s34, s49
    s_add_u32 s34, s34, 1179904
    v_lshrrev_b32 v211, 3, v0
    v_mul_u32_u24 v205, 512, v211
    v_add_u32 v204, s34, v205
    s_lshl_b32 s35, s51, 7
    s_add_u32 s34, s34, s35
    s_sub_u32 s34, s34, 256
    v_lshl_add_u32 v205, v210, 4, v205
    v_add_u32 v205, s34, v205
    s_lshl_b32 s34, s3, 12
    s_add_u32 s34, s34, 40960
    v_lshrrev_b32 v206, 2, v0
    v_lshlrev_b32 v206, 6, v206
    v_lshl_add_u32 v206, v200, 3, v206
    v_add_u32 v206, s34, v206
    s_mul_i32 s34, s3, 1152
    s_add_u32 s34, s34, 107520
    v_mul_u32_u24 v207, 144, v211
    v_lshl_add_u32 v207, v210, 4, v207
    v_add_u32 v207, s34, v207
    v_mul_u32_u24 v208, 144, v210
    v_lshl_add_u32 v208, v202, 4, v208
    v_add_u32 v208, s34, v208
    v_mul_u32_u24 v212, 144, v211
    v_add_u32 v212, s34, v212
    v_mul_u32_u24 v213, 144, v210
    v_add_u32 v213, s34, v213
    v_and_b32 v211, 1, v211
    v_bfe_u32 v203, v0, 1, 2
    v_mul_u32_u24 v203, 144, v203
    v_and_b32 v214, 1, v0
    v_mul_u32_u24 v214, 576, v214
    v_lshl_add_u32 v214, v211, 6, v214
    v_lshl_add_u32 v214, v202, 4, v214
    s_add_u32 s34, s34, 14592
    v_add3_u32 v203, v203, v214, s34
    v_mov_b32 v210, 98816
    v_cmp_eq_u32 vcc, 0, v211
    s_nop 1
    v_cndmask_b32 v209, v208, v210, vcc
    v_cndmask_b32 v208, v210, v208, vcc
    v_and_b32 v8, 15, v0
    s_lshr_b32 s34, s62, 1
    s_add_u32 s34, s34, 0
    s_lshr_b32 s35, s34, 2
    s_lshl_b32 s35, s35, 9
    s_and_b32 s34, s34, 3
    s_lshl_b32 s34, s34, 15
    s_add_u32 s34, s34, s35
    s_and_b32 s35, s62, 1
    s_mul_i32 s35, s35, 64
    s_add_u32 s34, s34, s35
    s_add_u32 s34, s34, 1572864
    v_lshlrev_b32 v9, 2, v8
    v_lshl_add_u32 v9, v14, 7, v9
    v_add_u32 v9, s34, v9
    s_lshr_b32 s34, s60, 2
    s_lshl_b32 s34, s34, 14
    s_and_b32 s35, s60, 3
    s_lshl_b32 s35, s35, 15
    s_add_u32 s34, s34, s35
    s_lshl_b32 s35, s62, 6
    s_add_u32 s34, s34, s35
    s_add_u32 s34, s34, 786432
    v_mul_u32_u24 v112, 1280, v14
    v_lshl_add_u32 v112, v8, 2, v112
    v_add_u32 v112, s34, v112
    v_mul_u32_u24 v113, 144, v14
    v_lshl_add_u32 v113, v8, 3, v113
    v_add_u32 v113, 122112, v113
    s_bfe_u32 s35, s60, 0x10002
    s_lshl_b32 s35, s35, 13
    s_xor_b32 s101, s99, s35
    s_xor_b32 s93, s101, 8192
    s_mul_i32 s34, s62, 52
    s_lshr_b32 s34, s34, 8
    s_mul_i32 s35, s34, 5
    s_sub_u32 s35, s62, s35
    s_mul_i32 s34, s34, 1310720
    s_lshl_b32 s35, s35, 15
    s_add_u32 s34, s34, s35
    s_mul_i32 s35, s60, 163840
    s_add_u32 s34, s34, s35
    v_lshl_add_u32 v197, v0, 6, s34
    s_movk_i32 s40, 4096
    s_movk_i32 s41, 4096
    s_mov_b32 s35, 0
L_poll33:
    buffer_load_dword v32, v9, s[44:47], 0 offen sc1
    s_add_u32 s35, s35, 1
    s_waitcnt vmcnt(0)
    v_mov_b32 v22, v32
    v_cmp_eq_u32 vcc, -1, v22
    s_cbranch_vccz L_done34
    s_sleep 16
    s_cmp_lt_u32 s35, 60000
    s_cbranch_scc1 L_poll33
L_done34:
    v_lshlrev_b32 v100, 16, v32
    v_and_b32 v101, 0xffff0000, v32
L_d_none:
    v_mov_b32 v22, 99072
    s_and_b32 s34, s60, 3
    s_lshl_b32 s34, s34, 15
    s_lshr_b32 s35, s60, 2
    s_lshl_b32 s35, s35, 7
    s_add_u32 s34, s34, s35
    s_add_u32 s34, s34, 793600
    v_and_b32 v252, 31, v0
    v_lshl_add_u32 v252, v252, 2, s34
    v_mov_b32 v253, 0
    s_mov_b32 s35, 0
L_poll36:
    ds_read_b32 v23, v22
    s_add_u32 s35, s35, 1
    s_waitcnt lgkmcnt(0)
    v_cmp_gt_u32 vcc, 46, v23
    s_cbranch_vccz L_done37
    s_sleep 2
    s_cmp_lt_u32 s35, 60000
    s_cbranch_scc1 L_poll36
L_done37:
    buffer_load_dword v251, v252, s[44:47], 0 offen sc1
    s_lshl_b64 exec, 1, s61
    buffer_store_dword v253, v252, s[44:47], 0 offen
    s_mov_b64 exec, -1
    s_waitcnt vmcnt(0)
    v_cmp_ne_u32 vcc, -1, v251
    v_mov_b32 v252, 99076
    s_bcnt1_i32_b32 s34, vcc_lo
    v_mov_b32 v251, s34
    s_mov_b64 exec, 1
    ds_write_b32 v252, v251
    s_mov_b64 exec, -1
    v_mov_b32 v22, 99072
    s_and_b32 s34, s60, 3
    s_lshl_b32 s34, s34, 15
    s_lshr_b32 s35, s60, 2
    s_lshl_b32 s35, s35, 7
    s_add_u32 s34, s34, s35
    s_add_u32 s34, s34, 793856
    v_and_b32 v252, 31, v0
    v_lshl_add_u32 v252, v252, 2, s34
    v_mov_b32 v253, 0
    s_mov_b32 s35, 0
L_poll39:
    ds_read_b32 v23, v22
    s_add_u32 s35, s35, 1
    s_waitcnt lgkmcnt(0)
    v_cmp_gt_u32 vcc, 57, v23
    s_cbranch_vccz L_done40
    s_sleep 2
    s_cmp_lt_u32 s35, 60000
    s_cbranch_scc1 L_poll39
L_done40:
    buffer_load_dword v251, v252, s[44:47], 0 offen sc1
    s_lshl_b64 exec, 1, s61
    buffer_store_dword v253, v252, s[44:47], 0 offen
    s_mov_b64 exec, -1
    s_waitcnt vmcnt(0)
    v_cmp_ne_u32 vcc, -1, v251
    v_mov_b32 v252, 99076
    s_bcnt1_i32_b32 s34, vcc_lo
    v_mov_b32 v251, s34
    s_mov_b64 exec, 1
    ds_write_b32 v252, v251
    s_mov_b64 exec, -1
    v_and_b32 v19, 7, v0
    v_lshlrev_b32 v19, 3, v19
    v_add_u32 v19, 98560, v19
    s_mov_b32 s35, 0
L_poll42:
    ds_read_b64 v[20:21], v19
    s_add_u32 s35, s35, 1
    s_waitcnt lgkmcnt(0)
    v_max_u32 v22, v20, v21
    v_cmp_eq_u32 vcc, -1, v22
    s_cbranch_vccz L_done43
    s_sleep 2
    s_cmp_lt_u32 s35, 60000
    s_cbranch_scc1 L_poll42
L_done43:
    v_max_f32_dpp v22, v20, v20 row_half_mirror row_mask:0xf bank_mask:0xf
    s_nop 1
    v_max_f32_dpp v22, v22, v22 quad_perm:[1,0,3,2] row_mask:0xf bank_mask:0xf
    s_nop 1
    v_max_f32_dpp v22, v22, v22 quad_perm:[2,3,0,1] row_mask:0xf bank_mask:0xf
    v_sub_f32 v20, v20, v22
    v_exp_f32 v20, v20
    s_nop 0
    v_mul_f32 v21, v21, v20
    s_nop 1
    v_add_f32_dpp v21, v21, v21 row_half_mirror row_mask:0xf bank_mask:0xf
    s_nop 1
    v_add_f32_dpp v21, v21, v21 quad_perm:[1,0,3,2] row_mask:0xf bank_mask:0xf
    s_nop 1
    v_add_f32_dpp v21, v21, v21 quad_perm:[2,3,0,1] row_mask:0xf bank_mask:0xf
    v_rcp_f32 v23, v21
    v_log_f32 v21, v21
    v_mul_f32 v20, v20, v23
    v_add_f32 v21, v21, v22
    v_min_u32 v21, -2, v21
    v_readlane_b32 s88, v20, 0
    v_readlane_b32 s90, v20, 1
    v_readlane_b32 s92, v20, 2
    v_readlane_b32 s94, v20, 3
    v_readlane_b32 s96, v20, 4
    v_readlane_b32 s98, v20, 5
    v_readlane_b32 s100, v20, 6
    v_readlane_b32 s89, v20, 7
    s_and_b32 s95, s61, 3
    s_lshl_b32 s95, s95, 15
    s_bfe_u32 s35, s2, 0x20005
    s_lshl_b32 s35, s35, 1
    s_lshr_b32 s91, s2, 7
    s_add_u32 s35, s35, s91
    s_getreg_b32 s91, hwreg(HW_REG_XCC_ID, 0, 4)
    v_and_b32 v24, 1, v0
    v_cmp_eq_u32 vcc, 0, v24
    v_mov_b32 v25, s91
    s_nop 0
    v_cndmask_b32 v25, v25, v21, vcc
    v_mul_f32 v20, s89, v116
    v_mul_f32 v21, s89, v117
    s_mul_i32 s34, s60, 4096
    s_mul_i32 s35, s35, 512
    s_add_u32 s34, s34, s35
    s_add_u32 s34, s34, s95
    s_add_u32 s34, s34, 1179648
    v_lshl_add_u32 v26, v0, 2, s34
    v_lshlrev_b32 v19, 3, v0
    v_add_u32 v19, 99328, v19
    v_lshlrev_b32 v18, 4, v0
    v_add_u32 v18, 131328, v18
    s_mov_b32 s36, s12
    s_mov_b32 s37, s13
    s_mov_b32 s38, 5242880
    s_and_b32 s34, s61, 24
    s_add_u32 s34, s34, s60
    s_mul_i32 s34, s34, 163840
    s_and_b32 s35, s61, 7
    s_mul_i32 s35, s35, 20480
    s_add_u32 s34, s34, s35
    v_lshl_add_u32 v195, v0, 6, s34
    s_mov_b32 s34, 0
    s_barrier
    buffer_load_dword v250, v195, s[36:39], s34 offen
    s_add_u32 s34, s34, 4096
    buffer_load_dword v250, v195, s[36:39], s34 offen
    s_add_u32 s34, s34, 4096
    buffer_load_dword v250, v195, s[36:39], s34 offen
    s_add_u32 s34, s34, 4096
    buffer_load_dword v250, v195, s[36:39], s34 offen
    s_add_u32 s34, s34, 4096
    buffer_load_dword v250, v195, s[36:39], s34 offen
    s_add_u32 s34, s34, 4096
    s_cmp_lt_u32 s63, 1
    s_cbranch_scc1 L_nopf
    buffer_load_dword v250, v197, s[52:55], s42 offen
    s_add_u32 s42, s42, s40
    buffer_load_dword v250, v197, s[52:55], s42 offen
    s_add_u32 s42, s42, s41
L_nopf:
    s_cmp_eq_u32 s97, 0
    s_barrier
    ds_read_b64 v[32:33], v19 offset:0
    ds_read_b64 v[34:35], v19 offset:1024
    ds_read_b64 v[36:37], v19 offset:2048
    ds_read_b64 v[38:39], v19 offset:3072
    ds_read_b64 v[40:41], v19 offset:4096
    ds_read_b64 v[42:43], v19 offset:5120
    ds_read_b64 v[44:45], v19 offset:6144
    buffer_store_dword v25, v26, s[44:47], 0 offen offset:256
    s_waitcnt lgkmcnt(6)
    v_pk_fma_f32 v[20:21], v[32:33], s[88:89], v[20:21] op_sel_hi:[1,0,1]
    s_waitcnt lgkmcnt(5)
    v_pk_fma_f32 v[20:21], v[34:35], s[90:91], v[20:21] op_sel_hi:[1,0,1]
    s_waitcnt lgkmcnt(4)
    v_pk_fma_f32 v[20:21], v[36:37], s[92:93], v[20:21] op_sel_hi:[1,0,1]
    s_waitcnt lgkmcnt(3)
    v_pk_fma_f32 v[20:21], v[38:39], s[94:95], v[20:21] op_sel_hi:[1,0,1]
    s_waitcnt lgkmcnt(2)
    v_pk_fma_f32 v[20:21], v[40:41], s[96:97], v[20:21] op_sel_hi:[1,0,1]
    s_waitcnt lgkmcnt(1)
    v_pk_fma_f32 v[20:21], v[42:43], s[98:99], v[20:21] op_sel_hi:[1,0,1]
    s_waitcnt lgkmcnt(0)
    v_pk_fma_f32 v[20:21], v[44:45], s[100:101], v[20:21] op_sel_hi:[1,0,1]
    v_cvt_pk_bf16_f32 v24, v20, v21
    v_min_u32 v24, -2, v24
    buffer_store_dword v24, v26, s[44:47], 0 offen
    s_cbranch_scc1 L_ostd
    buffer_store_dword v24, v26, s[44:47], 0 offen sc1
    buffer_store_dword v25, v26, s[44:47], 0 offen offset:256 sc1
L_ostd:
    ds_write_b96 v18, v[24:26]
    s_cmp_lt_u32 s63, 1
    s_cbranch_scc1 L_nopf2
    buffer_load_dword v250, v197, s[52:55], s42 offen
    s_add_u32 s42, s42, s40
    buffer_load_dword v250, v197, s[52:55], s42 offen
    s_add_u32 s42, s42, s41
    buffer_load_dword v250, v197, s[52:55], s42 offen
    s_add_u32 s42, s42, s40
    buffer_load_dword v250, v197, s[52:55], s42 offen
    s_add_u32 s42, s42, s41
    buffer_load_dword v250, v197, s[52:55], s42 offen
    s_add_u32 s42, s42, s40
    buffer_load_dword v250, v197, s[52:55], s42 offen
    s_add_u32 s42, s42, s41
    buffer_load_dword v250, v197, s[52:55], s42 offen
    s_add_u32 s42, s42, s40
    buffer_load_dword v250, v197, s[52:55], s42 offen
    s_add_u32 s42, s42, s41
L_nopf2:
    s_waitcnt lgkmcnt(0)
    s_barrier
    s_cmp_eq_u32 s63, 0
    s_cbranch_scc1 L_r_wo2
    buffer_load_dword v250, v197, s[52:55], s42 offen
    s_add_u32 s42, s42, s40
    s_cmp_eq_u32 s63, 1
    s_cbranch_scc1 L_r_w1
    buffer_load_dword v250, v197, s[52:55], s42 offen
    s_add_u32 s42, s42, s40
    buffer_load_dword v250, v197, s[52:55], s42 offen
    s_add_u32 s42, s42, s41
    buffer_load_dword v250, v197, s[52:55], s42 offen
    s_add_u32 s42, s42, s40
    buffer_load_dword v250, v197, s[52:55], s42 offen
    s_add_u32 s42, s42, s41
    s_cmp_eq_u32 s63, 2
    s_cbranch_scc1 L_w2_red
    s_waitcnt vmcnt(0)
    s_mov_b64 exec, -1
    v_lshlrev_b32 v243, 4, v0
    v_add_u32 v243, 131328, v243
    ds_read_b96 v[240:242], v243
    s_waitcnt lgkmcnt(0)
    buffer_store_dword v240, v242, s[44:47], 0 offen sc1
    buffer_store_dword v241, v242, s[44:47], 0 offen offset:256 sc1
    s_branch L_fin
L_stream:
    s_sub_u32 s49, s3, 1
    s_lshl_b32 s49, s49, 12
    v_lshl_add_u32 v1, v0, 4, s49
    s_and_b32 s34, s2, 127
    s_lshl_b32 s34, s34, 21
    s_lshr_b32 s35, s2, 7
    s_lshl_b32 s35, s35, 18
    s_add_u32 s34, s34, s35
    s_add_u32 s34, s34, 1572864
    s_mov_b32 s38, 0x40000
    s_mov_b32 s42, 0x40000
    s_waitcnt lgkmcnt(0)
    s_add_u32 s36, s6, s34
    s_addc_u32 s37, s7, 0
    s_add_u32 s40, s8, s34
    s_addc_u32 s41, s9, 0
    s_barrier
    s_waitcnt vmcnt(2)
    buffer_load_dwordx4 v[28:31], v1, s[36:39], s98 offen offset:3072 nt
    s_waitcnt vmcnt(2)
    s_add_u32 s98, s98, 28672
    s_cmp_eq_u32 s98, 258048
    s_cselect_b32 s98, 0, s98
    buffer_load_dwordx4 v[32:35], v1, s[36:39], s98 offen offset:0 nt
    s_waitcnt vmcnt(2)
    buffer_load_dwordx4 v[36:39], v1, s[36:39], s98 offen offset:1024 nt
    s_waitcnt vmcnt(2)
    buffer_load_dwordx4 v[40:43], v1, s[36:39], s98 offen offset:2048 nt
    s_waitcnt vmcnt(2)
    buffer_load_dwordx4 v[44:47], v1, s[36:39], s98 offen offset:3072 nt
    s_add_u32 s44, s32, 0
    s_addc_u32 s45, s33, 0
    s_mov_b32 s63, 0
    s_mov_b32 s62, s61
    s_cmp_lt_u32 s61, 20
    s_cbranch_scc1 L_rd45
    s_mul_i32 s62, s60, 12
    s_add_u32 s62, s62, s61
    s_sub_u32 s62, s62, 20
    s_mov_b32 s63, 1
    s_cmp_lt_u32 s62, 54
    s_cbranch_scc1 L_rd45
    s_cmp_lt_u32 s62, 56
    s_cselect_b32 s63, 3, 2
    s_sub_u32 s62, s62, 56
L_rd45:
    v_and_b32 v8, 3, v0
    v_bfe_u32 v9, v0, 2, 2
    v_lshrrev_b32 v10, 4, v0
    s_mov_b32 s55, 0x20000
    s_lshl_b32 s35, s62, 6
    s_and_b32 s49, s62, 1
    s_cmp_eq_u32 s63, 0
    s_cbranch_scc1 L_dp47
    s_cmp_eq_u32 s63, 1
    s_cbranch_scc1 L_dp48
    s_mov_b32 s52, s20
    s_mov_b32 s53, s21
    s_mov_b32 s54, 2211840
    v_mov_b32 v15, 0
    s_branch L_dp49
L_dp48:
    s_mov_b32 s52, s16
    s_mov_b32 s53, s17
    s_mov_b32 s54, 2211840
    v_lshl_add_u32 v15, v9, 3, v10
    v_mul_u32_u24 v15, 3456, v15
    v_lshl_add_u32 v15, v8, 4, v15
    v_add_u32 v15, s35, v15
    s_bfe_u32 s50, s3, 0x10001
    s_lshl_b32 s50, s50, 7
    s_and_b32 s34, s3, 1
    s_lshl_b32 s34, s34, 2
    s_add_u32 s50, s50, s34
    s_and_b32 s51, s3, 3
    s_lshl_b32 s51, s51, 5
    s_add_u32 s51, s51, 512
    s_mul_i32 s50, s50, 3456
    s_mul_i32 s51, s51, 3456
    s_branch L_dp49
L_dp47:
    s_mov_b32 s52, s12
    s_mov_b32 s53, s13
    s_mov_b32 s54, 5242880
    s_lshr_b32 s50, s3, 1
    s_lshl_b32 s50, s50, 3
    s_add_u32 s50, s50, s60
    s_and_b32 s51, s3, 1
    s_lshl_b32 s34, s50, 1
    s_add_u32 s34, s34, s51
    s_mul_i32 s34, s34, 81920
    s_add_u32 s34, s34, s35
    v_lshl_add_u32 v15, v9, 2, v10
    v_mul_u32_u24 v15, 2560, v15
    v_lshl_add_u32 v15, v8, 4, v15
    v_add_u32 v15, s34, v15
    s_lshl_b32 s56, s3, 12
    s_lshl_b32 s34, s49, 11
    s_add_u32 s56, s56, s34
    s_add_u32 s56, s56, 40960
    s_add_u32 s58, s56, 1024
    s_mul_i32 s57, s49, 40960
    s_add_u32 s59, s57, 1280
L_dp49:
    v_and_b32 v2, 15, v0
    v_lshlrev_b32 v2, 4, v2
    v_add_u32 v2, 98304, v2
    s_waitcnt vmcnt(2)
    s_add_u32 s98, s98, 28672
    s_cmp_eq_u32 s98, 258048
    s_cselect_b32 s98, 0, s98
    buffer_load_dwordx4 v[48:51], v1, s[36:39], s98 offen offset:0 nt
    s_waitcnt vmcnt(2)
    buffer_load_dwordx4 v[52:55], v1, s[36:39], s98 offen offset:1024 nt
    s_waitcnt vmcnt(2)
    s_cmp_ge_u32 s3, 4
    s_cbranch_scc1 L_sl50
    s_waitcnt vmcnt(1)
L_sl50:
    buffer_load_dwordx4 v[56:59], v1, s[36:39], s98 offen offset:2048 nt
    s_waitcnt vmcnt(2)
    s_cmp_ge_u32 s3, 4
    s_cbranch_scc1 L_sl51
    s_waitcnt vmcnt(1)
L_sl51:
    buffer_load_dwordx4 v[60:63], v1, s[36:39], s98 offen offset:3072 nt
    s_waitcnt vmcnt(2)
    s_cmp_ge_u32 s3, 4
    s_cbranch_scc1 L_sl52
    s_waitcnt vmcnt(1)
L_sl52:
    s_add_u32 s98, s98, 28672
    s_cmp_eq_u32 s98, 258048
    s_cselect_b32 s98, 0, s98
    buffer_load_dwordx4 v[64:67], v1, s[36:39], s98 offen offset:0 nt
    s_waitcnt vmcnt(2)
    buffer_load_dwordx4 v[68:71], v1, s[36:39], s98 offen offset:1024 nt
    s_waitcnt vmcnt(2)
    buffer_load_dwordx4 v[72:75], v1, s[36:39], s98 offen offset:2048 nt
    s_waitcnt vmcnt(2)
    buffer_load_dwordx4 v[76:79], v1, s[36:39], s98 offen offset:3072 nt
    s_waitcnt vmcnt(2)
    s_add_u32 s98, s98, 28672
    s_cmp_eq_u32 s98, 258048
    s_cselect_b32 s98, 0, s98
    buffer_load_dwordx4 v[80:83], v1, s[36:39], s98 offen offset:0 nt
    s_waitcnt vmcnt(2)
    buffer_load_dwordx4 v[84:87], v1, s[36:39], s98 offen offset:1024 nt
    s_waitcnt vmcnt(2)
    buffer_load_dwordx4 v[88:91], v1, s[36:39], s98 offen offset:2048 nt
    s_waitcnt vmcnt(2)
    buffer_load_dwordx4 v[92:95], v1, s[36:39], s98 offen offset:3072 nt
    s_waitcnt vmcnt(2)
    s_add_u32 s98, s98, 28672
    s_cmp_eq_u32 s98, 258048
    s_cselect_b32 s98, 0, s98
    buffer_load_dwordx4 v[96:99], v1, s[36:39], s98 offen offset:0 nt
    v_mov_b32 v3, 21
    v_mov_b32 v14, 99072
    s_mov_b64 exec, 1
    ds_write_b32 v14, v3
    s_mov_b64 exec, -1
    s_waitcnt vmcnt(2)
    buffer_load_dwordx4 v[100:103], v1, s[36:39], s98 offen offset:1024 nt
    s_waitcnt vmcnt(2)
    buffer_load_dwordx4 v[104:107], v1, s[36:39], s98 offen offset:2048 nt
    s_waitcnt vmcnt(2)
    buffer_load_dwordx4 v[108:111], v1, s[36:39], s98 offen offset:3072 nt
    s_waitcnt vmcnt(2)
    s_add_u32 s98, s98, 28672
    s_cmp_eq_u32 s98, 258048
    s_cselect_b32 s98, 0, s98
    buffer_load_dwordx4 v[112:115], v1, s[36:39], s98 offen offset:0 nt
    s_waitcnt vmcnt(2)
    buffer_load_dwordx4 v[116:119], v1, s[36:39], s98 offen offset:1024 nt
    s_waitcnt vmcnt(2)
    buffer_load_dwordx4 v[120:123], v1, s[36:39], s98 offen offset:2048 nt
    s_waitcnt vmcnt(2)
    buffer_load_dwordx4 v[124:127], v1, s[36:39], s98 offen offset:3072 nt
    s_waitcnt vmcnt(2)
    s_add_u32 s98, s98, 28672
    s_cmp_eq_u32 s98, 258048
    s_cselect_b32 s98, 0, s98
    buffer_load_dwordx4 v[128:131], v1, s[36:39], s98 offen offset:0 nt
    s_waitcnt vmcnt(2)
    buffer_load_dwordx4 v[132:135], v1, s[36:39], s98 offen offset:1024 nt
    s_waitcnt vmcnt(2)
    buffer_load_dwordx4 v[136:139], v1, s[36:39], s98 offen offset:2048 nt
    s_waitcnt vmcnt(2)
    buffer_load_dwordx4 v[140:143], v1, s[36:39], s98 offen offset:3072 nt
    s_waitcnt vmcnt(2)
    s_add_u32 s98, s98, 28672
    s_cmp_eq_u32 s98, 258048
    s_cselect_b32 s98, 0, s98
    buffer_load_dwordx4 v[144:147], v1, s[36:39], s98 offen offset:0 nt
    v_mov_b32 v3, 33
    v_mov_b32 v14, 99072
    s_mov_b64 exec, 1
    ds_write_b32 v14, v3
    s_mov_b64 exec, -1
    s_waitcnt vmcnt(2)
    buffer_load_dwordx4 v[148:151], v1, s[36:39], s98 offen offset:1024 nt
    s_waitcnt vmcnt(2)
    buffer_load_dwordx4 v[152:155], v1, s[36:39], s98 offen offset:2048 nt
    s_waitcnt vmcnt(2)
    buffer_load_dwordx4 v[156:159], v1, s[36:39], s98 offen offset:3072 nt
    s_waitcnt vmcnt(2)
    s_add_u32 s98, s98, 28672
    s_cmp_eq_u32 s98, 258048
    s_cselect_b32 s98, 0, s98
    buffer_load_dwordx4 v[160:163], v1, s[40:43], s98 offen offset:0 nt
    v_mov_b32 v3, 99076
    ds_read_b32 v3, v3
    s_waitcnt vmcnt(2)
    s_waitcnt lgkmcnt(0)
    v_readfirstlane_b32 s48, v3
    buffer_load_dwordx4 v[164:167], v1, s[40:43], s98 offen offset:1024 nt
    s_cmp_ge_u32 s48, 20
    s_cbranch_scc1 L_bo53
    s_waitcnt vmcnt(2)
L_bo53:
    buffer_load_dwordx4 v[168:171], v1, s[40:43], s98 offen offset:2048 nt
    s_waitcnt vmcnt(3)
    s_cmp_ge_u32 s48, 21
    s_cbranch_scc1 L_bo54
    s_waitcnt vmcnt(2)
L_bo54:
    buffer_load_dwordx4 v[172:175], v1, s[40:43], s98 offen offset:3072 nt
    s_waitcnt vmcnt(3)
    s_cmp_ge_u32 s48, 22
    s_cbranch_scc1 L_bo55
    s_waitcnt vmcnt(2)
L_bo55:
    s_add_u32 s98, s98, 28672
    s_cmp_eq_u32 s98, 258048
    s_cselect_b32 s98, 0, s98
    buffer_load_dwordx4 v[176:179], v1, s[40:43], s98 offen offset:0 nt
    s_waitcnt vmcnt(3)
    s_cmp_ge_u32 s48, 23
    s_cbranch_scc1 L_bo56
    s_waitcnt vmcnt(2)
L_bo56:
    buffer_load_dwordx4 v[180:183], v1, s[40:43], s98 offen offset:1024 nt
    s_waitcnt vmcnt(3)
    s_cmp_ge_u32 s48, 24
    s_cbranch_scc1 L_bo57
    s_waitcnt vmcnt(2)
L_bo57:
    buffer_load_dwordx4 v[184:187], v1, s[40:43], s98 offen offset:2048 nt
    s_waitcnt vmcnt(3)
    s_cmp_ge_u32 s48, 24
    s_cbranch_scc1 L_bo58
    s_waitcnt vmcnt(2)
L_bo58:
    buffer_load_dwordx4 v[188:191], v1, s[40:43], s98 offen offset:3072 nt
    s_waitcnt vmcnt(3)
    s_cmp_ge_u32 s48, 25
    s_cbranch_scc1 L_bo59
    s_waitcnt vmcnt(2)
L_bo59:
    s_add_u32 s98, s98, 28672
    s_cmp_eq_u32 s98, 258048
    s_cselect_b32 s98, 0, s98
    buffer_load_dwordx4 v[192:195], v1, s[40:43], s98 offen offset:0 nt
    s_waitcnt vmcnt(3)
    s_cmp_ge_u32 s48, 26
    s_cbranch_scc1 L_bo60
    s_waitcnt vmcnt(2)
L_bo60:
    buffer_load_dwordx4 v[196:199], v1, s[40:43], s98 offen offset:1024 nt
    v_mov_b32 v3, 46
    v_mov_b32 v14, 99072
    s_mov_b64 exec, 1
    ds_write_b32 v14, v3
    s_mov_b64 exec, -1
    s_waitcnt vmcnt(3)
    s_cmp_ge_u32 s48, 27
    s_cbranch_scc1 L_bo61
    s_waitcnt vmcnt(2)
L_bo61:
    buffer_load_dwordx4 v[200:203], v1, s[40:43], s98 offen offset:2048 nt
    s_waitcnt vmcnt(3)
    s_cmp_ge_u32 s48, 27
    s_cbranch_scc1 L_bo62
    s_waitcnt vmcnt(2)
L_bo62:
    buffer_load_dwordx4 v[204:207], v1, s[40:43], s98 offen offset:3072 nt
    s_waitcnt vmcnt(3)
    s_cmp_ge_u32 s48, 28
    s_cbranch_scc1 L_bo63
    s_waitcnt vmcnt(2)
L_bo63:
    s_add_u32 s98, s98, 28672
    s_cmp_eq_u32 s98, 258048
    s_cselect_b32 s98, 0, s98
    buffer_load_dwordx4 v[208:211], v1, s[40:43], s98 offen offset:0 nt
    s_waitcnt vmcnt(3)
    s_cmp_ge_u32 s48, 28
    s_cbranch_scc1 L_bo64
    s_waitcnt vmcnt(2)
L_bo64:
    buffer_load_dwordx4 v[212:215], v1, s[40:43], s98 offen offset:1024 nt
    v_mov_b32 v3, 99076
    ds_read_b32 v3, v3
    s_waitcnt vmcnt(3)
    s_cmp_ge_u32 s48, 29
    s_cbranch_scc1 L_bo65
    s_waitcnt vmcnt(2)
L_bo65:
    s_waitcnt lgkmcnt(0)
    v_readfirstlane_b32 s48, v3
    buffer_load_dwordx4 v[216:219], v1, s[40:43], s98 offen offset:2048 nt
    s_waitcnt vmcnt(3)
    s_cmp_ge_u32 s48, 20
    s_cbranch_scc1 L_bo66
    s_waitcnt vmcnt(2)
L_bo66:
    buffer_load_dwordx4 v[220:223], v1, s[40:43], s98 offen offset:3072 nt
    s_waitcnt vmcnt(3)
    s_cmp_ge_u32 s48, 21
    s_cbranch_scc1 L_bo67
    s_waitcnt vmcnt(2)
L_bo67:
    s_add_u32 s98, s98, 28672
    s_cmp_eq_u32 s98, 258048
    s_cselect_b32 s98, 0, s98
    buffer_load_dwordx4 v[224:227], v1, s[40:43], s98 offen offset:0 nt
    s_waitcnt vmcnt(3)
    s_cmp_ge_u32 s48, 22
    s_cbranch_scc1 L_bo68
    s_waitcnt vmcnt(2)
L_bo68:
    buffer_load_dwordx4 v[228:231], v1, s[40:43], s98 offen offset:1024 nt
    s_waitcnt vmcnt(3)
    s_cmp_ge_u32 s48, 23
    s_cbranch_scc1 L_bo69
    s_waitcnt vmcnt(2)
L_bo69:
    buffer_load_dwordx4 v[232:235], v1, s[40:43], s98 offen offset:2048 nt
    s_waitcnt vmcnt(3)
    s_cmp_ge_u32 s48, 24
    s_cbranch_scc1 L_bo70
    s_waitcnt vmcnt(2)
L_bo70:
    buffer_load_dwordx4 v[236:239], v1, s[40:43], s98 offen offset:3072 nt
    s_waitcnt vmcnt(3)
    s_cmp_ge_u32 s48, 24
    s_cbranch_scc1 L_bo71
    s_waitcnt vmcnt(2)
L_bo71:
    s_add_u32 s98, s98, 28672
    s_cmp_eq_u32 s98, 258048
    s_cselect_b32 s98, 0, s98
    buffer_load_dwordx4 v[240:243], v1, s[40:43], s98 offen offset:0 nt
    v_mov_b32 v3, 57
    v_mov_b32 v14, 99072
    s_mov_b64 exec, 1
    ds_write_b32 v14, v3
    s_mov_b64 exec, -1
    s_waitcnt vmcnt(3)
    s_cmp_ge_u32 s48, 25
    s_cbranch_scc1 L_bo72
    s_waitcnt vmcnt(2)
L_bo72:
    buffer_load_dwordx4 v[244:247], v1, s[40:43], s98 offen offset:1024 nt
    s_waitcnt vmcnt(3)
    s_cmp_ge_u32 s48, 26
    s_cbranch_scc1 L_bo73
    s_waitcnt vmcnt(2)
L_bo73:
    buffer_load_dwordx4 v[248:251], v1, s[40:43], s98 offen offset:2048 nt
    s_waitcnt vmcnt(3)
    s_cmp_ge_u32 s48, 27
    s_cbranch_scc1 L_bo74
    s_waitcnt vmcnt(2)
L_bo74:
    buffer_load_dwordx4 v[252:255], v1, s[40:43], s98 offen offset:3072 nt
    v_mov_b32 v14, 99080
    s_mov_b32 s35, 0
L_poll75:
    ds_read_b128 v[4:7], v2
    ds_read_b32 v8, v14
    s_add_u32 s35, s35, 1
    s_waitcnt lgkmcnt(0)
    v_max3_u32 v3, v4, v5, v6
    v_max_u32 v3, v3, v7
    v_cmp_eq_u32 vcc, -1, v3
    s_cbranch_vccz L_done76
    s_sleep 2
    s_cmp_lt_u32 s35, 60000
    s_cbranch_scc1 L_poll75
L_done76:
    v_readfirstlane_b32 s99, v8
    v_dot2_f32_bf16 v8, v16, v4, 0
    v_dot2_f32_bf16 v9, v20, v4, 0
    v_dot2_f32_bf16 v10, v24, v4, 0
    v_dot2_f32_bf16 v11, v28, v4, 0
    v_dot2c_f32_bf16 v8, v17, v5
    v_dot2c_f32_bf16 v9, v21, v5
    v_dot2c_f32_bf16 v10, v25, v5
    v_dot2c_f32_bf16 v11, v29, v5
    v_dot2c_f32_bf16 v8, v18, v6
    v_dot2c_f32_bf16 v9, v22, v6
    v_dot2c_f32_bf16 v10, v26, v6
    v_dot2c_f32_bf16 v11, v30, v6
    v_dot2c_f32_bf16 v8, v19, v7
    v_dot2c_f32_bf16 v9, v23, v7
    v_dot2c_f32_bf16 v10, v27, v7
    v_dot2c_f32_bf16 v11, v31, v7
    v_add_f32_dpp v12, v8, v8 row_ror:8 row_mask:0xf bank_mask:0x3
    v_add_f32_dpp v12, v9, v9 row_ror:8 row_mask:0xf bank_mask:0xc
    v_add_f32_dpp v13, v10, v10 row_ror:8 row_mask:0xf bank_mask:0x3
    v_add_f32_dpp v13, v11, v11 row_ror:8 row_mask:0xf bank_mask:0xc
    v_dot2_f32_bf16 v8, v32, v4, 0
    v_dot2_f32_bf16 v9, v36, v4, 0
    v_dot2_f32_bf16 v10, v40, v4, 0
    v_dot2_f32_bf16 v11, v44, v4, 0
    v_add_f32_dpp v12, v12, v12 row_half_mirror row_mask:0xf bank_mask:0xf
    v_add_f32_dpp v13, v13, v13 row_half_mirror row_mask:0xf bank_mask:0xf
    v_dot2c_f32_bf16 v8, v33, v5
    v_dot2c_f32_bf16 v9, v37, v5
    v_dot2c_f32_bf16 v10, v41, v5
    v_dot2c_f32_bf16 v11, v45, v5
    v_add_f32_dpp v12, v12, v12 quad_perm:[1,0,3,2] row_mask:0xf bank_mask:0xf
    v_add_f32_dpp v13, v13, v13 quad_perm:[1,0,3,2] row_mask:0xf bank_mask:0xf
    v_dot2c_f32_bf16 v8, v34, v6
    v_dot2c_f32_bf16 v9, v38, v6
    v_dot2c_f32_bf16 v10, v42, v6
    v_dot2c_f32_bf16 v11, v46, v6
    v_add_f32_dpp v12, v12, v12 quad_perm:[2,3,0,1] row_mask:0xf bank_mask:0xf
    v_add_f32_dpp v13, v13, v13 quad_perm:[2,3,0,1] row_mask:0xf bank_mask:0xf
    v_dot2c_f32_bf16 v8, v35, v7
    v_dot2c_f32_bf16 v9, v39, v7
    v_dot2c_f32_bf16 v10, v43, v7
    v_dot2c_f32_bf16 v11, v47, v7
    s_waitcnt vmcnt(3)
    s_cmp_ge_u32 s48, 27
    s_cbranch_scc1 L_bo78
    s_waitcnt vmcnt(2)
L_bo78:
    s_add_u32 s98, s98, 28672
    s_cmp_eq_u32 s98, 258048
    s_cselect_b32 s98, 0, s98
    buffer_load_dwordx4 v[32:35], v1, s[40:43], s98 offen offset:0 nt
    v_add_f32_dpp v16, v8, v8 row_ror:8 row_mask:0xf bank_mask:0x3
    v_add_f32_dpp v16, v9, v9 row_ror:8 row_mask:0xf bank_mask:0xc
    v_add_f32_dpp v17, v10, v10 row_ror:8 row_mask:0xf bank_mask:0x3
    v_add_f32_dpp v17, v11, v11 row_ror:8 row_mask:0xf bank_mask:0xc
    v_dot2_f32_bf16 v8, v48, v4, 0
    v_dot2_f32_bf16 v9, v52, v4, 0
    v_dot2_f32_bf16 v10, v56, v4, 0
    v_dot2_f32_bf16 v11, v60, v4, 0
    v_add_f32_dpp v16, v16, v16 row_half_mirror row_mask:0xf bank_mask:0xf
    v_add_f32_dpp v17, v17, v17 row_half_mirror row_mask:0xf bank_mask:0xf
    v_dot2c_f32_bf16 v8, v49, v5
    v_dot2c_f32_bf16 v9, v53, v5
    v_dot2c_f32_bf16 v10, v57, v5
    v_dot2c_f32_bf16 v11, v61, v5
    v_add_f32_dpp v16, v16, v16 quad_perm:[1,0,3,2] row_mask:0xf bank_mask:0xf
    v_add_f32_dpp v17, v17, v17 quad_perm:[1,0,3,2] row_mask:0xf bank_mask:0xf
    v_dot2c_f32_bf16 v8, v50, v6
    v_dot2c_f32_bf16 v9, v54, v6
    v_dot2c_f32_bf16 v10, v58, v6
    v_dot2c_f32_bf16 v11, v62, v6
    v_add_f32_dpp v16, v16, v16 quad_perm:[2,3,0,1] row_mask:0xf bank_mask:0xf
    v_add_f32_dpp v17, v17, v17 quad_perm:[2,3,0,1] row_mask:0xf bank_mask:0xf
    v_dot2c_f32_bf16 v8, v51, v7
    v_dot2c_f32_bf16 v9, v55, v7
    v_dot2c_f32_bf16 v10, v59, v7
    v_dot2c_f32_bf16 v11, v63, v7
    v_add_f32_dpp v18, v8, v8 row_ror:8 row_mask:0xf bank_mask:0x3
    v_add_f32_dpp v18, v9, v9 row_ror:8 row_mask:0xf bank_mask:0xc
    v_add_f32_dpp v19, v10, v10 row_ror:8 row_mask:0xf bank_mask:0x3
    v_add_f32_dpp v19, v11, v11 row_ror:8 row_mask:0xf bank_mask:0xc
    v_dot2_f32_bf16 v8, v64, v4, 0
    v_dot2_f32_bf16 v9, v68, v4, 0
    v_dot2_f32_bf16 v10, v72, v4, 0
    v_dot2_f32_bf16 v11, v76, v4, 0
    v_add_f32_dpp v18, v18, v18 row_half_mirror row_mask:0xf bank_mask:0xf
    v_add_f32_dpp v19, v19, v19 row_half_mirror row_mask:0xf bank_mask:0xf
    v_dot2c_f32_bf16 v8, v65, v5
    v_dot2c_f32_bf16 v9, v69, v5
    v_dot2c_f32_bf16 v10, v73, v5
    v_dot2c_f32_bf16 v11, v77, v5
    v_add_f32_dpp v18, v18, v18 quad_perm:[1,0,3,2] row_mask:0xf bank_mask:0xf
    v_add_f32_dpp v19, v19, v19 quad_perm:[1,0,3,2] row_mask:0xf bank_mask:0xf
    v_dot2c_f32_bf16 v8, v66, v6
    v_dot2c_f32_bf16 v9, v70, v6
    v_mov_b32 v3, 99076
    ds_read_b32 v3, v3
    s_waitcnt vmcnt(3)
    s_cmp_ge_u32 s48, 28
    s_cbranch_scc1 L_bo79
    s_waitcnt vmcnt(2)
L_bo79:
    s_waitcnt lgkmcnt(0)
    v_readfirstlane_b32 s48, v3
    buffer_load_dwordx4 v[36:39], v1, s[40:43], s98 offen offset:1024 nt
    v_dot2c_f32_bf16 v10, v74, v6
    v_dot2c_f32_bf16 v11, v78, v6
    v_add_f32_dpp v18, v18, v18 quad_perm:[2,3,0,1] row_mask:0xf bank_mask:0xf
    v_add_f32_dpp v19, v19, v19 quad_perm:[2,3,0,1] row_mask:0xf bank_mask:0xf
    v_dot2c_f32_bf16 v8, v67, v7
    v_dot2c_f32_bf16 v9, v71, v7
    v_dot2c_f32_bf16 v10, v75, v7
    v_dot2c_f32_bf16 v11, v79, v7
    v_add_f32_dpp v20, v8, v8 row_ror:8 row_mask:0xf bank_mask:0x3
    v_add_f32_dpp v20, v9, v9 row_ror:8 row_mask:0xf bank_mask:0xc
    v_add_f32_dpp v21, v10, v10 row_ror:8 row_mask:0xf bank_mask:0x3
    v_add_f32_dpp v21, v11, v11 row_ror:8 row_mask:0xf bank_mask:0xc
    v_dot2_f32_bf16 v8, v80, v4, 0
    v_dot2_f32_bf16 v9, v84, v4, 0
    v_dot2_f32_bf16 v10, v88, v4, 0
    v_dot2_f32_bf16 v11, v92, v4, 0
    v_add_f32_dpp v20, v20, v20 row_half_mirror row_mask:0xf bank_mask:0xf
    v_add_f32_dpp v21, v21, v21 row_half_mirror row_mask:0xf bank_mask:0xf
    v_dot2c_f32_bf16 v8, v81, v5
    v_dot2c_f32_bf16 v9, v85, v5
    v_dot2c_f32_bf16 v10, v89, v5
    v_dot2c_f32_bf16 v11, v93, v5
    v_add_f32_dpp v20, v20, v20 quad_perm:[1,0,3,2] row_mask:0xf bank_mask:0xf
    v_add_f32_dpp v21, v21, v21 quad_perm:[1,0,3,2] row_mask:0xf bank_mask:0xf
    v_dot2c_f32_bf16 v8, v82, v6
    v_dot2c_f32_bf16 v9, v86, v6
    v_dot2c_f32_bf16 v10, v90, v6
    v_dot2c_f32_bf16 v11, v94, v6
    v_add_f32_dpp v20, v20, v20 quad_perm:[2,3,0,1] row_mask:0xf bank_mask:0xf
    v_add_f32_dpp v21, v21, v21 quad_perm:[2,3,0,1] row_mask:0xf bank_mask:0xf
    v_dot2c_f32_bf16 v8, v83, v7
    v_dot2c_f32_bf16 v9, v87, v7
    v_dot2c_f32_bf16 v10, v91, v7
    v_dot2c_f32_bf16 v11, v95, v7
    v_add_f32_dpp v22, v8, v8 row_ror:8 row_mask:0xf bank_mask:0x3
    v_add_f32_dpp v22, v9, v9 row_ror:8 row_mask:0xf bank_mask:0xc
    v_add_f32_dpp v23, v10, v10 row_ror:8 row_mask:0xf bank_mask:0x3
    v_add_f32_dpp v23, v11, v11 row_ror:8 row_mask:0xf bank_mask:0xc
    v_dot2_f32_bf16 v8, v96, v4, 0
    v_dot2_f32_bf16 v9, v100, v4, 0
    v_dot2_f32_bf16 v10, v104, v4, 0
    v_dot2_f32_bf16 v11, v108, v4, 0
    v_add_f32_dpp v22, v22, v22 row_half_mirror row_mask:0xf bank_mask:0xf
    v_add_f32_dpp v23, v23, v23 row_half_mirror row_mask:0xf bank_mask:0xf
    s_waitcnt vmcnt(3)
    s_cmp_ge_u32 s48, 16
    s_cbranch_scc1 L_bo80
    s_waitcnt vmcnt(2)
L_bo80:
    buffer_load_dwordx4 v[40:43], v1, s[40:43], s98 offen offset:2048 nt
    v_dot2c_f32_bf16 v8, v97, v5
    v_dot2c_f32_bf16 v9, v101, v5
    v_dot2c_f32_bf16 v10, v105, v5
    v_dot2c_f32_bf16 v11, v109, v5
    v_add_f32_dpp v22, v22, v22 quad_perm:[1,0,3,2] row_mask:0xf bank_mask:0xf
    v_add_f32_dpp v23, v23, v23 quad_perm:[1,0,3,2] row_mask:0xf bank_mask:0xf
    v_dot2c_f32_bf16 v8, v98, v6
    v_dot2c_f32_bf16 v9, v102, v6
    v_dot2c_f32_bf16 v10, v106, v6
    v_dot2c_f32_bf16 v11, v110, v6
    v_add_f32_dpp v22, v22, v22 quad_perm:[2,3,0,1] row_mask:0xf bank_mask:0xf
    v_add_f32_dpp v23, v23, v23 quad_perm:[2,3,0,1] row_mask:0xf bank_mask:0xf
    v_dot2c_f32_bf16 v8, v99, v7
    v_dot2c_f32_bf16 v9, v103, v7
    v_dot2c_f32_bf16 v10, v107, v7
    v_dot2c_f32_bf16 v11, v111, v7
    v_add_f32_dpp v24, v8, v8 row_ror:8 row_mask:0xf bank_mask:0x3
    v_add_f32_dpp v24, v9, v9 row_ror:8 row_mask:0xf bank_mask:0xc
    v_add_f32_dpp v25, v10, v10 row_ror:8 row_mask:0xf bank_mask:0x3
    v_add_f32_dpp v25, v11, v11 row_ror:8 row_mask:0xf bank_mask:0xc
    v_dot2_f32_bf16 v8, v112, v4, 0
    v_dot2_f32_bf16 v9, v116, v4, 0
    v_dot2_f32_bf16 v10, v120, v4, 0
    v_dot2_f32_bf16 v11, v124, v4, 0
    v_add_f32_dpp v24, v24, v24 row_half_mirror row_mask:0xf bank_mask:0xf
    v_add_f32_dpp v25, v25, v25 row_half_mirror row_mask:0xf bank_mask:0xf
    v_dot2c_f32_bf16 v8, v113, v5
    v_dot2c_f32_bf16 v9, v117, v5
    v_dot2c_f32_bf16 v10, v121, v5
    v_dot2c_f32_bf16 v11, v125, v5
    v_add_f32_dpp v24, v24, v24 quad_perm:[1,0,3,2] row_mask:0xf bank_mask:0xf
    v_add_f32_dpp v25, v25, v25 quad_perm:[1,0,3,2] row_mask:0xf bank_mask:0xf
    v_dot2c_f32_bf16 v8, v114, v6
    v_dot2c_f32_bf16 v9, v118, v6
    v_dot2c_f32_bf16 v10, v122, v6
    v_dot2c_f32_bf16 v11, v126, v6
    v_add_f32_dpp v24, v24, v24 quad_perm:[2,3,0,1] row_mask:0xf bank_mask:0xf
    v_add_f32_dpp v25, v25, v25 quad_perm:[2,3,0,1] row_mask:0xf bank_mask:0xf
    v_dot2c_f32_bf16 v8, v115, v7
    v_dot2c_f32_bf16 v9, v119, v7
    v_dot2c_f32_bf16 v10, v123, v7
    v_dot2c_f32_bf16 v11, v127, v7
    v_add_f32_dpp v26, v8, v8 row_ror:8 row_mask:0xf bank_mask:0x3
    v_add_f32_dpp v26, v9, v9 row_ror:8 row_mask:0xf bank_mask:0xc
    s_waitcnt vmcnt(3)
    s_cmp_ge_u32 s48, 17
    s_cbranch_scc1 L_bo81
    s_waitcnt vmcnt(2)
L_bo81:
    buffer_load_dwordx4 v[44:47], v1, s[40:43], s98 offen offset:3072 nt
    v_add_f32_dpp v27, v10, v10 row_ror:8 row_mask:0xf bank_mask:0x3
    v_add_f32_dpp v27, v11, v11 row_ror:8 row_mask:0xf bank_mask:0xc
    v_dot2_f32_bf16 v8, v128, v4, 0
    v_dot2_f32_bf16 v9, v132, v4, 0
    v_dot2_f32_bf16 v10, v136, v4, 0
    v_dot2_f32_bf16 v11, v140, v4, 0
    v_add_f32_dpp v26, v26, v26 row_half_mirror row_mask:0xf bank_mask:0xf
    v_add_f32_dpp v27, v27, v27 row_half_mirror row_mask:0xf bank_mask:0xf
    v_dot2c_f32_bf16 v8, v129, v5
    v_dot2c_f32_bf16 v9, v133, v5
    v_dot2c_f32_bf16 v10, v137, v5
    v_dot2c_f32_bf16 v11, v141, v5
    v_add_f32_dpp v26, v26, v26 quad_perm:[1,0,3,2] row_mask:0xf bank_mask:0xf
    v_add_f32_dpp v27, v27, v27 quad_perm:[1,0,3,2] row_mask:0xf bank_mask:0xf
    v_dot2c_f32_bf16 v8, v130, v6
    v_dot2c_f32_bf16 v9, v134, v6
    v_dot2c_f32_bf16 v10, v138, v6
    v_dot2c_f32_bf16 v11, v142, v6
    v_add_f32_dpp v26, v26, v26 quad_perm:[2,3,0,1] row_mask:0xf bank_mask:0xf
    v_add_f32_dpp v27, v27, v27 quad_perm:[2,3,0,1] row_mask:0xf bank_mask:0xf
    v_dot2c_f32_bf16 v8, v131, v7
    v_dot2c_f32_bf16 v9, v135, v7
    v_dot2c_f32_bf16 v10, v139, v7
    v_dot2c_f32_bf16 v11, v143, v7
    v_add_f32_dpp v28, v8, v8 row_ror:8 row_mask:0xf bank_mask:0x3
    v_add_f32_dpp v28, v9, v9 row_ror:8 row_mask:0xf bank_mask:0xc
    v_add_f32_dpp v29, v10, v10 row_ror:8 row_mask:0xf bank_mask:0x3
    v_add_f32_dpp v29, v11, v11 row_ror:8 row_mask:0xf bank_mask:0xc
    v_dot2_f32_bf16 v8, v144, v4, 0
    v_dot2_f32_bf16 v9, v148, v4, 0
    v_dot2_f32_bf16 v10, v152, v4, 0
    v_dot2_f32_bf16 v11, v156, v4, 0
    v_add_f32_dpp v28, v28, v28 row_half_mirror row_mask:0xf bank_mask:0xf
    v_add_f32_dpp v29, v29, v29 row_half_mirror row_mask:0xf bank_mask:0xf
    v_dot2c_f32_bf16 v8, v145, v5
    v_dot2c_f32_bf16 v9, v149, v5
    v_dot2c_f32_bf16 v10, v153, v5
    v_dot2c_f32_bf16 v11, v157, v5
    v_add_f32_dpp v28, v28, v28 quad_perm:[1,0,3,2] row_mask:0xf bank_mask:0xf
    v_add_f32_dpp v29, v29, v29 quad_perm:[1,0,3,2] row_mask:0xf bank_mask:0xf
    v_dot2c_f32_bf16 v8, v146, v6
    v_dot2c_f32_bf16 v9, v150, v6
    v_dot2c_f32_bf16 v10, v154, v6
    v_dot2c_f32_bf16 v11, v158, v6
    s_waitcnt vmcnt(3)
    s_cmp_ge_u32 s48, 19
    s_cbranch_scc1 L_bo82
    s_waitcnt vmcnt(2)
L_bo82:
    s_add_u32 s98, s98, 28672
    s_cmp_eq_u32 s98, 258048
    s_cselect_b32 s98, 0, s98
    buffer_load_dwordx4 v[48:51], v1, s[40:43], s98 offen offset:0 nt
    v_add_f32_dpp v28, v28, v28 quad_perm:[2,3,0,1] row_mask:0xf bank_mask:0xf
    v_add_f32_dpp v29, v29, v29 quad_perm:[2,3,0,1] row_mask:0xf bank_mask:0xf
    v_dot2c_f32_bf16 v8, v147, v7
    v_dot2c_f32_bf16 v9, v151, v7
    v_dot2c_f32_bf16 v10, v155, v7
    v_dot2c_f32_bf16 v11, v159, v7
    v_add_f32_dpp v30, v8, v8 row_ror:8 row_mask:0xf bank_mask:0x3
    v_add_f32_dpp v30, v9, v9 row_ror:8 row_mask:0xf bank_mask:0xc
    v_add_f32_dpp v31, v10, v10 row_ror:8 row_mask:0xf bank_mask:0x3
    v_add_f32_dpp v31, v11, v11 row_ror:8 row_mask:0xf bank_mask:0xc
    v_add_f32_dpp v30, v30, v30 row_half_mirror row_mask:0xf bank_mask:0xf
    s_nop 0
    v_add_f32_dpp v31, v31, v31 row_half_mirror row_mask:0xf bank_mask:0xf
    v_add_f32_dpp v30, v30, v30 quad_perm:[1,0,3,2] row_mask:0xf bank_mask:0xf
    s_nop 0
    v_add_f32_dpp v31, v31, v31 quad_perm:[1,0,3,2] row_mask:0xf bank_mask:0xf
    v_add_f32_dpp v30, v30, v30 quad_perm:[2,3,0,1] row_mask:0xf bank_mask:0xf
    s_nop 0
    v_add_f32_dpp v31, v31, v31 quad_perm:[2,3,0,1] row_mask:0xf bank_mask:0xf
    v_max3_f32 v8, v12, v13, v16
    v_max3_f32 v8, v8, v17, v18
    v_max3_f32 v8, v8, v19, v20
    v_max3_f32 v8, v8, v21, v22
    v_max3_f32 v8, v8, v23, v24
    v_max3_f32 v8, v8, v25, v26
    v_max3_f32 v8, v8, v27, v28
    v_max3_f32 v8, v8, v29, v30
    v_max_f32 v8, v8, v31
    s_mov_b32 s34, 0x3e0293ee
    s_nop 0
    v_max_f32_dpp v8, v8, v8 row_ror:8 row_mask:0xf bank_mask:0xf
    v_mov_b32 v9, v8
    s_nop 1
    v_permlane16_swap_b32 v8, v9
    v_max_f32 v8, v8, v9
    v_mov_b32 v9, v8
    s_nop 1
    v_permlane32_swap_b32 v8, v9
    v_max_f32 v8, v8, v9
    v_mul_f32 v8, s34, v8
    v_fma_f32 v12, v12, s34, -v8
    v_fma_f32 v13, v13, s34, -v8
    v_fma_f32 v16, v16, s34, -v8
    v_fma_f32 v17, v17, s34, -v8
    v_fma_f32 v18, v18, s34, -v8
    v_fma_f32 v19, v19, s34, -v8
    v_fma_f32 v20, v20, s34, -v8
    v_fma_f32 v21, v21, s34, -v8
    v_fma_f32 v22, v22, s34, -v8
    v_fma_f32 v23, v23, s34, -v8
    s_waitcnt vmcnt(3)
    s_cmp_ge_u32 s48, 20
    s_cbranch_scc1 L_bo83
    s_waitcnt vmcnt(2)
L_bo83:
    buffer_load_dwordx4 v[52:55], v1, s[40:43], s98 offen offset:1024 nt
    v_fma_f32 v24, v24, s34, -v8
    v_fma_f32 v25, v25, s34, -v8
    v_fma_f32 v26, v26, s34, -v8
    v_fma_f32 v27, v27, s34, -v8
    v_fma_f32 v28, v28, s34, -v8
    v_fma_f32 v29, v29, s34, -v8
    v_fma_f32 v30, v30, s34, -v8
    v_fma_f32 v31, v31, s34, -v8
    v_exp_f32 v12, v12
    v_exp_f32 v13, v13
    v_exp_f32 v16, v16
    v_exp_f32 v17, v17
    v_exp_f32 v18, v18
    v_exp_f32 v19, v19
    v_exp_f32 v20, v20
    v_exp_f32 v21, v21
    v_exp_f32 v22, v22
    v_exp_f32 v23, v23
    v_exp_f32 v24, v24
    v_exp_f32 v25, v25
    v_exp_f32 v26, v26
    v_exp_f32 v27, v27
    v_exp_f32 v28, v28
    v_exp_f32 v29, v29
    v_exp_f32 v30, v30
    v_exp_f32 v31, v31
    v_add_f32 v9, v12, v13
    v_add_f32 v9, v9, v16
    v_add_f32 v9, v9, v17
    v_add_f32 v9, v9, v18
    v_add_f32 v9, v9, v19
    v_add_f32 v9, v9, v20
    v_add_f32 v9, v9, v21
    v_add_f32 v9, v9, v22
    v_add_f32 v9, v9, v23
    v_add_f32 v9, v9, v24
    v_add_f32 v9, v9, v25
    v_add_f32 v9, v9, v26
    v_add_f32 v9, v9, v27
    v_add_f32 v9, v9, v28
    v_add_f32 v9, v9, v29
    v_add_f32 v9, v9, v30
    v_add_f32 v9, v9, v31
    v_and_b32 v10, 1, v0
    s_cmp_ge_u32 s48, 21
    s_cbranch_scc1 L_bo84
    s_waitcnt vmcnt(3)
L_bo84:
    buffer_load_dwordx4 v[56:59], v1, s[40:43], s98 offen offset:2048 nt
    v_lshlrev_b32 v10, 4, v10
    v_mov_b32 v11, 0xffff
    v_lshlrev_b32 v10, v10, v11
    v_bfe_u32 v11, v0, 1, 2
    v_cmp_eq_u32 vcc, 0, v11
    s_nop 1
    v_cndmask_b32 v144, 0, v10, vcc
    v_cmp_eq_u32 vcc, 1, v11
    s_nop 1
    v_cndmask_b32 v145, 0, v10, vcc
    v_cmp_eq_u32 vcc, 2, v11
    s_nop 1
    v_cndmask_b32 v146, 0, v10, vcc
    v_cmp_eq_u32 vcc, 3, v11
    s_nop 1
    v_cndmask_b32 v147, 0, v10, vcc
    v_add_f32_dpp v9, v9, v9 row_ror:8 row_mask:0xf bank_mask:0xf
    v_mov_b32 v10, v9
    s_nop 1
    v_permlane16_swap_b32 v9, v10
    v_add_f32 v9, v9, v10
    v_mov_b32 v10, v9
    s_nop 1
    v_permlane32_swap_b32 v9, v10
    v_add_f32 v9, v9, v10
    s_lshl_b32 s34, s3, 3
    s_add_u32 s34, s34, 98552
    v_mov_b32 v10, s34
    s_mov_b64 exec, 1
    ds_write_b64 v10, v[8:9]
    s_mov_b64 exec, -1
    s_lshl_b32 s34, s3, 10
    s_add_u32 s34, s34, 98304
    v_lshrrev_b32 v2, 4, v0
    v_and_b32 v11, 7, v0
    v_lshl_add_u32 v2, v2, 3, v11
    v_bfe_u32 v11, v0, 3, 1
    v_lshl_add_u32 v2, v11, 5, v2
    v_lshl_add_u32 v2, v2, 4, s34
    v_cvt_pk_bf16_f32 v10, v12, v12
    v_and_b32 v128, v10, v144
    v_and_b32 v129, v10, v145
    v_and_b32 v130, v10, v146
    v_and_b32 v131, v10, v147
    s_nop 1
    v_mfma_f32_16x16x32_bf16 v[148:151], v[160:163], v[128:131], 0
    v_mfma_f32_16x16x32_bf16 v[152:155], v[164:167], v[128:131], 0
    v_cvt_pk_bf16_f32 v10, v13, v13
    v_and_b32 v132, v10, v144
    v_and_b32 v133, v10, v145
    v_and_b32 v134, v10, v146
    v_and_b32 v135, v10, v147
    s_nop 1
    v_mfma_f32_16x16x32_bf16 v[148:151], v[168:171], v[132:135], v[148:151]
    s_waitcnt vmcnt(4)
    s_cmp_ge_u32 s48, 22
    s_cbranch_scc1 L_bo85
    s_waitcnt vmcnt(3)
L_bo85:
    buffer_load_dwordx4 v[60:63], v1, s[40:43], s98 offen offset:3072 nt
    v_mfma_f32_16x16x32_bf16 v[152:155], v[172:175], v[132:135], v[152:155]
    v_cvt_pk_bf16_f32 v10, v16, v16
    v_and_b32 v128, v10, v144
    v_and_b32 v129, v10, v145
    v_and_b32 v130, v10, v146
    v_and_b32 v131, v10, v147
    s_nop 1
    v_mfma_f32_16x16x32_bf16 v[148:151], v[176:179], v[128:131], v[148:151]
    v_mfma_f32_16x16x32_bf16 v[152:155], v[180:183], v[128:131], v[152:155]
    v_cvt_pk_bf16_f32 v10, v17, v17
    v_and_b32 v132, v10, v144
    v_and_b32 v133, v10, v145
    v_and_b32 v134, v10, v146
    v_and_b32 v135, v10, v147
    s_nop 1
    v_mfma_f32_16x16x32_bf16 v[148:151], v[184:187], v[132:135], v[148:151]
    v_mfma_f32_16x16x32_bf16 v[152:155], v[188:191], v[132:135], v[152:155]
    v_cvt_pk_bf16_f32 v10, v18, v18
    v_and_b32 v128, v10, v144
    v_and_b32 v129, v10, v145
    v_and_b32 v130, v10, v146
    v_and_b32 v131, v10, v147
    s_nop 1
    v_mfma_f32_16x16x32_bf16 v[148:151], v[192:195], v[128:131], v[148:151]
    v_mfma_f32_16x16x32_bf16 v[152:155], v[196:199], v[128:131], v[152:155]
    v_cvt_pk_bf16_f32 v10, v19, v19
    v_and_b32 v132, v10, v144
    v_and_b32 v133, v10, v145
    v_and_b32 v134, v10, v146
    v_and_b32 v135, v10, v147
    s_nop 1
    v_mfma_f32_16x16x32_bf16 v[148:151], v[200:203], v[132:135], v[148:151]
    v_mfma_f32_16x16x32_bf16 v[152:155], v[204:207], v[132:135], v[152:155]
    v_cvt_pk_bf16_f32 v10, v20, v20
    v_and_b32 v128, v10, v144
    v_and_b32 v129, v10, v145
    v_and_b32 v130, v10, v146
    v_and_b32 v131, v10, v147
    s_nop 1
    v_mfma_f32_16x16x32_bf16 v[148:151], v[208:211], v[128:131], v[148:151]
    v_mfma_f32_16x16x32_bf16 v[152:155], v[212:215], v[128:131], v[152:155]
    v_cvt_pk_bf16_f32 v10, v21, v21
    v_and_b32 v132, v10, v144
    v_and_b32 v133, v10, v145
    v_and_b32 v134, v10, v146
    v_and_b32 v135, v10, v147
    s_nop 1
    v_mfma_f32_16x16x32_bf16 v[148:151], v[216:219], v[132:135], v[148:151]
    v_mfma_f32_16x16x32_bf16 v[152:155], v[220:223], v[132:135], v[152:155]
    v_cvt_pk_bf16_f32 v10, v22, v22
    s_waitcnt vmcnt(4)
    s_cmp_ge_u32 s48, 23
    s_cbranch_scc1 L_bo86
    s_waitcnt vmcnt(3)
L_bo86:
    s_add_u32 s98, s98, 28672
    s_cmp_eq_u32 s98, 258048
    s_cselect_b32 s98, 0, s98
    buffer_load_dwordx4 v[64:67], v1, s[40:43], s98 offen offset:0 nt
    v_and_b32 v128, v10, v144
    v_and_b32 v129, v10, v145
    v_and_b32 v130, v10, v146
    v_and_b32 v131, v10, v147
    s_nop 1
    v_mfma_f32_16x16x32_bf16 v[148:151], v[224:227], v[128:131], v[148:151]
    v_mfma_f32_16x16x32_bf16 v[152:155], v[228:231], v[128:131], v[152:155]
    v_cvt_pk_bf16_f32 v10, v23, v23
    v_and_b32 v132, v10, v144
    v_and_b32 v133, v10, v145
    v_and_b32 v134, v10, v146
    v_and_b32 v135, v10, v147
    s_nop 1
    v_mfma_f32_16x16x32_bf16 v[148:151], v[232:235], v[132:135], v[148:151]
    v_mfma_f32_16x16x32_bf16 v[152:155], v[236:239], v[132:135], v[152:155]
    v_cvt_pk_bf16_f32 v10, v24, v24
    v_and_b32 v128, v10, v144
    v_and_b32 v129, v10, v145
    v_and_b32 v130, v10, v146
    v_and_b32 v131, v10, v147
    s_nop 1
    v_mfma_f32_16x16x32_bf16 v[148:151], v[240:243], v[128:131], v[148:151]
    v_mfma_f32_16x16x32_bf16 v[152:155], v[244:247], v[128:131], v[152:155]
    v_cvt_pk_bf16_f32 v10, v25, v25
    v_and_b32 v132, v10, v144
    v_and_b32 v133, v10, v145
    v_and_b32 v134, v10, v146
    v_and_b32 v135, v10, v147
    s_nop 1
    v_mfma_f32_16x16x32_bf16 v[148:151], v[248:251], v[132:135], v[148:151]
    v_mfma_f32_16x16x32_bf16 v[152:155], v[252:255], v[132:135], v[152:155]
    v_cvt_pk_bf16_f32 v10, v26, v26
    v_and_b32 v128, v10, v144
    v_and_b32 v129, v10, v145
    v_and_b32 v130, v10, v146
    v_and_b32 v131, v10, v147
    s_nop 1
    v_mfma_f32_16x16x32_bf16 v[148:151], v[32:35], v[128:131], v[148:151]
    v_mfma_f32_16x16x32_bf16 v[152:155], v[36:39], v[128:131], v[152:155]
    v_cvt_pk_bf16_f32 v10, v27, v27
    v_and_b32 v132, v10, v144
    v_and_b32 v133, v10, v145
    v_and_b32 v134, v10, v146
    v_and_b32 v135, v10, v147
    s_nop 1
    v_mfma_f32_16x16x32_bf16 v[148:151], v[40:43], v[132:135], v[148:151]
    v_mfma_f32_16x16x32_bf16 v[152:155], v[44:47], v[132:135], v[152:155]
    v_cvt_pk_bf16_f32 v10, v28, v28
    v_and_b32 v128, v10, v144
    v_and_b32 v129, v10, v145
    s_waitcnt vmcnt(4)
    s_cmp_ge_u32 s48, 24
    s_cbranch_scc1 L_bo87
    s_waitcnt vmcnt(3)
L_bo87:
    buffer_load_dwordx4 v[68:71], v1, s[40:43], s98 offen offset:1024 nt
    v_and_b32 v130, v10, v146
    v_and_b32 v131, v10, v147
    buffer_load_dwordx4 v[72:75], v1, s[40:43], s98 offen offset:2048 nt
    s_waitcnt vmcnt(5)
    buffer_load_dwordx4 v[76:79], v1, s[40:43], s98 offen offset:3072 nt
    s_barrier
    v_and_b32 v200, 3, v0
    v_bfe_u32 v201, v0, 2, 2
    v_lshrrev_b32 v202, 4, v0
    s_lshl_b32 s34, s3, 10
    s_add_u32 s34, s34, 122112
    v_mul_u32_u24 v203, 320, v201
    v_min_u32 v203, 704, v203
    v_lshl_add_u32 v203, v202, 6, v203
    v_lshl_add_u32 v203, v200, 4, v203
    v_add_u32 v203, s34, v203
    s_movk_i32 s48, 16384
    s_cmp_eq_u32 s63, 0
    s_cbranch_scc1 L_tp_wo
    s_cmp_eq_u32 s63, 1
    s_cbranch_scc1 L_tp_w1
    v_bfe_u32 v205, v0, 3, 2
    v_lshlrev_b32 v204, 3, v205
    v_lshrrev_b32 v205, 5, v0
    v_lshl_add_u32 v204, v205, 2, v204
    v_bfe_u32 v205, v0, 1, 2
    v_add_u32 v204, v204, v205
    v_and_b32 v205, 1, v0
    s_sub_u32 s49, s3, 1
    v_mul_u32_u24 v204, 1280, v204
    v_lshl_add_u32 v204, v205, 4, v204
    s_lshl_b32 s34, s62, 5
    s_mul_i32 s35, s49, 327680
    s_add_u32 s34, s34, s35
    v_add_u32 v204, s34, v204
    s_lshl_b32 s50, s49, 13
    s_add_u32 s50, s50, 40960
    v_lshl_add_u32 v205, v0, 3, s50
    s_lshl_b32 s34, s49, 8
    s_add_u32 s34, s34, s99
    s_add_u32 s34, s34, 791552
    s_cmp_eq_u32 s49, 6
    s_cselect_b32 s35, 1, 3
    v_lshlrev_b32 v6, 6, v202
    v_lshl_add_u32 v6, v200, 4, v6
    v_add_u32 v6, s34, v6
    v_lshl_add_u32 v4, v201, 15, v6
    v_min_u32 v5, s35, v201
    v_lshl_add_u32 v5, v5, 15, v6
    v_mov_b32 v7, 99084
    s_lshl_b32 s40, s62, 1
    s_add_u32 s41, s40, 8
    s_add_u32 s42, s40, 2
    s_branch L_tp_e
L_tp_w1:
    v_and_b32 v205, 15, v0
    v_lshlrev_b32 v205, 4, v205
    s_and_b32 s49, s3, 3
    s_mul_i32 s34, s49, 1280
    s_add_u32 s34, s34, s99
    s_add_u32 s34, s34, 786432
    v_lshl_add_u32 v206, v202, 15, v205
    v_add_u32 v206, s34, v206
    s_mul_i32 s34, s49, 3840
    v_add_u32 v205, s34, v205
    s_branch L_tp_e
L_tp_wo:
    s_lshr_b32 s49, s3, 1
    s_lshl_b32 s49, s49, 15
    v_and_b32 v210, 7, v0
    s_mul_i32 s34, s60, 4096
    s_add_u32 s34, s34, s49
    s_add_u32 s34, s34, 1179904
    v_lshrrev_b32 v211, 3, v0
    v_mul_u32_u24 v205, 512, v211
    v_add_u32 v204, s34, v205
    s_lshl_b32 s35, s51, 7
    s_add_u32 s34, s34, s35
    s_sub_u32 s34, s34, 256
    v_lshl_add_u32 v205, v210, 4, v205
    v_add_u32 v205, s34, v205
    s_lshl_b32 s34, s3, 12
    s_add_u32 s34, s34, 40960
    v_lshrrev_b32 v206, 2, v0
    v_lshlrev_b32 v206, 6, v206
    v_lshl_add_u32 v206, v200, 3, v206
    v_add_u32 v206, s34, v206
    s_mul_i32 s34, s3, 1152
    s_add_u32 s34, s34, 107520
    v_mul_u32_u24 v207, 144, v211
    v_lshl_add_u32 v207, v210, 4, v207
    v_add_u32 v207, s34, v207
    v_mul_u32_u24 v208, 144, v210
    v_lshl_add_u32 v208, v202, 4, v208
    v_add_u32 v208, s34, v208
    v_mul_u32_u24 v212, 144, v211
    v_add_u32 v212, s34, v212
    v_mul_u32_u24 v213, 144, v210
    v_add_u32 v213, s34, v213
    v_and_b32 v211, 1, v211
    v_bfe_u32 v203, v0, 1, 2
    v_mul_u32_u24 v203, 144, v203
    v_and_b32 v214, 1, v0
    v_mul_u32_u24 v214, 576, v214
    v_lshl_add_u32 v214, v211, 6, v214
    v_lshl_add_u32 v214, v202, 4, v214
    s_add_u32 s34, s34, 14592
    v_add3_u32 v203, v203, v214, s34
    v_mov_b32 v210, 98816
    v_cmp_eq_u32 vcc, 0, v211
    s_nop 1
    v_cndmask_b32 v209, v208, v210, vcc
    v_cndmask_b32 v208, v210, v208, vcc
L_tp_e:
    v_mfma_f32_16x16x32_bf16 v[148:151], v[48:51], v[128:131], v[148:151]
    v_mfma_f32_16x16x32_bf16 v[152:155], v[52:55], v[128:131], v[152:155]
    v_cvt_pk_bf16_f32 v10, v29, v29
    v_and_b32 v132, v10, v144
    v_and_b32 v133, v10, v145
    v_and_b32 v134, v10, v146
    v_and_b32 v135, v10, v147
    s_waitcnt vmcnt(4)
    s_nop 0
    v_mfma_f32_16x16x32_bf16 v[148:151], v[56:59], v[132:135], v[148:151]
    v_mfma_f32_16x16x32_bf16 v[152:155], v[60:63], v[132:135], v[152:155]
    v_cvt_pk_bf16_f32 v10, v30, v30
    v_and_b32 v128, v10, v144
    v_and_b32 v129, v10, v145
    v_and_b32 v130, v10, v146
    v_and_b32 v131, v10, v147
    s_waitcnt vmcnt(2)
    s_nop 0
    v_mfma_f32_16x16x32_bf16 v[148:151], v[64:67], v[128:131], v[148:151]
    v_mfma_f32_16x16x32_bf16 v[152:155], v[68:71], v[128:131], v[152:155]
    v_cvt_pk_bf16_f32 v10, v31, v31
    v_and_b32 v132, v10, v144
    v_and_b32 v133, v10, v145
    v_and_b32 v134, v10, v146
    v_and_b32 v135, v10, v147
    s_waitcnt vmcnt(0)
    s_nop 0
    v_mfma_f32_16x16x32_bf16 v[148:151], v[72:75], v[132:135], v[148:151]
    v_mfma_f32_16x16x32_bf16 v[152:155], v[76:79], v[132:135], v[152:155]
    s_nop 7
    v_add_f32_dpp v148, v152, v148 row_ror:8 row_mask:0xf bank_mask:0xf
    v_add_f32_dpp v149, v153, v149 row_ror:8 row_mask:0xf bank_mask:0xf
    v_add_f32_dpp v150, v154, v150 row_ror:8 row_mask:0xf bank_mask:0xf
    v_add_f32_dpp v151, v155, v151 row_ror:8 row_mask:0xf bank_mask:0xf
    ds_write_b128 v2, v[148:151]
    s_waitcnt lgkmcnt(0)
    s_barrier
    s_cmp_eq_u32 s63, 0
    s_cbranch_scc1 L_t_wo
    s_cmp_eq_u32 s63, 2
    s_cbranch_scc1 L_t_w2
    s_cmp_eq_u32 s63, 3
    s_cbranch_scc1 L_fin
    s_barrier
L_r_w1:
    s_cmp_lt_u32 s3, 4
    s_cbranch_scc1 L_w1_ln
    s_and_b32 s49, s3, 3
    s_lshl_b32 s42, s49, 11
    s_add_u32 s42, s42, 40960
    s_bitcmp1_b32 s62, 0
    s_cbranch_scc1 L_rot1
    s_add_u32 m0, s42, 0
    s_add_u32 s34, s50, 0
    buffer_load_dwordx4 v15, s[52:55], s34 offen  lds
    s_add_u32 m0, s42, 1024
    s_add_u32 s34, s50, 884736
    buffer_load_dwordx4 v15, s[52:55], s34 offen  lds
    s_add_u32 m0, s42, 8192
    s_add_u32 s34, s50, 110592
    buffer_load_dwordx4 v15, s[52:55], s34 offen  lds
    s_add_u32 m0, s42, 9216
    s_add_u32 s34, s50, 995328
    buffer_load_dwordx4 v15, s[52:55], s34 offen  lds
    s_add_u32 m0, s42, 32768
    s_add_u32 s34, s51, 0
    buffer_load_dwordx4 v15, s[52:55], s34 offen  lds
    s_add_u32 m0, s42, 33792
    s_add_u32 s34, s51, 13824
    buffer_load_dwordx4 v15, s[52:55], s34 offen  lds
    s_add_u32 m0, s42, 16384
    s_add_u32 s34, s50, 221184
    buffer_load_dwordx4 v15, s[52:55], s34 offen  lds
    s_add_u32 m0, s42, 17408
    s_add_u32 s34, s50, 1105920
    buffer_load_dwordx4 v15, s[52:55], s34 offen  lds
    s_add_u32 m0, s42, 24576
    s_add_u32 s34, s50, 331776
    buffer_load_dwordx4 v15, s[52:55], s34 offen  lds
    s_add_u32 m0, s42, 25600
    s_add_u32 s34, s50, 1216512
    buffer_load_dwordx4 v15, s[52:55], s34 offen  lds
    s_branch L_rot2
L_rot1:
    s_add_u32 m0, s42, 16384
    s_add_u32 s34, s50, 221184
    buffer_load_dwordx4 v15, s[52:55], s34 offen  lds
    s_add_u32 m0, s42, 17408
    s_add_u32 s34, s50, 1105920
    buffer_load_dwordx4 v15, s[52:55], s34 offen  lds
    s_add_u32 m0, s42, 24576
    s_add_u32 s34, s50, 331776
    buffer_load_dwordx4 v15, s[52:55], s34 offen  lds
    s_add_u32 m0, s42, 25600
    s_add_u32 s34, s50, 1216512
    buffer_load_dwordx4 v15, s[52:55], s34 offen  lds
    s_add_u32 m0, s42, 32768
    s_add_u32 s34, s51, 0
    buffer_load_dwordx4 v15, s[52:55], s34 offen  lds
    s_add_u32 m0, s42, 33792
    s_add_u32 s34, s51, 13824
    buffer_load_dwordx4 v15, s[52:55], s34 offen  lds
    s_add_u32 m0, s42, 0
    s_add_u32 s34, s50, 0
    buffer_load_dwordx4 v15, s[52:55], s34 offen  lds
    s_add_u32 m0, s42, 1024
    s_add_u32 s34, s50, 884736
    buffer_load_dwordx4 v15, s[52:55], s34 offen  lds
    s_add_u32 m0, s42, 8192
    s_add_u32 s34, s50, 110592
    buffer_load_dwordx4 v15, s[52:55], s34 offen  lds
    s_add_u32 m0, s42, 9216
    s_add_u32 s34, s50, 995328
    buffer_load_dwordx4 v15, s[52:55], s34 offen  lds
L_rot2:
    v_lshrrev_b32 v3, 2, v0
    v_lshlrev_b32 v3, 6, v3
    v_lshl_add_u32 v3, v200, 3, v3
    v_add_u32 v3, s42, v3
    s_lshl_b32 s35, s49, 6
    s_add_u32 s35, s35, 116736
    v_mul_u32_u24 v4, 1344, v200
    v_lshl_add_u32 v4, v202, 4, v4
    v_add_u32 v4, s35, v4
    s_lshl_b32 s35, s49, 10
    s_sub_u32 s35, s35, 4096
    v_add_u32 v5, s35, v203
    v_and_b32 v6, 1, v201
    v_mul_u32_u24 v6, 5376, v6
    v_add_u32 v6, v6, v4
    v_subrev_u32 v6, 90112, v6
    v_subrev_u32 v7, 22784, v5
    s_waitcnt vmcnt(0)
    s_barrier
    ds_read_b64_tr_b16 v[32:33], v3 offset:0
    ds_read_b64_tr_b16 v[34:35], v3 offset:1024
    ds_read_b64_tr_b16 v[36:37], v3 offset:32
    ds_read_b64_tr_b16 v[38:39], v3 offset:1056
    ds_read_b64_tr_b16 v[40:41], v3 offset:8192
    ds_read_b64_tr_b16 v[42:43], v3 offset:9216
    ds_read_b64_tr_b16 v[44:45], v3 offset:8224
    ds_read_b64_tr_b16 v[46:47], v3 offset:9248
    ds_read_b64_tr_b16 v[48:49], v3 offset:16384
    ds_read_b64_tr_b16 v[50:51], v3 offset:17408
    ds_read_b64_tr_b16 v[52:53], v3 offset:16416
    ds_read_b64_tr_b16 v[54:55], v3 offset:17440
    s_waitcnt lgkmcnt(4)
    ds_read_b64_tr_b16 v[56:57], v3 offset:24576
    ds_read_b64_tr_b16 v[58:59], v3 offset:25600
    ds_read_b64_tr_b16 v[60:61], v3 offset:24608
    ds_read_b64_tr_b16 v[62:63], v3 offset:25632
    ds_read_b64_tr_b16 v[64:65], v3 offset:32768
    ds_read_b64_tr_b16 v[66:67], v3 offset:33792
    ds_read_b64_tr_b16 v[68:69], v3 offset:32800
    ds_read_b64_tr_b16 v[70:71], v3 offset:33824
    s_waitcnt lgkmcnt(0)
    ds_read_b128 v[140:143], v6 offset:0
    ds_read_b128 v[144:147], v6 offset:256
    ds_read_b128 v[148:151], v6 offset:512
    ds_read_b128 v[152:155], v6 offset:768
    ds_read_b128 v[156:159], v6 offset:1024
    s_waitcnt lgkmcnt(4)
    v_mfma_f32_16x16x32_bf16 v[20:23], v[32:35], v[140:143], 0
    v_mfma_f32_16x16x32_bf16 v[24:27], v[36:39], v[140:143], 0
    s_waitcnt lgkmcnt(3)
    v_mfma_f32_16x16x32_bf16 v[20:23], v[40:43], v[144:147], v[20:23]
    v_mfma_f32_16x16x32_bf16 v[24:27], v[44:47], v[144:147], v[24:27]
    s_waitcnt lgkmcnt(2)
    v_mfma_f32_16x16x32_bf16 v[20:23], v[48:51], v[148:151], v[20:23]
    v_mfma_f32_16x16x32_bf16 v[24:27], v[52:55], v[148:151], v[24:27]
    s_waitcnt lgkmcnt(1)
    v_mfma_f32_16x16x32_bf16 v[20:23], v[56:59], v[152:155], v[20:23]
    v_mfma_f32_16x16x32_bf16 v[24:27], v[60:63], v[152:155], v[24:27]
    s_waitcnt lgkmcnt(0)
    v_mfma_f32_16x16x32_bf16 v[20:23], v[64:67], v[156:159], v[20:23]
    v_mfma_f32_16x16x32_bf16 v[24:27], v[68:71], v[156:159], v[24:27]
    s_nop 6
    ds_write_b128 v7, v[20:23]
    ds_write_b128 v7, v[24:27] offset:1024
    s_waitcnt lgkmcnt(0)
    s_setprio 3
    s_barrier
    ds_read_b128 v[140:143], v4 offset:0
    ds_read_b128 v[144:147], v4 offset:256
    ds_read_b128 v[148:151], v4 offset:512
    ds_read_b128 v[152:155], v4 offset:768
    ds_read_b128 v[156:159], v4 offset:1024
    s_waitcnt lgkmcnt(4)
    v_mfma_f32_16x16x32_bf16 v[20:23], v[32:35], v[140:143], 0
    v_mfma_f32_16x16x32_bf16 v[24:27], v[36:39], v[140:143], 0
    s_waitcnt lgkmcnt(3)
    v_mfma_f32_16x16x32_bf16 v[20:23], v[40:43], v[144:147], v[20:23]
    v_mfma_f32_16x16x32_bf16 v[24:27], v[44:47], v[144:147], v[24:27]
    s_waitcnt lgkmcnt(2)
    v_mfma_f32_16x16x32_bf16 v[20:23], v[48:51], v[148:151], v[20:23]
    v_mfma_f32_16x16x32_bf16 v[24:27], v[52:55], v[148:151], v[24:27]
    s_waitcnt lgkmcnt(1)
    v_mfma_f32_16x16x32_bf16 v[20:23], v[56:59], v[152:155], v[20:23]
    v_mfma_f32_16x16x32_bf16 v[24:27], v[60:63], v[152:155], v[24:27]
    s_waitcnt lgkmcnt(0)
    v_mfma_f32_16x16x32_bf16 v[20:23], v[64:67], v[156:159], v[20:23]
    v_mfma_f32_16x16x32_bf16 v[24:27], v[68:71], v[156:159], v[24:27]
    s_nop 6
    ds_write_b128 v5, v[20:23]
    ds_write_b128 v5, v[24:27] offset:1024
    s_waitcnt lgkmcnt(0)
    s_barrier
    s_branch L_fin
L_w1_ln:
    s_setprio 1
    ds_read_b128 v[140:143], v205 offset:0
    ds_read_b128 v[144:147], v205 offset:256
    ds_read_b128 v[148:151], v205 offset:512
    ds_read_b128 v[152:155], v205 offset:768
    ds_read_b128 v[156:159], v205 offset:1024
    ds_read_b128 v[160:163], v205 offset:1280
    ds_read_b128 v[164:167], v205 offset:1536
    ds_read_b128 v[168:171], v205 offset:1792
    ds_read_b128 v[172:175], v205 offset:2048
    ds_read_b128 v[176:179], v205 offset:2304
    ds_read_b128 v[180:183], v205 offset:2560
    ds_read_b128 v[184:187], v205 offset:2816
    ds_read_b128 v[188:191], v205 offset:3072
    ds_read_b128 v[192:195], v205 offset:3328
    ds_read_b128 v[196:199], v205 offset:3584
    v_and_b32 v8, 1, v0
    v_lshlrev_b32 v8, 4, v8
    v_mov_b32 v9, 0xffff
    v_lshlrev_b32 v8, v8, v9
    v_bfe_u32 v9, v0, 1, 2
    v_cmp_eq_u32 vcc, 0, v9
    s_nop 1
    v_cndmask_b32 v16, 0, v8, vcc
    v_cmp_eq_u32 vcc, 1, v9
    s_nop 1
    v_cndmask_b32 v17, 0, v8, vcc
    v_cmp_eq_u32 vcc, 2, v9
    s_nop 1
    v_cndmask_b32 v18, 0, v8, vcc
    v_cmp_eq_u32 vcc, 3, v9
    s_nop 1
    v_cndmask_b32 v19, 0, v8, vcc
    v_bfe_u32 v8, v0, 3, 1
    v_cmp_eq_u32 vcc, 0, v8
    s_nop 1
    v_cndmask_b32 v20, 0, v16, vcc
    v_xor_b32 v24, v20, v16
    v_cndmask_b32 v21, 0, v17, vcc
    v_xor_b32 v25, v21, v17
    v_cndmask_b32 v22, 0, v18, vcc
    v_xor_b32 v26, v22, v18
    v_cndmask_b32 v23, 0, v19, vcc
    v_xor_b32 v27, v23, v19
    v_and_b32 v52, 0x3f803f80, v20
    v_and_b32 v60, 0x3e803e80, v20
    v_and_b32 v53, 0x3f803f80, v21
    v_and_b32 v61, 0x3e803e80, v21
    v_and_b32 v54, 0x3f803f80, v22
    v_and_b32 v62, 0x3e803e80, v22
    v_and_b32 v55, 0x3f803f80, v23
    v_and_b32 v63, 0x3e803e80, v23
    v_and_b32 v56, 0x3f803f80, v24
    v_and_b32 v64, 0x3e803e80, v24
    v_and_b32 v57, 0x3f803f80, v25
    v_and_b32 v65, 0x3e803e80, v25
    v_and_b32 v58, 0x3f803f80, v26
    v_and_b32 v66, 0x3e803e80, v26
    v_and_b32 v59, 0x3f803f80, v27
    v_and_b32 v67, 0x3e803e80, v27
    s_waitcnt lgkmcnt(0)
    v_mfma_f32_16x16x32_bf16 v[68:71], v[140:143], v[60:63], 0
    v_mfma_f32_16x16x32_bf16 v[68:71], v[144:147], v[64:67], v[68:71]
    v_mfma_f32_16x16x32_bf16 v[72:75], v[148:151], v[60:63], 0
    v_mfma_f32_16x16x32_bf16 v[72:75], v[152:155], v[64:67], v[72:75]
    v_mfma_f32_16x16x32_bf16 v[76:79], v[156:159], v[60:63], 0
    v_mfma_f32_16x16x32_bf16 v[116:119], v[160:163], v[60:63], 0
    v_mfma_f32_16x16x32_bf16 v[116:119], v[164:167], v[64:67], v[116:119]
    v_mfma_f32_16x16x32_bf16 v[120:123], v[168:171], v[60:63], 0
    v_mfma_f32_16x16x32_bf16 v[120:123], v[172:175], v[64:67], v[120:123]
    v_mfma_f32_16x16x32_bf16 v[124:127], v[176:179], v[60:63], 0
    v_mfma_f32_16x16x32_bf16 v[80:83], v[180:183], v[60:63], 1.0
    v_mfma_f32_16x16x32_bf16 v[80:83], v[184:187], v[64:67], v[80:83]
    v_mfma_f32_16x16x32_bf16 v[84:87], v[188:191], v[60:63], 1.0
    v_mfma_f32_16x16x32_bf16 v[84:87], v[192:195], v[64:67], v[84:87]
    v_mfma_f32_16x16x32_bf16 v[88:91], v[196:199], v[60:63], 1.0
    s_mul_i32 s34, s3, 1344
    s_add_u32 s34, s34, 116736
    v_lshl_add_u32 v7, v0, 4, s34
    v_lshlrev_b32 v8, 6, v202
    v_lshl_add_u32 v8, v200, 4, v8
    v_and_b32 v9, 1, v201
    v_lshl_add_u32 v8, v9, 3, v8
    v_add_u32 v8, s34, v8
    v_bfe_u32 v9, v0, 3, 1
    v_mul_u32_u24 v9, 6144, v9
    v_sub_u32 v8, v8, v9
    v_lshrrev_b32 v9, 5, v0
    v_lshlrev_b32 v9, 10, v9
    v_and_b32 v6, 1, v202
    v_lshl_add_u32 v9, v6, 7, v9
    v_bfe_u32 v6, v0, 1, 1
    v_lshl_add_u32 v9, v6, 6, v9
    v_lshl_add_u32 v9, v201, 4, v9
    v_and_b32 v6, 1, v0
    v_lshl_add_u32 v9, v6, 3, v9
    v_add_u32 v9, 122112, v9
    s_lshr_b32 s34, s62, 3
    s_lshl_b32 s34, s34, 8
    s_and_b32 s49, s62, 3
    s_lshl_b32 s49, s49, 15
    s_add_u32 s34, s34, s49
    s_bfe_u32 s49, s62, 0x10002
    s_lshl_b32 s49, s49, 14
    s_add_u32 s34, s34, s49
    s_add_u32 s34, s34, 791552
    v_lshl_add_u32 v5, v0, 2, s34
    s_bfe_u32 s49, s60, 0x10002
    s_lshl_b32 s49, s49, 13
    s_xor_b32 s53, s99, s49
    s_xor_b32 s52, s53, 8192
    v_subrev_u32 v10, 90112, v7
    v_subrev_u32 v11, 90112, v8
    v_cvt_pk_bf16_f32 v32, v116, v117
    v_cvt_pk_bf16_f32 v33, v118, v119
    v_cvt_pk_bf16_f32 v34, v120, v121
    v_cvt_pk_bf16_f32 v35, v122, v123
    v_cvt_pk_bf16_f32 v36, v124, v125
    v_cvt_pk_bf16_f32 v37, v126, v127
    s_mov_b32 exec_lo, 0x00ff00ff
    s_mov_b32 exec_hi, 0x00ff00ff
    ds_write_b64 v11, v[36:37] offset:6400
    s_mov_b64 exec, -1
    ds_write_b128 v10, v[32:35] offset:5376
    v_cvt_pk_bf16_f32 v20, v80, v81
    v_cvt_pk_bf16_f32 v21, v82, v83
    v_cvt_pk_bf16_f32 v22, v84, v85
    v_cvt_pk_bf16_f32 v23, v86, v87
    v_cvt_pk_bf16_f32 v24, v88, v89
    v_cvt_pk_bf16_f32 v25, v90, v91
    ds_write_b128 v10, v[20:23]
    ds_write_b64 v11, v[24:25] offset:1024
    v_lshlrev_b32 v80, 16, v20
    v_and_b32 v81, 0xffff0000, v20
    v_lshlrev_b32 v82, 16, v21
    v_and_b32 v83, 0xffff0000, v21
    v_lshlrev_b32 v84, 16, v22
    v_and_b32 v85, 0xffff0000, v22
    v_lshlrev_b32 v86, 16, v23
    v_and_b32 v87, 0xffff0000, v23
    v_lshlrev_b32 v88, 16, v24
    v_and_b32 v89, 0xffff0000, v24
    v_lshlrev_b32 v90, 16, v25
    v_and_b32 v91, 0xffff0000, v25
    v_subrev_u32 v11, 22784, v9
    s_lshl_b32 s34, s3, 3
    s_add_u32 s34, s34, 99136
    v_mov_b32 v12, s34
    v_lshlrev_b32 v13, 3, v201
    v_add_u32 v13, 99136, v13
    s_mov_b32 s54, 0
    s_brev_b32 s55, 1
    s_waitcnt lgkmcnt(0)
    s_barrier
    s_mov_b32 s35, 0
    s_mov_b64 s[40:41], -1
    s_mov_b64 s[42:43], -1
L_pb:
    s_mov_b64 exec, s[40:41]
    s_cbranch_execz L_pbs0
    buffer_load_dwordx4 v[140:143], v206, s[44:47], 0 offen offset:0 sc1
    buffer_load_dwordx4 v[148:151], v206, s[44:47], 0 offen offset:256 sc1
    buffer_load_dwordx4 v[156:159], v206, s[44:47], 0 offen offset:512 sc1
    buffer_load_dwordx4 v[164:167], v206, s[44:47], 0 offen offset:768 sc1
    buffer_load_dwordx4 v[172:175], v206, s[44:47], 0 offen offset:1024 sc1
L_pbs0:
    s_mov_b64 exec, s[42:43]
    s_cbranch_execz L_pbs1
    buffer_load_dwordx4 v[144:147], v206, s[44:47], s48 offen offset:0 sc1
    buffer_load_dwordx4 v[152:155], v206, s[44:47], s48 offen offset:256 sc1
    buffer_load_dwordx4 v[160:163], v206, s[44:47], s48 offen offset:512 sc1
    buffer_load_dwordx4 v[168:171], v206, s[44:47], s48 offen offset:768 sc1
    buffer_load_dwordx4 v[176:179], v206, s[44:47], s48 offen offset:1024 sc1
L_pbs1:
    s_mov_b64 exec, -1
    s_add_u32 s35, s35, 1
    s_waitcnt vmcnt(0)
    v_mfma_f32_16x16x32_bf16 v[128:131], v[140:143], v[52:55], v[68:71]
    v_max3_u32 v28, v140, v141, v142
    v_max3_u32 v29, v144, v145, v146
    v_mfma_f32_16x16x32_bf16 v[128:131], v[144:147], v[52:55], v[128:131]
    v_max3_u32 v28, v28, v143, v148
    v_max3_u32 v29, v29, v147, v152
    v_mfma_f32_16x16x32_bf16 v[128:131], v[148:151], v[56:59], v[128:131]
    v_max3_u32 v28, v28, v149, v150
    v_max3_u32 v29, v29, v153, v154
    v_mfma_f32_16x16x32_bf16 v[128:131], v[152:155], v[56:59], v[128:131]
    v_max3_u32 v28, v28, v151, v156
    v_max3_u32 v29, v29, v155, v160
    v_mfma_f32_16x16x32_bf16 v[132:135], v[156:159], v[52:55], v[72:75]
    v_max3_u32 v28, v28, v157, v158
    v_max3_u32 v29, v29, v161, v162
    v_mfma_f32_16x16x32_bf16 v[132:135], v[160:163], v[52:55], v[132:135]
    v_max3_u32 v28, v28, v159, v164
    v_max3_u32 v29, v29, v163, v168
    v_mfma_f32_16x16x32_bf16 v[132:135], v[164:167], v[56:59], v[132:135]
    v_max3_u32 v28, v28, v165, v166
    v_max3_u32 v29, v29, v169, v170
    v_mfma_f32_16x16x32_bf16 v[132:135], v[168:171], v[56:59], v[132:135]
    v_max3_u32 v28, v28, v167, v172
    v_max3_u32 v29, v29, v171, v176
    v_mfma_f32_16x16x32_bf16 v[136:139], v[172:175], v[52:55], v[76:79]
    v_max3_u32 v28, v28, v173, v174
    v_max3_u32 v29, v29, v177, v178
    v_mfma_f32_16x16x32_bf16 v[136:139], v[176:179], v[52:55], v[136:139]
    v_max_u32 v28, v28, v175
    v_max_u32 v29, v29, v179
    v_cmp_eq_u32 s[40:41], -1, v28
    v_cmp_eq_u32 s[42:43], -1, v29
    s_nop 0
    s_or_b64 vcc, s[40:41], s[42:43]
    s_cbranch_scc0 L_pbd
    s_cmp_lg_u32 s35, 64
    s_cbranch_scc1 L_tmo88
    s_mov_b64 exec, -1
    v_lshlrev_b32 v243, 4, v0
    v_add_u32 v243, 131328, v243
    ds_read_b96 v[240:242], v243
    s_waitcnt lgkmcnt(0)
    buffer_store_dword v240, v242, s[44:47], 0 offen sc1
    buffer_store_dword v241, v242, s[44:47], 0 offen offset:256 sc1
L_tmo88:
    s_cmp_lt_u32 s35, 60000
    s_cbranch_scc1 L_pb
L_pbd:
    v_pk_mul_f32 v[32:33], v[128:129], v[80:81]
    v_pk_mul_f32 v[34:35], v[130:131], v[82:83]
    v_pk_mul_f32 v[36:37], v[132:133], v[84:85]
    v_pk_mul_f32 v[38:39], v[134:135], v[86:87]
    v_cvt_pk_bf16_f32 v24, v32, v33
    v_cvt_pk_bf16_f32 v25, v34, v35
    v_cvt_pk_bf16_f32 v26, v36, v37
    v_cvt_pk_bf16_f32 v27, v38, v39
    ds_write_b128 v7, v[24:27]
    v_pk_mul_f32 v[40:41], v[136:137], v[88:89]
    v_pk_mul_f32 v[42:43], v[138:139], v[90:91]
    v_cvt_pk_bf16_f32 v28, v40, v41
    v_cvt_pk_bf16_f32 v29, v42, v43
    ds_write_b64 v8, v[28:29] offset:1024
    v_pk_add_f32 v[20:21], v[128:129], v[130:131]
    v_pk_mul_f32 v[22:23], v[128:129], v[128:129]
    v_pk_add_f32 v[20:21], v[20:21], v[132:133]
    v_pk_fma_f32 v[22:23], v[130:131], v[130:131], v[22:23]
    v_pk_add_f32 v[20:21], v[20:21], v[134:135]
    v_pk_fma_f32 v[22:23], v[132:133], v[132:133], v[22:23]
    v_pk_add_f32 v[20:21], v[20:21], v[136:137]
    v_pk_fma_f32 v[22:23], v[134:135], v[134:135], v[22:23]
    v_pk_add_f32 v[20:21], v[20:21], v[138:139]
    v_pk_fma_f32 v[22:23], v[136:137], v[136:137], v[22:23]
    v_pk_fma_f32 v[22:23], v[138:139], v[138:139], v[22:23]
    s_waitcnt lgkmcnt(0)
    s_barrier
    v_add_f32 v20, v20, v21
    v_add_f32 v21, v22, v23
    s_nop 0
    v_add_f32_dpp v20, v20, v20 row_ror:8 row_mask:0xf bank_mask:0xf
    v_add_f32_dpp v21, v21, v21 row_ror:8 row_mask:0xf bank_mask:0xf
    s_nop 0
    v_add_f32_dpp v20, v20, v20 row_ror:4 row_mask:0xf bank_mask:0xf
    v_add_f32_dpp v21, v21, v21 row_ror:4 row_mask:0xf bank_mask:0xf
    s_nop 0
    v_add_f32_dpp v20, v20, v20 row_ror:2 row_mask:0xf bank_mask:0xf
    v_add_f32_dpp v21, v21, v21 row_ror:2 row_mask:0xf bank_mask:0xf
    s_nop 0
    v_add_f32_dpp v20, v20, v20 row_ror:1 row_mask:0xf bank_mask:0xf
    v_add_f32_dpp v21, v21, v21 row_ror:1 row_mask:0xf bank_mask:0xf
    s_nop 0
    v_add_f32_dpp v20, v20, v20 row_bcast:15 row_mask:0xa bank_mask:0xf
    v_add_f32_dpp v21, v21, v21 row_bcast:15 row_mask:0xa bank_mask:0xf
    s_nop 0
    v_add_f32_dpp v20, v20, v20 row_bcast:31 row_mask:0xc bank_mask:0xf
    v_add_f32_dpp v21, v21, v21 row_bcast:31 row_mask:0xc bank_mask:0xf
    v_mul_f32 v22, 0x3acccccd, v20
    v_mul_f32 v21, 0x3acccccd, v21
    v_fma_f32 v21, -v22, v22, v21
    v_max_f32 v21, 0, v21
    v_add_f32 v21, 0x3727c5ac, v21
    v_rsq_f32 v20, v21
    s_nop 0
    v_mul_f32_e64 v21, -v22, v20
    s_mov_b64 exec, s[54:55]
    ds_write_b64 v12, v[20:21]
    s_mov_b64 exec, -1
    s_cmp_lg_u32 s3, 0
    s_cbranch_scc1 L_w1_x
    ds_read_b64 v[32:33], v11 offset:0
    ds_read_b64 v[40:41], v11 offset:320
    ds_read_b64 v[34:35], v11 offset:2048
    ds_read_b64 v[42:43], v11 offset:2368
    ds_read_b64 v[36:37], v11 offset:4096
    ds_read_b64 v[44:45], v11 offset:4416
    ds_read_b64 v[38:39], v11 offset:6144
    ds_read_b64 v[46:47], v11 offset:6464
    s_mov_b32 s34, 0xbdd2d3e8
    v_mov_b32 v10, 0xc0135761
    s_waitcnt lgkmcnt(8)
    s_barrier
    ds_read_b64 v[28:29], v13
    ds_read_b64 v[20:21], v9 offset:0
    ds_read_b64 v[22:23], v9 offset:2048
    ds_read_b64 v[24:25], v9 offset:4096
    ds_read_b64 v[26:27], v9 offset:6144
    s_waitcnt lgkmcnt(5)
    v_pk_add_f32 v[100:101], v[100:101], v[40:41]
    v_pk_add_f32 v[100:101], v[100:101], v[42:43]
    v_pk_add_f32 v[32:33], v[32:33], v[34:35]
    v_pk_add_f32 v[100:101], v[100:101], v[44:45]
    v_pk_add_f32 v[32:33], v[32:33], v[36:37]
    v_pk_add_f32 v[100:101], v[100:101], v[46:47]
    v_pk_add_f32 v[32:33], v[32:33], v[38:39]
    s_waitcnt lgkmcnt(4)
    v_pk_fma_f32 v[100:101], v[32:33], v[28:29], v[100:101] op_sel:[0,1,0] op_sel_hi:[1,1,1]
    s_waitcnt lgkmcnt(3)
    v_pk_fma_f32 v[100:101], v[20:21], v[28:29], v[100:101] op_sel_hi:[1,0,1]
    s_waitcnt lgkmcnt(2)
    v_pk_fma_f32 v[100:101], v[22:23], v[28:29], v[100:101] op_sel_hi:[1,0,1]
    s_waitcnt lgkmcnt(1)
    v_pk_fma_f32 v[100:101], v[24:25], v[28:29], v[100:101] op_sel_hi:[1,0,1]
    s_waitcnt lgkmcnt(0)
    v_pk_fma_f32 v[100:101], v[26:27], v[28:29], v[100:101] op_sel_hi:[1,0,1]
    v_pk_mul_f32 v[20:21], v[100:101], v[100:101]
    v_fma_f32 v20, v20, s34, v10
    v_fma_f32 v21, v21, s34, v10
    v_pk_mul_f32 v[20:21], v[20:21], v[100:101]
    v_exp_f32 v20, v20
    v_exp_f32 v21, v21
    v_add_f32 v20, 1.0, v20
    v_add_f32 v21, 1.0, v21
    v_rcp_f32 v20, v20
    v_rcp_f32 v21, v21
    s_nop 0
    v_pk_mul_f32 v[20:21], v[20:21], v[100:101]
    v_cvt_pk_bf16_f32 v20, v20, v21
    v_min_u32 v20, -2, v20
    buffer_store_dword v20, v5, s[44:47], s52 offen sc1
    buffer_store_dword v20, v5, s[44:47], s53 offen sc1
    s_branch L_fin
L_w1_x:
    s_waitcnt lgkmcnt(0)
    s_barrier
    s_branch L_fin
L_t_w2:
    s_barrier
L_w2_dma:
    s_and_b32 s34, s40, 7
    s_lshl_b32 s35, s34, 10
    s_add_u32 m0, s50, s35
    s_mul_i32 s34, s34, 40960
    buffer_load_dwordx4 v204, s[52:55], s34 offen  lds
    s_add_u32 s40, s40, 1
    s_cmp_lg_u32 s40, s42
    s_cbranch_scc1 L_w2_nw
L_w2_nw:
    s_cmp_lt_u32 s40, s41
    s_cbranch_scc1 L_w2_dma
    ds_read_b32 v8, v7
    s_waitcnt lgkmcnt(0)
    v_cmp_eq_u32 vcc, 0, v8
    s_cbranch_vccnz L_w2_slow
    s_mov_b32 s35, 0
    buffer_load_dwordx4 v[64:67], v4, s[44:47], 0 offen sc1
    buffer_load_dwordx4 v[68:71], v5, s[44:47], s48 offen sc1
    s_waitcnt vmcnt(2)
    ds_read_b64_tr_b16 v[32:33], v205 offset:0
    ds_read_b64_tr_b16 v[34:35], v205 offset:512
    ds_read_b64_tr_b16 v[36:37], v205 offset:1024
    ds_read_b64_tr_b16 v[38:39], v205 offset:1536
    ds_read_b64_tr_b16 v[40:41], v205 offset:2048
    ds_read_b64_tr_b16 v[42:43], v205 offset:2560
    ds_read_b64_tr_b16 v[44:45], v205 offset:3072
    ds_read_b64_tr_b16 v[46:47], v205 offset:3584
    s_waitcnt lgkmcnt(0)
    ds_read_b64_tr_b16 v[48:49], v205 offset:4096
    ds_read_b64_tr_b16 v[50:51], v205 offset:4608
    ds_read_b64_tr_b16 v[52:53], v205 offset:5120
    ds_read_b64_tr_b16 v[54:55], v205 offset:5632
    ds_read_b64_tr_b16 v[56:57], v205 offset:6144
    ds_read_b64_tr_b16 v[58:59], v205 offset:6656
    ds_read_b64_tr_b16 v[60:61], v205 offset:7168
    ds_read_b64_tr_b16 v[62:63], v205 offset:7680
    s_waitcnt lgkmcnt(0)
    s_branch L_w2_mid
L_w2_slow:
    s_waitcnt vmcnt(0)
    ds_read_b64_tr_b16 v[32:33], v205 offset:0
    ds_read_b64_tr_b16 v[34:35], v205 offset:512
    ds_read_b64_tr_b16 v[36:37], v205 offset:1024
    ds_read_b64_tr_b16 v[38:39], v205 offset:1536
    ds_read_b64_tr_b16 v[40:41], v205 offset:2048
    ds_read_b64_tr_b16 v[42:43], v205 offset:2560
    ds_read_b64_tr_b16 v[44:45], v205 offset:3072
    ds_read_b64_tr_b16 v[46:47], v205 offset:3584
    s_waitcnt lgkmcnt(0)
    ds_read_b64_tr_b16 v[48:49], v205 offset:4096
    ds_read_b64_tr_b16 v[50:51], v205 offset:4608
    ds_read_b64_tr_b16 v[52:53], v205 offset:5120
    ds_read_b64_tr_b16 v[54:55], v205 offset:5632
    ds_read_b64_tr_b16 v[56:57], v205 offset:6144
    ds_read_b64_tr_b16 v[58:59], v205 offset:6656
    ds_read_b64_tr_b16 v[60:61], v205 offset:7168
    ds_read_b64_tr_b16 v[62:63], v205 offset:7680
    s_waitcnt lgkmcnt(0)
    s_mov_b32 s35, 0
L_poll89:
    ds_read_b32 v8, v7
    s_add_u32 s35, s35, 1
    s_waitcnt lgkmcnt(0)
    v_cmp_eq_u32 vcc, 0, v8
    s_cbranch_vccz L_done90
    s_sleep 1
    s_cmp_lt_u32 s35, 60000
    s_cbranch_scc1 L_poll89
L_done90:
    s_mov_b32 s35, 0
L_poll92:
    buffer_load_dwordx4 v[64:67], v4, s[44:47], 0 offen sc1
    buffer_load_dwordx4 v[68:71], v5, s[44:47], s48 offen sc1
L_w2_mid:
    s_add_u32 s35, s35, 1
    s_waitcnt vmcnt(0)
    v_max3_u32 v28, v64, v65, v66
    v_max3_u32 v28, v28, v67, v68
    v_max3_u32 v28, v28, v69, v70
    v_max_u32 v28, v28, v71
    v_cmp_eq_u32 vcc, -1, v28
    s_cbranch_vccz L_done93
    s_cmp_lg_u32 s35, 64
    s_cbranch_scc1 L_tmo95
    s_mov_b64 exec, -1
    v_lshlrev_b32 v243, 4, v0
    v_add_u32 v243, 131328, v243
    ds_read_b96 v[240:242], v243
    s_waitcnt lgkmcnt(0)
    buffer_store_dword v240, v242, s[44:47], 0 offen sc1
    buffer_store_dword v241, v242, s[44:47], 0 offen offset:256 sc1
L_tmo95:
    s_cmp_lt_u32 s35, 60000
    s_cbranch_scc1 L_poll92
L_done93:
    v_mfma_f32_16x16x32_bf16 v[80:83], v[32:35], v[64:67], 0
    v_mfma_f32_16x16x32_bf16 v[80:83], v[48:51], v[68:71], v[80:83]
    v_mfma_f32_16x16x32_bf16 v[84:87], v[36:39], v[64:67], 0
    v_mfma_f32_16x16x32_bf16 v[84:87], v[52:55], v[68:71], v[84:87]
    v_mfma_f32_16x16x32_bf16 v[88:91], v[40:43], v[64:67], 0
    v_mfma_f32_16x16x32_bf16 v[88:91], v[56:59], v[68:71], v[88:91]
    v_mfma_f32_16x16x32_bf16 v[92:95], v[44:47], v[64:67], 0
    v_mfma_f32_16x16x32_bf16 v[92:95], v[60:63], v[68:71], v[92:95]
    s_nop 3
    v_add_f32_dpp v80, v84, v80 row_shl:4 row_mask:0xf bank_mask:0x1
    v_add_f32_dpp v81, v85, v81 row_shl:4 row_mask:0xf bank_mask:0x1
    v_add_f32_dpp v82, v86, v82 row_shl:4 row_mask:0xf bank_mask:0x1
    v_add_f32_dpp v83, v87, v83 row_shl:4 row_mask:0xf bank_mask:0x1
    v_add_f32_dpp v80, v88, v80 row_shl:8 row_mask:0xf bank_mask:0x1
    v_add_f32_dpp v81, v89, v81 row_shl:8 row_mask:0xf bank_mask:0x1
    v_add_f32_dpp v82, v90, v82 row_shl:8 row_mask:0xf bank_mask:0x1
    v_add_f32_dpp v83, v91, v83 row_shl:8 row_mask:0xf bank_mask:0x1
    v_add_f32_dpp v80, v92, v80 row_shl:12 row_mask:0xf bank_mask:0x1
    v_add_f32_dpp v81, v93, v81 row_shl:12 row_mask:0xf bank_mask:0x1
    v_add_f32_dpp v82, v94, v82 row_shl:12 row_mask:0xf bank_mask:0x1
    v_add_f32_dpp v83, v95, v83 row_shl:12 row_mask:0xf bank_mask:0x1
    ds_write_b128 v203, v[80:83]
    s_waitcnt lgkmcnt(0)
    s_barrier
    s_branch L_fin
L_w2_red:
    s_mov_b32 s35, 0
L_poll96:
    buffer_load_dwordx2 v[20:21], v204, s[44:47], 0 offen sc1
    buffer_load_dwordx2 v[22:23], v204, s[44:47], s48 offen sc1
    s_add_u32 s35, s35, 1
    s_waitcnt vmcnt(0)
    v_max3_u32 v28, v20, v21, v22
    v_max_u32 v28, v28, v23
    v_cmp_eq_u32 vcc, -1, v28
    s_cbranch_vccz L_done97
    s_cmp_lg_u32 s35, 21
    s_cbranch_scc1 L_tmo99
    s_mov_b64 exec, -1
    v_lshlrev_b32 v243, 4, v0
    v_add_u32 v243, 131328, v243
    ds_read_b96 v[240:242], v243
    s_waitcnt lgkmcnt(0)
    buffer_store_dword v240, v242, s[44:47], 0 offen sc1
    buffer_store_dword v241, v242, s[44:47], 0 offen offset:256 sc1
L_tmo99:
    s_sleep 6
    s_cmp_lt_u32 s35, 60000
    s_cbranch_scc1 L_poll96
L_done97:
    v_mov_b32 v7, 99084
    ds_write_b32 v7, v7
    v_lshlrev_b32 v44, 16, v20
    v_and_b32 v45, 0xffff0000, v20
    v_lshlrev_b32 v46, 16, v21
    v_and_b32 v47, 0xffff0000, v21
    v_lshlrev_b32 v48, 16, v22
    v_and_b32 v49, 0xffff0000, v22
    v_lshlrev_b32 v50, 16, v23
    v_and_b32 v51, 0xffff0000, v23
    v_add_f32 v108, v108, v44
    v_add_f32 v109, v109, v45
    v_add_f32 v110, v110, v46
    v_add_f32 v111, v111, v47
    v_add_f32 v108, v108, v48
    v_add_f32 v109, v109, v49
    v_add_f32 v110, v110, v50
    v_add_f32 v111, v111, v51
    s_mov_b32 s36, s28
    s_mov_b32 s37, s29
    s_movk_i32 s38, 5120
    v_add_f32_dpp v108, v108, v108 row_ror:4 row_mask:0xf bank_mask:0xf
    v_add_f32_dpp v109, v109, v109 row_ror:4 row_mask:0xf bank_mask:0xf
    v_add_f32_dpp v110, v110, v110 row_ror:4 row_mask:0xf bank_mask:0xf
    v_add_f32_dpp v111, v111, v111 row_ror:4 row_mask:0xf bank_mask:0xf
    v_add_f32_dpp v108, v108, v108 row_ror:8 row_mask:0xf bank_mask:0xf
    v_add_f32_dpp v109, v109, v109 row_ror:8 row_mask:0xf bank_mask:0xf
    v_add_f32_dpp v110, v110, v110 row_ror:8 row_mask:0xf bank_mask:0xf
    v_add_f32_dpp v111, v111, v111 row_ror:8 row_mask:0xf bank_mask:0xf
    v_mov_b32_dpp v108, v104 quad_perm:[0,1,2,3] row_mask:0xf bank_mask:0x2
    v_mov_b32_dpp v109, v105 quad_perm:[0,1,2,3] row_mask:0xf bank_mask:0x2
    v_mov_b32_dpp v110, v106 quad_perm:[0,1,2,3] row_mask:0xf bank_mask:0x2
    v_mov_b32_dpp v111, v107 quad_perm:[0,1,2,3] row_mask:0xf bank_mask:0x2
    ds_write_b128 v203, v[108:111]
    v_and_b32 v6, 31, v0
    v_lshlrev_b32 v6, 3, v6
    v_add_u32 v6, 122112, v6
    ds_read_b64 v[108:109], v6
    ds_read_b64 v[104:105], v6 offset:320
    v_bfe_u32 v112, v0, 1, 2
    v_mul_u32_u24 v112, 1280, v112
    v_bfe_u32 v7, v0, 3, 2
    v_lshl_add_u32 v112, v7, 3, v112
    v_and_b32 v7, 1, v0
    v_lshl_add_u32 v112, v7, 2, v112
    v_lshrrev_b32 v7, 5, v0
    v_lshl_add_u32 v112, v7, 28, v112
    s_lshl_b32 s34, s62, 5
    s_waitcnt lgkmcnt(0)
    s_barrier
    ds_read_b64 v[64:65], v6 offset:1024
    ds_read_b64 v[66:67], v6 offset:2048
    ds_read_b64 v[68:69], v6 offset:3072
    ds_read_b64 v[70:71], v6 offset:4096
    ds_read_b64 v[72:73], v6 offset:5120
    ds_read_b64 v[74:75], v6 offset:6144
    ds_read_b64 v[76:77], v6 offset:7168
    s_waitcnt lgkmcnt(6)
    v_pk_fma_f32 v[108:109], v[64:65], v[104:105], v[108:109]
    s_waitcnt lgkmcnt(5)
    v_pk_fma_f32 v[108:109], v[66:67], v[104:105], v[108:109]
    s_waitcnt lgkmcnt(4)
    v_pk_fma_f32 v[108:109], v[68:69], v[104:105], v[108:109]
    s_waitcnt lgkmcnt(3)
    v_pk_fma_f32 v[108:109], v[70:71], v[104:105], v[108:109]
    s_waitcnt lgkmcnt(2)
    v_pk_fma_f32 v[108:109], v[72:73], v[104:105], v[108:109]
    s_waitcnt lgkmcnt(1)
    v_pk_fma_f32 v[108:109], v[74:75], v[104:105], v[108:109]
    s_waitcnt lgkmcnt(0)
    v_pk_fma_f32 v[108:109], v[76:77], v[104:105], v[108:109]
    v_cvt_pk_bf16_f32 v20, v108, v109
    buffer_store_dword v20, v112, s[36:39], s34 offen
    s_branch L_fin
L_t_wo:
    s_barrier
L_r_wo2:
    s_mov_b32 m0, s56
    s_nop 0
    buffer_load_dwordx4 v15, s[52:55], s57 offen  lds
    s_mov_b32 m0, s58
    s_nop 0
    buffer_load_dwordx4 v15, s[52:55], s59 offen  lds
    s_xor_b32 m0, s56, 2048
    s_sub_u32 s34, 40960, s57
    buffer_load_dwordx4 v15, s[52:55], s34 offen  lds
    s_xor_b32 m0, s58, 2048
    s_sub_u32 s34, 42240, s57
    buffer_load_dwordx4 v15, s[52:55], s34 offen  lds
L_r_wo3:
    s_mov_b32 s35, 0
    s_mov_b32 s48, 0
    buffer_load_dwordx4 v[64:67], v205, s[44:47], 0 offen sc1
    buffer_load_dwordx2 v[26:27], v204, s[44:47], 0 offen sc1
    s_waitcnt vmcnt(2)
    ds_read_b64_tr_b16 v[32:33], v206 offset:0
    ds_read_b64_tr_b16 v[34:35], v206 offset:1024
    ds_read_b64_tr_b16 v[36:37], v206 offset:32
    ds_read_b64_tr_b16 v[38:39], v206 offset:1056
    ds_read_b64_tr_b16 v[40:41], v206 offset:2048
    ds_read_b64_tr_b16 v[42:43], v206 offset:3072
    ds_read_b64_tr_b16 v[44:45], v206 offset:2080
    ds_read_b64_tr_b16 v[46:47], v206 offset:3104
    s_branch L_pam
L_pa:
    buffer_load_dwordx4 v[64:67], v205, s[44:47], 0 offen sc1
    buffer_load_dwordx2 v[26:27], v204, s[44:47], 0 offen sc1
L_pam:
    s_add_u32 s35, s35, 1
    s_waitcnt vmcnt(0)
    ds_write_b128 v207, v[64:67]
    ds_write_b32 v212, v26 offset:128
    v_max3_u32 v28, v64, v65, v66
    v_max3_u32 v28, v28, v67, v26
    v_cmp_eq_u32 vcc, -1, v28
    s_cbranch_vccz L_pad
    s_cmp_lg_u32 s35, 64
    s_cbranch_scc1 L_tmo100
    s_mov_b64 exec, -1
    v_lshlrev_b32 v243, 4, v0
    v_add_u32 v243, 131328, v243
    ds_read_b96 v[240:242], v243
    s_waitcnt lgkmcnt(0)
    buffer_store_dword v240, v242, s[44:47], 0 offen sc1
    buffer_store_dword v241, v242, s[44:47], 0 offen offset:256 sc1
L_tmo100:
    s_mov_b64 exec, vcc
    s_cmp_lt_u32 s35, 60000
    s_cbranch_scc1 L_pa
L_pad:
    s_mov_b64 exec, -1
    ds_read_b32 v26, v213 offset:128
    ds_read_b128 v[68:71], v208 offset:0
    ds_read_b128 v[72:75], v209 offset:0
    ds_read_b128 v[76:79], v208 offset:64
    ds_read_b128 v[80:83], v209 offset:64
    s_waitcnt lgkmcnt(3)
    v_mfma_f32_16x16x32_bf16 v[20:23], v[32:35], v[68:71], 0
    s_waitcnt lgkmcnt(2)
    v_mfma_f32_16x16x32_bf16 v[20:23], v[36:39], v[72:75], v[20:23]
    s_waitcnt lgkmcnt(1)
    v_mfma_f32_16x16x32_bf16 v[20:23], v[40:43], v[76:79], v[20:23]
    s_waitcnt lgkmcnt(0)
    v_mfma_f32_16x16x32_bf16 v[20:23], v[44:47], v[80:83], v[20:23]
    v_sub_f32_dpp v26, v26, v26 quad_perm:[1,0,3,2] row_mask:0xf bank_mask:0xf
    v_exp_f32 v26, v26
    s_nop 0
    v_add_f32 v26, 1.0, v26
    v_rcp_f32 v26, v26
    s_nop 0
    v_sub_f32 v30, 1.0, v26
    s_nop 0
    v_pk_mul_f32 v[48:49], v[20:21], v[26:27] op_sel_hi:[1,0]
    v_pk_mul_f32 v[50:51], v[22:23], v[26:27] op_sel_hi:[1,0]
    v_fmac_f32_dpp v48, v20, v30 quad_perm:[1,0,3,2] row_mask:0xf bank_mask:0xf
    v_fmac_f32_dpp v49, v21, v30 quad_perm:[1,0,3,2] row_mask:0xf bank_mask:0xf
    v_fmac_f32_dpp v50, v22, v30 quad_perm:[1,0,3,2] row_mask:0xf bank_mask:0xf
    v_fmac_f32_dpp v51, v23, v30 quad_perm:[1,0,3,2] row_mask:0xf bank_mask:0xf
    ds_write_b128 v203, v[48:51]
    s_cmp_lg_u32 s3, 0
    s_waitcnt lgkmcnt(0)
    s_barrier
    s_cbranch_scc1 L_wo_x
    ds_read_b64 v[64:65], v113 offset:0
    ds_read_b64 v[66:67], v113 offset:1152
    ds_read_b64 v[68:69], v113 offset:2304
    ds_read_b64 v[70:71], v113 offset:3456
    ds_read_b64 v[72:73], v113 offset:4608
    ds_read_b64 v[74:75], v113 offset:5760
    ds_read_b64 v[76:77], v113 offset:6912
    ds_read_b64 v[78:79], v113 offset:8064
    s_waitcnt lgkmcnt(6)
    v_pk_add_f32 v[64:65], v[64:65], v[66:67]
    s_waitcnt lgkmcnt(5)
    v_pk_add_f32 v[64:65], v[64:65], v[68:69]
    s_waitcnt lgkmcnt(4)
    v_pk_add_f32 v[64:65], v[64:65], v[70:71]
    s_waitcnt lgkmcnt(3)
    v_pk_add_f32 v[64:65], v[64:65], v[72:73]
    s_waitcnt lgkmcnt(2)
    v_pk_add_f32 v[64:65], v[64:65], v[74:75]
    s_waitcnt lgkmcnt(1)
    v_pk_add_f32 v[64:65], v[64:65], v[76:77]
    s_waitcnt lgkmcnt(0)
    v_pk_add_f32 v[64:65], v[64:65], v[78:79]
    v_pk_mul_f32 v[64:65], v[64:65], v[100:101]
    v_cvt_pk_bf16_f32 v28, v64, v65
    v_min_u32 v28, -2, v28
    buffer_store_dword v28, v112, s[44:47], s101 offen sc1
    buffer_store_dword v28, v112, s[44:47], s93 offen sc1
L_wo_x:
    s_getreg_b32 s34, hwreg(HW_REG_XCC_ID, 0, 4)
    v_cmp_ne_u32 vcc, s34, v27
    s_cbranch_vccz L_fin
    s_mov_b64 exec, -1
    v_lshlrev_b32 v243, 4, v0
    v_add_u32 v243, 131328, v243
    ds_read_b96 v[240:242], v243
    s_waitcnt lgkmcnt(0)
    buffer_store_dword v240, v242, s[44:47], 0 offen sc1
    buffer_store_dword v241, v242, s[44:47], 0 offen offset:256 sc1
L_fin:
L_exit:
    s_endpgm
L_codeend:
.section .rodata,"a"
.p2align 6
.amdhsa_kernel adaLN_cond__sliding_block_cached__dense_activation_gelu__decode_kernel
  .amdhsa_next_free_vgpr 256
  .amdhsa_next_free_sgpr 102
  .amdhsa_accum_offset 256
  .amdhsa_group_segment_fixed_size 0
  .amdhsa_kernarg_size 120
  .amdhsa_user_sgpr_count 2
  .amdhsa_user_sgpr_kernarg_segment_ptr 1
  .amdhsa_system_sgpr_workgroup_id_x 1
  .amdhsa_float_denorm_mode_32 3
.end_amdhsa_kernel
```

```asm
; @launch grid=(256,1,1) block=(512,1,1) lds=132352
.amdgcn_target "amdgcn-amd-amdhsa--gfx950"
.text
.globl adaLN_cond__sliding_block_cached__dense_activation_gelu__decode_kernel
.p2align 8
.type adaLN_cond__sliding_block_cached__dense_activation_gelu__decode_kernel,@function
adaLN_cond__sliding_block_cached__dense_activation_gelu__decode_kernel:
    s_cmp_ge_u32 s2, 256
    s_cbranch_scc1 L_exit
    s_load_dwordx4 s[4:7], s[0:1], 0
    v_lshrrev_b32 v1, 6, v0
    v_and_b32 v0, 63, v0
    v_readfirstlane_b32 s3, v1
    s_and_b32 s34, s2, 127
    s_lshl_b32 s34, s34, 21
    s_lshr_b32 s35, s2, 7
    s_lshl_b32 s35, s35, 18
    s_add_u32 s34, s34, s35
    s_add_u32 s34, s34, 1572864
    s_mov_b32 s38, 0x40000
    s_mov_b32 s39, 0x20000
    s_sub_u32 s49, s3, 1
    s_cbranch_scc1 L_nohead
    s_lshl_b32 s49, s49, 12
    v_lshl_add_u32 v1, v0, 4, s49
    s_lshr_b32 s98, s2, 7
    s_mul_i32 s98, s98, 57344
    s_waitcnt lgkmcnt(0)
    s_add_u32 s36, s6, s34
    s_addc_u32 s37, s7, 0
    buffer_load_dwordx4 v[16:19], v1, s[36:39], s98 offen offset:0 nt
    buffer_load_dwordx4 v[20:23], v1, s[36:39], s98 offen offset:1024 nt
    buffer_load_dwordx4 v[24:27], v1, s[36:39], s98 offen offset:2048 nt
L_nohead:
    s_load_dwordx8 s[8:15], s[0:1], 16
    s_load_dwordx4 s[16:19], s[0:1], 48
    s_load_dwordx8 s[20:27], s[0:1], 64
    s_load_dwordx4 s[28:31], s[0:1], 96
    s_load_dwordx2 s[32:33], s[0:1], 112
    s_and_b32 s60, s2, 7
    s_lshr_b32 s61, s2, 3
    s_mov_b32 s39, 0x20000
    s_mov_b32 s43, 0x20000
    s_mov_b32 s46, 1835008
    s_mov_b32 s47, 0x20000
    s_cmp_lg_u32 s3, 0
    s_cbranch_scc1 L_stream
    s_setprio 3
    v_and_b32 v12, 3, v0
    v_bfe_u32 v13, v0, 2, 2
    v_lshrrev_b32 v14, 4, v0
    v_lshrrev_b32 v10, 3, v0
    v_and_b32 v11, 7, v0
    v_lshlrev_b32 v11, 4, v11
    s_lshr_b32 s50, s2, 2
    s_and_b32 s51, s2, 3
    s_mul_i32 s34, s51, 1228800
    s_lshl_b32 s35, s50, 7
    s_add_u32 s34, s34, s35
    v_mul_u32_u24 v17, 7680, v10
    v_add3_u32 v17, v17, v11, s34
    v_mul_u32_u24 v16, 1280, v12
    v_lshl_add_u32 v18, v14, 4, v16
    s_mul_i32 s34, s51, 320
    v_add_u32 v19, s34, v18
    s_mov_b32 s38, 4915200
    s_sub_u32 s52, s50, 10
    s_waitcnt lgkmcnt(0)
    s_add_u32 s44, s32, 0
    s_addc_u32 s45, s33, 0
    s_cmp_ge_u32 s2, 240
    s_cbranch_scc1 L_clear
    s_mov_b32 s36, s26
    s_mov_b32 s37, s27
    s_mov_b32 m0, 0
    s_mov_b32 s34, 0
L_dma1:
    buffer_load_dwordx4 v17, s[36:39], s34 offen  lds
    s_add_u32 m0, m0, 1024
    s_add_u32 s34, s34, 61440
    buffer_load_dwordx4 v17, s[36:39], s34 offen  lds
    s_add_u32 m0, m0, 1024
    s_add_u32 s34, s34, 61440
    buffer_load_dwordx4 v17, s[36:39], s34 offen  lds
    s_add_u32 m0, m0, 1024
    s_add_u32 s34, s34, 61440
    buffer_load_dwordx4 v17, s[36:39], s34 offen  lds
    s_add_u32 m0, m0, 1024
    s_add_u32 s34, s34, 61440
    s_cmp_lt_u32 s34, 1228800
    s_cbranch_scc1 L_dma1
    v_lshlrev_b32 v1, 2, v0
    v_add_u32 v1, 98304, v1
    v_mov_b32 v2, -1
    v_mov_b32 v3, 0
    ds_write_b32 v1, v2
    ds_write_b32 v1, v2 offset:256
    ds_write_b32 v1, v3 offset:512
    ds_write_b32 v1, v3 offset:768
    s_waitcnt lgkmcnt(0)
    s_barrier
    s_cmp_ge_u32 s52, 10
    s_cbranch_scc1 L_nox
    v_lshl_add_u32 v18, v13, 6, v18
    global_load_dwordx4 v[52:55], v18, s[4:5] offset:0
    global_load_dwordx4 v[56:59], v18, s[4:5] offset:256
    global_load_dwordx4 v[60:63], v18, s[4:5] offset:512
    global_load_dwordx4 v[64:67], v18, s[4:5] offset:768
    global_load_dwordx4 v[68:71], v18, s[4:5] offset:1024
    s_lshl_b32 s34, s52, 7
    v_lshl_add_u32 v16, v13, 5, v16
    v_lshl_add_u32 v16, v14, 3, v16
    v_add_u32 v16, s34, v16
    global_load_dwordx2 v[72:73], v16, s[4:5]
L_nox:
    global_load_dwordx4 v[32:35], v19, s[24:25] offset:0
    global_load_dwordx4 v[36:39], v19, s[24:25] offset:64
    global_load_dwordx4 v[40:43], v19, s[24:25] offset:128
    global_load_dwordx4 v[44:47], v19, s[24:25] offset:192
    global_load_dwordx4 v[48:51], v19, s[24:25] offset:256
    s_and_b32 s34, s2, 31
    s_lshl_b32 s34, s34, 8
    s_lshr_b32 s35, s2, 7
    s_lshl_b32 s35, s35, 7
    s_add_u32 s49, s34, s35
    s_bfe_u32 s53, s2, 0x20005
    s_mul_i32 s34, s53, 1310720
    s_add_u32 s34, s34, s49
    v_lshl_add_u32 v16, v10, 13, v11
    v_add_u32 v16, s34, v16
    s_mov_b32 s36, s10
    s_mov_b32 s37, s11
    s_mov_b32 s38, 5242880
    s_mov_b32 m0, 20480
    s_mov_b32 s34, 0
L_dma2:
    buffer_load_dwordx4 v16, s[36:39], s34 offen  lds
    s_add_u32 m0, m0, 1024
    s_add_u32 s34, s34, 65536
    buffer_load_dwordx4 v16, s[36:39], s34 offen  lds
    s_add_u32 m0, m0, 1024
    s_add_u32 s34, s34, 65536
    buffer_load_dwordx4 v16, s[36:39], s34 offen  lds
    s_add_u32 m0, m0, 1024
    s_add_u32 s34, s34, 65536
    buffer_load_dwordx4 v16, s[36:39], s34 offen  lds
    s_add_u32 m0, m0, 1024
    s_add_u32 s34, s34, 65536
    s_cmp_lt_u32 s34, 1310720
    s_cbranch_scc1 L_dma2
    v_lshl_add_u32 v15, v14, 3, v13
    v_lshlrev_b32 v15, 7, v15
    v_lshl_add_u32 v15, v12, 3, v15
    s_waitcnt vmcnt(20)
    s_mov_b32 s34, 0xbfb8aa3b
    v_lshlrev_b32 v20, 16, v32
    v_and_b32 v21, 0xffff0000, v32
    v_lshlrev_b32 v22, 16, v33
    v_and_b32 v23, 0xffff0000, v33
    v_mul_f32 v24, s34, v20
    v_mul_f32 v25, s34, v21
    v_mul_f32 v26, s34, v22
    v_mul_f32 v27, s34, v23
    v_exp_f32 v24, v24
    v_exp_f32 v25, v25
    v_exp_f32 v26, v26
    v_exp_f32 v27, v27
    v_add_f32 v24, 1.0, v24
    v_add_f32 v25, 1.0, v25
    v_add_f32 v26, 1.0, v26
    v_add_f32 v27, 1.0, v27
    v_rcp_f32 v24, v24
    v_rcp_f32 v25, v25
    v_rcp_f32 v26, v26
    v_rcp_f32 v27, v27
    v_mul_f32 v24, v20, v24
    v_mul_f32 v25, v21, v25
    v_mul_f32 v26, v22, v26
    v_mul_f32 v27, v23, v27
    v_cvt_pk_bf16_f32 v32, v24, v25
    v_cvt_pk_bf16_f32 v33, v26, v27
    v_lshlrev_b32 v20, 16, v34
    v_and_b32 v21, 0xffff0000, v34
    v_lshlrev_b32 v22, 16, v35
    v_and_b32 v23, 0xffff0000, v35
    v_mul_f32 v24, s34, v20
    v_mul_f32 v25, s34, v21
    v_mul_f32 v26, s34, v22
    v_mul_f32 v27, s34, v23
    v_exp_f32 v24, v24
    v_exp_f32 v25, v25
    v_exp_f32 v26, v26
    v_exp_f32 v27, v27
    v_add_f32 v24, 1.0, v24
    v_add_f32 v25, 1.0, v25
    v_add_f32 v26, 1.0, v26
    v_add_f32 v27, 1.0, v27
    v_rcp_f32 v24, v24
    v_rcp_f32 v25, v25
    v_rcp_f32 v26, v26
    v_rcp_f32 v27, v27
    v_mul_f32 v24, v20, v24
    v_mul_f32 v25, v21, v25
    v_mul_f32 v26, v22, v26
    v_mul_f32 v27, v23, v27
    v_cvt_pk_bf16_f32 v34, v24, v25
    v_cvt_pk_bf16_f32 v35, v26, v27
    v_lshlrev_b32 v20, 16, v36
    v_and_b32 v21, 0xffff0000, v36
    v_lshlrev_b32 v22, 16, v37
    v_and_b32 v23, 0xffff0000, v37
    v_mul_f32 v24, s34, v20
    v_mul_f32 v25, s34, v21
    v_mul_f32 v26, s34, v22
    v_mul_f32 v27, s34, v23
    v_exp_f32 v24, v24
    v_exp_f32 v25, v25
    v_exp_f32 v26, v26
    v_exp_f32 v27, v27
    v_add_f32 v24, 1.0, v24
    v_add_f32 v25, 1.0, v25
    v_add_f32 v26, 1.0, v26
    v_add_f32 v27, 1.0, v27
    v_rcp_f32 v24, v24
    v_rcp_f32 v25, v25
    v_rcp_f32 v26, v26
    v_rcp_f32 v27, v27
    v_mul_f32 v24, v20, v24
    v_mul_f32 v25, v21, v25
    v_mul_f32 v26, v22, v26
    v_mul_f32 v27, v23, v27
    v_cvt_pk_bf16_f32 v36, v24, v25
    v_cvt_pk_bf16_f32 v37, v26, v27
    v_lshlrev_b32 v20, 16, v38
    v_and_b32 v21, 0xffff0000, v38
    v_lshlrev_b32 v22, 16, v39
    v_and_b32 v23, 0xffff0000, v39
    v_mul_f32 v24, s34, v20
    v_mul_f32 v25, s34, v21
    v_mul_f32 v26, s34, v22
    v_mul_f32 v27, s34, v23
    v_exp_f32 v24, v24
    v_exp_f32 v25, v25
    v_exp_f32 v26, v26
    v_exp_f32 v27, v27
    v_add_f32 v24, 1.0, v24
    v_add_f32 v25, 1.0, v25
    v_add_f32 v26, 1.0, v26
    v_add_f32 v27, 1.0, v27
    v_rcp_f32 v24, v24
    v_rcp_f32 v25, v25
    v_rcp_f32 v26, v26
    v_rcp_f32 v27, v27
    v_mul_f32 v24, v20, v24
    v_mul_f32 v25, v21, v25
    v_mul_f32 v26, v22, v26
    v_mul_f32 v27, v23, v27
    v_cvt_pk_bf16_f32 v38, v24, v25
    v_cvt_pk_bf16_f32 v39, v26, v27
    v_lshlrev_b32 v20, 16, v40
    v_and_b32 v21, 0xffff0000, v40
    v_lshlrev_b32 v22, 16, v41
    v_and_b32 v23, 0xffff0000, v41
    v_mul_f32 v24, s34, v20
    v_mul_f32 v25, s34, v21
    v_mul_f32 v26, s34, v22
    v_mul_f32 v27, s34, v23
    v_exp_f32 v24, v24
    v_exp_f32 v25, v25
    v_exp_f32 v26, v26
    v_exp_f32 v27, v27
    v_add_f32 v24, 1.0, v24
    v_add_f32 v25, 1.0, v25
    v_add_f32 v26, 1.0, v26
    v_add_f32 v27, 1.0, v27
    v_rcp_f32 v24, v24
    v_rcp_f32 v25, v25
    v_rcp_f32 v26, v26
    v_rcp_f32 v27, v27
    v_mul_f32 v24, v20, v24
    v_mul_f32 v25, v21, v25
    v_mul_f32 v26, v22, v26
    v_mul_f32 v27, v23, v27
    v_cvt_pk_bf16_f32 v40, v24, v25
    v_cvt_pk_bf16_f32 v41, v26, v27
    v_lshlrev_b32 v20, 16, v42
    v_and_b32 v21, 0xffff0000, v42
    v_lshlrev_b32 v22, 16, v43
    v_and_b32 v23, 0xffff0000, v43
    v_mul_f32 v24, s34, v20
    v_mul_f32 v25, s34, v21
    v_mul_f32 v26, s34, v22
    v_mul_f32 v27, s34, v23
    v_exp_f32 v24, v24
    v_exp_f32 v25, v25
    v_exp_f32 v26, v26
    v_exp_f32 v27, v27
    v_add_f32 v24, 1.0, v24
    v_add_f32 v25, 1.0, v25
    v_add_f32 v26, 1.0, v26
    v_add_f32 v27, 1.0, v27
    v_rcp_f32 v24, v24
    v_rcp_f32 v25, v25
    v_rcp_f32 v26, v26
    v_rcp_f32 v27, v27
    v_mul_f32 v24, v20, v24
    v_mul_f32 v25, v21, v25
    v_mul_f32 v26, v22, v26
    v_mul_f32 v27, v23, v27
    v_cvt_pk_bf16_f32 v42, v24, v25
    v_cvt_pk_bf16_f32 v43, v26, v27
    v_lshlrev_b32 v20, 16, v44
    v_and_b32 v21, 0xffff0000, v44
    v_lshlrev_b32 v22, 16, v45
    v_and_b32 v23, 0xffff0000, v45
    v_mul_f32 v24, s34, v20
    v_mul_f32 v25, s34, v21
    v_mul_f32 v26, s34, v22
    v_mul_f32 v27, s34, v23
    v_exp_f32 v24, v24
    v_exp_f32 v25, v25
    v_exp_f32 v26, v26
    v_exp_f32 v27, v27
    v_add_f32 v24, 1.0, v24
    v_add_f32 v25, 1.0, v25
    v_add_f32 v26, 1.0, v26
    v_add_f32 v27, 1.0, v27
    v_rcp_f32 v24, v24
    v_rcp_f32 v25, v25
    v_rcp_f32 v26, v26
    v_rcp_f32 v27, v27
    v_mul_f32 v24, v20, v24
    v_mul_f32 v25, v21, v25
    v_mul_f32 v26, v22, v26
    v_mul_f32 v27, v23, v27
    v_cvt_pk_bf16_f32 v44, v24, v25
    v_cvt_pk_bf16_f32 v45, v26, v27
    v_lshlrev_b32 v20, 16, v46
    v_and_b32 v21, 0xffff0000, v46
    v_lshlrev_b32 v22, 16, v47
    v_and_b32 v23, 0xffff0000, v47
    v_mul_f32 v24, s34, v20
    v_mul_f32 v25, s34, v21
    v_mul_f32 v26, s34, v22
    v_mul_f32 v27, s34, v23
    v_exp_f32 v24, v24
    v_exp_f32 v25, v25
    v_exp_f32 v26, v26
    v_exp_f32 v27, v27
    v_add_f32 v24, 1.0, v24
    v_add_f32 v25, 1.0, v25
    v_add_f32 v26, 1.0, v26
    v_add_f32 v27, 1.0, v27
    v_rcp_f32 v24, v24
    v_rcp_f32 v25, v25
    v_rcp_f32 v26, v26
    v_rcp_f32 v27, v27
    v_mul_f32 v24, v20, v24
    v_mul_f32 v25, v21, v25
    v_mul_f32 v26, v22, v26
    v_mul_f32 v27, v23, v27
    v_cvt_pk_bf16_f32 v46, v24, v25
    v_cvt_pk_bf16_f32 v47, v26, v27
    v_lshlrev_b32 v20, 16, v48
    v_and_b32 v21, 0xffff0000, v48
    v_lshlrev_b32 v22, 16, v49
    v_and_b32 v23, 0xffff0000, v49
    v_mul_f32 v24, s34, v20
    v_mul_f32 v25, s34, v21
    v_mul_f32 v26, s34, v22
    v_mul_f32 v27, s34, v23
    v_exp_f32 v24, v24
    v_exp_f32 v25, v25
    v_exp_f32 v26, v26
    v_exp_f32 v27, v27
    v_add_f32 v24, 1.0, v24
    v_add_f32 v25, 1.0, v25
    v_add_f32 v26, 1.0, v26
    v_add_f32 v27, 1.0, v27
    v_rcp_f32 v24, v24
    v_rcp_f32 v25, v25
    v_rcp_f32 v26, v26
    v_rcp_f32 v27, v27
    v_mul_f32 v24, v20, v24
    v_mul_f32 v25, v21, v25
    v_mul_f32 v26, v22, v26
    v_mul_f32 v27, v23, v27
    v_cvt_pk_bf16_f32 v48, v24, v25
    v_cvt_pk_bf16_f32 v49, v26, v27
    v_lshlrev_b32 v20, 16, v50
    v_and_b32 v21, 0xffff0000, v50
    v_lshlrev_b32 v22, 16, v51
    v_and_b32 v23, 0xffff0000, v51
    v_mul_f32 v24, s34, v20
    v_mul_f32 v25, s34, v21
    v_mul_f32 v26, s34, v22
    v_mul_f32 v27, s34, v23
    v_exp_f32 v24, v24
    v_exp_f32 v25, v25
    v_exp_f32 v26, v26
    v_exp_f32 v27, v27
    v_add_f32 v24, 1.0, v24
    v_add_f32 v25, 1.0, v25
    v_add_f32 v26, 1.0, v26
    v_add_f32 v27, 1.0, v27
    v_rcp_f32 v24, v24
    v_rcp_f32 v25, v25
    v_rcp_f32 v26, v26
    v_rcp_f32 v27, v27
    v_mul_f32 v24, v20, v24
    v_mul_f32 v25, v21, v25
    v_mul_f32 v26, v22, v26
    v_mul_f32 v27, v23, v27
    v_cvt_pk_bf16_f32 v50, v24, v25
    v_cvt_pk_bf16_f32 v51, v26, v27
    s_cmp_ge_u32 s52, 10
    s_cbranch_scc1 L_nostats
    v_mov_b32 v20, 0
    v_mov_b32 v21, 0
    v_mov_b32 v22, 0x3f803f80
    v_dot2c_f32_bf16 v20, v52, v22
    v_dot2c_f32_bf16 v21, v52, v52
    v_dot2c_f32_bf16 v20, v53, v22
    v_dot2c_f32_bf16 v21, v53, v53
    v_dot2c_f32_bf16 v20, v54, v22
    v_dot2c_f32_bf16 v21, v54, v54
    v_dot2c_f32_bf16 v20, v55, v22
    v_dot2c_f32_bf16 v21, v55, v55
    v_dot2c_f32_bf16 v20, v56, v22
    v_dot2c_f32_bf16 v21, v56, v56
    v_dot2c_f32_bf16 v20, v57, v22
    v_dot2c_f32_bf16 v21, v57, v57
    v_dot2c_f32_bf16 v20, v58, v22
    v_dot2c_f32_bf16 v21, v58, v58
    v_dot2c_f32_bf16 v20, v59, v22
    v_dot2c_f32_bf16 v21, v59, v59
    v_dot2c_f32_bf16 v20, v60, v22
    v_dot2c_f32_bf16 v21, v60, v60
    v_dot2c_f32_bf16 v20, v61, v22
    v_dot2c_f32_bf16 v21, v61, v61
    v_dot2c_f32_bf16 v20, v62, v22
    v_dot2c_f32_bf16 v21, v62, v62
    v_dot2c_f32_bf16 v20, v63, v22
    v_dot2c_f32_bf16 v21, v63, v63
    v_dot2c_f32_bf16 v20, v64, v22
    v_dot2c_f32_bf16 v21, v64, v64
    v_dot2c_f32_bf16 v20, v65, v22
    v_dot2c_f32_bf16 v21, v65, v65
    v_dot2c_f32_bf16 v20, v66, v22
    v_dot2c_f32_bf16 v21, v66, v66
    v_dot2c_f32_bf16 v20, v67, v22
    v_dot2c_f32_bf16 v21, v67, v67
    v_dot2c_f32_bf16 v20, v68, v22
    v_dot2c_f32_bf16 v21, v68, v68
    v_dot2c_f32_bf16 v20, v69, v22
    v_dot2c_f32_bf16 v21, v69, v69
    v_dot2c_f32_bf16 v20, v70, v22
    v_dot2c_f32_bf16 v21, v70, v70
    v_dot2c_f32_bf16 v20, v71, v22
    v_dot2c_f32_bf16 v21, v71, v71
    s_nop 1
    v_add_f32_dpp v20, v20, v20 row_ror:4 row_mask:0xf bank_mask:0xf
    v_add_f32_dpp v21, v21, v21 row_ror:4 row_mask:0xf bank_mask:0xf
    s_nop 0
    v_add_f32_dpp v20, v20, v20 row_ror:8 row_mask:0xf bank_mask:0xf
    v_add_f32_dpp v21, v21, v21 row_ror:8 row_mask:0xf bank_mask:0xf
    v_mov_b32 v22, v20
    v_mov_b32 v23, v21
    s_nop 0
    v_permlane16_swap_b32 v20, v22
    v_permlane16_swap_b32 v21, v23
    v_add_f32 v20, v20, v22
    v_add_f32 v21, v21, v23
    v_mov_b32 v22, v20
    v_mov_b32 v23, v21
    s_nop 0
    v_permlane32_swap_b32 v20, v22
    v_permlane32_swap_b32 v21, v23
    v_add_f32 v20, v20, v22
    v_add_f32 v21, v21, v23
    v_mul_f32 v22, 0x3acccccd, v20
    v_mul_f32 v21, 0x3acccccd, v21
    v_fma_f32 v21, -v22, v22, v21
    v_max_f32 v21, 0, v21
    v_add_f32 v21, 0x3727c5ac, v21
    v_rsq_f32 v20, v21
    s_nop 0
    v_mul_f32_e64 v21, -v22, v20
    v_lshlrev_b32 v24, 16, v72
    v_and_b32 v25, 0xffff0000, v72
    v_lshlrev_b32 v26, 16, v73
    v_and_b32 v27, 0xffff0000, v73
    v_fma_f32 v24, v24, v20, v21
    v_fma_f32 v25, v25, v20, v21
    v_fma_f32 v26, v26, v20, v21
    v_fma_f32 v27, v27, v20, v21
L_nostats:
    s_waitcnt vmcnt(20)
    ds_read_b64_tr_b16 v[96:97], v15 offset:0
    ds_read_b64_tr_b16 v[98:99], v15 offset:512
    ds_read_b64_tr_b16 v[100:101], v15 offset:32
    ds_read_b64_tr_b16 v[102:103], v15 offset:544
    ds_read_b64_tr_b16 v[104:105], v15 offset:64
    ds_read_b64_tr_b16 v[106:107], v15 offset:576
    ds_read_b64_tr_b16 v[108:109], v15 offset:96
    ds_read_b64_tr_b16 v[110:111], v15 offset:608
    s_waitcnt lgkmcnt(7)
    ds_read_b64_tr_b16 v[112:113], v15 offset:4096
    ds_read_b64_tr_b16 v[114:115], v15 offset:4608
    ds_read_b64_tr_b16 v[116:117], v15 offset:4128
    ds_read_b64_tr_b16 v[118:119], v15 offset:4640
    ds_read_b64_tr_b16 v[120:121], v15 offset:4160
    ds_read_b64_tr_b16 v[122:123], v15 offset:4672
    ds_read_b64_tr_b16 v[124:125], v15 offset:4192
    ds_read_b64_tr_b16 v[126:127], v15 offset:4704
    s_waitcnt lgkmcnt(7)
    ds_read_b64_tr_b16 v[128:129], v15 offset:8192
    ds_read_b64_tr_b16 v[130:131], v15 offset:8704
    ds_read_b64_tr_b16 v[132:133], v15 offset:8224
    ds_read_b64_tr_b16 v[134:135], v15 offset:8736
    ds_read_b64_tr_b16 v[136:137], v15 offset:8256
    ds_read_b64_tr_b16 v[138:139], v15 offset:8768
    ds_read_b64_tr_b16 v[140:141], v15 offset:8288
    ds_read_b64_tr_b16 v[142:143], v15 offset:8800
    s_waitcnt lgkmcnt(7)
    ds_read_b64_tr_b16 v[144:145], v15 offset:12288
    ds_read_b64_tr_b16 v[146:147], v15 offset:12800
    ds_read_b64_tr_b16 v[148:149], v15 offset:12320
    ds_read_b64_tr_b16 v[150:151], v15 offset:12832
    ds_read_b64_tr_b16 v[152:153], v15 offset:12352
    ds_read_b64_tr_b16 v[154:155], v15 offset:12864
    ds_read_b64_tr_b16 v[156:157], v15 offset:12384
    ds_read_b64_tr_b16 v[158:159], v15 offset:12896
    s_waitcnt lgkmcnt(7)
    ds_read_b64_tr_b16 v[160:161], v15 offset:16384
    ds_read_b64_tr_b16 v[162:163], v15 offset:16896
    ds_read_b64_tr_b16 v[164:165], v15 offset:16416
    ds_read_b64_tr_b16 v[166:167], v15 offset:16928
    ds_read_b64_tr_b16 v[168:169], v15 offset:16448
    ds_read_b64_tr_b16 v[170:171], v15 offset:16960
    ds_read_b64_tr_b16 v[172:173], v15 offset:16480
    ds_read_b64_tr_b16 v[174:175], v15 offset:16992
    s_waitcnt lgkmcnt(0)
    v_mfma_f32_16x16x32_bf16 v[80:83], v[96:99], v[32:35], 0
    v_mfma_f32_16x16x32_bf16 v[84:87], v[100:103], v[32:35], 0
    v_mfma_f32_16x16x32_bf16 v[88:91], v[104:107], v[32:35], 0
    v_mfma_f32_16x16x32_bf16 v[92:95], v[108:111], v[32:35], 0
    v_mfma_f32_16x16x32_bf16 v[80:83], v[112:115], v[36:39], v[80:83]
    v_mfma_f32_16x16x32_bf16 v[84:87], v[116:119], v[36:39], v[84:87]
    v_mfma_f32_16x16x32_bf16 v[88:91], v[120:123], v[36:39], v[88:91]
    v_mfma_f32_16x16x32_bf16 v[92:95], v[124:127], v[36:39], v[92:95]
    v_mfma_f32_16x16x32_bf16 v[80:83], v[128:131], v[40:43], v[80:83]
    v_mfma_f32_16x16x32_bf16 v[84:87], v[132:135], v[40:43], v[84:87]
    v_mfma_f32_16x16x32_bf16 v[88:91], v[136:139], v[40:43], v[88:91]
    v_mfma_f32_16x16x32_bf16 v[92:95], v[140:143], v[40:43], v[92:95]
    v_mfma_f32_16x16x32_bf16 v[80:83], v[144:147], v[44:47], v[80:83]
    v_mfma_f32_16x16x32_bf16 v[84:87], v[148:151], v[44:47], v[84:87]
    v_mfma_f32_16x16x32_bf16 v[88:91], v[152:155], v[44:47], v[88:91]
    v_mfma_f32_16x16x32_bf16 v[92:95], v[156:159], v[44:47], v[92:95]
    v_mfma_f32_16x16x32_bf16 v[80:83], v[160:163], v[48:51], v[80:83]
    v_mfma_f32_16x16x32_bf16 v[84:87], v[164:167], v[48:51], v[84:87]
    v_mfma_f32_16x16x32_bf16 v[88:91], v[168:171], v[48:51], v[88:91]
    v_mfma_f32_16x16x32_bf16 v[92:95], v[172:175], v[48:51], v[92:95]
    s_cmp_ge_u32 s50, 20
    s_cbranch_scc1 L_adr_rest
    s_cmp_lt_u32 s50, 10
    s_cselect_b32 s34, 5120, 0
    s_cselect_b32 s35, s50, s52
    s_lshl_b32 s35, s35, 9
    s_add_u32 s34, s34, s35
    s_lshl_b32 s35, s51, 15
    s_add_u32 s34, s34, s35
    v_lshrrev_b32 v19, 1, v14
    v_lshl_add_u32 v19, v13, 1, v19
    v_lshlrev_b32 v19, 6, v19
    v_lshl_add_u32 v19, v12, 4, v19
    v_and_b32 v20, 1, v14
    v_lshl_add_u32 v19, v20, 3, v19
    s_branch L_adr_done
L_adr_rest:
    s_lshl_b32 s34, s51, 15
    s_lshl_b32 s35, s50, 9
    s_add_u32 s34, s34, s35
    s_add_u32 s34, s34, 0
    v_lshlrev_b32 v19, 7, v12
    v_lshl_add_u32 v19, v13, 5, v19
    v_lshl_add_u32 v19, v14, 3, v19
    s_nop 3
L_adr_done:
    v_add_u32 v19, s34, v19
    v_mov_b32_dpp v80, v84 quad_perm:[0,1,2,3] row_mask:0xf bank_mask:0x2
    v_mov_b32_dpp v81, v85 quad_perm:[0,1,2,3] row_mask:0xf bank_mask:0x2
    v_mov_b32_dpp v82, v86 quad_perm:[0,1,2,3] row_mask:0xf bank_mask:0x2
    v_mov_b32_dpp v83, v87 quad_perm:[0,1,2,3] row_mask:0xf bank_mask:0x2
    v_mov_b32_dpp v80, v88 quad_perm:[0,1,2,3] row_mask:0xf bank_mask:0x4
    v_mov_b32_dpp v81, v89 quad_perm:[0,1,2,3] row_mask:0xf bank_mask:0x4
    v_mov_b32_dpp v82, v90 quad_perm:[0,1,2,3] row_mask:0xf bank_mask:0x4
    v_mov_b32_dpp v83, v91 quad_perm:[0,1,2,3] row_mask:0xf bank_mask:0x4
    v_mov_b32_dpp v80, v92 quad_perm:[0,1,2,3] row_mask:0xf bank_mask:0x8
    v_mov_b32_dpp v81, v93 quad_perm:[0,1,2,3] row_mask:0xf bank_mask:0x8
    v_mov_b32_dpp v82, v94 quad_perm:[0,1,2,3] row_mask:0xf bank_mask:0x8
    v_mov_b32_dpp v83, v95 quad_perm:[0,1,2,3] row_mask:0xf bank_mask:0x8
    s_cmp_ge_u32 s52, 10
    s_cbranch_scc1 L_noz
    v_add_f32 v80, 0x3e800000, v80
    v_add_f32 v81, 0x3e800000, v81
    v_add_f32 v82, 0x3e800000, v82
    v_add_f32 v83, 0x3e800000, v83
    v_mul_f32 v80, v80, v24
    v_mul_f32 v81, v81, v25
    v_mul_f32 v82, v82, v26
    v_mul_f32 v83, v83, v27
L_noz:
    v_cvt_pk_bf16_f32 v20, v80, v81
    v_cvt_pk_bf16_f32 v21, v82, v83
    v_min_u32 v20, -2, v20
    v_min_u32 v21, -2, v21
    v_and_b32 v22, 15, v0
    v_lshlrev_b32 v22, 2, v22
    s_mov_b32 s35, 0
L_poll3:
    global_load_dword v23, v22, s[30:31] offset:128 sc1
    s_add_u32 s35, s35, 1
    s_waitcnt vmcnt(0)
    v_cmp_eq_u32 vcc, 0, v23
    s_cbranch_vccz L_done4
    s_sleep 8
    s_cmp_lt_u32 s35, 60000
    s_cbranch_scc1 L_poll3
L_done4:
    s_getreg_b32 s97, hwreg(HW_REG_XCC_ID, 0, 4)
    s_sub_u32 s97, s97, s2
    s_and_b32 s97, s97, 7
    s_add_u32 s97, s97, 1
    v_cmp_ne_u32 vcc, s97, v23
    s_nop 0
    s_mov_b32 s97, vcc_lo
    buffer_store_dwordx2 v[20:21], v19, s[44:47], 0 offen sc1
    s_branch L_p2
L_clear:
    s_sub_u32 s55, s2, 240
    s_lshr_b32 s34, s55, 2
    s_lshl_b32 s35, s34, 3
    s_lshr_b32 s54, 538910750, s35
    s_and_b32 s54, s54, 0xff
    s_lshl_b32 s54, s54, 10
    s_mul_i32 s34, s34, 393216
    s_lshl_b32 s35, s51, 15
    s_add_u32 s34, s34, s35
    v_lshl_add_u32 v19, v0, 4, s34
    v_mov_b32 v20, -1
    v_mov_b32 v21, -1
    v_mov_b32 v22, -1
    v_mov_b32 v23, -1
    s_mov_b32 s34, 0
L_clrloop:
    buffer_store_dwordx4 v[20:23], v19, s[44:47], s34 offen offset:0 sc1
    s_add_u32 s34, s34, 1024
    s_cmp_lt_u32 s34, s54
    s_cbranch_scc1 L_clrloop
L_clrend:
    s_cmp_ge_u32 s55, 4
    s_cbranch_scc1 L_clrend2
    s_mov_b32 s34, 1572864
    buffer_store_dwordx4 v[20:23], v19, s[44:47], s34 offen sc1
    s_mov_b32 s34, 1573888
    buffer_store_dwordx4 v[20:23], v19, s[44:47], s34 offen sc1
    s_mov_b32 s34, 1574912
    buffer_store_dwordx4 v[20:23], v19, s[44:47], s34 offen sc1
    s_mov_b32 s34, 1575936
    buffer_store_dwordx4 v[20:23], v19, s[44:47], s34 offen sc1
    s_mov_b32 s34, 1576960
    buffer_store_dwordx4 v[20:23], v19, s[44:47], s34 offen sc1
L_clrend2:
    s_lshr_b32 s35, s55, 2
    s_mul_i32 s35, s35, -385024
    s_add_u32 s34, s35, 1709056
    buffer_store_dwordx4 v[20:23], v19, s[44:47], s34 offen sc1
    s_add_u32 s34, s35, 1710080
    buffer_store_dwordx4 v[20:23], v19, s[44:47], s34 offen sc1
    v_lshlrev_b32 v1, 2, v0
    v_add_u32 v1, 98304, v1
    v_mov_b32 v2, -1
    v_mov_b32 v3, 0
    ds_write_b32 v1, v2
    ds_write_b32 v1, v2 offset:256
    ds_write_b32 v1, v3 offset:512
    ds_write_b32 v1, v3 offset:768
    s_waitcnt lgkmcnt(0)
    s_barrier
    s_lshl_b32 s34, s55, 2
    v_mov_b32 v24, s34
    s_getreg_b32 s97, hwreg(HW_REG_XCC_ID, 0, 4)
    s_sub_u32 s97, s97, s2
    s_and_b32 s97, s97, 7
    s_add_u32 s97, s97, 1
    v_mov_b32 v25, s97
    v_readfirstlane_b32 s90, v19
    s_mov_b32 s91, 0
    s_waitcnt vmcnt(0)
    s_mov_b64 exec, 1
    global_store_dword v24, v25, s[30:31] offset:128 sc1
    s_mov_b64 exec, -1
    s_and_b32 s34, s2, 31
    s_lshl_b32 s34, s34, 8
    s_lshr_b32 s35, s2, 7
    s_lshl_b32 s35, s35, 7
    s_add_u32 s49, s34, s35
    s_bfe_u32 s53, s2, 0x20005
    s_mul_i32 s34, s53, 1310720
    s_add_u32 s34, s34, s49
    v_lshl_add_u32 v16, v10, 13, v11
    v_add_u32 v16, s34, v16
    s_mov_b32 s36, s10
    s_mov_b32 s37, s11
    s_mov_b32 s38, 5242880
    s_mov_b32 m0, 20480
    s_mov_b32 s34, 0
L_dma6:
    buffer_load_dwordx4 v16, s[36:39], s34 offen  lds
    s_add_u32 m0, m0, 1024
    s_add_u32 s34, s34, 65536
    buffer_load_dwordx4 v16, s[36:39], s34 offen  lds
    s_add_u32 m0, m0, 1024
    s_add_u32 s34, s34, 65536
    buffer_load_dwordx4 v16, s[36:39], s34 offen  lds
    s_add_u32 m0, m0, 1024
    s_add_u32 s34, s34, 65536
    buffer_load_dwordx4 v16, s[36:39], s34 offen  lds
    s_add_u32 m0, m0, 1024
    s_add_u32 s34, s34, 65536
    s_cmp_lt_u32 s34, 1310720
    s_cbranch_scc1 L_dma6
    v_lshl_add_u32 v15, v14, 3, v13
    v_lshlrev_b32 v15, 7, v15
    v_lshl_add_u32 v15, v12, 3, v15
    s_add_u32 s34, s90, 0
    s_add_u32 s35, s90, 8192
    s_mov_b64 s[88:89], 0
    s_load_dword s88, s[44:45], s34
    s_load_dword s89, s[44:45], s35
    s_waitcnt lgkmcnt(1)
    s_cmp_lg_u32 s89, 0
    s_addc_u32 s91, s91, 0
    s_waitcnt lgkmcnt(0)
    s_add_u32 s34, s90, 1024
    s_add_u32 s35, s90, 9216
    s_mov_b64 s[88:89], 0
    s_load_dword s89, s[44:45], s35
    s_load_dword s88, s[44:45], s34
    s_waitcnt lgkmcnt(1)
    s_cmp_eq_u32 s88, 0
    s_addc_u32 s91, s91, 0
    s_waitcnt lgkmcnt(0)
    s_add_u32 s34, s90, 2048
    s_add_u32 s35, s90, 10240
    s_mov_b64 s[88:89], 0
    s_load_dword s88, s[44:45], s34
    s_load_dword s89, s[44:45], s35
    s_waitcnt lgkmcnt(1)
    s_cmp_lg_u32 s89, 0
    s_addc_u32 s91, s91, 0
    s_waitcnt lgkmcnt(0)
    s_add_u32 s34, s90, 3072
    s_add_u32 s35, s90, 11264
    s_mov_b64 s[88:89], 0
    s_load_dword s89, s[44:45], s35
    s_load_dword s88, s[44:45], s34
    s_waitcnt lgkmcnt(1)
    s_cmp_eq_u32 s88, 0
    s_addc_u32 s91, s91, 0
    s_waitcnt lgkmcnt(0)
    s_getreg_b32 s34, hwreg(HW_REG_XCC_ID, 2, 1)
    s_sub_u32 s35, 2, s91
    s_sub_u32 s91, s91, 2
    s_cmp_eq_u32 s34, 0
    s_cselect_b32 s91, s91, s35
    v_mov_b32 v25, s91
    s_mov_b64 exec, 1
    global_store_dword v24, v25, s[30:31] sc1
    s_mov_b64 exec, -1
L_novote:
    v_and_b32 v22, 15, v0
    v_lshlrev_b32 v22, 2, v22
    s_mov_b32 s35, 0
L_poll7:
    global_load_dword v23, v22, s[30:31] offset:128 sc1
    s_add_u32 s35, s35, 1
    s_waitcnt vmcnt(0)
    v_cmp_eq_u32 vcc, 0, v23
    s_cbranch_vccz L_done8
    s_sleep 8
    s_cmp_lt_u32 s35, 60000
    s_cbranch_scc1 L_poll7
L_done8:
    s_getreg_b32 s97, hwreg(HW_REG_XCC_ID, 0, 4)
    s_sub_u32 s97, s97, s2
    s_and_b32 s97, s97, 7
    s_add_u32 s97, s97, 1
    v_cmp_ne_u32 vcc, s97, v23
    s_nop 0
    s_mov_b32 s97, vcc_lo
L_p2:
    v_mov_b32 v199, v19
    ds_read_b64_tr_b16 v[96:97], v15 offset:20480
    ds_read_b64_tr_b16 v[98:99], v15 offset:20992
    ds_read_b64_tr_b16 v[100:101], v15 offset:20512
    ds_read_b64_tr_b16 v[102:103], v15 offset:21024
    ds_read_b64_tr_b16 v[104:105], v15 offset:20544
    ds_read_b64_tr_b16 v[106:107], v15 offset:21056
    ds_read_b64_tr_b16 v[108:109], v15 offset:20576
    ds_read_b64_tr_b16 v[110:111], v15 offset:21088
    s_waitcnt lgkmcnt(7)
    ds_read_b64_tr_b16 v[112:113], v15 offset:24576
    ds_read_b64_tr_b16 v[114:115], v15 offset:25088
    ds_read_b64_tr_b16 v[116:117], v15 offset:24608
    ds_read_b64_tr_b16 v[118:119], v15 offset:25120
    ds_read_b64_tr_b16 v[120:121], v15 offset:24640
    ds_read_b64_tr_b16 v[122:123], v15 offset:25152
    ds_read_b64_tr_b16 v[124:125], v15 offset:24672
    ds_read_b64_tr_b16 v[126:127], v15 offset:25184
    s_waitcnt lgkmcnt(7)
    ds_read_b64_tr_b16 v[128:129], v15 offset:28672
    ds_read_b64_tr_b16 v[130:131], v15 offset:29184
    ds_read_b64_tr_b16 v[132:133], v15 offset:28704
    ds_read_b64_tr_b16 v[134:135], v15 offset:29216
    ds_read_b64_tr_b16 v[136:137], v15 offset:28736
    ds_read_b64_tr_b16 v[138:139], v15 offset:29248
    ds_read_b64_tr_b16 v[140:141], v15 offset:28768
    ds_read_b64_tr_b16 v[142:143], v15 offset:29280
    s_waitcnt lgkmcnt(7)
    ds_read_b64_tr_b16 v[144:145], v15 offset:32768
    ds_read_b64_tr_b16 v[146:147], v15 offset:33280
    ds_read_b64_tr_b16 v[148:149], v15 offset:32800
    ds_read_b64_tr_b16 v[150:151], v15 offset:33312
    ds_read_b64_tr_b16 v[152:153], v15 offset:32832
    ds_read_b64_tr_b16 v[154:155], v15 offset:33344
    ds_read_b64_tr_b16 v[156:157], v15 offset:32864
    ds_read_b64_tr_b16 v[158:159], v15 offset:33376
    s_waitcnt lgkmcnt(7)
    ds_read_b64_tr_b16 v[160:161], v15 offset:36864
    ds_read_b64_tr_b16 v[162:163], v15 offset:37376
    ds_read_b64_tr_b16 v[164:165], v15 offset:36896
    ds_read_b64_tr_b16 v[166:167], v15 offset:37408
    ds_read_b64_tr_b16 v[168:169], v15 offset:36928
    ds_read_b64_tr_b16 v[170:171], v15 offset:37440
    ds_read_b64_tr_b16 v[172:173], v15 offset:36960
    ds_read_b64_tr_b16 v[174:175], v15 offset:37472
    s_waitcnt lgkmcnt(0)
    s_mul_i32 s34, s53, 1280
    v_lshlrev_b32 v19, 15, v13
    v_lshl_add_u32 v19, v14, 6, v19
    v_lshl_add_u32 v19, v12, 4, v19
    v_add_u32 v19, s34, v19
    s_movk_i32 s48, 5120
    s_mov_b32 s56, 32768
    s_mov_b32 s57, 65536
    s_mov_b32 s58, 98304
    s_sub_u32 s34, s2, 80
    s_cmp_lt_u32 s34, 160
    s_cselect_b32 s54, 1, 0
    s_and_b32 s34, s2, 3
    s_cselect_b32 s54, 0, s54
    v_mov_b32 v180, 0
    v_mov_b32 v181, 0
    v_mov_b32 v182, 0
    v_mov_b32 v183, 0
    v_mov_b32 v184, 0
    v_mov_b32 v185, 0
    v_mov_b32 v186, 0
    v_mov_b32 v187, 0
    v_mov_b32 v22, 99072
    s_mov_b32 s35, 0
L_poll10:
    ds_read_b32 v23, v22
    s_add_u32 s35, s35, 1
    s_waitcnt lgkmcnt(0)
    v_cmp_gt_u32 vcc, 21, v23
    s_cbranch_vccz L_done11
    s_sleep 2
    s_cmp_lt_u32 s35, 60000
    s_cbranch_scc1 L_poll10
L_done11:
    s_mov_b32 s35, 0
L_poll13:
    buffer_load_dwordx4 v[32:35], v19, s[44:47], 0 offen offset:0 sc1
    buffer_load_dwordx4 v[36:39], v19, s[44:47], s48 offen offset:0 sc1
    buffer_load_dwordx4 v[40:43], v19, s[44:47], 0 offen offset:256 sc1
    buffer_load_dwordx4 v[44:47], v19, s[44:47], s48 offen offset:256 sc1
    buffer_load_dwordx4 v[48:51], v19, s[44:47], 0 offen offset:512 sc1
    buffer_load_dwordx4 v[52:55], v19, s[44:47], s48 offen offset:512 sc1
    buffer_load_dwordx4 v[56:59], v19, s[44:47], 0 offen offset:768 sc1
    buffer_load_dwordx4 v[60:63], v19, s[44:47], s48 offen offset:768 sc1
    buffer_load_dwordx4 v[64:67], v19, s[44:47], 0 offen offset:1024 sc1
    buffer_load_dwordx4 v[68:71], v19, s[44:47], s48 offen offset:1024 sc1
    s_cmp_eq_u32 s54, 0
    s_cbranch_scc1 L_hskip
    buffer_load_dwordx2 v[180:181], v199, s[44:47], 0 offen sc1
    buffer_load_dwordx2 v[182:183], v199, s[44:47], s56 offen sc1
    buffer_load_dwordx2 v[184:185], v199, s[44:47], s57 offen sc1
    buffer_load_dwordx2 v[186:187], v199, s[44:47], s58 offen sc1
L_hskip:
    s_add_u32 s35, s35, 1
    s_waitcnt vmcnt(0)
    v_max3_u32 v20, v32, v33, v34
    v_max3_u32 v20, v20, v35, v36
    v_max3_u32 v20, v20, v37, v38
    v_max3_u32 v20, v20, v39, v40
    v_max3_u32 v20, v20, v41, v42
    v_max3_u32 v20, v20, v43, v44
    v_max3_u32 v20, v20, v45, v46
    v_max3_u32 v20, v20, v47, v48
    v_max3_u32 v20, v20, v49, v50
    v_max3_u32 v20, v20, v51, v52
    v_max3_u32 v20, v20, v53, v54
    v_max3_u32 v20, v20, v55, v56
    v_max3_u32 v20, v20, v57, v58
    v_max3_u32 v20, v20, v59, v60
    v_max3_u32 v20, v20, v61, v62
    v_max3_u32 v20, v20, v63, v64
    v_max3_u32 v20, v20, v65, v66
    v_max3_u32 v20, v20, v67, v68
    v_max3_u32 v20, v20, v69, v70
    v_max3_u32 v20, v20, v71, v180
    v_max3_u32 v20, v20, v181, v182
    v_max3_u32 v20, v20, v183, v184
    v_max3_u32 v20, v20, v185, v186
    v_max_u32 v20, v20, v187
    v_cmp_eq_u32 vcc, -1, v20
    s_cbranch_vccz L_done14
    s_sleep 16
    s_cmp_lt_u32 s35, 60000
    s_cbranch_scc1 L_poll13
L_done14:
    v_mfma_f32_16x16x32_bf16 v[80:83], v[96:99], v[32:35], 0
    v_mfma_f32_16x16x32_bf16 v[84:87], v[100:103], v[32:35], 0
    v_mfma_f32_16x16x32_bf16 v[88:91], v[104:107], v[32:35], 0
    v_mfma_f32_16x16x32_bf16 v[92:95], v[108:111], v[32:35], 0
    v_mfma_f32_16x16x32_bf16 v[80:83], v[96:99], v[36:39], v[80:83]
    v_mfma_f32_16x16x32_bf16 v[84:87], v[100:103], v[36:39], v[84:87]
    v_mfma_f32_16x16x32_bf16 v[88:91], v[104:107], v[36:39], v[88:91]
    v_mfma_f32_16x16x32_bf16 v[92:95], v[108:111], v[36:39], v[92:95]
    v_mfma_f32_16x16x32_bf16 v[80:83], v[112:115], v[40:43], v[80:83]
    v_mfma_f32_16x16x32_bf16 v[84:87], v[116:119], v[40:43], v[84:87]
    v_mfma_f32_16x16x32_bf16 v[88:91], v[120:123], v[40:43], v[88:91]
    v_mfma_f32_16x16x32_bf16 v[92:95], v[124:127], v[40:43], v[92:95]
    v_mfma_f32_16x16x32_bf16 v[80:83], v[112:115], v[44:47], v[80:83]
    v_mfma_f32_16x16x32_bf16 v[84:87], v[116:119], v[44:47], v[84:87]
    v_mfma_f32_16x16x32_bf16 v[88:91], v[120:123], v[44:47], v[88:91]
    v_mfma_f32_16x16x32_bf16 v[92:95], v[124:127], v[44:47], v[92:95]
    v_mfma_f32_16x16x32_bf16 v[80:83], v[128:131], v[48:51], v[80:83]
    v_mfma_f32_16x16x32_bf16 v[84:87], v[132:135], v[48:51], v[84:87]
    v_mfma_f32_16x16x32_bf16 v[88:91], v[136:139], v[48:51], v[88:91]
    v_mfma_f32_16x16x32_bf16 v[92:95], v[140:143], v[48:51], v[92:95]
    v_mfma_f32_16x16x32_bf16 v[80:83], v[128:131], v[52:55], v[80:83]
    v_mfma_f32_16x16x32_bf16 v[84:87], v[132:135], v[52:55], v[84:87]
    v_mfma_f32_16x16x32_bf16 v[88:91], v[136:139], v[52:55], v[88:91]
    v_mfma_f32_16x16x32_bf16 v[92:95], v[140:143], v[52:55], v[92:95]
    v_mfma_f32_16x16x32_bf16 v[80:83], v[144:147], v[56:59], v[80:83]
    v_mfma_f32_16x16x32_bf16 v[84:87], v[148:151], v[56:59], v[84:87]
    v_mfma_f32_16x16x32_bf16 v[88:91], v[152:155], v[56:59], v[88:91]
    v_mfma_f32_16x16x32_bf16 v[92:95], v[156:159], v[56:59], v[92:95]
    v_mfma_f32_16x16x32_bf16 v[80:83], v[144:147], v[60:63], v[80:83]
    v_mfma_f32_16x16x32_bf16 v[84:87], v[148:151], v[60:63], v[84:87]
    v_mfma_f32_16x16x32_bf16 v[88:91], v[152:155], v[60:63], v[88:91]
    v_mfma_f32_16x16x32_bf16 v[92:95], v[156:159], v[60:63], v[92:95]
    v_mfma_f32_16x16x32_bf16 v[80:83], v[160:163], v[64:67], v[80:83]
    v_mfma_f32_16x16x32_bf16 v[84:87], v[164:167], v[64:67], v[84:87]
    v_mfma_f32_16x16x32_bf16 v[88:91], v[168:171], v[64:67], v[88:91]
    v_mfma_f32_16x16x32_bf16 v[92:95], v[172:175], v[64:67], v[92:95]
    v_mfma_f32_16x16x32_bf16 v[80:83], v[160:163], v[68:71], v[80:83]
    v_mfma_f32_16x16x32_bf16 v[84:87], v[164:167], v[68:71], v[84:87]
    v_mfma_f32_16x16x32_bf16 v[88:91], v[168:171], v[68:71], v[88:91]
    v_mfma_f32_16x16x32_bf16 v[92:95], v[172:175], v[68:71], v[92:95]
    s_lshl_b32 s34, s53, 15
    s_lshl_b32 s35, s49, 2
    s_add_u32 s34, s34, s35
    s_add_u32 s34, s34, 393216
    v_lshlrev_b32 v19, 7, v12
    v_lshl_add_u32 v19, v13, 5, v19
    v_lshl_add_u32 v19, v14, 3, v19
    v_add_u32 v19, s34, v19
    v_add_f32_dpp v20, v80, v80 row_ror:8 row_mask:0xf bank_mask:0x3
    v_add_f32_dpp v24, v84, v84 row_ror:8 row_mask:0xf bank_mask:0x3
    v_add_f32_dpp v21, v81, v81 row_ror:8 row_mask:0xf bank_mask:0x3
    v_add_f32_dpp v25, v85, v85 row_ror:8 row_mask:0xf bank_mask:0x3
    v_add_f32_dpp v22, v82, v82 row_ror:8 row_mask:0xf bank_mask:0x3
    v_add_f32_dpp v26, v86, v86 row_ror:8 row_mask:0xf bank_mask:0x3
    v_add_f32_dpp v23, v83, v83 row_ror:8 row_mask:0xf bank_mask:0x3
    v_add_f32_dpp v27, v87, v87 row_ror:8 row_mask:0xf bank_mask:0x3
    v_add_f32_dpp v20, v88, v88 row_ror:8 row_mask:0xf bank_mask:0xc
    v_add_f32_dpp v24, v92, v92 row_ror:8 row_mask:0xf bank_mask:0xc
    v_add_f32_dpp v21, v89, v89 row_ror:8 row_mask:0xf bank_mask:0xc
    v_add_f32_dpp v25, v93, v93 row_ror:8 row_mask:0xf bank_mask:0xc
    v_add_f32_dpp v22, v90, v90 row_ror:8 row_mask:0xf bank_mask:0xc
    v_add_f32_dpp v26, v94, v94 row_ror:8 row_mask:0xf bank_mask:0xc
    v_add_f32_dpp v23, v91, v91 row_ror:8 row_mask:0xf bank_mask:0xc
    v_add_f32_dpp v27, v95, v95 row_ror:8 row_mask:0xf bank_mask:0xc
    v_add_f32_dpp v28, v20, v20 row_shl:4 row_mask:0xf bank_mask:0x5
    v_add_f32_dpp v29, v21, v21 row_shl:4 row_mask:0xf bank_mask:0x5
    v_add_f32_dpp v30, v22, v22 row_shl:4 row_mask:0xf bank_mask:0x5
    v_add_f32_dpp v31, v23, v23 row_shl:4 row_mask:0xf bank_mask:0x5
    v_add_f32_dpp v28, v24, v24 row_shr:4 row_mask:0xf bank_mask:0xa
    v_add_f32_dpp v29, v25, v25 row_shr:4 row_mask:0xf bank_mask:0xa
    v_add_f32_dpp v30, v26, v26 row_shr:4 row_mask:0xf bank_mask:0xa
    v_add_f32_dpp v31, v27, v27 row_shr:4 row_mask:0xf bank_mask:0xa
    v_cvt_pk_bf16_f32 v20, v28, v29
    v_cvt_pk_bf16_f32 v21, v30, v31
    v_min_u32 v20, -2, v20
    v_min_u32 v21, -2, v21
    buffer_store_dwordx2 v[20:21], v19, s[44:47], 0 offen sc1
    s_cmp_eq_u32 s54, 0
    s_cbranch_scc1 L_nomf
    v_lshlrev_b32 v24, 16, v180
    v_and_b32 v25, 0xffff0000, v180
    v_lshlrev_b32 v26, 16, v181
    v_and_b32 v27, 0xffff0000, v181
    v_lshlrev_b32 v28, 16, v182
    v_and_b32 v29, 0xffff0000, v182
    v_lshlrev_b32 v30, 16, v183
    v_and_b32 v31, 0xffff0000, v183
    v_add_f32 v24, v24, v28
    v_add_f32 v25, v25, v29
    v_add_f32 v26, v26, v30
    v_add_f32 v27, v27, v31
    v_lshlrev_b32 v28, 16, v184
    v_and_b32 v29, 0xffff0000, v184
    v_lshlrev_b32 v30, 16, v185
    v_and_b32 v31, 0xffff0000, v185
    v_add_f32 v24, v24, v28
    v_add_f32 v25, v25, v29
    v_add_f32 v26, v26, v30
    v_add_f32 v27, v27, v31
    v_lshlrev_b32 v28, 16, v186
    v_and_b32 v29, 0xffff0000, v186
    v_lshlrev_b32 v30, 16, v187
    v_and_b32 v31, 0xffff0000, v187
    v_add_f32 v24, v24, v28
    v_add_f32 v25, v25, v29
    v_add_f32 v26, v26, v30
    v_add_f32 v27, v27, v31
    v_cvt_pk_bf16_f32 v22, v24, v25
    v_cvt_pk_bf16_f32 v23, v26, v27
    v_min_u32 v22, -2, v22
    v_min_u32 v23, -2, v23
    s_sub_u32 s34, s50, 20
    s_lshl_b32 s35, s34, 9
    v_subrev_u32 v199, s35, v199
    s_lshr_b32 s35, s34, 2
    s_lshl_b32 s35, s35, 9
    s_and_b32 s34, s34, 3
    s_lshl_b32 s34, s34, 15
    s_add_u32 s34, s34, s35
    s_add_u32 s34, s34, 1562624
    v_add_u32 v199, s34, v199
    buffer_store_dwordx2 v[22:23], v199, s[44:47], 0 offen sc1
L_nomf:
    s_and_b32 s34, s2, 127
    s_lshl_b32 s34, s34, 21
    s_lshr_b32 s35, s2, 7
    s_lshl_b32 s35, s35, 18
    s_add_u32 s34, s34, s35
    s_add_u32 s34, s34, 1572864
    s_mov_b32 s38, 0x40000
    s_mov_b32 s42, 0x40000
    s_waitcnt lgkmcnt(0)
    s_add_u32 s36, s6, s34
    s_addc_u32 s37, s7, 0
    s_add_u32 s40, s8, s34
    s_addc_u32 s41, s9, 0
    v_lshlrev_b32 v18, 4, v0
    s_mov_b32 s34, 258048
    buffer_load_dwordx4 v[128:131], v18, s[36:39], s34 offen offset:0 nt
    buffer_load_dwordx4 v[132:135], v18, s[36:39], s34 offen offset:1024 nt
    buffer_load_dwordx4 v[136:139], v18, s[36:39], s34 offen offset:2048 nt
    buffer_load_dwordx4 v[140:143], v18, s[36:39], s34 offen offset:3072 nt
    s_and_b32 s34, s2, 31
    s_lshl_b32 s34, s34, 10
    s_lshl_b32 s35, s53, 7
    s_add_u32 s34, s34, s35
    s_add_u32 s34, s34, 393216
    v_lshrrev_b32 v19, 5, v0
    v_mul_u32_u24 v19, 384, v19
    v_lshl_add_u32 v19, v0, 2, v19
    v_add_u32 v19, s34, v19
    v_mov_b32 v22, 99072
    s_and_b32 s34, s60, 3
    s_lshl_b32 s34, s34, 15
    s_lshr_b32 s35, s60, 2
    s_lshl_b32 s35, s35, 7
    s_add_u32 s34, s34, s35
    s_add_u32 s34, s34, 793344
    v_and_b32 v252, 31, v0
    v_lshl_add_u32 v252, v252, 2, s34
    v_mov_b32 v253, 0
    s_mov_b32 s35, 0
L_poll16:
    ds_read_b32 v23, v22
    s_add_u32 s35, s35, 1
    s_waitcnt lgkmcnt(0)
    v_cmp_gt_u32 vcc, 33, v23
    s_cbranch_vccz L_done17
    s_sleep 2
    s_cmp_lt_u32 s35, 60000
    s_cbranch_scc1 L_poll16
L_done17:
    buffer_load_dword v251, v252, s[44:47], 0 offen sc1
    s_lshl_b64 exec, 1, s61
    buffer_store_dword v253, v252, s[44:47], 0 offen
    s_mov_b64 exec, -1
    v_and_b32 v44, 15, v0
    v_lshlrev_b32 v44, 2, v44
    global_load_dword v44, v44, s[30:31] sc1
    s_mov_b32 s35, 0
L_poll19:
    buffer_load_dword v32, v19, s[44:47], 0 offen sc1
    buffer_load_dword v33, v19, s[44:47], s56 offen sc1
    buffer_load_dword v34, v19, s[44:47], s57 offen sc1
    buffer_load_dword v35, v19, s[44:47], s58 offen sc1
    s_add_u32 s35, s35, 1
    s_waitcnt vmcnt(0)
    v_max3_u32 v22, v32, v33, v34
    v_max_u32 v22, v22, v35
    v_cmp_eq_u32 vcc, -1, v22
    s_cbranch_vccz L_done20
    s_sleep 16
    s_cmp_lt_u32 s35, 60000
    s_cbranch_scc1 L_poll19
L_done20:
    v_cmp_ne_u32 vcc, -1, v251
    v_mov_b32 v252, 99076
    s_bcnt1_i32_b32 s34, vcc_lo
    v_mov_b32 v251, s34
    s_mov_b64 exec, 1
    ds_write_b32 v252, v251
    s_mov_b64 exec, -1
    v_add_u32_dpp v44, v44, v44 row_ror:8 row_mask:0xf bank_mask:0xf
    s_nop 1
    v_add_u32_dpp v44, v44, v44 row_ror:4 row_mask:0xf bank_mask:0xf
    s_nop 1
    v_add_u32_dpp v44, v44, v44 row_ror:2 row_mask:0xf bank_mask:0xf
    s_nop 1
    v_add_u32_dpp v44, v44, v44 row_ror:1 row_mask:0xf bank_mask:0xf
    s_nop 0
    v_readfirstlane_b32 s99, v44
    s_nop 0
    s_cmp_gt_i32 s99, 0
    s_cselect_b32 s99, 1, 0
    s_getreg_b32 s34, hwreg(HW_REG_XCC_ID, 2, 1)
    s_xor_b32 s99, s99, s34
    s_lshl_b32 s99, s99, 13
    v_mov_b32 v45, 99080
    v_mov_b32 v44, s99
    ds_write_b32 v45, v44
    v_lshlrev_b32 v36, 16, v32
    v_and_b32 v37, 0xffff0000, v32
    v_lshlrev_b32 v38, 16, v33
    v_and_b32 v39, 0xffff0000, v33
    v_lshlrev_b32 v40, 16, v34
    v_and_b32 v41, 0xffff0000, v34
    v_lshlrev_b32 v42, 16, v35
    v_and_b32 v43, 0xffff0000, v35
    v_pk_add_f32 v[36:37], v[36:37], v[38:39]
    v_pk_add_f32 v[40:41], v[40:41], v[42:43]
    v_pk_add_f32 v[36:37], v[36:37], v[40:41]
    v_cvt_pk_bf16_f32 v32, v36, v37
    v_min_u32 v32, -2, v32
    ds_write_b32 v1, v32
    s_mov_b32 s34, 258048
    buffer_load_dwordx4 v[144:147], v18, s[40:43], s34 offen offset:0 nt
    buffer_load_dwordx4 v[148:151], v18, s[40:43], s34 offen offset:1024 nt
    buffer_load_dwordx4 v[152:155], v18, s[40:43], s34 offen offset:2048 nt
    buffer_load_dwordx4 v[156:159], v18, s[40:43], s34 offen offset:3072 nt
    v_and_b32 v2, 15, v0
    v_lshlrev_b32 v2, 4, v2
    v_add_u32 v2, 98304, v2
    ds_read_b128 v[4:7], v2
    s_waitcnt lgkmcnt(0)
    v_dot2_f32_bf16 v8, v128, v4, 0
    v_dot2_f32_bf16 v9, v132, v4, 0
    v_dot2_f32_bf16 v10, v136, v4, 0
    v_dot2_f32_bf16 v11, v140, v4, 0
    v_dot2c_f32_bf16 v8, v129, v5
    v_dot2c_f32_bf16 v9, v133, v5
    v_dot2c_f32_bf16 v10, v137, v5
    v_dot2c_f32_bf16 v11, v141, v5
    v_dot2c_f32_bf16 v8, v130, v6
    v_dot2c_f32_bf16 v9, v134, v6
    v_dot2c_f32_bf16 v10, v138, v6
    v_dot2c_f32_bf16 v11, v142, v6
    v_dot2c_f32_bf16 v8, v131, v7
    v_dot2c_f32_bf16 v9, v135, v7
    v_dot2c_f32_bf16 v10, v139, v7
    v_dot2c_f32_bf16 v11, v143, v7
    v_add_f32_dpp v16, v8, v8 row_ror:8 row_mask:0xf bank_mask:0x3
    v_add_f32_dpp v16, v9, v9 row_ror:8 row_mask:0xf bank_mask:0xc
    v_add_f32_dpp v17, v10, v10 row_ror:8 row_mask:0xf bank_mask:0x3
    v_add_f32_dpp v17, v11, v11 row_ror:8 row_mask:0xf bank_mask:0xc
    v_add_f32_dpp v16, v16, v16 row_half_mirror row_mask:0xf bank_mask:0xf
    s_nop 0
    v_add_f32_dpp v17, v17, v17 row_half_mirror row_mask:0xf bank_mask:0xf
    v_add_f32_dpp v16, v16, v16 quad_perm:[1,0,3,2] row_mask:0xf bank_mask:0xf
    s_nop 0
    v_add_f32_dpp v17, v17, v17 quad_perm:[1,0,3,2] row_mask:0xf bank_mask:0xf
    v_add_f32_dpp v16, v16, v16 quad_perm:[2,3,0,1] row_mask:0xf bank_mask:0xf
    s_nop 0
    v_add_f32_dpp v17, v17, v17 quad_perm:[2,3,0,1] row_mask:0xf bank_mask:0xf
    v_max_f32 v8, v16, v17
    s_mov_b32 s34, 0x3e0293ee
    s_nop 0
    v_max_f32_dpp v8, v8, v8 row_ror:8 row_mask:0xf bank_mask:0xf
    v_mov_b32 v9, v8
    s_nop 1
    v_permlane16_swap_b32 v8, v9
    v_max_f32 v8, v8, v9
    v_mov_b32 v9, v8
    s_nop 1
    v_permlane32_swap_b32 v8, v9
    v_max_f32 v8, v8, v9
    v_mul_f32 v8, s34, v8
    v_fma_f32 v16, v16, s34, -v8
    v_fma_f32 v17, v17, s34, -v8
    v_exp_f32 v16, v16
    v_exp_f32 v17, v17
    s_nop 0
    v_add_f32 v9, v16, v17
    v_and_b32 v10, 1, v0
    v_lshlrev_b32 v10, 4, v10
    v_mov_b32 v11, 0xffff
    v_lshlrev_b32 v10, v10, v11
    v_bfe_u32 v11, v0, 1, 2
    v_cmp_eq_u32 vcc, 0, v11
    s_nop 1
    v_cndmask_b32 v20, 0, v10, vcc
    v_cmp_eq_u32 vcc, 1, v11
    s_nop 1
    v_cndmask_b32 v21, 0, v10, vcc
    v_cmp_eq_u32 vcc, 2, v11
    s_nop 1
    v_cndmask_b32 v22, 0, v10, vcc
    v_cmp_eq_u32 vcc, 3, v11
    s_nop 1
    v_cndmask_b32 v23, 0, v10, vcc
    v_add_f32_dpp v9, v9, v9 row_ror:8 row_mask:0xf bank_mask:0xf
    v_mov_b32 v10, v9
    s_nop 1
    v_permlane16_swap_b32 v9, v10
    v_add_f32 v9, v9, v10
    v_mov_b32 v10, v9
    s_nop 1
    v_permlane32_swap_b32 v9, v10
    v_add_f32 v9, v9, v10
    v_mov_b32 v10, 98616
    s_mov_b64 exec, 1
    ds_write_b64 v10, v[8:9]
    s_mov_b64 exec, -1
    s_waitcnt vmcnt(0)
    v_cvt_pk_bf16_f32 v10, v16, v16
    v_and_b32 v24, v10, v20
    v_and_b32 v25, v10, v21
    v_and_b32 v26, v10, v22
    v_and_b32 v27, v10, v23
    s_nop 1
    v_mfma_f32_16x16x32_bf16 v[116:119], v[144:147], v[24:27], 0
    v_mfma_f32_16x16x32_bf16 v[120:123], v[148:151], v[24:27], 0
    v_cvt_pk_bf16_f32 v10, v17, v17
    v_and_b32 v28, v10, v20
    v_and_b32 v29, v10, v21
    v_and_b32 v30, v10, v22
    v_and_b32 v31, v10, v23
    s_nop 1
    v_mfma_f32_16x16x32_bf16 v[116:119], v[152:155], v[28:31], v[116:119]
    v_mfma_f32_16x16x32_bf16 v[120:123], v[156:159], v[28:31], v[120:123]
    s_mov_b32 s34, 106496
    v_lshrrev_b32 v16, 4, v0
    v_and_b32 v17, 7, v0
    v_lshl_add_u32 v16, v16, 3, v17
    v_bfe_u32 v17, v0, 3, 1
    v_lshl_add_u32 v16, v17, 5, v16
    v_lshl_add_u32 v16, v16, 4, s34
    s_nop 0
    v_add_f32_dpp v116, v120, v116 row_ror:8 row_mask:0xf bank_mask:0xf
    v_add_f32_dpp v117, v121, v117 row_ror:8 row_mask:0xf bank_mask:0xf
    v_add_f32_dpp v118, v122, v118 row_ror:8 row_mask:0xf bank_mask:0xf
    v_add_f32_dpp v119, v123, v119 row_ror:8 row_mask:0xf bank_mask:0xf
    ds_write_b128 v16, v[116:119]
    v_lshl_add_u32 v16, v0, 3, s34
    ds_read_b64 v[116:117], v16
    s_waitcnt lgkmcnt(0)
    s_mov_b32 s63, 0
    s_mov_b32 s62, s61
    s_cmp_lt_u32 s61, 20
    s_cbranch_scc1 L_rd22
    s_mul_i32 s62, s60, 12
    s_add_u32 s62, s62, s61
    s_sub_u32 s62, s62, 20
    s_mov_b32 s63, 1
    s_cmp_lt_u32 s62, 54
    s_cbranch_scc1 L_rd22
    s_cmp_lt_u32 s62, 56
    s_cselect_b32 s63, 3, 2
    s_sub_u32 s62, s62, 56
L_rd22:
    v_and_b32 v8, 3, v0
    v_bfe_u32 v9, v0, 2, 2
    v_lshrrev_b32 v10, 4, v0
    s_mov_b32 s55, 0x20000
    s_lshl_b32 s35, s62, 6
    s_and_b32 s49, s62, 1
    s_cmp_eq_u32 s63, 0
    s_cbranch_scc1 L_dp24
    s_cmp_eq_u32 s63, 1
    s_cbranch_scc1 L_dp25
    s_mov_b32 s52, s20
    s_mov_b32 s53, s21
    s_mov_b32 s54, 2211840
    v_mov_b32 v15, 0
    s_branch L_dp26
L_dp25:
    s_mov_b32 s52, s16
    s_mov_b32 s53, s17
    s_mov_b32 s54, 2211840
    v_lshl_add_u32 v15, v9, 3, v10
    v_mul_u32_u24 v15, 3456, v15
    v_lshl_add_u32 v15, v8, 4, v15
    v_add_u32 v15, s35, v15
    s_bfe_u32 s50, s3, 0x10001
    s_lshl_b32 s50, s50, 7
    s_and_b32 s34, s3, 1
    s_lshl_b32 s34, s34, 2
    s_add_u32 s50, s50, s34
    s_and_b32 s51, s3, 3
    s_lshl_b32 s51, s51, 5
    s_add_u32 s51, s51, 512
    s_mul_i32 s50, s50, 3456
    s_mul_i32 s51, s51, 3456
    s_branch L_dp26
L_dp24:
    s_mov_b32 s52, s12
    s_mov_b32 s53, s13
    s_mov_b32 s54, 5242880
    s_lshr_b32 s50, s3, 1
    s_lshl_b32 s50, s50, 3
    s_add_u32 s50, s50, s60
    s_and_b32 s51, s3, 1
    s_lshl_b32 s34, s50, 1
    s_add_u32 s34, s34, s51
    s_mul_i32 s34, s34, 81920
    s_add_u32 s34, s34, s35
    v_lshl_add_u32 v15, v9, 2, v10
    v_mul_u32_u24 v15, 2560, v15
    v_lshl_add_u32 v15, v8, 4, v15
    v_add_u32 v15, s34, v15
    s_lshl_b32 s56, s3, 12
    s_lshl_b32 s34, s49, 11
    s_add_u32 s56, s56, s34
    s_add_u32 s56, s56, 40960
    s_add_u32 s58, s56, 1024
    s_mul_i32 s57, s49, 40960
    s_add_u32 s59, s57, 1280
L_dp26:
    v_and_b32 v200, 3, v0
    v_bfe_u32 v201, v0, 2, 2
    v_lshrrev_b32 v202, 4, v0
    s_lshl_b32 s34, s3, 10
    s_add_u32 s34, s34, 122112
    v_mul_u32_u24 v203, 320, v201
    v_min_u32 v203, 704, v203
    v_lshl_add_u32 v203, v202, 6, v203
    v_lshl_add_u32 v203, v200, 4, v203
    v_add_u32 v203, s34, v203
    s_movk_i32 s48, 16384
    v_mov_b32 v197, 0
    s_mov_b32 s40, 0
    s_mov_b32 s41, 0
    s_mov_b32 s42, 0
    s_cmp_eq_u32 s63, 0
    s_cbranch_scc1 L_d_wo
    s_cmp_eq_u32 s63, 2
    s_cbranch_scc1 L_d_w2
    s_cmp_eq_u32 s63, 3
    s_cbranch_scc1 L_d_none
    v_and_b32 v205, 15, v0
    v_lshlrev_b32 v205, 4, v205
    s_and_b32 s49, s3, 3
    s_mul_i32 s34, s49, 1280
    s_add_u32 s34, s34, s99
    s_add_u32 s34, s34, 786432
    v_lshl_add_u32 v206, v202, 15, v205
    v_add_u32 v206, s34, v206
    s_mul_i32 s34, s49, 3840
    v_add_u32 v205, s34, v205
    s_lshl_b32 s34, s62, 6
    v_lshlrev_b32 v5, 4, v14
    v_lshl_add_u32 v5, v12, 2, v5
    v_add_u32 v5, s34, v5
    global_load_dword v6, v5, s[18:19]
    v_and_b32 v7, 15, v0
    v_lshlrev_b32 v7, 4, v7
    v_mul_u32_u24 v8, 1280, v14
    v_add_u32 v8, v8, v7
    v_bfe_u32 v9, v0, 3, 1
    v_lshlrev_b32 v9, 15, v9
    v_lshl_add_u32 v9, v14, 7, v9
    v_and_b32 v10, 7, v0
    v_lshl_add_u32 v9, v10, 4, v9
    v_add_u32 v9, 1572864, v9
    s_mov_b32 s57, 65536
    v_mul_u32_u24 v5, 3840, v14
    v_add_u32 v5, v5, v7
    global_load_dwordx4 v[32:35], v8, s[4:5] offset:0
    global_load_dwordx4 v[36:39], v8, s[4:5] offset:256
    global_load_dwordx4 v[40:43], v8, s[4:5] offset:512
    global_load_dwordx4 v[44:47], v8, s[4:5] offset:768
    global_load_dwordx4 v[48:51], v8, s[4:5] offset:1024
    s_mov_b32 s35, 0
L_poll27:
    buffer_load_dwordx4 v[52:55], v9, s[44:47], s57 offen offset:1024 sc1
    buffer_load_dwordx4 v[56:59], v9, s[44:47], 0 offen offset:1536 sc1
    buffer_load_dwordx4 v[60:63], v9, s[44:47], s57 offen offset:1536 sc1
    buffer_load_dwordx4 v[64:67], v9, s[44:47], 0 offen offset:2048 sc1
    buffer_load_dwordx4 v[68:71], v9, s[44:47], s57 offen offset:2048 sc1
    buffer_load_dwordx4 v[72:75], v9, s[44:47], 0 offen offset:2560 sc1
    buffer_load_dwordx4 v[76:79], v9, s[44:47], s57 offen offset:2560 sc1
    buffer_load_dwordx4 v[80:83], v9, s[44:47], 0 offen offset:3072 sc1
    buffer_load_dwordx4 v[84:87], v9, s[44:47], s57 offen offset:3072 sc1
    buffer_load_dwordx4 v[88:91], v9, s[44:47], 0 offen offset:3584 sc1
    s_add_u32 s35, s35, 1
    s_waitcnt vmcnt(0)
    v_max3_u32 v28, v52, v53, v54
    v_max3_u32 v28, v28, v55, v56
    v_max3_u32 v28, v28, v57, v58
    v_max3_u32 v28, v28, v59, v60
    v_max3_u32 v28, v28, v61, v62
    v_max3_u32 v28, v28, v63, v64
    v_max3_u32 v28, v28, v65, v66
    v_max3_u32 v28, v28, v67, v68
    v_max3_u32 v28, v28, v69, v70
    v_max3_u32 v28, v28, v71, v72
    v_max3_u32 v28, v28, v73, v74
    v_max3_u32 v28, v28, v75, v76
    v_max3_u32 v28, v28, v77, v78
    v_max3_u32 v28, v28, v79, v80
    v_max3_u32 v28, v28, v81, v82
    v_max3_u32 v28, v28, v83, v84
    v_max3_u32 v28, v28, v85, v86
    v_max3_u32 v28, v28, v87, v88
    v_max3_u32 v28, v28, v89, v90
    v_max_u32 v28, v28, v91
    v_cmp_eq_u32 vcc, -1, v28
    s_cbranch_vccz L_done28
    s_sleep 16
    s_cmp_lt_u32 s35, 60000
    s_cbranch_scc1 L_poll27
L_done28:
    ds_write_b128 v5, v[32:35] offset:0
    ds_write_b128 v5, v[36:39] offset:256
    ds_write_b128 v5, v[40:43] offset:512
    ds_write_b128 v5, v[44:47] offset:768
    ds_write_b128 v5, v[48:51] offset:1024
    ds_write_b128 v5, v[52:55] offset:1280
    ds_write_b128 v5, v[56:59] offset:1536
    ds_write_b128 v5, v[60:63] offset:1792
    ds_write_b128 v5, v[64:67] offset:2048
    ds_write_b128 v5, v[68:71] offset:2304
    ds_write_b128 v5, v[72:75] offset:2560
    ds_write_b128 v5, v[76:79] offset:2816
    ds_write_b128 v5, v[80:83] offset:3072
    ds_write_b128 v5, v[84:87] offset:3328
    ds_write_b128 v5, v[88:91] offset:3584
    s_waitcnt lgkmcnt(0)
    v_lshlrev_b32 v100, 16, v6
    v_and_b32 v101, 0xffff0000, v6
    s_cmp_eq_u32 s60, 4
    s_cselect_b32 s40, 6, 12
    s_mov_b32 s41, 5462
    s_cmov_b32 s41, 10923
    s_cselect_b32 s34, 20, 20
    s_mov_b32 s49, 17280
    s_cmov_b32 s49, 34560
    v_min_u32 v196, 59, v0
    v_mul_u32_u24 v197, s41, v196
    v_lshrrev_b32 v197, 16, v197
    v_mul_u32_u24 v194, s40, v197
    v_sub_u32 v196, v196, v194
    v_mul_u32_u24 v197, 3456, v197
    v_lshl_add_u32 v197, v196, 6, v197
    s_mul_i32 s35, s60, 768
    s_add_i32 s35, s35, 0
    s_cmp_eq_u32 s60, 4
    s_cselect_b32 s35, 3072, s35
    s_sub_u32 s34, s61, s34
    s_mul_i32 s34, s34, s49
    s_mul_i32 s34, s34, 11
    s_add_u32 s34, s34, s35
    v_add_u32 v197, s34, v197
    s_mov_b32 s40, s49
    s_mov_b32 s41, s49
    s_branch L_d_none
L_d_w2:
    s_lshl_b32 s34, s62, 5
    v_lshl_add_u32 v3, v14, 3, s34
    global_load_dwordx2 v[20:21], v3, s[22:23]
    v_mul_u32_u24 v112, 1280, v12
    v_add_u32 v112, v112, v3
    global_load_dwordx2 v[22:23], v112, s[4:5]
    s_lshr_b32 s34, s62, 2
    s_add_u32 s34, s34, 30
    s_lshr_b32 s35, s34, 2
    s_lshl_b32 s35, s35, 9
    s_and_b32 s34, s34, 3
    s_lshl_b32 s34, s34, 15
    s_add_u32 s34, s34, s35
    s_and_b32 s35, s62, 3
    s_mul_i32 s35, s35, 32
    s_add_u32 s34, s34, s35
    s_add_u32 s34, s34, 1572864
    v_lshlrev_b32 v5, 7, v12
    v_lshl_add_u32 v5, v14, 3, v5
    v_add_u32 v5, s34, v5
    s_waitcnt vmcnt(0)
    v_lshlrev_b32 v32, 16, v20
    v_and_b32 v33, 0xffff0000, v20
    v_lshlrev_b32 v34, 16, v21
    v_and_b32 v35, 0xffff0000, v21
    v_lshlrev_b32 v108, 16, v22
    v_and_b32 v109, 0xffff0000, v22
    v_lshlrev_b32 v110, 16, v23
    v_and_b32 v111, 0xffff0000, v23
    s_mov_b32 s35, 0
L_poll30:
    buffer_load_dwordx2 v[24:25], v5, s[44:47], 0 offen sc1
    s_add_u32 s35, s35, 1
    s_waitcnt vmcnt(0)
    v_max_u32 v28, v24, v25
    v_cmp_eq_u32 vcc, -1, v28
    s_cbranch_vccz L_done31
    s_sleep 16
    s_cmp_lt_u32 s35, 60000
    s_cbranch_scc1 L_poll30
L_done31:
    v_lshlrev_b32 v104, 16, v24
    v_and_b32 v105, 0xffff0000, v24
    v_lshlrev_b32 v106, 16, v25
    v_and_b32 v107, 0xffff0000, v25
    v_fma_f32 v108, v104, v32, v108
    v_fma_f32 v109, v105, v33, v109
    v_fma_f32 v110, v106, v34, v110
    v_fma_f32 v111, v107, v35, v111
    v_mul_f32 v108, 0x3e800000, v108
    v_mul_f32 v109, 0x3e800000, v109
    v_mul_f32 v110, 0x3e800000, v110
    v_mul_f32 v111, 0x3e800000, v111
    v_lshl_add_u32 v204, v13, 15, v112
    s_add_u32 s34, s99, 786432
    v_add_u32 v204, s34, v204
    s_cmp_eq_u32 s60, 4
    s_cselect_b32 s40, 2, 6
    s_mov_b32 s41, 10923
    s_cmov_b32 s41, 32769
    s_cselect_b32 s34, 28, 20
    s_mov_b32 s49, 12800
    s_cmov_b32 s49, 38400
    v_min_u32 v196, 59, v0
    v_mul_u32_u24 v197, s41, v196
    v_lshrrev_b32 v197, 16, v197
    v_mul_u32_u24 v194, s40, v197
    v_sub_u32 v196, v196, v194
    v_mul_u32_u24 v197, 1280, v197
    v_lshl_add_u32 v197, v196, 6, v197
    s_mul_i32 s35, s60, 384
    s_add_i32 s35, s35, -1792
    s_cmp_eq_u32 s60, 4
    s_cselect_b32 s35, 0, s35
    s_sub_u32 s34, s61, s34
    s_mul_i32 s34, s34, s49
    s_mul_i32 s34, s34, 15
    s_add_u32 s34, s34, s35
    v_add_u32 v197, s34, v197
    s_mov_b32 s40, s49
    s_mov_b32 s41, s49
    s_branch L_d_none
L_d_wo:
    s_lshr_b32 s49, s3, 1
    s_lshl_b32 s49, s49, 15
    v_and_b32 v210, 7, v0
    s_mul_i32 s34, s60, 4096
    s_add_u32 s34, s34, s49
    s_add_u32 s34, s34, 1179904
    v_lshrrev_b32 v211, 3, v0
    v_mul_u32_u24 v205, 512, v211
    v_add_u32 v204, s34, v205
    s_lshl_b32 s35, s51, 7
    s_add_u32 s34, s34, s35
    s_sub_u32 s34, s34, 256
    v_lshl_add_u32 v205, v210, 4, v205
    v_add_u32 v205, s34, v205
    s_lshl_b32 s34, s3, 12
    s_add_u32 s34, s34, 40960
    v_lshrrev_b32 v206, 2, v0
    v_lshlrev_b32 v206, 6, v206
    v_lshl_add_u32 v206, v200, 3, v206
    v_add_u32 v206, s34, v206
    s_mul_i32 s34, s3, 1152
    s_add_u32 s34, s34, 107520
    v_mul_u32_u24 v207, 144, v211
    v_lshl_add_u32 v207, v210, 4, v207
    v_add_u32 v207, s34, v207
    v_mul_u32_u24 v208, 144, v210
    v_lshl_add_u32 v208, v202, 4, v208
    v_add_u32 v208, s34, v208
    v_mul_u32_u24 v212, 144, v211
    v_add_u32 v212, s34, v212
    v_mul_u32_u24 v213, 144, v210
    v_add_u32 v213, s34, v213
    v_and_b32 v211, 1, v211
    v_bfe_u32 v203, v0, 1, 2
    v_mul_u32_u24 v203, 144, v203
    v_and_b32 v214, 1, v0
    v_mul_u32_u24 v214, 576, v214
    v_lshl_add_u32 v214, v211, 6, v214
    v_lshl_add_u32 v214, v202, 4, v214
    s_add_u32 s34, s34, 14592
    v_add3_u32 v203, v203, v214, s34
    v_mov_b32 v210, 98816
    v_cmp_eq_u32 vcc, 0, v211
    s_nop 1
    v_cndmask_b32 v209, v208, v210, vcc
    v_cndmask_b32 v208, v210, v208, vcc
    v_and_b32 v8, 15, v0
    s_lshr_b32 s34, s62, 1
    s_add_u32 s34, s34, 0
    s_lshr_b32 s35, s34, 2
    s_lshl_b32 s35, s35, 9
    s_and_b32 s34, s34, 3
    s_lshl_b32 s34, s34, 15
    s_add_u32 s34, s34, s35
    s_and_b32 s35, s62, 1
    s_mul_i32 s35, s35, 64
    s_add_u32 s34, s34, s35
    s_add_u32 s34, s34, 1572864
    v_lshlrev_b32 v9, 2, v8
    v_lshl_add_u32 v9, v14, 7, v9
    v_add_u32 v9, s34, v9
    s_lshr_b32 s34, s60, 2
    s_lshl_b32 s34, s34, 14
    s_and_b32 s35, s60, 3
    s_lshl_b32 s35, s35, 15
    s_add_u32 s34, s34, s35
    s_lshl_b32 s35, s62, 6
    s_add_u32 s34, s34, s35
    s_add_u32 s34, s34, 786432
    v_mul_u32_u24 v112, 1280, v14
    v_lshl_add_u32 v112, v8, 2, v112
    v_add_u32 v112, s34, v112
    v_add_u32 v114, 917504, v112
    v_mul_u32_u24 v113, 144, v14
    v_lshl_add_u32 v113, v8, 3, v113
    v_add_u32 v113, 122112, v113
    s_bfe_u32 s35, s60, 0x10002
    s_lshl_b32 s35, s35, 13
    s_xor_b32 s101, s99, s35
    s_xor_b32 s93, s101, 8192
    s_mul_i32 s34, s62, 52
    s_lshr_b32 s34, s34, 8
    s_mul_i32 s35, s34, 5
    s_sub_u32 s35, s62, s35
    s_mul_i32 s34, s34, 1310720
    s_lshl_b32 s35, s35, 15
    s_add_u32 s34, s34, s35
    s_mul_i32 s35, s60, 163840
    s_add_u32 s34, s34, s35
    v_lshl_add_u32 v197, v0, 6, s34
    s_movk_i32 s40, 4096
    s_movk_i32 s41, 4096
    s_mov_b32 s35, 0
L_poll33:
    buffer_load_dword v32, v9, s[44:47], 0 offen sc1
    s_add_u32 s35, s35, 1
    s_waitcnt vmcnt(0)
    v_mov_b32 v22, v32
    v_cmp_eq_u32 vcc, -1, v22
    s_cbranch_vccz L_done34
    s_sleep 16
    s_cmp_lt_u32 s35, 60000
    s_cbranch_scc1 L_poll33
L_done34:
    v_lshlrev_b32 v100, 16, v32
    v_and_b32 v101, 0xffff0000, v32
L_d_none:
    v_mov_b32 v22, 99072
    s_and_b32 s34, s60, 3
    s_lshl_b32 s34, s34, 15
    s_lshr_b32 s35, s60, 2
    s_lshl_b32 s35, s35, 7
    s_add_u32 s34, s34, s35
    s_add_u32 s34, s34, 793600
    v_and_b32 v252, 31, v0
    v_lshl_add_u32 v252, v252, 2, s34
    v_mov_b32 v253, 0
    s_mov_b32 s35, 0
L_poll36:
    ds_read_b32 v23, v22
    s_add_u32 s35, s35, 1
    s_waitcnt lgkmcnt(0)
    v_cmp_gt_u32 vcc, 46, v23
    s_cbranch_vccz L_done37
    s_sleep 2
    s_cmp_lt_u32 s35, 60000
    s_cbranch_scc1 L_poll36
L_done37:
    buffer_load_dword v251, v252, s[44:47], 0 offen sc1
    s_lshl_b64 exec, 1, s61
    buffer_store_dword v253, v252, s[44:47], 0 offen
    s_mov_b64 exec, -1
    s_waitcnt vmcnt(1)
    v_cmp_ne_u32 vcc, -1, v251
    v_mov_b32 v252, 99076
    s_bcnt1_i32_b32 s34, vcc_lo
    v_mov_b32 v251, s34
    s_mov_b64 exec, 1
    ds_write_b32 v252, v251
    s_mov_b64 exec, -1
    v_mov_b32 v22, 99072
    s_and_b32 s34, s60, 3
    s_lshl_b32 s34, s34, 15
    s_lshr_b32 s35, s60, 2
    s_lshl_b32 s35, s35, 7
    s_add_u32 s34, s34, s35
    s_add_u32 s34, s34, 793856
    v_and_b32 v252, 31, v0
    v_lshl_add_u32 v252, v252, 2, s34
    v_mov_b32 v253, 0
    s_mov_b32 s35, 0
L_poll39:
    ds_read_b32 v23, v22
    s_add_u32 s35, s35, 1
    s_waitcnt lgkmcnt(0)
    v_cmp_gt_u32 vcc, 57, v23
    s_cbranch_vccz L_done40
    s_sleep 2
    s_cmp_lt_u32 s35, 60000
    s_cbranch_scc1 L_poll39
L_done40:
    buffer_load_dword v251, v252, s[44:47], 0 offen sc1
    s_lshl_b64 exec, 1, s61
    buffer_store_dword v253, v252, s[44:47], 0 offen
    s_mov_b64 exec, -1
    s_waitcnt vmcnt(1)
    v_cmp_ne_u32 vcc, -1, v251
    v_mov_b32 v252, 99076
    s_bcnt1_i32_b32 s34, vcc_lo
    v_mov_b32 v251, s34
    s_mov_b64 exec, 1
    ds_write_b32 v252, v251
    s_mov_b64 exec, -1
    v_and_b32 v19, 7, v0
    v_lshlrev_b32 v19, 3, v19
    v_add_u32 v19, 98560, v19
    s_mov_b32 s35, 0
L_poll42:
    ds_read_b64 v[20:21], v19
    s_add_u32 s35, s35, 1
    s_waitcnt lgkmcnt(0)
    v_max_u32 v22, v20, v21
    v_cmp_eq_u32 vcc, -1, v22
    s_cbranch_vccz L_done43
    s_sleep 2
    s_cmp_lt_u32 s35, 60000
    s_cbranch_scc1 L_poll42
L_done43:
    v_max_f32_dpp v22, v20, v20 row_half_mirror row_mask:0xf bank_mask:0xf
    s_nop 1
    v_max_f32_dpp v22, v22, v22 quad_perm:[1,0,3,2] row_mask:0xf bank_mask:0xf
    s_nop 1
    v_max_f32_dpp v22, v22, v22 quad_perm:[2,3,0,1] row_mask:0xf bank_mask:0xf
    v_sub_f32 v20, v20, v22
    v_exp_f32 v20, v20
    s_nop 0
    v_mul_f32 v21, v21, v20
    s_nop 1
    v_add_f32_dpp v21, v21, v21 row_half_mirror row_mask:0xf bank_mask:0xf
    s_nop 1
    v_add_f32_dpp v21, v21, v21 quad_perm:[1,0,3,2] row_mask:0xf bank_mask:0xf
    s_nop 1
    v_add_f32_dpp v21, v21, v21 quad_perm:[2,3,0,1] row_mask:0xf bank_mask:0xf
    v_rcp_f32 v23, v21
    v_log_f32 v21, v21
    v_mul_f32 v20, v20, v23
    v_add_f32 v21, v21, v22
    v_min_u32 v21, -2, v21
    v_readlane_b32 s88, v20, 0
    v_readlane_b32 s90, v20, 1
    v_readlane_b32 s92, v20, 2
    v_readlane_b32 s94, v20, 3
    v_readlane_b32 s96, v20, 4
    v_readlane_b32 s98, v20, 5
    v_readlane_b32 s100, v20, 6
    v_readlane_b32 s89, v20, 7
    s_and_b32 s95, s61, 3
    s_lshl_b32 s95, s95, 15
    s_bfe_u32 s35, s2, 0x20005
    s_lshl_b32 s35, s35, 1
    s_lshr_b32 s91, s2, 7
    s_add_u32 s35, s35, s91
    s_getreg_b32 s91, hwreg(HW_REG_XCC_ID, 0, 4)
    v_and_b32 v24, 1, v0
    v_cmp_eq_u32 vcc, 0, v24
    v_mov_b32 v25, s91
    s_nop 0
    v_cndmask_b32 v25, v25, v21, vcc
    v_mul_f32 v20, s89, v116
    v_mul_f32 v21, s89, v117
    s_mul_i32 s34, s60, 4096
    s_mul_i32 s35, s35, 512
    s_add_u32 s34, s34, s35
    s_add_u32 s34, s34, s95
    s_add_u32 s34, s34, 1179648
    v_lshl_add_u32 v26, v0, 2, s34
    v_lshlrev_b32 v19, 3, v0
    v_add_u32 v19, 99328, v19
    v_lshlrev_b32 v18, 4, v0
    v_add_u32 v18, 131328, v18
    s_mov_b32 s36, s12
    s_mov_b32 s37, s13
    s_mov_b32 s38, 5242880
    s_and_b32 s34, s61, 24
    s_add_u32 s34, s34, s60
    s_mul_i32 s34, s34, 163840
    s_and_b32 s35, s61, 7
    s_mul_i32 s35, s35, 20480
    s_add_u32 s34, s34, s35
    v_lshl_add_u32 v195, v0, 6, s34
    s_mov_b32 s34, 0
    s_barrier
    buffer_load_dword v250, v195, s[36:39], s34 offen
    s_add_u32 s34, s34, 4096
    buffer_load_dword v250, v195, s[36:39], s34 offen
    s_add_u32 s34, s34, 4096
    buffer_load_dword v250, v195, s[36:39], s34 offen
    s_add_u32 s34, s34, 4096
    buffer_load_dword v250, v195, s[36:39], s34 offen
    s_add_u32 s34, s34, 4096
    buffer_load_dword v250, v195, s[36:39], s34 offen
    s_add_u32 s34, s34, 4096
    s_cmp_lt_u32 s63, 1
    s_cbranch_scc1 L_nopf
    buffer_load_dword v250, v197, s[52:55], s42 offen
    s_add_u32 s42, s42, s40
    buffer_load_dword v250, v197, s[52:55], s42 offen
    s_add_u32 s42, s42, s41
L_nopf:
    s_cmp_eq_u32 s97, 0
    s_barrier
    ds_read_b64 v[32:33], v19 offset:0
    ds_read_b64 v[34:35], v19 offset:1024
    ds_read_b64 v[36:37], v19 offset:2048
    ds_read_b64 v[38:39], v19 offset:3072
    ds_read_b64 v[40:41], v19 offset:4096
    ds_read_b64 v[42:43], v19 offset:5120
    ds_read_b64 v[44:45], v19 offset:6144
    buffer_store_dword v25, v26, s[44:47], 0 offen offset:256
    s_waitcnt lgkmcnt(6)
    v_pk_fma_f32 v[20:21], v[32:33], s[88:89], v[20:21] op_sel_hi:[1,0,1]
    s_waitcnt lgkmcnt(5)
    v_pk_fma_f32 v[20:21], v[34:35], s[90:91], v[20:21] op_sel_hi:[1,0,1]
    s_waitcnt lgkmcnt(4)
    v_pk_fma_f32 v[20:21], v[36:37], s[92:93], v[20:21] op_sel_hi:[1,0,1]
    s_waitcnt lgkmcnt(3)
    v_pk_fma_f32 v[20:21], v[38:39], s[94:95], v[20:21] op_sel_hi:[1,0,1]
    s_waitcnt lgkmcnt(2)
    v_pk_fma_f32 v[20:21], v[40:41], s[96:97], v[20:21] op_sel_hi:[1,0,1]
    s_waitcnt lgkmcnt(1)
    v_pk_fma_f32 v[20:21], v[42:43], s[98:99], v[20:21] op_sel_hi:[1,0,1]
    s_waitcnt lgkmcnt(0)
    v_pk_fma_f32 v[20:21], v[44:45], s[100:101], v[20:21] op_sel_hi:[1,0,1]
    v_cvt_pk_bf16_f32 v24, v20, v21
    v_min_u32 v24, -2, v24
    buffer_store_dword v24, v26, s[44:47], 0 offen
    s_cbranch_scc1 L_ostd
    buffer_store_dword v24, v26, s[44:47], 0 offen sc1
    buffer_store_dword v25, v26, s[44:47], 0 offen offset:256 sc1
L_ostd:
    ds_write_b96 v18, v[24:26]
    s_cmp_lt_u32 s63, 1
    s_cbranch_scc1 L_nopf2
    buffer_load_dword v250, v197, s[52:55], s42 offen
    s_add_u32 s42, s42, s40
    buffer_load_dword v250, v197, s[52:55], s42 offen
    s_add_u32 s42, s42, s41
    buffer_load_dword v250, v197, s[52:55], s42 offen
    s_add_u32 s42, s42, s40
    buffer_load_dword v250, v197, s[52:55], s42 offen
    s_add_u32 s42, s42, s41
    buffer_load_dword v250, v197, s[52:55], s42 offen
    s_add_u32 s42, s42, s40
    buffer_load_dword v250, v197, s[52:55], s42 offen
    s_add_u32 s42, s42, s41
    buffer_load_dword v250, v197, s[52:55], s42 offen
    s_add_u32 s42, s42, s40
    buffer_load_dword v250, v197, s[52:55], s42 offen
    s_add_u32 s42, s42, s41
L_nopf2:
    s_waitcnt lgkmcnt(0)
    s_barrier
    s_cmp_eq_u32 s63, 0
    s_cbranch_scc1 L_r_wo2
    buffer_load_dword v250, v197, s[52:55], s42 offen
    s_add_u32 s42, s42, s40
    s_cmp_eq_u32 s63, 1
    s_cbranch_scc1 L_r_w1
    buffer_load_dword v250, v197, s[52:55], s42 offen
    s_add_u32 s42, s42, s40
    buffer_load_dword v250, v197, s[52:55], s42 offen
    s_add_u32 s42, s42, s41
    buffer_load_dword v250, v197, s[52:55], s42 offen
    s_add_u32 s42, s42, s40
    buffer_load_dword v250, v197, s[52:55], s42 offen
    s_add_u32 s42, s42, s41
    s_cmp_eq_u32 s63, 2
    s_cbranch_scc1 L_w2_red
    s_waitcnt vmcnt(0)
    s_mov_b64 exec, -1
    v_lshlrev_b32 v243, 4, v0
    v_add_u32 v243, 131328, v243
    ds_read_b96 v[240:242], v243
    s_waitcnt lgkmcnt(0)
    buffer_store_dword v240, v242, s[44:47], 0 offen sc1
    buffer_store_dword v241, v242, s[44:47], 0 offen offset:256 sc1
    s_branch L_fin
L_stream:
    s_sub_u32 s49, s3, 1
    s_lshl_b32 s49, s49, 12
    v_lshl_add_u32 v1, v0, 4, s49
    s_and_b32 s34, s2, 127
    s_lshl_b32 s34, s34, 21
    s_lshr_b32 s35, s2, 7
    s_lshl_b32 s35, s35, 18
    s_add_u32 s34, s34, s35
    s_add_u32 s34, s34, 1572864
    s_mov_b32 s38, 0x40000
    s_mov_b32 s42, 0x40000
    s_waitcnt lgkmcnt(0)
    s_add_u32 s36, s6, s34
    s_addc_u32 s37, s7, 0
    s_add_u32 s40, s8, s34
    s_addc_u32 s41, s9, 0
    s_barrier
    s_waitcnt vmcnt(2)
    buffer_load_dwordx4 v[28:31], v1, s[36:39], s98 offen offset:3072 nt
    s_waitcnt vmcnt(2)
    s_add_u32 s98, s98, 28672
    s_cmp_eq_u32 s98, 258048
    s_cselect_b32 s98, 0, s98
    buffer_load_dwordx4 v[32:35], v1, s[36:39], s98 offen offset:0 nt
    s_waitcnt vmcnt(2)
    buffer_load_dwordx4 v[36:39], v1, s[36:39], s98 offen offset:1024 nt
    s_waitcnt vmcnt(2)
    buffer_load_dwordx4 v[40:43], v1, s[36:39], s98 offen offset:2048 nt
    s_waitcnt vmcnt(2)
    buffer_load_dwordx4 v[44:47], v1, s[36:39], s98 offen offset:3072 nt
    s_add_u32 s44, s32, 0
    s_addc_u32 s45, s33, 0
    s_mov_b32 s63, 0
    s_mov_b32 s62, s61
    s_cmp_lt_u32 s61, 20
    s_cbranch_scc1 L_rd45
    s_mul_i32 s62, s60, 12
    s_add_u32 s62, s62, s61
    s_sub_u32 s62, s62, 20
    s_mov_b32 s63, 1
    s_cmp_lt_u32 s62, 54
    s_cbranch_scc1 L_rd45
    s_cmp_lt_u32 s62, 56
    s_cselect_b32 s63, 3, 2
    s_sub_u32 s62, s62, 56
L_rd45:
    v_and_b32 v8, 3, v0
    v_bfe_u32 v9, v0, 2, 2
    v_lshrrev_b32 v10, 4, v0
    s_mov_b32 s55, 0x20000
    s_lshl_b32 s35, s62, 6
    s_and_b32 s49, s62, 1
    s_cmp_eq_u32 s63, 0
    s_cbranch_scc1 L_dp47
    s_cmp_eq_u32 s63, 1
    s_cbranch_scc1 L_dp48
    s_mov_b32 s52, s20
    s_mov_b32 s53, s21
    s_mov_b32 s54, 2211840
    v_mov_b32 v15, 0
    s_branch L_dp49
L_dp48:
    s_mov_b32 s52, s16
    s_mov_b32 s53, s17
    s_mov_b32 s54, 2211840
    v_lshl_add_u32 v15, v9, 3, v10
    v_mul_u32_u24 v15, 3456, v15
    v_lshl_add_u32 v15, v8, 4, v15
    v_add_u32 v15, s35, v15
    s_bfe_u32 s50, s3, 0x10001
    s_lshl_b32 s50, s50, 7
    s_and_b32 s34, s3, 1
    s_lshl_b32 s34, s34, 2
    s_add_u32 s50, s50, s34
    s_and_b32 s51, s3, 3
    s_lshl_b32 s51, s51, 5
    s_add_u32 s51, s51, 512
    s_mul_i32 s50, s50, 3456
    s_mul_i32 s51, s51, 3456
    s_branch L_dp49
L_dp47:
    s_mov_b32 s52, s12
    s_mov_b32 s53, s13
    s_mov_b32 s54, 5242880
    s_lshr_b32 s50, s3, 1
    s_lshl_b32 s50, s50, 3
    s_add_u32 s50, s50, s60
    s_and_b32 s51, s3, 1
    s_lshl_b32 s34, s50, 1
    s_add_u32 s34, s34, s51
    s_mul_i32 s34, s34, 81920
    s_add_u32 s34, s34, s35
    v_lshl_add_u32 v15, v9, 2, v10
    v_mul_u32_u24 v15, 2560, v15
    v_lshl_add_u32 v15, v8, 4, v15
    v_add_u32 v15, s34, v15
    s_lshl_b32 s56, s3, 12
    s_lshl_b32 s34, s49, 11
    s_add_u32 s56, s56, s34
    s_add_u32 s56, s56, 40960
    s_add_u32 s58, s56, 1024
    s_mul_i32 s57, s49, 40960
    s_add_u32 s59, s57, 1280
L_dp49:
    v_and_b32 v2, 15, v0
    v_lshlrev_b32 v2, 4, v2
    v_add_u32 v2, 98304, v2
    s_waitcnt vmcnt(2)
    s_add_u32 s98, s98, 28672
    s_cmp_eq_u32 s98, 258048
    s_cselect_b32 s98, 0, s98
    buffer_load_dwordx4 v[48:51], v1, s[36:39], s98 offen offset:0 nt
    s_waitcnt vmcnt(2)
    buffer_load_dwordx4 v[52:55], v1, s[36:39], s98 offen offset:1024 nt
    s_waitcnt vmcnt(2)
    s_cmp_ge_u32 s3, 4
    s_cbranch_scc1 L_sl50
    s_waitcnt vmcnt(1)
L_sl50:
    buffer_load_dwordx4 v[56:59], v1, s[36:39], s98 offen offset:2048 nt
    s_waitcnt vmcnt(2)
    s_cmp_ge_u32 s3, 4
    s_cbranch_scc1 L_sl51
    s_waitcnt vmcnt(1)
L_sl51:
    buffer_load_dwordx4 v[60:63], v1, s[36:39], s98 offen offset:3072 nt
    s_waitcnt vmcnt(2)
    s_cmp_ge_u32 s3, 4
    s_cbranch_scc1 L_sl52
    s_waitcnt vmcnt(1)
L_sl52:
    s_add_u32 s98, s98, 28672
    s_cmp_eq_u32 s98, 258048
    s_cselect_b32 s98, 0, s98
    buffer_load_dwordx4 v[64:67], v1, s[36:39], s98 offen offset:0 nt
    s_waitcnt vmcnt(2)
    buffer_load_dwordx4 v[68:71], v1, s[36:39], s98 offen offset:1024 nt
    s_waitcnt vmcnt(2)
    buffer_load_dwordx4 v[72:75], v1, s[36:39], s98 offen offset:2048 nt
    s_waitcnt vmcnt(2)
    buffer_load_dwordx4 v[76:79], v1, s[36:39], s98 offen offset:3072 nt
    s_waitcnt vmcnt(2)
    s_add_u32 s98, s98, 28672
    s_cmp_eq_u32 s98, 258048
    s_cselect_b32 s98, 0, s98
    buffer_load_dwordx4 v[80:83], v1, s[36:39], s98 offen offset:0 nt
    s_waitcnt vmcnt(2)
    buffer_load_dwordx4 v[84:87], v1, s[36:39], s98 offen offset:1024 nt
    s_waitcnt vmcnt(2)
    buffer_load_dwordx4 v[88:91], v1, s[36:39], s98 offen offset:2048 nt
    s_waitcnt vmcnt(2)
    buffer_load_dwordx4 v[92:95], v1, s[36:39], s98 offen offset:3072 nt
    s_waitcnt vmcnt(2)
    s_add_u32 s98, s98, 28672
    s_cmp_eq_u32 s98, 258048
    s_cselect_b32 s98, 0, s98
    buffer_load_dwordx4 v[96:99], v1, s[36:39], s98 offen offset:0 nt
    v_mov_b32 v3, 21
    v_mov_b32 v14, 99072
    s_mov_b64 exec, 1
    ds_write_b32 v14, v3
    s_mov_b64 exec, -1
    s_waitcnt vmcnt(2)
    buffer_load_dwordx4 v[100:103], v1, s[36:39], s98 offen offset:1024 nt
    s_waitcnt vmcnt(2)
    buffer_load_dwordx4 v[104:107], v1, s[36:39], s98 offen offset:2048 nt
    s_waitcnt vmcnt(2)
    buffer_load_dwordx4 v[108:111], v1, s[36:39], s98 offen offset:3072 nt
    s_waitcnt vmcnt(2)
    s_add_u32 s98, s98, 28672
    s_cmp_eq_u32 s98, 258048
    s_cselect_b32 s98, 0, s98
    buffer_load_dwordx4 v[112:115], v1, s[36:39], s98 offen offset:0 nt
    s_waitcnt vmcnt(2)
    buffer_load_dwordx4 v[116:119], v1, s[36:39], s98 offen offset:1024 nt
    s_waitcnt vmcnt(2)
    buffer_load_dwordx4 v[120:123], v1, s[36:39], s98 offen offset:2048 nt
    s_waitcnt vmcnt(2)
    buffer_load_dwordx4 v[124:127], v1, s[36:39], s98 offen offset:3072 nt
    s_waitcnt vmcnt(2)
    s_add_u32 s98, s98, 28672
    s_cmp_eq_u32 s98, 258048
    s_cselect_b32 s98, 0, s98
    buffer_load_dwordx4 v[128:131], v1, s[36:39], s98 offen offset:0 nt
    s_waitcnt vmcnt(2)
    buffer_load_dwordx4 v[132:135], v1, s[36:39], s98 offen offset:1024 nt
    s_waitcnt vmcnt(2)
    buffer_load_dwordx4 v[136:139], v1, s[36:39], s98 offen offset:2048 nt
    s_waitcnt vmcnt(2)
    buffer_load_dwordx4 v[140:143], v1, s[36:39], s98 offen offset:3072 nt
    s_waitcnt vmcnt(2)
    s_add_u32 s98, s98, 28672
    s_cmp_eq_u32 s98, 258048
    s_cselect_b32 s98, 0, s98
    buffer_load_dwordx4 v[144:147], v1, s[36:39], s98 offen offset:0 nt
    v_mov_b32 v3, 33
    v_mov_b32 v14, 99072
    s_mov_b64 exec, 1
    ds_write_b32 v14, v3
    s_mov_b64 exec, -1
    s_waitcnt vmcnt(2)
    buffer_load_dwordx4 v[148:151], v1, s[36:39], s98 offen offset:1024 nt
    s_waitcnt vmcnt(2)
    buffer_load_dwordx4 v[152:155], v1, s[36:39], s98 offen offset:2048 nt
    s_waitcnt vmcnt(2)
    buffer_load_dwordx4 v[156:159], v1, s[36:39], s98 offen offset:3072 nt
    s_waitcnt vmcnt(2)
    s_add_u32 s98, s98, 28672
    s_cmp_eq_u32 s98, 258048
    s_cselect_b32 s98, 0, s98
    buffer_load_dwordx4 v[160:163], v1, s[40:43], s98 offen offset:0 nt
    v_mov_b32 v3, 99076
    ds_read_b32 v3, v3
    s_waitcnt vmcnt(2)
    s_waitcnt lgkmcnt(0)
    v_readfirstlane_b32 s48, v3
    buffer_load_dwordx4 v[164:167], v1, s[40:43], s98 offen offset:1024 nt
    s_cmp_ge_u32 s48, 20
    s_cbranch_scc1 L_bo53
    s_waitcnt vmcnt(2)
L_bo53:
    buffer_load_dwordx4 v[168:171], v1, s[40:43], s98 offen offset:2048 nt
    s_waitcnt vmcnt(3)
    s_cmp_ge_u32 s48, 21
    s_cbranch_scc1 L_bo54
    s_waitcnt vmcnt(2)
L_bo54:
    buffer_load_dwordx4 v[172:175], v1, s[40:43], s98 offen offset:3072 nt
    s_waitcnt vmcnt(3)
    s_cmp_ge_u32 s48, 22
    s_cbranch_scc1 L_bo55
    s_waitcnt vmcnt(2)
L_bo55:
    s_add_u32 s98, s98, 28672
    s_cmp_eq_u32 s98, 258048
    s_cselect_b32 s98, 0, s98
    buffer_load_dwordx4 v[176:179], v1, s[40:43], s98 offen offset:0 nt
    s_waitcnt vmcnt(3)
    s_cmp_ge_u32 s48, 23
    s_cbranch_scc1 L_bo56
    s_waitcnt vmcnt(2)
L_bo56:
    buffer_load_dwordx4 v[180:183], v1, s[40:43], s98 offen offset:1024 nt
    s_waitcnt vmcnt(3)
    s_cmp_ge_u32 s48, 24
    s_cbranch_scc1 L_bo57
    s_waitcnt vmcnt(2)
L_bo57:
    buffer_load_dwordx4 v[184:187], v1, s[40:43], s98 offen offset:2048 nt
    s_waitcnt vmcnt(3)
    s_cmp_ge_u32 s48, 24
    s_cbranch_scc1 L_bo58
    s_waitcnt vmcnt(2)
L_bo58:
    buffer_load_dwordx4 v[188:191], v1, s[40:43], s98 offen offset:3072 nt
    s_waitcnt vmcnt(3)
    s_cmp_ge_u32 s48, 25
    s_cbranch_scc1 L_bo59
    s_waitcnt vmcnt(2)
L_bo59:
    s_add_u32 s98, s98, 28672
    s_cmp_eq_u32 s98, 258048
    s_cselect_b32 s98, 0, s98
    buffer_load_dwordx4 v[192:195], v1, s[40:43], s98 offen offset:0 nt
    s_waitcnt vmcnt(3)
    s_cmp_ge_u32 s48, 26
    s_cbranch_scc1 L_bo60
    s_waitcnt vmcnt(2)
L_bo60:
    buffer_load_dwordx4 v[196:199], v1, s[40:43], s98 offen offset:1024 nt
    v_mov_b32 v3, 46
    v_mov_b32 v14, 99072
    s_mov_b64 exec, 1
    ds_write_b32 v14, v3
    s_mov_b64 exec, -1
    s_waitcnt vmcnt(3)
    s_cmp_ge_u32 s48, 27
    s_cbranch_scc1 L_bo61
    s_waitcnt vmcnt(2)
L_bo61:
    buffer_load_dwordx4 v[200:203], v1, s[40:43], s98 offen offset:2048 nt
    s_waitcnt vmcnt(3)
    s_cmp_ge_u32 s48, 27
    s_cbranch_scc1 L_bo62
    s_waitcnt vmcnt(2)
L_bo62:
    buffer_load_dwordx4 v[204:207], v1, s[40:43], s98 offen offset:3072 nt
    s_waitcnt vmcnt(3)
    s_cmp_ge_u32 s48, 28
    s_cbranch_scc1 L_bo63
    s_waitcnt vmcnt(2)
L_bo63:
    s_add_u32 s98, s98, 28672
    s_cmp_eq_u32 s98, 258048
    s_cselect_b32 s98, 0, s98
    buffer_load_dwordx4 v[208:211], v1, s[40:43], s98 offen offset:0 nt
    s_waitcnt vmcnt(3)
    s_cmp_ge_u32 s48, 28
    s_cbranch_scc1 L_bo64
    s_waitcnt vmcnt(2)
L_bo64:
    buffer_load_dwordx4 v[212:215], v1, s[40:43], s98 offen offset:1024 nt
    v_mov_b32 v3, 99076
    ds_read_b32 v3, v3
    s_waitcnt vmcnt(3)
    s_cmp_ge_u32 s48, 29
    s_cbranch_scc1 L_bo65
    s_waitcnt vmcnt(2)
L_bo65:
    s_waitcnt lgkmcnt(0)
    v_readfirstlane_b32 s48, v3
    buffer_load_dwordx4 v[216:219], v1, s[40:43], s98 offen offset:2048 nt
    s_waitcnt vmcnt(3)
    s_cmp_ge_u32 s48, 20
    s_cbranch_scc1 L_bo66
    s_waitcnt vmcnt(2)
L_bo66:
    buffer_load_dwordx4 v[220:223], v1, s[40:43], s98 offen offset:3072 nt
    s_waitcnt vmcnt(3)
    s_cmp_ge_u32 s48, 21
    s_cbranch_scc1 L_bo67
    s_waitcnt vmcnt(2)
L_bo67:
    s_add_u32 s98, s98, 28672
    s_cmp_eq_u32 s98, 258048
    s_cselect_b32 s98, 0, s98
    buffer_load_dwordx4 v[224:227], v1, s[40:43], s98 offen offset:0 nt
    s_waitcnt vmcnt(3)
    s_cmp_ge_u32 s48, 22
    s_cbranch_scc1 L_bo68
    s_waitcnt vmcnt(2)
L_bo68:
    buffer_load_dwordx4 v[228:231], v1, s[40:43], s98 offen offset:1024 nt
    s_waitcnt vmcnt(3)
    s_cmp_ge_u32 s48, 23
    s_cbranch_scc1 L_bo69
    s_waitcnt vmcnt(2)
L_bo69:
    buffer_load_dwordx4 v[232:235], v1, s[40:43], s98 offen offset:2048 nt
    s_waitcnt vmcnt(3)
    s_cmp_ge_u32 s48, 24
    s_cbranch_scc1 L_bo70
    s_waitcnt vmcnt(2)
L_bo70:
    buffer_load_dwordx4 v[236:239], v1, s[40:43], s98 offen offset:3072 nt
    s_waitcnt vmcnt(3)
    s_cmp_ge_u32 s48, 24
    s_cbranch_scc1 L_bo71
    s_waitcnt vmcnt(2)
L_bo71:
    s_add_u32 s98, s98, 28672
    s_cmp_eq_u32 s98, 258048
    s_cselect_b32 s98, 0, s98
    buffer_load_dwordx4 v[240:243], v1, s[40:43], s98 offen offset:0 nt
    v_mov_b32 v3, 57
    v_mov_b32 v14, 99072
    s_mov_b64 exec, 1
    ds_write_b32 v14, v3
    s_mov_b64 exec, -1
    s_waitcnt vmcnt(3)
    s_cmp_ge_u32 s48, 25
    s_cbranch_scc1 L_bo72
    s_waitcnt vmcnt(2)
L_bo72:
    buffer_load_dwordx4 v[244:247], v1, s[40:43], s98 offen offset:1024 nt
    s_waitcnt vmcnt(3)
    s_cmp_ge_u32 s48, 26
    s_cbranch_scc1 L_bo73
    s_waitcnt vmcnt(2)
L_bo73:
    buffer_load_dwordx4 v[248:251], v1, s[40:43], s98 offen offset:2048 nt
    s_waitcnt vmcnt(3)
    s_cmp_ge_u32 s48, 27
    s_cbranch_scc1 L_bo74
    s_waitcnt vmcnt(2)
L_bo74:
    buffer_load_dwordx4 v[252:255], v1, s[40:43], s98 offen offset:3072 nt
    v_mov_b32 v14, 99080
    s_mov_b32 s35, 0
L_poll75:
    ds_read_b128 v[4:7], v2
    ds_read_b32 v8, v14
    s_add_u32 s35, s35, 1
    s_waitcnt lgkmcnt(0)
    v_max3_u32 v3, v4, v5, v6
    v_max_u32 v3, v3, v7
    v_cmp_eq_u32 vcc, -1, v3
    s_cbranch_vccz L_done76
    s_sleep 2
    s_cmp_lt_u32 s35, 60000
    s_cbranch_scc1 L_poll75
L_done76:
    v_readfirstlane_b32 s99, v8
    v_dot2_f32_bf16 v8, v16, v4, 0
    v_dot2_f32_bf16 v9, v20, v4, 0
    v_dot2_f32_bf16 v10, v24, v4, 0
    v_dot2_f32_bf16 v11, v28, v4, 0
    v_dot2c_f32_bf16 v8, v17, v5
    v_dot2c_f32_bf16 v9, v21, v5
    v_dot2c_f32_bf16 v10, v25, v5
    v_dot2c_f32_bf16 v11, v29, v5
    v_dot2c_f32_bf16 v8, v18, v6
    v_dot2c_f32_bf16 v9, v22, v6
    v_dot2c_f32_bf16 v10, v26, v6
    v_dot2c_f32_bf16 v11, v30, v6
    v_dot2c_f32_bf16 v8, v19, v7
    v_dot2c_f32_bf16 v9, v23, v7
    v_dot2c_f32_bf16 v10, v27, v7
    v_dot2c_f32_bf16 v11, v31, v7
    v_add_f32_dpp v12, v8, v8 row_ror:8 row_mask:0xf bank_mask:0x3
    v_add_f32_dpp v12, v9, v9 row_ror:8 row_mask:0xf bank_mask:0xc
    v_add_f32_dpp v13, v10, v10 row_ror:8 row_mask:0xf bank_mask:0x3
    v_add_f32_dpp v13, v11, v11 row_ror:8 row_mask:0xf bank_mask:0xc
    v_dot2_f32_bf16 v8, v32, v4, 0
    v_dot2_f32_bf16 v9, v36, v4, 0
    v_dot2_f32_bf16 v10, v40, v4, 0
    v_dot2_f32_bf16 v11, v44, v4, 0
    v_add_f32_dpp v12, v12, v12 row_half_mirror row_mask:0xf bank_mask:0xf
    v_add_f32_dpp v13, v13, v13 row_half_mirror row_mask:0xf bank_mask:0xf
    v_dot2c_f32_bf16 v8, v33, v5
    v_dot2c_f32_bf16 v9, v37, v5
    v_dot2c_f32_bf16 v10, v41, v5
    v_dot2c_f32_bf16 v11, v45, v5
    v_add_f32_dpp v12, v12, v12 quad_perm:[1,0,3,2] row_mask:0xf bank_mask:0xf
    v_add_f32_dpp v13, v13, v13 quad_perm:[1,0,3,2] row_mask:0xf bank_mask:0xf
    v_dot2c_f32_bf16 v8, v34, v6
    v_dot2c_f32_bf16 v9, v38, v6
    v_dot2c_f32_bf16 v10, v42, v6
    v_dot2c_f32_bf16 v11, v46, v6
    v_add_f32_dpp v12, v12, v12 quad_perm:[2,3,0,1] row_mask:0xf bank_mask:0xf
    v_add_f32_dpp v13, v13, v13 quad_perm:[2,3,0,1] row_mask:0xf bank_mask:0xf
    v_dot2c_f32_bf16 v8, v35, v7
    v_dot2c_f32_bf16 v9, v39, v7
    v_dot2c_f32_bf16 v10, v43, v7
    v_dot2c_f32_bf16 v11, v47, v7
    s_waitcnt vmcnt(3)
    s_cmp_ge_u32 s48, 27
    s_cbranch_scc1 L_bo78
    s_waitcnt vmcnt(2)
L_bo78:
    s_add_u32 s98, s98, 28672
    s_cmp_eq_u32 s98, 258048
    s_cselect_b32 s98, 0, s98
    buffer_load_dwordx4 v[32:35], v1, s[40:43], s98 offen offset:0 nt
    v_add_f32_dpp v16, v8, v8 row_ror:8 row_mask:0xf bank_mask:0x3
    v_add_f32_dpp v16, v9, v9 row_ror:8 row_mask:0xf bank_mask:0xc
    v_add_f32_dpp v17, v10, v10 row_ror:8 row_mask:0xf bank_mask:0x3
    v_add_f32_dpp v17, v11, v11 row_ror:8 row_mask:0xf bank_mask:0xc
    v_dot2_f32_bf16 v8, v48, v4, 0
    v_dot2_f32_bf16 v9, v52, v4, 0
    v_dot2_f32_bf16 v10, v56, v4, 0
    v_dot2_f32_bf16 v11, v60, v4, 0
    v_add_f32_dpp v16, v16, v16 row_half_mirror row_mask:0xf bank_mask:0xf
    v_add_f32_dpp v17, v17, v17 row_half_mirror row_mask:0xf bank_mask:0xf
    v_dot2c_f32_bf16 v8, v49, v5
    v_dot2c_f32_bf16 v9, v53, v5
    v_dot2c_f32_bf16 v10, v57, v5
    v_dot2c_f32_bf16 v11, v61, v5
    v_add_f32_dpp v16, v16, v16 quad_perm:[1,0,3,2] row_mask:0xf bank_mask:0xf
    v_add_f32_dpp v17, v17, v17 quad_perm:[1,0,3,2] row_mask:0xf bank_mask:0xf
    v_dot2c_f32_bf16 v8, v50, v6
    v_dot2c_f32_bf16 v9, v54, v6
    v_dot2c_f32_bf16 v10, v58, v6
    v_dot2c_f32_bf16 v11, v62, v6
    v_add_f32_dpp v16, v16, v16 quad_perm:[2,3,0,1] row_mask:0xf bank_mask:0xf
    v_add_f32_dpp v17, v17, v17 quad_perm:[2,3,0,1] row_mask:0xf bank_mask:0xf
    v_dot2c_f32_bf16 v8, v51, v7
    v_dot2c_f32_bf16 v9, v55, v7
    v_dot2c_f32_bf16 v10, v59, v7
    v_dot2c_f32_bf16 v11, v63, v7
    v_add_f32_dpp v18, v8, v8 row_ror:8 row_mask:0xf bank_mask:0x3
    v_add_f32_dpp v18, v9, v9 row_ror:8 row_mask:0xf bank_mask:0xc
    v_add_f32_dpp v19, v10, v10 row_ror:8 row_mask:0xf bank_mask:0x3
    v_add_f32_dpp v19, v11, v11 row_ror:8 row_mask:0xf bank_mask:0xc
    v_dot2_f32_bf16 v8, v64, v4, 0
    v_dot2_f32_bf16 v9, v68, v4, 0
    v_dot2_f32_bf16 v10, v72, v4, 0
    v_dot2_f32_bf16 v11, v76, v4, 0
    v_add_f32_dpp v18, v18, v18 row_half_mirror row_mask:0xf bank_mask:0xf
    v_add_f32_dpp v19, v19, v19 row_half_mirror row_mask:0xf bank_mask:0xf
    v_dot2c_f32_bf16 v8, v65, v5
    v_dot2c_f32_bf16 v9, v69, v5
    v_dot2c_f32_bf16 v10, v73, v5
    v_dot2c_f32_bf16 v11, v77, v5
    v_add_f32_dpp v18, v18, v18 quad_perm:[1,0,3,2] row_mask:0xf bank_mask:0xf
    v_add_f32_dpp v19, v19, v19 quad_perm:[1,0,3,2] row_mask:0xf bank_mask:0xf
    v_dot2c_f32_bf16 v8, v66, v6
    v_dot2c_f32_bf16 v9, v70, v6
    v_mov_b32 v3, 99076
    ds_read_b32 v3, v3
    s_waitcnt vmcnt(3)
    s_cmp_ge_u32 s48, 28
    s_cbranch_scc1 L_bo79
    s_waitcnt vmcnt(2)
L_bo79:
    s_waitcnt lgkmcnt(0)
    v_readfirstlane_b32 s48, v3
    buffer_load_dwordx4 v[36:39], v1, s[40:43], s98 offen offset:1024 nt
    v_dot2c_f32_bf16 v10, v74, v6
    v_dot2c_f32_bf16 v11, v78, v6
    v_add_f32_dpp v18, v18, v18 quad_perm:[2,3,0,1] row_mask:0xf bank_mask:0xf
    v_add_f32_dpp v19, v19, v19 quad_perm:[2,3,0,1] row_mask:0xf bank_mask:0xf
    v_dot2c_f32_bf16 v8, v67, v7
    v_dot2c_f32_bf16 v9, v71, v7
    v_dot2c_f32_bf16 v10, v75, v7
    v_dot2c_f32_bf16 v11, v79, v7
    v_add_f32_dpp v20, v8, v8 row_ror:8 row_mask:0xf bank_mask:0x3
    v_add_f32_dpp v20, v9, v9 row_ror:8 row_mask:0xf bank_mask:0xc
    v_add_f32_dpp v21, v10, v10 row_ror:8 row_mask:0xf bank_mask:0x3
    v_add_f32_dpp v21, v11, v11 row_ror:8 row_mask:0xf bank_mask:0xc
    v_dot2_f32_bf16 v8, v80, v4, 0
    v_dot2_f32_bf16 v9, v84, v4, 0
    v_dot2_f32_bf16 v10, v88, v4, 0
    v_dot2_f32_bf16 v11, v92, v4, 0
    v_add_f32_dpp v20, v20, v20 row_half_mirror row_mask:0xf bank_mask:0xf
    v_add_f32_dpp v21, v21, v21 row_half_mirror row_mask:0xf bank_mask:0xf
    v_dot2c_f32_bf16 v8, v81, v5
    v_dot2c_f32_bf16 v9, v85, v5
    v_dot2c_f32_bf16 v10, v89, v5
    v_dot2c_f32_bf16 v11, v93, v5
    v_add_f32_dpp v20, v20, v20 quad_perm:[1,0,3,2] row_mask:0xf bank_mask:0xf
    v_add_f32_dpp v21, v21, v21 quad_perm:[1,0,3,2] row_mask:0xf bank_mask:0xf
    v_dot2c_f32_bf16 v8, v82, v6
    v_dot2c_f32_bf16 v9, v86, v6
    v_dot2c_f32_bf16 v10, v90, v6
    v_dot2c_f32_bf16 v11, v94, v6
    v_add_f32_dpp v20, v20, v20 quad_perm:[2,3,0,1] row_mask:0xf bank_mask:0xf
    v_add_f32_dpp v21, v21, v21 quad_perm:[2,3,0,1] row_mask:0xf bank_mask:0xf
    v_dot2c_f32_bf16 v8, v83, v7
    v_dot2c_f32_bf16 v9, v87, v7
    v_dot2c_f32_bf16 v10, v91, v7
    v_dot2c_f32_bf16 v11, v95, v7
    v_add_f32_dpp v22, v8, v8 row_ror:8 row_mask:0xf bank_mask:0x3
    v_add_f32_dpp v22, v9, v9 row_ror:8 row_mask:0xf bank_mask:0xc
    v_add_f32_dpp v23, v10, v10 row_ror:8 row_mask:0xf bank_mask:0x3
    v_add_f32_dpp v23, v11, v11 row_ror:8 row_mask:0xf bank_mask:0xc
    v_dot2_f32_bf16 v8, v96, v4, 0
    v_dot2_f32_bf16 v9, v100, v4, 0
    v_dot2_f32_bf16 v10, v104, v4, 0
    v_dot2_f32_bf16 v11, v108, v4, 0
    v_add_f32_dpp v22, v22, v22 row_half_mirror row_mask:0xf bank_mask:0xf
    v_add_f32_dpp v23, v23, v23 row_half_mirror row_mask:0xf bank_mask:0xf
    s_waitcnt vmcnt(3)
    s_cmp_ge_u32 s48, 16
    s_cbranch_scc1 L_bo80
    s_waitcnt vmcnt(2)
L_bo80:
    buffer_load_dwordx4 v[40:43], v1, s[40:43], s98 offen offset:2048 nt
    v_dot2c_f32_bf16 v8, v97, v5
    v_dot2c_f32_bf16 v9, v101, v5
    v_dot2c_f32_bf16 v10, v105, v5
    v_dot2c_f32_bf16 v11, v109, v5
    v_add_f32_dpp v22, v22, v22 quad_perm:[1,0,3,2] row_mask:0xf bank_mask:0xf
    v_add_f32_dpp v23, v23, v23 quad_perm:[1,0,3,2] row_mask:0xf bank_mask:0xf
    v_dot2c_f32_bf16 v8, v98, v6
    v_dot2c_f32_bf16 v9, v102, v6
    v_dot2c_f32_bf16 v10, v106, v6
    v_dot2c_f32_bf16 v11, v110, v6
    v_add_f32_dpp v22, v22, v22 quad_perm:[2,3,0,1] row_mask:0xf bank_mask:0xf
    v_add_f32_dpp v23, v23, v23 quad_perm:[2,3,0,1] row_mask:0xf bank_mask:0xf
    v_dot2c_f32_bf16 v8, v99, v7
    v_dot2c_f32_bf16 v9, v103, v7
    v_dot2c_f32_bf16 v10, v107, v7
    v_dot2c_f32_bf16 v11, v111, v7
    v_add_f32_dpp v24, v8, v8 row_ror:8 row_mask:0xf bank_mask:0x3
    v_add_f32_dpp v24, v9, v9 row_ror:8 row_mask:0xf bank_mask:0xc
    v_add_f32_dpp v25, v10, v10 row_ror:8 row_mask:0xf bank_mask:0x3
    v_add_f32_dpp v25, v11, v11 row_ror:8 row_mask:0xf bank_mask:0xc
    v_dot2_f32_bf16 v8, v112, v4, 0
    v_dot2_f32_bf16 v9, v116, v4, 0
    v_dot2_f32_bf16 v10, v120, v4, 0
    v_dot2_f32_bf16 v11, v124, v4, 0
    v_add_f32_dpp v24, v24, v24 row_half_mirror row_mask:0xf bank_mask:0xf
    v_add_f32_dpp v25, v25, v25 row_half_mirror row_mask:0xf bank_mask:0xf
    v_dot2c_f32_bf16 v8, v113, v5
    v_dot2c_f32_bf16 v9, v117, v5
    v_dot2c_f32_bf16 v10, v121, v5
    v_dot2c_f32_bf16 v11, v125, v5
    v_add_f32_dpp v24, v24, v24 quad_perm:[1,0,3,2] row_mask:0xf bank_mask:0xf
    v_add_f32_dpp v25, v25, v25 quad_perm:[1,0,3,2] row_mask:0xf bank_mask:0xf
    v_dot2c_f32_bf16 v8, v114, v6
    v_dot2c_f32_bf16 v9, v118, v6
    v_dot2c_f32_bf16 v10, v122, v6
    v_dot2c_f32_bf16 v11, v126, v6
    v_add_f32_dpp v24, v24, v24 quad_perm:[2,3,0,1] row_mask:0xf bank_mask:0xf
    v_add_f32_dpp v25, v25, v25 quad_perm:[2,3,0,1] row_mask:0xf bank_mask:0xf
    v_dot2c_f32_bf16 v8, v115, v7
    v_dot2c_f32_bf16 v9, v119, v7
    v_dot2c_f32_bf16 v10, v123, v7
    v_dot2c_f32_bf16 v11, v127, v7
    v_add_f32_dpp v26, v8, v8 row_ror:8 row_mask:0xf bank_mask:0x3
    v_add_f32_dpp v26, v9, v9 row_ror:8 row_mask:0xf bank_mask:0xc
    s_waitcnt vmcnt(3)
    s_cmp_ge_u32 s48, 17
    s_cbranch_scc1 L_bo81
    s_waitcnt vmcnt(2)
L_bo81:
    buffer_load_dwordx4 v[44:47], v1, s[40:43], s98 offen offset:3072 nt
    v_add_f32_dpp v27, v10, v10 row_ror:8 row_mask:0xf bank_mask:0x3
    v_add_f32_dpp v27, v11, v11 row_ror:8 row_mask:0xf bank_mask:0xc
    v_dot2_f32_bf16 v8, v128, v4, 0
    v_dot2_f32_bf16 v9, v132, v4, 0
    v_dot2_f32_bf16 v10, v136, v4, 0
    v_dot2_f32_bf16 v11, v140, v4, 0
    v_add_f32_dpp v26, v26, v26 row_half_mirror row_mask:0xf bank_mask:0xf
    v_add_f32_dpp v27, v27, v27 row_half_mirror row_mask:0xf bank_mask:0xf
    v_dot2c_f32_bf16 v8, v129, v5
    v_dot2c_f32_bf16 v9, v133, v5
    v_dot2c_f32_bf16 v10, v137, v5
    v_dot2c_f32_bf16 v11, v141, v5
    v_add_f32_dpp v26, v26, v26 quad_perm:[1,0,3,2] row_mask:0xf bank_mask:0xf
    v_add_f32_dpp v27, v27, v27 quad_perm:[1,0,3,2] row_mask:0xf bank_mask:0xf
    v_dot2c_f32_bf16 v8, v130, v6
    v_dot2c_f32_bf16 v9, v134, v6
    v_dot2c_f32_bf16 v10, v138, v6
    v_dot2c_f32_bf16 v11, v142, v6
    v_add_f32_dpp v26, v26, v26 quad_perm:[2,3,0,1] row_mask:0xf bank_mask:0xf
    v_add_f32_dpp v27, v27, v27 quad_perm:[2,3,0,1] row_mask:0xf bank_mask:0xf
    v_dot2c_f32_bf16 v8, v131, v7
    v_dot2c_f32_bf16 v9, v135, v7
    v_dot2c_f32_bf16 v10, v139, v7
    v_dot2c_f32_bf16 v11, v143, v7
    v_add_f32_dpp v28, v8, v8 row_ror:8 row_mask:0xf bank_mask:0x3
    v_add_f32_dpp v28, v9, v9 row_ror:8 row_mask:0xf bank_mask:0xc
    v_add_f32_dpp v29, v10, v10 row_ror:8 row_mask:0xf bank_mask:0x3
    v_add_f32_dpp v29, v11, v11 row_ror:8 row_mask:0xf bank_mask:0xc
    v_dot2_f32_bf16 v8, v144, v4, 0
    v_dot2_f32_bf16 v9, v148, v4, 0
    v_dot2_f32_bf16 v10, v152, v4, 0
    v_dot2_f32_bf16 v11, v156, v4, 0
    v_add_f32_dpp v28, v28, v28 row_half_mirror row_mask:0xf bank_mask:0xf
    v_add_f32_dpp v29, v29, v29 row_half_mirror row_mask:0xf bank_mask:0xf
    v_dot2c_f32_bf16 v8, v145, v5
    v_dot2c_f32_bf16 v9, v149, v5
    v_dot2c_f32_bf16 v10, v153, v5
    v_dot2c_f32_bf16 v11, v157, v5
    v_add_f32_dpp v28, v28, v28 quad_perm:[1,0,3,2] row_mask:0xf bank_mask:0xf
    v_add_f32_dpp v29, v29, v29 quad_perm:[1,0,3,2] row_mask:0xf bank_mask:0xf
    v_dot2c_f32_bf16 v8, v146, v6
    v_dot2c_f32_bf16 v9, v150, v6
    v_dot2c_f32_bf16 v10, v154, v6
    v_dot2c_f32_bf16 v11, v158, v6
    s_waitcnt vmcnt(3)
    s_cmp_ge_u32 s48, 19
    s_cbranch_scc1 L_bo82
    s_waitcnt vmcnt(2)
L_bo82:
    s_add_u32 s98, s98, 28672
    s_cmp_eq_u32 s98, 258048
    s_cselect_b32 s98, 0, s98
    buffer_load_dwordx4 v[48:51], v1, s[40:43], s98 offen offset:0 nt
    v_add_f32_dpp v28, v28, v28 quad_perm:[2,3,0,1] row_mask:0xf bank_mask:0xf
    v_add_f32_dpp v29, v29, v29 quad_perm:[2,3,0,1] row_mask:0xf bank_mask:0xf
    v_dot2c_f32_bf16 v8, v147, v7
    v_dot2c_f32_bf16 v9, v151, v7
    v_dot2c_f32_bf16 v10, v155, v7
    v_dot2c_f32_bf16 v11, v159, v7
    v_add_f32_dpp v30, v8, v8 row_ror:8 row_mask:0xf bank_mask:0x3
    v_add_f32_dpp v30, v9, v9 row_ror:8 row_mask:0xf bank_mask:0xc
    v_add_f32_dpp v31, v10, v10 row_ror:8 row_mask:0xf bank_mask:0x3
    v_add_f32_dpp v31, v11, v11 row_ror:8 row_mask:0xf bank_mask:0xc
    v_add_f32_dpp v30, v30, v30 row_half_mirror row_mask:0xf bank_mask:0xf
    s_nop 0
    v_add_f32_dpp v31, v31, v31 row_half_mirror row_mask:0xf bank_mask:0xf
    v_add_f32_dpp v30, v30, v30 quad_perm:[1,0,3,2] row_mask:0xf bank_mask:0xf
    s_nop 0
    v_add_f32_dpp v31, v31, v31 quad_perm:[1,0,3,2] row_mask:0xf bank_mask:0xf
    v_add_f32_dpp v30, v30, v30 quad_perm:[2,3,0,1] row_mask:0xf bank_mask:0xf
    s_nop 0
    v_add_f32_dpp v31, v31, v31 quad_perm:[2,3,0,1] row_mask:0xf bank_mask:0xf
    v_max3_f32 v8, v12, v13, v16
    v_max3_f32 v8, v8, v17, v18
    v_max3_f32 v8, v8, v19, v20
    v_max3_f32 v8, v8, v21, v22
    v_max3_f32 v8, v8, v23, v24
    v_max3_f32 v8, v8, v25, v26
    v_max3_f32 v8, v8, v27, v28
    v_max3_f32 v8, v8, v29, v30
    v_max_f32 v8, v8, v31
    s_mov_b32 s34, 0x3e0293ee
    s_nop 0
    v_max_f32_dpp v8, v8, v8 row_ror:8 row_mask:0xf bank_mask:0xf
    v_mov_b32 v9, v8
    s_nop 1
    v_permlane16_swap_b32 v8, v9
    v_max_f32 v8, v8, v9
    v_mov_b32 v9, v8
    s_nop 1
    v_permlane32_swap_b32 v8, v9
    v_max_f32 v8, v8, v9
    v_mul_f32 v8, s34, v8
    v_fma_f32 v12, v12, s34, -v8
    v_fma_f32 v13, v13, s34, -v8
    v_fma_f32 v16, v16, s34, -v8
    v_fma_f32 v17, v17, s34, -v8
    v_fma_f32 v18, v18, s34, -v8
    v_fma_f32 v19, v19, s34, -v8
    v_fma_f32 v20, v20, s34, -v8
    v_fma_f32 v21, v21, s34, -v8
    v_fma_f32 v22, v22, s34, -v8
    v_fma_f32 v23, v23, s34, -v8
    s_waitcnt vmcnt(3)
    s_cmp_ge_u32 s48, 20
    s_cbranch_scc1 L_bo83
    s_waitcnt vmcnt(2)
L_bo83:
    buffer_load_dwordx4 v[52:55], v1, s[40:43], s98 offen offset:1024 nt
    v_fma_f32 v24, v24, s34, -v8
    v_fma_f32 v25, v25, s34, -v8
    v_fma_f32 v26, v26, s34, -v8
    v_fma_f32 v27, v27, s34, -v8
    v_fma_f32 v28, v28, s34, -v8
    v_fma_f32 v29, v29, s34, -v8
    v_fma_f32 v30, v30, s34, -v8
    v_fma_f32 v31, v31, s34, -v8
    v_exp_f32 v12, v12
    v_exp_f32 v13, v13
    v_exp_f32 v16, v16
    v_exp_f32 v17, v17
    v_exp_f32 v18, v18
    v_exp_f32 v19, v19
    v_exp_f32 v20, v20
    v_exp_f32 v21, v21
    v_exp_f32 v22, v22
    v_exp_f32 v23, v23
    v_exp_f32 v24, v24
    v_exp_f32 v25, v25
    v_exp_f32 v26, v26
    v_exp_f32 v27, v27
    v_exp_f32 v28, v28
    v_exp_f32 v29, v29
    v_exp_f32 v30, v30
    v_exp_f32 v31, v31
    v_add_f32 v9, v12, v13
    v_add_f32 v9, v9, v16
    v_add_f32 v9, v9, v17
    v_add_f32 v9, v9, v18
    v_add_f32 v9, v9, v19
    v_add_f32 v9, v9, v20
    v_add_f32 v9, v9, v21
    v_add_f32 v9, v9, v22
    v_add_f32 v9, v9, v23
    v_add_f32 v9, v9, v24
    v_add_f32 v9, v9, v25
    v_add_f32 v9, v9, v26
    v_add_f32 v9, v9, v27
    v_add_f32 v9, v9, v28
    v_add_f32 v9, v9, v29
    v_add_f32 v9, v9, v30
    v_add_f32 v9, v9, v31
    v_and_b32 v10, 1, v0
    s_cmp_ge_u32 s48, 21
    s_cbranch_scc1 L_bo84
    s_waitcnt vmcnt(3)
L_bo84:
    buffer_load_dwordx4 v[56:59], v1, s[40:43], s98 offen offset:2048 nt
    v_lshlrev_b32 v10, 4, v10
    v_mov_b32 v11, 0xffff
    v_lshlrev_b32 v10, v10, v11
    v_bfe_u32 v11, v0, 1, 2
    v_cmp_eq_u32 vcc, 0, v11
    s_nop 1
    v_cndmask_b32 v144, 0, v10, vcc
    v_cmp_eq_u32 vcc, 1, v11
    s_nop 1
    v_cndmask_b32 v145, 0, v10, vcc
    v_cmp_eq_u32 vcc, 2, v11
    s_nop 1
    v_cndmask_b32 v146, 0, v10, vcc
    v_cmp_eq_u32 vcc, 3, v11
    s_nop 1
    v_cndmask_b32 v147, 0, v10, vcc
    v_add_f32_dpp v9, v9, v9 row_ror:8 row_mask:0xf bank_mask:0xf
    v_mov_b32 v10, v9
    s_nop 1
    v_permlane16_swap_b32 v9, v10
    v_add_f32 v9, v9, v10
    v_mov_b32 v10, v9
    s_nop 1
    v_permlane32_swap_b32 v9, v10
    v_add_f32 v9, v9, v10
    s_lshl_b32 s34, s3, 3
    s_add_u32 s34, s34, 98552
    v_mov_b32 v10, s34
    s_mov_b64 exec, 1
    ds_write_b64 v10, v[8:9]
    s_mov_b64 exec, -1
    s_lshl_b32 s34, s3, 10
    s_add_u32 s34, s34, 98304
    v_lshrrev_b32 v2, 4, v0
    v_and_b32 v11, 7, v0
    v_lshl_add_u32 v2, v2, 3, v11
    v_bfe_u32 v11, v0, 3, 1
    v_lshl_add_u32 v2, v11, 5, v2
    v_lshl_add_u32 v2, v2, 4, s34
    v_cvt_pk_bf16_f32 v10, v12, v12
    v_and_b32 v128, v10, v144
    v_and_b32 v129, v10, v145
    v_and_b32 v130, v10, v146
    v_and_b32 v131, v10, v147
    s_nop 1
    v_mfma_f32_16x16x32_bf16 v[148:151], v[160:163], v[128:131], 0
    v_mfma_f32_16x16x32_bf16 v[152:155], v[164:167], v[128:131], 0
    v_cvt_pk_bf16_f32 v10, v13, v13
    v_and_b32 v132, v10, v144
    v_and_b32 v133, v10, v145
    v_and_b32 v134, v10, v146
    v_and_b32 v135, v10, v147
    s_nop 1
    v_mfma_f32_16x16x32_bf16 v[148:151], v[168:171], v[132:135], v[148:151]
    s_waitcnt vmcnt(4)
    s_cmp_ge_u32 s48, 22
    s_cbranch_scc1 L_bo85
    s_waitcnt vmcnt(3)
L_bo85:
    buffer_load_dwordx4 v[60:63], v1, s[40:43], s98 offen offset:3072 nt
    v_mfma_f32_16x16x32_bf16 v[152:155], v[172:175], v[132:135], v[152:155]
    v_cvt_pk_bf16_f32 v10, v16, v16
    v_and_b32 v128, v10, v144
    v_and_b32 v129, v10, v145
    v_and_b32 v130, v10, v146
    v_and_b32 v131, v10, v147
    s_nop 1
    v_mfma_f32_16x16x32_bf16 v[148:151], v[176:179], v[128:131], v[148:151]
    v_mfma_f32_16x16x32_bf16 v[152:155], v[180:183], v[128:131], v[152:155]
    v_cvt_pk_bf16_f32 v10, v17, v17
    v_and_b32 v132, v10, v144
    v_and_b32 v133, v10, v145
    v_and_b32 v134, v10, v146
    v_and_b32 v135, v10, v147
    s_nop 1
    v_mfma_f32_16x16x32_bf16 v[148:151], v[184:187], v[132:135], v[148:151]
    v_mfma_f32_16x16x32_bf16 v[152:155], v[188:191], v[132:135], v[152:155]
    v_cvt_pk_bf16_f32 v10, v18, v18
    v_and_b32 v128, v10, v144
    v_and_b32 v129, v10, v145
    v_and_b32 v130, v10, v146
    v_and_b32 v131, v10, v147
    s_nop 1
    v_mfma_f32_16x16x32_bf16 v[148:151], v[192:195], v[128:131], v[148:151]
    v_mfma_f32_16x16x32_bf16 v[152:155], v[196:199], v[128:131], v[152:155]
    v_cvt_pk_bf16_f32 v10, v19, v19
    v_and_b32 v132, v10, v144
    v_and_b32 v133, v10, v145
    v_and_b32 v134, v10, v146
    v_and_b32 v135, v10, v147
    s_nop 1
    v_mfma_f32_16x16x32_bf16 v[148:151], v[200:203], v[132:135], v[148:151]
    v_mfma_f32_16x16x32_bf16 v[152:155], v[204:207], v[132:135], v[152:155]
    v_cvt_pk_bf16_f32 v10, v20, v20
    v_and_b32 v128, v10, v144
    v_and_b32 v129, v10, v145
    v_and_b32 v130, v10, v146
    v_and_b32 v131, v10, v147
    s_nop 1
    v_mfma_f32_16x16x32_bf16 v[148:151], v[208:211], v[128:131], v[148:151]
    v_mfma_f32_16x16x32_bf16 v[152:155], v[212:215], v[128:131], v[152:155]
    v_cvt_pk_bf16_f32 v10, v21, v21
    v_and_b32 v132, v10, v144
    v_and_b32 v133, v10, v145
    v_and_b32 v134, v10, v146
    v_and_b32 v135, v10, v147
    s_nop 1
    v_mfma_f32_16x16x32_bf16 v[148:151], v[216:219], v[132:135], v[148:151]
    v_mfma_f32_16x16x32_bf16 v[152:155], v[220:223], v[132:135], v[152:155]
    v_cvt_pk_bf16_f32 v10, v22, v22
    s_waitcnt vmcnt(4)
    s_cmp_ge_u32 s48, 23
    s_cbranch_scc1 L_bo86
    s_waitcnt vmcnt(3)
L_bo86:
    s_add_u32 s98, s98, 28672
    s_cmp_eq_u32 s98, 258048
    s_cselect_b32 s98, 0, s98
    buffer_load_dwordx4 v[64:67], v1, s[40:43], s98 offen offset:0 nt
    v_and_b32 v128, v10, v144
    v_and_b32 v129, v10, v145
    v_and_b32 v130, v10, v146
    v_and_b32 v131, v10, v147
    s_nop 1
    v_mfma_f32_16x16x32_bf16 v[148:151], v[224:227], v[128:131], v[148:151]
    v_mfma_f32_16x16x32_bf16 v[152:155], v[228:231], v[128:131], v[152:155]
    v_cvt_pk_bf16_f32 v10, v23, v23
    v_and_b32 v132, v10, v144
    v_and_b32 v133, v10, v145
    v_and_b32 v134, v10, v146
    v_and_b32 v135, v10, v147
    s_nop 1
    v_mfma_f32_16x16x32_bf16 v[148:151], v[232:235], v[132:135], v[148:151]
    v_mfma_f32_16x16x32_bf16 v[152:155], v[236:239], v[132:135], v[152:155]
    v_cvt_pk_bf16_f32 v10, v24, v24
    v_and_b32 v128, v10, v144
    v_and_b32 v129, v10, v145
    v_and_b32 v130, v10, v146
    v_and_b32 v131, v10, v147
    s_nop 1
    v_mfma_f32_16x16x32_bf16 v[148:151], v[240:243], v[128:131], v[148:151]
    v_mfma_f32_16x16x32_bf16 v[152:155], v[244:247], v[128:131], v[152:155]
    v_cvt_pk_bf16_f32 v10, v25, v25
    v_and_b32 v132, v10, v144
    v_and_b32 v133, v10, v145
    v_and_b32 v134, v10, v146
    v_and_b32 v135, v10, v147
    s_nop 1
    v_mfma_f32_16x16x32_bf16 v[148:151], v[248:251], v[132:135], v[148:151]
    v_mfma_f32_16x16x32_bf16 v[152:155], v[252:255], v[132:135], v[152:155]
    v_cvt_pk_bf16_f32 v10, v26, v26
    v_and_b32 v128, v10, v144
    v_and_b32 v129, v10, v145
    v_and_b32 v130, v10, v146
    v_and_b32 v131, v10, v147
    s_nop 1
    v_mfma_f32_16x16x32_bf16 v[148:151], v[32:35], v[128:131], v[148:151]
    v_mfma_f32_16x16x32_bf16 v[152:155], v[36:39], v[128:131], v[152:155]
    v_cvt_pk_bf16_f32 v10, v27, v27
    v_and_b32 v132, v10, v144
    v_and_b32 v133, v10, v145
    v_and_b32 v134, v10, v146
    v_and_b32 v135, v10, v147
    s_nop 1
    v_mfma_f32_16x16x32_bf16 v[148:151], v[40:43], v[132:135], v[148:151]
    v_mfma_f32_16x16x32_bf16 v[152:155], v[44:47], v[132:135], v[152:155]
    v_cvt_pk_bf16_f32 v10, v28, v28
    v_and_b32 v128, v10, v144
    v_and_b32 v129, v10, v145
    s_waitcnt vmcnt(4)
    s_cmp_ge_u32 s48, 24
    s_cbranch_scc1 L_bo87
    s_waitcnt vmcnt(3)
L_bo87:
    buffer_load_dwordx4 v[68:71], v1, s[40:43], s98 offen offset:1024 nt
    v_and_b32 v130, v10, v146
    v_and_b32 v131, v10, v147
    buffer_load_dwordx4 v[72:75], v1, s[40:43], s98 offen offset:2048 nt
    s_waitcnt vmcnt(5)
    buffer_load_dwordx4 v[76:79], v1, s[40:43], s98 offen offset:3072 nt
    s_barrier
    v_and_b32 v200, 3, v0
    v_bfe_u32 v201, v0, 2, 2
    v_lshrrev_b32 v202, 4, v0
    s_lshl_b32 s34, s3, 10
    s_add_u32 s34, s34, 122112
    v_mul_u32_u24 v203, 320, v201
    v_min_u32 v203, 704, v203
    v_lshl_add_u32 v203, v202, 6, v203
    v_lshl_add_u32 v203, v200, 4, v203
    v_add_u32 v203, s34, v203
    s_movk_i32 s48, 16384
    s_cmp_eq_u32 s63, 0
    s_cbranch_scc1 L_tp_wo
    s_cmp_eq_u32 s63, 1
    s_cbranch_scc1 L_tp_w1
    v_bfe_u32 v205, v0, 3, 2
    v_lshlrev_b32 v204, 3, v205
    v_lshrrev_b32 v205, 5, v0
    v_lshl_add_u32 v204, v205, 2, v204
    v_bfe_u32 v205, v0, 1, 2
    v_add_u32 v204, v204, v205
    v_and_b32 v205, 1, v0
    s_sub_u32 s49, s3, 1
    v_mul_u32_u24 v204, 1280, v204
    v_lshl_add_u32 v204, v205, 4, v204
    s_lshl_b32 s34, s62, 5
    s_mul_i32 s35, s49, 327680
    s_add_u32 s34, s34, s35
    v_add_u32 v204, s34, v204
    s_lshl_b32 s50, s49, 13
    s_add_u32 s50, s50, 40960
    v_lshl_add_u32 v205, v0, 3, s50
    s_lshl_b32 s34, s49, 8
    s_add_u32 s34, s34, s99
    s_and_b32 s35, s60, 1
    s_mul_i32 s35, s35, 917504
    s_add_u32 s34, s34, s35
    s_add_u32 s34, s34, 791552
    s_cmp_eq_u32 s49, 6
    s_cselect_b32 s35, 1, 3
    v_lshlrev_b32 v6, 6, v202
    v_lshl_add_u32 v6, v200, 4, v6
    v_add_u32 v6, s34, v6
    v_lshl_add_u32 v4, v201, 15, v6
    v_min_u32 v5, s35, v201
    v_lshl_add_u32 v5, v5, 15, v6
    v_mov_b32 v7, 99084
    s_lshl_b32 s40, s62, 1
    s_add_u32 s41, s40, 8
    s_add_u32 s42, s40, 2
    s_branch L_tp_e
L_tp_w1:
    v_and_b32 v205, 15, v0
    v_lshlrev_b32 v205, 4, v205
    s_and_b32 s49, s3, 3
    s_mul_i32 s34, s49, 1280
    s_add_u32 s34, s34, s99
    s_add_u32 s34, s34, 786432
    v_lshl_add_u32 v206, v202, 15, v205
    v_add_u32 v206, s34, v206
    s_mul_i32 s34, s49, 3840
    v_add_u32 v205, s34, v205
    s_branch L_tp_e
L_tp_wo:
    s_lshr_b32 s49, s3, 1
    s_lshl_b32 s49, s49, 15
    v_and_b32 v210, 7, v0
    s_mul_i32 s34, s60, 4096
    s_add_u32 s34, s34, s49
    s_add_u32 s34, s34, 1179904
    v_lshrrev_b32 v211, 3, v0
    v_mul_u32_u24 v205, 512, v211
    v_add_u32 v204, s34, v205
    s_lshl_b32 s35, s51, 7
    s_add_u32 s34, s34, s35
    s_sub_u32 s34, s34, 256
    v_lshl_add_u32 v205, v210, 4, v205
    v_add_u32 v205, s34, v205
    s_lshl_b32 s34, s3, 12
    s_add_u32 s34, s34, 40960
    v_lshrrev_b32 v206, 2, v0
    v_lshlrev_b32 v206, 6, v206
    v_lshl_add_u32 v206, v200, 3, v206
    v_add_u32 v206, s34, v206
    s_mul_i32 s34, s3, 1152
    s_add_u32 s34, s34, 107520
    v_mul_u32_u24 v207, 144, v211
    v_lshl_add_u32 v207, v210, 4, v207
    v_add_u32 v207, s34, v207
    v_mul_u32_u24 v208, 144, v210
    v_lshl_add_u32 v208, v202, 4, v208
    v_add_u32 v208, s34, v208
    v_mul_u32_u24 v212, 144, v211
    v_add_u32 v212, s34, v212
    v_mul_u32_u24 v213, 144, v210
    v_add_u32 v213, s34, v213
    v_and_b32 v211, 1, v211
    v_bfe_u32 v203, v0, 1, 2
    v_mul_u32_u24 v203, 144, v203
    v_and_b32 v214, 1, v0
    v_mul_u32_u24 v214, 576, v214
    v_lshl_add_u32 v214, v211, 6, v214
    v_lshl_add_u32 v214, v202, 4, v214
    s_add_u32 s34, s34, 14592
    v_add3_u32 v203, v203, v214, s34
    v_mov_b32 v210, 98816
    v_cmp_eq_u32 vcc, 0, v211
    s_nop 1
    v_cndmask_b32 v209, v208, v210, vcc
    v_cndmask_b32 v208, v210, v208, vcc
L_tp_e:
    v_mfma_f32_16x16x32_bf16 v[148:151], v[48:51], v[128:131], v[148:151]
    v_mfma_f32_16x16x32_bf16 v[152:155], v[52:55], v[128:131], v[152:155]
    v_cvt_pk_bf16_f32 v10, v29, v29
    v_and_b32 v132, v10, v144
    v_and_b32 v133, v10, v145
    v_and_b32 v134, v10, v146
    v_and_b32 v135, v10, v147
    s_waitcnt vmcnt(4)
    s_nop 0
    v_mfma_f32_16x16x32_bf16 v[148:151], v[56:59], v[132:135], v[148:151]
    v_mfma_f32_16x16x32_bf16 v[152:155], v[60:63], v[132:135], v[152:155]
    v_cvt_pk_bf16_f32 v10, v30, v30
    v_and_b32 v128, v10, v144
    v_and_b32 v129, v10, v145
    v_and_b32 v130, v10, v146
    v_and_b32 v131, v10, v147
    s_waitcnt vmcnt(2)
    s_nop 0
    v_mfma_f32_16x16x32_bf16 v[148:151], v[64:67], v[128:131], v[148:151]
    v_mfma_f32_16x16x32_bf16 v[152:155], v[68:71], v[128:131], v[152:155]
    v_cvt_pk_bf16_f32 v10, v31, v31
    v_and_b32 v132, v10, v144
    v_and_b32 v133, v10, v145
    v_and_b32 v134, v10, v146
    v_and_b32 v135, v10, v147
    s_waitcnt vmcnt(0)
    s_nop 0
    v_mfma_f32_16x16x32_bf16 v[148:151], v[72:75], v[132:135], v[148:151]
    v_mfma_f32_16x16x32_bf16 v[152:155], v[76:79], v[132:135], v[152:155]
    s_nop 7
    v_add_f32_dpp v148, v152, v148 row_ror:8 row_mask:0xf bank_mask:0xf
    v_add_f32_dpp v149, v153, v149 row_ror:8 row_mask:0xf bank_mask:0xf
    v_add_f32_dpp v150, v154, v150 row_ror:8 row_mask:0xf bank_mask:0xf
    v_add_f32_dpp v151, v155, v151 row_ror:8 row_mask:0xf bank_mask:0xf
    ds_write_b128 v2, v[148:151]
    s_waitcnt lgkmcnt(0)
    s_barrier
    s_cmp_eq_u32 s63, 0
    s_cbranch_scc1 L_t_wo
    s_cmp_eq_u32 s63, 2
    s_cbranch_scc1 L_t_w2
    s_cmp_eq_u32 s63, 3
    s_cbranch_scc1 L_fin
    s_barrier
L_r_w1:
    s_cmp_lt_u32 s3, 4
    s_cbranch_scc1 L_w1_ln
    s_and_b32 s49, s3, 3
    s_lshl_b32 s42, s49, 11
    s_add_u32 s42, s42, 40960
    s_bitcmp1_b32 s62, 0
    s_cbranch_scc1 L_rot1
    s_add_u32 m0, s42, 0
    s_add_u32 s34, s50, 0
    buffer_load_dwordx4 v15, s[52:55], s34 offen  lds
    s_add_u32 m0, s42, 1024
    s_add_u32 s34, s50, 884736
    buffer_load_dwordx4 v15, s[52:55], s34 offen  lds
    s_add_u32 m0, s42, 8192
    s_add_u32 s34, s50, 110592
    buffer_load_dwordx4 v15, s[52:55], s34 offen  lds
    s_add_u32 m0, s42, 9216
    s_add_u32 s34, s50, 995328
    buffer_load_dwordx4 v15, s[52:55], s34 offen  lds
    s_add_u32 m0, s42, 32768
    s_add_u32 s34, s51, 0
    buffer_load_dwordx4 v15, s[52:55], s34 offen  lds
    s_add_u32 m0, s42, 33792
    s_add_u32 s34, s51, 13824
    buffer_load_dwordx4 v15, s[52:55], s34 offen  lds
    s_add_u32 m0, s42, 16384
    s_add_u32 s34, s50, 221184
    buffer_load_dwordx4 v15, s[52:55], s34 offen  lds
    s_add_u32 m0, s42, 17408
    s_add_u32 s34, s50, 1105920
    buffer_load_dwordx4 v15, s[52:55], s34 offen  lds
    s_add_u32 m0, s42, 24576
    s_add_u32 s34, s50, 331776
    buffer_load_dwordx4 v15, s[52:55], s34 offen  lds
    s_add_u32 m0, s42, 25600
    s_add_u32 s34, s50, 1216512
    buffer_load_dwordx4 v15, s[52:55], s34 offen  lds
    s_branch L_rot2
L_rot1:
    s_add_u32 m0, s42, 16384
    s_add_u32 s34, s50, 221184
    buffer_load_dwordx4 v15, s[52:55], s34 offen  lds
    s_add_u32 m0, s42, 17408
    s_add_u32 s34, s50, 1105920
    buffer_load_dwordx4 v15, s[52:55], s34 offen  lds
    s_add_u32 m0, s42, 24576
    s_add_u32 s34, s50, 331776
    buffer_load_dwordx4 v15, s[52:55], s34 offen  lds
    s_add_u32 m0, s42, 25600
    s_add_u32 s34, s50, 1216512
    buffer_load_dwordx4 v15, s[52:55], s34 offen  lds
    s_add_u32 m0, s42, 32768
    s_add_u32 s34, s51, 0
    buffer_load_dwordx4 v15, s[52:55], s34 offen  lds
    s_add_u32 m0, s42, 33792
    s_add_u32 s34, s51, 13824
    buffer_load_dwordx4 v15, s[52:55], s34 offen  lds
    s_add_u32 m0, s42, 0
    s_add_u32 s34, s50, 0
    buffer_load_dwordx4 v15, s[52:55], s34 offen  lds
    s_add_u32 m0, s42, 1024
    s_add_u32 s34, s50, 884736
    buffer_load_dwordx4 v15, s[52:55], s34 offen  lds
    s_add_u32 m0, s42, 8192
    s_add_u32 s34, s50, 110592
    buffer_load_dwordx4 v15, s[52:55], s34 offen  lds
    s_add_u32 m0, s42, 9216
    s_add_u32 s34, s50, 995328
    buffer_load_dwordx4 v15, s[52:55], s34 offen  lds
L_rot2:
    v_lshrrev_b32 v3, 2, v0
    v_lshlrev_b32 v3, 6, v3
    v_lshl_add_u32 v3, v200, 3, v3
    v_add_u32 v3, s42, v3
    s_lshl_b32 s35, s49, 6
    s_add_u32 s35, s35, 116736
    v_mul_u32_u24 v4, 1344, v200
    v_lshl_add_u32 v4, v202, 4, v4
    v_add_u32 v4, s35, v4
    s_lshl_b32 s35, s49, 10
    s_sub_u32 s35, s35, 4096
    v_add_u32 v5, s35, v203
    v_and_b32 v6, 1, v201
    v_mul_u32_u24 v6, 5376, v6
    v_add_u32 v6, v6, v4
    v_subrev_u32 v6, 90112, v6
    v_subrev_u32 v7, 22784, v5
    s_waitcnt vmcnt(0)
    s_barrier
    ds_read_b64_tr_b16 v[32:33], v3 offset:0
    ds_read_b64_tr_b16 v[34:35], v3 offset:1024
    ds_read_b64_tr_b16 v[36:37], v3 offset:32
    ds_read_b64_tr_b16 v[38:39], v3 offset:1056
    ds_read_b64_tr_b16 v[40:41], v3 offset:8192
    ds_read_b64_tr_b16 v[42:43], v3 offset:9216
    ds_read_b64_tr_b16 v[44:45], v3 offset:8224
    ds_read_b64_tr_b16 v[46:47], v3 offset:9248
    ds_read_b64_tr_b16 v[48:49], v3 offset:16384
    ds_read_b64_tr_b16 v[50:51], v3 offset:17408
    ds_read_b64_tr_b16 v[52:53], v3 offset:16416
    ds_read_b64_tr_b16 v[54:55], v3 offset:17440
    s_waitcnt lgkmcnt(4)
    ds_read_b64_tr_b16 v[56:57], v3 offset:24576
    ds_read_b64_tr_b16 v[58:59], v3 offset:25600
    ds_read_b64_tr_b16 v[60:61], v3 offset:24608
    ds_read_b64_tr_b16 v[62:63], v3 offset:25632
    ds_read_b64_tr_b16 v[64:65], v3 offset:32768
    ds_read_b64_tr_b16 v[66:67], v3 offset:33792
    ds_read_b64_tr_b16 v[68:69], v3 offset:32800
    ds_read_b64_tr_b16 v[70:71], v3 offset:33824
    s_waitcnt lgkmcnt(0)
    ds_read_b128 v[140:143], v6 offset:0
    ds_read_b128 v[144:147], v6 offset:256
    ds_read_b128 v[148:151], v6 offset:512
    ds_read_b128 v[152:155], v6 offset:768
    ds_read_b128 v[156:159], v6 offset:1024
    s_waitcnt lgkmcnt(4)
    v_mfma_f32_16x16x32_bf16 v[20:23], v[32:35], v[140:143], 0
    v_mfma_f32_16x16x32_bf16 v[24:27], v[36:39], v[140:143], 0
    s_waitcnt lgkmcnt(3)
    v_mfma_f32_16x16x32_bf16 v[20:23], v[40:43], v[144:147], v[20:23]
    v_mfma_f32_16x16x32_bf16 v[24:27], v[44:47], v[144:147], v[24:27]
    s_waitcnt lgkmcnt(2)
    v_mfma_f32_16x16x32_bf16 v[20:23], v[48:51], v[148:151], v[20:23]
    v_mfma_f32_16x16x32_bf16 v[24:27], v[52:55], v[148:151], v[24:27]
    s_waitcnt lgkmcnt(1)
    v_mfma_f32_16x16x32_bf16 v[20:23], v[56:59], v[152:155], v[20:23]
    v_mfma_f32_16x16x32_bf16 v[24:27], v[60:63], v[152:155], v[24:27]
    s_waitcnt lgkmcnt(0)
    v_mfma_f32_16x16x32_bf16 v[20:23], v[64:67], v[156:159], v[20:23]
    v_mfma_f32_16x16x32_bf16 v[24:27], v[68:71], v[156:159], v[24:27]
    s_nop 6
    ds_write_b128 v7, v[20:23]
    ds_write_b128 v7, v[24:27] offset:1024
    s_waitcnt lgkmcnt(0)
    s_setprio 3
    s_barrier
    ds_read_b128 v[140:143], v4 offset:0
    ds_read_b128 v[144:147], v4 offset:256
    ds_read_b128 v[148:151], v4 offset:512
    ds_read_b128 v[152:155], v4 offset:768
    ds_read_b128 v[156:159], v4 offset:1024
    s_waitcnt lgkmcnt(4)
    v_mfma_f32_16x16x32_bf16 v[20:23], v[32:35], v[140:143], 0
    v_mfma_f32_16x16x32_bf16 v[24:27], v[36:39], v[140:143], 0
    s_waitcnt lgkmcnt(3)
    v_mfma_f32_16x16x32_bf16 v[20:23], v[40:43], v[144:147], v[20:23]
    v_mfma_f32_16x16x32_bf16 v[24:27], v[44:47], v[144:147], v[24:27]
    s_waitcnt lgkmcnt(2)
    v_mfma_f32_16x16x32_bf16 v[20:23], v[48:51], v[148:151], v[20:23]
    v_mfma_f32_16x16x32_bf16 v[24:27], v[52:55], v[148:151], v[24:27]
    s_waitcnt lgkmcnt(1)
    v_mfma_f32_16x16x32_bf16 v[20:23], v[56:59], v[152:155], v[20:23]
    v_mfma_f32_16x16x32_bf16 v[24:27], v[60:63], v[152:155], v[24:27]
    s_waitcnt lgkmcnt(0)
    v_mfma_f32_16x16x32_bf16 v[20:23], v[64:67], v[156:159], v[20:23]
    v_mfma_f32_16x16x32_bf16 v[24:27], v[68:71], v[156:159], v[24:27]
    s_nop 6
    ds_write_b128 v5, v[20:23]
    ds_write_b128 v5, v[24:27] offset:1024
    s_waitcnt lgkmcnt(0)
    s_barrier
    s_branch L_fin
L_w1_ln:
    s_setprio 1
    ds_read_b128 v[140:143], v205 offset:0
    ds_read_b128 v[144:147], v205 offset:256
    ds_read_b128 v[148:151], v205 offset:512
    ds_read_b128 v[152:155], v205 offset:768
    ds_read_b128 v[156:159], v205 offset:1024
    ds_read_b128 v[160:163], v205 offset:1280
    ds_read_b128 v[164:167], v205 offset:1536
    ds_read_b128 v[168:171], v205 offset:1792
    ds_read_b128 v[172:175], v205 offset:2048
    ds_read_b128 v[176:179], v205 offset:2304
    ds_read_b128 v[180:183], v205 offset:2560
    ds_read_b128 v[184:187], v205 offset:2816
    ds_read_b128 v[188:191], v205 offset:3072
    ds_read_b128 v[192:195], v205 offset:3328
    ds_read_b128 v[196:199], v205 offset:3584
    v_and_b32 v8, 1, v0
    v_lshlrev_b32 v8, 4, v8
    v_mov_b32 v9, 0xffff
    v_lshlrev_b32 v8, v8, v9
    v_bfe_u32 v9, v0, 1, 2
    v_cmp_eq_u32 vcc, 0, v9
    s_nop 1
    v_cndmask_b32 v16, 0, v8, vcc
    v_cmp_eq_u32 vcc, 1, v9
    s_nop 1
    v_cndmask_b32 v17, 0, v8, vcc
    v_cmp_eq_u32 vcc, 2, v9
    s_nop 1
    v_cndmask_b32 v18, 0, v8, vcc
    v_cmp_eq_u32 vcc, 3, v9
    s_nop 1
    v_cndmask_b32 v19, 0, v8, vcc
    v_bfe_u32 v8, v0, 3, 1
    v_cmp_eq_u32 vcc, 0, v8
    s_nop 1
    v_cndmask_b32 v20, 0, v16, vcc
    v_xor_b32 v24, v20, v16
    v_cndmask_b32 v21, 0, v17, vcc
    v_xor_b32 v25, v21, v17
    v_cndmask_b32 v22, 0, v18, vcc
    v_xor_b32 v26, v22, v18
    v_cndmask_b32 v23, 0, v19, vcc
    v_xor_b32 v27, v23, v19
    v_and_b32 v52, 0x3f803f80, v20
    v_and_b32 v60, 0x3e803e80, v20
    v_and_b32 v53, 0x3f803f80, v21
    v_and_b32 v61, 0x3e803e80, v21
    v_and_b32 v54, 0x3f803f80, v22
    v_and_b32 v62, 0x3e803e80, v22
    v_and_b32 v55, 0x3f803f80, v23
    v_and_b32 v63, 0x3e803e80, v23
    v_and_b32 v56, 0x3f803f80, v24
    v_and_b32 v64, 0x3e803e80, v24
    v_and_b32 v57, 0x3f803f80, v25
    v_and_b32 v65, 0x3e803e80, v25
    v_and_b32 v58, 0x3f803f80, v26
    v_and_b32 v66, 0x3e803e80, v26
    v_and_b32 v59, 0x3f803f80, v27
    v_and_b32 v67, 0x3e803e80, v27
    s_waitcnt lgkmcnt(0)
    v_mfma_f32_16x16x32_bf16 v[68:71], v[140:143], v[60:63], 0
    v_mfma_f32_16x16x32_bf16 v[68:71], v[144:147], v[64:67], v[68:71]
    v_mfma_f32_16x16x32_bf16 v[72:75], v[148:151], v[60:63], 0
    v_mfma_f32_16x16x32_bf16 v[72:75], v[152:155], v[64:67], v[72:75]
    v_mfma_f32_16x16x32_bf16 v[76:79], v[156:159], v[60:63], 0
    v_mfma_f32_16x16x32_bf16 v[116:119], v[160:163], v[60:63], 0
    v_mfma_f32_16x16x32_bf16 v[116:119], v[164:167], v[64:67], v[116:119]
    v_mfma_f32_16x16x32_bf16 v[120:123], v[168:171], v[60:63], 0
    v_mfma_f32_16x16x32_bf16 v[120:123], v[172:175], v[64:67], v[120:123]
    v_mfma_f32_16x16x32_bf16 v[124:127], v[176:179], v[60:63], 0
    v_mfma_f32_16x16x32_bf16 v[80:83], v[180:183], v[60:63], 1.0
    v_mfma_f32_16x16x32_bf16 v[80:83], v[184:187], v[64:67], v[80:83]
    v_mfma_f32_16x16x32_bf16 v[84:87], v[188:191], v[60:63], 1.0
    v_mfma_f32_16x16x32_bf16 v[84:87], v[192:195], v[64:67], v[84:87]
    v_mfma_f32_16x16x32_bf16 v[88:91], v[196:199], v[60:63], 1.0
    s_mul_i32 s34, s3, 1344
    s_add_u32 s34, s34, 116736
    v_lshl_add_u32 v7, v0, 4, s34
    v_lshlrev_b32 v8, 6, v202
    v_lshl_add_u32 v8, v200, 4, v8
    v_and_b32 v9, 1, v201
    v_lshl_add_u32 v8, v9, 3, v8
    v_add_u32 v8, s34, v8
    v_bfe_u32 v9, v0, 3, 1
    v_mul_u32_u24 v9, 6144, v9
    v_sub_u32 v8, v8, v9
    v_lshrrev_b32 v9, 5, v0
    v_lshlrev_b32 v9, 10, v9
    v_and_b32 v6, 1, v202
    v_lshl_add_u32 v9, v6, 7, v9
    v_bfe_u32 v6, v0, 1, 1
    v_lshl_add_u32 v9, v6, 6, v9
    v_lshl_add_u32 v9, v201, 4, v9
    v_and_b32 v6, 1, v0
    v_lshl_add_u32 v9, v6, 3, v9
    v_add_u32 v9, 122112, v9
    s_lshr_b32 s34, s62, 3
    s_lshl_b32 s34, s34, 8
    s_and_b32 s49, s62, 3
    s_lshl_b32 s49, s49, 15
    s_add_u32 s34, s34, s49
    s_bfe_u32 s49, s62, 0x10002
    s_lshl_b32 s49, s49, 14
    s_add_u32 s34, s34, s49
    s_add_u32 s34, s34, 791552
    v_lshl_add_u32 v5, v0, 2, s34
    v_add_u32 v4, 917504, v5
    s_bfe_u32 s49, s60, 0x10002
    s_lshl_b32 s49, s49, 13
    s_xor_b32 s53, s99, s49
    s_xor_b32 s52, s53, 8192
    v_subrev_u32 v10, 90112, v7
    v_subrev_u32 v11, 90112, v8
    v_cvt_pk_bf16_f32 v32, v116, v117
    v_cvt_pk_bf16_f32 v33, v118, v119
    v_cvt_pk_bf16_f32 v34, v120, v121
    v_cvt_pk_bf16_f32 v35, v122, v123
    v_cvt_pk_bf16_f32 v36, v124, v125
    v_cvt_pk_bf16_f32 v37, v126, v127
    s_mov_b32 exec_lo, 0x00ff00ff
    s_mov_b32 exec_hi, 0x00ff00ff
    ds_write_b64 v11, v[36:37] offset:6400
    s_mov_b64 exec, -1
    ds_write_b128 v10, v[32:35] offset:5376
    v_cvt_pk_bf16_f32 v20, v80, v81
    v_cvt_pk_bf16_f32 v21, v82, v83
    v_cvt_pk_bf16_f32 v22, v84, v85
    v_cvt_pk_bf16_f32 v23, v86, v87
    v_cvt_pk_bf16_f32 v24, v88, v89
    v_cvt_pk_bf16_f32 v25, v90, v91
    ds_write_b128 v10, v[20:23]
    ds_write_b64 v11, v[24:25] offset:1024
    v_lshlrev_b32 v80, 16, v20
    v_and_b32 v81, 0xffff0000, v20
    v_lshlrev_b32 v82, 16, v21
    v_and_b32 v83, 0xffff0000, v21
    v_lshlrev_b32 v84, 16, v22
    v_and_b32 v85, 0xffff0000, v22
    v_lshlrev_b32 v86, 16, v23
    v_and_b32 v87, 0xffff0000, v23
    v_lshlrev_b32 v88, 16, v24
    v_and_b32 v89, 0xffff0000, v24
    v_lshlrev_b32 v90, 16, v25
    v_and_b32 v91, 0xffff0000, v25
    v_subrev_u32 v11, 22784, v9
    s_lshl_b32 s34, s3, 3
    s_add_u32 s34, s34, 99136
    v_mov_b32 v12, s34
    v_lshlrev_b32 v13, 3, v201
    v_add_u32 v13, 99136, v13
    s_mov_b32 s54, 0
    s_brev_b32 s55, 1
    s_waitcnt lgkmcnt(0)
    s_barrier
    s_mov_b32 s35, 0
    s_mov_b64 s[40:41], -1
    s_mov_b64 s[42:43], -1
L_pb:
    s_mov_b64 exec, s[40:41]
    s_cbranch_execz L_pbs0
    buffer_load_dwordx4 v[140:143], v206, s[44:47], 0 offen offset:0 sc1
    buffer_load_dwordx4 v[148:151], v206, s[44:47], 0 offen offset:256 sc1
    buffer_load_dwordx4 v[156:159], v206, s[44:47], 0 offen offset:512 sc1
    buffer_load_dwordx4 v[164:167], v206, s[44:47], 0 offen offset:768 sc1
    buffer_load_dwordx4 v[172:175], v206, s[44:47], 0 offen offset:1024 sc1
L_pbs0:
    s_mov_b64 exec, s[42:43]
    s_cbranch_execz L_pbs1
    buffer_load_dwordx4 v[144:147], v206, s[44:47], s48 offen offset:0 sc1
    buffer_load_dwordx4 v[152:155], v206, s[44:47], s48 offen offset:256 sc1
    buffer_load_dwordx4 v[160:163], v206, s[44:47], s48 offen offset:512 sc1
    buffer_load_dwordx4 v[168:171], v206, s[44:47], s48 offen offset:768 sc1
    buffer_load_dwordx4 v[176:179], v206, s[44:47], s48 offen offset:1024 sc1
L_pbs1:
    s_mov_b64 exec, -1
    s_add_u32 s35, s35, 1
    s_waitcnt vmcnt(0)
    v_mfma_f32_16x16x32_bf16 v[128:131], v[140:143], v[52:55], v[68:71]
    v_max3_u32 v28, v140, v141, v142
    v_max3_u32 v29, v144, v145, v146
    v_mfma_f32_16x16x32_bf16 v[128:131], v[144:147], v[52:55], v[128:131]
    v_max3_u32 v28, v28, v143, v148
    v_max3_u32 v29, v29, v147, v152
    v_mfma_f32_16x16x32_bf16 v[128:131], v[148:151], v[56:59], v[128:131]
    v_max3_u32 v28, v28, v149, v150
    v_max3_u32 v29, v29, v153, v154
    v_mfma_f32_16x16x32_bf16 v[128:131], v[152:155], v[56:59], v[128:131]
    v_max3_u32 v28, v28, v151, v156
    v_max3_u32 v29, v29, v155, v160
    v_mfma_f32_16x16x32_bf16 v[132:135], v[156:159], v[52:55], v[72:75]
    v_max3_u32 v28, v28, v157, v158
    v_max3_u32 v29, v29, v161, v162
    v_mfma_f32_16x16x32_bf16 v[132:135], v[160:163], v[52:55], v[132:135]
    v_max3_u32 v28, v28, v159, v164
    v_max3_u32 v29, v29, v163, v168
    v_mfma_f32_16x16x32_bf16 v[132:135], v[164:167], v[56:59], v[132:135]
    v_max3_u32 v28, v28, v165, v166
    v_max3_u32 v29, v29, v169, v170
    v_mfma_f32_16x16x32_bf16 v[132:135], v[168:171], v[56:59], v[132:135]
    v_max3_u32 v28, v28, v167, v172
    v_max3_u32 v29, v29, v171, v176
    v_mfma_f32_16x16x32_bf16 v[136:139], v[172:175], v[52:55], v[76:79]
    v_max3_u32 v28, v28, v173, v174
    v_max3_u32 v29, v29, v177, v178
    v_mfma_f32_16x16x32_bf16 v[136:139], v[176:179], v[52:55], v[136:139]
    v_max_u32 v28, v28, v175
    v_max_u32 v29, v29, v179
    v_cmp_eq_u32 s[40:41], -1, v28
    v_cmp_eq_u32 s[42:43], -1, v29
    s_nop 0
    s_or_b64 vcc, s[40:41], s[42:43]
    s_cbranch_scc0 L_pbd
    s_cmp_lg_u32 s35, 64
    s_cbranch_scc1 L_tmo88
    s_mov_b64 exec, -1
    v_lshlrev_b32 v243, 4, v0
    v_add_u32 v243, 131328, v243
    ds_read_b96 v[240:242], v243
    s_waitcnt lgkmcnt(0)
    buffer_store_dword v240, v242, s[44:47], 0 offen sc1
    buffer_store_dword v241, v242, s[44:47], 0 offen offset:256 sc1
L_tmo88:
    s_cmp_lt_u32 s35, 60000
    s_cbranch_scc1 L_pb
L_pbd:
    v_pk_mul_f32 v[32:33], v[128:129], v[80:81]
    v_pk_mul_f32 v[34:35], v[130:131], v[82:83]
    v_pk_mul_f32 v[36:37], v[132:133], v[84:85]
    v_pk_mul_f32 v[38:39], v[134:135], v[86:87]
    v_cvt_pk_bf16_f32 v24, v32, v33
    v_cvt_pk_bf16_f32 v25, v34, v35
    v_cvt_pk_bf16_f32 v26, v36, v37
    v_cvt_pk_bf16_f32 v27, v38, v39
    ds_write_b128 v7, v[24:27]
    v_pk_mul_f32 v[40:41], v[136:137], v[88:89]
    v_pk_mul_f32 v[42:43], v[138:139], v[90:91]
    v_cvt_pk_bf16_f32 v28, v40, v41
    v_cvt_pk_bf16_f32 v29, v42, v43
    ds_write_b64 v8, v[28:29] offset:1024
    v_pk_add_f32 v[20:21], v[128:129], v[130:131]
    v_pk_mul_f32 v[22:23], v[128:129], v[128:129]
    v_pk_add_f32 v[20:21], v[20:21], v[132:133]
    v_pk_fma_f32 v[22:23], v[130:131], v[130:131], v[22:23]
    v_pk_add_f32 v[20:21], v[20:21], v[134:135]
    v_pk_fma_f32 v[22:23], v[132:133], v[132:133], v[22:23]
    v_pk_add_f32 v[20:21], v[20:21], v[136:137]
    v_pk_fma_f32 v[22:23], v[134:135], v[134:135], v[22:23]
    v_pk_add_f32 v[20:21], v[20:21], v[138:139]
    v_pk_fma_f32 v[22:23], v[136:137], v[136:137], v[22:23]
    v_pk_fma_f32 v[22:23], v[138:139], v[138:139], v[22:23]
    s_waitcnt lgkmcnt(0)
    s_barrier
    v_add_f32 v20, v20, v21
    v_add_f32 v21, v22, v23
    s_nop 0
    v_add_f32_dpp v20, v20, v20 row_ror:8 row_mask:0xf bank_mask:0xf
    v_add_f32_dpp v21, v21, v21 row_ror:8 row_mask:0xf bank_mask:0xf
    s_nop 0
    v_add_f32_dpp v20, v20, v20 row_ror:4 row_mask:0xf bank_mask:0xf
    v_add_f32_dpp v21, v21, v21 row_ror:4 row_mask:0xf bank_mask:0xf
    s_nop 0
    v_add_f32_dpp v20, v20, v20 row_ror:2 row_mask:0xf bank_mask:0xf
    v_add_f32_dpp v21, v21, v21 row_ror:2 row_mask:0xf bank_mask:0xf
    s_nop 0
    v_add_f32_dpp v20, v20, v20 row_ror:1 row_mask:0xf bank_mask:0xf
    v_add_f32_dpp v21, v21, v21 row_ror:1 row_mask:0xf bank_mask:0xf
    s_nop 0
    v_add_f32_dpp v20, v20, v20 row_bcast:15 row_mask:0xa bank_mask:0xf
    v_add_f32_dpp v21, v21, v21 row_bcast:15 row_mask:0xa bank_mask:0xf
    s_nop 0
    v_add_f32_dpp v20, v20, v20 row_bcast:31 row_mask:0xc bank_mask:0xf
    v_add_f32_dpp v21, v21, v21 row_bcast:31 row_mask:0xc bank_mask:0xf
    v_mul_f32 v22, 0x3acccccd, v20
    v_mul_f32 v21, 0x3acccccd, v21
    v_fma_f32 v21, -v22, v22, v21
    v_max_f32 v21, 0, v21
    v_add_f32 v21, 0x3727c5ac, v21
    v_rsq_f32 v20, v21
    s_nop 0
    v_mul_f32_e64 v21, -v22, v20
    s_mov_b64 exec, s[54:55]
    ds_write_b64 v12, v[20:21]
    s_mov_b64 exec, -1
    s_cmp_lg_u32 s3, 0
    s_cbranch_scc1 L_w1_x
    ds_read_b64 v[32:33], v11 offset:0
    ds_read_b64 v[40:41], v11 offset:320
    ds_read_b64 v[34:35], v11 offset:2048
    ds_read_b64 v[42:43], v11 offset:2368
    ds_read_b64 v[36:37], v11 offset:4096
    ds_read_b64 v[44:45], v11 offset:4416
    ds_read_b64 v[38:39], v11 offset:6144
    ds_read_b64 v[46:47], v11 offset:6464
    s_mov_b32 s34, 0xbdd2d3e8
    v_mov_b32 v10, 0xc0135761
    s_waitcnt lgkmcnt(8)
    s_barrier
    ds_read_b64 v[28:29], v13
    ds_read_b64 v[20:21], v9 offset:0
    ds_read_b64 v[22:23], v9 offset:2048
    ds_read_b64 v[24:25], v9 offset:4096
    ds_read_b64 v[26:27], v9 offset:6144
    s_waitcnt lgkmcnt(5)
    v_pk_add_f32 v[100:101], v[100:101], v[40:41]
    v_pk_add_f32 v[100:101], v[100:101], v[42:43]
    v_pk_add_f32 v[32:33], v[32:33], v[34:35]
    v_pk_add_f32 v[100:101], v[100:101], v[44:45]
    v_pk_add_f32 v[32:33], v[32:33], v[36:37]
    v_pk_add_f32 v[100:101], v[100:101], v[46:47]
    v_pk_add_f32 v[32:33], v[32:33], v[38:39]
    s_waitcnt lgkmcnt(4)
    v_pk_fma_f32 v[100:101], v[32:33], v[28:29], v[100:101] op_sel:[0,1,0] op_sel_hi:[1,1,1]
    s_waitcnt lgkmcnt(3)
    v_pk_fma_f32 v[100:101], v[20:21], v[28:29], v[100:101] op_sel_hi:[1,0,1]
    s_waitcnt lgkmcnt(2)
    v_pk_fma_f32 v[100:101], v[22:23], v[28:29], v[100:101] op_sel_hi:[1,0,1]
    s_waitcnt lgkmcnt(1)
    v_pk_fma_f32 v[100:101], v[24:25], v[28:29], v[100:101] op_sel_hi:[1,0,1]
    s_waitcnt lgkmcnt(0)
    v_pk_fma_f32 v[100:101], v[26:27], v[28:29], v[100:101] op_sel_hi:[1,0,1]
    v_pk_mul_f32 v[20:21], v[100:101], v[100:101]
    v_fma_f32 v20, v20, s34, v10
    v_fma_f32 v21, v21, s34, v10
    v_pk_mul_f32 v[20:21], v[20:21], v[100:101]
    v_exp_f32 v20, v20
    v_exp_f32 v21, v21
    v_add_f32 v20, 1.0, v20
    v_add_f32 v21, 1.0, v21
    v_rcp_f32 v20, v20
    v_rcp_f32 v21, v21
    s_nop 0
    v_pk_mul_f32 v[20:21], v[20:21], v[100:101]
    v_cvt_pk_bf16_f32 v20, v20, v21
    v_min_u32 v20, -2, v20
    buffer_store_dword v20, v5, s[44:47], s52 offen sc1
    buffer_store_dword v20, v4, s[44:47], s52 offen sc1
    buffer_store_dword v20, v5, s[44:47], s53 offen sc1
    buffer_store_dword v20, v4, s[44:47], s53 offen sc1
    s_branch L_fin
L_w1_x:
    s_waitcnt lgkmcnt(0)
    s_barrier
    s_branch L_fin
L_t_w2:
    s_barrier
L_w2_dma:
    s_and_b32 s34, s40, 7
    s_lshl_b32 s35, s34, 10
    s_add_u32 m0, s50, s35
    s_mul_i32 s34, s34, 40960
    buffer_load_dwordx4 v204, s[52:55], s34 offen  lds
    s_add_u32 s40, s40, 1
    s_cmp_lg_u32 s40, s42
    s_cbranch_scc1 L_w2_nw
L_w2_nw:
    s_cmp_lt_u32 s40, s41
    s_cbranch_scc1 L_w2_dma
    ds_read_b32 v8, v7
    s_waitcnt lgkmcnt(0)
    v_cmp_eq_u32 vcc, 0, v8
    s_cbranch_vccnz L_w2_slow
    s_mov_b32 s35, 0
    buffer_load_dwordx4 v[64:67], v4, s[44:47], 0 offen sc1
    buffer_load_dwordx4 v[68:71], v5, s[44:47], s48 offen sc1
    s_waitcnt vmcnt(2)
    ds_read_b64_tr_b16 v[32:33], v205 offset:0
    ds_read_b64_tr_b16 v[34:35], v205 offset:512
    ds_read_b64_tr_b16 v[36:37], v205 offset:1024
    ds_read_b64_tr_b16 v[38:39], v205 offset:1536
    ds_read_b64_tr_b16 v[40:41], v205 offset:2048
    ds_read_b64_tr_b16 v[42:43], v205 offset:2560
    ds_read_b64_tr_b16 v[44:45], v205 offset:3072
    ds_read_b64_tr_b16 v[46:47], v205 offset:3584
    s_waitcnt lgkmcnt(0)
    ds_read_b64_tr_b16 v[48:49], v205 offset:4096
    ds_read_b64_tr_b16 v[50:51], v205 offset:4608
    ds_read_b64_tr_b16 v[52:53], v205 offset:5120
    ds_read_b64_tr_b16 v[54:55], v205 offset:5632
    ds_read_b64_tr_b16 v[56:57], v205 offset:6144
    ds_read_b64_tr_b16 v[58:59], v205 offset:6656
    ds_read_b64_tr_b16 v[60:61], v205 offset:7168
    ds_read_b64_tr_b16 v[62:63], v205 offset:7680
    s_waitcnt lgkmcnt(0)
    s_branch L_w2_mid
L_w2_slow:
    s_waitcnt vmcnt(0)
    ds_read_b64_tr_b16 v[32:33], v205 offset:0
    ds_read_b64_tr_b16 v[34:35], v205 offset:512
    ds_read_b64_tr_b16 v[36:37], v205 offset:1024
    ds_read_b64_tr_b16 v[38:39], v205 offset:1536
    ds_read_b64_tr_b16 v[40:41], v205 offset:2048
    ds_read_b64_tr_b16 v[42:43], v205 offset:2560
    ds_read_b64_tr_b16 v[44:45], v205 offset:3072
    ds_read_b64_tr_b16 v[46:47], v205 offset:3584
    s_waitcnt lgkmcnt(0)
    ds_read_b64_tr_b16 v[48:49], v205 offset:4096
    ds_read_b64_tr_b16 v[50:51], v205 offset:4608
    ds_read_b64_tr_b16 v[52:53], v205 offset:5120
    ds_read_b64_tr_b16 v[54:55], v205 offset:5632
    ds_read_b64_tr_b16 v[56:57], v205 offset:6144
    ds_read_b64_tr_b16 v[58:59], v205 offset:6656
    ds_read_b64_tr_b16 v[60:61], v205 offset:7168
    ds_read_b64_tr_b16 v[62:63], v205 offset:7680
    s_waitcnt lgkmcnt(0)
    s_mov_b32 s35, 0
L_poll89:
    ds_read_b32 v8, v7
    s_add_u32 s35, s35, 1
    s_waitcnt lgkmcnt(0)
    v_cmp_eq_u32 vcc, 0, v8
    s_cbranch_vccz L_done90
    s_sleep 1
    s_cmp_lt_u32 s35, 60000
    s_cbranch_scc1 L_poll89
L_done90:
    s_mov_b32 s35, 0
L_poll92:
    buffer_load_dwordx4 v[64:67], v4, s[44:47], 0 offen sc1
    buffer_load_dwordx4 v[68:71], v5, s[44:47], s48 offen sc1
L_w2_mid:
    s_add_u32 s35, s35, 1
    s_waitcnt vmcnt(0)
    v_max3_u32 v28, v64, v65, v66
    v_max3_u32 v28, v28, v67, v68
    v_max3_u32 v28, v28, v69, v70
    v_max_u32 v28, v28, v71
    v_cmp_eq_u32 vcc, -1, v28
    s_cbranch_vccz L_done93
    s_cmp_lg_u32 s35, 64
    s_cbranch_scc1 L_tmo95
    s_mov_b64 exec, -1
    v_lshlrev_b32 v243, 4, v0
    v_add_u32 v243, 131328, v243
    ds_read_b96 v[240:242], v243
    s_waitcnt lgkmcnt(0)
    buffer_store_dword v240, v242, s[44:47], 0 offen sc1
    buffer_store_dword v241, v242, s[44:47], 0 offen offset:256 sc1
L_tmo95:
    s_cmp_lt_u32 s35, 60000
    s_cbranch_scc1 L_poll92
L_done93:
    v_mfma_f32_16x16x32_bf16 v[80:83], v[32:35], v[64:67], 0
    v_mfma_f32_16x16x32_bf16 v[80:83], v[48:51], v[68:71], v[80:83]
    v_mfma_f32_16x16x32_bf16 v[84:87], v[36:39], v[64:67], 0
    v_mfma_f32_16x16x32_bf16 v[84:87], v[52:55], v[68:71], v[84:87]
    v_mfma_f32_16x16x32_bf16 v[88:91], v[40:43], v[64:67], 0
    v_mfma_f32_16x16x32_bf16 v[88:91], v[56:59], v[68:71], v[88:91]
    v_mfma_f32_16x16x32_bf16 v[92:95], v[44:47], v[64:67], 0
    v_mfma_f32_16x16x32_bf16 v[92:95], v[60:63], v[68:71], v[92:95]
    s_nop 3
    v_add_f32_dpp v80, v84, v80 row_shl:4 row_mask:0xf bank_mask:0x1
    v_add_f32_dpp v81, v85, v81 row_shl:4 row_mask:0xf bank_mask:0x1
    v_add_f32_dpp v82, v86, v82 row_shl:4 row_mask:0xf bank_mask:0x1
    v_add_f32_dpp v83, v87, v83 row_shl:4 row_mask:0xf bank_mask:0x1
    v_add_f32_dpp v80, v88, v80 row_shl:8 row_mask:0xf bank_mask:0x1
    v_add_f32_dpp v81, v89, v81 row_shl:8 row_mask:0xf bank_mask:0x1
    v_add_f32_dpp v82, v90, v82 row_shl:8 row_mask:0xf bank_mask:0x1
    v_add_f32_dpp v83, v91, v83 row_shl:8 row_mask:0xf bank_mask:0x1
    v_add_f32_dpp v80, v92, v80 row_shl:12 row_mask:0xf bank_mask:0x1
    v_add_f32_dpp v81, v93, v81 row_shl:12 row_mask:0xf bank_mask:0x1
    v_add_f32_dpp v82, v94, v82 row_shl:12 row_mask:0xf bank_mask:0x1
    v_add_f32_dpp v83, v95, v83 row_shl:12 row_mask:0xf bank_mask:0x1
    ds_write_b128 v203, v[80:83]
    s_waitcnt lgkmcnt(0)
    s_barrier
    s_branch L_fin
L_w2_red:
    s_mov_b32 s35, 0
L_poll96:
    buffer_load_dwordx2 v[20:21], v204, s[44:47], 0 offen sc1
    buffer_load_dwordx2 v[22:23], v204, s[44:47], s48 offen sc1
    s_add_u32 s35, s35, 1
    s_waitcnt vmcnt(0)
    v_max3_u32 v28, v20, v21, v22
    v_max_u32 v28, v28, v23
    v_cmp_eq_u32 vcc, -1, v28
    s_cbranch_vccz L_done97
    s_cmp_lg_u32 s35, 21
    s_cbranch_scc1 L_tmo99
    s_mov_b64 exec, -1
    v_lshlrev_b32 v243, 4, v0
    v_add_u32 v243, 131328, v243
    ds_read_b96 v[240:242], v243
    s_waitcnt lgkmcnt(0)
    buffer_store_dword v240, v242, s[44:47], 0 offen sc1
    buffer_store_dword v241, v242, s[44:47], 0 offen offset:256 sc1
L_tmo99:
    s_sleep 6
    s_cmp_lt_u32 s35, 60000
    s_cbranch_scc1 L_poll96
L_done97:
    v_mov_b32 v7, 99084
    ds_write_b32 v7, v7
    v_lshlrev_b32 v44, 16, v20
    v_and_b32 v45, 0xffff0000, v20
    v_lshlrev_b32 v46, 16, v21
    v_and_b32 v47, 0xffff0000, v21
    v_lshlrev_b32 v48, 16, v22
    v_and_b32 v49, 0xffff0000, v22
    v_lshlrev_b32 v50, 16, v23
    v_and_b32 v51, 0xffff0000, v23
    v_add_f32 v108, v108, v44
    v_add_f32 v109, v109, v45
    v_add_f32 v110, v110, v46
    v_add_f32 v111, v111, v47
    v_add_f32 v108, v108, v48
    v_add_f32 v109, v109, v49
    v_add_f32 v110, v110, v50
    v_add_f32 v111, v111, v51
    s_mov_b32 s36, s28
    s_mov_b32 s37, s29
    s_movk_i32 s38, 5120
    v_add_f32_dpp v108, v108, v108 row_ror:4 row_mask:0xf bank_mask:0xf
    v_add_f32_dpp v109, v109, v109 row_ror:4 row_mask:0xf bank_mask:0xf
    v_add_f32_dpp v110, v110, v110 row_ror:4 row_mask:0xf bank_mask:0xf
    v_add_f32_dpp v111, v111, v111 row_ror:4 row_mask:0xf bank_mask:0xf
    v_add_f32_dpp v108, v108, v108 row_ror:8 row_mask:0xf bank_mask:0xf
    v_add_f32_dpp v109, v109, v109 row_ror:8 row_mask:0xf bank_mask:0xf
    v_add_f32_dpp v110, v110, v110 row_ror:8 row_mask:0xf bank_mask:0xf
    v_add_f32_dpp v111, v111, v111 row_ror:8 row_mask:0xf bank_mask:0xf
    v_mov_b32_dpp v108, v104 quad_perm:[0,1,2,3] row_mask:0xf bank_mask:0x2
    v_mov_b32_dpp v109, v105 quad_perm:[0,1,2,3] row_mask:0xf bank_mask:0x2
    v_mov_b32_dpp v110, v106 quad_perm:[0,1,2,3] row_mask:0xf bank_mask:0x2
    v_mov_b32_dpp v111, v107 quad_perm:[0,1,2,3] row_mask:0xf bank_mask:0x2
    ds_write_b128 v203, v[108:111]
    v_and_b32 v6, 31, v0
    v_lshlrev_b32 v6, 3, v6
    v_add_u32 v6, 122112, v6
    ds_read_b64 v[108:109], v6
    ds_read_b64 v[104:105], v6 offset:320
    v_bfe_u32 v112, v0, 1, 2
    v_mul_u32_u24 v112, 1280, v112
    v_bfe_u32 v7, v0, 3, 2
    v_lshl_add_u32 v112, v7, 3, v112
    v_and_b32 v7, 1, v0
    v_lshl_add_u32 v112, v7, 2, v112
    v_lshrrev_b32 v7, 5, v0
    v_lshl_add_u32 v112, v7, 28, v112
    s_lshl_b32 s34, s62, 5
    s_waitcnt lgkmcnt(0)
    s_barrier
    ds_read_b64 v[64:65], v6 offset:1024
    ds_read_b64 v[66:67], v6 offset:2048
    ds_read_b64 v[68:69], v6 offset:3072
    ds_read_b64 v[70:71], v6 offset:4096
    ds_read_b64 v[72:73], v6 offset:5120
    ds_read_b64 v[74:75], v6 offset:6144
    ds_read_b64 v[76:77], v6 offset:7168
    s_waitcnt lgkmcnt(6)
    v_pk_fma_f32 v[108:109], v[64:65], v[104:105], v[108:109]
    s_waitcnt lgkmcnt(5)
    v_pk_fma_f32 v[108:109], v[66:67], v[104:105], v[108:109]
    s_waitcnt lgkmcnt(4)
    v_pk_fma_f32 v[108:109], v[68:69], v[104:105], v[108:109]
    s_waitcnt lgkmcnt(3)
    v_pk_fma_f32 v[108:109], v[70:71], v[104:105], v[108:109]
    s_waitcnt lgkmcnt(2)
    v_pk_fma_f32 v[108:109], v[72:73], v[104:105], v[108:109]
    s_waitcnt lgkmcnt(1)
    v_pk_fma_f32 v[108:109], v[74:75], v[104:105], v[108:109]
    s_waitcnt lgkmcnt(0)
    v_pk_fma_f32 v[108:109], v[76:77], v[104:105], v[108:109]
    v_cvt_pk_bf16_f32 v20, v108, v109
    buffer_store_dword v20, v112, s[36:39], s34 offen
    s_branch L_fin
L_t_wo:
    s_barrier
L_r_wo2:
    s_mov_b32 m0, s56
    s_nop 0
    buffer_load_dwordx4 v15, s[52:55], s57 offen  lds
    s_mov_b32 m0, s58
    s_nop 0
    buffer_load_dwordx4 v15, s[52:55], s59 offen  lds
    s_xor_b32 m0, s56, 2048
    s_sub_u32 s34, 40960, s57
    buffer_load_dwordx4 v15, s[52:55], s34 offen  lds
    s_xor_b32 m0, s58, 2048
    s_sub_u32 s34, 42240, s57
    buffer_load_dwordx4 v15, s[52:55], s34 offen  lds
L_r_wo3:
    s_mov_b32 s35, 0
    s_mov_b32 s48, 0
    buffer_load_dwordx4 v[64:67], v205, s[44:47], 0 offen sc1
    buffer_load_dwordx2 v[26:27], v204, s[44:47], 0 offen sc1
    s_waitcnt vmcnt(2)
    ds_read_b64_tr_b16 v[32:33], v206 offset:0
    ds_read_b64_tr_b16 v[34:35], v206 offset:1024
    ds_read_b64_tr_b16 v[36:37], v206 offset:32
    ds_read_b64_tr_b16 v[38:39], v206 offset:1056
    ds_read_b64_tr_b16 v[40:41], v206 offset:2048
    ds_read_b64_tr_b16 v[42:43], v206 offset:3072
    ds_read_b64_tr_b16 v[44:45], v206 offset:2080
    ds_read_b64_tr_b16 v[46:47], v206 offset:3104
    s_branch L_pam
L_pa:
    buffer_load_dwordx4 v[64:67], v205, s[44:47], 0 offen sc1
    buffer_load_dwordx2 v[26:27], v204, s[44:47], 0 offen sc1
L_pam:
    s_add_u32 s35, s35, 1
    s_waitcnt vmcnt(0)
    ds_write_b128 v207, v[64:67]
    ds_write_b32 v212, v26 offset:128
    v_max3_u32 v28, v64, v65, v66
    v_max3_u32 v28, v28, v67, v26
    v_cmp_eq_u32 vcc, -1, v28
    s_cbranch_vccz L_pad
    s_cmp_lg_u32 s35, 64
    s_cbranch_scc1 L_tmo100
    s_mov_b64 exec, -1
    v_lshlrev_b32 v243, 4, v0
    v_add_u32 v243, 131328, v243
    ds_read_b96 v[240:242], v243
    s_waitcnt lgkmcnt(0)
    buffer_store_dword v240, v242, s[44:47], 0 offen sc1
    buffer_store_dword v241, v242, s[44:47], 0 offen offset:256 sc1
L_tmo100:
    s_mov_b64 exec, vcc
    s_cmp_lt_u32 s35, 60000
    s_cbranch_scc1 L_pa
L_pad:
    s_mov_b64 exec, -1
    ds_read_b32 v26, v213 offset:128
    ds_read_b128 v[68:71], v208 offset:0
    ds_read_b128 v[72:75], v209 offset:0
    ds_read_b128 v[76:79], v208 offset:64
    ds_read_b128 v[80:83], v209 offset:64
    s_waitcnt lgkmcnt(3)
    v_mfma_f32_16x16x32_bf16 v[20:23], v[32:35], v[68:71], 0
    s_waitcnt lgkmcnt(2)
    v_mfma_f32_16x16x32_bf16 v[20:23], v[36:39], v[72:75], v[20:23]
    s_waitcnt lgkmcnt(1)
    v_mfma_f32_16x16x32_bf16 v[20:23], v[40:43], v[76:79], v[20:23]
    s_waitcnt lgkmcnt(0)
    v_mfma_f32_16x16x32_bf16 v[20:23], v[44:47], v[80:83], v[20:23]
    v_sub_f32_dpp v26, v26, v26 quad_perm:[1,0,3,2] row_mask:0xf bank_mask:0xf
    v_exp_f32 v26, v26
    s_nop 0
    v_add_f32 v26, 1.0, v26
    v_rcp_f32 v26, v26
    s_nop 0
    v_sub_f32 v30, 1.0, v26
    s_nop 0
    v_pk_mul_f32 v[48:49], v[20:21], v[26:27] op_sel_hi:[1,0]
    v_pk_mul_f32 v[50:51], v[22:23], v[26:27] op_sel_hi:[1,0]
    v_fmac_f32_dpp v48, v20, v30 quad_perm:[1,0,3,2] row_mask:0xf bank_mask:0xf
    v_fmac_f32_dpp v49, v21, v30 quad_perm:[1,0,3,2] row_mask:0xf bank_mask:0xf
    v_fmac_f32_dpp v50, v22, v30 quad_perm:[1,0,3,2] row_mask:0xf bank_mask:0xf
    v_fmac_f32_dpp v51, v23, v30 quad_perm:[1,0,3,2] row_mask:0xf bank_mask:0xf
    ds_write_b128 v203, v[48:51]
    s_cmp_lg_u32 s3, 0
    s_waitcnt lgkmcnt(0)
    s_barrier
    s_cbranch_scc1 L_wo_x
    ds_read_b64 v[64:65], v113 offset:0
    ds_read_b64 v[66:67], v113 offset:1152
    ds_read_b64 v[68:69], v113 offset:2304
    ds_read_b64 v[70:71], v113 offset:3456
    ds_read_b64 v[72:73], v113 offset:4608
    ds_read_b64 v[74:75], v113 offset:5760
    ds_read_b64 v[76:77], v113 offset:6912
    ds_read_b64 v[78:79], v113 offset:8064
    s_waitcnt lgkmcnt(6)
    v_pk_add_f32 v[64:65], v[64:65], v[66:67]
    s_waitcnt lgkmcnt(5)
    v_pk_add_f32 v[64:65], v[64:65], v[68:69]
    s_waitcnt lgkmcnt(4)
    v_pk_add_f32 v[64:65], v[64:65], v[70:71]
    s_waitcnt lgkmcnt(3)
    v_pk_add_f32 v[64:65], v[64:65], v[72:73]
    s_waitcnt lgkmcnt(2)
    v_pk_add_f32 v[64:65], v[64:65], v[74:75]
    s_waitcnt lgkmcnt(1)
    v_pk_add_f32 v[64:65], v[64:65], v[76:77]
    s_waitcnt lgkmcnt(0)
    v_pk_add_f32 v[64:65], v[64:65], v[78:79]
    v_pk_mul_f32 v[64:65], v[64:65], v[100:101]
    v_cvt_pk_bf16_f32 v28, v64, v65
    v_min_u32 v28, -2, v28
    buffer_store_dword v28, v112, s[44:47], s101 offen sc1
    buffer_store_dword v28, v112, s[44:47], s93 offen sc1
L_wo_x:
    s_getreg_b32 s34, hwreg(HW_REG_XCC_ID, 0, 4)
    v_cmp_ne_u32 vcc, s34, v27
    s_cbranch_vccz L_fin
    s_mov_b64 exec, -1
    v_lshlrev_b32 v243, 4, v0
    v_add_u32 v243, 131328, v243
    ds_read_b96 v[240:242], v243
    s_waitcnt lgkmcnt(0)
    buffer_store_dword v240, v242, s[44:47], 0 offen sc1
    buffer_store_dword v241, v242, s[44:47], 0 offen offset:256 sc1
L_fin:
L_exit:
    s_endpgm
L_codeend:
.section .rodata,"a"
.p2align 6
.amdhsa_kernel adaLN_cond__sliding_block_cached__dense_activation_gelu__decode_kernel
  .amdhsa_next_free_vgpr 256
  .amdhsa_next_free_sgpr 102
  .amdhsa_accum_offset 256
  .amdhsa_group_segment_fixed_size 0
  .amdhsa_kernarg_size 120
  .amdhsa_user_sgpr_count 2
  .amdhsa_user_sgpr_kernarg_segment_ptr 1
  .amdhsa_system_sgpr_workgroup_id_x 1
  .amdhsa_float_denorm_mode_32 3
.end_amdhsa_kernel
```

```asm
; @launch grid=(256,1,1) block=(512,1,1) lds=132352
.amdgcn_target "amdgcn-amd-amdhsa--gfx950"
.text
.globl adaLN_cond__sliding_block_cached__dense_activation_gelu__decode_kernel
.p2align 8
.type adaLN_cond__sliding_block_cached__dense_activation_gelu__decode_kernel,@function
adaLN_cond__sliding_block_cached__dense_activation_gelu__decode_kernel:
    s_load_dwordx4 s[4:7], s[0:1], 0
    s_cmpk_ge_u32 s2, 256
    s_cbranch_scc1 L_exit
    v_lshrrev_b32 v1, 6, v0
    v_and_b32 v0, 63, v0
    v_readfirstlane_b32 s3, v1
    v_add_u32 v1, -1, v1
    v_lshlrev_b32 v1, 12, v1
    v_lshl_add_u32 v1, v0, 4, v1
    s_lshl_b32 s34, s2, 21
    s_bitset0_b32 s34, 28
    s_lshr_b32 s35, s2, 7
    s_mul_i32 s98, s35, 57344
    s_add_u32 s35, s35, 6
    s_lshl_b32 s35, s35, 18
    s_add_u32 s34, s34, s35
    s_lshl_b32 s38, 1, 18
    s_lshl_b32 s39, 1, 17
    s_cmp_eq_u32 s3, 0
    s_cbranch_scc1 L_nohead
    s_waitcnt lgkmcnt(0)
    s_add_u32 s36, s6, s34
    s_addc_u32 s37, s7, 0
    buffer_load_dwordx4 v[16:19], v1, s[36:39], s98 offen offset:0 nt
    buffer_load_dwordx4 v[20:23], v1, s[36:39], s98 offen offset:1024 nt
    buffer_load_dwordx4 v[24:27], v1, s[36:39], s98 offen offset:2048 nt
L_nohead:
    s_load_dwordx8 s[8:15], s[0:1], 16
    s_load_dwordx4 s[16:19], s[0:1], 48
    s_load_dwordx8 s[20:27], s[0:1], 64
    s_load_dwordx4 s[28:31], s[0:1], 96
    s_load_dwordx2 s[32:33], s[0:1], 112
    s_and_b32 s60, s2, 7
    s_lshr_b32 s61, s2, 3
    s_mov_b32 s39, 0x20000
    s_mov_b32 s43, 0x20000
    s_mov_b32 s46, 1835008
    s_mov_b32 s47, 0x20000
    s_cmp_lg_u32 s3, 0
    s_cbranch_scc1 L_stream
    s_setprio 3
    v_and_b32 v12, 3, v0
    v_bfe_u32 v13, v0, 2, 2
    v_lshrrev_b32 v14, 4, v0
    v_lshrrev_b32 v10, 3, v0
    v_and_b32 v11, 7, v0
    v_lshlrev_b32 v11, 4, v11
    s_lshr_b32 s50, s2, 2
    s_and_b32 s51, s2, 3
    s_mul_i32 s34, s51, 1228800
    s_lshl_b32 s35, s50, 7
    s_add_u32 s34, s34, s35
    v_mul_u32_u24 v17, 7680, v10
    v_add3_u32 v17, v17, v11, s34
    v_mul_u32_u24 v16, 1280, v12
    v_lshl_add_u32 v18, v14, 4, v16
    s_mul_i32 s34, s51, 320
    v_add_u32 v19, s34, v18
    s_mov_b32 s38, 4915200
    s_sub_u32 s52, s50, 10
    s_waitcnt lgkmcnt(0)
    s_add_u32 s44, s32, 0
    s_addc_u32 s45, s33, 0
    s_cmp_ge_u32 s2, 240
    s_cbranch_scc1 L_clear
    s_mov_b32 s36, s26
    s_mov_b32 s37, s27
    s_mov_b32 m0, 0
    s_mov_b32 s34, 0
L_dma1:
    buffer_load_dwordx4 v17, s[36:39], s34 offen  lds
    s_add_u32 m0, m0, 1024
    s_add_u32 s34, s34, 61440
    buffer_load_dwordx4 v17, s[36:39], s34 offen  lds
    s_add_u32 m0, m0, 1024
    s_add_u32 s34, s34, 61440
    buffer_load_dwordx4 v17, s[36:39], s34 offen  lds
    s_add_u32 m0, m0, 1024
    s_add_u32 s34, s34, 61440
    buffer_load_dwordx4 v17, s[36:39], s34 offen  lds
    s_add_u32 m0, m0, 1024
    s_add_u32 s34, s34, 61440
    s_cmp_lt_u32 s34, 1228800
    s_cbranch_scc1 L_dma1
    v_lshlrev_b32 v1, 2, v0
    v_add_u32 v1, 98304, v1
    v_mov_b32 v2, -1
    v_mov_b32 v3, 0
    ds_write_b32 v1, v2
    ds_write_b32 v1, v2 offset:256
    ds_write_b32 v1, v3 offset:512
    ds_write_b32 v1, v3 offset:768
    s_waitcnt lgkmcnt(0)
    s_barrier
    s_cmp_ge_u32 s52, 10
    s_cbranch_scc1 L_nox
    v_lshl_add_u32 v18, v13, 6, v18
    global_load_dwordx4 v[52:55], v18, s[4:5] offset:0
    global_load_dwordx4 v[56:59], v18, s[4:5] offset:256
    global_load_dwordx4 v[60:63], v18, s[4:5] offset:512
    global_load_dwordx4 v[64:67], v18, s[4:5] offset:768
    global_load_dwordx4 v[68:71], v18, s[4:5] offset:1024
    s_lshl_b32 s34, s52, 7
    v_lshl_add_u32 v16, v13, 5, v16
    v_lshl_add_u32 v16, v14, 3, v16
    v_add_u32 v16, s34, v16
    global_load_dwordx2 v[72:73], v16, s[4:5]
L_nox:
    global_load_dwordx4 v[32:35], v19, s[24:25] offset:0
    global_load_dwordx4 v[36:39], v19, s[24:25] offset:64
    global_load_dwordx4 v[40:43], v19, s[24:25] offset:128
    global_load_dwordx4 v[44:47], v19, s[24:25] offset:192
    global_load_dwordx4 v[48:51], v19, s[24:25] offset:256
    s_and_b32 s34, s2, 31
    s_lshl_b32 s34, s34, 8
    s_lshr_b32 s35, s2, 7
    s_lshl_b32 s35, s35, 7
    s_add_u32 s49, s34, s35
    s_bfe_u32 s53, s2, 0x20005
    s_mul_i32 s34, s53, 1310720
    s_add_u32 s34, s34, s49
    v_lshl_add_u32 v16, v10, 13, v11
    v_add_u32 v16, s34, v16
    s_mov_b32 s36, s10
    s_mov_b32 s37, s11
    s_mov_b32 s38, 5242880
    s_mov_b32 m0, 20480
    s_mov_b32 s34, 0
L_dma2:
    buffer_load_dwordx4 v16, s[36:39], s34 offen  lds
    s_add_u32 m0, m0, 1024
    s_add_u32 s34, s34, 65536
    buffer_load_dwordx4 v16, s[36:39], s34 offen  lds
    s_add_u32 m0, m0, 1024
    s_add_u32 s34, s34, 65536
    buffer_load_dwordx4 v16, s[36:39], s34 offen  lds
    s_add_u32 m0, m0, 1024
    s_add_u32 s34, s34, 65536
    buffer_load_dwordx4 v16, s[36:39], s34 offen  lds
    s_add_u32 m0, m0, 1024
    s_add_u32 s34, s34, 65536
    s_cmp_lt_u32 s34, 1310720
    s_cbranch_scc1 L_dma2
    v_lshl_add_u32 v15, v14, 3, v13
    v_lshlrev_b32 v15, 7, v15
    v_lshl_add_u32 v15, v12, 3, v15
    s_waitcnt vmcnt(20)
    s_mov_b32 s34, 0xbfb8aa3b
    v_lshlrev_b32 v20, 16, v32
    v_and_b32 v21, 0xffff0000, v32
    v_lshlrev_b32 v22, 16, v33
    v_and_b32 v23, 0xffff0000, v33
    v_mul_f32 v24, s34, v20
    v_mul_f32 v25, s34, v21
    v_mul_f32 v26, s34, v22
    v_mul_f32 v27, s34, v23
    v_exp_f32 v24, v24
    v_exp_f32 v25, v25
    v_exp_f32 v26, v26
    v_exp_f32 v27, v27
    v_add_f32 v24, 1.0, v24
    v_add_f32 v25, 1.0, v25
    v_add_f32 v26, 1.0, v26
    v_add_f32 v27, 1.0, v27
    v_rcp_f32 v24, v24
    v_rcp_f32 v25, v25
    v_rcp_f32 v26, v26
    v_rcp_f32 v27, v27
    v_mul_f32 v24, v20, v24
    v_mul_f32 v25, v21, v25
    v_mul_f32 v26, v22, v26
    v_mul_f32 v27, v23, v27
    v_cvt_pk_bf16_f32 v32, v24, v25
    v_cvt_pk_bf16_f32 v33, v26, v27
    v_lshlrev_b32 v20, 16, v34
    v_and_b32 v21, 0xffff0000, v34
    v_lshlrev_b32 v22, 16, v35
    v_and_b32 v23, 0xffff0000, v35
    v_mul_f32 v24, s34, v20
    v_mul_f32 v25, s34, v21
    v_mul_f32 v26, s34, v22
    v_mul_f32 v27, s34, v23
    v_exp_f32 v24, v24
    v_exp_f32 v25, v25
    v_exp_f32 v26, v26
    v_exp_f32 v27, v27
    v_add_f32 v24, 1.0, v24
    v_add_f32 v25, 1.0, v25
    v_add_f32 v26, 1.0, v26
    v_add_f32 v27, 1.0, v27
    v_rcp_f32 v24, v24
    v_rcp_f32 v25, v25
    v_rcp_f32 v26, v26
    v_rcp_f32 v27, v27
    v_mul_f32 v24, v20, v24
    v_mul_f32 v25, v21, v25
    v_mul_f32 v26, v22, v26
    v_mul_f32 v27, v23, v27
    v_cvt_pk_bf16_f32 v34, v24, v25
    v_cvt_pk_bf16_f32 v35, v26, v27
    v_lshlrev_b32 v20, 16, v36
    v_and_b32 v21, 0xffff0000, v36
    v_lshlrev_b32 v22, 16, v37
    v_and_b32 v23, 0xffff0000, v37
    v_mul_f32 v24, s34, v20
    v_mul_f32 v25, s34, v21
    v_mul_f32 v26, s34, v22
    v_mul_f32 v27, s34, v23
    v_exp_f32 v24, v24
    v_exp_f32 v25, v25
    v_exp_f32 v26, v26
    v_exp_f32 v27, v27
    v_add_f32 v24, 1.0, v24
    v_add_f32 v25, 1.0, v25
    v_add_f32 v26, 1.0, v26
    v_add_f32 v27, 1.0, v27
    v_rcp_f32 v24, v24
    v_rcp_f32 v25, v25
    v_rcp_f32 v26, v26
    v_rcp_f32 v27, v27
    v_mul_f32 v24, v20, v24
    v_mul_f32 v25, v21, v25
    v_mul_f32 v26, v22, v26
    v_mul_f32 v27, v23, v27
    v_cvt_pk_bf16_f32 v36, v24, v25
    v_cvt_pk_bf16_f32 v37, v26, v27
    v_lshlrev_b32 v20, 16, v38
    v_and_b32 v21, 0xffff0000, v38
    v_lshlrev_b32 v22, 16, v39
    v_and_b32 v23, 0xffff0000, v39
    v_mul_f32 v24, s34, v20
    v_mul_f32 v25, s34, v21
    v_mul_f32 v26, s34, v22
    v_mul_f32 v27, s34, v23
    v_exp_f32 v24, v24
    v_exp_f32 v25, v25
    v_exp_f32 v26, v26
    v_exp_f32 v27, v27
    v_add_f32 v24, 1.0, v24
    v_add_f32 v25, 1.0, v25
    v_add_f32 v26, 1.0, v26
    v_add_f32 v27, 1.0, v27
    v_rcp_f32 v24, v24
    v_rcp_f32 v25, v25
    v_rcp_f32 v26, v26
    v_rcp_f32 v27, v27
    v_mul_f32 v24, v20, v24
    v_mul_f32 v25, v21, v25
    v_mul_f32 v26, v22, v26
    v_mul_f32 v27, v23, v27
    v_cvt_pk_bf16_f32 v38, v24, v25
    v_cvt_pk_bf16_f32 v39, v26, v27
    v_lshlrev_b32 v20, 16, v40
    v_and_b32 v21, 0xffff0000, v40
    v_lshlrev_b32 v22, 16, v41
    v_and_b32 v23, 0xffff0000, v41
    v_mul_f32 v24, s34, v20
    v_mul_f32 v25, s34, v21
    v_mul_f32 v26, s34, v22
    v_mul_f32 v27, s34, v23
    v_exp_f32 v24, v24
    v_exp_f32 v25, v25
    v_exp_f32 v26, v26
    v_exp_f32 v27, v27
    v_add_f32 v24, 1.0, v24
    v_add_f32 v25, 1.0, v25
    v_add_f32 v26, 1.0, v26
    v_add_f32 v27, 1.0, v27
    v_rcp_f32 v24, v24
    v_rcp_f32 v25, v25
    v_rcp_f32 v26, v26
    v_rcp_f32 v27, v27
    v_mul_f32 v24, v20, v24
    v_mul_f32 v25, v21, v25
    v_mul_f32 v26, v22, v26
    v_mul_f32 v27, v23, v27
    v_cvt_pk_bf16_f32 v40, v24, v25
    v_cvt_pk_bf16_f32 v41, v26, v27
    v_lshlrev_b32 v20, 16, v42
    v_and_b32 v21, 0xffff0000, v42
    v_lshlrev_b32 v22, 16, v43
    v_and_b32 v23, 0xffff0000, v43
    v_mul_f32 v24, s34, v20
    v_mul_f32 v25, s34, v21
    v_mul_f32 v26, s34, v22
    v_mul_f32 v27, s34, v23
    v_exp_f32 v24, v24
    v_exp_f32 v25, v25
    v_exp_f32 v26, v26
    v_exp_f32 v27, v27
    v_add_f32 v24, 1.0, v24
    v_add_f32 v25, 1.0, v25
    v_add_f32 v26, 1.0, v26
    v_add_f32 v27, 1.0, v27
    v_rcp_f32 v24, v24
    v_rcp_f32 v25, v25
    v_rcp_f32 v26, v26
    v_rcp_f32 v27, v27
    v_mul_f32 v24, v20, v24
    v_mul_f32 v25, v21, v25
    v_mul_f32 v26, v22, v26
    v_mul_f32 v27, v23, v27
    v_cvt_pk_bf16_f32 v42, v24, v25
    v_cvt_pk_bf16_f32 v43, v26, v27
    v_lshlrev_b32 v20, 16, v44
    v_and_b32 v21, 0xffff0000, v44
    v_lshlrev_b32 v22, 16, v45
    v_and_b32 v23, 0xffff0000, v45
    v_mul_f32 v24, s34, v20
    v_mul_f32 v25, s34, v21
    v_mul_f32 v26, s34, v22
    v_mul_f32 v27, s34, v23
    v_exp_f32 v24, v24
    v_exp_f32 v25, v25
    v_exp_f32 v26, v26
    v_exp_f32 v27, v27
    v_add_f32 v24, 1.0, v24
    v_add_f32 v25, 1.0, v25
    v_add_f32 v26, 1.0, v26
    v_add_f32 v27, 1.0, v27
    v_rcp_f32 v24, v24
    v_rcp_f32 v25, v25
    v_rcp_f32 v26, v26
    v_rcp_f32 v27, v27
    v_mul_f32 v24, v20, v24
    v_mul_f32 v25, v21, v25
    v_mul_f32 v26, v22, v26
    v_mul_f32 v27, v23, v27
    v_cvt_pk_bf16_f32 v44, v24, v25
    v_cvt_pk_bf16_f32 v45, v26, v27
    v_lshlrev_b32 v20, 16, v46
    v_and_b32 v21, 0xffff0000, v46
    v_lshlrev_b32 v22, 16, v47
    v_and_b32 v23, 0xffff0000, v47
    v_mul_f32 v24, s34, v20
    v_mul_f32 v25, s34, v21
    v_mul_f32 v26, s34, v22
    v_mul_f32 v27, s34, v23
    v_exp_f32 v24, v24
    v_exp_f32 v25, v25
    v_exp_f32 v26, v26
    v_exp_f32 v27, v27
    v_add_f32 v24, 1.0, v24
    v_add_f32 v25, 1.0, v25
    v_add_f32 v26, 1.0, v26
    v_add_f32 v27, 1.0, v27
    v_rcp_f32 v24, v24
    v_rcp_f32 v25, v25
    v_rcp_f32 v26, v26
    v_rcp_f32 v27, v27
    v_mul_f32 v24, v20, v24
    v_mul_f32 v25, v21, v25
    v_mul_f32 v26, v22, v26
    v_mul_f32 v27, v23, v27
    v_cvt_pk_bf16_f32 v46, v24, v25
    v_cvt_pk_bf16_f32 v47, v26, v27
    v_lshlrev_b32 v20, 16, v48
    v_and_b32 v21, 0xffff0000, v48
    v_lshlrev_b32 v22, 16, v49
    v_and_b32 v23, 0xffff0000, v49
    v_mul_f32 v24, s34, v20
    v_mul_f32 v25, s34, v21
    v_mul_f32 v26, s34, v22
    v_mul_f32 v27, s34, v23
    v_exp_f32 v24, v24
    v_exp_f32 v25, v25
    v_exp_f32 v26, v26
    v_exp_f32 v27, v27
    v_add_f32 v24, 1.0, v24
    v_add_f32 v25, 1.0, v25
    v_add_f32 v26, 1.0, v26
    v_add_f32 v27, 1.0, v27
    v_rcp_f32 v24, v24
    v_rcp_f32 v25, v25
    v_rcp_f32 v26, v26
    v_rcp_f32 v27, v27
    v_mul_f32 v24, v20, v24
    v_mul_f32 v25, v21, v25
    v_mul_f32 v26, v22, v26
    v_mul_f32 v27, v23, v27
    v_cvt_pk_bf16_f32 v48, v24, v25
    v_cvt_pk_bf16_f32 v49, v26, v27
    v_lshlrev_b32 v20, 16, v50
    v_and_b32 v21, 0xffff0000, v50
    v_lshlrev_b32 v22, 16, v51
    v_and_b32 v23, 0xffff0000, v51
    v_mul_f32 v24, s34, v20
    v_mul_f32 v25, s34, v21
    v_mul_f32 v26, s34, v22
    v_mul_f32 v27, s34, v23
    v_exp_f32 v24, v24
    v_exp_f32 v25, v25
    v_exp_f32 v26, v26
    v_exp_f32 v27, v27
    v_add_f32 v24, 1.0, v24
    v_add_f32 v25, 1.0, v25
    v_add_f32 v26, 1.0, v26
    v_add_f32 v27, 1.0, v27
    v_rcp_f32 v24, v24
    v_rcp_f32 v25, v25
    v_rcp_f32 v26, v26
    v_rcp_f32 v27, v27
    v_mul_f32 v24, v20, v24
    v_mul_f32 v25, v21, v25
    v_mul_f32 v26, v22, v26
    v_mul_f32 v27, v23, v27
    v_cvt_pk_bf16_f32 v50, v24, v25
    v_cvt_pk_bf16_f32 v51, v26, v27
    s_cmp_ge_u32 s52, 10
    s_cbranch_scc1 L_nostats
    v_mov_b32 v20, 0
    v_mov_b32 v21, 0
    v_mov_b32 v22, 0x3f803f80
    v_dot2c_f32_bf16 v20, v52, v22
    v_dot2c_f32_bf16 v21, v52, v52
    v_dot2c_f32_bf16 v20, v53, v22
    v_dot2c_f32_bf16 v21, v53, v53
    v_dot2c_f32_bf16 v20, v54, v22
    v_dot2c_f32_bf16 v21, v54, v54
    v_dot2c_f32_bf16 v20, v55, v22
    v_dot2c_f32_bf16 v21, v55, v55
    v_dot2c_f32_bf16 v20, v56, v22
    v_dot2c_f32_bf16 v21, v56, v56
    v_dot2c_f32_bf16 v20, v57, v22
    v_dot2c_f32_bf16 v21, v57, v57
    v_dot2c_f32_bf16 v20, v58, v22
    v_dot2c_f32_bf16 v21, v58, v58
    v_dot2c_f32_bf16 v20, v59, v22
    v_dot2c_f32_bf16 v21, v59, v59
    v_dot2c_f32_bf16 v20, v60, v22
    v_dot2c_f32_bf16 v21, v60, v60
    v_dot2c_f32_bf16 v20, v61, v22
    v_dot2c_f32_bf16 v21, v61, v61
    v_dot2c_f32_bf16 v20, v62, v22
    v_dot2c_f32_bf16 v21, v62, v62
    v_dot2c_f32_bf16 v20, v63, v22
    v_dot2c_f32_bf16 v21, v63, v63
    v_dot2c_f32_bf16 v20, v64, v22
    v_dot2c_f32_bf16 v21, v64, v64
    v_dot2c_f32_bf16 v20, v65, v22
    v_dot2c_f32_bf16 v21, v65, v65
    v_dot2c_f32_bf16 v20, v66, v22
    v_dot2c_f32_bf16 v21, v66, v66
    v_dot2c_f32_bf16 v20, v67, v22
    v_dot2c_f32_bf16 v21, v67, v67
    v_dot2c_f32_bf16 v20, v68, v22
    v_dot2c_f32_bf16 v21, v68, v68
    v_dot2c_f32_bf16 v20, v69, v22
    v_dot2c_f32_bf16 v21, v69, v69
    v_dot2c_f32_bf16 v20, v70, v22
    v_dot2c_f32_bf16 v21, v70, v70
    v_dot2c_f32_bf16 v20, v71, v22
    v_dot2c_f32_bf16 v21, v71, v71
    s_nop 1
    v_add_f32_dpp v20, v20, v20 row_ror:4 row_mask:0xf bank_mask:0xf
    v_add_f32_dpp v21, v21, v21 row_ror:4 row_mask:0xf bank_mask:0xf
    s_nop 0
    v_add_f32_dpp v20, v20, v20 row_ror:8 row_mask:0xf bank_mask:0xf
    v_add_f32_dpp v21, v21, v21 row_ror:8 row_mask:0xf bank_mask:0xf
    v_mov_b32 v22, v20
    v_mov_b32 v23, v21
    s_nop 0
    v_permlane16_swap_b32 v20, v22
    v_permlane16_swap_b32 v21, v23
    v_add_f32 v20, v20, v22
    v_add_f32 v21, v21, v23
    v_mov_b32 v22, v20
    v_mov_b32 v23, v21
    s_nop 0
    v_permlane32_swap_b32 v20, v22
    v_permlane32_swap_b32 v21, v23
    v_add_f32 v20, v20, v22
    v_add_f32 v21, v21, v23
    v_mul_f32 v22, 0x3acccccd, v20
    v_mul_f32 v21, 0x3acccccd, v21
    v_fma_f32 v21, -v22, v22, v21
    v_max_f32 v21, 0, v21
    v_add_f32 v21, 0x3727c5ac, v21
    v_rsq_f32 v20, v21
    s_nop 0
    v_mul_f32_e64 v21, -v22, v20
    v_lshlrev_b32 v24, 16, v72
    v_and_b32 v25, 0xffff0000, v72
    v_lshlrev_b32 v26, 16, v73
    v_and_b32 v27, 0xffff0000, v73
    v_fma_f32 v24, v24, v20, v21
    v_fma_f32 v25, v25, v20, v21
    v_fma_f32 v26, v26, v20, v21
    v_fma_f32 v27, v27, v20, v21
L_nostats:
    s_waitcnt vmcnt(20)
    ds_read_b64_tr_b16 v[96:97], v15 offset:0
    ds_read_b64_tr_b16 v[98:99], v15 offset:512
    ds_read_b64_tr_b16 v[100:101], v15 offset:32
    ds_read_b64_tr_b16 v[102:103], v15 offset:544
    ds_read_b64_tr_b16 v[104:105], v15 offset:64
    ds_read_b64_tr_b16 v[106:107], v15 offset:576
    ds_read_b64_tr_b16 v[108:109], v15 offset:96
    ds_read_b64_tr_b16 v[110:111], v15 offset:608
    s_waitcnt lgkmcnt(7)
    ds_read_b64_tr_b16 v[112:113], v15 offset:4096
    ds_read_b64_tr_b16 v[114:115], v15 offset:4608
    ds_read_b64_tr_b16 v[116:117], v15 offset:4128
    ds_read_b64_tr_b16 v[118:119], v15 offset:4640
    ds_read_b64_tr_b16 v[120:121], v15 offset:4160
    ds_read_b64_tr_b16 v[122:123], v15 offset:4672
    ds_read_b64_tr_b16 v[124:125], v15 offset:4192
    ds_read_b64_tr_b16 v[126:127], v15 offset:4704
    s_waitcnt lgkmcnt(7)
    ds_read_b64_tr_b16 v[128:129], v15 offset:8192
    ds_read_b64_tr_b16 v[130:131], v15 offset:8704
    ds_read_b64_tr_b16 v[132:133], v15 offset:8224
    ds_read_b64_tr_b16 v[134:135], v15 offset:8736
    ds_read_b64_tr_b16 v[136:137], v15 offset:8256
    ds_read_b64_tr_b16 v[138:139], v15 offset:8768
    ds_read_b64_tr_b16 v[140:141], v15 offset:8288
    ds_read_b64_tr_b16 v[142:143], v15 offset:8800
    s_waitcnt lgkmcnt(7)
    ds_read_b64_tr_b16 v[144:145], v15 offset:12288
    ds_read_b64_tr_b16 v[146:147], v15 offset:12800
    ds_read_b64_tr_b16 v[148:149], v15 offset:12320
    ds_read_b64_tr_b16 v[150:151], v15 offset:12832
    ds_read_b64_tr_b16 v[152:153], v15 offset:12352
    ds_read_b64_tr_b16 v[154:155], v15 offset:12864
    ds_read_b64_tr_b16 v[156:157], v15 offset:12384
    ds_read_b64_tr_b16 v[158:159], v15 offset:12896
    s_waitcnt lgkmcnt(7)
    ds_read_b64_tr_b16 v[160:161], v15 offset:16384
    ds_read_b64_tr_b16 v[162:163], v15 offset:16896
    ds_read_b64_tr_b16 v[164:165], v15 offset:16416
    ds_read_b64_tr_b16 v[166:167], v15 offset:16928
    ds_read_b64_tr_b16 v[168:169], v15 offset:16448
    ds_read_b64_tr_b16 v[170:171], v15 offset:16960
    ds_read_b64_tr_b16 v[172:173], v15 offset:16480
    ds_read_b64_tr_b16 v[174:175], v15 offset:16992
    s_waitcnt lgkmcnt(0)
    v_mfma_f32_16x16x32_bf16 v[80:83], v[96:99], v[32:35], 0
    v_mfma_f32_16x16x32_bf16 v[84:87], v[100:103], v[32:35], 0
    v_mfma_f32_16x16x32_bf16 v[88:91], v[104:107], v[32:35], 0
    v_mfma_f32_16x16x32_bf16 v[92:95], v[108:111], v[32:35], 0
    v_mfma_f32_16x16x32_bf16 v[80:83], v[112:115], v[36:39], v[80:83]
    v_mfma_f32_16x16x32_bf16 v[84:87], v[116:119], v[36:39], v[84:87]
    v_mfma_f32_16x16x32_bf16 v[88:91], v[120:123], v[36:39], v[88:91]
    v_mfma_f32_16x16x32_bf16 v[92:95], v[124:127], v[36:39], v[92:95]
    v_mfma_f32_16x16x32_bf16 v[80:83], v[128:131], v[40:43], v[80:83]
    v_mfma_f32_16x16x32_bf16 v[84:87], v[132:135], v[40:43], v[84:87]
    v_mfma_f32_16x16x32_bf16 v[88:91], v[136:139], v[40:43], v[88:91]
    v_mfma_f32_16x16x32_bf16 v[92:95], v[140:143], v[40:43], v[92:95]
    v_mfma_f32_16x16x32_bf16 v[80:83], v[144:147], v[44:47], v[80:83]
    v_mfma_f32_16x16x32_bf16 v[84:87], v[148:151], v[44:47], v[84:87]
    v_mfma_f32_16x16x32_bf16 v[88:91], v[152:155], v[44:47], v[88:91]
    v_mfma_f32_16x16x32_bf16 v[92:95], v[156:159], v[44:47], v[92:95]
    v_mfma_f32_16x16x32_bf16 v[80:83], v[160:163], v[48:51], v[80:83]
    v_mfma_f32_16x16x32_bf16 v[84:87], v[164:167], v[48:51], v[84:87]
    v_mfma_f32_16x16x32_bf16 v[88:91], v[168:171], v[48:51], v[88:91]
    v_mfma_f32_16x16x32_bf16 v[92:95], v[172:175], v[48:51], v[92:95]
    s_cmp_ge_u32 s50, 20
    s_cbranch_scc1 L_adr_rest
    s_cmp_lt_u32 s50, 10
    s_cselect_b32 s34, 5120, 0
    s_cselect_b32 s35, s50, s52
    s_lshl_b32 s35, s35, 9
    s_add_u32 s34, s34, s35
    s_lshl_b32 s35, s51, 15
    s_add_u32 s34, s34, s35
    v_lshrrev_b32 v19, 1, v14
    v_lshl_add_u32 v19, v13, 1, v19
    v_lshlrev_b32 v19, 6, v19
    v_lshl_add_u32 v19, v12, 4, v19
    v_and_b32 v20, 1, v14
    v_lshl_add_u32 v19, v20, 3, v19
    s_branch L_adr_done
L_adr_rest:
    s_lshl_b32 s34, s51, 15
    s_lshl_b32 s35, s50, 9
    s_add_u32 s34, s34, s35
    s_add_u32 s34, s34, 0
    v_lshlrev_b32 v19, 7, v12
    v_lshl_add_u32 v19, v13, 5, v19
    v_lshl_add_u32 v19, v14, 3, v19
    s_nop 3
L_adr_done:
    v_add_u32 v19, s34, v19
    v_mov_b32_dpp v80, v84 quad_perm:[0,1,2,3] row_mask:0xf bank_mask:0x2
    v_mov_b32_dpp v81, v85 quad_perm:[0,1,2,3] row_mask:0xf bank_mask:0x2
    v_mov_b32_dpp v82, v86 quad_perm:[0,1,2,3] row_mask:0xf bank_mask:0x2
    v_mov_b32_dpp v83, v87 quad_perm:[0,1,2,3] row_mask:0xf bank_mask:0x2
    v_mov_b32_dpp v80, v88 quad_perm:[0,1,2,3] row_mask:0xf bank_mask:0x4
    v_mov_b32_dpp v81, v89 quad_perm:[0,1,2,3] row_mask:0xf bank_mask:0x4
    v_mov_b32_dpp v82, v90 quad_perm:[0,1,2,3] row_mask:0xf bank_mask:0x4
    v_mov_b32_dpp v83, v91 quad_perm:[0,1,2,3] row_mask:0xf bank_mask:0x4
    v_mov_b32_dpp v80, v92 quad_perm:[0,1,2,3] row_mask:0xf bank_mask:0x8
    v_mov_b32_dpp v81, v93 quad_perm:[0,1,2,3] row_mask:0xf bank_mask:0x8
    v_mov_b32_dpp v82, v94 quad_perm:[0,1,2,3] row_mask:0xf bank_mask:0x8
    v_mov_b32_dpp v83, v95 quad_perm:[0,1,2,3] row_mask:0xf bank_mask:0x8
    s_cmp_ge_u32 s52, 10
    s_cbranch_scc1 L_noz
    v_add_f32 v80, 0x3e800000, v80
    v_add_f32 v81, 0x3e800000, v81
    v_add_f32 v82, 0x3e800000, v82
    v_add_f32 v83, 0x3e800000, v83
    v_mul_f32 v80, v80, v24
    v_mul_f32 v81, v81, v25
    v_mul_f32 v82, v82, v26
    v_mul_f32 v83, v83, v27
L_noz:
    v_cvt_pk_bf16_f32 v20, v80, v81
    v_cvt_pk_bf16_f32 v21, v82, v83
    v_min_u32 v20, -2, v20
    v_min_u32 v21, -2, v21
    v_and_b32 v22, 15, v0
    v_lshlrev_b32 v22, 2, v22
    s_mov_b32 s35, 0
L_poll3:
    global_load_dword v23, v22, s[30:31] offset:128 sc1
    s_add_u32 s35, s35, 1
    s_waitcnt vmcnt(0)
    v_cmp_eq_u32 vcc, 0, v23
    s_cbranch_vccz L_done4
    s_sleep 8
    s_cmp_lt_u32 s35, 60000
    s_cbranch_scc1 L_poll3
L_done4:
    s_getreg_b32 s97, hwreg(HW_REG_XCC_ID, 0, 4)
    s_sub_u32 s97, s97, s2
    s_and_b32 s97, s97, 7
    s_add_u32 s97, s97, 1
    v_cmp_ne_u32 vcc, s97, v23
    s_nop 0
    s_mov_b32 s97, vcc_lo
    buffer_store_dwordx2 v[20:21], v19, s[44:47], 0 offen sc1
    s_branch L_p2
L_clear:
    s_sub_u32 s55, s2, 240
    s_lshr_b32 s34, s55, 2
    s_lshl_b32 s35, s34, 3
    s_lshr_b32 s54, 538910750, s35
    s_and_b32 s54, s54, 0xff
    s_lshl_b32 s54, s54, 10
    s_mul_i32 s34, s34, 393216
    s_lshl_b32 s35, s51, 15
    s_add_u32 s34, s34, s35
    v_lshl_add_u32 v19, v0, 4, s34
    v_mov_b32 v20, -1
    v_mov_b32 v21, -1
    v_mov_b32 v22, -1
    v_mov_b32 v23, -1
    s_mov_b32 s34, 0
L_clrloop:
    buffer_store_dwordx4 v[20:23], v19, s[44:47], s34 offen offset:0 sc1
    s_add_u32 s34, s34, 1024
    s_cmp_lt_u32 s34, s54
    s_cbranch_scc1 L_clrloop
L_clrend:
    s_cmp_ge_u32 s55, 4
    s_cbranch_scc1 L_clrend2
    s_mov_b32 s34, 1572864
    buffer_store_dwordx4 v[20:23], v19, s[44:47], s34 offen sc1
    s_mov_b32 s34, 1573888
    buffer_store_dwordx4 v[20:23], v19, s[44:47], s34 offen sc1
    s_mov_b32 s34, 1574912
    buffer_store_dwordx4 v[20:23], v19, s[44:47], s34 offen sc1
    s_mov_b32 s34, 1575936
    buffer_store_dwordx4 v[20:23], v19, s[44:47], s34 offen sc1
    s_mov_b32 s34, 1576960
    buffer_store_dwordx4 v[20:23], v19, s[44:47], s34 offen sc1
L_clrend2:
    s_lshr_b32 s35, s55, 2
    s_mul_i32 s35, s35, -385024
    s_add_u32 s34, s35, 1709056
    buffer_store_dwordx4 v[20:23], v19, s[44:47], s34 offen sc1
    s_add_u32 s34, s35, 1710080
    buffer_store_dwordx4 v[20:23], v19, s[44:47], s34 offen sc1
    v_lshlrev_b32 v1, 2, v0
    v_add_u32 v1, 98304, v1
    v_mov_b32 v2, -1
    v_mov_b32 v3, 0
    ds_write_b32 v1, v2
    ds_write_b32 v1, v2 offset:256
    ds_write_b32 v1, v3 offset:512
    ds_write_b32 v1, v3 offset:768
    s_waitcnt lgkmcnt(0)
    s_barrier
    s_lshl_b32 s34, s55, 2
    v_mov_b32 v24, s34
    s_getreg_b32 s97, hwreg(HW_REG_XCC_ID, 0, 4)
    s_sub_u32 s97, s97, s2
    s_and_b32 s97, s97, 7
    s_add_u32 s97, s97, 1
    v_mov_b32 v25, s97
    v_readfirstlane_b32 s90, v19
    s_mov_b32 s91, 0
    s_waitcnt vmcnt(0)
    s_mov_b64 exec, 1
    global_store_dword v24, v25, s[30:31] offset:128 sc1
    s_mov_b64 exec, -1
    s_and_b32 s34, s2, 31
    s_lshl_b32 s34, s34, 8
    s_lshr_b32 s35, s2, 7
    s_lshl_b32 s35, s35, 7
    s_add_u32 s49, s34, s35
    s_bfe_u32 s53, s2, 0x20005
    s_mul_i32 s34, s53, 1310720
    s_add_u32 s34, s34, s49
    v_lshl_add_u32 v16, v10, 13, v11
    v_add_u32 v16, s34, v16
    s_mov_b32 s36, s10
    s_mov_b32 s37, s11
    s_mov_b32 s38, 5242880
    s_mov_b32 m0, 20480
    s_mov_b32 s34, 0
L_dma6:
    buffer_load_dwordx4 v16, s[36:39], s34 offen  lds
    s_add_u32 m0, m0, 1024
    s_add_u32 s34, s34, 65536
    buffer_load_dwordx4 v16, s[36:39], s34 offen  lds
    s_add_u32 m0, m0, 1024
    s_add_u32 s34, s34, 65536
    buffer_load_dwordx4 v16, s[36:39], s34 offen  lds
    s_add_u32 m0, m0, 1024
    s_add_u32 s34, s34, 65536
    buffer_load_dwordx4 v16, s[36:39], s34 offen  lds
    s_add_u32 m0, m0, 1024
    s_add_u32 s34, s34, 65536
    s_cmp_lt_u32 s34, 1310720
    s_cbranch_scc1 L_dma6
    v_lshl_add_u32 v15, v14, 3, v13
    v_lshlrev_b32 v15, 7, v15
    v_lshl_add_u32 v15, v12, 3, v15
    s_add_u32 s34, s90, 0
    s_add_u32 s35, s90, 8192
    s_mov_b64 s[88:89], 0
    s_load_dword s88, s[44:45], s34
    s_load_dword s89, s[44:45], s35
    s_waitcnt lgkmcnt(1)
    s_cmp_lg_u32 s89, 0
    s_addc_u32 s91, s91, 0
    s_waitcnt lgkmcnt(0)
    s_add_u32 s34, s90, 1024
    s_add_u32 s35, s90, 9216
    s_mov_b64 s[88:89], 0
    s_load_dword s89, s[44:45], s35
    s_load_dword s88, s[44:45], s34
    s_waitcnt lgkmcnt(1)
    s_cmp_eq_u32 s88, 0
    s_addc_u32 s91, s91, 0
    s_waitcnt lgkmcnt(0)
    s_add_u32 s34, s90, 2048
    s_add_u32 s35, s90, 10240
    s_mov_b64 s[88:89], 0
    s_load_dword s88, s[44:45], s34
    s_load_dword s89, s[44:45], s35
    s_waitcnt lgkmcnt(1)
    s_cmp_lg_u32 s89, 0
    s_addc_u32 s91, s91, 0
    s_waitcnt lgkmcnt(0)
    s_add_u32 s34, s90, 3072
    s_add_u32 s35, s90, 11264
    s_mov_b64 s[88:89], 0
    s_load_dword s89, s[44:45], s35
    s_load_dword s88, s[44:45], s34
    s_waitcnt lgkmcnt(1)
    s_cmp_eq_u32 s88, 0
    s_addc_u32 s91, s91, 0
    s_waitcnt lgkmcnt(0)
    s_getreg_b32 s34, hwreg(HW_REG_XCC_ID, 2, 1)
    s_sub_u32 s35, 2, s91
    s_sub_u32 s91, s91, 2
    s_cmp_eq_u32 s34, 0
    s_cselect_b32 s91, s91, s35
    v_mov_b32 v25, s91
    s_mov_b64 exec, 1
    global_store_dword v24, v25, s[30:31] sc1
    s_mov_b64 exec, -1
L_novote:
    v_and_b32 v22, 15, v0
    v_lshlrev_b32 v22, 2, v22
    s_mov_b32 s35, 0
L_poll7:
    global_load_dword v23, v22, s[30:31] offset:128 sc1
    s_add_u32 s35, s35, 1
    s_waitcnt vmcnt(0)
    v_cmp_eq_u32 vcc, 0, v23
    s_cbranch_vccz L_done8
    s_sleep 8
    s_cmp_lt_u32 s35, 60000
    s_cbranch_scc1 L_poll7
L_done8:
    s_getreg_b32 s97, hwreg(HW_REG_XCC_ID, 0, 4)
    s_sub_u32 s97, s97, s2
    s_and_b32 s97, s97, 7
    s_add_u32 s97, s97, 1
    v_cmp_ne_u32 vcc, s97, v23
    s_nop 0
    s_mov_b32 s97, vcc_lo
L_p2:
    v_mov_b32 v199, v19
    ds_read_b64_tr_b16 v[96:97], v15 offset:20480
    ds_read_b64_tr_b16 v[98:99], v15 offset:20992
    ds_read_b64_tr_b16 v[100:101], v15 offset:20512
    ds_read_b64_tr_b16 v[102:103], v15 offset:21024
    ds_read_b64_tr_b16 v[104:105], v15 offset:20544
    ds_read_b64_tr_b16 v[106:107], v15 offset:21056
    ds_read_b64_tr_b16 v[108:109], v15 offset:20576
    ds_read_b64_tr_b16 v[110:111], v15 offset:21088
    s_waitcnt lgkmcnt(7)
    ds_read_b64_tr_b16 v[112:113], v15 offset:24576
    ds_read_b64_tr_b16 v[114:115], v15 offset:25088
    ds_read_b64_tr_b16 v[116:117], v15 offset:24608
    ds_read_b64_tr_b16 v[118:119], v15 offset:25120
    ds_read_b64_tr_b16 v[120:121], v15 offset:24640
    ds_read_b64_tr_b16 v[122:123], v15 offset:25152
    ds_read_b64_tr_b16 v[124:125], v15 offset:24672
    ds_read_b64_tr_b16 v[126:127], v15 offset:25184
    s_waitcnt lgkmcnt(7)
    ds_read_b64_tr_b16 v[128:129], v15 offset:28672
    ds_read_b64_tr_b16 v[130:131], v15 offset:29184
    ds_read_b64_tr_b16 v[132:133], v15 offset:28704
    ds_read_b64_tr_b16 v[134:135], v15 offset:29216
    ds_read_b64_tr_b16 v[136:137], v15 offset:28736
    ds_read_b64_tr_b16 v[138:139], v15 offset:29248
    ds_read_b64_tr_b16 v[140:141], v15 offset:28768
    ds_read_b64_tr_b16 v[142:143], v15 offset:29280
    s_waitcnt lgkmcnt(7)
    ds_read_b64_tr_b16 v[144:145], v15 offset:32768
    ds_read_b64_tr_b16 v[146:147], v15 offset:33280
    ds_read_b64_tr_b16 v[148:149], v15 offset:32800
    ds_read_b64_tr_b16 v[150:151], v15 offset:33312
    ds_read_b64_tr_b16 v[152:153], v15 offset:32832
    ds_read_b64_tr_b16 v[154:155], v15 offset:33344
    ds_read_b64_tr_b16 v[156:157], v15 offset:32864
    ds_read_b64_tr_b16 v[158:159], v15 offset:33376
    s_waitcnt lgkmcnt(7)
    ds_read_b64_tr_b16 v[160:161], v15 offset:36864
    ds_read_b64_tr_b16 v[162:163], v15 offset:37376
    ds_read_b64_tr_b16 v[164:165], v15 offset:36896
    ds_read_b64_tr_b16 v[166:167], v15 offset:37408
    ds_read_b64_tr_b16 v[168:169], v15 offset:36928
    ds_read_b64_tr_b16 v[170:171], v15 offset:37440
    ds_read_b64_tr_b16 v[172:173], v15 offset:36960
    ds_read_b64_tr_b16 v[174:175], v15 offset:37472
    s_waitcnt lgkmcnt(0)
    s_mul_i32 s34, s53, 1280
    v_lshlrev_b32 v19, 15, v13
    v_lshl_add_u32 v19, v14, 6, v19
    v_lshl_add_u32 v19, v12, 4, v19
    v_add_u32 v19, s34, v19
    s_movk_i32 s48, 5120
    s_mov_b32 s56, 32768
    s_mov_b32 s57, 65536
    s_mov_b32 s58, 98304
    s_sub_u32 s34, s2, 80
    s_cmp_lt_u32 s34, 160
    s_cselect_b32 s54, 1, 0
    s_and_b32 s34, s2, 3
    s_cselect_b32 s54, 0, s54
    v_mov_b32 v180, 0
    v_mov_b32 v181, 0
    v_mov_b32 v182, 0
    v_mov_b32 v183, 0
    v_mov_b32 v184, 0
    v_mov_b32 v185, 0
    v_mov_b32 v186, 0
    v_mov_b32 v187, 0
    v_mov_b32 v22, 99072
    s_mov_b32 s35, 0
L_poll10:
    ds_read_b32 v23, v22
    s_add_u32 s35, s35, 1
    s_waitcnt lgkmcnt(0)
    v_cmp_gt_u32 vcc, 21, v23
    s_cbranch_vccz L_done11
    s_sleep 2
    s_cmp_lt_u32 s35, 60000
    s_cbranch_scc1 L_poll10
L_done11:
    s_mov_b32 s35, 0
L_poll13:
    buffer_load_dwordx4 v[32:35], v19, s[44:47], 0 offen offset:0 sc1
    buffer_load_dwordx4 v[36:39], v19, s[44:47], s48 offen offset:0 sc1
    buffer_load_dwordx4 v[40:43], v19, s[44:47], 0 offen offset:256 sc1
    buffer_load_dwordx4 v[44:47], v19, s[44:47], s48 offen offset:256 sc1
    buffer_load_dwordx4 v[48:51], v19, s[44:47], 0 offen offset:512 sc1
    buffer_load_dwordx4 v[52:55], v19, s[44:47], s48 offen offset:512 sc1
    buffer_load_dwordx4 v[56:59], v19, s[44:47], 0 offen offset:768 sc1
    buffer_load_dwordx4 v[60:63], v19, s[44:47], s48 offen offset:768 sc1
    buffer_load_dwordx4 v[64:67], v19, s[44:47], 0 offen offset:1024 sc1
    buffer_load_dwordx4 v[68:71], v19, s[44:47], s48 offen offset:1024 sc1
    s_cmp_eq_u32 s54, 0
    s_cbranch_scc1 L_hskip
    buffer_load_dwordx2 v[180:181], v199, s[44:47], 0 offen sc1
    buffer_load_dwordx2 v[182:183], v199, s[44:47], s56 offen sc1
    buffer_load_dwordx2 v[184:185], v199, s[44:47], s57 offen sc1
    buffer_load_dwordx2 v[186:187], v199, s[44:47], s58 offen sc1
L_hskip:
    s_add_u32 s35, s35, 1
    s_waitcnt vmcnt(0)
    v_max3_u32 v20, v32, v33, v34
    v_max3_u32 v20, v20, v35, v36
    v_max3_u32 v20, v20, v37, v38
    v_max3_u32 v20, v20, v39, v40
    v_max3_u32 v20, v20, v41, v42
    v_max3_u32 v20, v20, v43, v44
    v_max3_u32 v20, v20, v45, v46
    v_max3_u32 v20, v20, v47, v48
    v_max3_u32 v20, v20, v49, v50
    v_max3_u32 v20, v20, v51, v52
    v_max3_u32 v20, v20, v53, v54
    v_max3_u32 v20, v20, v55, v56
    v_max3_u32 v20, v20, v57, v58
    v_max3_u32 v20, v20, v59, v60
    v_max3_u32 v20, v20, v61, v62
    v_max3_u32 v20, v20, v63, v64
    v_max3_u32 v20, v20, v65, v66
    v_max3_u32 v20, v20, v67, v68
    v_max3_u32 v20, v20, v69, v70
    v_max3_u32 v20, v20, v71, v180
    v_max3_u32 v20, v20, v181, v182
    v_max3_u32 v20, v20, v183, v184
    v_max3_u32 v20, v20, v185, v186
    v_max_u32 v20, v20, v187
    v_cmp_eq_u32 vcc, -1, v20
    s_cbranch_vccz L_done14
    s_sleep 16
    s_cmp_lt_u32 s35, 60000
    s_cbranch_scc1 L_poll13
L_done14:
    v_mfma_f32_16x16x32_bf16 v[80:83], v[96:99], v[32:35], 0
    v_mfma_f32_16x16x32_bf16 v[84:87], v[100:103], v[32:35], 0
    v_mfma_f32_16x16x32_bf16 v[88:91], v[104:107], v[32:35], 0
    v_mfma_f32_16x16x32_bf16 v[92:95], v[108:111], v[32:35], 0
    v_mfma_f32_16x16x32_bf16 v[80:83], v[96:99], v[36:39], v[80:83]
    v_mfma_f32_16x16x32_bf16 v[84:87], v[100:103], v[36:39], v[84:87]
    v_mfma_f32_16x16x32_bf16 v[88:91], v[104:107], v[36:39], v[88:91]
    v_mfma_f32_16x16x32_bf16 v[92:95], v[108:111], v[36:39], v[92:95]
    v_mfma_f32_16x16x32_bf16 v[80:83], v[112:115], v[40:43], v[80:83]
    v_mfma_f32_16x16x32_bf16 v[84:87], v[116:119], v[40:43], v[84:87]
    v_mfma_f32_16x16x32_bf16 v[88:91], v[120:123], v[40:43], v[88:91]
    v_mfma_f32_16x16x32_bf16 v[92:95], v[124:127], v[40:43], v[92:95]
    v_mfma_f32_16x16x32_bf16 v[80:83], v[112:115], v[44:47], v[80:83]
    v_mfma_f32_16x16x32_bf16 v[84:87], v[116:119], v[44:47], v[84:87]
    v_mfma_f32_16x16x32_bf16 v[88:91], v[120:123], v[44:47], v[88:91]
    v_mfma_f32_16x16x32_bf16 v[92:95], v[124:127], v[44:47], v[92:95]
    v_mfma_f32_16x16x32_bf16 v[80:83], v[128:131], v[48:51], v[80:83]
    v_mfma_f32_16x16x32_bf16 v[84:87], v[132:135], v[48:51], v[84:87]
    v_mfma_f32_16x16x32_bf16 v[88:91], v[136:139], v[48:51], v[88:91]
    v_mfma_f32_16x16x32_bf16 v[92:95], v[140:143], v[48:51], v[92:95]
    v_mfma_f32_16x16x32_bf16 v[80:83], v[128:131], v[52:55], v[80:83]
    v_mfma_f32_16x16x32_bf16 v[84:87], v[132:135], v[52:55], v[84:87]
    v_mfma_f32_16x16x32_bf16 v[88:91], v[136:139], v[52:55], v[88:91]
    v_mfma_f32_16x16x32_bf16 v[92:95], v[140:143], v[52:55], v[92:95]
    v_mfma_f32_16x16x32_bf16 v[80:83], v[144:147], v[56:59], v[80:83]
    v_mfma_f32_16x16x32_bf16 v[84:87], v[148:151], v[56:59], v[84:87]
    v_mfma_f32_16x16x32_bf16 v[88:91], v[152:155], v[56:59], v[88:91]
    v_mfma_f32_16x16x32_bf16 v[92:95], v[156:159], v[56:59], v[92:95]
    v_mfma_f32_16x16x32_bf16 v[80:83], v[144:147], v[60:63], v[80:83]
    v_mfma_f32_16x16x32_bf16 v[84:87], v[148:151], v[60:63], v[84:87]
    v_mfma_f32_16x16x32_bf16 v[88:91], v[152:155], v[60:63], v[88:91]
    v_mfma_f32_16x16x32_bf16 v[92:95], v[156:159], v[60:63], v[92:95]
    v_mfma_f32_16x16x32_bf16 v[80:83], v[160:163], v[64:67], v[80:83]
    v_mfma_f32_16x16x32_bf16 v[84:87], v[164:167], v[64:67], v[84:87]
    v_mfma_f32_16x16x32_bf16 v[88:91], v[168:171], v[64:67], v[88:91]
    v_mfma_f32_16x16x32_bf16 v[92:95], v[172:175], v[64:67], v[92:95]
    v_mfma_f32_16x16x32_bf16 v[80:83], v[160:163], v[68:71], v[80:83]
    v_mfma_f32_16x16x32_bf16 v[84:87], v[164:167], v[68:71], v[84:87]
    v_mfma_f32_16x16x32_bf16 v[88:91], v[168:171], v[68:71], v[88:91]
    v_mfma_f32_16x16x32_bf16 v[92:95], v[172:175], v[68:71], v[92:95]
    s_lshl_b32 s34, s53, 15
    s_lshl_b32 s35, s49, 2
    s_add_u32 s34, s34, s35
    s_add_u32 s34, s34, 393216
    v_lshlrev_b32 v19, 7, v12
    v_lshl_add_u32 v19, v13, 5, v19
    v_lshl_add_u32 v19, v14, 3, v19
    v_add_u32 v19, s34, v19
    v_add_f32_dpp v20, v80, v80 row_ror:8 row_mask:0xf bank_mask:0x3
    v_add_f32_dpp v24, v84, v84 row_ror:8 row_mask:0xf bank_mask:0x3
    v_add_f32_dpp v21, v81, v81 row_ror:8 row_mask:0xf bank_mask:0x3
    v_add_f32_dpp v25, v85, v85 row_ror:8 row_mask:0xf bank_mask:0x3
    v_add_f32_dpp v22, v82, v82 row_ror:8 row_mask:0xf bank_mask:0x3
    v_add_f32_dpp v26, v86, v86 row_ror:8 row_mask:0xf bank_mask:0x3
    v_add_f32_dpp v23, v83, v83 row_ror:8 row_mask:0xf bank_mask:0x3
    v_add_f32_dpp v27, v87, v87 row_ror:8 row_mask:0xf bank_mask:0x3
    v_add_f32_dpp v20, v88, v88 row_ror:8 row_mask:0xf bank_mask:0xc
    v_add_f32_dpp v24, v92, v92 row_ror:8 row_mask:0xf bank_mask:0xc
    v_add_f32_dpp v21, v89, v89 row_ror:8 row_mask:0xf bank_mask:0xc
    v_add_f32_dpp v25, v93, v93 row_ror:8 row_mask:0xf bank_mask:0xc
    v_add_f32_dpp v22, v90, v90 row_ror:8 row_mask:0xf bank_mask:0xc
    v_add_f32_dpp v26, v94, v94 row_ror:8 row_mask:0xf bank_mask:0xc
    v_add_f32_dpp v23, v91, v91 row_ror:8 row_mask:0xf bank_mask:0xc
    v_add_f32_dpp v27, v95, v95 row_ror:8 row_mask:0xf bank_mask:0xc
    v_add_f32_dpp v28, v20, v20 row_shl:4 row_mask:0xf bank_mask:0x5
    v_add_f32_dpp v29, v21, v21 row_shl:4 row_mask:0xf bank_mask:0x5
    v_add_f32_dpp v30, v22, v22 row_shl:4 row_mask:0xf bank_mask:0x5
    v_add_f32_dpp v31, v23, v23 row_shl:4 row_mask:0xf bank_mask:0x5
    v_add_f32_dpp v28, v24, v24 row_shr:4 row_mask:0xf bank_mask:0xa
    v_add_f32_dpp v29, v25, v25 row_shr:4 row_mask:0xf bank_mask:0xa
    v_add_f32_dpp v30, v26, v26 row_shr:4 row_mask:0xf bank_mask:0xa
    v_add_f32_dpp v31, v27, v27 row_shr:4 row_mask:0xf bank_mask:0xa
    v_cvt_pk_bf16_f32 v20, v28, v29
    v_cvt_pk_bf16_f32 v21, v30, v31
    v_min_u32 v20, -2, v20
    v_min_u32 v21, -2, v21
    buffer_store_dwordx2 v[20:21], v19, s[44:47], 0 offen sc1
    s_cmp_eq_u32 s54, 0
    s_cbranch_scc1 L_nomf
    v_lshlrev_b32 v24, 16, v180
    v_and_b32 v25, 0xffff0000, v180
    v_lshlrev_b32 v26, 16, v181
    v_and_b32 v27, 0xffff0000, v181
    v_lshlrev_b32 v28, 16, v182
    v_and_b32 v29, 0xffff0000, v182
    v_lshlrev_b32 v30, 16, v183
    v_and_b32 v31, 0xffff0000, v183
    v_add_f32 v24, v24, v28
    v_add_f32 v25, v25, v29
    v_add_f32 v26, v26, v30
    v_add_f32 v27, v27, v31
    v_lshlrev_b32 v28, 16, v184
    v_and_b32 v29, 0xffff0000, v184
    v_lshlrev_b32 v30, 16, v185
    v_and_b32 v31, 0xffff0000, v185
    v_add_f32 v24, v24, v28
    v_add_f32 v25, v25, v29
    v_add_f32 v26, v26, v30
    v_add_f32 v27, v27, v31
    v_lshlrev_b32 v28, 16, v186
    v_and_b32 v29, 0xffff0000, v186
    v_lshlrev_b32 v30, 16, v187
    v_and_b32 v31, 0xffff0000, v187
    v_add_f32 v24, v24, v28
    v_add_f32 v25, v25, v29
    v_add_f32 v26, v26, v30
    v_add_f32 v27, v27, v31
    v_cvt_pk_bf16_f32 v22, v24, v25
    v_cvt_pk_bf16_f32 v23, v26, v27
    v_min_u32 v22, -2, v22
    v_min_u32 v23, -2, v23
    s_sub_u32 s34, s50, 20
    s_lshl_b32 s35, s34, 9
    v_subrev_u32 v199, s35, v199
    s_lshr_b32 s35, s34, 2
    s_lshl_b32 s35, s35, 9
    s_and_b32 s34, s34, 3
    s_lshl_b32 s34, s34, 15
    s_add_u32 s34, s34, s35
    s_add_u32 s34, s34, 1562624
    v_add_u32 v199, s34, v199
    buffer_store_dwordx2 v[22:23], v199, s[44:47], 0 offen sc1
L_nomf:
    s_and_b32 s34, s2, 127
    s_lshl_b32 s34, s34, 21
    s_lshr_b32 s35, s2, 7
    s_lshl_b32 s35, s35, 18
    s_add_u32 s34, s34, s35
    s_add_u32 s34, s34, 1572864
    s_mov_b32 s38, 0x40000
    s_mov_b32 s42, 0x40000
    s_waitcnt lgkmcnt(0)
    s_add_u32 s36, s6, s34
    s_addc_u32 s37, s7, 0
    s_add_u32 s40, s8, s34
    s_addc_u32 s41, s9, 0
    v_lshlrev_b32 v18, 4, v0
    s_mov_b32 s34, 258048
    buffer_load_dwordx4 v[128:131], v18, s[36:39], s34 offen offset:0 nt
    buffer_load_dwordx4 v[132:135], v18, s[36:39], s34 offen offset:1024 nt
    buffer_load_dwordx4 v[136:139], v18, s[36:39], s34 offen offset:2048 nt
    buffer_load_dwordx4 v[140:143], v18, s[36:39], s34 offen offset:3072 nt
    s_and_b32 s34, s2, 31
    s_lshl_b32 s34, s34, 10
    s_lshl_b32 s35, s53, 7
    s_add_u32 s34, s34, s35
    s_add_u32 s34, s34, 393216
    v_lshrrev_b32 v19, 5, v0
    v_mul_u32_u24 v19, 384, v19
    v_lshl_add_u32 v19, v0, 2, v19
    v_add_u32 v19, s34, v19
    v_mov_b32 v22, 99072
    s_and_b32 s34, s60, 3
    s_lshl_b32 s34, s34, 15
    s_lshr_b32 s35, s60, 2
    s_lshl_b32 s35, s35, 7
    s_add_u32 s34, s34, s35
    s_add_u32 s34, s34, 793344
    v_and_b32 v252, 31, v0
    v_lshl_add_u32 v252, v252, 2, s34
    v_mov_b32 v253, 0
    s_mov_b32 s35, 0
L_poll16:
    ds_read_b32 v23, v22
    s_add_u32 s35, s35, 1
    s_waitcnt lgkmcnt(0)
    v_cmp_gt_u32 vcc, 33, v23
    s_cbranch_vccz L_done17
    s_sleep 2
    s_cmp_lt_u32 s35, 60000
    s_cbranch_scc1 L_poll16
L_done17:
    buffer_load_dword v251, v252, s[44:47], 0 offen sc1
    s_lshl_b64 exec, 1, s61
    buffer_store_dword v253, v252, s[44:47], 0 offen
    s_mov_b64 exec, -1
    v_and_b32 v44, 15, v0
    v_lshlrev_b32 v44, 2, v44
    global_load_dword v44, v44, s[30:31] sc1
    s_mov_b32 s35, 0
L_poll19:
    buffer_load_dword v32, v19, s[44:47], 0 offen sc1
    buffer_load_dword v33, v19, s[44:47], s56 offen sc1
    buffer_load_dword v34, v19, s[44:47], s57 offen sc1
    buffer_load_dword v35, v19, s[44:47], s58 offen sc1
    s_add_u32 s35, s35, 1
    s_waitcnt vmcnt(0)
    v_max3_u32 v22, v32, v33, v34
    v_max_u32 v22, v22, v35
    v_cmp_eq_u32 vcc, -1, v22
    s_cbranch_vccz L_done20
    s_sleep 16
    s_cmp_lt_u32 s35, 60000
    s_cbranch_scc1 L_poll19
L_done20:
    v_cmp_ne_u32 vcc, -1, v251
    v_mov_b32 v252, 99076
    s_bcnt1_i32_b32 s34, vcc_lo
    v_mov_b32 v251, s34
    s_mov_b64 exec, 1
    ds_write_b32 v252, v251
    s_mov_b64 exec, -1
    v_add_u32_dpp v44, v44, v44 row_ror:8 row_mask:0xf bank_mask:0xf
    s_nop 1
    v_add_u32_dpp v44, v44, v44 row_ror:4 row_mask:0xf bank_mask:0xf
    s_nop 1
    v_add_u32_dpp v44, v44, v44 row_ror:2 row_mask:0xf bank_mask:0xf
    s_nop 1
    v_add_u32_dpp v44, v44, v44 row_ror:1 row_mask:0xf bank_mask:0xf
    s_nop 0
    v_readfirstlane_b32 s99, v44
    s_nop 0
    s_cmp_gt_i32 s99, 0
    s_cselect_b32 s99, 1, 0
    s_getreg_b32 s34, hwreg(HW_REG_XCC_ID, 2, 1)
    s_xor_b32 s99, s99, s34
    s_lshl_b32 s99, s99, 13
    v_mov_b32 v45, 99080
    v_mov_b32 v44, s99
    ds_write_b32 v45, v44
    v_lshlrev_b32 v36, 16, v32
    v_and_b32 v37, 0xffff0000, v32
    v_lshlrev_b32 v38, 16, v33
    v_and_b32 v39, 0xffff0000, v33
    v_lshlrev_b32 v40, 16, v34
    v_and_b32 v41, 0xffff0000, v34
    v_lshlrev_b32 v42, 16, v35
    v_and_b32 v43, 0xffff0000, v35
    v_pk_add_f32 v[36:37], v[36:37], v[38:39]
    v_pk_add_f32 v[40:41], v[40:41], v[42:43]
    v_pk_add_f32 v[36:37], v[36:37], v[40:41]
    v_cvt_pk_bf16_f32 v32, v36, v37
    v_min_u32 v32, -2, v32
    ds_write_b32 v1, v32
    s_mov_b32 s34, 258048
    buffer_load_dwordx4 v[144:147], v18, s[40:43], s34 offen offset:0 nt
    buffer_load_dwordx4 v[148:151], v18, s[40:43], s34 offen offset:1024 nt
    buffer_load_dwordx4 v[152:155], v18, s[40:43], s34 offen offset:2048 nt
    buffer_load_dwordx4 v[156:159], v18, s[40:43], s34 offen offset:3072 nt
    v_and_b32 v2, 15, v0
    v_lshlrev_b32 v2, 4, v2
    v_add_u32 v2, 98304, v2
    ds_read_b128 v[4:7], v2
    s_waitcnt lgkmcnt(0)
    v_dot2_f32_bf16 v8, v128, v4, 0
    v_dot2_f32_bf16 v9, v132, v4, 0
    v_dot2_f32_bf16 v10, v136, v4, 0
    v_dot2_f32_bf16 v11, v140, v4, 0
    v_dot2c_f32_bf16 v8, v129, v5
    v_dot2c_f32_bf16 v9, v133, v5
    v_dot2c_f32_bf16 v10, v137, v5
    v_dot2c_f32_bf16 v11, v141, v5
    v_dot2c_f32_bf16 v8, v130, v6
    v_dot2c_f32_bf16 v9, v134, v6
    v_dot2c_f32_bf16 v10, v138, v6
    v_dot2c_f32_bf16 v11, v142, v6
    v_dot2c_f32_bf16 v8, v131, v7
    v_dot2c_f32_bf16 v9, v135, v7
    v_dot2c_f32_bf16 v10, v139, v7
    v_dot2c_f32_bf16 v11, v143, v7
    v_add_f32_dpp v16, v8, v8 row_ror:8 row_mask:0xf bank_mask:0x3
    v_add_f32_dpp v16, v9, v9 row_ror:8 row_mask:0xf bank_mask:0xc
    v_add_f32_dpp v17, v10, v10 row_ror:8 row_mask:0xf bank_mask:0x3
    v_add_f32_dpp v17, v11, v11 row_ror:8 row_mask:0xf bank_mask:0xc
    v_add_f32_dpp v16, v16, v16 row_half_mirror row_mask:0xf bank_mask:0xf
    s_nop 0
    v_add_f32_dpp v17, v17, v17 row_half_mirror row_mask:0xf bank_mask:0xf
    v_add_f32_dpp v16, v16, v16 quad_perm:[1,0,3,2] row_mask:0xf bank_mask:0xf
    s_nop 0
    v_add_f32_dpp v17, v17, v17 quad_perm:[1,0,3,2] row_mask:0xf bank_mask:0xf
    v_add_f32_dpp v16, v16, v16 quad_perm:[2,3,0,1] row_mask:0xf bank_mask:0xf
    s_nop 0
    v_add_f32_dpp v17, v17, v17 quad_perm:[2,3,0,1] row_mask:0xf bank_mask:0xf
    v_max_f32 v8, v16, v17
    s_mov_b32 s34, 0x3e0293ee
    s_nop 0
    v_max_f32_dpp v8, v8, v8 row_ror:8 row_mask:0xf bank_mask:0xf
    v_mov_b32 v9, v8
    s_nop 1
    v_permlane16_swap_b32 v8, v9
    v_max_f32 v8, v8, v9
    v_mov_b32 v9, v8
    s_nop 1
    v_permlane32_swap_b32 v8, v9
    v_max_f32 v8, v8, v9
    v_mul_f32 v8, s34, v8
    v_fma_f32 v16, v16, s34, -v8
    v_fma_f32 v17, v17, s34, -v8
    v_exp_f32 v16, v16
    v_exp_f32 v17, v17
    s_nop 0
    v_add_f32 v9, v16, v17
    v_and_b32 v10, 1, v0
    v_lshlrev_b32 v10, 4, v10
    v_mov_b32 v11, 0xffff
    v_lshlrev_b32 v10, v10, v11
    v_bfe_u32 v11, v0, 1, 2
    v_cmp_eq_u32 vcc, 0, v11
    s_nop 1
    v_cndmask_b32 v20, 0, v10, vcc
    v_cmp_eq_u32 vcc, 1, v11
    s_nop 1
    v_cndmask_b32 v21, 0, v10, vcc
    v_cmp_eq_u32 vcc, 2, v11
    s_nop 1
    v_cndmask_b32 v22, 0, v10, vcc
    v_cmp_eq_u32 vcc, 3, v11
    s_nop 1
    v_cndmask_b32 v23, 0, v10, vcc
    v_add_f32_dpp v9, v9, v9 row_ror:8 row_mask:0xf bank_mask:0xf
    v_mov_b32 v10, v9
    s_nop 1
    v_permlane16_swap_b32 v9, v10
    v_add_f32 v9, v9, v10
    v_mov_b32 v10, v9
    s_nop 1
    v_permlane32_swap_b32 v9, v10
    v_add_f32 v9, v9, v10
    v_mov_b32 v10, 98616
    s_mov_b64 exec, 1
    ds_write_b64 v10, v[8:9]
    s_mov_b64 exec, -1
    s_waitcnt vmcnt(0)
    v_cvt_pk_bf16_f32 v10, v16, v16
    v_and_b32 v24, v10, v20
    v_and_b32 v25, v10, v21
    v_and_b32 v26, v10, v22
    v_and_b32 v27, v10, v23
    s_nop 1
    v_mfma_f32_16x16x32_bf16 v[116:119], v[144:147], v[24:27], 0
    v_mfma_f32_16x16x32_bf16 v[120:123], v[148:151], v[24:27], 0
    v_cvt_pk_bf16_f32 v10, v17, v17
    v_and_b32 v28, v10, v20
    v_and_b32 v29, v10, v21
    v_and_b32 v30, v10, v22
    v_and_b32 v31, v10, v23
    s_nop 1
    v_mfma_f32_16x16x32_bf16 v[116:119], v[152:155], v[28:31], v[116:119]
    v_mfma_f32_16x16x32_bf16 v[120:123], v[156:159], v[28:31], v[120:123]
    s_mov_b32 s34, 106496
    v_lshrrev_b32 v16, 4, v0
    v_and_b32 v17, 7, v0
    v_lshl_add_u32 v16, v16, 3, v17
    v_bfe_u32 v17, v0, 3, 1
    v_lshl_add_u32 v16, v17, 5, v16
    v_lshl_add_u32 v16, v16, 4, s34
    s_nop 0
    v_add_f32_dpp v116, v120, v116 row_ror:8 row_mask:0xf bank_mask:0xf
    v_add_f32_dpp v117, v121, v117 row_ror:8 row_mask:0xf bank_mask:0xf
    v_add_f32_dpp v118, v122, v118 row_ror:8 row_mask:0xf bank_mask:0xf
    v_add_f32_dpp v119, v123, v119 row_ror:8 row_mask:0xf bank_mask:0xf
    ds_write_b128 v16, v[116:119]
    v_lshl_add_u32 v16, v0, 3, s34
    ds_read_b64 v[116:117], v16
    s_waitcnt lgkmcnt(0)
    s_mov_b32 s63, 0
    s_mov_b32 s62, s61
    s_cmp_lt_u32 s61, 20
    s_cbranch_scc1 L_rd22
    s_mul_i32 s62, s60, 12
    s_add_u32 s62, s62, s61
    s_sub_u32 s62, s62, 20
    s_mov_b32 s63, 1
    s_cmp_lt_u32 s62, 54
    s_cbranch_scc1 L_rd22
    s_cmp_lt_u32 s62, 56
    s_cselect_b32 s63, 3, 2
    s_sub_u32 s62, s62, 56
L_rd22:
    v_and_b32 v8, 3, v0
    v_bfe_u32 v9, v0, 2, 2
    v_lshrrev_b32 v10, 4, v0
    s_mov_b32 s55, 0x20000
    s_lshl_b32 s35, s62, 6
    s_and_b32 s49, s62, 1
    s_cmp_eq_u32 s63, 0
    s_cbranch_scc1 L_dp24
    s_cmp_eq_u32 s63, 1
    s_cbranch_scc1 L_dp25
    s_mov_b32 s52, s20
    s_mov_b32 s53, s21
    s_mov_b32 s54, 2211840
    v_mov_b32 v15, 0
    s_branch L_dp26
L_dp25:
    s_mov_b32 s52, s16
    s_mov_b32 s53, s17
    s_mov_b32 s54, 2211840
    v_lshl_add_u32 v15, v9, 3, v10
    v_mul_u32_u24 v15, 3456, v15
    v_lshl_add_u32 v15, v8, 4, v15
    v_add_u32 v15, s35, v15
    s_bfe_u32 s50, s3, 0x10001
    s_lshl_b32 s50, s50, 7
    s_and_b32 s34, s3, 1
    s_lshl_b32 s34, s34, 2
    s_add_u32 s50, s50, s34
    s_and_b32 s51, s3, 3
    s_lshl_b32 s51, s51, 5
    s_add_u32 s51, s51, 512
    s_mul_i32 s50, s50, 3456
    s_mul_i32 s51, s51, 3456
    s_branch L_dp26
L_dp24:
    s_mov_b32 s52, s12
    s_mov_b32 s53, s13
    s_mov_b32 s54, 5242880
    s_lshr_b32 s50, s3, 1
    s_lshl_b32 s50, s50, 3
    s_add_u32 s50, s50, s60
    s_and_b32 s51, s3, 1
    s_lshl_b32 s34, s50, 1
    s_add_u32 s34, s34, s51
    s_mul_i32 s34, s34, 81920
    s_add_u32 s34, s34, s35
    v_lshl_add_u32 v15, v9, 2, v10
    v_mul_u32_u24 v15, 2560, v15
    v_lshl_add_u32 v15, v8, 4, v15
    v_add_u32 v15, s34, v15
    s_lshl_b32 s56, s3, 12
    s_lshl_b32 s34, s49, 11
    s_add_u32 s56, s56, s34
    s_add_u32 s56, s56, 40960
    s_add_u32 s58, s56, 1024
    s_mul_i32 s57, s49, 40960
    s_add_u32 s59, s57, 1280
L_dp26:
    v_and_b32 v200, 3, v0
    v_bfe_u32 v201, v0, 2, 2
    v_lshrrev_b32 v202, 4, v0
    s_lshl_b32 s34, s3, 10
    s_add_u32 s34, s34, 122112
    v_mul_u32_u24 v203, 320, v201
    v_min_u32 v203, 704, v203
    v_lshl_add_u32 v203, v202, 6, v203
    v_lshl_add_u32 v203, v200, 4, v203
    v_add_u32 v203, s34, v203
    s_movk_i32 s48, 16384
    v_mov_b32 v197, 0
    s_mov_b32 s40, 0
    s_mov_b32 s41, 0
    s_mov_b32 s42, 0
    s_cmp_eq_u32 s63, 0
    s_cbranch_scc1 L_d_wo
    s_cmp_eq_u32 s63, 2
    s_cbranch_scc1 L_d_w2
    s_cmp_eq_u32 s63, 3
    s_cbranch_scc1 L_d_none
    v_and_b32 v205, 15, v0
    v_lshlrev_b32 v205, 4, v205
    s_and_b32 s49, s3, 3
    s_mul_i32 s34, s49, 1280
    s_add_u32 s34, s34, s99
    s_add_u32 s34, s34, 786432
    v_lshl_add_u32 v206, v202, 15, v205
    v_add_u32 v206, s34, v206
    s_mul_i32 s34, s49, 3840
    v_add_u32 v205, s34, v205
    s_lshl_b32 s34, s62, 6
    v_lshlrev_b32 v5, 4, v14
    v_lshl_add_u32 v5, v12, 2, v5
    v_add_u32 v5, s34, v5
    global_load_dword v6, v5, s[18:19]
    v_and_b32 v7, 15, v0
    v_lshlrev_b32 v7, 4, v7
    v_mul_u32_u24 v8, 1280, v14
    v_add_u32 v8, v8, v7
    v_bfe_u32 v9, v0, 3, 1
    v_lshlrev_b32 v9, 15, v9
    v_lshl_add_u32 v9, v14, 7, v9
    v_and_b32 v10, 7, v0
    v_lshl_add_u32 v9, v10, 4, v9
    v_add_u32 v9, 1572864, v9
    s_mov_b32 s57, 65536
    v_mul_u32_u24 v5, 3840, v14
    v_add_u32 v5, v5, v7
    global_load_dwordx4 v[32:35], v8, s[4:5] offset:0
    global_load_dwordx4 v[36:39], v8, s[4:5] offset:256
    global_load_dwordx4 v[40:43], v8, s[4:5] offset:512
    global_load_dwordx4 v[44:47], v8, s[4:5] offset:768
    global_load_dwordx4 v[48:51], v8, s[4:5] offset:1024
    s_mov_b32 s35, 0
L_poll27:
    buffer_load_dwordx4 v[52:55], v9, s[44:47], s57 offen offset:1024 sc1
    buffer_load_dwordx4 v[56:59], v9, s[44:47], 0 offen offset:1536 sc1
    buffer_load_dwordx4 v[60:63], v9, s[44:47], s57 offen offset:1536 sc1
    buffer_load_dwordx4 v[64:67], v9, s[44:47], 0 offen offset:2048 sc1
    buffer_load_dwordx4 v[68:71], v9, s[44:47], s57 offen offset:2048 sc1
    buffer_load_dwordx4 v[72:75], v9, s[44:47], 0 offen offset:2560 sc1
    buffer_load_dwordx4 v[76:79], v9, s[44:47], s57 offen offset:2560 sc1
    buffer_load_dwordx4 v[80:83], v9, s[44:47], 0 offen offset:3072 sc1
    buffer_load_dwordx4 v[84:87], v9, s[44:47], s57 offen offset:3072 sc1
    buffer_load_dwordx4 v[88:91], v9, s[44:47], 0 offen offset:3584 sc1
    s_add_u32 s35, s35, 1
    s_waitcnt vmcnt(0)
    v_max3_u32 v28, v52, v53, v54
    v_max3_u32 v28, v28, v55, v56
    v_max3_u32 v28, v28, v57, v58
    v_max3_u32 v28, v28, v59, v60
    v_max3_u32 v28, v28, v61, v62
    v_max3_u32 v28, v28, v63, v64
    v_max3_u32 v28, v28, v65, v66
    v_max3_u32 v28, v28, v67, v68
    v_max3_u32 v28, v28, v69, v70
    v_max3_u32 v28, v28, v71, v72
    v_max3_u32 v28, v28, v73, v74
    v_max3_u32 v28, v28, v75, v76
    v_max3_u32 v28, v28, v77, v78
    v_max3_u32 v28, v28, v79, v80
    v_max3_u32 v28, v28, v81, v82
    v_max3_u32 v28, v28, v83, v84
    v_max3_u32 v28, v28, v85, v86
    v_max3_u32 v28, v28, v87, v88
    v_max3_u32 v28, v28, v89, v90
    v_max_u32 v28, v28, v91
    v_cmp_eq_u32 vcc, -1, v28
    s_cbranch_vccz L_done28
    s_sleep 16
    s_cmp_lt_u32 s35, 60000
    s_cbranch_scc1 L_poll27
L_done28:
    ds_write_b128 v5, v[32:35] offset:0
    ds_write_b128 v5, v[36:39] offset:256
    ds_write_b128 v5, v[40:43] offset:512
    ds_write_b128 v5, v[44:47] offset:768
    ds_write_b128 v5, v[48:51] offset:1024
    ds_write_b128 v5, v[52:55] offset:1280
    ds_write_b128 v5, v[56:59] offset:1536
    ds_write_b128 v5, v[60:63] offset:1792
    ds_write_b128 v5, v[64:67] offset:2048
    ds_write_b128 v5, v[68:71] offset:2304
    ds_write_b128 v5, v[72:75] offset:2560
    ds_write_b128 v5, v[76:79] offset:2816
    ds_write_b128 v5, v[80:83] offset:3072
    ds_write_b128 v5, v[84:87] offset:3328
    ds_write_b128 v5, v[88:91] offset:3584
    s_waitcnt lgkmcnt(0)
    v_lshlrev_b32 v100, 16, v6
    v_and_b32 v101, 0xffff0000, v6
    s_cmp_eq_u32 s60, 4
    s_cselect_b32 s40, 6, 12
    s_mov_b32 s41, 5462
    s_cmov_b32 s41, 10923
    s_cselect_b32 s34, 20, 20
    s_mov_b32 s49, 17280
    s_cmov_b32 s49, 34560
    v_min_u32 v196, 59, v0
    v_mul_u32_u24 v197, s41, v196
    v_lshrrev_b32 v197, 16, v197
    v_mul_u32_u24 v194, s40, v197
    v_sub_u32 v196, v196, v194
    v_mul_u32_u24 v197, 3456, v197
    v_lshl_add_u32 v197, v196, 6, v197
    s_mul_i32 s35, s60, 768
    s_add_i32 s35, s35, 0
    s_cmp_eq_u32 s60, 4
    s_cselect_b32 s35, 3072, s35
    s_sub_u32 s34, s61, s34
    s_mul_i32 s34, s34, s49
    s_mul_i32 s34, s34, 11
    s_add_u32 s34, s34, s35
    v_add_u32 v197, s34, v197
    s_mov_b32 s40, s49
    s_mov_b32 s41, s49
    s_branch L_d_none
L_d_w2:
    s_lshl_b32 s34, s62, 5
    v_lshl_add_u32 v3, v14, 3, s34
    global_load_dwordx2 v[20:21], v3, s[22:23]
    v_mul_u32_u24 v112, 1280, v12
    v_add_u32 v112, v112, v3
    global_load_dwordx2 v[22:23], v112, s[4:5]
    s_lshr_b32 s34, s62, 2
    s_add_u32 s34, s34, 30
    s_lshr_b32 s35, s34, 2
    s_lshl_b32 s35, s35, 9
    s_and_b32 s34, s34, 3
    s_lshl_b32 s34, s34, 15
    s_add_u32 s34, s34, s35
    s_and_b32 s35, s62, 3
    s_mul_i32 s35, s35, 32
    s_add_u32 s34, s34, s35
    s_add_u32 s34, s34, 1572864
    v_lshlrev_b32 v5, 7, v12
    v_lshl_add_u32 v5, v14, 3, v5
    v_add_u32 v5, s34, v5
    s_waitcnt vmcnt(0)
    v_lshlrev_b32 v32, 16, v20
    v_and_b32 v33, 0xffff0000, v20
    v_lshlrev_b32 v34, 16, v21
    v_and_b32 v35, 0xffff0000, v21
    v_lshlrev_b32 v108, 16, v22
    v_and_b32 v109, 0xffff0000, v22
    v_lshlrev_b32 v110, 16, v23
    v_and_b32 v111, 0xffff0000, v23
    s_mov_b32 s35, 0
L_poll30:
    buffer_load_dwordx2 v[24:25], v5, s[44:47], 0 offen sc1
    s_add_u32 s35, s35, 1
    s_waitcnt vmcnt(0)
    v_max_u32 v28, v24, v25
    v_cmp_eq_u32 vcc, -1, v28
    s_cbranch_vccz L_done31
    s_sleep 16
    s_cmp_lt_u32 s35, 60000
    s_cbranch_scc1 L_poll30
L_done31:
    v_lshlrev_b32 v104, 16, v24
    v_and_b32 v105, 0xffff0000, v24
    v_lshlrev_b32 v106, 16, v25
    v_and_b32 v107, 0xffff0000, v25
    v_fma_f32 v108, v104, v32, v108
    v_fma_f32 v109, v105, v33, v109
    v_fma_f32 v110, v106, v34, v110
    v_fma_f32 v111, v107, v35, v111
    v_mul_f32 v108, 0x3e800000, v108
    v_mul_f32 v109, 0x3e800000, v109
    v_mul_f32 v110, 0x3e800000, v110
    v_mul_f32 v111, 0x3e800000, v111
    v_lshl_add_u32 v204, v13, 15, v112
    s_add_u32 s34, s99, 786432
    v_add_u32 v204, s34, v204
    s_cmp_eq_u32 s60, 4
    s_cselect_b32 s40, 2, 6
    s_mov_b32 s41, 10923
    s_cmov_b32 s41, 32769
    s_cselect_b32 s34, 28, 20
    s_mov_b32 s49, 12800
    s_cmov_b32 s49, 38400
    v_min_u32 v196, 59, v0
    v_mul_u32_u24 v197, s41, v196
    v_lshrrev_b32 v197, 16, v197
    v_mul_u32_u24 v194, s40, v197
    v_sub_u32 v196, v196, v194
    v_mul_u32_u24 v197, 1280, v197
    v_lshl_add_u32 v197, v196, 6, v197
    s_mul_i32 s35, s60, 384
    s_add_i32 s35, s35, -1792
    s_cmp_eq_u32 s60, 4
    s_cselect_b32 s35, 0, s35
    s_sub_u32 s34, s61, s34
    s_mul_i32 s34, s34, s49
    s_mul_i32 s34, s34, 15
    s_add_u32 s34, s34, s35
    v_add_u32 v197, s34, v197
    s_mov_b32 s40, s49
    s_mov_b32 s41, s49
    s_branch L_d_none
L_d_wo:
    s_lshr_b32 s49, s3, 1
    s_lshl_b32 s49, s49, 15
    v_and_b32 v210, 7, v0
    s_mul_i32 s34, s60, 4096
    s_add_u32 s34, s34, s49
    s_add_u32 s34, s34, 1179904
    v_lshrrev_b32 v211, 3, v0
    v_mul_u32_u24 v205, 512, v211
    v_add_u32 v204, s34, v205
    s_lshl_b32 s35, s51, 7
    s_add_u32 s34, s34, s35
    s_sub_u32 s34, s34, 256
    v_lshl_add_u32 v205, v210, 4, v205
    v_add_u32 v205, s34, v205
    s_lshl_b32 s34, s3, 12
    s_add_u32 s34, s34, 40960
    v_lshrrev_b32 v206, 2, v0
    v_lshlrev_b32 v206, 6, v206
    v_lshl_add_u32 v206, v200, 3, v206
    v_add_u32 v206, s34, v206
    s_mul_i32 s34, s3, 1152
    s_add_u32 s34, s34, 107520
    v_mul_u32_u24 v207, 144, v211
    v_lshl_add_u32 v207, v210, 4, v207
    v_add_u32 v207, s34, v207
    v_mul_u32_u24 v208, 144, v210
    v_lshl_add_u32 v208, v202, 4, v208
    v_add_u32 v208, s34, v208
    v_mul_u32_u24 v212, 144, v211
    v_add_u32 v212, s34, v212
    v_mul_u32_u24 v213, 144, v210
    v_add_u32 v213, s34, v213
    v_and_b32 v211, 1, v211
    v_bfe_u32 v203, v0, 1, 2
    v_mul_u32_u24 v203, 144, v203
    v_and_b32 v214, 1, v0
    v_mul_u32_u24 v214, 576, v214
    v_lshl_add_u32 v214, v211, 6, v214
    v_lshl_add_u32 v214, v202, 4, v214
    s_add_u32 s34, s34, 14592
    v_add3_u32 v203, v203, v214, s34
    v_mov_b32 v210, 98816
    v_cmp_eq_u32 vcc, 0, v211
    s_nop 1
    v_cndmask_b32 v209, v208, v210, vcc
    v_cndmask_b32 v208, v210, v208, vcc
    v_and_b32 v8, 15, v0
    s_lshr_b32 s34, s62, 1
    s_add_u32 s34, s34, 0
    s_lshr_b32 s35, s34, 2
    s_lshl_b32 s35, s35, 9
    s_and_b32 s34, s34, 3
    s_lshl_b32 s34, s34, 15
    s_add_u32 s34, s34, s35
    s_and_b32 s35, s62, 1
    s_mul_i32 s35, s35, 64
    s_add_u32 s34, s34, s35
    s_add_u32 s34, s34, 1572864
    v_lshlrev_b32 v9, 2, v8
    v_lshl_add_u32 v9, v14, 7, v9
    v_add_u32 v9, s34, v9
    s_lshr_b32 s34, s60, 2
    s_lshl_b32 s34, s34, 14
    s_and_b32 s35, s60, 3
    s_lshl_b32 s35, s35, 15
    s_add_u32 s34, s34, s35
    s_lshl_b32 s35, s62, 6
    s_add_u32 s34, s34, s35
    s_add_u32 s34, s34, 786432
    v_mul_u32_u24 v112, 1280, v14
    v_lshl_add_u32 v112, v8, 2, v112
    v_add_u32 v112, s34, v112
    v_add_u32 v114, 917504, v112
    v_mul_u32_u24 v113, 144, v14
    v_lshl_add_u32 v113, v8, 3, v113
    v_add_u32 v113, 122112, v113
    s_bfe_u32 s35, s60, 0x10002
    s_lshl_b32 s35, s35, 13
    s_xor_b32 s101, s99, s35
    s_xor_b32 s93, s101, 8192
    s_mul_i32 s34, s62, 52
    s_lshr_b32 s34, s34, 8
    s_mul_i32 s35, s34, 5
    s_sub_u32 s35, s62, s35
    s_mul_i32 s34, s34, 1310720
    s_lshl_b32 s35, s35, 15
    s_add_u32 s34, s34, s35
    s_mul_i32 s35, s60, 163840
    s_add_u32 s34, s34, s35
    v_lshl_add_u32 v197, v0, 6, s34
    s_movk_i32 s40, 4096
    s_movk_i32 s41, 4096
    s_mov_b32 s35, 0
L_poll33:
    buffer_load_dword v32, v9, s[44:47], 0 offen sc1
    s_add_u32 s35, s35, 1
    s_waitcnt vmcnt(0)
    v_mov_b32 v22, v32
    v_cmp_eq_u32 vcc, -1, v22
    s_cbranch_vccz L_done34
    s_sleep 16
    s_cmp_lt_u32 s35, 60000
    s_cbranch_scc1 L_poll33
L_done34:
    v_lshlrev_b32 v100, 16, v32
    v_and_b32 v101, 0xffff0000, v32
L_d_none:
    v_mov_b32 v22, 99072
    s_and_b32 s34, s60, 3
    s_lshl_b32 s34, s34, 15
    s_lshr_b32 s35, s60, 2
    s_lshl_b32 s35, s35, 7
    s_add_u32 s34, s34, s35
    s_add_u32 s34, s34, 793600
    v_and_b32 v252, 31, v0
    v_lshl_add_u32 v252, v252, 2, s34
    v_mov_b32 v253, 0
    s_mov_b32 s35, 0
L_poll36:
    ds_read_b32 v23, v22
    s_add_u32 s35, s35, 1
    s_waitcnt lgkmcnt(0)
    v_cmp_gt_u32 vcc, 46, v23
    s_cbranch_vccz L_done37
    s_sleep 2
    s_cmp_lt_u32 s35, 60000
    s_cbranch_scc1 L_poll36
L_done37:
    buffer_load_dword v251, v252, s[44:47], 0 offen sc1
    s_lshl_b64 exec, 1, s61
    buffer_store_dword v253, v252, s[44:47], 0 offen
    s_mov_b64 exec, -1
    s_waitcnt vmcnt(1)
    v_cmp_ne_u32 vcc, -1, v251
    v_mov_b32 v252, 99076
    s_bcnt1_i32_b32 s34, vcc_lo
    v_mov_b32 v251, s34
    s_mov_b64 exec, 1
    ds_write_b32 v252, v251
    s_mov_b64 exec, -1
    v_mov_b32 v22, 99072
    s_and_b32 s34, s60, 3
    s_lshl_b32 s34, s34, 15
    s_lshr_b32 s35, s60, 2
    s_lshl_b32 s35, s35, 7
    s_add_u32 s34, s34, s35
    s_add_u32 s34, s34, 793856
    v_and_b32 v252, 31, v0
    v_lshl_add_u32 v252, v252, 2, s34
    v_mov_b32 v253, 0
    s_mov_b32 s35, 0
L_poll39:
    ds_read_b32 v23, v22
    s_add_u32 s35, s35, 1
    s_waitcnt lgkmcnt(0)
    v_cmp_gt_u32 vcc, 57, v23
    s_cbranch_vccz L_done40
    s_sleep 2
    s_cmp_lt_u32 s35, 60000
    s_cbranch_scc1 L_poll39
L_done40:
    buffer_load_dword v251, v252, s[44:47], 0 offen sc1
    s_lshl_b64 exec, 1, s61
    buffer_store_dword v253, v252, s[44:47], 0 offen
    s_mov_b64 exec, -1
    s_waitcnt vmcnt(1)
    v_cmp_ne_u32 vcc, -1, v251
    v_mov_b32 v252, 99076
    s_bcnt1_i32_b32 s34, vcc_lo
    v_mov_b32 v251, s34
    s_mov_b64 exec, 1
    ds_write_b32 v252, v251
    s_mov_b64 exec, -1
    v_and_b32 v19, 7, v0
    v_lshlrev_b32 v19, 3, v19
    v_add_u32 v19, 98560, v19
    s_mov_b32 s35, 0
L_poll42:
    ds_read_b64 v[20:21], v19
    s_add_u32 s35, s35, 1
    s_waitcnt lgkmcnt(0)
    v_max_u32 v22, v20, v21
    v_cmp_eq_u32 vcc, -1, v22
    s_cbranch_vccz L_done43
    s_sleep 2
    s_cmp_lt_u32 s35, 60000
    s_cbranch_scc1 L_poll42
L_done43:
    v_max_f32_dpp v22, v20, v20 row_half_mirror row_mask:0xf bank_mask:0xf
    s_nop 1
    v_max_f32_dpp v22, v22, v22 quad_perm:[1,0,3,2] row_mask:0xf bank_mask:0xf
    s_nop 1
    v_max_f32_dpp v22, v22, v22 quad_perm:[2,3,0,1] row_mask:0xf bank_mask:0xf
    v_sub_f32 v20, v20, v22
    v_exp_f32 v20, v20
    s_nop 0
    v_mul_f32 v21, v21, v20
    s_nop 1
    v_add_f32_dpp v21, v21, v21 row_half_mirror row_mask:0xf bank_mask:0xf
    s_nop 1
    v_add_f32_dpp v21, v21, v21 quad_perm:[1,0,3,2] row_mask:0xf bank_mask:0xf
    s_nop 1
    v_add_f32_dpp v21, v21, v21 quad_perm:[2,3,0,1] row_mask:0xf bank_mask:0xf
    v_rcp_f32 v23, v21
    v_log_f32 v21, v21
    v_mul_f32 v20, v20, v23
    v_add_f32 v21, v21, v22
    v_min_u32 v21, -2, v21
    v_readlane_b32 s88, v20, 0
    v_readlane_b32 s90, v20, 1
    v_readlane_b32 s92, v20, 2
    v_readlane_b32 s94, v20, 3
    v_readlane_b32 s96, v20, 4
    v_readlane_b32 s98, v20, 5
    v_readlane_b32 s100, v20, 6
    v_readlane_b32 s89, v20, 7
    s_and_b32 s95, s61, 3
    s_lshl_b32 s95, s95, 15
    s_bfe_u32 s35, s2, 0x20005
    s_lshl_b32 s35, s35, 1
    s_lshr_b32 s91, s2, 7
    s_add_u32 s35, s35, s91
    s_getreg_b32 s91, hwreg(HW_REG_XCC_ID, 0, 4)
    v_and_b32 v24, 1, v0
    v_cmp_eq_u32 vcc, 0, v24
    v_mov_b32 v25, s91
    s_nop 0
    v_cndmask_b32 v25, v25, v21, vcc
    v_mul_f32 v20, s89, v116
    v_mul_f32 v21, s89, v117
    s_mul_i32 s34, s60, 4096
    s_mul_i32 s35, s35, 512
    s_add_u32 s34, s34, s35
    s_add_u32 s34, s34, s95
    s_add_u32 s34, s34, 1179648
    v_lshl_add_u32 v26, v0, 2, s34
    v_lshlrev_b32 v19, 3, v0
    v_add_u32 v19, 99328, v19
    v_lshlrev_b32 v18, 4, v0
    v_add_u32 v18, 131328, v18
    s_mov_b32 s36, s12
    s_mov_b32 s37, s13
    s_mov_b32 s38, 5242880
    s_and_b32 s34, s61, 24
    s_add_u32 s34, s34, s60
    s_mul_i32 s34, s34, 163840
    s_and_b32 s35, s61, 7
    s_mul_i32 s35, s35, 20480
    s_add_u32 s34, s34, s35
    v_lshl_add_u32 v195, v0, 6, s34
    s_mov_b32 s34, 0
    s_barrier
    buffer_load_dword v250, v195, s[36:39], s34 offen
    s_add_u32 s34, s34, 4096
    buffer_load_dword v250, v195, s[36:39], s34 offen
    s_add_u32 s34, s34, 4096
    buffer_load_dword v250, v195, s[36:39], s34 offen
    s_add_u32 s34, s34, 4096
    buffer_load_dword v250, v195, s[36:39], s34 offen
    s_add_u32 s34, s34, 4096
    buffer_load_dword v250, v195, s[36:39], s34 offen
    s_add_u32 s34, s34, 4096
    s_cmp_lt_u32 s63, 1
    s_cbranch_scc1 L_nopf
    buffer_load_dword v250, v197, s[52:55], s42 offen
    s_add_u32 s42, s42, s40
    buffer_load_dword v250, v197, s[52:55], s42 offen
    s_add_u32 s42, s42, s41
L_nopf:
    s_cmp_eq_u32 s97, 0
    s_barrier
    ds_read_b64 v[32:33], v19 offset:0
    ds_read_b64 v[34:35], v19 offset:1024
    ds_read_b64 v[36:37], v19 offset:2048
    ds_read_b64 v[38:39], v19 offset:3072
    ds_read_b64 v[40:41], v19 offset:4096
    ds_read_b64 v[42:43], v19 offset:5120
    ds_read_b64 v[44:45], v19 offset:6144
    buffer_store_dword v25, v26, s[44:47], 0 offen offset:256
    s_waitcnt lgkmcnt(6)
    v_pk_fma_f32 v[20:21], v[32:33], s[88:89], v[20:21] op_sel_hi:[1,0,1]
    s_waitcnt lgkmcnt(5)
    v_pk_fma_f32 v[20:21], v[34:35], s[90:91], v[20:21] op_sel_hi:[1,0,1]
    s_waitcnt lgkmcnt(4)
    v_pk_fma_f32 v[20:21], v[36:37], s[92:93], v[20:21] op_sel_hi:[1,0,1]
    s_waitcnt lgkmcnt(3)
    v_pk_fma_f32 v[20:21], v[38:39], s[94:95], v[20:21] op_sel_hi:[1,0,1]
    s_waitcnt lgkmcnt(2)
    v_pk_fma_f32 v[20:21], v[40:41], s[96:97], v[20:21] op_sel_hi:[1,0,1]
    s_waitcnt lgkmcnt(1)
    v_pk_fma_f32 v[20:21], v[42:43], s[98:99], v[20:21] op_sel_hi:[1,0,1]
    s_waitcnt lgkmcnt(0)
    v_pk_fma_f32 v[20:21], v[44:45], s[100:101], v[20:21] op_sel_hi:[1,0,1]
    v_cvt_pk_bf16_f32 v24, v20, v21
    v_min_u32 v24, -2, v24
    buffer_store_dword v24, v26, s[44:47], 0 offen
    s_cbranch_scc1 L_ostd
    buffer_store_dword v24, v26, s[44:47], 0 offen sc1
    buffer_store_dword v25, v26, s[44:47], 0 offen offset:256 sc1
L_ostd:
    ds_write_b96 v18, v[24:26]
    s_cmp_lt_u32 s63, 1
    s_cbranch_scc1 L_nopf2
    buffer_load_dword v250, v197, s[52:55], s42 offen
    s_add_u32 s42, s42, s40
    buffer_load_dword v250, v197, s[52:55], s42 offen
    s_add_u32 s42, s42, s41
    buffer_load_dword v250, v197, s[52:55], s42 offen
    s_add_u32 s42, s42, s40
    buffer_load_dword v250, v197, s[52:55], s42 offen
    s_add_u32 s42, s42, s41
    buffer_load_dword v250, v197, s[52:55], s42 offen
    s_add_u32 s42, s42, s40
    buffer_load_dword v250, v197, s[52:55], s42 offen
    s_add_u32 s42, s42, s41
    buffer_load_dword v250, v197, s[52:55], s42 offen
    s_add_u32 s42, s42, s40
    buffer_load_dword v250, v197, s[52:55], s42 offen
    s_add_u32 s42, s42, s41
L_nopf2:
    s_waitcnt lgkmcnt(0)
    s_barrier
    s_cmp_eq_u32 s63, 0
    s_cbranch_scc1 L_r_wo2
    buffer_load_dword v250, v197, s[52:55], s42 offen
    s_add_u32 s42, s42, s40
    s_cmp_eq_u32 s63, 1
    s_cbranch_scc1 L_r_w1
    buffer_load_dword v250, v197, s[52:55], s42 offen
    s_add_u32 s42, s42, s40
    buffer_load_dword v250, v197, s[52:55], s42 offen
    s_add_u32 s42, s42, s41
    buffer_load_dword v250, v197, s[52:55], s42 offen
    s_add_u32 s42, s42, s40
    buffer_load_dword v250, v197, s[52:55], s42 offen
    s_add_u32 s42, s42, s41
    s_cmp_eq_u32 s63, 2
    s_cbranch_scc1 L_w2_red
    s_waitcnt vmcnt(0)
    s_mov_b64 exec, -1
    v_lshlrev_b32 v243, 4, v0
    v_add_u32 v243, 131328, v243
    ds_read_b96 v[240:242], v243
    s_waitcnt lgkmcnt(0)
    buffer_store_dword v240, v242, s[44:47], 0 offen sc1
    buffer_store_dword v241, v242, s[44:47], 0 offen offset:256 sc1
    s_branch L_fin
L_stream:
    s_sub_u32 s49, s3, 1
    s_lshl_b32 s49, s49, 12
    v_lshl_add_u32 v1, v0, 4, s49
    s_and_b32 s34, s2, 127
    s_lshl_b32 s34, s34, 21
    s_lshr_b32 s35, s2, 7
    s_lshl_b32 s35, s35, 18
    s_add_u32 s34, s34, s35
    s_add_u32 s34, s34, 1572864
    s_mov_b32 s38, 0x40000
    s_mov_b32 s42, 0x40000
    s_waitcnt lgkmcnt(0)
    s_add_u32 s36, s6, s34
    s_addc_u32 s37, s7, 0
    s_add_u32 s40, s8, s34
    s_addc_u32 s41, s9, 0
    s_barrier
    s_waitcnt vmcnt(2)
    buffer_load_dwordx4 v[28:31], v1, s[36:39], s98 offen offset:3072 nt
    s_waitcnt vmcnt(2)
    s_add_u32 s98, s98, 28672
    s_cmp_eq_u32 s98, 258048
    s_cselect_b32 s98, 0, s98
    buffer_load_dwordx4 v[32:35], v1, s[36:39], s98 offen offset:0 nt
    s_waitcnt vmcnt(2)
    buffer_load_dwordx4 v[36:39], v1, s[36:39], s98 offen offset:1024 nt
    s_waitcnt vmcnt(2)
    buffer_load_dwordx4 v[40:43], v1, s[36:39], s98 offen offset:2048 nt
    s_waitcnt vmcnt(2)
    buffer_load_dwordx4 v[44:47], v1, s[36:39], s98 offen offset:3072 nt
    s_add_u32 s44, s32, 0
    s_addc_u32 s45, s33, 0
    s_mov_b32 s63, 0
    s_mov_b32 s62, s61
    s_cmp_lt_u32 s61, 20
    s_cbranch_scc1 L_rd45
    s_mul_i32 s62, s60, 12
    s_add_u32 s62, s62, s61
    s_sub_u32 s62, s62, 20
    s_mov_b32 s63, 1
    s_cmp_lt_u32 s62, 54
    s_cbranch_scc1 L_rd45
    s_cmp_lt_u32 s62, 56
    s_cselect_b32 s63, 3, 2
    s_sub_u32 s62, s62, 56
L_rd45:
    v_and_b32 v8, 3, v0
    v_bfe_u32 v9, v0, 2, 2
    v_lshrrev_b32 v10, 4, v0
    s_mov_b32 s55, 0x20000
    s_lshl_b32 s35, s62, 6
    s_and_b32 s49, s62, 1
    s_cmp_eq_u32 s63, 0
    s_cbranch_scc1 L_dp47
    s_cmp_eq_u32 s63, 1
    s_cbranch_scc1 L_dp48
    s_mov_b32 s52, s20
    s_mov_b32 s53, s21
    s_mov_b32 s54, 2211840
    v_mov_b32 v15, 0
    s_branch L_dp49
L_dp48:
    s_mov_b32 s52, s16
    s_mov_b32 s53, s17
    s_mov_b32 s54, 2211840
    v_lshl_add_u32 v15, v9, 3, v10
    v_mul_u32_u24 v15, 3456, v15
    v_lshl_add_u32 v15, v8, 4, v15
    v_add_u32 v15, s35, v15
    s_bfe_u32 s50, s3, 0x10001
    s_lshl_b32 s50, s50, 7
    s_and_b32 s34, s3, 1
    s_lshl_b32 s34, s34, 2
    s_add_u32 s50, s50, s34
    s_and_b32 s51, s3, 3
    s_lshl_b32 s51, s51, 5
    s_add_u32 s51, s51, 512
    s_mul_i32 s50, s50, 3456
    s_mul_i32 s51, s51, 3456
    s_branch L_dp49
L_dp47:
    s_mov_b32 s52, s12
    s_mov_b32 s53, s13
    s_mov_b32 s54, 5242880
    s_lshr_b32 s50, s3, 1
    s_lshl_b32 s50, s50, 3
    s_add_u32 s50, s50, s60
    s_and_b32 s51, s3, 1
    s_lshl_b32 s34, s50, 1
    s_add_u32 s34, s34, s51
    s_mul_i32 s34, s34, 81920
    s_add_u32 s34, s34, s35
    v_lshl_add_u32 v15, v9, 2, v10
    v_mul_u32_u24 v15, 2560, v15
    v_lshl_add_u32 v15, v8, 4, v15
    v_add_u32 v15, s34, v15
    s_lshl_b32 s56, s3, 12
    s_lshl_b32 s34, s49, 11
    s_add_u32 s56, s56, s34
    s_add_u32 s56, s56, 40960
    s_add_u32 s58, s56, 1024
    s_mul_i32 s57, s49, 40960
    s_add_u32 s59, s57, 1280
L_dp49:
    v_and_b32 v2, 15, v0
    v_lshlrev_b32 v2, 4, v2
    v_add_u32 v2, 98304, v2
    s_waitcnt vmcnt(2)
    s_add_u32 s98, s98, 28672
    s_cmp_eq_u32 s98, 258048
    s_cselect_b32 s98, 0, s98
    buffer_load_dwordx4 v[48:51], v1, s[36:39], s98 offen offset:0 nt
    s_waitcnt vmcnt(2)
    buffer_load_dwordx4 v[52:55], v1, s[36:39], s98 offen offset:1024 nt
    s_waitcnt vmcnt(2)
    s_cmp_ge_u32 s3, 4
    s_cbranch_scc1 L_sl50
    s_waitcnt vmcnt(1)
L_sl50:
    buffer_load_dwordx4 v[56:59], v1, s[36:39], s98 offen offset:2048 nt
    s_waitcnt vmcnt(2)
    s_cmp_ge_u32 s3, 4
    s_cbranch_scc1 L_sl51
    s_waitcnt vmcnt(1)
L_sl51:
    buffer_load_dwordx4 v[60:63], v1, s[36:39], s98 offen offset:3072 nt
    s_waitcnt vmcnt(2)
    s_cmp_ge_u32 s3, 4
    s_cbranch_scc1 L_sl52
    s_waitcnt vmcnt(1)
L_sl52:
    s_add_u32 s98, s98, 28672
    s_cmp_eq_u32 s98, 258048
    s_cselect_b32 s98, 0, s98
    buffer_load_dwordx4 v[64:67], v1, s[36:39], s98 offen offset:0 nt
    s_waitcnt vmcnt(2)
    buffer_load_dwordx4 v[68:71], v1, s[36:39], s98 offen offset:1024 nt
    s_waitcnt vmcnt(2)
    buffer_load_dwordx4 v[72:75], v1, s[36:39], s98 offen offset:2048 nt
    s_waitcnt vmcnt(2)
    buffer_load_dwordx4 v[76:79], v1, s[36:39], s98 offen offset:3072 nt
    s_waitcnt vmcnt(2)
    s_add_u32 s98, s98, 28672
    s_cmp_eq_u32 s98, 258048
    s_cselect_b32 s98, 0, s98
    buffer_load_dwordx4 v[80:83], v1, s[36:39], s98 offen offset:0 nt
    s_waitcnt vmcnt(2)
    buffer_load_dwordx4 v[84:87], v1, s[36:39], s98 offen offset:1024 nt
    s_waitcnt vmcnt(2)
    buffer_load_dwordx4 v[88:91], v1, s[36:39], s98 offen offset:2048 nt
    s_waitcnt vmcnt(2)
    buffer_load_dwordx4 v[92:95], v1, s[36:39], s98 offen offset:3072 nt
    s_waitcnt vmcnt(2)
    s_add_u32 s98, s98, 28672
    s_cmp_eq_u32 s98, 258048
    s_cselect_b32 s98, 0, s98
    buffer_load_dwordx4 v[96:99], v1, s[36:39], s98 offen offset:0 nt
    v_mov_b32 v3, 21
    v_mov_b32 v14, 99072
    s_mov_b64 exec, 1
    ds_write_b32 v14, v3
    s_mov_b64 exec, -1
    s_waitcnt vmcnt(2)
    buffer_load_dwordx4 v[100:103], v1, s[36:39], s98 offen offset:1024 nt
    s_waitcnt vmcnt(2)
    buffer_load_dwordx4 v[104:107], v1, s[36:39], s98 offen offset:2048 nt
    s_waitcnt vmcnt(2)
    buffer_load_dwordx4 v[108:111], v1, s[36:39], s98 offen offset:3072 nt
    s_waitcnt vmcnt(2)
    s_add_u32 s98, s98, 28672
    s_cmp_eq_u32 s98, 258048
    s_cselect_b32 s98, 0, s98
    buffer_load_dwordx4 v[112:115], v1, s[36:39], s98 offen offset:0 nt
    s_waitcnt vmcnt(2)
    buffer_load_dwordx4 v[116:119], v1, s[36:39], s98 offen offset:1024 nt
    s_waitcnt vmcnt(2)
    buffer_load_dwordx4 v[120:123], v1, s[36:39], s98 offen offset:2048 nt
    s_waitcnt vmcnt(2)
    buffer_load_dwordx4 v[124:127], v1, s[36:39], s98 offen offset:3072 nt
    s_waitcnt vmcnt(2)
    s_add_u32 s98, s98, 28672
    s_cmp_eq_u32 s98, 258048
    s_cselect_b32 s98, 0, s98
    buffer_load_dwordx4 v[128:131], v1, s[36:39], s98 offen offset:0 nt
    s_waitcnt vmcnt(2)
    buffer_load_dwordx4 v[132:135], v1, s[36:39], s98 offen offset:1024 nt
    s_waitcnt vmcnt(2)
    buffer_load_dwordx4 v[136:139], v1, s[36:39], s98 offen offset:2048 nt
    s_waitcnt vmcnt(2)
    buffer_load_dwordx4 v[140:143], v1, s[36:39], s98 offen offset:3072 nt
    s_waitcnt vmcnt(2)
    s_add_u32 s98, s98, 28672
    s_cmp_eq_u32 s98, 258048
    s_cselect_b32 s98, 0, s98
    buffer_load_dwordx4 v[144:147], v1, s[36:39], s98 offen offset:0 nt
    v_mov_b32 v3, 33
    v_mov_b32 v14, 99072
    s_mov_b64 exec, 1
    ds_write_b32 v14, v3
    s_mov_b64 exec, -1
    s_waitcnt vmcnt(2)
    buffer_load_dwordx4 v[148:151], v1, s[36:39], s98 offen offset:1024 nt
    s_waitcnt vmcnt(2)
    buffer_load_dwordx4 v[152:155], v1, s[36:39], s98 offen offset:2048 nt
    s_waitcnt vmcnt(2)
    buffer_load_dwordx4 v[156:159], v1, s[36:39], s98 offen offset:3072 nt
    s_waitcnt vmcnt(2)
    s_add_u32 s98, s98, 28672
    s_cmp_eq_u32 s98, 258048
    s_cselect_b32 s98, 0, s98
    buffer_load_dwordx4 v[160:163], v1, s[40:43], s98 offen offset:0 nt
    v_mov_b32 v3, 99076
    ds_read_b32 v3, v3
    s_waitcnt vmcnt(2)
    s_waitcnt lgkmcnt(0)
    v_readfirstlane_b32 s48, v3
    buffer_load_dwordx4 v[164:167], v1, s[40:43], s98 offen offset:1024 nt
    s_cmp_ge_u32 s48, 20
    s_cbranch_scc1 L_bo53
    s_waitcnt vmcnt(2)
L_bo53:
    buffer_load_dwordx4 v[168:171], v1, s[40:43], s98 offen offset:2048 nt
    s_waitcnt vmcnt(3)
    s_cmp_ge_u32 s48, 21
    s_cbranch_scc1 L_bo54
    s_waitcnt vmcnt(2)
L_bo54:
    buffer_load_dwordx4 v[172:175], v1, s[40:43], s98 offen offset:3072 nt
    s_waitcnt vmcnt(3)
    s_cmp_ge_u32 s48, 22
    s_cbranch_scc1 L_bo55
    s_waitcnt vmcnt(2)
L_bo55:
    s_add_u32 s98, s98, 28672
    s_cmp_eq_u32 s98, 258048
    s_cselect_b32 s98, 0, s98
    buffer_load_dwordx4 v[176:179], v1, s[40:43], s98 offen offset:0 nt
    s_waitcnt vmcnt(3)
    s_cmp_ge_u32 s48, 23
    s_cbranch_scc1 L_bo56
    s_waitcnt vmcnt(2)
L_bo56:
    buffer_load_dwordx4 v[180:183], v1, s[40:43], s98 offen offset:1024 nt
    s_waitcnt vmcnt(3)
    s_cmp_ge_u32 s48, 24
    s_cbranch_scc1 L_bo57
    s_waitcnt vmcnt(2)
L_bo57:
    buffer_load_dwordx4 v[184:187], v1, s[40:43], s98 offen offset:2048 nt
    s_waitcnt vmcnt(3)
    s_cmp_ge_u32 s48, 24
    s_cbranch_scc1 L_bo58
    s_waitcnt vmcnt(2)
L_bo58:
    buffer_load_dwordx4 v[188:191], v1, s[40:43], s98 offen offset:3072 nt
    s_waitcnt vmcnt(3)
    s_cmp_ge_u32 s48, 25
    s_cbranch_scc1 L_bo59
    s_waitcnt vmcnt(2)
L_bo59:
    s_add_u32 s98, s98, 28672
    s_cmp_eq_u32 s98, 258048
    s_cselect_b32 s98, 0, s98
    buffer_load_dwordx4 v[192:195], v1, s[40:43], s98 offen offset:0 nt
    s_waitcnt vmcnt(3)
    s_cmp_ge_u32 s48, 26
    s_cbranch_scc1 L_bo60
    s_waitcnt vmcnt(2)
L_bo60:
    buffer_load_dwordx4 v[196:199], v1, s[40:43], s98 offen offset:1024 nt
    v_mov_b32 v3, 46
    v_mov_b32 v14, 99072
    s_mov_b64 exec, 1
    ds_write_b32 v14, v3
    s_mov_b64 exec, -1
    s_waitcnt vmcnt(3)
    s_cmp_ge_u32 s48, 27
    s_cbranch_scc1 L_bo61
    s_waitcnt vmcnt(2)
L_bo61:
    buffer_load_dwordx4 v[200:203], v1, s[40:43], s98 offen offset:2048 nt
    s_waitcnt vmcnt(3)
    s_cmp_ge_u32 s48, 27
    s_cbranch_scc1 L_bo62
    s_waitcnt vmcnt(2)
L_bo62:
    buffer_load_dwordx4 v[204:207], v1, s[40:43], s98 offen offset:3072 nt
    s_waitcnt vmcnt(3)
    s_cmp_ge_u32 s48, 28
    s_cbranch_scc1 L_bo63
    s_waitcnt vmcnt(2)
L_bo63:
    s_add_u32 s98, s98, 28672
    s_cmp_eq_u32 s98, 258048
    s_cselect_b32 s98, 0, s98
    buffer_load_dwordx4 v[208:211], v1, s[40:43], s98 offen offset:0 nt
    s_waitcnt vmcnt(3)
    s_cmp_ge_u32 s48, 28
    s_cbranch_scc1 L_bo64
    s_waitcnt vmcnt(2)
L_bo64:
    buffer_load_dwordx4 v[212:215], v1, s[40:43], s98 offen offset:1024 nt
    v_mov_b32 v3, 99076
    ds_read_b32 v3, v3
    s_waitcnt vmcnt(3)
    s_cmp_ge_u32 s48, 29
    s_cbranch_scc1 L_bo65
    s_waitcnt vmcnt(2)
L_bo65:
    s_waitcnt lgkmcnt(0)
    v_readfirstlane_b32 s48, v3
    buffer_load_dwordx4 v[216:219], v1, s[40:43], s98 offen offset:2048 nt
    s_waitcnt vmcnt(3)
    s_cmp_ge_u32 s48, 20
    s_cbranch_scc1 L_bo66
    s_waitcnt vmcnt(2)
L_bo66:
    buffer_load_dwordx4 v[220:223], v1, s[40:43], s98 offen offset:3072 nt
    s_waitcnt vmcnt(3)
    s_cmp_ge_u32 s48, 21
    s_cbranch_scc1 L_bo67
    s_waitcnt vmcnt(2)
L_bo67:
    s_add_u32 s98, s98, 28672
    s_cmp_eq_u32 s98, 258048
    s_cselect_b32 s98, 0, s98
    buffer_load_dwordx4 v[224:227], v1, s[40:43], s98 offen offset:0 nt
    s_waitcnt vmcnt(3)
    s_cmp_ge_u32 s48, 22
    s_cbranch_scc1 L_bo68
    s_waitcnt vmcnt(2)
L_bo68:
    buffer_load_dwordx4 v[228:231], v1, s[40:43], s98 offen offset:1024 nt
    s_waitcnt vmcnt(3)
    s_cmp_ge_u32 s48, 23
    s_cbranch_scc1 L_bo69
    s_waitcnt vmcnt(2)
L_bo69:
    buffer_load_dwordx4 v[232:235], v1, s[40:43], s98 offen offset:2048 nt
    s_waitcnt vmcnt(3)
    s_cmp_ge_u32 s48, 24
    s_cbranch_scc1 L_bo70
    s_waitcnt vmcnt(2)
L_bo70:
    buffer_load_dwordx4 v[236:239], v1, s[40:43], s98 offen offset:3072 nt
    s_waitcnt vmcnt(3)
    s_cmp_ge_u32 s48, 24
    s_cbranch_scc1 L_bo71
    s_waitcnt vmcnt(2)
L_bo71:
    s_add_u32 s98, s98, 28672
    s_cmp_eq_u32 s98, 258048
    s_cselect_b32 s98, 0, s98
    buffer_load_dwordx4 v[240:243], v1, s[40:43], s98 offen offset:0 nt
    v_mov_b32 v3, 57
    v_mov_b32 v14, 99072
    s_mov_b64 exec, 1
    ds_write_b32 v14, v3
    s_mov_b64 exec, -1
    s_waitcnt vmcnt(3)
    s_cmp_ge_u32 s48, 25
    s_cbranch_scc1 L_bo72
    s_waitcnt vmcnt(2)
L_bo72:
    buffer_load_dwordx4 v[244:247], v1, s[40:43], s98 offen offset:1024 nt
    s_waitcnt vmcnt(3)
    s_cmp_ge_u32 s48, 26
    s_cbranch_scc1 L_bo73
    s_waitcnt vmcnt(2)
L_bo73:
    buffer_load_dwordx4 v[248:251], v1, s[40:43], s98 offen offset:2048 nt
    s_waitcnt vmcnt(3)
    s_cmp_ge_u32 s48, 27
    s_cbranch_scc1 L_bo74
    s_waitcnt vmcnt(2)
L_bo74:
    buffer_load_dwordx4 v[252:255], v1, s[40:43], s98 offen offset:3072 nt
    v_mov_b32 v14, 99080
    s_mov_b32 s35, 0
L_poll75:
    ds_read_b128 v[4:7], v2
    ds_read_b32 v8, v14
    s_add_u32 s35, s35, 1
    s_waitcnt lgkmcnt(0)
    v_max3_u32 v3, v4, v5, v6
    v_max_u32 v3, v3, v7
    v_cmp_eq_u32 vcc, -1, v3
    s_cbranch_vccz L_done76
    s_sleep 2
    s_cmp_lt_u32 s35, 60000
    s_cbranch_scc1 L_poll75
L_done76:
    v_readfirstlane_b32 s99, v8
    v_dot2_f32_bf16 v8, v16, v4, 0
    v_dot2_f32_bf16 v9, v20, v4, 0
    v_dot2_f32_bf16 v10, v24, v4, 0
    v_dot2_f32_bf16 v11, v28, v4, 0
    v_dot2c_f32_bf16 v8, v17, v5
    v_dot2c_f32_bf16 v9, v21, v5
    v_dot2c_f32_bf16 v10, v25, v5
    v_dot2c_f32_bf16 v11, v29, v5
    v_dot2c_f32_bf16 v8, v18, v6
    v_dot2c_f32_bf16 v9, v22, v6
    v_dot2c_f32_bf16 v10, v26, v6
    v_dot2c_f32_bf16 v11, v30, v6
    v_dot2c_f32_bf16 v8, v19, v7
    v_dot2c_f32_bf16 v9, v23, v7
    v_dot2c_f32_bf16 v10, v27, v7
    v_dot2c_f32_bf16 v11, v31, v7
    v_add_f32_dpp v12, v8, v8 row_ror:8 row_mask:0xf bank_mask:0x3
    v_add_f32_dpp v12, v9, v9 row_ror:8 row_mask:0xf bank_mask:0xc
    v_add_f32_dpp v13, v10, v10 row_ror:8 row_mask:0xf bank_mask:0x3
    v_add_f32_dpp v13, v11, v11 row_ror:8 row_mask:0xf bank_mask:0xc
    v_dot2_f32_bf16 v8, v32, v4, 0
    v_dot2_f32_bf16 v9, v36, v4, 0
    v_dot2_f32_bf16 v10, v40, v4, 0
    v_dot2_f32_bf16 v11, v44, v4, 0
    v_add_f32_dpp v12, v12, v12 row_half_mirror row_mask:0xf bank_mask:0xf
    v_add_f32_dpp v13, v13, v13 row_half_mirror row_mask:0xf bank_mask:0xf
    v_dot2c_f32_bf16 v8, v33, v5
    v_dot2c_f32_bf16 v9, v37, v5
    v_dot2c_f32_bf16 v10, v41, v5
    v_dot2c_f32_bf16 v11, v45, v5
    v_add_f32_dpp v12, v12, v12 quad_perm:[1,0,3,2] row_mask:0xf bank_mask:0xf
    v_add_f32_dpp v13, v13, v13 quad_perm:[1,0,3,2] row_mask:0xf bank_mask:0xf
    v_dot2c_f32_bf16 v8, v34, v6
    v_dot2c_f32_bf16 v9, v38, v6
    v_dot2c_f32_bf16 v10, v42, v6
    v_dot2c_f32_bf16 v11, v46, v6
    v_add_f32_dpp v12, v12, v12 quad_perm:[2,3,0,1] row_mask:0xf bank_mask:0xf
    v_add_f32_dpp v13, v13, v13 quad_perm:[2,3,0,1] row_mask:0xf bank_mask:0xf
    v_dot2c_f32_bf16 v8, v35, v7
    v_dot2c_f32_bf16 v9, v39, v7
    v_dot2c_f32_bf16 v10, v43, v7
    v_dot2c_f32_bf16 v11, v47, v7
    s_waitcnt vmcnt(3)
    s_cmp_ge_u32 s48, 27
    s_cbranch_scc1 L_bo78
    s_waitcnt vmcnt(2)
L_bo78:
    s_add_u32 s98, s98, 28672
    s_cmp_eq_u32 s98, 258048
    s_cselect_b32 s98, 0, s98
    buffer_load_dwordx4 v[32:35], v1, s[40:43], s98 offen offset:0 nt
    v_add_f32_dpp v16, v8, v8 row_ror:8 row_mask:0xf bank_mask:0x3
    v_add_f32_dpp v16, v9, v9 row_ror:8 row_mask:0xf bank_mask:0xc
    v_add_f32_dpp v17, v10, v10 row_ror:8 row_mask:0xf bank_mask:0x3
    v_add_f32_dpp v17, v11, v11 row_ror:8 row_mask:0xf bank_mask:0xc
    v_dot2_f32_bf16 v8, v48, v4, 0
    v_dot2_f32_bf16 v9, v52, v4, 0
    v_dot2_f32_bf16 v10, v56, v4, 0
    v_dot2_f32_bf16 v11, v60, v4, 0
    v_add_f32_dpp v16, v16, v16 row_half_mirror row_mask:0xf bank_mask:0xf
    v_add_f32_dpp v17, v17, v17 row_half_mirror row_mask:0xf bank_mask:0xf
    v_dot2c_f32_bf16 v8, v49, v5
    v_dot2c_f32_bf16 v9, v53, v5
    v_dot2c_f32_bf16 v10, v57, v5
    v_dot2c_f32_bf16 v11, v61, v5
    v_add_f32_dpp v16, v16, v16 quad_perm:[1,0,3,2] row_mask:0xf bank_mask:0xf
    v_add_f32_dpp v17, v17, v17 quad_perm:[1,0,3,2] row_mask:0xf bank_mask:0xf
    v_dot2c_f32_bf16 v8, v50, v6
    v_dot2c_f32_bf16 v9, v54, v6
    v_dot2c_f32_bf16 v10, v58, v6
    v_dot2c_f32_bf16 v11, v62, v6
    v_add_f32_dpp v16, v16, v16 quad_perm:[2,3,0,1] row_mask:0xf bank_mask:0xf
    v_add_f32_dpp v17, v17, v17 quad_perm:[2,3,0,1] row_mask:0xf bank_mask:0xf
    v_dot2c_f32_bf16 v8, v51, v7
    v_dot2c_f32_bf16 v9, v55, v7
    v_dot2c_f32_bf16 v10, v59, v7
    v_dot2c_f32_bf16 v11, v63, v7
    v_add_f32_dpp v18, v8, v8 row_ror:8 row_mask:0xf bank_mask:0x3
    v_add_f32_dpp v18, v9, v9 row_ror:8 row_mask:0xf bank_mask:0xc
    v_add_f32_dpp v19, v10, v10 row_ror:8 row_mask:0xf bank_mask:0x3
    v_add_f32_dpp v19, v11, v11 row_ror:8 row_mask:0xf bank_mask:0xc
    v_dot2_f32_bf16 v8, v64, v4, 0
    v_dot2_f32_bf16 v9, v68, v4, 0
    v_dot2_f32_bf16 v10, v72, v4, 0
    v_dot2_f32_bf16 v11, v76, v4, 0
    v_add_f32_dpp v18, v18, v18 row_half_mirror row_mask:0xf bank_mask:0xf
    v_add_f32_dpp v19, v19, v19 row_half_mirror row_mask:0xf bank_mask:0xf
    v_dot2c_f32_bf16 v8, v65, v5
    v_dot2c_f32_bf16 v9, v69, v5
    v_dot2c_f32_bf16 v10, v73, v5
    v_dot2c_f32_bf16 v11, v77, v5
    v_add_f32_dpp v18, v18, v18 quad_perm:[1,0,3,2] row_mask:0xf bank_mask:0xf
    v_add_f32_dpp v19, v19, v19 quad_perm:[1,0,3,2] row_mask:0xf bank_mask:0xf
    v_dot2c_f32_bf16 v8, v66, v6
    v_dot2c_f32_bf16 v9, v70, v6
    v_mov_b32 v3, 99076
    ds_read_b32 v3, v3
    s_waitcnt vmcnt(3)
    s_cmp_ge_u32 s48, 28
    s_cbranch_scc1 L_bo79
    s_waitcnt vmcnt(2)
L_bo79:
    s_waitcnt lgkmcnt(0)
    v_readfirstlane_b32 s48, v3
    buffer_load_dwordx4 v[36:39], v1, s[40:43], s98 offen offset:1024 nt
    v_dot2c_f32_bf16 v10, v74, v6
    v_dot2c_f32_bf16 v11, v78, v6
    v_add_f32_dpp v18, v18, v18 quad_perm:[2,3,0,1] row_mask:0xf bank_mask:0xf
    v_add_f32_dpp v19, v19, v19 quad_perm:[2,3,0,1] row_mask:0xf bank_mask:0xf
    v_dot2c_f32_bf16 v8, v67, v7
    v_dot2c_f32_bf16 v9, v71, v7
    v_dot2c_f32_bf16 v10, v75, v7
    v_dot2c_f32_bf16 v11, v79, v7
    v_add_f32_dpp v20, v8, v8 row_ror:8 row_mask:0xf bank_mask:0x3
    v_add_f32_dpp v20, v9, v9 row_ror:8 row_mask:0xf bank_mask:0xc
    v_add_f32_dpp v21, v10, v10 row_ror:8 row_mask:0xf bank_mask:0x3
    v_add_f32_dpp v21, v11, v11 row_ror:8 row_mask:0xf bank_mask:0xc
    v_dot2_f32_bf16 v8, v80, v4, 0
    v_dot2_f32_bf16 v9, v84, v4, 0
    v_dot2_f32_bf16 v10, v88, v4, 0
    v_dot2_f32_bf16 v11, v92, v4, 0
    v_add_f32_dpp v20, v20, v20 row_half_mirror row_mask:0xf bank_mask:0xf
    v_add_f32_dpp v21, v21, v21 row_half_mirror row_mask:0xf bank_mask:0xf
    v_dot2c_f32_bf16 v8, v81, v5
    v_dot2c_f32_bf16 v9, v85, v5
    v_dot2c_f32_bf16 v10, v89, v5
    v_dot2c_f32_bf16 v11, v93, v5
    v_add_f32_dpp v20, v20, v20 quad_perm:[1,0,3,2] row_mask:0xf bank_mask:0xf
    v_add_f32_dpp v21, v21, v21 quad_perm:[1,0,3,2] row_mask:0xf bank_mask:0xf
    v_dot2c_f32_bf16 v8, v82, v6
    v_dot2c_f32_bf16 v9, v86, v6
    v_dot2c_f32_bf16 v10, v90, v6
    v_dot2c_f32_bf16 v11, v94, v6
    v_add_f32_dpp v20, v20, v20 quad_perm:[2,3,0,1] row_mask:0xf bank_mask:0xf
    v_add_f32_dpp v21, v21, v21 quad_perm:[2,3,0,1] row_mask:0xf bank_mask:0xf
    v_dot2c_f32_bf16 v8, v83, v7
    v_dot2c_f32_bf16 v9, v87, v7
    v_dot2c_f32_bf16 v10, v91, v7
    v_dot2c_f32_bf16 v11, v95, v7
    v_add_f32_dpp v22, v8, v8 row_ror:8 row_mask:0xf bank_mask:0x3
    v_add_f32_dpp v22, v9, v9 row_ror:8 row_mask:0xf bank_mask:0xc
    v_add_f32_dpp v23, v10, v10 row_ror:8 row_mask:0xf bank_mask:0x3
    v_add_f32_dpp v23, v11, v11 row_ror:8 row_mask:0xf bank_mask:0xc
    v_dot2_f32_bf16 v8, v96, v4, 0
    v_dot2_f32_bf16 v9, v100, v4, 0
    v_dot2_f32_bf16 v10, v104, v4, 0
    v_dot2_f32_bf16 v11, v108, v4, 0
    v_add_f32_dpp v22, v22, v22 row_half_mirror row_mask:0xf bank_mask:0xf
    v_add_f32_dpp v23, v23, v23 row_half_mirror row_mask:0xf bank_mask:0xf
    s_waitcnt vmcnt(3)
    s_cmp_ge_u32 s48, 16
    s_cbranch_scc1 L_bo80
    s_waitcnt vmcnt(2)
L_bo80:
    buffer_load_dwordx4 v[40:43], v1, s[40:43], s98 offen offset:2048 nt
    v_dot2c_f32_bf16 v8, v97, v5
    v_dot2c_f32_bf16 v9, v101, v5
    v_dot2c_f32_bf16 v10, v105, v5
    v_dot2c_f32_bf16 v11, v109, v5
    v_add_f32_dpp v22, v22, v22 quad_perm:[1,0,3,2] row_mask:0xf bank_mask:0xf
    v_add_f32_dpp v23, v23, v23 quad_perm:[1,0,3,2] row_mask:0xf bank_mask:0xf
    v_dot2c_f32_bf16 v8, v98, v6
    v_dot2c_f32_bf16 v9, v102, v6
    v_dot2c_f32_bf16 v10, v106, v6
    v_dot2c_f32_bf16 v11, v110, v6
    v_add_f32_dpp v22, v22, v22 quad_perm:[2,3,0,1] row_mask:0xf bank_mask:0xf
    v_add_f32_dpp v23, v23, v23 quad_perm:[2,3,0,1] row_mask:0xf bank_mask:0xf
    v_dot2c_f32_bf16 v8, v99, v7
    v_dot2c_f32_bf16 v9, v103, v7
    v_dot2c_f32_bf16 v10, v107, v7
    v_dot2c_f32_bf16 v11, v111, v7
    v_add_f32_dpp v24, v8, v8 row_ror:8 row_mask:0xf bank_mask:0x3
    v_add_f32_dpp v24, v9, v9 row_ror:8 row_mask:0xf bank_mask:0xc
    v_add_f32_dpp v25, v10, v10 row_ror:8 row_mask:0xf bank_mask:0x3
    v_add_f32_dpp v25, v11, v11 row_ror:8 row_mask:0xf bank_mask:0xc
    v_dot2_f32_bf16 v8, v112, v4, 0
    v_dot2_f32_bf16 v9, v116, v4, 0
    v_dot2_f32_bf16 v10, v120, v4, 0
    v_dot2_f32_bf16 v11, v124, v4, 0
    v_add_f32_dpp v24, v24, v24 row_half_mirror row_mask:0xf bank_mask:0xf
    v_add_f32_dpp v25, v25, v25 row_half_mirror row_mask:0xf bank_mask:0xf
    v_dot2c_f32_bf16 v8, v113, v5
    v_dot2c_f32_bf16 v9, v117, v5
    v_dot2c_f32_bf16 v10, v121, v5
    v_dot2c_f32_bf16 v11, v125, v5
    v_add_f32_dpp v24, v24, v24 quad_perm:[1,0,3,2] row_mask:0xf bank_mask:0xf
    v_add_f32_dpp v25, v25, v25 quad_perm:[1,0,3,2] row_mask:0xf bank_mask:0xf
    v_dot2c_f32_bf16 v8, v114, v6
    v_dot2c_f32_bf16 v9, v118, v6
    v_dot2c_f32_bf16 v10, v122, v6
    v_dot2c_f32_bf16 v11, v126, v6
    v_add_f32_dpp v24, v24, v24 quad_perm:[2,3,0,1] row_mask:0xf bank_mask:0xf
    v_add_f32_dpp v25, v25, v25 quad_perm:[2,3,0,1] row_mask:0xf bank_mask:0xf
    v_dot2c_f32_bf16 v8, v115, v7
    v_dot2c_f32_bf16 v9, v119, v7
    v_dot2c_f32_bf16 v10, v123, v7
    v_dot2c_f32_bf16 v11, v127, v7
    v_add_f32_dpp v26, v8, v8 row_ror:8 row_mask:0xf bank_mask:0x3
    v_add_f32_dpp v26, v9, v9 row_ror:8 row_mask:0xf bank_mask:0xc
    s_waitcnt vmcnt(3)
    s_cmp_ge_u32 s48, 17
    s_cbranch_scc1 L_bo81
    s_waitcnt vmcnt(2)
L_bo81:
    buffer_load_dwordx4 v[44:47], v1, s[40:43], s98 offen offset:3072 nt
    v_add_f32_dpp v27, v10, v10 row_ror:8 row_mask:0xf bank_mask:0x3
    v_add_f32_dpp v27, v11, v11 row_ror:8 row_mask:0xf bank_mask:0xc
    v_dot2_f32_bf16 v8, v128, v4, 0
    v_dot2_f32_bf16 v9, v132, v4, 0
    v_dot2_f32_bf16 v10, v136, v4, 0
    v_dot2_f32_bf16 v11, v140, v4, 0
    v_add_f32_dpp v26, v26, v26 row_half_mirror row_mask:0xf bank_mask:0xf
    v_add_f32_dpp v27, v27, v27 row_half_mirror row_mask:0xf bank_mask:0xf
    v_dot2c_f32_bf16 v8, v129, v5
    v_dot2c_f32_bf16 v9, v133, v5
    v_dot2c_f32_bf16 v10, v137, v5
    v_dot2c_f32_bf16 v11, v141, v5
    v_add_f32_dpp v26, v26, v26 quad_perm:[1,0,3,2] row_mask:0xf bank_mask:0xf
    v_add_f32_dpp v27, v27, v27 quad_perm:[1,0,3,2] row_mask:0xf bank_mask:0xf
    v_dot2c_f32_bf16 v8, v130, v6
    v_dot2c_f32_bf16 v9, v134, v6
    v_dot2c_f32_bf16 v10, v138, v6
    v_dot2c_f32_bf16 v11, v142, v6
    v_add_f32_dpp v26, v26, v26 quad_perm:[2,3,0,1] row_mask:0xf bank_mask:0xf
    v_add_f32_dpp v27, v27, v27 quad_perm:[2,3,0,1] row_mask:0xf bank_mask:0xf
    v_dot2c_f32_bf16 v8, v131, v7
    v_dot2c_f32_bf16 v9, v135, v7
    v_dot2c_f32_bf16 v10, v139, v7
    v_dot2c_f32_bf16 v11, v143, v7
    v_add_f32_dpp v28, v8, v8 row_ror:8 row_mask:0xf bank_mask:0x3
    v_add_f32_dpp v28, v9, v9 row_ror:8 row_mask:0xf bank_mask:0xc
    v_add_f32_dpp v29, v10, v10 row_ror:8 row_mask:0xf bank_mask:0x3
    v_add_f32_dpp v29, v11, v11 row_ror:8 row_mask:0xf bank_mask:0xc
    v_dot2_f32_bf16 v8, v144, v4, 0
    v_dot2_f32_bf16 v9, v148, v4, 0
    v_dot2_f32_bf16 v10, v152, v4, 0
    v_dot2_f32_bf16 v11, v156, v4, 0
    v_add_f32_dpp v28, v28, v28 row_half_mirror row_mask:0xf bank_mask:0xf
    v_add_f32_dpp v29, v29, v29 row_half_mirror row_mask:0xf bank_mask:0xf
    v_dot2c_f32_bf16 v8, v145, v5
    v_dot2c_f32_bf16 v9, v149, v5
    v_dot2c_f32_bf16 v10, v153, v5
    v_dot2c_f32_bf16 v11, v157, v5
    v_add_f32_dpp v28, v28, v28 quad_perm:[1,0,3,2] row_mask:0xf bank_mask:0xf
    v_add_f32_dpp v29, v29, v29 quad_perm:[1,0,3,2] row_mask:0xf bank_mask:0xf
    v_dot2c_f32_bf16 v8, v146, v6
    v_dot2c_f32_bf16 v9, v150, v6
    v_dot2c_f32_bf16 v10, v154, v6
    v_dot2c_f32_bf16 v11, v158, v6
    s_waitcnt vmcnt(3)
    s_cmp_ge_u32 s48, 19
    s_cbranch_scc1 L_bo82
    s_waitcnt vmcnt(2)
L_bo82:
    s_add_u32 s98, s98, 28672
    s_cmp_eq_u32 s98, 258048
    s_cselect_b32 s98, 0, s98
    buffer_load_dwordx4 v[48:51], v1, s[40:43], s98 offen offset:0 nt
    v_add_f32_dpp v28, v28, v28 quad_perm:[2,3,0,1] row_mask:0xf bank_mask:0xf
    v_add_f32_dpp v29, v29, v29 quad_perm:[2,3,0,1] row_mask:0xf bank_mask:0xf
    v_dot2c_f32_bf16 v8, v147, v7
    v_dot2c_f32_bf16 v9, v151, v7
    v_dot2c_f32_bf16 v10, v155, v7
    v_dot2c_f32_bf16 v11, v159, v7
    v_add_f32_dpp v30, v8, v8 row_ror:8 row_mask:0xf bank_mask:0x3
    v_add_f32_dpp v30, v9, v9 row_ror:8 row_mask:0xf bank_mask:0xc
    v_add_f32_dpp v31, v10, v10 row_ror:8 row_mask:0xf bank_mask:0x3
    v_add_f32_dpp v31, v11, v11 row_ror:8 row_mask:0xf bank_mask:0xc
    v_add_f32_dpp v30, v30, v30 row_half_mirror row_mask:0xf bank_mask:0xf
    s_nop 0
    v_add_f32_dpp v31, v31, v31 row_half_mirror row_mask:0xf bank_mask:0xf
    v_add_f32_dpp v30, v30, v30 quad_perm:[1,0,3,2] row_mask:0xf bank_mask:0xf
    s_nop 0
    v_add_f32_dpp v31, v31, v31 quad_perm:[1,0,3,2] row_mask:0xf bank_mask:0xf
    v_add_f32_dpp v30, v30, v30 quad_perm:[2,3,0,1] row_mask:0xf bank_mask:0xf
    s_nop 0
    v_add_f32_dpp v31, v31, v31 quad_perm:[2,3,0,1] row_mask:0xf bank_mask:0xf
    v_max3_f32 v8, v12, v13, v16
    v_max3_f32 v8, v8, v17, v18
    v_max3_f32 v8, v8, v19, v20
    v_max3_f32 v8, v8, v21, v22
    v_max3_f32 v8, v8, v23, v24
    v_max3_f32 v8, v8, v25, v26
    v_max3_f32 v8, v8, v27, v28
    v_max3_f32 v8, v8, v29, v30
    v_max_f32 v8, v8, v31
    s_mov_b32 s34, 0x3e0293ee
    s_nop 0
    v_max_f32_dpp v8, v8, v8 row_ror:8 row_mask:0xf bank_mask:0xf
    v_mov_b32 v9, v8
    s_nop 1
    v_permlane16_swap_b32 v8, v9
    v_max_f32 v8, v8, v9
    v_mov_b32 v9, v8
    s_nop 1
    v_permlane32_swap_b32 v8, v9
    v_max_f32 v8, v8, v9
    v_mul_f32 v8, s34, v8
    v_fma_f32 v12, v12, s34, -v8
    v_fma_f32 v13, v13, s34, -v8
    v_fma_f32 v16, v16, s34, -v8
    v_fma_f32 v17, v17, s34, -v8
    v_fma_f32 v18, v18, s34, -v8
    v_fma_f32 v19, v19, s34, -v8
    v_fma_f32 v20, v20, s34, -v8
    v_fma_f32 v21, v21, s34, -v8
    v_fma_f32 v22, v22, s34, -v8
    v_fma_f32 v23, v23, s34, -v8
    s_waitcnt vmcnt(3)
    s_cmp_ge_u32 s48, 20
    s_cbranch_scc1 L_bo83
    s_waitcnt vmcnt(2)
L_bo83:
    buffer_load_dwordx4 v[52:55], v1, s[40:43], s98 offen offset:1024 nt
    v_fma_f32 v24, v24, s34, -v8
    v_fma_f32 v25, v25, s34, -v8
    v_fma_f32 v26, v26, s34, -v8
    v_fma_f32 v27, v27, s34, -v8
    v_fma_f32 v28, v28, s34, -v8
    v_fma_f32 v29, v29, s34, -v8
    v_fma_f32 v30, v30, s34, -v8
    v_fma_f32 v31, v31, s34, -v8
    v_exp_f32 v12, v12
    v_exp_f32 v13, v13
    v_exp_f32 v16, v16
    v_exp_f32 v17, v17
    v_exp_f32 v18, v18
    v_exp_f32 v19, v19
    v_exp_f32 v20, v20
    v_exp_f32 v21, v21
    v_exp_f32 v22, v22
    v_exp_f32 v23, v23
    v_exp_f32 v24, v24
    v_exp_f32 v25, v25
    v_exp_f32 v26, v26
    v_exp_f32 v27, v27
    v_exp_f32 v28, v28
    v_exp_f32 v29, v29
    v_exp_f32 v30, v30
    v_exp_f32 v31, v31
    v_add_f32 v9, v12, v13
    v_add_f32 v9, v9, v16
    v_add_f32 v9, v9, v17
    v_add_f32 v9, v9, v18
    v_add_f32 v9, v9, v19
    v_add_f32 v9, v9, v20
    v_add_f32 v9, v9, v21
    v_add_f32 v9, v9, v22
    v_add_f32 v9, v9, v23
    v_add_f32 v9, v9, v24
    v_add_f32 v9, v9, v25
    v_add_f32 v9, v9, v26
    v_add_f32 v9, v9, v27
    v_add_f32 v9, v9, v28
    v_add_f32 v9, v9, v29
    v_add_f32 v9, v9, v30
    v_add_f32 v9, v9, v31
    v_and_b32 v10, 1, v0
    s_cmp_ge_u32 s48, 21
    s_cbranch_scc1 L_bo84
    s_waitcnt vmcnt(3)
L_bo84:
    buffer_load_dwordx4 v[56:59], v1, s[40:43], s98 offen offset:2048 nt
    v_lshlrev_b32 v10, 4, v10
    v_mov_b32 v11, 0xffff
    v_lshlrev_b32 v10, v10, v11
    v_bfe_u32 v11, v0, 1, 2
    v_cmp_eq_u32 vcc, 0, v11
    s_nop 1
    v_cndmask_b32 v144, 0, v10, vcc
    v_cmp_eq_u32 vcc, 1, v11
    s_nop 1
    v_cndmask_b32 v145, 0, v10, vcc
    v_cmp_eq_u32 vcc, 2, v11
    s_nop 1
    v_cndmask_b32 v146, 0, v10, vcc
    v_cmp_eq_u32 vcc, 3, v11
    s_nop 1
    v_cndmask_b32 v147, 0, v10, vcc
    v_add_f32_dpp v9, v9, v9 row_ror:8 row_mask:0xf bank_mask:0xf
    v_mov_b32 v10, v9
    s_nop 1
    v_permlane16_swap_b32 v9, v10
    v_add_f32 v9, v9, v10
    v_mov_b32 v10, v9
    s_nop 1
    v_permlane32_swap_b32 v9, v10
    v_add_f32 v9, v9, v10
    s_lshl_b32 s34, s3, 3
    s_add_u32 s34, s34, 98552
    v_mov_b32 v10, s34
    s_mov_b64 exec, 1
    ds_write_b64 v10, v[8:9]
    s_mov_b64 exec, -1
    s_lshl_b32 s34, s3, 10
    s_add_u32 s34, s34, 98304
    v_lshrrev_b32 v2, 4, v0
    v_and_b32 v11, 7, v0
    v_lshl_add_u32 v2, v2, 3, v11
    v_bfe_u32 v11, v0, 3, 1
    v_lshl_add_u32 v2, v11, 5, v2
    v_lshl_add_u32 v2, v2, 4, s34
    v_cvt_pk_bf16_f32 v10, v12, v12
    v_and_b32 v128, v10, v144
    v_and_b32 v129, v10, v145
    v_and_b32 v130, v10, v146
    v_and_b32 v131, v10, v147
    s_nop 1
    v_mfma_f32_16x16x32_bf16 v[148:151], v[160:163], v[128:131], 0
    v_mfma_f32_16x16x32_bf16 v[152:155], v[164:167], v[128:131], 0
    v_cvt_pk_bf16_f32 v10, v13, v13
    v_and_b32 v132, v10, v144
    v_and_b32 v133, v10, v145
    v_and_b32 v134, v10, v146
    v_and_b32 v135, v10, v147
    s_nop 1
    v_mfma_f32_16x16x32_bf16 v[148:151], v[168:171], v[132:135], v[148:151]
    s_waitcnt vmcnt(4)
    s_cmp_ge_u32 s48, 22
    s_cbranch_scc1 L_bo85
    s_waitcnt vmcnt(3)
L_bo85:
    buffer_load_dwordx4 v[60:63], v1, s[40:43], s98 offen offset:3072 nt
    v_mfma_f32_16x16x32_bf16 v[152:155], v[172:175], v[132:135], v[152:155]
    v_cvt_pk_bf16_f32 v10, v16, v16
    v_and_b32 v128, v10, v144
    v_and_b32 v129, v10, v145
    v_and_b32 v130, v10, v146
    v_and_b32 v131, v10, v147
    s_nop 1
    v_mfma_f32_16x16x32_bf16 v[148:151], v[176:179], v[128:131], v[148:151]
    v_mfma_f32_16x16x32_bf16 v[152:155], v[180:183], v[128:131], v[152:155]
    v_cvt_pk_bf16_f32 v10, v17, v17
    v_and_b32 v132, v10, v144
    v_and_b32 v133, v10, v145
    v_and_b32 v134, v10, v146
    v_and_b32 v135, v10, v147
    s_nop 1
    v_mfma_f32_16x16x32_bf16 v[148:151], v[184:187], v[132:135], v[148:151]
    v_mfma_f32_16x16x32_bf16 v[152:155], v[188:191], v[132:135], v[152:155]
    v_cvt_pk_bf16_f32 v10, v18, v18
    v_and_b32 v128, v10, v144
    v_and_b32 v129, v10, v145
    v_and_b32 v130, v10, v146
    v_and_b32 v131, v10, v147
    s_nop 1
    v_mfma_f32_16x16x32_bf16 v[148:151], v[192:195], v[128:131], v[148:151]
    v_mfma_f32_16x16x32_bf16 v[152:155], v[196:199], v[128:131], v[152:155]
    v_cvt_pk_bf16_f32 v10, v19, v19
    v_and_b32 v132, v10, v144
    v_and_b32 v133, v10, v145
    v_and_b32 v134, v10, v146
    v_and_b32 v135, v10, v147
    s_nop 1
    v_mfma_f32_16x16x32_bf16 v[148:151], v[200:203], v[132:135], v[148:151]
    v_mfma_f32_16x16x32_bf16 v[152:155], v[204:207], v[132:135], v[152:155]
    v_cvt_pk_bf16_f32 v10, v20, v20
    v_and_b32 v128, v10, v144
    v_and_b32 v129, v10, v145
    v_and_b32 v130, v10, v146
    v_and_b32 v131, v10, v147
    s_nop 1
    v_mfma_f32_16x16x32_bf16 v[148:151], v[208:211], v[128:131], v[148:151]
    v_mfma_f32_16x16x32_bf16 v[152:155], v[212:215], v[128:131], v[152:155]
    v_cvt_pk_bf16_f32 v10, v21, v21
    v_and_b32 v132, v10, v144
    v_and_b32 v133, v10, v145
    v_and_b32 v134, v10, v146
    v_and_b32 v135, v10, v147
    s_nop 1
    v_mfma_f32_16x16x32_bf16 v[148:151], v[216:219], v[132:135], v[148:151]
    v_mfma_f32_16x16x32_bf16 v[152:155], v[220:223], v[132:135], v[152:155]
    v_cvt_pk_bf16_f32 v10, v22, v22
    s_waitcnt vmcnt(4)
    s_cmp_ge_u32 s48, 23
    s_cbranch_scc1 L_bo86
    s_waitcnt vmcnt(3)
L_bo86:
    s_add_u32 s98, s98, 28672
    s_cmp_eq_u32 s98, 258048
    s_cselect_b32 s98, 0, s98
    buffer_load_dwordx4 v[64:67], v1, s[40:43], s98 offen offset:0 nt
    v_and_b32 v128, v10, v144
    v_and_b32 v129, v10, v145
    v_and_b32 v130, v10, v146
    v_and_b32 v131, v10, v147
    s_nop 1
    v_mfma_f32_16x16x32_bf16 v[148:151], v[224:227], v[128:131], v[148:151]
    v_mfma_f32_16x16x32_bf16 v[152:155], v[228:231], v[128:131], v[152:155]
    v_cvt_pk_bf16_f32 v10, v23, v23
    v_and_b32 v132, v10, v144
    v_and_b32 v133, v10, v145
    v_and_b32 v134, v10, v146
    v_and_b32 v135, v10, v147
    s_nop 1
    v_mfma_f32_16x16x32_bf16 v[148:151], v[232:235], v[132:135], v[148:151]
    v_mfma_f32_16x16x32_bf16 v[152:155], v[236:239], v[132:135], v[152:155]
    v_cvt_pk_bf16_f32 v10, v24, v24
    v_and_b32 v128, v10, v144
    v_and_b32 v129, v10, v145
    v_and_b32 v130, v10, v146
    v_and_b32 v131, v10, v147
    s_nop 1
    v_mfma_f32_16x16x32_bf16 v[148:151], v[240:243], v[128:131], v[148:151]
    v_mfma_f32_16x16x32_bf16 v[152:155], v[244:247], v[128:131], v[152:155]
    v_cvt_pk_bf16_f32 v10, v25, v25
    v_and_b32 v132, v10, v144
    v_and_b32 v133, v10, v145
    v_and_b32 v134, v10, v146
    v_and_b32 v135, v10, v147
    s_nop 1
    v_mfma_f32_16x16x32_bf16 v[148:151], v[248:251], v[132:135], v[148:151]
    v_mfma_f32_16x16x32_bf16 v[152:155], v[252:255], v[132:135], v[152:155]
    v_cvt_pk_bf16_f32 v10, v26, v26
    v_and_b32 v128, v10, v144
    v_and_b32 v129, v10, v145
    v_and_b32 v130, v10, v146
    v_and_b32 v131, v10, v147
    s_nop 1
    v_mfma_f32_16x16x32_bf16 v[148:151], v[32:35], v[128:131], v[148:151]
    v_mfma_f32_16x16x32_bf16 v[152:155], v[36:39], v[128:131], v[152:155]
    v_cvt_pk_bf16_f32 v10, v27, v27
    v_and_b32 v132, v10, v144
    v_and_b32 v133, v10, v145
    v_and_b32 v134, v10, v146
    v_and_b32 v135, v10, v147
    s_nop 1
    v_mfma_f32_16x16x32_bf16 v[148:151], v[40:43], v[132:135], v[148:151]
    v_mfma_f32_16x16x32_bf16 v[152:155], v[44:47], v[132:135], v[152:155]
    v_cvt_pk_bf16_f32 v10, v28, v28
    v_and_b32 v128, v10, v144
    v_and_b32 v129, v10, v145
    s_waitcnt vmcnt(4)
    s_cmp_ge_u32 s48, 24
    s_cbranch_scc1 L_bo87
    s_waitcnt vmcnt(3)
L_bo87:
    buffer_load_dwordx4 v[68:71], v1, s[40:43], s98 offen offset:1024 nt
    v_and_b32 v130, v10, v146
    v_and_b32 v131, v10, v147
    buffer_load_dwordx4 v[72:75], v1, s[40:43], s98 offen offset:2048 nt
    s_waitcnt vmcnt(5)
    buffer_load_dwordx4 v[76:79], v1, s[40:43], s98 offen offset:3072 nt
    s_barrier
    v_and_b32 v200, 3, v0
    v_bfe_u32 v201, v0, 2, 2
    v_lshrrev_b32 v202, 4, v0
    s_lshl_b32 s34, s3, 10
    s_add_u32 s34, s34, 122112
    v_mul_u32_u24 v203, 320, v201
    v_min_u32 v203, 704, v203
    v_lshl_add_u32 v203, v202, 6, v203
    v_lshl_add_u32 v203, v200, 4, v203
    v_add_u32 v203, s34, v203
    s_movk_i32 s48, 16384
    s_cmp_eq_u32 s63, 0
    s_cbranch_scc1 L_tp_wo
    s_cmp_eq_u32 s63, 1
    s_cbranch_scc1 L_tp_w1
    v_bfe_u32 v205, v0, 3, 2
    v_lshlrev_b32 v204, 3, v205
    v_lshrrev_b32 v205, 5, v0
    v_lshl_add_u32 v204, v205, 2, v204
    v_bfe_u32 v205, v0, 1, 2
    v_add_u32 v204, v204, v205
    v_and_b32 v205, 1, v0
    s_sub_u32 s49, s3, 1
    v_mul_u32_u24 v204, 1280, v204
    v_lshl_add_u32 v204, v205, 4, v204
    s_lshl_b32 s34, s62, 5
    s_mul_i32 s35, s49, 327680
    s_add_u32 s34, s34, s35
    v_add_u32 v204, s34, v204
    s_lshl_b32 s50, s49, 13
    s_add_u32 s50, s50, 40960
    v_lshl_add_u32 v205, v0, 3, s50
    s_lshl_b32 s34, s49, 8
    s_add_u32 s34, s34, s99
    s_and_b32 s35, s60, 1
    s_mul_i32 s35, s35, 917504
    s_add_u32 s34, s34, s35
    s_add_u32 s34, s34, 791552
    s_cmp_eq_u32 s49, 6
    s_cselect_b32 s35, 1, 3
    v_lshlrev_b32 v6, 6, v202
    v_lshl_add_u32 v6, v200, 4, v6
    v_add_u32 v6, s34, v6
    v_lshl_add_u32 v4, v201, 15, v6
    v_min_u32 v5, s35, v201
    v_lshl_add_u32 v5, v5, 15, v6
    v_mov_b32 v7, 99084
    s_lshl_b32 s40, s62, 1
    s_add_u32 s41, s40, 8
    s_add_u32 s42, s40, 2
    s_branch L_tp_e
L_tp_w1:
    v_and_b32 v205, 15, v0
    v_lshlrev_b32 v205, 4, v205
    s_and_b32 s49, s3, 3
    s_mul_i32 s34, s49, 1280
    s_add_u32 s34, s34, s99
    s_add_u32 s34, s34, 786432
    v_lshl_add_u32 v206, v202, 15, v205
    v_add_u32 v206, s34, v206
    s_mul_i32 s34, s49, 3840
    v_add_u32 v205, s34, v205
    s_branch L_tp_e
L_tp_wo:
    s_lshr_b32 s49, s3, 1
    s_lshl_b32 s49, s49, 15
    v_and_b32 v210, 7, v0
    s_mul_i32 s34, s60, 4096
    s_add_u32 s34, s34, s49
    s_add_u32 s34, s34, 1179904
    v_lshrrev_b32 v211, 3, v0
    v_mul_u32_u24 v205, 512, v211
    v_add_u32 v204, s34, v205
    s_lshl_b32 s35, s51, 7
    s_add_u32 s34, s34, s35
    s_sub_u32 s34, s34, 256
    v_lshl_add_u32 v205, v210, 4, v205
    v_add_u32 v205, s34, v205
    s_lshl_b32 s34, s3, 12
    s_add_u32 s34, s34, 40960
    v_lshrrev_b32 v206, 2, v0
    v_lshlrev_b32 v206, 6, v206
    v_lshl_add_u32 v206, v200, 3, v206
    v_add_u32 v206, s34, v206
    s_mul_i32 s34, s3, 1152
    s_add_u32 s34, s34, 107520
    v_mul_u32_u24 v207, 144, v211
    v_lshl_add_u32 v207, v210, 4, v207
    v_add_u32 v207, s34, v207
    v_mul_u32_u24 v208, 144, v210
    v_lshl_add_u32 v208, v202, 4, v208
    v_add_u32 v208, s34, v208
    v_mul_u32_u24 v212, 144, v211
    v_add_u32 v212, s34, v212
    v_mul_u32_u24 v213, 144, v210
    v_add_u32 v213, s34, v213
    v_and_b32 v211, 1, v211
    v_bfe_u32 v203, v0, 1, 2
    v_mul_u32_u24 v203, 144, v203
    v_and_b32 v214, 1, v0
    v_mul_u32_u24 v214, 576, v214
    v_lshl_add_u32 v214, v211, 6, v214
    v_lshl_add_u32 v214, v202, 4, v214
    s_add_u32 s34, s34, 14592
    v_add3_u32 v203, v203, v214, s34
    v_mov_b32 v210, 98816
    v_cmp_eq_u32 vcc, 0, v211
    s_nop 1
    v_cndmask_b32 v209, v208, v210, vcc
    v_cndmask_b32 v208, v210, v208, vcc
L_tp_e:
    v_mfma_f32_16x16x32_bf16 v[148:151], v[48:51], v[128:131], v[148:151]
    v_mfma_f32_16x16x32_bf16 v[152:155], v[52:55], v[128:131], v[152:155]
    v_cvt_pk_bf16_f32 v10, v29, v29
    v_and_b32 v132, v10, v144
    v_and_b32 v133, v10, v145
    v_and_b32 v134, v10, v146
    v_and_b32 v135, v10, v147
    s_waitcnt vmcnt(4)
    s_nop 0
    v_mfma_f32_16x16x32_bf16 v[148:151], v[56:59], v[132:135], v[148:151]
    v_mfma_f32_16x16x32_bf16 v[152:155], v[60:63], v[132:135], v[152:155]
    v_cvt_pk_bf16_f32 v10, v30, v30
    v_and_b32 v128, v10, v144
    v_and_b32 v129, v10, v145
    v_and_b32 v130, v10, v146
    v_and_b32 v131, v10, v147
    s_waitcnt vmcnt(2)
    s_nop 0
    v_mfma_f32_16x16x32_bf16 v[148:151], v[64:67], v[128:131], v[148:151]
    v_mfma_f32_16x16x32_bf16 v[152:155], v[68:71], v[128:131], v[152:155]
    v_cvt_pk_bf16_f32 v10, v31, v31
    v_and_b32 v132, v10, v144
    v_and_b32 v133, v10, v145
    v_and_b32 v134, v10, v146
    v_and_b32 v135, v10, v147
    s_waitcnt vmcnt(0)
    s_nop 0
    v_mfma_f32_16x16x32_bf16 v[148:151], v[72:75], v[132:135], v[148:151]
    v_mfma_f32_16x16x32_bf16 v[152:155], v[76:79], v[132:135], v[152:155]
    s_nop 7
    v_add_f32_dpp v148, v152, v148 row_ror:8 row_mask:0xf bank_mask:0xf
    v_add_f32_dpp v149, v153, v149 row_ror:8 row_mask:0xf bank_mask:0xf
    v_add_f32_dpp v150, v154, v150 row_ror:8 row_mask:0xf bank_mask:0xf
    v_add_f32_dpp v151, v155, v151 row_ror:8 row_mask:0xf bank_mask:0xf
    ds_write_b128 v2, v[148:151]
    s_waitcnt lgkmcnt(0)
    s_barrier
    s_cmp_eq_u32 s63, 0
    s_cbranch_scc1 L_t_wo
    s_cmp_eq_u32 s63, 2
    s_cbranch_scc1 L_t_w2
    s_cmp_eq_u32 s63, 3
    s_cbranch_scc1 L_fin
    s_barrier
L_r_w1:
    s_cmp_lt_u32 s3, 4
    s_cbranch_scc1 L_w1_ln
    s_and_b32 s49, s3, 3
    s_lshl_b32 s42, s49, 11
    s_add_u32 s42, s42, 40960
    s_bitcmp1_b32 s62, 0
    s_cbranch_scc1 L_rot1
    s_add_u32 m0, s42, 0
    s_add_u32 s34, s50, 0
    buffer_load_dwordx4 v15, s[52:55], s34 offen  lds
    s_add_u32 m0, s42, 1024
    s_add_u32 s34, s50, 884736
    buffer_load_dwordx4 v15, s[52:55], s34 offen  lds
    s_add_u32 m0, s42, 8192
    s_add_u32 s34, s50, 110592
    buffer_load_dwordx4 v15, s[52:55], s34 offen  lds
    s_add_u32 m0, s42, 9216
    s_add_u32 s34, s50, 995328
    buffer_load_dwordx4 v15, s[52:55], s34 offen  lds
    s_add_u32 m0, s42, 32768
    s_add_u32 s34, s51, 0
    buffer_load_dwordx4 v15, s[52:55], s34 offen  lds
    s_add_u32 m0, s42, 33792
    s_add_u32 s34, s51, 13824
    buffer_load_dwordx4 v15, s[52:55], s34 offen  lds
    s_add_u32 m0, s42, 16384
    s_add_u32 s34, s50, 221184
    buffer_load_dwordx4 v15, s[52:55], s34 offen  lds
    s_add_u32 m0, s42, 17408
    s_add_u32 s34, s50, 1105920
    buffer_load_dwordx4 v15, s[52:55], s34 offen  lds
    s_add_u32 m0, s42, 24576
    s_add_u32 s34, s50, 331776
    buffer_load_dwordx4 v15, s[52:55], s34 offen  lds
    s_add_u32 m0, s42, 25600
    s_add_u32 s34, s50, 1216512
    buffer_load_dwordx4 v15, s[52:55], s34 offen  lds
    s_branch L_rot2
L_rot1:
    s_add_u32 m0, s42, 16384
    s_add_u32 s34, s50, 221184
    buffer_load_dwordx4 v15, s[52:55], s34 offen  lds
    s_add_u32 m0, s42, 17408
    s_add_u32 s34, s50, 1105920
    buffer_load_dwordx4 v15, s[52:55], s34 offen  lds
    s_add_u32 m0, s42, 24576
    s_add_u32 s34, s50, 331776
    buffer_load_dwordx4 v15, s[52:55], s34 offen  lds
    s_add_u32 m0, s42, 25600
    s_add_u32 s34, s50, 1216512
    buffer_load_dwordx4 v15, s[52:55], s34 offen  lds
    s_add_u32 m0, s42, 32768
    s_add_u32 s34, s51, 0
    buffer_load_dwordx4 v15, s[52:55], s34 offen  lds
    s_add_u32 m0, s42, 33792
    s_add_u32 s34, s51, 13824
    buffer_load_dwordx4 v15, s[52:55], s34 offen  lds
    s_add_u32 m0, s42, 0
    s_add_u32 s34, s50, 0
    buffer_load_dwordx4 v15, s[52:55], s34 offen  lds
    s_add_u32 m0, s42, 1024
    s_add_u32 s34, s50, 884736
    buffer_load_dwordx4 v15, s[52:55], s34 offen  lds
    s_add_u32 m0, s42, 8192
    s_add_u32 s34, s50, 110592
    buffer_load_dwordx4 v15, s[52:55], s34 offen  lds
    s_add_u32 m0, s42, 9216
    s_add_u32 s34, s50, 995328
    buffer_load_dwordx4 v15, s[52:55], s34 offen  lds
L_rot2:
    v_lshrrev_b32 v3, 2, v0
    v_lshlrev_b32 v3, 6, v3
    v_lshl_add_u32 v3, v200, 3, v3
    v_add_u32 v3, s42, v3
    s_lshl_b32 s35, s49, 6
    s_add_u32 s35, s35, 116736
    v_mul_u32_u24 v4, 1344, v200
    v_lshl_add_u32 v4, v202, 4, v4
    v_add_u32 v4, s35, v4
    s_lshl_b32 s35, s49, 10
    s_sub_u32 s35, s35, 4096
    v_add_u32 v5, s35, v203
    v_and_b32 v6, 1, v201
    v_mul_u32_u24 v6, 5376, v6
    v_add_u32 v6, v6, v4
    v_subrev_u32 v6, 90112, v6
    v_subrev_u32 v7, 22784, v5
    s_waitcnt vmcnt(0)
    s_barrier
    ds_read_b64_tr_b16 v[32:33], v3 offset:0
    ds_read_b64_tr_b16 v[34:35], v3 offset:1024
    ds_read_b64_tr_b16 v[36:37], v3 offset:32
    ds_read_b64_tr_b16 v[38:39], v3 offset:1056
    ds_read_b64_tr_b16 v[40:41], v3 offset:8192
    ds_read_b64_tr_b16 v[42:43], v3 offset:9216
    ds_read_b64_tr_b16 v[44:45], v3 offset:8224
    ds_read_b64_tr_b16 v[46:47], v3 offset:9248
    ds_read_b64_tr_b16 v[48:49], v3 offset:16384
    ds_read_b64_tr_b16 v[50:51], v3 offset:17408
    ds_read_b64_tr_b16 v[52:53], v3 offset:16416
    ds_read_b64_tr_b16 v[54:55], v3 offset:17440
    s_waitcnt lgkmcnt(4)
    ds_read_b64_tr_b16 v[56:57], v3 offset:24576
    ds_read_b64_tr_b16 v[58:59], v3 offset:25600
    ds_read_b64_tr_b16 v[60:61], v3 offset:24608
    ds_read_b64_tr_b16 v[62:63], v3 offset:25632
    ds_read_b64_tr_b16 v[64:65], v3 offset:32768
    ds_read_b64_tr_b16 v[66:67], v3 offset:33792
    ds_read_b64_tr_b16 v[68:69], v3 offset:32800
    ds_read_b64_tr_b16 v[70:71], v3 offset:33824
    s_waitcnt lgkmcnt(0)
    ds_read_b128 v[140:143], v6 offset:0
    ds_read_b128 v[144:147], v6 offset:256
    ds_read_b128 v[148:151], v6 offset:512
    ds_read_b128 v[152:155], v6 offset:768
    ds_read_b128 v[156:159], v6 offset:1024
    s_waitcnt lgkmcnt(4)
    v_mfma_f32_16x16x32_bf16 v[20:23], v[32:35], v[140:143], 0
    v_mfma_f32_16x16x32_bf16 v[24:27], v[36:39], v[140:143], 0
    s_waitcnt lgkmcnt(3)
    v_mfma_f32_16x16x32_bf16 v[20:23], v[40:43], v[144:147], v[20:23]
    v_mfma_f32_16x16x32_bf16 v[24:27], v[44:47], v[144:147], v[24:27]
    s_waitcnt lgkmcnt(2)
    v_mfma_f32_16x16x32_bf16 v[20:23], v[48:51], v[148:151], v[20:23]
    v_mfma_f32_16x16x32_bf16 v[24:27], v[52:55], v[148:151], v[24:27]
    s_waitcnt lgkmcnt(1)
    v_mfma_f32_16x16x32_bf16 v[20:23], v[56:59], v[152:155], v[20:23]
    v_mfma_f32_16x16x32_bf16 v[24:27], v[60:63], v[152:155], v[24:27]
    s_waitcnt lgkmcnt(0)
    v_mfma_f32_16x16x32_bf16 v[20:23], v[64:67], v[156:159], v[20:23]
    v_mfma_f32_16x16x32_bf16 v[24:27], v[68:71], v[156:159], v[24:27]
    s_nop 6
    ds_write_b128 v7, v[20:23]
    ds_write_b128 v7, v[24:27] offset:1024
    s_waitcnt lgkmcnt(0)
    s_setprio 3
    s_barrier
    ds_read_b128 v[140:143], v4 offset:0
    ds_read_b128 v[144:147], v4 offset:256
    ds_read_b128 v[148:151], v4 offset:512
    ds_read_b128 v[152:155], v4 offset:768
    ds_read_b128 v[156:159], v4 offset:1024
    s_waitcnt lgkmcnt(4)
    v_mfma_f32_16x16x32_bf16 v[20:23], v[32:35], v[140:143], 0
    v_mfma_f32_16x16x32_bf16 v[24:27], v[36:39], v[140:143], 0
    s_waitcnt lgkmcnt(3)
    v_mfma_f32_16x16x32_bf16 v[20:23], v[40:43], v[144:147], v[20:23]
    v_mfma_f32_16x16x32_bf16 v[24:27], v[44:47], v[144:147], v[24:27]
    s_waitcnt lgkmcnt(2)
    v_mfma_f32_16x16x32_bf16 v[20:23], v[48:51], v[148:151], v[20:23]
    v_mfma_f32_16x16x32_bf16 v[24:27], v[52:55], v[148:151], v[24:27]
    s_waitcnt lgkmcnt(1)
    v_mfma_f32_16x16x32_bf16 v[20:23], v[56:59], v[152:155], v[20:23]
    v_mfma_f32_16x16x32_bf16 v[24:27], v[60:63], v[152:155], v[24:27]
    s_waitcnt lgkmcnt(0)
    v_mfma_f32_16x16x32_bf16 v[20:23], v[64:67], v[156:159], v[20:23]
    v_mfma_f32_16x16x32_bf16 v[24:27], v[68:71], v[156:159], v[24:27]
    s_nop 6
    ds_write_b128 v5, v[20:23]
    ds_write_b128 v5, v[24:27] offset:1024
    s_waitcnt lgkmcnt(0)
    s_barrier
    s_branch L_fin
L_w1_ln:
    s_setprio 1
    ds_read_b128 v[140:143], v205 offset:0
    ds_read_b128 v[144:147], v205 offset:256
    ds_read_b128 v[148:151], v205 offset:512
    ds_read_b128 v[152:155], v205 offset:768
    ds_read_b128 v[156:159], v205 offset:1024
    ds_read_b128 v[160:163], v205 offset:1280
    ds_read_b128 v[164:167], v205 offset:1536
    ds_read_b128 v[168:171], v205 offset:1792
    ds_read_b128 v[172:175], v205 offset:2048
    ds_read_b128 v[176:179], v205 offset:2304
    ds_read_b128 v[180:183], v205 offset:2560
    ds_read_b128 v[184:187], v205 offset:2816
    ds_read_b128 v[188:191], v205 offset:3072
    ds_read_b128 v[192:195], v205 offset:3328
    ds_read_b128 v[196:199], v205 offset:3584
    v_and_b32 v8, 1, v0
    v_lshlrev_b32 v8, 4, v8
    v_mov_b32 v9, 0xffff
    v_lshlrev_b32 v8, v8, v9
    v_bfe_u32 v9, v0, 1, 2
    v_cmp_eq_u32 vcc, 0, v9
    s_nop 1
    v_cndmask_b32 v16, 0, v8, vcc
    v_cmp_eq_u32 vcc, 1, v9
    s_nop 1
    v_cndmask_b32 v17, 0, v8, vcc
    v_cmp_eq_u32 vcc, 2, v9
    s_nop 1
    v_cndmask_b32 v18, 0, v8, vcc
    v_cmp_eq_u32 vcc, 3, v9
    s_nop 1
    v_cndmask_b32 v19, 0, v8, vcc
    v_bfe_u32 v8, v0, 3, 1
    v_cmp_eq_u32 vcc, 0, v8
    s_nop 1
    v_cndmask_b32 v20, 0, v16, vcc
    v_xor_b32 v24, v20, v16
    v_cndmask_b32 v21, 0, v17, vcc
    v_xor_b32 v25, v21, v17
    v_cndmask_b32 v22, 0, v18, vcc
    v_xor_b32 v26, v22, v18
    v_cndmask_b32 v23, 0, v19, vcc
    v_xor_b32 v27, v23, v19
    v_and_b32 v52, 0x3f803f80, v20
    v_and_b32 v60, 0x3e803e80, v20
    v_and_b32 v53, 0x3f803f80, v21
    v_and_b32 v61, 0x3e803e80, v21
    v_and_b32 v54, 0x3f803f80, v22
    v_and_b32 v62, 0x3e803e80, v22
    v_and_b32 v55, 0x3f803f80, v23
    v_and_b32 v63, 0x3e803e80, v23
    v_and_b32 v56, 0x3f803f80, v24
    v_and_b32 v64, 0x3e803e80, v24
    v_and_b32 v57, 0x3f803f80, v25
    v_and_b32 v65, 0x3e803e80, v25
    v_and_b32 v58, 0x3f803f80, v26
    v_and_b32 v66, 0x3e803e80, v26
    v_and_b32 v59, 0x3f803f80, v27
    v_and_b32 v67, 0x3e803e80, v27
    s_waitcnt lgkmcnt(0)
    v_mfma_f32_16x16x32_bf16 v[68:71], v[140:143], v[60:63], 0
    v_mfma_f32_16x16x32_bf16 v[68:71], v[144:147], v[64:67], v[68:71]
    v_mfma_f32_16x16x32_bf16 v[72:75], v[148:151], v[60:63], 0
    v_mfma_f32_16x16x32_bf16 v[72:75], v[152:155], v[64:67], v[72:75]
    v_mfma_f32_16x16x32_bf16 v[76:79], v[156:159], v[60:63], 0
    v_mfma_f32_16x16x32_bf16 v[116:119], v[160:163], v[60:63], 0
    v_mfma_f32_16x16x32_bf16 v[116:119], v[164:167], v[64:67], v[116:119]
    v_mfma_f32_16x16x32_bf16 v[120:123], v[168:171], v[60:63], 0
    v_mfma_f32_16x16x32_bf16 v[120:123], v[172:175], v[64:67], v[120:123]
    v_mfma_f32_16x16x32_bf16 v[124:127], v[176:179], v[60:63], 0
    v_mfma_f32_16x16x32_bf16 v[80:83], v[180:183], v[60:63], 1.0
    v_mfma_f32_16x16x32_bf16 v[80:83], v[184:187], v[64:67], v[80:83]
    v_mfma_f32_16x16x32_bf16 v[84:87], v[188:191], v[60:63], 1.0
    v_mfma_f32_16x16x32_bf16 v[84:87], v[192:195], v[64:67], v[84:87]
    v_mfma_f32_16x16x32_bf16 v[88:91], v[196:199], v[60:63], 1.0
    s_mul_i32 s34, s3, 1344
    s_add_u32 s34, s34, 116736
    v_lshl_add_u32 v7, v0, 4, s34
    v_lshlrev_b32 v8, 6, v202
    v_lshl_add_u32 v8, v200, 4, v8
    v_and_b32 v9, 1, v201
    v_lshl_add_u32 v8, v9, 3, v8
    v_add_u32 v8, s34, v8
    v_bfe_u32 v9, v0, 3, 1
    v_mul_u32_u24 v9, 6144, v9
    v_sub_u32 v8, v8, v9
    v_lshrrev_b32 v9, 5, v0
    v_lshlrev_b32 v9, 10, v9
    v_and_b32 v6, 1, v202
    v_lshl_add_u32 v9, v6, 7, v9
    v_bfe_u32 v6, v0, 1, 1
    v_lshl_add_u32 v9, v6, 6, v9
    v_lshl_add_u32 v9, v201, 4, v9
    v_and_b32 v6, 1, v0
    v_lshl_add_u32 v9, v6, 3, v9
    v_add_u32 v9, 122112, v9
    s_lshr_b32 s34, s62, 3
    s_lshl_b32 s34, s34, 8
    s_and_b32 s49, s62, 3
    s_lshl_b32 s49, s49, 15
    s_add_u32 s34, s34, s49
    s_bfe_u32 s49, s62, 0x10002
    s_lshl_b32 s49, s49, 14
    s_add_u32 s34, s34, s49
    s_add_u32 s34, s34, 791552
    v_lshl_add_u32 v5, v0, 2, s34
    v_add_u32 v4, 917504, v5
    s_bfe_u32 s49, s60, 0x10002
    s_lshl_b32 s49, s49, 13
    s_xor_b32 s53, s99, s49
    s_xor_b32 s52, s53, 8192
    v_subrev_u32 v10, 90112, v7
    v_subrev_u32 v11, 90112, v8
    v_cvt_pk_bf16_f32 v32, v116, v117
    v_cvt_pk_bf16_f32 v33, v118, v119
    v_cvt_pk_bf16_f32 v34, v120, v121
    v_cvt_pk_bf16_f32 v35, v122, v123
    v_cvt_pk_bf16_f32 v36, v124, v125
    v_cvt_pk_bf16_f32 v37, v126, v127
    s_mov_b32 exec_lo, 0x00ff00ff
    s_mov_b32 exec_hi, 0x00ff00ff
    ds_write_b64 v11, v[36:37] offset:6400
    s_mov_b64 exec, -1
    ds_write_b128 v10, v[32:35] offset:5376
    v_cvt_pk_bf16_f32 v20, v80, v81
    v_cvt_pk_bf16_f32 v21, v82, v83
    v_cvt_pk_bf16_f32 v22, v84, v85
    v_cvt_pk_bf16_f32 v23, v86, v87
    v_cvt_pk_bf16_f32 v24, v88, v89
    v_cvt_pk_bf16_f32 v25, v90, v91
    ds_write_b128 v10, v[20:23]
    ds_write_b64 v11, v[24:25] offset:1024
    v_lshlrev_b32 v80, 16, v20
    v_and_b32 v81, 0xffff0000, v20
    v_lshlrev_b32 v82, 16, v21
    v_and_b32 v83, 0xffff0000, v21
    v_lshlrev_b32 v84, 16, v22
    v_and_b32 v85, 0xffff0000, v22
    v_lshlrev_b32 v86, 16, v23
    v_and_b32 v87, 0xffff0000, v23
    v_lshlrev_b32 v88, 16, v24
    v_and_b32 v89, 0xffff0000, v24
    v_lshlrev_b32 v90, 16, v25
    v_and_b32 v91, 0xffff0000, v25
    v_subrev_u32 v11, 22784, v9
    s_lshl_b32 s34, s3, 3
    s_add_u32 s34, s34, 99136
    v_mov_b32 v12, s34
    v_lshlrev_b32 v13, 3, v201
    v_add_u32 v13, 99136, v13
    s_mov_b32 s54, 0
    s_brev_b32 s55, 1
    s_waitcnt lgkmcnt(0)
    s_barrier
    s_mov_b32 s35, 0
    s_mov_b64 s[40:41], -1
    s_mov_b64 s[42:43], -1
L_pb:
    s_mov_b64 exec, s[40:41]
    s_cbranch_execz L_pbs0
    buffer_load_dwordx4 v[140:143], v206, s[44:47], 0 offen offset:0 sc1
    buffer_load_dwordx4 v[148:151], v206, s[44:47], 0 offen offset:256 sc1
    buffer_load_dwordx4 v[156:159], v206, s[44:47], 0 offen offset:512 sc1
    buffer_load_dwordx4 v[164:167], v206, s[44:47], 0 offen offset:768 sc1
    buffer_load_dwordx4 v[172:175], v206, s[44:47], 0 offen offset:1024 sc1
L_pbs0:
    s_mov_b64 exec, s[42:43]
    s_cbranch_execz L_pbs1
    buffer_load_dwordx4 v[144:147], v206, s[44:47], s48 offen offset:0 sc1
    buffer_load_dwordx4 v[152:155], v206, s[44:47], s48 offen offset:256 sc1
    buffer_load_dwordx4 v[160:163], v206, s[44:47], s48 offen offset:512 sc1
    buffer_load_dwordx4 v[168:171], v206, s[44:47], s48 offen offset:768 sc1
    buffer_load_dwordx4 v[176:179], v206, s[44:47], s48 offen offset:1024 sc1
L_pbs1:
    s_mov_b64 exec, -1
    s_add_u32 s35, s35, 1
    s_waitcnt vmcnt(0)
    v_mfma_f32_16x16x32_bf16 v[128:131], v[140:143], v[52:55], v[68:71]
    v_max3_u32 v28, v140, v141, v142
    v_max3_u32 v29, v144, v145, v146
    v_mfma_f32_16x16x32_bf16 v[128:131], v[144:147], v[52:55], v[128:131]
    v_max3_u32 v28, v28, v143, v148
    v_max3_u32 v29, v29, v147, v152
    v_mfma_f32_16x16x32_bf16 v[128:131], v[148:151], v[56:59], v[128:131]
    v_max3_u32 v28, v28, v149, v150
    v_max3_u32 v29, v29, v153, v154
    v_mfma_f32_16x16x32_bf16 v[128:131], v[152:155], v[56:59], v[128:131]
    v_max3_u32 v28, v28, v151, v156
    v_max3_u32 v29, v29, v155, v160
    v_mfma_f32_16x16x32_bf16 v[132:135], v[156:159], v[52:55], v[72:75]
    v_max3_u32 v28, v28, v157, v158
    v_max3_u32 v29, v29, v161, v162
    v_mfma_f32_16x16x32_bf16 v[132:135], v[160:163], v[52:55], v[132:135]
    v_max3_u32 v28, v28, v159, v164
    v_max3_u32 v29, v29, v163, v168
    v_mfma_f32_16x16x32_bf16 v[132:135], v[164:167], v[56:59], v[132:135]
    v_max3_u32 v28, v28, v165, v166
    v_max3_u32 v29, v29, v169, v170
    v_mfma_f32_16x16x32_bf16 v[132:135], v[168:171], v[56:59], v[132:135]
    v_max3_u32 v28, v28, v167, v172
    v_max3_u32 v29, v29, v171, v176
    v_mfma_f32_16x16x32_bf16 v[136:139], v[172:175], v[52:55], v[76:79]
    v_max3_u32 v28, v28, v173, v174
    v_max3_u32 v29, v29, v177, v178
    v_mfma_f32_16x16x32_bf16 v[136:139], v[176:179], v[52:55], v[136:139]
    v_max_u32 v28, v28, v175
    v_max_u32 v29, v29, v179
    v_cmp_eq_u32 s[40:41], -1, v28
    v_cmp_eq_u32 s[42:43], -1, v29
    s_nop 0
    s_or_b64 vcc, s[40:41], s[42:43]
    s_cbranch_scc0 L_pbd
    s_cmp_lg_u32 s35, 64
    s_cbranch_scc1 L_tmo88
    s_mov_b64 exec, -1
    v_lshlrev_b32 v243, 4, v0
    v_add_u32 v243, 131328, v243
    ds_read_b96 v[240:242], v243
    s_waitcnt lgkmcnt(0)
    buffer_store_dword v240, v242, s[44:47], 0 offen sc1
    buffer_store_dword v241, v242, s[44:47], 0 offen offset:256 sc1
L_tmo88:
    s_cmp_lt_u32 s35, 60000
    s_cbranch_scc1 L_pb
L_pbd:
    v_pk_mul_f32 v[32:33], v[128:129], v[80:81]
    v_pk_mul_f32 v[34:35], v[130:131], v[82:83]
    v_pk_mul_f32 v[36:37], v[132:133], v[84:85]
    v_pk_mul_f32 v[38:39], v[134:135], v[86:87]
    v_cvt_pk_bf16_f32 v24, v32, v33
    v_cvt_pk_bf16_f32 v25, v34, v35
    v_cvt_pk_bf16_f32 v26, v36, v37
    v_cvt_pk_bf16_f32 v27, v38, v39
    ds_write_b128 v7, v[24:27]
    v_pk_mul_f32 v[40:41], v[136:137], v[88:89]
    v_pk_mul_f32 v[42:43], v[138:139], v[90:91]
    v_cvt_pk_bf16_f32 v28, v40, v41
    v_cvt_pk_bf16_f32 v29, v42, v43
    ds_write_b64 v8, v[28:29] offset:1024
    v_pk_add_f32 v[20:21], v[128:129], v[130:131]
    v_pk_mul_f32 v[22:23], v[128:129], v[128:129]
    v_pk_add_f32 v[20:21], v[20:21], v[132:133]
    v_pk_fma_f32 v[22:23], v[130:131], v[130:131], v[22:23]
    v_pk_add_f32 v[20:21], v[20:21], v[134:135]
    v_pk_fma_f32 v[22:23], v[132:133], v[132:133], v[22:23]
    v_pk_add_f32 v[20:21], v[20:21], v[136:137]
    v_pk_fma_f32 v[22:23], v[134:135], v[134:135], v[22:23]
    v_pk_add_f32 v[20:21], v[20:21], v[138:139]
    v_pk_fma_f32 v[22:23], v[136:137], v[136:137], v[22:23]
    v_pk_fma_f32 v[22:23], v[138:139], v[138:139], v[22:23]
    s_waitcnt lgkmcnt(0)
    s_barrier
    v_add_f32 v20, v20, v21
    v_add_f32 v21, v22, v23
    s_nop 0
    v_add_f32_dpp v20, v20, v20 row_ror:8 row_mask:0xf bank_mask:0xf
    v_add_f32_dpp v21, v21, v21 row_ror:8 row_mask:0xf bank_mask:0xf
    s_nop 0
    v_add_f32_dpp v20, v20, v20 row_ror:4 row_mask:0xf bank_mask:0xf
    v_add_f32_dpp v21, v21, v21 row_ror:4 row_mask:0xf bank_mask:0xf
    s_nop 0
    v_add_f32_dpp v20, v20, v20 row_ror:2 row_mask:0xf bank_mask:0xf
    v_add_f32_dpp v21, v21, v21 row_ror:2 row_mask:0xf bank_mask:0xf
    s_nop 0
    v_add_f32_dpp v20, v20, v20 row_ror:1 row_mask:0xf bank_mask:0xf
    v_add_f32_dpp v21, v21, v21 row_ror:1 row_mask:0xf bank_mask:0xf
    s_nop 0
    v_add_f32_dpp v20, v20, v20 row_bcast:15 row_mask:0xa bank_mask:0xf
    v_add_f32_dpp v21, v21, v21 row_bcast:15 row_mask:0xa bank_mask:0xf
    s_nop 0
    v_add_f32_dpp v20, v20, v20 row_bcast:31 row_mask:0xc bank_mask:0xf
    v_add_f32_dpp v21, v21, v21 row_bcast:31 row_mask:0xc bank_mask:0xf
    v_mul_f32 v22, 0x3acccccd, v20
    v_mul_f32 v21, 0x3acccccd, v21
    v_fma_f32 v21, -v22, v22, v21
    v_max_f32 v21, 0, v21
    v_add_f32 v21, 0x3727c5ac, v21
    v_rsq_f32 v20, v21
    s_nop 0
    v_mul_f32_e64 v21, -v22, v20
    s_mov_b64 exec, s[54:55]
    ds_write_b64 v12, v[20:21]
    s_mov_b64 exec, -1
    s_cmp_lg_u32 s3, 0
    s_cbranch_scc1 L_w1_x
    ds_read_b64 v[32:33], v11 offset:0
    ds_read_b64 v[40:41], v11 offset:320
    ds_read_b64 v[34:35], v11 offset:2048
    ds_read_b64 v[42:43], v11 offset:2368
    ds_read_b64 v[36:37], v11 offset:4096
    ds_read_b64 v[44:45], v11 offset:4416
    ds_read_b64 v[38:39], v11 offset:6144
    ds_read_b64 v[46:47], v11 offset:6464
    s_mov_b32 s34, 0xbdd2d3e8
    v_mov_b32 v10, 0xc0135761
    s_waitcnt lgkmcnt(8)
    s_barrier
    ds_read_b64 v[28:29], v13
    ds_read_b64 v[20:21], v9 offset:0
    ds_read_b64 v[22:23], v9 offset:2048
    ds_read_b64 v[24:25], v9 offset:4096
    ds_read_b64 v[26:27], v9 offset:6144
    s_waitcnt lgkmcnt(5)
    v_pk_add_f32 v[100:101], v[100:101], v[40:41]
    v_pk_add_f32 v[100:101], v[100:101], v[42:43]
    v_pk_add_f32 v[32:33], v[32:33], v[34:35]
    v_pk_add_f32 v[100:101], v[100:101], v[44:45]
    v_pk_add_f32 v[32:33], v[32:33], v[36:37]
    v_pk_add_f32 v[100:101], v[100:101], v[46:47]
    v_pk_add_f32 v[32:33], v[32:33], v[38:39]
    s_waitcnt lgkmcnt(4)
    v_pk_fma_f32 v[100:101], v[32:33], v[28:29], v[100:101] op_sel:[0,1,0] op_sel_hi:[1,1,1]
    s_waitcnt lgkmcnt(3)
    v_pk_fma_f32 v[100:101], v[20:21], v[28:29], v[100:101] op_sel_hi:[1,0,1]
    s_waitcnt lgkmcnt(2)
    v_pk_fma_f32 v[100:101], v[22:23], v[28:29], v[100:101] op_sel_hi:[1,0,1]
    s_waitcnt lgkmcnt(1)
    v_pk_fma_f32 v[100:101], v[24:25], v[28:29], v[100:101] op_sel_hi:[1,0,1]
    s_waitcnt lgkmcnt(0)
    v_pk_fma_f32 v[100:101], v[26:27], v[28:29], v[100:101] op_sel_hi:[1,0,1]
    v_pk_mul_f32 v[20:21], v[100:101], v[100:101]
    v_fma_f32 v20, v20, s34, v10
    v_fma_f32 v21, v21, s34, v10
    v_pk_mul_f32 v[20:21], v[20:21], v[100:101]
    v_exp_f32 v20, v20
    v_exp_f32 v21, v21
    v_add_f32 v20, 1.0, v20
    v_add_f32 v21, 1.0, v21
    v_rcp_f32 v20, v20
    v_rcp_f32 v21, v21
    s_nop 0
    v_pk_mul_f32 v[20:21], v[20:21], v[100:101]
    v_cvt_pk_bf16_f32 v20, v20, v21
    v_min_u32 v20, -2, v20
    buffer_store_dword v20, v5, s[44:47], s52 offen sc1
    buffer_store_dword v20, v4, s[44:47], s52 offen sc1
    buffer_store_dword v20, v5, s[44:47], s53 offen sc1
    buffer_store_dword v20, v4, s[44:47], s53 offen sc1
    s_branch L_fin
L_w1_x:
    s_waitcnt lgkmcnt(0)
    s_barrier
    s_branch L_fin
L_t_w2:
    s_barrier
L_w2_dma:
    s_and_b32 s34, s40, 7
    s_lshl_b32 s35, s34, 10
    s_add_u32 m0, s50, s35
    s_mul_i32 s34, s34, 40960
    buffer_load_dwordx4 v204, s[52:55], s34 offen  lds
    s_add_u32 s40, s40, 1
    s_cmp_lg_u32 s40, s42
    s_cbranch_scc1 L_w2_nw
L_w2_nw:
    s_cmp_lt_u32 s40, s41
    s_cbranch_scc1 L_w2_dma
    ds_read_b32 v8, v7
    s_waitcnt lgkmcnt(0)
    v_cmp_eq_u32 vcc, 0, v8
    s_cbranch_vccnz L_w2_slow
    s_mov_b32 s35, 0
    buffer_load_dwordx4 v[64:67], v4, s[44:47], 0 offen sc1
    buffer_load_dwordx4 v[68:71], v5, s[44:47], s48 offen sc1
    s_waitcnt vmcnt(2)
    ds_read_b64_tr_b16 v[32:33], v205 offset:0
    ds_read_b64_tr_b16 v[34:35], v205 offset:512
    ds_read_b64_tr_b16 v[36:37], v205 offset:1024
    ds_read_b64_tr_b16 v[38:39], v205 offset:1536
    ds_read_b64_tr_b16 v[40:41], v205 offset:2048
    ds_read_b64_tr_b16 v[42:43], v205 offset:2560
    ds_read_b64_tr_b16 v[44:45], v205 offset:3072
    ds_read_b64_tr_b16 v[46:47], v205 offset:3584
    s_waitcnt lgkmcnt(0)
    ds_read_b64_tr_b16 v[48:49], v205 offset:4096
    ds_read_b64_tr_b16 v[50:51], v205 offset:4608
    ds_read_b64_tr_b16 v[52:53], v205 offset:5120
    ds_read_b64_tr_b16 v[54:55], v205 offset:5632
    ds_read_b64_tr_b16 v[56:57], v205 offset:6144
    ds_read_b64_tr_b16 v[58:59], v205 offset:6656
    ds_read_b64_tr_b16 v[60:61], v205 offset:7168
    ds_read_b64_tr_b16 v[62:63], v205 offset:7680
    s_waitcnt lgkmcnt(0)
    s_branch L_w2_mid
L_w2_slow:
    s_waitcnt vmcnt(0)
    ds_read_b64_tr_b16 v[32:33], v205 offset:0
    ds_read_b64_tr_b16 v[34:35], v205 offset:512
    ds_read_b64_tr_b16 v[36:37], v205 offset:1024
    ds_read_b64_tr_b16 v[38:39], v205 offset:1536
    ds_read_b64_tr_b16 v[40:41], v205 offset:2048
    ds_read_b64_tr_b16 v[42:43], v205 offset:2560
    ds_read_b64_tr_b16 v[44:45], v205 offset:3072
    ds_read_b64_tr_b16 v[46:47], v205 offset:3584
    s_waitcnt lgkmcnt(0)
    ds_read_b64_tr_b16 v[48:49], v205 offset:4096
    ds_read_b64_tr_b16 v[50:51], v205 offset:4608
    ds_read_b64_tr_b16 v[52:53], v205 offset:5120
    ds_read_b64_tr_b16 v[54:55], v205 offset:5632
    ds_read_b64_tr_b16 v[56:57], v205 offset:6144
    ds_read_b64_tr_b16 v[58:59], v205 offset:6656
    ds_read_b64_tr_b16 v[60:61], v205 offset:7168
    ds_read_b64_tr_b16 v[62:63], v205 offset:7680
    s_waitcnt lgkmcnt(0)
    s_mov_b32 s35, 0
L_poll89:
    ds_read_b32 v8, v7
    s_add_u32 s35, s35, 1
    s_waitcnt lgkmcnt(0)
    v_cmp_eq_u32 vcc, 0, v8
    s_cbranch_vccz L_done90
    s_sleep 1
    s_cmp_lt_u32 s35, 60000
    s_cbranch_scc1 L_poll89
L_done90:
    s_mov_b32 s35, 0
L_poll92:
    buffer_load_dwordx4 v[64:67], v4, s[44:47], 0 offen sc1
    buffer_load_dwordx4 v[68:71], v5, s[44:47], s48 offen sc1
L_w2_mid:
    s_add_u32 s35, s35, 1
    s_waitcnt vmcnt(0)
    v_max3_u32 v28, v64, v65, v66
    v_max3_u32 v28, v28, v67, v68
    v_max3_u32 v28, v28, v69, v70
    v_max_u32 v28, v28, v71
    v_cmp_eq_u32 vcc, -1, v28
    s_cbranch_vccz L_done93
    s_cmp_lg_u32 s35, 64
    s_cbranch_scc1 L_tmo95
    s_mov_b64 exec, -1
    v_lshlrev_b32 v243, 4, v0
    v_add_u32 v243, 131328, v243
    ds_read_b96 v[240:242], v243
    s_waitcnt lgkmcnt(0)
    buffer_store_dword v240, v242, s[44:47], 0 offen sc1
    buffer_store_dword v241, v242, s[44:47], 0 offen offset:256 sc1
L_tmo95:
    s_cmp_lt_u32 s35, 60000
    s_cbranch_scc1 L_poll92
L_done93:
    v_mfma_f32_16x16x32_bf16 v[80:83], v[32:35], v[64:67], 0
    v_mfma_f32_16x16x32_bf16 v[80:83], v[48:51], v[68:71], v[80:83]
    v_mfma_f32_16x16x32_bf16 v[84:87], v[36:39], v[64:67], 0
    v_mfma_f32_16x16x32_bf16 v[84:87], v[52:55], v[68:71], v[84:87]
    v_mfma_f32_16x16x32_bf16 v[88:91], v[40:43], v[64:67], 0
    v_mfma_f32_16x16x32_bf16 v[88:91], v[56:59], v[68:71], v[88:91]
    v_mfma_f32_16x16x32_bf16 v[92:95], v[44:47], v[64:67], 0
    v_mfma_f32_16x16x32_bf16 v[92:95], v[60:63], v[68:71], v[92:95]
    s_nop 3
    v_add_f32_dpp v80, v84, v80 row_shl:4 row_mask:0xf bank_mask:0x1
    v_add_f32_dpp v81, v85, v81 row_shl:4 row_mask:0xf bank_mask:0x1
    v_add_f32_dpp v82, v86, v82 row_shl:4 row_mask:0xf bank_mask:0x1
    v_add_f32_dpp v83, v87, v83 row_shl:4 row_mask:0xf bank_mask:0x1
    v_add_f32_dpp v80, v88, v80 row_shl:8 row_mask:0xf bank_mask:0x1
    v_add_f32_dpp v81, v89, v81 row_shl:8 row_mask:0xf bank_mask:0x1
    v_add_f32_dpp v82, v90, v82 row_shl:8 row_mask:0xf bank_mask:0x1
    v_add_f32_dpp v83, v91, v83 row_shl:8 row_mask:0xf bank_mask:0x1
    v_add_f32_dpp v80, v92, v80 row_shl:12 row_mask:0xf bank_mask:0x1
    v_add_f32_dpp v81, v93, v81 row_shl:12 row_mask:0xf bank_mask:0x1
    v_add_f32_dpp v82, v94, v82 row_shl:12 row_mask:0xf bank_mask:0x1
    v_add_f32_dpp v83, v95, v83 row_shl:12 row_mask:0xf bank_mask:0x1
    ds_write_b128 v203, v[80:83]
    s_waitcnt lgkmcnt(0)
    s_barrier
    s_branch L_fin
L_w2_red:
    s_mov_b32 s35, 0
L_poll96:
    buffer_load_dwordx2 v[20:21], v204, s[44:47], 0 offen sc1
    buffer_load_dwordx2 v[22:23], v204, s[44:47], s48 offen sc1
    s_add_u32 s35, s35, 1
    s_waitcnt vmcnt(0)
    v_max3_u32 v28, v20, v21, v22
    v_max_u32 v28, v28, v23
    v_cmp_eq_u32 vcc, -1, v28
    s_cbranch_vccz L_done97
    s_cmp_lg_u32 s35, 21
    s_cbranch_scc1 L_tmo99
    s_mov_b64 exec, -1
    v_lshlrev_b32 v243, 4, v0
    v_add_u32 v243, 131328, v243
    ds_read_b96 v[240:242], v243
    s_waitcnt lgkmcnt(0)
    buffer_store_dword v240, v242, s[44:47], 0 offen sc1
    buffer_store_dword v241, v242, s[44:47], 0 offen offset:256 sc1
L_tmo99:
    s_sleep 6
    s_cmp_lt_u32 s35, 60000
    s_cbranch_scc1 L_poll96
L_done97:
    v_mov_b32 v7, 99084
    ds_write_b32 v7, v7
    v_lshlrev_b32 v44, 16, v20
    v_and_b32 v45, 0xffff0000, v20
    v_lshlrev_b32 v46, 16, v21
    v_and_b32 v47, 0xffff0000, v21
    v_lshlrev_b32 v48, 16, v22
    v_and_b32 v49, 0xffff0000, v22
    v_lshlrev_b32 v50, 16, v23
    v_and_b32 v51, 0xffff0000, v23
    v_add_f32 v108, v108, v44
    v_add_f32 v109, v109, v45
    v_add_f32 v110, v110, v46
    v_add_f32 v111, v111, v47
    v_add_f32 v108, v108, v48
    v_add_f32 v109, v109, v49
    v_add_f32 v110, v110, v50
    v_add_f32 v111, v111, v51
    s_mov_b32 s36, s28
    s_mov_b32 s37, s29
    s_movk_i32 s38, 5120
    v_add_f32_dpp v108, v108, v108 row_ror:4 row_mask:0xf bank_mask:0xf
    v_add_f32_dpp v109, v109, v109 row_ror:4 row_mask:0xf bank_mask:0xf
    v_add_f32_dpp v110, v110, v110 row_ror:4 row_mask:0xf bank_mask:0xf
    v_add_f32_dpp v111, v111, v111 row_ror:4 row_mask:0xf bank_mask:0xf
    v_add_f32_dpp v108, v108, v108 row_ror:8 row_mask:0xf bank_mask:0xf
    v_add_f32_dpp v109, v109, v109 row_ror:8 row_mask:0xf bank_mask:0xf
    v_add_f32_dpp v110, v110, v110 row_ror:8 row_mask:0xf bank_mask:0xf
    v_add_f32_dpp v111, v111, v111 row_ror:8 row_mask:0xf bank_mask:0xf
    v_mov_b32_dpp v108, v104 quad_perm:[0,1,2,3] row_mask:0xf bank_mask:0x2
    v_mov_b32_dpp v109, v105 quad_perm:[0,1,2,3] row_mask:0xf bank_mask:0x2
    v_mov_b32_dpp v110, v106 quad_perm:[0,1,2,3] row_mask:0xf bank_mask:0x2
    v_mov_b32_dpp v111, v107 quad_perm:[0,1,2,3] row_mask:0xf bank_mask:0x2
    ds_write_b128 v203, v[108:111]
    v_and_b32 v6, 31, v0
    v_lshlrev_b32 v6, 3, v6
    v_add_u32 v6, 122112, v6
    ds_read_b64 v[108:109], v6
    ds_read_b64 v[104:105], v6 offset:320
    v_bfe_u32 v112, v0, 1, 2
    v_mul_u32_u24 v112, 1280, v112
    v_bfe_u32 v7, v0, 3, 2
    v_lshl_add_u32 v112, v7, 3, v112
    v_and_b32 v7, 1, v0
    v_lshl_add_u32 v112, v7, 2, v112
    v_lshrrev_b32 v7, 5, v0
    v_lshl_add_u32 v112, v7, 28, v112
    s_lshl_b32 s34, s62, 5
    s_waitcnt lgkmcnt(0)
    s_barrier
    ds_read_b64 v[64:65], v6 offset:1024
    ds_read_b64 v[66:67], v6 offset:2048
    ds_read_b64 v[68:69], v6 offset:3072
    ds_read_b64 v[70:71], v6 offset:4096
    ds_read_b64 v[72:73], v6 offset:5120
    ds_read_b64 v[74:75], v6 offset:6144
    ds_read_b64 v[76:77], v6 offset:7168
    s_waitcnt lgkmcnt(6)
    v_pk_fma_f32 v[108:109], v[64:65], v[104:105], v[108:109]
    s_waitcnt lgkmcnt(5)
    v_pk_fma_f32 v[108:109], v[66:67], v[104:105], v[108:109]
    s_waitcnt lgkmcnt(4)
    v_pk_fma_f32 v[108:109], v[68:69], v[104:105], v[108:109]
    s_waitcnt lgkmcnt(3)
    v_pk_fma_f32 v[108:109], v[70:71], v[104:105], v[108:109]
    s_waitcnt lgkmcnt(2)
    v_pk_fma_f32 v[108:109], v[72:73], v[104:105], v[108:109]
    s_waitcnt lgkmcnt(1)
    v_pk_fma_f32 v[108:109], v[74:75], v[104:105], v[108:109]
    s_waitcnt lgkmcnt(0)
    v_pk_fma_f32 v[108:109], v[76:77], v[104:105], v[108:109]
    v_cvt_pk_bf16_f32 v20, v108, v109
    buffer_store_dword v20, v112, s[36:39], s34 offen
    s_branch L_fin
L_t_wo:
    s_barrier
L_r_wo2:
    s_mov_b32 m0, s56
    s_nop 0
    buffer_load_dwordx4 v15, s[52:55], s57 offen  lds
    s_mov_b32 m0, s58
    s_nop 0
    buffer_load_dwordx4 v15, s[52:55], s59 offen  lds
    s_xor_b32 m0, s56, 2048
    s_sub_u32 s34, 40960, s57
    buffer_load_dwordx4 v15, s[52:55], s34 offen  lds
    s_xor_b32 m0, s58, 2048
    s_sub_u32 s34, 42240, s57
    buffer_load_dwordx4 v15, s[52:55], s34 offen  lds
L_r_wo3:
    s_mov_b32 s35, 0
    s_mov_b32 s48, 0
    buffer_load_dwordx4 v[64:67], v205, s[44:47], 0 offen sc1
    buffer_load_dwordx2 v[26:27], v204, s[44:47], 0 offen sc1
    s_waitcnt vmcnt(2)
    ds_read_b64_tr_b16 v[32:33], v206 offset:0
    ds_read_b64_tr_b16 v[34:35], v206 offset:1024
    ds_read_b64_tr_b16 v[36:37], v206 offset:32
    ds_read_b64_tr_b16 v[38:39], v206 offset:1056
    ds_read_b64_tr_b16 v[40:41], v206 offset:2048
    ds_read_b64_tr_b16 v[42:43], v206 offset:3072
    ds_read_b64_tr_b16 v[44:45], v206 offset:2080
    ds_read_b64_tr_b16 v[46:47], v206 offset:3104
    s_branch L_pam
L_pa:
    buffer_load_dwordx4 v[64:67], v205, s[44:47], 0 offen sc1
    buffer_load_dwordx2 v[26:27], v204, s[44:47], 0 offen sc1
L_pam:
    s_add_u32 s35, s35, 1
    s_waitcnt vmcnt(0)
    ds_write_b128 v207, v[64:67]
    ds_write_b32 v212, v26 offset:128
    v_max3_u32 v28, v64, v65, v66
    v_max3_u32 v28, v28, v67, v26
    v_cmp_eq_u32 vcc, -1, v28
    s_cbranch_vccz L_pad
    s_cmp_lg_u32 s35, 64
    s_cbranch_scc1 L_tmo100
    s_mov_b64 exec, -1
    v_lshlrev_b32 v243, 4, v0
    v_add_u32 v243, 131328, v243
    ds_read_b96 v[240:242], v243
    s_waitcnt lgkmcnt(0)
    buffer_store_dword v240, v242, s[44:47], 0 offen sc1
    buffer_store_dword v241, v242, s[44:47], 0 offen offset:256 sc1
L_tmo100:
    s_mov_b64 exec, vcc
    s_cmp_lt_u32 s35, 60000
    s_cbranch_scc1 L_pa
L_pad:
    s_mov_b64 exec, -1
    ds_read_b32 v26, v213 offset:128
    ds_read_b128 v[68:71], v208 offset:0
    ds_read_b128 v[72:75], v209 offset:0
    ds_read_b128 v[76:79], v208 offset:64
    ds_read_b128 v[80:83], v209 offset:64
    s_waitcnt lgkmcnt(3)
    v_mfma_f32_16x16x32_bf16 v[20:23], v[32:35], v[68:71], 0
    s_waitcnt lgkmcnt(2)
    v_mfma_f32_16x16x32_bf16 v[20:23], v[36:39], v[72:75], v[20:23]
    s_waitcnt lgkmcnt(1)
    v_mfma_f32_16x16x32_bf16 v[20:23], v[40:43], v[76:79], v[20:23]
    s_waitcnt lgkmcnt(0)
    v_mfma_f32_16x16x32_bf16 v[20:23], v[44:47], v[80:83], v[20:23]
    v_sub_f32_dpp v26, v26, v26 quad_perm:[1,0,3,2] row_mask:0xf bank_mask:0xf
    v_exp_f32 v26, v26
    s_nop 0
    v_add_f32 v26, 1.0, v26
    v_rcp_f32 v26, v26
    s_nop 0
    v_sub_f32 v30, 1.0, v26
    s_nop 0
    v_pk_mul_f32 v[48:49], v[20:21], v[26:27] op_sel_hi:[1,0]
    v_pk_mul_f32 v[50:51], v[22:23], v[26:27] op_sel_hi:[1,0]
    v_fmac_f32_dpp v48, v20, v30 quad_perm:[1,0,3,2] row_mask:0xf bank_mask:0xf
    v_fmac_f32_dpp v49, v21, v30 quad_perm:[1,0,3,2] row_mask:0xf bank_mask:0xf
    v_fmac_f32_dpp v50, v22, v30 quad_perm:[1,0,3,2] row_mask:0xf bank_mask:0xf
    v_fmac_f32_dpp v51, v23, v30 quad_perm:[1,0,3,2] row_mask:0xf bank_mask:0xf
    ds_write_b128 v203, v[48:51]
    s_cmp_lg_u32 s3, 0
    s_waitcnt lgkmcnt(0)
    s_barrier
    s_cbranch_scc1 L_wo_x
    ds_read_b64 v[64:65], v113 offset:0
    ds_read_b64 v[66:67], v113 offset:1152
    ds_read_b64 v[68:69], v113 offset:2304
    ds_read_b64 v[70:71], v113 offset:3456
    ds_read_b64 v[72:73], v113 offset:4608
    ds_read_b64 v[74:75], v113 offset:5760
    ds_read_b64 v[76:77], v113 offset:6912
    ds_read_b64 v[78:79], v113 offset:8064
    s_waitcnt lgkmcnt(6)
    v_pk_add_f32 v[64:65], v[64:65], v[66:67]
    s_waitcnt lgkmcnt(5)
    v_pk_add_f32 v[64:65], v[64:65], v[68:69]
    s_waitcnt lgkmcnt(4)
    v_pk_add_f32 v[64:65], v[64:65], v[70:71]
    s_waitcnt lgkmcnt(3)
    v_pk_add_f32 v[64:65], v[64:65], v[72:73]
    s_waitcnt lgkmcnt(2)
    v_pk_add_f32 v[64:65], v[64:65], v[74:75]
    s_waitcnt lgkmcnt(1)
    v_pk_add_f32 v[64:65], v[64:65], v[76:77]
    s_waitcnt lgkmcnt(0)
    v_pk_add_f32 v[64:65], v[64:65], v[78:79]
    v_pk_mul_f32 v[64:65], v[64:65], v[100:101]
    v_cvt_pk_bf16_f32 v28, v64, v65
    v_min_u32 v28, -2, v28
    buffer_store_dword v28, v112, s[44:47], s101 offen sc1
    buffer_store_dword v28, v112, s[44:47], s93 offen sc1
L_wo_x:
    s_getreg_b32 s34, hwreg(HW_REG_XCC_ID, 0, 4)
    v_cmp_ne_u32 vcc, s34, v27
    s_cbranch_vccz L_fin
    s_mov_b64 exec, -1
    v_lshlrev_b32 v243, 4, v0
    v_add_u32 v243, 131328, v243
    ds_read_b96 v[240:242], v243
    s_waitcnt lgkmcnt(0)
    buffer_store_dword v240, v242, s[44:47], 0 offen sc1
    buffer_store_dword v241, v242, s[44:47], 0 offen offset:256 sc1
L_fin:
L_exit:
    s_endpgm
L_codeend:
.section .rodata,"a"
.p2align 6
.amdhsa_kernel adaLN_cond__sliding_block_cached__dense_activation_gelu__decode_kernel
  .amdhsa_next_free_vgpr 256
  .amdhsa_next_free_sgpr 102
  .amdhsa_accum_offset 256
  .amdhsa_group_segment_fixed_size 0
  .amdhsa_kernarg_size 120
  .amdhsa_user_sgpr_count 2
  .amdhsa_user_sgpr_kernarg_segment_ptr 1
  .amdhsa_system_sgpr_workgroup_id_x 1
  .amdhsa_float_denorm_mode_32 3
.end_amdhsa_kernel
```

```asm
; @launch grid=(256,1,1) block=(512,1,1) lds=132352
.amdgcn_target "amdgcn-amd-amdhsa--gfx950"
.text
.globl adaLN_cond__sliding_block_cached__dense_activation_gelu__decode_kernel
.p2align 8
.type adaLN_cond__sliding_block_cached__dense_activation_gelu__decode_kernel,@function
adaLN_cond__sliding_block_cached__dense_activation_gelu__decode_kernel:
    s_load_dwordx16 s[4:19], s[0:1], 0
    s_load_dwordx8 s[20:27], s[0:1], 64
    s_cmpk_ge_u32 s2, 256
    s_cbranch_scc1 L_exit
    v_lshrrev_b32 v1, 6, v0
    v_and_b32 v0, 63, v0
    v_readfirstlane_b32 s3, v1
    v_lshrrev_b32 v10, 3, v0
    v_and_b32 v11, 7, v0
    v_lshlrev_b32 v11, 4, v11
    s_lshr_b32 s50, s2, 2
    s_and_b32 s51, s2, 3
    s_lshl_b32 s34, s50, 7
    s_and_b32 s49, s2, 31
    s_lshl_b32 s49, s49, 8
    s_and_b32 s35, s2, 0x80
    s_add_u32 s49, s49, s35
    s_bfe_u32 s53, s2, 0x20005
    s_cmpk_lt_u32 s2, 240
    s_cselect_b32 s38, 4915200, 0
    s_movk_i32 s48, 7680
    s_mul_i32 m0, s3, 5120
    s_and_b32 s52, s3, 3
    s_cmp_ge_u32 s3, 4
    s_cselect_b32 s34, s49, s34
    s_cselect_b32 s35, s53, s51
    s_cmovk_i32 s48, 8192
    s_cmov_b32 s38, 5242880
    s_mul_i32 s35, s35, 160
    s_mul_i32 s52, s52, 40
    v_add_u32 v10, s35, v10
    v_add_u32 v10, s52, v10
    v_mad_u32_u24 v8, v10, s48, v11
    s_mul_i32 s48, s48, 8
    s_mov_b32 s39, 0x20000
    s_waitcnt lgkmcnt(0)
    s_cselect_b32 s36, s10, s26
    s_cselect_b32 s37, s11, s27
    buffer_load_dwordx4 v8, s[36:39], s34 offen nt lds
    s_add_u32 m0, m0, 1024
    s_add_u32 s34, s34, s48
    buffer_load_dwordx4 v8, s[36:39], s34 offen nt lds
    s_add_u32 m0, m0, 1024
    s_add_u32 s34, s34, s48
    buffer_load_dwordx4 v8, s[36:39], s34 offen nt lds
    s_add_u32 m0, m0, 1024
    s_add_u32 s34, s34, s48
    buffer_load_dwordx4 v8, s[36:39], s34 offen nt lds
    s_add_u32 m0, m0, 1024
    s_add_u32 s34, s34, s48
    buffer_load_dwordx4 v8, s[36:39], s34 offen nt lds
    s_load_dwordx4 s[28:31], s[0:1], 96
    s_load_dwordx2 s[32:33], s[0:1], 112
    s_and_b32 s60, s2, 7
    s_lshr_b32 s61, s2, 3
    s_mov_b32 s39, 0x20000
    s_mov_b32 s43, 0x20000
    s_mov_b32 s46, 1835008
    s_mov_b32 s47, 0x20000
    s_cmp_lg_u32 s3, 0
    s_cbranch_scc1 L_stream
    s_setprio 3
    v_and_b32 v12, 3, v0
    v_bfe_u32 v13, v0, 2, 2
    v_lshrrev_b32 v14, 4, v0
    v_mul_u32_u24 v16, 1280, v12
    v_lshl_add_u32 v18, v14, 4, v16
    s_mul_i32 s34, s51, 320
    v_add_u32 v19, s34, v18
    s_sub_u32 s52, s50, 10
    s_waitcnt lgkmcnt(0)
    s_add_u32 s44, s32, 0
    s_addc_u32 s45, s33, 0
    s_cmp_ge_u32 s2, 240
    s_cbranch_scc1 L_clear
    v_lshlrev_b32 v1, 2, v0
    v_add_u32 v1, 98304, v1
    v_mov_b32 v2, -1
    v_mov_b32 v3, 0
    ds_write_b32 v1, v2
    ds_write_b32 v1, v2 offset:256
    ds_write_b32 v1, v3 offset:512
    ds_write_b32 v1, v3 offset:768
    s_waitcnt lgkmcnt(0)
    s_barrier
    s_cmp_ge_u32 s52, 10
    s_cbranch_scc1 L_nox
    v_lshl_add_u32 v18, v13, 6, v18
    global_load_dwordx4 v[52:55], v18, s[4:5] offset:0
    global_load_dwordx4 v[56:59], v18, s[4:5] offset:256
    global_load_dwordx4 v[60:63], v18, s[4:5] offset:512
    global_load_dwordx4 v[64:67], v18, s[4:5] offset:768
    global_load_dwordx4 v[68:71], v18, s[4:5] offset:1024
    s_lshl_b32 s34, s52, 7
    v_lshl_add_u32 v16, v13, 5, v16
    v_lshl_add_u32 v16, v14, 3, v16
    v_add_u32 v16, s34, v16
    global_load_dwordx2 v[72:73], v16, s[4:5]
L_nox:
    global_load_dwordx4 v[32:35], v19, s[24:25] offset:0
    global_load_dwordx4 v[36:39], v19, s[24:25] offset:64
    global_load_dwordx4 v[40:43], v19, s[24:25] offset:128
    global_load_dwordx4 v[44:47], v19, s[24:25] offset:192
    global_load_dwordx4 v[48:51], v19, s[24:25] offset:256
    v_lshl_add_u32 v15, v14, 3, v13
    v_lshlrev_b32 v15, 7, v15
    v_lshl_add_u32 v15, v12, 3, v15
    s_waitcnt vmcnt(0)
    s_mov_b32 s34, 0xbfb8aa3b
    v_lshlrev_b32 v20, 16, v32
    v_and_b32 v21, 0xffff0000, v32
    v_lshlrev_b32 v22, 16, v33
    v_and_b32 v23, 0xffff0000, v33
    v_mul_f32 v24, s34, v20
    v_mul_f32 v25, s34, v21
    v_mul_f32 v26, s34, v22
    v_mul_f32 v27, s34, v23
    v_exp_f32 v24, v24
    v_exp_f32 v25, v25
    v_exp_f32 v26, v26
    v_exp_f32 v27, v27
    v_add_f32 v24, 1.0, v24
    v_add_f32 v25, 1.0, v25
    v_add_f32 v26, 1.0, v26
    v_add_f32 v27, 1.0, v27
    v_rcp_f32 v24, v24
    v_rcp_f32 v25, v25
    v_rcp_f32 v26, v26
    v_rcp_f32 v27, v27
    v_mul_f32 v24, v20, v24
    v_mul_f32 v25, v21, v25
    v_mul_f32 v26, v22, v26
    v_mul_f32 v27, v23, v27
    v_cvt_pk_bf16_f32 v32, v24, v25
    v_cvt_pk_bf16_f32 v33, v26, v27
    v_lshlrev_b32 v20, 16, v34
    v_and_b32 v21, 0xffff0000, v34
    v_lshlrev_b32 v22, 16, v35
    v_and_b32 v23, 0xffff0000, v35
    v_mul_f32 v24, s34, v20
    v_mul_f32 v25, s34, v21
    v_mul_f32 v26, s34, v22
    v_mul_f32 v27, s34, v23
    v_exp_f32 v24, v24
    v_exp_f32 v25, v25
    v_exp_f32 v26, v26
    v_exp_f32 v27, v27
    v_add_f32 v24, 1.0, v24
    v_add_f32 v25, 1.0, v25
    v_add_f32 v26, 1.0, v26
    v_add_f32 v27, 1.0, v27
    v_rcp_f32 v24, v24
    v_rcp_f32 v25, v25
    v_rcp_f32 v26, v26
    v_rcp_f32 v27, v27
    v_mul_f32 v24, v20, v24
    v_mul_f32 v25, v21, v25
    v_mul_f32 v26, v22, v26
    v_mul_f32 v27, v23, v27
    v_cvt_pk_bf16_f32 v34, v24, v25
    v_cvt_pk_bf16_f32 v35, v26, v27
    v_lshlrev_b32 v20, 16, v36
    v_and_b32 v21, 0xffff0000, v36
    v_lshlrev_b32 v22, 16, v37
    v_and_b32 v23, 0xffff0000, v37
    v_mul_f32 v24, s34, v20
    v_mul_f32 v25, s34, v21
    v_mul_f32 v26, s34, v22
    v_mul_f32 v27, s34, v23
    v_exp_f32 v24, v24
    v_exp_f32 v25, v25
    v_exp_f32 v26, v26
    v_exp_f32 v27, v27
    v_add_f32 v24, 1.0, v24
    v_add_f32 v25, 1.0, v25
    v_add_f32 v26, 1.0, v26
    v_add_f32 v27, 1.0, v27
    v_rcp_f32 v24, v24
    v_rcp_f32 v25, v25
    v_rcp_f32 v26, v26
    v_rcp_f32 v27, v27
    v_mul_f32 v24, v20, v24
    v_mul_f32 v25, v21, v25
    v_mul_f32 v26, v22, v26
    v_mul_f32 v27, v23, v27
    v_cvt_pk_bf16_f32 v36, v24, v25
    v_cvt_pk_bf16_f32 v37, v26, v27
    v_lshlrev_b32 v20, 16, v38
    v_and_b32 v21, 0xffff0000, v38
    v_lshlrev_b32 v22, 16, v39
    v_and_b32 v23, 0xffff0000, v39
    v_mul_f32 v24, s34, v20
    v_mul_f32 v25, s34, v21
    v_mul_f32 v26, s34, v22
    v_mul_f32 v27, s34, v23
    v_exp_f32 v24, v24
    v_exp_f32 v25, v25
    v_exp_f32 v26, v26
    v_exp_f32 v27, v27
    v_add_f32 v24, 1.0, v24
    v_add_f32 v25, 1.0, v25
    v_add_f32 v26, 1.0, v26
    v_add_f32 v27, 1.0, v27
    v_rcp_f32 v24, v24
    v_rcp_f32 v25, v25
    v_rcp_f32 v26, v26
    v_rcp_f32 v27, v27
    v_mul_f32 v24, v20, v24
    v_mul_f32 v25, v21, v25
    v_mul_f32 v26, v22, v26
    v_mul_f32 v27, v23, v27
    v_cvt_pk_bf16_f32 v38, v24, v25
    v_cvt_pk_bf16_f32 v39, v26, v27
    v_lshlrev_b32 v20, 16, v40
    v_and_b32 v21, 0xffff0000, v40
    v_lshlrev_b32 v22, 16, v41
    v_and_b32 v23, 0xffff0000, v41
    v_mul_f32 v24, s34, v20
    v_mul_f32 v25, s34, v21
    v_mul_f32 v26, s34, v22
    v_mul_f32 v27, s34, v23
    v_exp_f32 v24, v24
    v_exp_f32 v25, v25
    v_exp_f32 v26, v26
    v_exp_f32 v27, v27
    v_add_f32 v24, 1.0, v24
    v_add_f32 v25, 1.0, v25
    v_add_f32 v26, 1.0, v26
    v_add_f32 v27, 1.0, v27
    v_rcp_f32 v24, v24
    v_rcp_f32 v25, v25
    v_rcp_f32 v26, v26
    v_rcp_f32 v27, v27
    v_mul_f32 v24, v20, v24
    v_mul_f32 v25, v21, v25
    v_mul_f32 v26, v22, v26
    v_mul_f32 v27, v23, v27
    v_cvt_pk_bf16_f32 v40, v24, v25
    v_cvt_pk_bf16_f32 v41, v26, v27
    v_lshlrev_b32 v20, 16, v42
    v_and_b32 v21, 0xffff0000, v42
    v_lshlrev_b32 v22, 16, v43
    v_and_b32 v23, 0xffff0000, v43
    v_mul_f32 v24, s34, v20
    v_mul_f32 v25, s34, v21
    v_mul_f32 v26, s34, v22
    v_mul_f32 v27, s34, v23
    v_exp_f32 v24, v24
    v_exp_f32 v25, v25
    v_exp_f32 v26, v26
    v_exp_f32 v27, v27
    v_add_f32 v24, 1.0, v24
    v_add_f32 v25, 1.0, v25
    v_add_f32 v26, 1.0, v26
    v_add_f32 v27, 1.0, v27
    v_rcp_f32 v24, v24
    v_rcp_f32 v25, v25
    v_rcp_f32 v26, v26
    v_rcp_f32 v27, v27
    v_mul_f32 v24, v20, v24
    v_mul_f32 v25, v21, v25
    v_mul_f32 v26, v22, v26
    v_mul_f32 v27, v23, v27
    v_cvt_pk_bf16_f32 v42, v24, v25
    v_cvt_pk_bf16_f32 v43, v26, v27
    v_lshlrev_b32 v20, 16, v44
    v_and_b32 v21, 0xffff0000, v44
    v_lshlrev_b32 v22, 16, v45
    v_and_b32 v23, 0xffff0000, v45
    v_mul_f32 v24, s34, v20
    v_mul_f32 v25, s34, v21
    v_mul_f32 v26, s34, v22
    v_mul_f32 v27, s34, v23
    v_exp_f32 v24, v24
    v_exp_f32 v25, v25
    v_exp_f32 v26, v26
    v_exp_f32 v27, v27
    v_add_f32 v24, 1.0, v24
    v_add_f32 v25, 1.0, v25
    v_add_f32 v26, 1.0, v26
    v_add_f32 v27, 1.0, v27
    v_rcp_f32 v24, v24
    v_rcp_f32 v25, v25
    v_rcp_f32 v26, v26
    v_rcp_f32 v27, v27
    v_mul_f32 v24, v20, v24
    v_mul_f32 v25, v21, v25
    v_mul_f32 v26, v22, v26
    v_mul_f32 v27, v23, v27
    v_cvt_pk_bf16_f32 v44, v24, v25
    v_cvt_pk_bf16_f32 v45, v26, v27
    v_lshlrev_b32 v20, 16, v46
    v_and_b32 v21, 0xffff0000, v46
    v_lshlrev_b32 v22, 16, v47
    v_and_b32 v23, 0xffff0000, v47
    v_mul_f32 v24, s34, v20
    v_mul_f32 v25, s34, v21
    v_mul_f32 v26, s34, v22
    v_mul_f32 v27, s34, v23
    v_exp_f32 v24, v24
    v_exp_f32 v25, v25
    v_exp_f32 v26, v26
    v_exp_f32 v27, v27
    v_add_f32 v24, 1.0, v24
    v_add_f32 v25, 1.0, v25
    v_add_f32 v26, 1.0, v26
    v_add_f32 v27, 1.0, v27
    v_rcp_f32 v24, v24
    v_rcp_f32 v25, v25
    v_rcp_f32 v26, v26
    v_rcp_f32 v27, v27
    v_mul_f32 v24, v20, v24
    v_mul_f32 v25, v21, v25
    v_mul_f32 v26, v22, v26
    v_mul_f32 v27, v23, v27
    v_cvt_pk_bf16_f32 v46, v24, v25
    v_cvt_pk_bf16_f32 v47, v26, v27
    v_lshlrev_b32 v20, 16, v48
    v_and_b32 v21, 0xffff0000, v48
    v_lshlrev_b32 v22, 16, v49
    v_and_b32 v23, 0xffff0000, v49
    v_mul_f32 v24, s34, v20
    v_mul_f32 v25, s34, v21
    v_mul_f32 v26, s34, v22
    v_mul_f32 v27, s34, v23
    v_exp_f32 v24, v24
    v_exp_f32 v25, v25
    v_exp_f32 v26, v26
    v_exp_f32 v27, v27
    v_add_f32 v24, 1.0, v24
    v_add_f32 v25, 1.0, v25
    v_add_f32 v26, 1.0, v26
    v_add_f32 v27, 1.0, v27
    v_rcp_f32 v24, v24
    v_rcp_f32 v25, v25
    v_rcp_f32 v26, v26
    v_rcp_f32 v27, v27
    v_mul_f32 v24, v20, v24
    v_mul_f32 v25, v21, v25
    v_mul_f32 v26, v22, v26
    v_mul_f32 v27, v23, v27
    v_cvt_pk_bf16_f32 v48, v24, v25
    v_cvt_pk_bf16_f32 v49, v26, v27
    v_lshlrev_b32 v20, 16, v50
    v_and_b32 v21, 0xffff0000, v50
    v_lshlrev_b32 v22, 16, v51
    v_and_b32 v23, 0xffff0000, v51
    v_mul_f32 v24, s34, v20
    v_mul_f32 v25, s34, v21
    v_mul_f32 v26, s34, v22
    v_mul_f32 v27, s34, v23
    v_exp_f32 v24, v24
    v_exp_f32 v25, v25
    v_exp_f32 v26, v26
    v_exp_f32 v27, v27
    v_add_f32 v24, 1.0, v24
    v_add_f32 v25, 1.0, v25
    v_add_f32 v26, 1.0, v26
    v_add_f32 v27, 1.0, v27
    v_rcp_f32 v24, v24
    v_rcp_f32 v25, v25
    v_rcp_f32 v26, v26
    v_rcp_f32 v27, v27
    v_mul_f32 v24, v20, v24
    v_mul_f32 v25, v21, v25
    v_mul_f32 v26, v22, v26
    v_mul_f32 v27, v23, v27
    v_cvt_pk_bf16_f32 v50, v24, v25
    v_cvt_pk_bf16_f32 v51, v26, v27
    s_cmp_ge_u32 s52, 10
    s_cbranch_scc1 L_nostats
    v_mov_b32 v20, 0
    v_mov_b32 v21, 0
    v_mov_b32 v22, 0x3f803f80
    v_dot2c_f32_bf16 v20, v52, v22
    v_dot2c_f32_bf16 v21, v52, v52
    v_dot2c_f32_bf16 v20, v53, v22
    v_dot2c_f32_bf16 v21, v53, v53
    v_dot2c_f32_bf16 v20, v54, v22
    v_dot2c_f32_bf16 v21, v54, v54
    v_dot2c_f32_bf16 v20, v55, v22
    v_dot2c_f32_bf16 v21, v55, v55
    v_dot2c_f32_bf16 v20, v56, v22
    v_dot2c_f32_bf16 v21, v56, v56
    v_dot2c_f32_bf16 v20, v57, v22
    v_dot2c_f32_bf16 v21, v57, v57
    v_dot2c_f32_bf16 v20, v58, v22
    v_dot2c_f32_bf16 v21, v58, v58
    v_dot2c_f32_bf16 v20, v59, v22
    v_dot2c_f32_bf16 v21, v59, v59
    v_dot2c_f32_bf16 v20, v60, v22
    v_dot2c_f32_bf16 v21, v60, v60
    v_dot2c_f32_bf16 v20, v61, v22
    v_dot2c_f32_bf16 v21, v61, v61
    v_dot2c_f32_bf16 v20, v62, v22
    v_dot2c_f32_bf16 v21, v62, v62
    v_dot2c_f32_bf16 v20, v63, v22
    v_dot2c_f32_bf16 v21, v63, v63
    v_dot2c_f32_bf16 v20, v64, v22
    v_dot2c_f32_bf16 v21, v64, v64
    v_dot2c_f32_bf16 v20, v65, v22
    v_dot2c_f32_bf16 v21, v65, v65
    v_dot2c_f32_bf16 v20, v66, v22
    v_dot2c_f32_bf16 v21, v66, v66
    v_dot2c_f32_bf16 v20, v67, v22
    v_dot2c_f32_bf16 v21, v67, v67
    v_dot2c_f32_bf16 v20, v68, v22
    v_dot2c_f32_bf16 v21, v68, v68
    v_dot2c_f32_bf16 v20, v69, v22
    v_dot2c_f32_bf16 v21, v69, v69
    v_dot2c_f32_bf16 v20, v70, v22
    v_dot2c_f32_bf16 v21, v70, v70
    v_dot2c_f32_bf16 v20, v71, v22
    v_dot2c_f32_bf16 v21, v71, v71
    s_nop 1
    v_add_f32_dpp v20, v20, v20 row_ror:4 row_mask:0xf bank_mask:0xf
    v_add_f32_dpp v21, v21, v21 row_ror:4 row_mask:0xf bank_mask:0xf
    s_nop 0
    v_add_f32_dpp v20, v20, v20 row_ror:8 row_mask:0xf bank_mask:0xf
    v_add_f32_dpp v21, v21, v21 row_ror:8 row_mask:0xf bank_mask:0xf
    v_mov_b32 v22, v20
    v_mov_b32 v23, v21
    s_nop 0
    v_permlane16_swap_b32 v20, v22
    v_permlane16_swap_b32 v21, v23
    v_add_f32 v20, v20, v22
    v_add_f32 v21, v21, v23
    v_mov_b32 v22, v20
    v_mov_b32 v23, v21
    s_nop 0
    v_permlane32_swap_b32 v20, v22
    v_permlane32_swap_b32 v21, v23
    v_add_f32 v20, v20, v22
    v_add_f32 v21, v21, v23
    v_mul_f32 v22, 0x3acccccd, v20
    v_mul_f32 v21, 0x3acccccd, v21
    v_fma_f32 v21, -v22, v22, v21
    v_max_f32 v21, 0, v21
    v_add_f32 v21, 0x3727c5ac, v21
    v_rsq_f32 v20, v21
    s_nop 0
    v_mul_f32_e64 v21, -v22, v20
    v_lshlrev_b32 v24, 16, v72
    v_and_b32 v25, 0xffff0000, v72
    v_lshlrev_b32 v26, 16, v73
    v_and_b32 v27, 0xffff0000, v73
    v_fma_f32 v24, v24, v20, v21
    v_fma_f32 v25, v25, v20, v21
    v_fma_f32 v26, v26, v20, v21
    v_fma_f32 v27, v27, v20, v21
L_nostats:
    ds_read_b64_tr_b16 v[96:97], v15 offset:0
    ds_read_b64_tr_b16 v[98:99], v15 offset:512
    ds_read_b64_tr_b16 v[100:101], v15 offset:32
    ds_read_b64_tr_b16 v[102:103], v15 offset:544
    ds_read_b64_tr_b16 v[104:105], v15 offset:64
    ds_read_b64_tr_b16 v[106:107], v15 offset:576
    ds_read_b64_tr_b16 v[108:109], v15 offset:96
    ds_read_b64_tr_b16 v[110:111], v15 offset:608
    s_waitcnt lgkmcnt(7)
    ds_read_b64_tr_b16 v[112:113], v15 offset:4096
    ds_read_b64_tr_b16 v[114:115], v15 offset:4608
    ds_read_b64_tr_b16 v[116:117], v15 offset:4128
    ds_read_b64_tr_b16 v[118:119], v15 offset:4640
    ds_read_b64_tr_b16 v[120:121], v15 offset:4160
    ds_read_b64_tr_b16 v[122:123], v15 offset:4672
    ds_read_b64_tr_b16 v[124:125], v15 offset:4192
    ds_read_b64_tr_b16 v[126:127], v15 offset:4704
    s_waitcnt lgkmcnt(7)
    ds_read_b64_tr_b16 v[128:129], v15 offset:8192
    ds_read_b64_tr_b16 v[130:131], v15 offset:8704
    ds_read_b64_tr_b16 v[132:133], v15 offset:8224
    ds_read_b64_tr_b16 v[134:135], v15 offset:8736
    ds_read_b64_tr_b16 v[136:137], v15 offset:8256
    ds_read_b64_tr_b16 v[138:139], v15 offset:8768
    ds_read_b64_tr_b16 v[140:141], v15 offset:8288
    ds_read_b64_tr_b16 v[142:143], v15 offset:8800
    s_waitcnt lgkmcnt(7)
    ds_read_b64_tr_b16 v[144:145], v15 offset:12288
    ds_read_b64_tr_b16 v[146:147], v15 offset:12800
    ds_read_b64_tr_b16 v[148:149], v15 offset:12320
    ds_read_b64_tr_b16 v[150:151], v15 offset:12832
    ds_read_b64_tr_b16 v[152:153], v15 offset:12352
    ds_read_b64_tr_b16 v[154:155], v15 offset:12864
    ds_read_b64_tr_b16 v[156:157], v15 offset:12384
    ds_read_b64_tr_b16 v[158:159], v15 offset:12896
    s_waitcnt lgkmcnt(7)
    ds_read_b64_tr_b16 v[160:161], v15 offset:16384
    ds_read_b64_tr_b16 v[162:163], v15 offset:16896
    ds_read_b64_tr_b16 v[164:165], v15 offset:16416
    ds_read_b64_tr_b16 v[166:167], v15 offset:16928
    ds_read_b64_tr_b16 v[168:169], v15 offset:16448
    ds_read_b64_tr_b16 v[170:171], v15 offset:16960
    ds_read_b64_tr_b16 v[172:173], v15 offset:16480
    ds_read_b64_tr_b16 v[174:175], v15 offset:16992
    s_waitcnt lgkmcnt(0)
    v_mfma_f32_16x16x32_bf16 v[80:83], v[96:99], v[32:35], 0
    v_mfma_f32_16x16x32_bf16 v[84:87], v[100:103], v[32:35], 0
    v_mfma_f32_16x16x32_bf16 v[88:91], v[104:107], v[32:35], 0
    v_mfma_f32_16x16x32_bf16 v[92:95], v[108:111], v[32:35], 0
    v_mfma_f32_16x16x32_bf16 v[80:83], v[112:115], v[36:39], v[80:83]
    v_mfma_f32_16x16x32_bf16 v[84:87], v[116:119], v[36:39], v[84:87]
    v_mfma_f32_16x16x32_bf16 v[88:91], v[120:123], v[36:39], v[88:91]
    v_mfma_f32_16x16x32_bf16 v[92:95], v[124:127], v[36:39], v[92:95]
    v_mfma_f32_16x16x32_bf16 v[80:83], v[128:131], v[40:43], v[80:83]
    v_mfma_f32_16x16x32_bf16 v[84:87], v[132:135], v[40:43], v[84:87]
    v_mfma_f32_16x16x32_bf16 v[88:91], v[136:139], v[40:43], v[88:91]
    v_mfma_f32_16x16x32_bf16 v[92:95], v[140:143], v[40:43], v[92:95]
    v_mfma_f32_16x16x32_bf16 v[80:83], v[144:147], v[44:47], v[80:83]
    v_mfma_f32_16x16x32_bf16 v[84:87], v[148:151], v[44:47], v[84:87]
    v_mfma_f32_16x16x32_bf16 v[88:91], v[152:155], v[44:47], v[88:91]
    v_mfma_f32_16x16x32_bf16 v[92:95], v[156:159], v[44:47], v[92:95]
    v_mfma_f32_16x16x32_bf16 v[80:83], v[160:163], v[48:51], v[80:83]
    v_mfma_f32_16x16x32_bf16 v[84:87], v[164:167], v[48:51], v[84:87]
    v_mfma_f32_16x16x32_bf16 v[88:91], v[168:171], v[48:51], v[88:91]
    v_mfma_f32_16x16x32_bf16 v[92:95], v[172:175], v[48:51], v[92:95]
    s_cmp_ge_u32 s50, 20
    s_cbranch_scc1 L_adr_rest
    s_cmp_lt_u32 s50, 10
    s_cselect_b32 s34, 5120, 0
    s_cselect_b32 s35, s50, s52
    s_lshl_b32 s35, s35, 9
    s_add_u32 s34, s34, s35
    s_lshl_b32 s35, s51, 15
    s_add_u32 s34, s34, s35
    v_lshrrev_b32 v19, 1, v14
    v_lshl_add_u32 v19, v13, 1, v19
    v_lshlrev_b32 v19, 6, v19
    v_lshl_add_u32 v19, v12, 4, v19
    v_and_b32 v20, 1, v14
    v_lshl_add_u32 v19, v20, 3, v19
    s_branch L_adr_done
L_adr_rest:
    s_lshl_b32 s34, s51, 15
    s_lshl_b32 s35, s50, 9
    s_add_u32 s34, s34, s35
    s_add_u32 s34, s34, 0
    v_lshlrev_b32 v19, 7, v12
    v_lshl_add_u32 v19, v13, 5, v19
    v_lshl_add_u32 v19, v14, 3, v19
    s_nop 3
L_adr_done:
    v_add_u32 v19, s34, v19
    v_mov_b32_dpp v80, v84 quad_perm:[0,1,2,3] row_mask:0xf bank_mask:0x2
    v_mov_b32_dpp v81, v85 quad_perm:[0,1,2,3] row_mask:0xf bank_mask:0x2
    v_mov_b32_dpp v82, v86 quad_perm:[0,1,2,3] row_mask:0xf bank_mask:0x2
    v_mov_b32_dpp v83, v87 quad_perm:[0,1,2,3] row_mask:0xf bank_mask:0x2
    v_mov_b32_dpp v80, v88 quad_perm:[0,1,2,3] row_mask:0xf bank_mask:0x4
    v_mov_b32_dpp v81, v89 quad_perm:[0,1,2,3] row_mask:0xf bank_mask:0x4
    v_mov_b32_dpp v82, v90 quad_perm:[0,1,2,3] row_mask:0xf bank_mask:0x4
    v_mov_b32_dpp v83, v91 quad_perm:[0,1,2,3] row_mask:0xf bank_mask:0x4
    v_mov_b32_dpp v80, v92 quad_perm:[0,1,2,3] row_mask:0xf bank_mask:0x8
    v_mov_b32_dpp v81, v93 quad_perm:[0,1,2,3] row_mask:0xf bank_mask:0x8
    v_mov_b32_dpp v82, v94 quad_perm:[0,1,2,3] row_mask:0xf bank_mask:0x8
    v_mov_b32_dpp v83, v95 quad_perm:[0,1,2,3] row_mask:0xf bank_mask:0x8
    s_cmp_ge_u32 s52, 10
    s_cbranch_scc1 L_noz
    v_add_f32 v80, 0x3e800000, v80
    v_add_f32 v81, 0x3e800000, v81
    v_add_f32 v82, 0x3e800000, v82
    v_add_f32 v83, 0x3e800000, v83
    v_mul_f32 v80, v80, v24
    v_mul_f32 v81, v81, v25
    v_mul_f32 v82, v82, v26
    v_mul_f32 v83, v83, v27
L_noz:
    v_cvt_pk_bf16_f32 v20, v80, v81
    v_cvt_pk_bf16_f32 v21, v82, v83
    v_min_u32 v20, -2, v20
    v_min_u32 v21, -2, v21
    v_mov_b32 v22, 99072
    s_mov_b32 s35, 0
L_poll1:
    ds_read_b32 v23, v22
    s_add_u32 s35, s35, 1
    s_waitcnt lgkmcnt(0)
    v_cmp_gt_u32 vcc, 14, v23
    s_cbranch_vccz L_done2
    s_sleep 2
    s_cmp_lt_u32 s35, 60000
    s_cbranch_scc1 L_poll1
L_done2:
    v_and_b32 v22, 15, v0
    v_lshlrev_b32 v22, 2, v22
    s_mov_b32 s35, 0
L_poll4:
    global_load_dword v23, v22, s[30:31] offset:128 sc1
    s_add_u32 s35, s35, 1
    s_waitcnt vmcnt(0)
    v_cmp_eq_u32 vcc, 0, v23
    s_cbranch_vccz L_done5
    s_sleep 8
    s_cmp_lt_u32 s35, 60000
    s_cbranch_scc1 L_poll4
L_done5:
    s_getreg_b32 s97, hwreg(HW_REG_XCC_ID, 0, 4)
    s_sub_u32 s97, s97, s2
    s_and_b32 s97, s97, 7
    s_add_u32 s97, s97, 1
    v_cmp_ne_u32 vcc, s97, v23
    s_nop 0
    s_mov_b32 s97, vcc_lo
    buffer_store_dwordx2 v[20:21], v19, s[44:47], 0 offen sc1
    s_branch L_p2
L_clear:
    s_sub_u32 s55, s2, 240
    s_lshr_b32 s34, s55, 2
    s_lshl_b32 s35, s34, 3
    s_lshr_b32 s54, 538910750, s35
    s_and_b32 s54, s54, 0xff
    s_lshl_b32 s54, s54, 10
    s_mul_i32 s34, s34, 393216
    s_lshl_b32 s35, s51, 15
    s_add_u32 s34, s34, s35
    v_lshl_add_u32 v9, v0, 4, s34
    v_mov_b32 v4, -1
    v_mov_b32 v5, -1
    v_mov_b32 v6, -1
    v_mov_b32 v7, -1
    s_lshl_b32 s34, s3, 10
L_clrloop:
    buffer_store_dwordx4 v[4:7], v9, s[44:47], s34 offen offset:0 sc1
    s_add_u32 s34, s34, 1024
    s_cmp_lt_u32 s34, s54
    s_cbranch_scc1 L_clrloop
L_clrend:
    s_cmp_ge_u32 s55, 4
    s_cbranch_scc1 L_clrend2
    s_mov_b32 s34, 1572864
    buffer_store_dwordx4 v[4:7], v9, s[44:47], s34 offen sc1
    s_mov_b32 s34, 1573888
    buffer_store_dwordx4 v[4:7], v9, s[44:47], s34 offen sc1
    s_mov_b32 s34, 1574912
    buffer_store_dwordx4 v[4:7], v9, s[44:47], s34 offen sc1
    s_mov_b32 s34, 1575936
    buffer_store_dwordx4 v[4:7], v9, s[44:47], s34 offen sc1
    s_mov_b32 s34, 1576960
    buffer_store_dwordx4 v[4:7], v9, s[44:47], s34 offen sc1
L_clrend2:
    s_lshr_b32 s35, s55, 2
    s_mul_i32 s35, s35, -385024
    s_add_u32 s34, s35, 1709056
    buffer_store_dwordx4 v[4:7], v9, s[44:47], s34 offen sc1
    s_add_u32 s34, s35, 1710080
    buffer_store_dwordx4 v[4:7], v9, s[44:47], s34 offen sc1
    v_lshlrev_b32 v1, 2, v0
    v_add_u32 v1, 98304, v1
    v_mov_b32 v2, -1
    v_mov_b32 v3, 0
    ds_write_b32 v1, v2
    ds_write_b32 v1, v2 offset:256
    ds_write_b32 v1, v3 offset:512
    ds_write_b32 v1, v3 offset:768
    s_waitcnt lgkmcnt(0)
    s_barrier
    s_lshl_b32 s34, s55, 2
    v_mov_b32 v24, s34
    s_getreg_b32 s97, hwreg(HW_REG_XCC_ID, 0, 4)
    s_sub_u32 s97, s97, s2
    s_and_b32 s97, s97, 7
    s_add_u32 s97, s97, 1
    v_mov_b32 v25, s97
    v_readfirstlane_b32 s90, v9
    s_mov_b32 s91, 0
    s_waitcnt vmcnt(0)
    s_mov_b64 exec, 1
    global_store_dword v24, v25, s[30:31] offset:128 sc1
    s_mov_b64 exec, -1
    v_lshl_add_u32 v15, v14, 3, v13
    v_lshlrev_b32 v15, 7, v15
    v_lshl_add_u32 v15, v12, 3, v15
    s_cmp_ge_u32 s55, 6
    s_cbranch_scc1 L_novote
    s_add_u32 s34, s90, 0
    s_add_u32 s35, s90, 8192
    s_mov_b64 s[88:89], 0
    s_load_dword s88, s[44:45], s34
    s_load_dword s89, s[44:45], s35
    s_waitcnt lgkmcnt(1)
    s_cmp_lg_u32 s89, 0
    s_addc_u32 s91, s91, 0
    s_waitcnt lgkmcnt(0)
    s_add_u32 s34, s90, 1024
    s_add_u32 s35, s90, 9216
    s_mov_b64 s[88:89], 0
    s_load_dword s89, s[44:45], s35
    s_load_dword s88, s[44:45], s34
    s_waitcnt lgkmcnt(1)
    s_cmp_eq_u32 s88, 0
    s_addc_u32 s91, s91, 0
    s_waitcnt lgkmcnt(0)
    s_add_u32 s34, s90, 2048
    s_add_u32 s35, s90, 10240
    s_mov_b64 s[88:89], 0
    s_load_dword s88, s[44:45], s34
    s_load_dword s89, s[44:45], s35
    s_waitcnt lgkmcnt(1)
    s_cmp_lg_u32 s89, 0
    s_addc_u32 s91, s91, 0
    s_waitcnt lgkmcnt(0)
    s_add_u32 s34, s90, 3072
    s_add_u32 s35, s90, 11264
    s_mov_b64 s[88:89], 0
    s_load_dword s89, s[44:45], s35
    s_load_dword s88, s[44:45], s34
    s_waitcnt lgkmcnt(1)
    s_cmp_eq_u32 s88, 0
    s_addc_u32 s91, s91, 0
    s_waitcnt lgkmcnt(0)
    s_getreg_b32 s34, hwreg(HW_REG_XCC_ID, 2, 1)
    s_sub_u32 s35, 2, s91
    s_sub_u32 s91, s91, 2
    s_cmp_eq_u32 s34, 0
    s_cselect_b32 s91, s91, s35
    v_mov_b32 v25, s91
    s_mov_b64 exec, 1
    global_store_dword v24, v25, s[30:31] sc1
    s_mov_b64 exec, -1
L_novote:
    v_mov_b32 v22, 99072
    s_mov_b32 s35, 0
L_poll7:
    ds_read_b32 v23, v22
    s_add_u32 s35, s35, 1
    s_waitcnt lgkmcnt(0)
    v_cmp_gt_u32 vcc, 14, v23
    s_cbranch_vccz L_done8
    s_sleep 2
    s_cmp_lt_u32 s35, 60000
    s_cbranch_scc1 L_poll7
L_done8:
    v_and_b32 v22, 15, v0
    v_lshlrev_b32 v22, 2, v22
    s_mov_b32 s35, 0
L_poll10:
    global_load_dword v23, v22, s[30:31] offset:128 sc1
    s_add_u32 s35, s35, 1
    s_waitcnt vmcnt(0)
    v_cmp_eq_u32 vcc, 0, v23
    s_cbranch_vccz L_done11
    s_sleep 8
    s_cmp_lt_u32 s35, 60000
    s_cbranch_scc1 L_poll10
L_done11:
    s_getreg_b32 s97, hwreg(HW_REG_XCC_ID, 0, 4)
    s_sub_u32 s97, s97, s2
    s_and_b32 s97, s97, 7
    s_add_u32 s97, s97, 1
    v_cmp_ne_u32 vcc, s97, v23
    s_nop 0
    s_mov_b32 s97, vcc_lo
L_p2:
    v_mov_b32 v199, v19
    ds_read_b64_tr_b16 v[96:97], v15 offset:20480
    ds_read_b64_tr_b16 v[98:99], v15 offset:20992
    ds_read_b64_tr_b16 v[100:101], v15 offset:20512
    ds_read_b64_tr_b16 v[102:103], v15 offset:21024
    ds_read_b64_tr_b16 v[104:105], v15 offset:20544
    ds_read_b64_tr_b16 v[106:107], v15 offset:21056
    ds_read_b64_tr_b16 v[108:109], v15 offset:20576
    ds_read_b64_tr_b16 v[110:111], v15 offset:21088
    s_waitcnt lgkmcnt(7)
    ds_read_b64_tr_b16 v[112:113], v15 offset:24576
    ds_read_b64_tr_b16 v[114:115], v15 offset:25088
    ds_read_b64_tr_b16 v[116:117], v15 offset:24608
    ds_read_b64_tr_b16 v[118:119], v15 offset:25120
    ds_read_b64_tr_b16 v[120:121], v15 offset:24640
    ds_read_b64_tr_b16 v[122:123], v15 offset:25152
    ds_read_b64_tr_b16 v[124:125], v15 offset:24672
    ds_read_b64_tr_b16 v[126:127], v15 offset:25184
    s_waitcnt lgkmcnt(7)
    ds_read_b64_tr_b16 v[128:129], v15 offset:28672
    ds_read_b64_tr_b16 v[130:131], v15 offset:29184
    ds_read_b64_tr_b16 v[132:133], v15 offset:28704
    ds_read_b64_tr_b16 v[134:135], v15 offset:29216
    ds_read_b64_tr_b16 v[136:137], v15 offset:28736
    ds_read_b64_tr_b16 v[138:139], v15 offset:29248
    ds_read_b64_tr_b16 v[140:141], v15 offset:28768
    ds_read_b64_tr_b16 v[142:143], v15 offset:29280
    s_waitcnt lgkmcnt(7)
    ds_read_b64_tr_b16 v[144:145], v15 offset:32768
    ds_read_b64_tr_b16 v[146:147], v15 offset:33280
    ds_read_b64_tr_b16 v[148:149], v15 offset:32800
    ds_read_b64_tr_b16 v[150:151], v15 offset:33312
    ds_read_b64_tr_b16 v[152:153], v15 offset:32832
    ds_read_b64_tr_b16 v[154:155], v15 offset:33344
    ds_read_b64_tr_b16 v[156:157], v15 offset:32864
    ds_read_b64_tr_b16 v[158:159], v15 offset:33376
    s_waitcnt lgkmcnt(7)
    ds_read_b64_tr_b16 v[160:161], v15 offset:36864
    ds_read_b64_tr_b16 v[162:163], v15 offset:37376
    ds_read_b64_tr_b16 v[164:165], v15 offset:36896
    ds_read_b64_tr_b16 v[166:167], v15 offset:37408
    ds_read_b64_tr_b16 v[168:169], v15 offset:36928
    ds_read_b64_tr_b16 v[170:171], v15 offset:37440
    ds_read_b64_tr_b16 v[172:173], v15 offset:36960
    ds_read_b64_tr_b16 v[174:175], v15 offset:37472
    s_waitcnt lgkmcnt(0)
    s_mul_i32 s34, s53, 1280
    v_lshlrev_b32 v19, 15, v13
    v_lshl_add_u32 v19, v14, 6, v19
    v_lshl_add_u32 v19, v12, 4, v19
    v_add_u32 v19, s34, v19
    s_movk_i32 s48, 5120
    s_mov_b32 s56, 32768
    s_mov_b32 s57, 65536
    s_mov_b32 s58, 98304
    s_sub_u32 s34, s2, 80
    s_cmp_lt_u32 s34, 160
    s_cselect_b32 s54, 1, 0
    s_and_b32 s34, s2, 3
    s_cselect_b32 s54, 0, s54
    v_mov_b32 v180, 0
    v_mov_b32 v181, 0
    v_mov_b32 v182, 0
    v_mov_b32 v183, 0
    v_mov_b32 v184, 0
    v_mov_b32 v185, 0
    v_mov_b32 v186, 0
    v_mov_b32 v187, 0
    v_mov_b32 v22, 99072
    s_mov_b32 s35, 0
L_poll13:
    ds_read_b32 v23, v22
    s_add_u32 s35, s35, 1
    s_waitcnt lgkmcnt(0)
    v_cmp_gt_u32 vcc, 22, v23
    s_cbranch_vccz L_done14
    s_sleep 2
    s_cmp_lt_u32 s35, 60000
    s_cbranch_scc1 L_poll13
L_done14:
    s_mov_b32 s35, 0
L_poll16:
    buffer_load_dwordx4 v[32:35], v19, s[44:47], 0 offen offset:0 sc1
    buffer_load_dwordx4 v[36:39], v19, s[44:47], s48 offen offset:0 sc1
    buffer_load_dwordx4 v[40:43], v19, s[44:47], 0 offen offset:256 sc1
    buffer_load_dwordx4 v[44:47], v19, s[44:47], s48 offen offset:256 sc1
    buffer_load_dwordx4 v[48:51], v19, s[44:47], 0 offen offset:512 sc1
    buffer_load_dwordx4 v[52:55], v19, s[44:47], s48 offen offset:512 sc1
    buffer_load_dwordx4 v[56:59], v19, s[44:47], 0 offen offset:768 sc1
    buffer_load_dwordx4 v[60:63], v19, s[44:47], s48 offen offset:768 sc1
    buffer_load_dwordx4 v[64:67], v19, s[44:47], 0 offen offset:1024 sc1
    buffer_load_dwordx4 v[68:71], v19, s[44:47], s48 offen offset:1024 sc1
    s_cmp_eq_u32 s54, 0
    s_cbranch_scc1 L_hskip
    buffer_load_dwordx2 v[180:181], v199, s[44:47], 0 offen sc1
    buffer_load_dwordx2 v[182:183], v199, s[44:47], s56 offen sc1
    buffer_load_dwordx2 v[184:185], v199, s[44:47], s57 offen sc1
    buffer_load_dwordx2 v[186:187], v199, s[44:47], s58 offen sc1
L_hskip:
    s_add_u32 s35, s35, 1
    s_waitcnt vmcnt(0)
    v_max3_u32 v20, v32, v33, v34
    v_max3_u32 v20, v20, v35, v36
    v_max3_u32 v20, v20, v37, v38
    v_max3_u32 v20, v20, v39, v40
    v_max3_u32 v20, v20, v41, v42
    v_max3_u32 v20, v20, v43, v44
    v_max3_u32 v20, v20, v45, v46
    v_max3_u32 v20, v20, v47, v48
    v_max3_u32 v20, v20, v49, v50
    v_max3_u32 v20, v20, v51, v52
    v_max3_u32 v20, v20, v53, v54
    v_max3_u32 v20, v20, v55, v56
    v_max3_u32 v20, v20, v57, v58
    v_max3_u32 v20, v20, v59, v60
    v_max3_u32 v20, v20, v61, v62
    v_max3_u32 v20, v20, v63, v64
    v_max3_u32 v20, v20, v65, v66
    v_max3_u32 v20, v20, v67, v68
    v_max3_u32 v20, v20, v69, v70
    v_max3_u32 v20, v20, v71, v180
    v_max3_u32 v20, v20, v181, v182
    v_max3_u32 v20, v20, v183, v184
    v_max3_u32 v20, v20, v185, v186
    v_max_u32 v20, v20, v187
    v_cmp_eq_u32 vcc, -1, v20
    s_cbranch_vccz L_done17
    s_sleep 16
    s_cmp_lt_u32 s35, 60000
    s_cbranch_scc1 L_poll16
L_done17:
    v_mfma_f32_16x16x32_bf16 v[80:83], v[96:99], v[32:35], 0
    v_mfma_f32_16x16x32_bf16 v[84:87], v[100:103], v[32:35], 0
    v_mfma_f32_16x16x32_bf16 v[88:91], v[104:107], v[32:35], 0
    v_mfma_f32_16x16x32_bf16 v[92:95], v[108:111], v[32:35], 0
    v_mfma_f32_16x16x32_bf16 v[80:83], v[96:99], v[36:39], v[80:83]
    v_mfma_f32_16x16x32_bf16 v[84:87], v[100:103], v[36:39], v[84:87]
    v_mfma_f32_16x16x32_bf16 v[88:91], v[104:107], v[36:39], v[88:91]
    v_mfma_f32_16x16x32_bf16 v[92:95], v[108:111], v[36:39], v[92:95]
    v_mfma_f32_16x16x32_bf16 v[80:83], v[112:115], v[40:43], v[80:83]
    v_mfma_f32_16x16x32_bf16 v[84:87], v[116:119], v[40:43], v[84:87]
    v_mfma_f32_16x16x32_bf16 v[88:91], v[120:123], v[40:43], v[88:91]
    v_mfma_f32_16x16x32_bf16 v[92:95], v[124:127], v[40:43], v[92:95]
    v_mfma_f32_16x16x32_bf16 v[80:83], v[112:115], v[44:47], v[80:83]
    v_mfma_f32_16x16x32_bf16 v[84:87], v[116:119], v[44:47], v[84:87]
    v_mfma_f32_16x16x32_bf16 v[88:91], v[120:123], v[44:47], v[88:91]
    v_mfma_f32_16x16x32_bf16 v[92:95], v[124:127], v[44:47], v[92:95]
    v_mfma_f32_16x16x32_bf16 v[80:83], v[128:131], v[48:51], v[80:83]
    v_mfma_f32_16x16x32_bf16 v[84:87], v[132:135], v[48:51], v[84:87]
    v_mfma_f32_16x16x32_bf16 v[88:91], v[136:139], v[48:51], v[88:91]
    v_mfma_f32_16x16x32_bf16 v[92:95], v[140:143], v[48:51], v[92:95]
    v_mfma_f32_16x16x32_bf16 v[80:83], v[128:131], v[52:55], v[80:83]
    v_mfma_f32_16x16x32_bf16 v[84:87], v[132:135], v[52:55], v[84:87]
    v_mfma_f32_16x16x32_bf16 v[88:91], v[136:139], v[52:55], v[88:91]
    v_mfma_f32_16x16x32_bf16 v[92:95], v[140:143], v[52:55], v[92:95]
    v_mfma_f32_16x16x32_bf16 v[80:83], v[144:147], v[56:59], v[80:83]
    v_mfma_f32_16x16x32_bf16 v[84:87], v[148:151], v[56:59], v[84:87]
    v_mfma_f32_16x16x32_bf16 v[88:91], v[152:155], v[56:59], v[88:91]
    v_mfma_f32_16x16x32_bf16 v[92:95], v[156:159], v[56:59], v[92:95]
    v_mfma_f32_16x16x32_bf16 v[80:83], v[144:147], v[60:63], v[80:83]
    v_mfma_f32_16x16x32_bf16 v[84:87], v[148:151], v[60:63], v[84:87]
    v_mfma_f32_16x16x32_bf16 v[88:91], v[152:155], v[60:63], v[88:91]
    v_mfma_f32_16x16x32_bf16 v[92:95], v[156:159], v[60:63], v[92:95]
    v_mfma_f32_16x16x32_bf16 v[80:83], v[160:163], v[64:67], v[80:83]
    v_mfma_f32_16x16x32_bf16 v[84:87], v[164:167], v[64:67], v[84:87]
    v_mfma_f32_16x16x32_bf16 v[88:91], v[168:171], v[64:67], v[88:91]
    v_mfma_f32_16x16x32_bf16 v[92:95], v[172:175], v[64:67], v[92:95]
    v_mfma_f32_16x16x32_bf16 v[80:83], v[160:163], v[68:71], v[80:83]
    v_mfma_f32_16x16x32_bf16 v[84:87], v[164:167], v[68:71], v[84:87]
    v_mfma_f32_16x16x32_bf16 v[88:91], v[168:171], v[68:71], v[88:91]
    v_mfma_f32_16x16x32_bf16 v[92:95], v[172:175], v[68:71], v[92:95]
    s_lshl_b32 s34, s53, 15
    s_lshl_b32 s35, s49, 2
    s_add_u32 s34, s34, s35
    s_add_u32 s34, s34, 393216
    v_lshlrev_b32 v19, 7, v12
    v_lshl_add_u32 v19, v13, 5, v19
    v_lshl_add_u32 v19, v14, 3, v19
    v_add_u32 v19, s34, v19
    v_add_f32_dpp v20, v80, v80 row_ror:8 row_mask:0xf bank_mask:0x3
    v_add_f32_dpp v24, v84, v84 row_ror:8 row_mask:0xf bank_mask:0x3
    v_add_f32_dpp v21, v81, v81 row_ror:8 row_mask:0xf bank_mask:0x3
    v_add_f32_dpp v25, v85, v85 row_ror:8 row_mask:0xf bank_mask:0x3
    v_add_f32_dpp v22, v82, v82 row_ror:8 row_mask:0xf bank_mask:0x3
    v_add_f32_dpp v26, v86, v86 row_ror:8 row_mask:0xf bank_mask:0x3
    v_add_f32_dpp v23, v83, v83 row_ror:8 row_mask:0xf bank_mask:0x3
    v_add_f32_dpp v27, v87, v87 row_ror:8 row_mask:0xf bank_mask:0x3
    v_add_f32_dpp v20, v88, v88 row_ror:8 row_mask:0xf bank_mask:0xc
    v_add_f32_dpp v24, v92, v92 row_ror:8 row_mask:0xf bank_mask:0xc
    v_add_f32_dpp v21, v89, v89 row_ror:8 row_mask:0xf bank_mask:0xc
    v_add_f32_dpp v25, v93, v93 row_ror:8 row_mask:0xf bank_mask:0xc
    v_add_f32_dpp v22, v90, v90 row_ror:8 row_mask:0xf bank_mask:0xc
    v_add_f32_dpp v26, v94, v94 row_ror:8 row_mask:0xf bank_mask:0xc
    v_add_f32_dpp v23, v91, v91 row_ror:8 row_mask:0xf bank_mask:0xc
    v_add_f32_dpp v27, v95, v95 row_ror:8 row_mask:0xf bank_mask:0xc
    v_add_f32_dpp v28, v20, v20 row_shl:4 row_mask:0xf bank_mask:0x5
    v_add_f32_dpp v29, v21, v21 row_shl:4 row_mask:0xf bank_mask:0x5
    v_add_f32_dpp v30, v22, v22 row_shl:4 row_mask:0xf bank_mask:0x5
    v_add_f32_dpp v31, v23, v23 row_shl:4 row_mask:0xf bank_mask:0x5
    v_add_f32_dpp v28, v24, v24 row_shr:4 row_mask:0xf bank_mask:0xa
    v_add_f32_dpp v29, v25, v25 row_shr:4 row_mask:0xf bank_mask:0xa
    v_add_f32_dpp v30, v26, v26 row_shr:4 row_mask:0xf bank_mask:0xa
    v_add_f32_dpp v31, v27, v27 row_shr:4 row_mask:0xf bank_mask:0xa
    v_cvt_pk_bf16_f32 v20, v28, v29
    v_cvt_pk_bf16_f32 v21, v30, v31
    v_min_u32 v20, -2, v20
    v_min_u32 v21, -2, v21
    buffer_store_dwordx2 v[20:21], v19, s[44:47], 0 offen sc1
    s_cmp_eq_u32 s54, 0
    s_cbranch_scc1 L_nomf
    v_lshlrev_b32 v24, 16, v180
    v_and_b32 v25, 0xffff0000, v180
    v_lshlrev_b32 v26, 16, v181
    v_and_b32 v27, 0xffff0000, v181
    v_lshlrev_b32 v28, 16, v182
    v_and_b32 v29, 0xffff0000, v182
    v_lshlrev_b32 v30, 16, v183
    v_and_b32 v31, 0xffff0000, v183
    v_add_f32 v24, v24, v28
    v_add_f32 v25, v25, v29
    v_add_f32 v26, v26, v30
    v_add_f32 v27, v27, v31
    v_lshlrev_b32 v28, 16, v184
    v_and_b32 v29, 0xffff0000, v184
    v_lshlrev_b32 v30, 16, v185
    v_and_b32 v31, 0xffff0000, v185
    v_add_f32 v24, v24, v28
    v_add_f32 v25, v25, v29
    v_add_f32 v26, v26, v30
    v_add_f32 v27, v27, v31
    v_lshlrev_b32 v28, 16, v186
    v_and_b32 v29, 0xffff0000, v186
    v_lshlrev_b32 v30, 16, v187
    v_and_b32 v31, 0xffff0000, v187
    v_add_f32 v24, v24, v28
    v_add_f32 v25, v25, v29
    v_add_f32 v26, v26, v30
    v_add_f32 v27, v27, v31
    v_cvt_pk_bf16_f32 v22, v24, v25
    v_cvt_pk_bf16_f32 v23, v26, v27
    v_min_u32 v22, -2, v22
    v_min_u32 v23, -2, v23
    s_sub_u32 s34, s50, 20
    s_lshl_b32 s35, s34, 9
    v_subrev_u32 v199, s35, v199
    s_lshr_b32 s35, s34, 2
    s_lshl_b32 s35, s35, 9
    s_and_b32 s34, s34, 3
    s_lshl_b32 s34, s34, 15
    s_add_u32 s34, s34, s35
    s_add_u32 s34, s34, 1562624
    v_add_u32 v199, s34, v199
    buffer_store_dwordx2 v[22:23], v199, s[44:47], 0 offen sc1
L_nomf:
    s_and_b32 s34, s2, 127
    s_lshl_b32 s34, s34, 21
    s_lshr_b32 s35, s2, 7
    s_lshl_b32 s35, s35, 18
    s_add_u32 s34, s34, s35
    s_add_u32 s34, s34, 1572864
    s_mov_b32 s38, 0x40000
    s_mov_b32 s42, 0x40000
    s_waitcnt lgkmcnt(0)
    s_add_u32 s36, s6, s34
    s_addc_u32 s37, s7, 0
    s_add_u32 s40, s8, s34
    s_addc_u32 s41, s9, 0
    v_lshlrev_b32 v18, 4, v0
    s_mov_b32 s34, 258048
    buffer_load_dwordx4 v[128:131], v18, s[36:39], s34 offen offset:0 nt
    buffer_load_dwordx4 v[132:135], v18, s[36:39], s34 offen offset:1024 nt
    buffer_load_dwordx4 v[136:139], v18, s[36:39], s34 offen offset:2048 nt
    buffer_load_dwordx4 v[140:143], v18, s[36:39], s34 offen offset:3072 nt
    s_and_b32 s34, s2, 31
    s_lshl_b32 s34, s34, 10
    s_lshl_b32 s35, s53, 7
    s_add_u32 s34, s34, s35
    s_add_u32 s34, s34, 393216
    v_lshrrev_b32 v19, 5, v0
    v_mul_u32_u24 v19, 384, v19
    v_lshl_add_u32 v19, v0, 2, v19
    v_add_u32 v19, s34, v19
    v_mov_b32 v22, 99072
    s_and_b32 s34, s60, 3
    s_lshl_b32 s34, s34, 15
    s_lshr_b32 s35, s60, 2
    s_lshl_b32 s35, s35, 7
    s_add_u32 s34, s34, s35
    s_add_u32 s34, s34, 793344
    v_and_b32 v252, 31, v0
    v_lshl_add_u32 v252, v252, 2, s34
    v_mov_b32 v253, 0
    s_mov_b32 s35, 0
L_poll19:
    ds_read_b32 v23, v22
    s_add_u32 s35, s35, 1
    s_waitcnt lgkmcnt(0)
    v_cmp_gt_u32 vcc, 34, v23
    s_cbranch_vccz L_done20
    s_sleep 2
    s_cmp_lt_u32 s35, 60000
    s_cbranch_scc1 L_poll19
L_done20:
    buffer_load_dword v251, v252, s[44:47], 0 offen sc1
    s_lshl_b64 exec, 1, s61
    buffer_store_dword v253, v252, s[44:47], 0 offen
    s_mov_b64 exec, -1
    v_and_b32 v44, 15, v0
    v_lshlrev_b32 v44, 2, v44
    global_load_dword v44, v44, s[30:31] sc1
    s_mov_b32 s35, 0
L_poll22:
    buffer_load_dword v32, v19, s[44:47], 0 offen sc1
    buffer_load_dword v33, v19, s[44:47], s56 offen sc1
    buffer_load_dword v34, v19, s[44:47], s57 offen sc1
    buffer_load_dword v35, v19, s[44:47], s58 offen sc1
    s_add_u32 s35, s35, 1
    s_waitcnt vmcnt(0)
    v_max3_u32 v22, v32, v33, v34
    v_max_u32 v22, v22, v35
    v_cmp_eq_u32 vcc, -1, v22
    s_cbranch_vccz L_done23
    s_sleep 16
    s_cmp_lt_u32 s35, 60000
    s_cbranch_scc1 L_poll22
L_done23:
    v_cmp_ne_u32 vcc, -1, v251
    v_mov_b32 v252, 99076
    s_bcnt1_i32_b32 s34, vcc_lo
    v_mov_b32 v251, s34
    s_mov_b64 exec, 1
    ds_write_b32 v252, v251
    s_mov_b64 exec, -1
    v_add_u32_dpp v44, v44, v44 row_ror:8 row_mask:0xf bank_mask:0xf
    s_nop 1
    v_add_u32_dpp v44, v44, v44 row_ror:4 row_mask:0xf bank_mask:0xf
    s_nop 1
    v_add_u32_dpp v44, v44, v44 row_ror:2 row_mask:0xf bank_mask:0xf
    s_nop 1
    v_add_u32_dpp v44, v44, v44 row_ror:1 row_mask:0xf bank_mask:0xf
    s_nop 0
    v_readfirstlane_b32 s99, v44
    s_nop 0
    s_cmp_gt_i32 s99, 0
    s_cselect_b32 s99, 1, 0
    s_getreg_b32 s34, hwreg(HW_REG_XCC_ID, 2, 1)
    s_xor_b32 s99, s99, s34
    s_lshl_b32 s99, s99, 13
    v_mov_b32 v45, 99080
    v_mov_b32 v44, s99
    ds_write_b32 v45, v44
    v_lshlrev_b32 v36, 16, v32
    v_and_b32 v37, 0xffff0000, v32
    v_lshlrev_b32 v38, 16, v33
    v_and_b32 v39, 0xffff0000, v33
    v_lshlrev_b32 v40, 16, v34
    v_and_b32 v41, 0xffff0000, v34
    v_lshlrev_b32 v42, 16, v35
    v_and_b32 v43, 0xffff0000, v35
    v_pk_add_f32 v[36:37], v[36:37], v[38:39]
    v_pk_add_f32 v[40:41], v[40:41], v[42:43]
    v_pk_add_f32 v[36:37], v[36:37], v[40:41]
    v_cvt_pk_bf16_f32 v32, v36, v37
    v_min_u32 v32, -2, v32
    ds_write_b32 v1, v32
    s_mov_b32 s34, 258048
    buffer_load_dwordx4 v[144:147], v18, s[40:43], s34 offen offset:0 nt
    buffer_load_dwordx4 v[148:151], v18, s[40:43], s34 offen offset:1024 nt
    buffer_load_dwordx4 v[152:155], v18, s[40:43], s34 offen offset:2048 nt
    buffer_load_dwordx4 v[156:159], v18, s[40:43], s34 offen offset:3072 nt
    v_and_b32 v2, 15, v0
    v_lshlrev_b32 v2, 4, v2
    v_add_u32 v2, 98304, v2
    ds_read_b128 v[4:7], v2
    s_waitcnt lgkmcnt(0)
    v_dot2_f32_bf16 v8, v128, v4, 0
    v_dot2_f32_bf16 v9, v132, v4, 0
    v_dot2_f32_bf16 v10, v136, v4, 0
    v_dot2_f32_bf16 v11, v140, v4, 0
    v_dot2c_f32_bf16 v8, v129, v5
    v_dot2c_f32_bf16 v9, v133, v5
    v_dot2c_f32_bf16 v10, v137, v5
    v_dot2c_f32_bf16 v11, v141, v5
    v_dot2c_f32_bf16 v8, v130, v6
    v_dot2c_f32_bf16 v9, v134, v6
    v_dot2c_f32_bf16 v10, v138, v6
    v_dot2c_f32_bf16 v11, v142, v6
    v_dot2c_f32_bf16 v8, v131, v7
    v_dot2c_f32_bf16 v9, v135, v7
    v_dot2c_f32_bf16 v10, v139, v7
    v_dot2c_f32_bf16 v11, v143, v7
    v_add_f32_dpp v16, v8, v8 row_ror:8 row_mask:0xf bank_mask:0x3
    v_add_f32_dpp v16, v9, v9 row_ror:8 row_mask:0xf bank_mask:0xc
    v_add_f32_dpp v17, v10, v10 row_ror:8 row_mask:0xf bank_mask:0x3
    v_add_f32_dpp v17, v11, v11 row_ror:8 row_mask:0xf bank_mask:0xc
    v_add_f32_dpp v16, v16, v16 row_half_mirror row_mask:0xf bank_mask:0xf
    s_nop 0
    v_add_f32_dpp v17, v17, v17 row_half_mirror row_mask:0xf bank_mask:0xf
    v_add_f32_dpp v16, v16, v16 quad_perm:[1,0,3,2] row_mask:0xf bank_mask:0xf
    s_nop 0
    v_add_f32_dpp v17, v17, v17 quad_perm:[1,0,3,2] row_mask:0xf bank_mask:0xf
    v_add_f32_dpp v16, v16, v16 quad_perm:[2,3,0,1] row_mask:0xf bank_mask:0xf
    s_nop 0
    v_add_f32_dpp v17, v17, v17 quad_perm:[2,3,0,1] row_mask:0xf bank_mask:0xf
    v_max_f32 v8, v16, v17
    s_mov_b32 s34, 0x3e0293ee
    s_nop 0
    v_max_f32_dpp v8, v8, v8 row_ror:8 row_mask:0xf bank_mask:0xf
    v_mov_b32 v9, v8
    s_nop 1
    v_permlane16_swap_b32 v8, v9
    v_max_f32 v8, v8, v9
    v_mov_b32 v9, v8
    s_nop 1
    v_permlane32_swap_b32 v8, v9
    v_max_f32 v8, v8, v9
    v_mul_f32 v8, s34, v8
    v_fma_f32 v16, v16, s34, -v8
    v_fma_f32 v17, v17, s34, -v8
    v_exp_f32 v16, v16
    v_exp_f32 v17, v17
    s_nop 0
    v_add_f32 v9, v16, v17
    v_and_b32 v10, 1, v0
    v_lshlrev_b32 v10, 4, v10
    v_mov_b32 v11, 0xffff
    v_lshlrev_b32 v10, v10, v11
    v_bfe_u32 v11, v0, 1, 2
    v_cmp_eq_u32 vcc, 0, v11
    s_nop 1
    v_cndmask_b32 v20, 0, v10, vcc
    v_cmp_eq_u32 vcc, 1, v11
    s_nop 1
    v_cndmask_b32 v21, 0, v10, vcc
    v_cmp_eq_u32 vcc, 2, v11
    s_nop 1
    v_cndmask_b32 v22, 0, v10, vcc
    v_cmp_eq_u32 vcc, 3, v11
    s_nop 1
    v_cndmask_b32 v23, 0, v10, vcc
    v_add_f32_dpp v9, v9, v9 row_ror:8 row_mask:0xf bank_mask:0xf
    v_mov_b32 v10, v9
    s_nop 1
    v_permlane16_swap_b32 v9, v10
    v_add_f32 v9, v9, v10
    v_mov_b32 v10, v9
    s_nop 1
    v_permlane32_swap_b32 v9, v10
    v_add_f32 v9, v9, v10
    v_mov_b32 v10, 98616
    s_mov_b64 exec, 1
    ds_write_b64 v10, v[8:9]
    s_mov_b64 exec, -1
    s_waitcnt vmcnt(0)
    v_cvt_pk_bf16_f32 v10, v16, v16
    v_and_b32 v24, v10, v20
    v_and_b32 v25, v10, v21
    v_and_b32 v26, v10, v22
    v_and_b32 v27, v10, v23
    s_nop 1
    v_mfma_f32_16x16x32_bf16 v[116:119], v[144:147], v[24:27], 0
    v_mfma_f32_16x16x32_bf16 v[120:123], v[148:151], v[24:27], 0
    v_cvt_pk_bf16_f32 v10, v17, v17
    v_and_b32 v28, v10, v20
    v_and_b32 v29, v10, v21
    v_and_b32 v30, v10, v22
    v_and_b32 v31, v10, v23
    s_nop 1
    v_mfma_f32_16x16x32_bf16 v[116:119], v[152:155], v[28:31], v[116:119]
    v_mfma_f32_16x16x32_bf16 v[120:123], v[156:159], v[28:31], v[120:123]
    s_mov_b32 s34, 106496
    v_lshrrev_b32 v16, 4, v0
    v_and_b32 v17, 7, v0
    v_lshl_add_u32 v16, v16, 3, v17
    v_bfe_u32 v17, v0, 3, 1
    v_lshl_add_u32 v16, v17, 5, v16
    v_lshl_add_u32 v16, v16, 4, s34
    s_nop 0
    v_add_f32_dpp v116, v120, v116 row_ror:8 row_mask:0xf bank_mask:0xf
    v_add_f32_dpp v117, v121, v117 row_ror:8 row_mask:0xf bank_mask:0xf
    v_add_f32_dpp v118, v122, v118 row_ror:8 row_mask:0xf bank_mask:0xf
    v_add_f32_dpp v119, v123, v119 row_ror:8 row_mask:0xf bank_mask:0xf
    ds_write_b128 v16, v[116:119]
    v_lshl_add_u32 v16, v0, 3, s34
    ds_read_b64 v[116:117], v16
    s_waitcnt lgkmcnt(0)
    s_mov_b32 s63, 0
    s_mov_b32 s62, s61
    s_cmp_lt_u32 s61, 20
    s_cbranch_scc1 L_rd25
    s_mul_i32 s62, s60, 12
    s_add_u32 s62, s62, s61
    s_sub_u32 s62, s62, 20
    s_mov_b32 s63, 1
    s_cmp_lt_u32 s62, 54
    s_cbranch_scc1 L_rd25
    s_cmp_lt_u32 s62, 56
    s_cselect_b32 s63, 3, 2
    s_sub_u32 s62, s62, 56
L_rd25:
    v_and_b32 v8, 3, v0
    v_bfe_u32 v9, v0, 2, 2
    v_lshrrev_b32 v10, 4, v0
    s_mov_b32 s55, 0x20000
    s_lshl_b32 s35, s62, 6
    s_and_b32 s49, s62, 1
    s_cmp_eq_u32 s63, 0
    s_cbranch_scc1 L_dp27
    s_cmp_eq_u32 s63, 1
    s_cbranch_scc1 L_dp28
    s_mov_b32 s52, s20
    s_mov_b32 s53, s21
    s_mov_b32 s54, 2211840
    v_mov_b32 v15, 0
    s_branch L_dp29
L_dp28:
    s_mov_b32 s52, s16
    s_mov_b32 s53, s17
    s_mov_b32 s54, 2211840
    v_lshl_add_u32 v15, v9, 3, v10
    v_mul_u32_u24 v15, 3456, v15
    v_lshl_add_u32 v15, v8, 4, v15
    v_add_u32 v15, s35, v15
    s_bfe_u32 s50, s3, 0x10001
    s_lshl_b32 s50, s50, 7
    s_and_b32 s34, s3, 1
    s_lshl_b32 s34, s34, 2
    s_add_u32 s50, s50, s34
    s_and_b32 s51, s3, 3
    s_lshl_b32 s51, s51, 5
    s_add_u32 s51, s51, 512
    s_mul_i32 s50, s50, 3456
    s_mul_i32 s51, s51, 3456
    s_branch L_dp29
L_dp27:
    s_mov_b32 s52, s12
    s_mov_b32 s53, s13
    s_mov_b32 s54, 5242880
    s_lshr_b32 s50, s3, 1
    s_lshl_b32 s50, s50, 3
    s_add_u32 s50, s50, s60
    s_and_b32 s51, s3, 1
    s_lshl_b32 s34, s50, 1
    s_add_u32 s34, s34, s51
    s_mul_i32 s34, s34, 81920
    s_add_u32 s34, s34, s35
    v_lshl_add_u32 v15, v9, 2, v10
    v_mul_u32_u24 v15, 2560, v15
    v_lshl_add_u32 v15, v8, 4, v15
    v_add_u32 v15, s34, v15
    s_lshl_b32 s56, s3, 12
    s_lshl_b32 s34, s49, 11
    s_add_u32 s56, s56, s34
    s_add_u32 s56, s56, 40960
    s_add_u32 s58, s56, 1024
    s_mul_i32 s57, s49, 40960
    s_add_u32 s59, s57, 1280
L_dp29:
    v_and_b32 v200, 3, v0
    v_bfe_u32 v201, v0, 2, 2
    v_lshrrev_b32 v202, 4, v0
    s_lshl_b32 s34, s3, 10
    s_add_u32 s34, s34, 122112
    v_mul_u32_u24 v203, 320, v201
    v_min_u32 v203, 704, v203
    v_lshl_add_u32 v203, v202, 6, v203
    v_lshl_add_u32 v203, v200, 4, v203
    v_add_u32 v203, s34, v203
    s_movk_i32 s48, 16384
    v_mov_b32 v197, 0
    s_mov_b32 s40, 0
    s_mov_b32 s41, 0
    s_mov_b32 s42, 0
    s_cmp_eq_u32 s63, 0
    s_cbranch_scc1 L_d_wo
    s_cmp_eq_u32 s63, 2
    s_cbranch_scc1 L_d_w2
    s_cmp_eq_u32 s63, 3
    s_cbranch_scc1 L_d_none
    v_and_b32 v205, 15, v0
    v_lshlrev_b32 v205, 4, v205
    s_and_b32 s49, s3, 3
    s_mul_i32 s34, s49, 1280
    s_add_u32 s34, s34, s99
    s_add_u32 s34, s34, 786432
    v_lshl_add_u32 v206, v202, 15, v205
    v_add_u32 v206, s34, v206
    s_mul_i32 s34, s49, 3840
    v_add_u32 v205, s34, v205
    s_lshl_b32 s34, s62, 6
    v_lshlrev_b32 v5, 4, v14
    v_lshl_add_u32 v5, v12, 2, v5
    v_add_u32 v5, s34, v5
    global_load_dword v6, v5, s[18:19]
    v_and_b32 v7, 15, v0
    v_lshlrev_b32 v7, 4, v7
    v_mul_u32_u24 v8, 1280, v14
    v_add_u32 v8, v8, v7
    v_bfe_u32 v9, v0, 3, 1
    v_lshlrev_b32 v9, 15, v9
    v_lshl_add_u32 v9, v14, 7, v9
    v_and_b32 v10, 7, v0
    v_lshl_add_u32 v9, v10, 4, v9
    v_add_u32 v9, 1572864, v9
    s_mov_b32 s57, 65536
    v_mul_u32_u24 v5, 3840, v14
    v_add_u32 v5, v5, v7
    global_load_dwordx4 v[32:35], v8, s[4:5] offset:0
    global_load_dwordx4 v[36:39], v8, s[4:5] offset:256
    global_load_dwordx4 v[40:43], v8, s[4:5] offset:512
    global_load_dwordx4 v[44:47], v8, s[4:5] offset:768
    global_load_dwordx4 v[48:51], v8, s[4:5] offset:1024
    s_mov_b32 s35, 0
L_poll30:
    buffer_load_dwordx4 v[52:55], v9, s[44:47], s57 offen offset:1024 sc1
    buffer_load_dwordx4 v[56:59], v9, s[44:47], 0 offen offset:1536 sc1
    buffer_load_dwordx4 v[60:63], v9, s[44:47], s57 offen offset:1536 sc1
    buffer_load_dwordx4 v[64:67], v9, s[44:47], 0 offen offset:2048 sc1
    buffer_load_dwordx4 v[68:71], v9, s[44:47], s57 offen offset:2048 sc1
    buffer_load_dwordx4 v[72:75], v9, s[44:47], 0 offen offset:2560 sc1
    buffer_load_dwordx4 v[76:79], v9, s[44:47], s57 offen offset:2560 sc1
    buffer_load_dwordx4 v[80:83], v9, s[44:47], 0 offen offset:3072 sc1
    buffer_load_dwordx4 v[84:87], v9, s[44:47], s57 offen offset:3072 sc1
    buffer_load_dwordx4 v[88:91], v9, s[44:47], 0 offen offset:3584 sc1
    s_add_u32 s35, s35, 1
    s_waitcnt vmcnt(0)
    v_max3_u32 v28, v52, v53, v54
    v_max3_u32 v28, v28, v55, v56
    v_max3_u32 v28, v28, v57, v58
    v_max3_u32 v28, v28, v59, v60
    v_max3_u32 v28, v28, v61, v62
    v_max3_u32 v28, v28, v63, v64
    v_max3_u32 v28, v28, v65, v66
    v_max3_u32 v28, v28, v67, v68
    v_max3_u32 v28, v28, v69, v70
    v_max3_u32 v28, v28, v71, v72
    v_max3_u32 v28, v28, v73, v74
    v_max3_u32 v28, v28, v75, v76
    v_max3_u32 v28, v28, v77, v78
    v_max3_u32 v28, v28, v79, v80
    v_max3_u32 v28, v28, v81, v82
    v_max3_u32 v28, v28, v83, v84
    v_max3_u32 v28, v28, v85, v86
    v_max3_u32 v28, v28, v87, v88
    v_max3_u32 v28, v28, v89, v90
    v_max_u32 v28, v28, v91
    v_cmp_eq_u32 vcc, -1, v28
    s_cbranch_vccz L_done31
    s_sleep 16
    s_cmp_lt_u32 s35, 60000
    s_cbranch_scc1 L_poll30
L_done31:
    ds_write_b128 v5, v[32:35] offset:0
    ds_write_b128 v5, v[36:39] offset:256
    ds_write_b128 v5, v[40:43] offset:512
    ds_write_b128 v5, v[44:47] offset:768
    ds_write_b128 v5, v[48:51] offset:1024
    ds_write_b128 v5, v[52:55] offset:1280
    ds_write_b128 v5, v[56:59] offset:1536
    ds_write_b128 v5, v[60:63] offset:1792
    ds_write_b128 v5, v[64:67] offset:2048
    ds_write_b128 v5, v[68:71] offset:2304
    ds_write_b128 v5, v[72:75] offset:2560
    ds_write_b128 v5, v[76:79] offset:2816
    ds_write_b128 v5, v[80:83] offset:3072
    ds_write_b128 v5, v[84:87] offset:3328
    ds_write_b128 v5, v[88:91] offset:3584
    s_waitcnt lgkmcnt(0)
    v_lshlrev_b32 v100, 16, v6
    v_and_b32 v101, 0xffff0000, v6
    s_cmp_eq_u32 s60, 4
    s_cselect_b32 s40, 6, 12
    s_mov_b32 s41, 5462
    s_cmov_b32 s41, 10923
    s_cselect_b32 s34, 20, 20
    s_mov_b32 s49, 17280
    s_cmov_b32 s49, 34560
    v_min_u32 v196, 59, v0
    v_mul_u32_u24 v197, s41, v196
    v_lshrrev_b32 v197, 16, v197
    v_mul_u32_u24 v194, s40, v197
    v_sub_u32 v196, v196, v194
    v_mul_u32_u24 v197, 3456, v197
    v_lshl_add_u32 v197, v196, 6, v197
    s_mul_i32 s35, s60, 768
    s_add_i32 s35, s35, 0
    s_cmp_eq_u32 s60, 4
    s_cselect_b32 s35, 3072, s35
    s_sub_u32 s34, s61, s34
    s_mul_i32 s34, s34, s49
    s_mul_i32 s34, s34, 11
    s_add_u32 s34, s34, s35
    v_add_u32 v197, s34, v197
    s_mov_b32 s40, s49
    s_mov_b32 s41, s49
    s_branch L_d_none
L_d_w2:
    s_lshl_b32 s34, s62, 5
    v_lshl_add_u32 v3, v14, 3, s34
    global_load_dwordx2 v[20:21], v3, s[22:23]
    v_mul_u32_u24 v112, 1280, v12
    v_add_u32 v112, v112, v3
    global_load_dwordx2 v[22:23], v112, s[4:5]
    s_lshr_b32 s34, s62, 2
    s_add_u32 s34, s34, 30
    s_lshr_b32 s35, s34, 2
    s_lshl_b32 s35, s35, 9
    s_and_b32 s34, s34, 3
    s_lshl_b32 s34, s34, 15
    s_add_u32 s34, s34, s35
    s_and_b32 s35, s62, 3
    s_mul_i32 s35, s35, 32
    s_add_u32 s34, s34, s35
    s_add_u32 s34, s34, 1572864
    v_lshlrev_b32 v5, 7, v12
    v_lshl_add_u32 v5, v14, 3, v5
    v_add_u32 v5, s34, v5
    s_waitcnt vmcnt(0)
    v_lshlrev_b32 v32, 16, v20
    v_and_b32 v33, 0xffff0000, v20
    v_lshlrev_b32 v34, 16, v21
    v_and_b32 v35, 0xffff0000, v21
    v_lshlrev_b32 v108, 16, v22
    v_and_b32 v109, 0xffff0000, v22
    v_lshlrev_b32 v110, 16, v23
    v_and_b32 v111, 0xffff0000, v23
    s_mov_b32 s35, 0
L_poll33:
    buffer_load_dwordx2 v[24:25], v5, s[44:47], 0 offen sc1
    s_add_u32 s35, s35, 1
    s_waitcnt vmcnt(0)
    v_max_u32 v28, v24, v25
    v_cmp_eq_u32 vcc, -1, v28
    s_cbranch_vccz L_done34
    s_sleep 16
    s_cmp_lt_u32 s35, 60000
    s_cbranch_scc1 L_poll33
L_done34:
    v_lshlrev_b32 v104, 16, v24
    v_and_b32 v105, 0xffff0000, v24
    v_lshlrev_b32 v106, 16, v25
    v_and_b32 v107, 0xffff0000, v25
    v_fma_f32 v108, v104, v32, v108
    v_fma_f32 v109, v105, v33, v109
    v_fma_f32 v110, v106, v34, v110
    v_fma_f32 v111, v107, v35, v111
    v_mul_f32 v108, 0x3e800000, v108
    v_mul_f32 v109, 0x3e800000, v109
    v_mul_f32 v110, 0x3e800000, v110
    v_mul_f32 v111, 0x3e800000, v111
    v_lshl_add_u32 v204, v13, 15, v112
    s_add_u32 s34, s99, 786432
    v_add_u32 v204, s34, v204
    s_cmp_eq_u32 s60, 4
    s_cselect_b32 s40, 2, 6
    s_mov_b32 s41, 10923
    s_cmov_b32 s41, 32769
    s_cselect_b32 s34, 28, 20
    s_mov_b32 s49, 12800
    s_cmov_b32 s49, 38400
    v_min_u32 v196, 59, v0
    v_mul_u32_u24 v197, s41, v196
    v_lshrrev_b32 v197, 16, v197
    v_mul_u32_u24 v194, s40, v197
    v_sub_u32 v196, v196, v194
    v_mul_u32_u24 v197, 1280, v197
    v_lshl_add_u32 v197, v196, 6, v197
    s_mul_i32 s35, s60, 384
    s_add_i32 s35, s35, -1792
    s_cmp_eq_u32 s60, 4
    s_cselect_b32 s35, 0, s35
    s_sub_u32 s34, s61, s34
    s_mul_i32 s34, s34, s49
    s_mul_i32 s34, s34, 15
    s_add_u32 s34, s34, s35
    v_add_u32 v197, s34, v197
    s_mov_b32 s40, s49
    s_mov_b32 s41, s49
    s_branch L_d_none
L_d_wo:
    s_lshr_b32 s49, s3, 1
    s_lshl_b32 s49, s49, 15
    v_and_b32 v210, 7, v0
    s_mul_i32 s34, s60, 4096
    s_add_u32 s34, s34, s49
    s_add_u32 s34, s34, 1179904
    v_lshrrev_b32 v211, 3, v0
    v_mul_u32_u24 v205, 512, v211
    v_add_u32 v204, s34, v205
    s_lshl_b32 s35, s51, 7
    s_add_u32 s34, s34, s35
    s_sub_u32 s34, s34, 256
    v_lshl_add_u32 v205, v210, 4, v205
    v_add_u32 v205, s34, v205
    s_lshl_b32 s34, s3, 12
    s_add_u32 s34, s34, 40960
    v_lshrrev_b32 v206, 2, v0
    v_lshlrev_b32 v206, 6, v206
    v_lshl_add_u32 v206, v200, 3, v206
    v_add_u32 v206, s34, v206
    s_mul_i32 s34, s3, 1152
    s_add_u32 s34, s34, 107520
    v_mul_u32_u24 v207, 144, v211
    v_lshl_add_u32 v207, v210, 4, v207
    v_add_u32 v207, s34, v207
    v_mul_u32_u24 v208, 144, v210
    v_lshl_add_u32 v208, v202, 4, v208
    v_add_u32 v208, s34, v208
    v_mul_u32_u24 v212, 144, v211
    v_add_u32 v212, s34, v212
    v_mul_u32_u24 v213, 144, v210
    v_add_u32 v213, s34, v213
    v_and_b32 v211, 1, v211
    v_bfe_u32 v203, v0, 1, 2
    v_mul_u32_u24 v203, 144, v203
    v_and_b32 v214, 1, v0
    v_mul_u32_u24 v214, 576, v214
    v_lshl_add_u32 v214, v211, 6, v214
    v_lshl_add_u32 v214, v202, 4, v214
    s_add_u32 s34, s34, 14592
    v_add3_u32 v203, v203, v214, s34
    v_mov_b32 v210, 98816
    v_cmp_eq_u32 vcc, 0, v211
    s_nop 1
    v_cndmask_b32 v209, v208, v210, vcc
    v_cndmask_b32 v208, v210, v208, vcc
    v_and_b32 v8, 15, v0
    s_lshr_b32 s34, s62, 1
    s_add_u32 s34, s34, 0
    s_lshr_b32 s35, s34, 2
    s_lshl_b32 s35, s35, 9
    s_and_b32 s34, s34, 3
    s_lshl_b32 s34, s34, 15
    s_add_u32 s34, s34, s35
    s_and_b32 s35, s62, 1
    s_mul_i32 s35, s35, 64
    s_add_u32 s34, s34, s35
    s_add_u32 s34, s34, 1572864
    v_lshlrev_b32 v9, 2, v8
    v_lshl_add_u32 v9, v14, 7, v9
    v_add_u32 v9, s34, v9
    s_lshr_b32 s34, s60, 2
    s_lshl_b32 s34, s34, 14
    s_and_b32 s35, s60, 3
    s_lshl_b32 s35, s35, 15
    s_add_u32 s34, s34, s35
    s_lshl_b32 s35, s62, 6
    s_add_u32 s34, s34, s35
    s_add_u32 s34, s34, 786432
    v_mul_u32_u24 v112, 1280, v14
    v_lshl_add_u32 v112, v8, 2, v112
    v_add_u32 v112, s34, v112
    v_add_u32 v114, 917504, v112
    v_mul_u32_u24 v113, 144, v14
    v_lshl_add_u32 v113, v8, 3, v113
    v_add_u32 v113, 122112, v113
    s_bfe_u32 s35, s60, 0x10002
    s_lshl_b32 s35, s35, 13
    s_xor_b32 s101, s99, s35
    s_xor_b32 s93, s101, 8192
    s_mul_i32 s34, s62, 52
    s_lshr_b32 s34, s34, 8
    s_mul_i32 s35, s34, 5
    s_sub_u32 s35, s62, s35
    s_mul_i32 s34, s34, 1310720
    s_lshl_b32 s35, s35, 15
    s_add_u32 s34, s34, s35
    s_mul_i32 s35, s60, 163840
    s_add_u32 s34, s34, s35
    v_lshl_add_u32 v197, v0, 6, s34
    s_movk_i32 s40, 4096
    s_movk_i32 s41, 4096
    s_mov_b32 s35, 0
L_poll36:
    buffer_load_dword v32, v9, s[44:47], 0 offen sc1
    s_add_u32 s35, s35, 1
    s_waitcnt vmcnt(0)
    v_mov_b32 v22, v32
    v_cmp_eq_u32 vcc, -1, v22
    s_cbranch_vccz L_done37
    s_sleep 16
    s_cmp_lt_u32 s35, 60000
    s_cbranch_scc1 L_poll36
L_done37:
    v_lshlrev_b32 v100, 16, v32
    v_and_b32 v101, 0xffff0000, v32
L_d_none:
    v_mov_b32 v22, 99072
    s_and_b32 s34, s60, 3
    s_lshl_b32 s34, s34, 15
    s_lshr_b32 s35, s60, 2
    s_lshl_b32 s35, s35, 7
    s_add_u32 s34, s34, s35
    s_add_u32 s34, s34, 793600
    v_and_b32 v252, 31, v0
    v_lshl_add_u32 v252, v252, 2, s34
    v_mov_b32 v253, 0
    s_mov_b32 s35, 0
L_poll39:
    ds_read_b32 v23, v22
    s_add_u32 s35, s35, 1
    s_waitcnt lgkmcnt(0)
    v_cmp_gt_u32 vcc, 46, v23
    s_cbranch_vccz L_done40
    s_sleep 2
    s_cmp_lt_u32 s35, 60000
    s_cbranch_scc1 L_poll39
L_done40:
    buffer_load_dword v251, v252, s[44:47], 0 offen sc1
    s_lshl_b64 exec, 1, s61
    buffer_store_dword v253, v252, s[44:47], 0 offen
    s_mov_b64 exec, -1
    s_waitcnt vmcnt(1)
    v_cmp_ne_u32 vcc, -1, v251
    v_mov_b32 v252, 99076
    s_bcnt1_i32_b32 s34, vcc_lo
    v_mov_b32 v251, s34
    s_mov_b64 exec, 1
    ds_write_b32 v252, v251
    s_mov_b64 exec, -1
    v_mov_b32 v22, 99072
    s_and_b32 s34, s60, 3
    s_lshl_b32 s34, s34, 15
    s_lshr_b32 s35, s60, 2
    s_lshl_b32 s35, s35, 7
    s_add_u32 s34, s34, s35
    s_add_u32 s34, s34, 793856
    v_and_b32 v252, 31, v0
    v_lshl_add_u32 v252, v252, 2, s34
    v_mov_b32 v253, 0
    s_mov_b32 s35, 0
L_poll42:
    ds_read_b32 v23, v22
    s_add_u32 s35, s35, 1
    s_waitcnt lgkmcnt(0)
    v_cmp_gt_u32 vcc, 57, v23
    s_cbranch_vccz L_done43
    s_sleep 2
    s_cmp_lt_u32 s35, 60000
    s_cbranch_scc1 L_poll42
L_done43:
    buffer_load_dword v251, v252, s[44:47], 0 offen sc1
    s_lshl_b64 exec, 1, s61
    buffer_store_dword v253, v252, s[44:47], 0 offen
    s_mov_b64 exec, -1
    s_waitcnt vmcnt(1)
    v_cmp_ne_u32 vcc, -1, v251
    v_mov_b32 v252, 99076
    s_bcnt1_i32_b32 s34, vcc_lo
    v_mov_b32 v251, s34
    s_mov_b64 exec, 1
    ds_write_b32 v252, v251
    s_mov_b64 exec, -1
    v_and_b32 v19, 7, v0
    v_lshlrev_b32 v19, 3, v19
    v_add_u32 v19, 98560, v19
    s_mov_b32 s35, 0
L_poll45:
    ds_read_b64 v[20:21], v19
    s_add_u32 s35, s35, 1
    s_waitcnt lgkmcnt(0)
    v_max_u32 v22, v20, v21
    v_cmp_eq_u32 vcc, -1, v22
    s_cbranch_vccz L_done46
    s_sleep 2
    s_cmp_lt_u32 s35, 60000
    s_cbranch_scc1 L_poll45
L_done46:
    v_max_f32_dpp v22, v20, v20 row_half_mirror row_mask:0xf bank_mask:0xf
    s_nop 1
    v_max_f32_dpp v22, v22, v22 quad_perm:[1,0,3,2] row_mask:0xf bank_mask:0xf
    s_nop 1
    v_max_f32_dpp v22, v22, v22 quad_perm:[2,3,0,1] row_mask:0xf bank_mask:0xf
    v_sub_f32 v20, v20, v22
    v_exp_f32 v20, v20
    s_nop 0
    v_mul_f32 v21, v21, v20
    s_nop 1
    v_add_f32_dpp v21, v21, v21 row_half_mirror row_mask:0xf bank_mask:0xf
    s_nop 1
    v_add_f32_dpp v21, v21, v21 quad_perm:[1,0,3,2] row_mask:0xf bank_mask:0xf
    s_nop 1
    v_add_f32_dpp v21, v21, v21 quad_perm:[2,3,0,1] row_mask:0xf bank_mask:0xf
    v_rcp_f32 v23, v21
    v_log_f32 v21, v21
    v_mul_f32 v20, v20, v23
    v_add_f32 v21, v21, v22
    v_min_u32 v21, -2, v21
    v_readlane_b32 s88, v20, 0
    v_readlane_b32 s90, v20, 1
    v_readlane_b32 s92, v20, 2
    v_readlane_b32 s94, v20, 3
    v_readlane_b32 s96, v20, 4
    v_readlane_b32 s98, v20, 5
    v_readlane_b32 s100, v20, 6
    v_readlane_b32 s89, v20, 7
    s_and_b32 s95, s61, 3
    s_lshl_b32 s95, s95, 15
    s_bfe_u32 s35, s2, 0x20005
    s_lshl_b32 s35, s35, 1
    s_lshr_b32 s91, s2, 7
    s_add_u32 s35, s35, s91
    s_getreg_b32 s91, hwreg(HW_REG_XCC_ID, 0, 4)
    v_and_b32 v24, 1, v0
    v_cmp_eq_u32 vcc, 0, v24
    v_mov_b32 v25, s91
    s_nop 0
    v_cndmask_b32 v25, v25, v21, vcc
    v_mul_f32 v20, s89, v116
    v_mul_f32 v21, s89, v117
    s_mul_i32 s34, s60, 4096
    s_mul_i32 s35, s35, 512
    s_add_u32 s34, s34, s35
    s_add_u32 s34, s34, s95
    s_add_u32 s34, s34, 1179648
    v_lshl_add_u32 v26, v0, 2, s34
    v_lshlrev_b32 v19, 3, v0
    v_add_u32 v19, 99328, v19
    v_lshlrev_b32 v18, 4, v0
    v_add_u32 v18, 131328, v18
    s_mov_b32 s36, s12
    s_mov_b32 s37, s13
    s_mov_b32 s38, 5242880
    s_and_b32 s34, s61, 24
    s_add_u32 s34, s34, s60
    s_mul_i32 s34, s34, 163840
    s_and_b32 s35, s61, 7
    s_mul_i32 s35, s35, 20480
    s_add_u32 s34, s34, s35
    v_lshl_add_u32 v195, v0, 6, s34
    s_mov_b32 s34, 0
    s_barrier
    buffer_load_dword v250, v195, s[36:39], s34 offen
    s_add_u32 s34, s34, 4096
    buffer_load_dword v250, v195, s[36:39], s34 offen
    s_add_u32 s34, s34, 4096
    buffer_load_dword v250, v195, s[36:39], s34 offen
    s_add_u32 s34, s34, 4096
    buffer_load_dword v250, v195, s[36:39], s34 offen
    s_add_u32 s34, s34, 4096
    buffer_load_dword v250, v195, s[36:39], s34 offen
    s_add_u32 s34, s34, 4096
    s_cmp_lt_u32 s63, 1
    s_cbranch_scc1 L_nopf
    buffer_load_dword v250, v197, s[52:55], s42 offen
    s_add_u32 s42, s42, s40
    buffer_load_dword v250, v197, s[52:55], s42 offen
    s_add_u32 s42, s42, s41
L_nopf:
    s_cmp_eq_u32 s97, 0
    s_barrier
    ds_read_b64 v[32:33], v19 offset:0
    ds_read_b64 v[34:35], v19 offset:1024
    ds_read_b64 v[36:37], v19 offset:2048
    ds_read_b64 v[38:39], v19 offset:3072
    ds_read_b64 v[40:41], v19 offset:4096
    ds_read_b64 v[42:43], v19 offset:5120
    ds_read_b64 v[44:45], v19 offset:6144
    buffer_store_dword v25, v26, s[44:47], 0 offen offset:256
    s_waitcnt lgkmcnt(6)
    v_pk_fma_f32 v[20:21], v[32:33], s[88:89], v[20:21] op_sel_hi:[1,0,1]
    s_waitcnt lgkmcnt(5)
    v_pk_fma_f32 v[20:21], v[34:35], s[90:91], v[20:21] op_sel_hi:[1,0,1]
    s_waitcnt lgkmcnt(4)
    v_pk_fma_f32 v[20:21], v[36:37], s[92:93], v[20:21] op_sel_hi:[1,0,1]
    s_waitcnt lgkmcnt(3)
    v_pk_fma_f32 v[20:21], v[38:39], s[94:95], v[20:21] op_sel_hi:[1,0,1]
    s_waitcnt lgkmcnt(2)
    v_pk_fma_f32 v[20:21], v[40:41], s[96:97], v[20:21] op_sel_hi:[1,0,1]
    s_waitcnt lgkmcnt(1)
    v_pk_fma_f32 v[20:21], v[42:43], s[98:99], v[20:21] op_sel_hi:[1,0,1]
    s_waitcnt lgkmcnt(0)
    v_pk_fma_f32 v[20:21], v[44:45], s[100:101], v[20:21] op_sel_hi:[1,0,1]
    v_cvt_pk_bf16_f32 v24, v20, v21
    v_min_u32 v24, -2, v24
    buffer_store_dword v24, v26, s[44:47], 0 offen
    s_cbranch_scc1 L_ostd
    buffer_store_dword v24, v26, s[44:47], 0 offen sc1
    buffer_store_dword v25, v26, s[44:47], 0 offen offset:256 sc1
L_ostd:
    ds_write_b96 v18, v[24:26]
    s_cmp_lt_u32 s63, 1
    s_cbranch_scc1 L_nopf2
    buffer_load_dword v250, v197, s[52:55], s42 offen
    s_add_u32 s42, s42, s40
    buffer_load_dword v250, v197, s[52:55], s42 offen
    s_add_u32 s42, s42, s41
    buffer_load_dword v250, v197, s[52:55], s42 offen
    s_add_u32 s42, s42, s40
    buffer_load_dword v250, v197, s[52:55], s42 offen
    s_add_u32 s42, s42, s41
    buffer_load_dword v250, v197, s[52:55], s42 offen
    s_add_u32 s42, s42, s40
    buffer_load_dword v250, v197, s[52:55], s42 offen
    s_add_u32 s42, s42, s41
    buffer_load_dword v250, v197, s[52:55], s42 offen
    s_add_u32 s42, s42, s40
    buffer_load_dword v250, v197, s[52:55], s42 offen
    s_add_u32 s42, s42, s41
L_nopf2:
    s_waitcnt lgkmcnt(0)
    s_barrier
    s_cmp_eq_u32 s63, 0
    s_cbranch_scc1 L_r_wo2
    buffer_load_dword v250, v197, s[52:55], s42 offen
    s_add_u32 s42, s42, s40
    s_cmp_eq_u32 s63, 1
    s_cbranch_scc1 L_r_w1
    buffer_load_dword v250, v197, s[52:55], s42 offen
    s_add_u32 s42, s42, s40
    buffer_load_dword v250, v197, s[52:55], s42 offen
    s_add_u32 s42, s42, s41
    buffer_load_dword v250, v197, s[52:55], s42 offen
    s_add_u32 s42, s42, s40
    buffer_load_dword v250, v197, s[52:55], s42 offen
    s_add_u32 s42, s42, s41
    s_cmp_eq_u32 s63, 2
    s_cbranch_scc1 L_w2_red
    s_waitcnt vmcnt(0)
    s_mov_b64 exec, -1
    v_lshlrev_b32 v243, 4, v0
    v_add_u32 v243, 131328, v243
    ds_read_b96 v[240:242], v243
    s_waitcnt lgkmcnt(0)
    buffer_store_dword v240, v242, s[44:47], 0 offen sc1
    buffer_store_dword v241, v242, s[44:47], 0 offen offset:256 sc1
    s_branch L_fin
L_stream:
    s_sub_u32 s49, s3, 1
    s_lshl_b32 s49, s49, 12
    v_lshl_add_u32 v1, v0, 4, s49
    s_lshr_b32 s98, s2, 7
    s_mul_i32 s98, s98, 57344
    s_and_b32 s34, s2, 127
    s_lshl_b32 s34, s34, 21
    s_lshr_b32 s35, s2, 7
    s_lshl_b32 s35, s35, 18
    s_add_u32 s34, s34, s35
    s_add_u32 s34, s34, 1572864
    s_mov_b32 s38, 0x40000
    s_mov_b32 s42, 0x40000
    s_waitcnt lgkmcnt(0)
    s_add_u32 s36, s6, s34
    s_addc_u32 s37, s7, 0
    s_add_u32 s40, s8, s34
    s_addc_u32 s41, s9, 0
    s_waitcnt vmcnt(3)
    buffer_load_dwordx4 v[16:19], v1, s[36:39], s98 offen offset:0 nt
    s_waitcnt vmcnt(3)
    buffer_load_dwordx4 v[20:23], v1, s[36:39], s98 offen offset:1024 nt
    s_waitcnt vmcnt(3)
    buffer_load_dwordx4 v[24:27], v1, s[36:39], s98 offen offset:2048 nt
    s_waitcnt vmcnt(3)
    s_barrier
    s_waitcnt vmcnt(2)
    buffer_load_dwordx4 v[28:31], v1, s[36:39], s98 offen offset:3072 nt
    s_waitcnt vmcnt(2)
    s_add_u32 s98, s98, 28672
    s_cmp_eq_u32 s98, 258048
    s_cselect_b32 s98, 0, s98
    buffer_load_dwordx4 v[32:35], v1, s[36:39], s98 offen offset:0 nt
    s_waitcnt vmcnt(2)
    buffer_load_dwordx4 v[36:39], v1, s[36:39], s98 offen offset:1024 nt
    s_waitcnt vmcnt(2)
    buffer_load_dwordx4 v[40:43], v1, s[36:39], s98 offen offset:2048 nt
    s_waitcnt vmcnt(2)
    buffer_load_dwordx4 v[44:47], v1, s[36:39], s98 offen offset:3072 nt
    s_add_u32 s44, s32, 0
    s_addc_u32 s45, s33, 0
    s_mov_b32 s63, 0
    s_mov_b32 s62, s61
    s_cmp_lt_u32 s61, 20
    s_cbranch_scc1 L_rd48
    s_mul_i32 s62, s60, 12
    s_add_u32 s62, s62, s61
    s_sub_u32 s62, s62, 20
    s_mov_b32 s63, 1
    s_cmp_lt_u32 s62, 54
    s_cbranch_scc1 L_rd48
    s_cmp_lt_u32 s62, 56
    s_cselect_b32 s63, 3, 2
    s_sub_u32 s62, s62, 56
L_rd48:
    v_and_b32 v8, 3, v0
    v_bfe_u32 v9, v0, 2, 2
    v_lshrrev_b32 v10, 4, v0
    s_mov_b32 s55, 0x20000
    s_lshl_b32 s35, s62, 6
    s_and_b32 s49, s62, 1
    s_cmp_eq_u32 s63, 0
    s_cbranch_scc1 L_dp50
    s_cmp_eq_u32 s63, 1
    s_cbranch_scc1 L_dp51
    s_mov_b32 s52, s20
    s_mov_b32 s53, s21
    s_mov_b32 s54, 2211840
    v_mov_b32 v15, 0
    s_branch L_dp52
L_dp51:
    s_mov_b32 s52, s16
    s_mov_b32 s53, s17
    s_mov_b32 s54, 2211840
    v_lshl_add_u32 v15, v9, 3, v10
    v_mul_u32_u24 v15, 3456, v15
    v_lshl_add_u32 v15, v8, 4, v15
    v_add_u32 v15, s35, v15
    s_bfe_u32 s50, s3, 0x10001
    s_lshl_b32 s50, s50, 7
    s_and_b32 s34, s3, 1
    s_lshl_b32 s34, s34, 2
    s_add_u32 s50, s50, s34
    s_and_b32 s51, s3, 3
    s_lshl_b32 s51, s51, 5
    s_add_u32 s51, s51, 512
    s_mul_i32 s50, s50, 3456
    s_mul_i32 s51, s51, 3456
    s_branch L_dp52
L_dp50:
    s_mov_b32 s52, s12
    s_mov_b32 s53, s13
    s_mov_b32 s54, 5242880
    s_lshr_b32 s50, s3, 1
    s_lshl_b32 s50, s50, 3
    s_add_u32 s50, s50, s60
    s_and_b32 s51, s3, 1
    s_lshl_b32 s34, s50, 1
    s_add_u32 s34, s34, s51
    s_mul_i32 s34, s34, 81920
    s_add_u32 s34, s34, s35
    v_lshl_add_u32 v15, v9, 2, v10
    v_mul_u32_u24 v15, 2560, v15
    v_lshl_add_u32 v15, v8, 4, v15
    v_add_u32 v15, s34, v15
    s_lshl_b32 s56, s3, 12
    s_lshl_b32 s34, s49, 11
    s_add_u32 s56, s56, s34
    s_add_u32 s56, s56, 40960
    s_add_u32 s58, s56, 1024
    s_mul_i32 s57, s49, 40960
    s_add_u32 s59, s57, 1280
L_dp52:
    v_and_b32 v2, 15, v0
    v_lshlrev_b32 v2, 4, v2
    v_add_u32 v2, 98304, v2
    s_waitcnt vmcnt(2)
    s_add_u32 s98, s98, 28672
    s_cmp_eq_u32 s98, 258048
    s_cselect_b32 s98, 0, s98
    buffer_load_dwordx4 v[48:51], v1, s[36:39], s98 offen offset:0 nt
    s_waitcnt vmcnt(2)
    buffer_load_dwordx4 v[52:55], v1, s[36:39], s98 offen offset:1024 nt
    s_waitcnt vmcnt(2)
    buffer_load_dwordx4 v[56:59], v1, s[36:39], s98 offen offset:2048 nt
    s_waitcnt vmcnt(2)
    buffer_load_dwordx4 v[60:63], v1, s[36:39], s98 offen offset:3072 nt
    s_waitcnt vmcnt(2)
    s_add_u32 s98, s98, 28672
    s_cmp_eq_u32 s98, 258048
    s_cselect_b32 s98, 0, s98
    buffer_load_dwordx4 v[64:67], v1, s[36:39], s98 offen offset:0 nt
    s_waitcnt vmcnt(2)
    buffer_load_dwordx4 v[68:71], v1, s[36:39], s98 offen offset:1024 nt
    v_mov_b32 v3, 14
    v_mov_b32 v14, 99072
    s_mov_b64 exec, 1
    ds_write_b32 v14, v3
    s_mov_b64 exec, -1
    s_waitcnt vmcnt(2)
    buffer_load_dwordx4 v[72:75], v1, s[36:39], s98 offen offset:2048 nt
    s_waitcnt vmcnt(2)
    buffer_load_dwordx4 v[76:79], v1, s[36:39], s98 offen offset:3072 nt
    s_waitcnt vmcnt(2)
    s_add_u32 s98, s98, 28672
    s_cmp_eq_u32 s98, 258048
    s_cselect_b32 s98, 0, s98
    buffer_load_dwordx4 v[80:83], v1, s[36:39], s98 offen offset:0 nt
    s_waitcnt vmcnt(2)
    buffer_load_dwordx4 v[84:87], v1, s[36:39], s98 offen offset:1024 nt
    s_waitcnt vmcnt(2)
    buffer_load_dwordx4 v[88:91], v1, s[36:39], s98 offen offset:2048 nt
    s_waitcnt vmcnt(2)
    buffer_load_dwordx4 v[92:95], v1, s[36:39], s98 offen offset:3072 nt
    s_waitcnt vmcnt(2)
    s_add_u32 s98, s98, 28672
    s_cmp_eq_u32 s98, 258048
    s_cselect_b32 s98, 0, s98
    buffer_load_dwordx4 v[96:99], v1, s[36:39], s98 offen offset:0 nt
    s_waitcnt vmcnt(2)
    buffer_load_dwordx4 v[100:103], v1, s[36:39], s98 offen offset:1024 nt
    v_mov_b32 v3, 22
    v_mov_b32 v14, 99072
    s_mov_b64 exec, 1
    ds_write_b32 v14, v3
    s_mov_b64 exec, -1
    s_waitcnt vmcnt(2)
    buffer_load_dwordx4 v[104:107], v1, s[36:39], s98 offen offset:2048 nt
    s_waitcnt vmcnt(2)
    buffer_load_dwordx4 v[108:111], v1, s[36:39], s98 offen offset:3072 nt
    s_waitcnt vmcnt(2)
    s_add_u32 s98, s98, 28672
    s_cmp_eq_u32 s98, 258048
    s_cselect_b32 s98, 0, s98
    buffer_load_dwordx4 v[112:115], v1, s[36:39], s98 offen offset:0 nt
    s_waitcnt vmcnt(2)
    buffer_load_dwordx4 v[116:119], v1, s[36:39], s98 offen offset:1024 nt
    s_waitcnt vmcnt(2)
    buffer_load_dwordx4 v[120:123], v1, s[36:39], s98 offen offset:2048 nt
    s_waitcnt vmcnt(2)
    buffer_load_dwordx4 v[124:127], v1, s[36:39], s98 offen offset:3072 nt
    s_waitcnt vmcnt(2)
    s_add_u32 s98, s98, 28672
    s_cmp_eq_u32 s98, 258048
    s_cselect_b32 s98, 0, s98
    buffer_load_dwordx4 v[128:131], v1, s[36:39], s98 offen offset:0 nt
    s_waitcnt vmcnt(2)
    buffer_load_dwordx4 v[132:135], v1, s[36:39], s98 offen offset:1024 nt
    s_waitcnt vmcnt(2)
    buffer_load_dwordx4 v[136:139], v1, s[36:39], s98 offen offset:2048 nt
    s_waitcnt vmcnt(2)
    buffer_load_dwordx4 v[140:143], v1, s[36:39], s98 offen offset:3072 nt
    s_waitcnt vmcnt(2)
    s_add_u32 s98, s98, 28672
    s_cmp_eq_u32 s98, 258048
    s_cselect_b32 s98, 0, s98
    buffer_load_dwordx4 v[144:147], v1, s[36:39], s98 offen offset:0 nt
    s_waitcnt vmcnt(2)
    buffer_load_dwordx4 v[148:151], v1, s[36:39], s98 offen offset:1024 nt
    v_mov_b32 v3, 34
    v_mov_b32 v14, 99072
    s_mov_b64 exec, 1
    ds_write_b32 v14, v3
    s_mov_b64 exec, -1
    s_waitcnt vmcnt(2)
    buffer_load_dwordx4 v[152:155], v1, s[36:39], s98 offen offset:2048 nt
    s_waitcnt vmcnt(2)
    buffer_load_dwordx4 v[156:159], v1, s[36:39], s98 offen offset:3072 nt
    s_waitcnt vmcnt(2)
    s_add_u32 s98, s98, 28672
    s_cmp_eq_u32 s98, 258048
    s_cselect_b32 s98, 0, s98
    buffer_load_dwordx4 v[160:163], v1, s[40:43], s98 offen offset:0 nt
    s_waitcnt vmcnt(2)
    buffer_load_dwordx4 v[164:167], v1, s[40:43], s98 offen offset:1024 nt
    v_mov_b32 v3, 99076
    ds_read_b32 v3, v3
    s_waitcnt vmcnt(2)
    s_waitcnt lgkmcnt(0)
    v_readfirstlane_b32 s48, v3
    buffer_load_dwordx4 v[168:171], v1, s[40:43], s98 offen offset:2048 nt
    s_cmp_ge_u32 s48, 20
    s_cbranch_scc1 L_bo53
    s_waitcnt vmcnt(2)
L_bo53:
    buffer_load_dwordx4 v[172:175], v1, s[40:43], s98 offen offset:3072 nt
    s_waitcnt vmcnt(3)
    s_cmp_ge_u32 s48, 21
    s_cbranch_scc1 L_bo54
    s_waitcnt vmcnt(2)
L_bo54:
    s_add_u32 s98, s98, 28672
    s_cmp_eq_u32 s98, 258048
    s_cselect_b32 s98, 0, s98
    buffer_load_dwordx4 v[176:179], v1, s[40:43], s98 offen offset:0 nt
    s_waitcnt vmcnt(3)
    s_cmp_ge_u32 s48, 22
    s_cbranch_scc1 L_bo55
    s_waitcnt vmcnt(2)
L_bo55:
    buffer_load_dwordx4 v[180:183], v1, s[40:43], s98 offen offset:1024 nt
    s_waitcnt vmcnt(3)
    s_cmp_ge_u32 s48, 23
    s_cbranch_scc1 L_bo56
    s_waitcnt vmcnt(2)
L_bo56:
    buffer_load_dwordx4 v[184:187], v1, s[40:43], s98 offen offset:2048 nt
    s_waitcnt vmcnt(3)
    s_cmp_ge_u32 s48, 24
    s_cbranch_scc1 L_bo57
    s_waitcnt vmcnt(2)
L_bo57:
    buffer_load_dwordx4 v[188:191], v1, s[40:43], s98 offen offset:3072 nt
    s_waitcnt vmcnt(3)
    s_cmp_ge_u32 s48, 24
    s_cbranch_scc1 L_bo58
    s_waitcnt vmcnt(2)
L_bo58:
    s_add_u32 s98, s98, 28672
    s_cmp_eq_u32 s98, 258048
    s_cselect_b32 s98, 0, s98
    buffer_load_dwordx4 v[192:195], v1, s[40:43], s98 offen offset:0 nt
    s_waitcnt vmcnt(3)
    s_cmp_ge_u32 s48, 25
    s_cbranch_scc1 L_bo59
    s_waitcnt vmcnt(2)
L_bo59:
    buffer_load_dwordx4 v[196:199], v1, s[40:43], s98 offen offset:1024 nt
    v_mov_b32 v3, 46
    v_mov_b32 v14, 99072
    s_mov_b64 exec, 1
    ds_write_b32 v14, v3
    s_mov_b64 exec, -1
    s_waitcnt vmcnt(3)
    s_cmp_ge_u32 s48, 26
    s_cbranch_scc1 L_bo60
    s_waitcnt vmcnt(2)
L_bo60:
    buffer_load_dwordx4 v[200:203], v1, s[40:43], s98 offen offset:2048 nt
    s_waitcnt vmcnt(3)
    s_cmp_ge_u32 s48, 27
    s_cbranch_scc1 L_bo61
    s_waitcnt vmcnt(2)
L_bo61:
    buffer_load_dwordx4 v[204:207], v1, s[40:43], s98 offen offset:3072 nt
    s_waitcnt vmcnt(3)
    s_cmp_ge_u32 s48, 27
    s_cbranch_scc1 L_bo62
    s_waitcnt vmcnt(2)
L_bo62:
    s_add_u32 s98, s98, 28672
    s_cmp_eq_u32 s98, 258048
    s_cselect_b32 s98, 0, s98
    buffer_load_dwordx4 v[208:211], v1, s[40:43], s98 offen offset:0 nt
    s_waitcnt vmcnt(3)
    s_cmp_ge_u32 s48, 28
    s_cbranch_scc1 L_bo63
    s_waitcnt vmcnt(2)
L_bo63:
    buffer_load_dwordx4 v[212:215], v1, s[40:43], s98 offen offset:1024 nt
    v_mov_b32 v3, 99076
    ds_read_b32 v3, v3
    s_waitcnt vmcnt(3)
    s_cmp_ge_u32 s48, 28
    s_cbranch_scc1 L_bo64
    s_waitcnt vmcnt(2)
L_bo64:
    s_waitcnt lgkmcnt(0)
    v_readfirstlane_b32 s48, v3
    buffer_load_dwordx4 v[216:219], v1, s[40:43], s98 offen offset:2048 nt
    s_waitcnt vmcnt(3)
    s_cmp_ge_u32 s48, 20
    s_cbranch_scc1 L_bo65
    s_waitcnt vmcnt(2)
L_bo65:
    buffer_load_dwordx4 v[220:223], v1, s[40:43], s98 offen offset:3072 nt
    s_waitcnt vmcnt(3)
    s_cmp_ge_u32 s48, 21
    s_cbranch_scc1 L_bo66
    s_waitcnt vmcnt(2)
L_bo66:
    s_add_u32 s98, s98, 28672
    s_cmp_eq_u32 s98, 258048
    s_cselect_b32 s98, 0, s98
    buffer_load_dwordx4 v[224:227], v1, s[40:43], s98 offen offset:0 nt
    s_waitcnt vmcnt(3)
    s_cmp_ge_u32 s48, 22
    s_cbranch_scc1 L_bo67
    s_waitcnt vmcnt(2)
L_bo67:
    buffer_load_dwordx4 v[228:231], v1, s[40:43], s98 offen offset:1024 nt
    s_waitcnt vmcnt(3)
    s_cmp_ge_u32 s48, 23
    s_cbranch_scc1 L_bo68
    s_waitcnt vmcnt(2)
L_bo68:
    buffer_load_dwordx4 v[232:235], v1, s[40:43], s98 offen offset:2048 nt
    s_waitcnt vmcnt(3)
    s_cmp_ge_u32 s48, 24
    s_cbranch_scc1 L_bo69
    s_waitcnt vmcnt(2)
L_bo69:
    buffer_load_dwordx4 v[236:239], v1, s[40:43], s98 offen offset:3072 nt
    s_waitcnt vmcnt(3)
    s_cmp_ge_u32 s48, 24
    s_cbranch_scc1 L_bo70
    s_waitcnt vmcnt(2)
L_bo70:
    s_add_u32 s98, s98, 28672
    s_cmp_eq_u32 s98, 258048
    s_cselect_b32 s98, 0, s98
    buffer_load_dwordx4 v[240:243], v1, s[40:43], s98 offen offset:0 nt
    v_mov_b32 v3, 57
    v_mov_b32 v14, 99072
    s_mov_b64 exec, 1
    ds_write_b32 v14, v3
    s_mov_b64 exec, -1
    s_waitcnt vmcnt(3)
    s_cmp_ge_u32 s48, 25
    s_cbranch_scc1 L_bo71
    s_waitcnt vmcnt(2)
L_bo71:
    buffer_load_dwordx4 v[244:247], v1, s[40:43], s98 offen offset:1024 nt
    s_waitcnt vmcnt(3)
    s_cmp_ge_u32 s48, 26
    s_cbranch_scc1 L_bo72
    s_waitcnt vmcnt(2)
L_bo72:
    buffer_load_dwordx4 v[248:251], v1, s[40:43], s98 offen offset:2048 nt
    s_waitcnt vmcnt(3)
    s_cmp_ge_u32 s48, 27
    s_cbranch_scc1 L_bo73
    s_waitcnt vmcnt(2)
L_bo73:
    buffer_load_dwordx4 v[252:255], v1, s[40:43], s98 offen offset:3072 nt
    v_mov_b32 v14, 99080
    s_mov_b32 s35, 0
L_poll74:
    ds_read_b128 v[4:7], v2
    ds_read_b32 v8, v14
    s_add_u32 s35, s35, 1
    s_waitcnt lgkmcnt(0)
    v_max3_u32 v3, v4, v5, v6
    v_max_u32 v3, v3, v7
    v_cmp_eq_u32 vcc, -1, v3
    s_cbranch_vccz L_done75
    s_sleep 2
    s_cmp_lt_u32 s35, 60000
    s_cbranch_scc1 L_poll74
L_done75:
    v_readfirstlane_b32 s99, v8
    v_dot2_f32_bf16 v8, v16, v4, 0
    v_dot2_f32_bf16 v9, v20, v4, 0
    v_dot2_f32_bf16 v10, v24, v4, 0
    v_dot2_f32_bf16 v11, v28, v4, 0
    v_dot2c_f32_bf16 v8, v17, v5
    v_dot2c_f32_bf16 v9, v21, v5
    v_dot2c_f32_bf16 v10, v25, v5
    v_dot2c_f32_bf16 v11, v29, v5
    v_dot2c_f32_bf16 v8, v18, v6
    v_dot2c_f32_bf16 v9, v22, v6
    v_dot2c_f32_bf16 v10, v26, v6
    v_dot2c_f32_bf16 v11, v30, v6
    v_dot2c_f32_bf16 v8, v19, v7
    v_dot2c_f32_bf16 v9, v23, v7
    v_dot2c_f32_bf16 v10, v27, v7
    v_dot2c_f32_bf16 v11, v31, v7
    v_add_f32_dpp v12, v8, v8 row_ror:8 row_mask:0xf bank_mask:0x3
    v_add_f32_dpp v12, v9, v9 row_ror:8 row_mask:0xf bank_mask:0xc
    v_add_f32_dpp v13, v10, v10 row_ror:8 row_mask:0xf bank_mask:0x3
    v_add_f32_dpp v13, v11, v11 row_ror:8 row_mask:0xf bank_mask:0xc
    v_dot2_f32_bf16 v8, v32, v4, 0
    v_dot2_f32_bf16 v9, v36, v4, 0
    v_dot2_f32_bf16 v10, v40, v4, 0
    v_dot2_f32_bf16 v11, v44, v4, 0
    v_add_f32_dpp v12, v12, v12 row_half_mirror row_mask:0xf bank_mask:0xf
    v_add_f32_dpp v13, v13, v13 row_half_mirror row_mask:0xf bank_mask:0xf
    v_dot2c_f32_bf16 v8, v33, v5
    v_dot2c_f32_bf16 v9, v37, v5
    v_dot2c_f32_bf16 v10, v41, v5
    v_dot2c_f32_bf16 v11, v45, v5
    v_add_f32_dpp v12, v12, v12 quad_perm:[1,0,3,2] row_mask:0xf bank_mask:0xf
    v_add_f32_dpp v13, v13, v13 quad_perm:[1,0,3,2] row_mask:0xf bank_mask:0xf
    v_dot2c_f32_bf16 v8, v34, v6
    v_dot2c_f32_bf16 v9, v38, v6
    v_dot2c_f32_bf16 v10, v42, v6
    v_dot2c_f32_bf16 v11, v46, v6
    v_add_f32_dpp v12, v12, v12 quad_perm:[2,3,0,1] row_mask:0xf bank_mask:0xf
    v_add_f32_dpp v13, v13, v13 quad_perm:[2,3,0,1] row_mask:0xf bank_mask:0xf
    v_dot2c_f32_bf16 v8, v35, v7
    v_dot2c_f32_bf16 v9, v39, v7
    v_dot2c_f32_bf16 v10, v43, v7
    v_dot2c_f32_bf16 v11, v47, v7
    s_waitcnt vmcnt(3)
    s_cmp_ge_u32 s48, 27
    s_cbranch_scc1 L_bo77
    s_waitcnt vmcnt(2)
L_bo77:
    s_add_u32 s98, s98, 28672
    s_cmp_eq_u32 s98, 258048
    s_cselect_b32 s98, 0, s98
    buffer_load_dwordx4 v[32:35], v1, s[40:43], s98 offen offset:0 nt
    v_add_f32_dpp v16, v8, v8 row_ror:8 row_mask:0xf bank_mask:0x3
    v_add_f32_dpp v16, v9, v9 row_ror:8 row_mask:0xf bank_mask:0xc
    v_add_f32_dpp v17, v10, v10 row_ror:8 row_mask:0xf bank_mask:0x3
    v_add_f32_dpp v17, v11, v11 row_ror:8 row_mask:0xf bank_mask:0xc
    v_dot2_f32_bf16 v8, v48, v4, 0
    v_dot2_f32_bf16 v9, v52, v4, 0
    v_dot2_f32_bf16 v10, v56, v4, 0
    v_dot2_f32_bf16 v11, v60, v4, 0
    v_add_f32_dpp v16, v16, v16 row_half_mirror row_mask:0xf bank_mask:0xf
    v_add_f32_dpp v17, v17, v17 row_half_mirror row_mask:0xf bank_mask:0xf
    v_dot2c_f32_bf16 v8, v49, v5
    v_dot2c_f32_bf16 v9, v53, v5
    v_dot2c_f32_bf16 v10, v57, v5
    v_dot2c_f32_bf16 v11, v61, v5
    v_add_f32_dpp v16, v16, v16 quad_perm:[1,0,3,2] row_mask:0xf bank_mask:0xf
    v_add_f32_dpp v17, v17, v17 quad_perm:[1,0,3,2] row_mask:0xf bank_mask:0xf
    v_dot2c_f32_bf16 v8, v50, v6
    v_dot2c_f32_bf16 v9, v54, v6
    v_dot2c_f32_bf16 v10, v58, v6
    v_dot2c_f32_bf16 v11, v62, v6
    v_add_f32_dpp v16, v16, v16 quad_perm:[2,3,0,1] row_mask:0xf bank_mask:0xf
    v_add_f32_dpp v17, v17, v17 quad_perm:[2,3,0,1] row_mask:0xf bank_mask:0xf
    v_dot2c_f32_bf16 v8, v51, v7
    v_dot2c_f32_bf16 v9, v55, v7
    v_dot2c_f32_bf16 v10, v59, v7
    v_dot2c_f32_bf16 v11, v63, v7
    v_add_f32_dpp v18, v8, v8 row_ror:8 row_mask:0xf bank_mask:0x3
    v_add_f32_dpp v18, v9, v9 row_ror:8 row_mask:0xf bank_mask:0xc
    v_add_f32_dpp v19, v10, v10 row_ror:8 row_mask:0xf bank_mask:0x3
    v_add_f32_dpp v19, v11, v11 row_ror:8 row_mask:0xf bank_mask:0xc
    v_dot2_f32_bf16 v8, v64, v4, 0
    v_dot2_f32_bf16 v9, v68, v4, 0
    v_dot2_f32_bf16 v10, v72, v4, 0
    v_dot2_f32_bf16 v11, v76, v4, 0
    v_add_f32_dpp v18, v18, v18 row_half_mirror row_mask:0xf bank_mask:0xf
    v_add_f32_dpp v19, v19, v19 row_half_mirror row_mask:0xf bank_mask:0xf
    v_dot2c_f32_bf16 v8, v65, v5
    v_dot2c_f32_bf16 v9, v69, v5
    v_dot2c_f32_bf16 v10, v73, v5
    v_dot2c_f32_bf16 v11, v77, v5
    v_add_f32_dpp v18, v18, v18 quad_perm:[1,0,3,2] row_mask:0xf bank_mask:0xf
    v_add_f32_dpp v19, v19, v19 quad_perm:[1,0,3,2] row_mask:0xf bank_mask:0xf
    v_dot2c_f32_bf16 v8, v66, v6
    v_dot2c_f32_bf16 v9, v70, v6
    v_mov_b32 v3, 99076
    ds_read_b32 v3, v3
    s_waitcnt vmcnt(3)
    s_cmp_ge_u32 s48, 28
    s_cbranch_scc1 L_bo78
    s_waitcnt vmcnt(2)
L_bo78:
    s_waitcnt lgkmcnt(0)
    v_readfirstlane_b32 s48, v3
    buffer_load_dwordx4 v[36:39], v1, s[40:43], s98 offen offset:1024 nt
    v_dot2c_f32_bf16 v10, v74, v6
    v_dot2c_f32_bf16 v11, v78, v6
    v_add_f32_dpp v18, v18, v18 quad_perm:[2,3,0,1] row_mask:0xf bank_mask:0xf
    v_add_f32_dpp v19, v19, v19 quad_perm:[2,3,0,1] row_mask:0xf bank_mask:0xf
    v_dot2c_f32_bf16 v8, v67, v7
    v_dot2c_f32_bf16 v9, v71, v7
    v_dot2c_f32_bf16 v10, v75, v7
    v_dot2c_f32_bf16 v11, v79, v7
    v_add_f32_dpp v20, v8, v8 row_ror:8 row_mask:0xf bank_mask:0x3
    v_add_f32_dpp v20, v9, v9 row_ror:8 row_mask:0xf bank_mask:0xc
    v_add_f32_dpp v21, v10, v10 row_ror:8 row_mask:0xf bank_mask:0x3
    v_add_f32_dpp v21, v11, v11 row_ror:8 row_mask:0xf bank_mask:0xc
    v_dot2_f32_bf16 v8, v80, v4, 0
    v_dot2_f32_bf16 v9, v84, v4, 0
    v_dot2_f32_bf16 v10, v88, v4, 0
    v_dot2_f32_bf16 v11, v92, v4, 0
    v_add_f32_dpp v20, v20, v20 row_half_mirror row_mask:0xf bank_mask:0xf
    v_add_f32_dpp v21, v21, v21 row_half_mirror row_mask:0xf bank_mask:0xf
    v_dot2c_f32_bf16 v8, v81, v5
    v_dot2c_f32_bf16 v9, v85, v5
    v_dot2c_f32_bf16 v10, v89, v5
    v_dot2c_f32_bf16 v11, v93, v5
    v_add_f32_dpp v20, v20, v20 quad_perm:[1,0,3,2] row_mask:0xf bank_mask:0xf
    v_add_f32_dpp v21, v21, v21 quad_perm:[1,0,3,2] row_mask:0xf bank_mask:0xf
    v_dot2c_f32_bf16 v8, v82, v6
    v_dot2c_f32_bf16 v9, v86, v6
    v_dot2c_f32_bf16 v10, v90, v6
    v_dot2c_f32_bf16 v11, v94, v6
    v_add_f32_dpp v20, v20, v20 quad_perm:[2,3,0,1] row_mask:0xf bank_mask:0xf
    v_add_f32_dpp v21, v21, v21 quad_perm:[2,3,0,1] row_mask:0xf bank_mask:0xf
    v_dot2c_f32_bf16 v8, v83, v7
    v_dot2c_f32_bf16 v9, v87, v7
    v_dot2c_f32_bf16 v10, v91, v7
    v_dot2c_f32_bf16 v11, v95, v7
    v_add_f32_dpp v22, v8, v8 row_ror:8 row_mask:0xf bank_mask:0x3
    v_add_f32_dpp v22, v9, v9 row_ror:8 row_mask:0xf bank_mask:0xc
    v_add_f32_dpp v23, v10, v10 row_ror:8 row_mask:0xf bank_mask:0x3
    v_add_f32_dpp v23, v11, v11 row_ror:8 row_mask:0xf bank_mask:0xc
    v_dot2_f32_bf16 v8, v96, v4, 0
    v_dot2_f32_bf16 v9, v100, v4, 0
    v_dot2_f32_bf16 v10, v104, v4, 0
    v_dot2_f32_bf16 v11, v108, v4, 0
    v_add_f32_dpp v22, v22, v22 row_half_mirror row_mask:0xf bank_mask:0xf
    v_add_f32_dpp v23, v23, v23 row_half_mirror row_mask:0xf bank_mask:0xf
    s_waitcnt vmcnt(3)
    s_cmp_ge_u32 s48, 16
    s_cbranch_scc1 L_bo79
    s_waitcnt vmcnt(2)
L_bo79:
    buffer_load_dwordx4 v[40:43], v1, s[40:43], s98 offen offset:2048 nt
    v_dot2c_f32_bf16 v8, v97, v5
    v_dot2c_f32_bf16 v9, v101, v5
    v_dot2c_f32_bf16 v10, v105, v5
    v_dot2c_f32_bf16 v11, v109, v5
    v_add_f32_dpp v22, v22, v22 quad_perm:[1,0,3,2] row_mask:0xf bank_mask:0xf
    v_add_f32_dpp v23, v23, v23 quad_perm:[1,0,3,2] row_mask:0xf bank_mask:0xf
    v_dot2c_f32_bf16 v8, v98, v6
    v_dot2c_f32_bf16 v9, v102, v6
    v_dot2c_f32_bf16 v10, v106, v6
    v_dot2c_f32_bf16 v11, v110, v6
    v_add_f32_dpp v22, v22, v22 quad_perm:[2,3,0,1] row_mask:0xf bank_mask:0xf
    v_add_f32_dpp v23, v23, v23 quad_perm:[2,3,0,1] row_mask:0xf bank_mask:0xf
    v_dot2c_f32_bf16 v8, v99, v7
    v_dot2c_f32_bf16 v9, v103, v7
    v_dot2c_f32_bf16 v10, v107, v7
    v_dot2c_f32_bf16 v11, v111, v7
    v_add_f32_dpp v24, v8, v8 row_ror:8 row_mask:0xf bank_mask:0x3
    v_add_f32_dpp v24, v9, v9 row_ror:8 row_mask:0xf bank_mask:0xc
    v_add_f32_dpp v25, v10, v10 row_ror:8 row_mask:0xf bank_mask:0x3
    v_add_f32_dpp v25, v11, v11 row_ror:8 row_mask:0xf bank_mask:0xc
    v_dot2_f32_bf16 v8, v112, v4, 0
    v_dot2_f32_bf16 v9, v116, v4, 0
    v_dot2_f32_bf16 v10, v120, v4, 0
    v_dot2_f32_bf16 v11, v124, v4, 0
    v_add_f32_dpp v24, v24, v24 row_half_mirror row_mask:0xf bank_mask:0xf
    v_add_f32_dpp v25, v25, v25 row_half_mirror row_mask:0xf bank_mask:0xf
    v_dot2c_f32_bf16 v8, v113, v5
    v_dot2c_f32_bf16 v9, v117, v5
    v_dot2c_f32_bf16 v10, v121, v5
    v_dot2c_f32_bf16 v11, v125, v5
    v_add_f32_dpp v24, v24, v24 quad_perm:[1,0,3,2] row_mask:0xf bank_mask:0xf
    v_add_f32_dpp v25, v25, v25 quad_perm:[1,0,3,2] row_mask:0xf bank_mask:0xf
    v_dot2c_f32_bf16 v8, v114, v6
    v_dot2c_f32_bf16 v9, v118, v6
    v_dot2c_f32_bf16 v10, v122, v6
    v_dot2c_f32_bf16 v11, v126, v6
    v_add_f32_dpp v24, v24, v24 quad_perm:[2,3,0,1] row_mask:0xf bank_mask:0xf
    v_add_f32_dpp v25, v25, v25 quad_perm:[2,3,0,1] row_mask:0xf bank_mask:0xf
    v_dot2c_f32_bf16 v8, v115, v7
    v_dot2c_f32_bf16 v9, v119, v7
    v_dot2c_f32_bf16 v10, v123, v7
    v_dot2c_f32_bf16 v11, v127, v7
    v_add_f32_dpp v26, v8, v8 row_ror:8 row_mask:0xf bank_mask:0x3
    v_add_f32_dpp v26, v9, v9 row_ror:8 row_mask:0xf bank_mask:0xc
    s_waitcnt vmcnt(3)
    s_cmp_ge_u32 s48, 17
    s_cbranch_scc1 L_bo80
    s_waitcnt vmcnt(2)
L_bo80:
    buffer_load_dwordx4 v[44:47], v1, s[40:43], s98 offen offset:3072 nt
    v_add_f32_dpp v27, v10, v10 row_ror:8 row_mask:0xf bank_mask:0x3
    v_add_f32_dpp v27, v11, v11 row_ror:8 row_mask:0xf bank_mask:0xc
    v_dot2_f32_bf16 v8, v128, v4, 0
    v_dot2_f32_bf16 v9, v132, v4, 0
    v_dot2_f32_bf16 v10, v136, v4, 0
    v_dot2_f32_bf16 v11, v140, v4, 0
    v_add_f32_dpp v26, v26, v26 row_half_mirror row_mask:0xf bank_mask:0xf
    v_add_f32_dpp v27, v27, v27 row_half_mirror row_mask:0xf bank_mask:0xf
    v_dot2c_f32_bf16 v8, v129, v5
    v_dot2c_f32_bf16 v9, v133, v5
    v_dot2c_f32_bf16 v10, v137, v5
    v_dot2c_f32_bf16 v11, v141, v5
    v_add_f32_dpp v26, v26, v26 quad_perm:[1,0,3,2] row_mask:0xf bank_mask:0xf
    v_add_f32_dpp v27, v27, v27 quad_perm:[1,0,3,2] row_mask:0xf bank_mask:0xf
    v_dot2c_f32_bf16 v8, v130, v6
    v_dot2c_f32_bf16 v9, v134, v6
    v_dot2c_f32_bf16 v10, v138, v6
    v_dot2c_f32_bf16 v11, v142, v6
    v_add_f32_dpp v26, v26, v26 quad_perm:[2,3,0,1] row_mask:0xf bank_mask:0xf
    v_add_f32_dpp v27, v27, v27 quad_perm:[2,3,0,1] row_mask:0xf bank_mask:0xf
    v_dot2c_f32_bf16 v8, v131, v7
    v_dot2c_f32_bf16 v9, v135, v7
    v_dot2c_f32_bf16 v10, v139, v7
    v_dot2c_f32_bf16 v11, v143, v7
    v_add_f32_dpp v28, v8, v8 row_ror:8 row_mask:0xf bank_mask:0x3
    v_add_f32_dpp v28, v9, v9 row_ror:8 row_mask:0xf bank_mask:0xc
    v_add_f32_dpp v29, v10, v10 row_ror:8 row_mask:0xf bank_mask:0x3
    v_add_f32_dpp v29, v11, v11 row_ror:8 row_mask:0xf bank_mask:0xc
    v_dot2_f32_bf16 v8, v144, v4, 0
    v_dot2_f32_bf16 v9, v148, v4, 0
    v_dot2_f32_bf16 v10, v152, v4, 0
    v_dot2_f32_bf16 v11, v156, v4, 0
    v_add_f32_dpp v28, v28, v28 row_half_mirror row_mask:0xf bank_mask:0xf
    v_add_f32_dpp v29, v29, v29 row_half_mirror row_mask:0xf bank_mask:0xf
    v_dot2c_f32_bf16 v8, v145, v5
    v_dot2c_f32_bf16 v9, v149, v5
    v_dot2c_f32_bf16 v10, v153, v5
    v_dot2c_f32_bf16 v11, v157, v5
    v_add_f32_dpp v28, v28, v28 quad_perm:[1,0,3,2] row_mask:0xf bank_mask:0xf
    v_add_f32_dpp v29, v29, v29 quad_perm:[1,0,3,2] row_mask:0xf bank_mask:0xf
    v_dot2c_f32_bf16 v8, v146, v6
    v_dot2c_f32_bf16 v9, v150, v6
    v_dot2c_f32_bf16 v10, v154, v6
    v_dot2c_f32_bf16 v11, v158, v6
    s_waitcnt vmcnt(3)
    s_cmp_ge_u32 s48, 19
    s_cbranch_scc1 L_bo81
    s_waitcnt vmcnt(2)
L_bo81:
    s_add_u32 s98, s98, 28672
    s_cmp_eq_u32 s98, 258048
    s_cselect_b32 s98, 0, s98
    buffer_load_dwordx4 v[48:51], v1, s[40:43], s98 offen offset:0 nt
    v_add_f32_dpp v28, v28, v28 quad_perm:[2,3,0,1] row_mask:0xf bank_mask:0xf
    v_add_f32_dpp v29, v29, v29 quad_perm:[2,3,0,1] row_mask:0xf bank_mask:0xf
    v_dot2c_f32_bf16 v8, v147, v7
    v_dot2c_f32_bf16 v9, v151, v7
    v_dot2c_f32_bf16 v10, v155, v7
    v_dot2c_f32_bf16 v11, v159, v7
    v_add_f32_dpp v30, v8, v8 row_ror:8 row_mask:0xf bank_mask:0x3
    v_add_f32_dpp v30, v9, v9 row_ror:8 row_mask:0xf bank_mask:0xc
    v_add_f32_dpp v31, v10, v10 row_ror:8 row_mask:0xf bank_mask:0x3
    v_add_f32_dpp v31, v11, v11 row_ror:8 row_mask:0xf bank_mask:0xc
    v_add_f32_dpp v30, v30, v30 row_half_mirror row_mask:0xf bank_mask:0xf
    s_nop 0
    v_add_f32_dpp v31, v31, v31 row_half_mirror row_mask:0xf bank_mask:0xf
    v_add_f32_dpp v30, v30, v30 quad_perm:[1,0,3,2] row_mask:0xf bank_mask:0xf
    s_nop 0
    v_add_f32_dpp v31, v31, v31 quad_perm:[1,0,3,2] row_mask:0xf bank_mask:0xf
    v_add_f32_dpp v30, v30, v30 quad_perm:[2,3,0,1] row_mask:0xf bank_mask:0xf
    s_nop 0
    v_add_f32_dpp v31, v31, v31 quad_perm:[2,3,0,1] row_mask:0xf bank_mask:0xf
    v_max3_f32 v8, v12, v13, v16
    v_max3_f32 v8, v8, v17, v18
    v_max3_f32 v8, v8, v19, v20
    v_max3_f32 v8, v8, v21, v22
    v_max3_f32 v8, v8, v23, v24
    v_max3_f32 v8, v8, v25, v26
    v_max3_f32 v8, v8, v27, v28
    v_max3_f32 v8, v8, v29, v30
    v_max_f32 v8, v8, v31
    s_mov_b32 s34, 0x3e0293ee
    s_nop 0
    v_max_f32_dpp v8, v8, v8 row_ror:8 row_mask:0xf bank_mask:0xf
    v_mov_b32 v9, v8
    s_nop 1
    v_permlane16_swap_b32 v8, v9
    v_max_f32 v8, v8, v9
    v_mov_b32 v9, v8
    s_nop 1
    v_permlane32_swap_b32 v8, v9
    v_max_f32 v8, v8, v9
    v_mul_f32 v8, s34, v8
    v_fma_f32 v12, v12, s34, -v8
    v_fma_f32 v13, v13, s34, -v8
    v_fma_f32 v16, v16, s34, -v8
    v_fma_f32 v17, v17, s34, -v8
    v_fma_f32 v18, v18, s34, -v8
    v_fma_f32 v19, v19, s34, -v8
    v_fma_f32 v20, v20, s34, -v8
    v_fma_f32 v21, v21, s34, -v8
    v_fma_f32 v22, v22, s34, -v8
    v_fma_f32 v23, v23, s34, -v8
    s_waitcnt vmcnt(3)
    s_cmp_ge_u32 s48, 20
    s_cbranch_scc1 L_bo82
    s_waitcnt vmcnt(2)
L_bo82:
    buffer_load_dwordx4 v[52:55], v1, s[40:43], s98 offen offset:1024 nt
    v_fma_f32 v24, v24, s34, -v8
    v_fma_f32 v25, v25, s34, -v8
    v_fma_f32 v26, v26, s34, -v8
    v_fma_f32 v27, v27, s34, -v8
    v_fma_f32 v28, v28, s34, -v8
    v_fma_f32 v29, v29, s34, -v8
    v_fma_f32 v30, v30, s34, -v8
    v_fma_f32 v31, v31, s34, -v8
    v_exp_f32 v12, v12
    v_exp_f32 v13, v13
    v_exp_f32 v16, v16
    v_exp_f32 v17, v17
    v_exp_f32 v18, v18
    v_exp_f32 v19, v19
    v_exp_f32 v20, v20
    v_exp_f32 v21, v21
    v_exp_f32 v22, v22
    v_exp_f32 v23, v23
    v_exp_f32 v24, v24
    v_exp_f32 v25, v25
    v_exp_f32 v26, v26
    v_exp_f32 v27, v27
    v_exp_f32 v28, v28
    v_exp_f32 v29, v29
    v_exp_f32 v30, v30
    v_exp_f32 v31, v31
    v_add_f32 v9, v12, v13
    v_add_f32 v9, v9, v16
    v_add_f32 v9, v9, v17
    v_add_f32 v9, v9, v18
    v_add_f32 v9, v9, v19
    v_add_f32 v9, v9, v20
    v_add_f32 v9, v9, v21
    v_add_f32 v9, v9, v22
    v_add_f32 v9, v9, v23
    v_add_f32 v9, v9, v24
    v_add_f32 v9, v9, v25
    v_add_f32 v9, v9, v26
    v_add_f32 v9, v9, v27
    v_add_f32 v9, v9, v28
    v_add_f32 v9, v9, v29
    v_add_f32 v9, v9, v30
    v_add_f32 v9, v9, v31
    v_and_b32 v10, 1, v0
    s_cmp_ge_u32 s48, 21
    s_cbranch_scc1 L_bo83
    s_waitcnt vmcnt(3)
L_bo83:
    buffer_load_dwordx4 v[56:59], v1, s[40:43], s98 offen offset:2048 nt
    v_lshlrev_b32 v10, 4, v10
    v_mov_b32 v11, 0xffff
    v_lshlrev_b32 v10, v10, v11
    v_bfe_u32 v11, v0, 1, 2
    v_cmp_eq_u32 vcc, 0, v11
    s_nop 1
    v_cndmask_b32 v144, 0, v10, vcc
    v_cmp_eq_u32 vcc, 1, v11
    s_nop 1
    v_cndmask_b32 v145, 0, v10, vcc
    v_cmp_eq_u32 vcc, 2, v11
    s_nop 1
    v_cndmask_b32 v146, 0, v10, vcc
    v_cmp_eq_u32 vcc, 3, v11
    s_nop 1
    v_cndmask_b32 v147, 0, v10, vcc
    v_add_f32_dpp v9, v9, v9 row_ror:8 row_mask:0xf bank_mask:0xf
    v_mov_b32 v10, v9
    s_nop 1
    v_permlane16_swap_b32 v9, v10
    v_add_f32 v9, v9, v10
    v_mov_b32 v10, v9
    s_nop 1
    v_permlane32_swap_b32 v9, v10
    v_add_f32 v9, v9, v10
    s_lshl_b32 s34, s3, 3
    s_add_u32 s34, s34, 98552
    v_mov_b32 v10, s34
    s_mov_b64 exec, 1
    ds_write_b64 v10, v[8:9]
    s_mov_b64 exec, -1
    s_lshl_b32 s34, s3, 10
    s_add_u32 s34, s34, 98304
    v_lshrrev_b32 v2, 4, v0
    v_and_b32 v11, 7, v0
    v_lshl_add_u32 v2, v2, 3, v11
    v_bfe_u32 v11, v0, 3, 1
    v_lshl_add_u32 v2, v11, 5, v2
    v_lshl_add_u32 v2, v2, 4, s34
    v_cvt_pk_bf16_f32 v10, v12, v12
    v_and_b32 v128, v10, v144
    v_and_b32 v129, v10, v145
    v_and_b32 v130, v10, v146
    v_and_b32 v131, v10, v147
    s_nop 1
    v_mfma_f32_16x16x32_bf16 v[148:151], v[160:163], v[128:131], 0
    v_mfma_f32_16x16x32_bf16 v[152:155], v[164:167], v[128:131], 0
    v_cvt_pk_bf16_f32 v10, v13, v13
    v_and_b32 v132, v10, v144
    v_and_b32 v133, v10, v145
    v_and_b32 v134, v10, v146
    v_and_b32 v135, v10, v147
    s_nop 1
    v_mfma_f32_16x16x32_bf16 v[148:151], v[168:171], v[132:135], v[148:151]
    s_waitcnt vmcnt(4)
    s_cmp_ge_u32 s48, 22
    s_cbranch_scc1 L_bo84
    s_waitcnt vmcnt(3)
L_bo84:
    buffer_load_dwordx4 v[60:63], v1, s[40:43], s98 offen offset:3072 nt
    v_mfma_f32_16x16x32_bf16 v[152:155], v[172:175], v[132:135], v[152:155]
    v_cvt_pk_bf16_f32 v10, v16, v16
    v_and_b32 v128, v10, v144
    v_and_b32 v129, v10, v145
    v_and_b32 v130, v10, v146
    v_and_b32 v131, v10, v147
    s_nop 1
    v_mfma_f32_16x16x32_bf16 v[148:151], v[176:179], v[128:131], v[148:151]
    v_mfma_f32_16x16x32_bf16 v[152:155], v[180:183], v[128:131], v[152:155]
    v_cvt_pk_bf16_f32 v10, v17, v17
    v_and_b32 v132, v10, v144
    v_and_b32 v133, v10, v145
    v_and_b32 v134, v10, v146
    v_and_b32 v135, v10, v147
    s_nop 1
    v_mfma_f32_16x16x32_bf16 v[148:151], v[184:187], v[132:135], v[148:151]
    v_mfma_f32_16x16x32_bf16 v[152:155], v[188:191], v[132:135], v[152:155]
    v_cvt_pk_bf16_f32 v10, v18, v18
    v_and_b32 v128, v10, v144
    v_and_b32 v129, v10, v145
    v_and_b32 v130, v10, v146
    v_and_b32 v131, v10, v147
    s_nop 1
    v_mfma_f32_16x16x32_bf16 v[148:151], v[192:195], v[128:131], v[148:151]
    v_mfma_f32_16x16x32_bf16 v[152:155], v[196:199], v[128:131], v[152:155]
    v_cvt_pk_bf16_f32 v10, v19, v19
    v_and_b32 v132, v10, v144
    v_and_b32 v133, v10, v145
    v_and_b32 v134, v10, v146
    v_and_b32 v135, v10, v147
    s_nop 1
    v_mfma_f32_16x16x32_bf16 v[148:151], v[200:203], v[132:135], v[148:151]
    v_mfma_f32_16x16x32_bf16 v[152:155], v[204:207], v[132:135], v[152:155]
    v_cvt_pk_bf16_f32 v10, v20, v20
    v_and_b32 v128, v10, v144
    v_and_b32 v129, v10, v145
    v_and_b32 v130, v10, v146
    v_and_b32 v131, v10, v147
    s_nop 1
    v_mfma_f32_16x16x32_bf16 v[148:151], v[208:211], v[128:131], v[148:151]
    v_mfma_f32_16x16x32_bf16 v[152:155], v[212:215], v[128:131], v[152:155]
    v_cvt_pk_bf16_f32 v10, v21, v21
    v_and_b32 v132, v10, v144
    v_and_b32 v133, v10, v145
    v_and_b32 v134, v10, v146
    v_and_b32 v135, v10, v147
    s_nop 1
    v_mfma_f32_16x16x32_bf16 v[148:151], v[216:219], v[132:135], v[148:151]
    v_mfma_f32_16x16x32_bf16 v[152:155], v[220:223], v[132:135], v[152:155]
    v_cvt_pk_bf16_f32 v10, v22, v22
    s_waitcnt vmcnt(4)
    s_cmp_ge_u32 s48, 23
    s_cbranch_scc1 L_bo85
    s_waitcnt vmcnt(3)
L_bo85:
    s_add_u32 s98, s98, 28672
    s_cmp_eq_u32 s98, 258048
    s_cselect_b32 s98, 0, s98
    buffer_load_dwordx4 v[64:67], v1, s[40:43], s98 offen offset:0 nt
    v_and_b32 v128, v10, v144
    v_and_b32 v129, v10, v145
    v_and_b32 v130, v10, v146
    v_and_b32 v131, v10, v147
    s_nop 1
    v_mfma_f32_16x16x32_bf16 v[148:151], v[224:227], v[128:131], v[148:151]
    v_mfma_f32_16x16x32_bf16 v[152:155], v[228:231], v[128:131], v[152:155]
    v_cvt_pk_bf16_f32 v10, v23, v23
    v_and_b32 v132, v10, v144
    v_and_b32 v133, v10, v145
    v_and_b32 v134, v10, v146
    v_and_b32 v135, v10, v147
    s_nop 1
    v_mfma_f32_16x16x32_bf16 v[148:151], v[232:235], v[132:135], v[148:151]
    v_mfma_f32_16x16x32_bf16 v[152:155], v[236:239], v[132:135], v[152:155]
    v_cvt_pk_bf16_f32 v10, v24, v24
    v_and_b32 v128, v10, v144
    v_and_b32 v129, v10, v145
    v_and_b32 v130, v10, v146
    v_and_b32 v131, v10, v147
    s_nop 1
    v_mfma_f32_16x16x32_bf16 v[148:151], v[240:243], v[128:131], v[148:151]
    v_mfma_f32_16x16x32_bf16 v[152:155], v[244:247], v[128:131], v[152:155]
    v_cvt_pk_bf16_f32 v10, v25, v25
    v_and_b32 v132, v10, v144
    v_and_b32 v133, v10, v145
    v_and_b32 v134, v10, v146
    v_and_b32 v135, v10, v147
    s_nop 1
    v_mfma_f32_16x16x32_bf16 v[148:151], v[248:251], v[132:135], v[148:151]
    v_mfma_f32_16x16x32_bf16 v[152:155], v[252:255], v[132:135], v[152:155]
    v_cvt_pk_bf16_f32 v10, v26, v26
    v_and_b32 v128, v10, v144
    v_and_b32 v129, v10, v145
    v_and_b32 v130, v10, v146
    v_and_b32 v131, v10, v147
    s_nop 1
    v_mfma_f32_16x16x32_bf16 v[148:151], v[32:35], v[128:131], v[148:151]
    v_mfma_f32_16x16x32_bf16 v[152:155], v[36:39], v[128:131], v[152:155]
    v_cvt_pk_bf16_f32 v10, v27, v27
    v_and_b32 v132, v10, v144
    v_and_b32 v133, v10, v145
    v_and_b32 v134, v10, v146
    v_and_b32 v135, v10, v147
    s_nop 1
    v_mfma_f32_16x16x32_bf16 v[148:151], v[40:43], v[132:135], v[148:151]
    v_mfma_f32_16x16x32_bf16 v[152:155], v[44:47], v[132:135], v[152:155]
    v_cvt_pk_bf16_f32 v10, v28, v28
    v_and_b32 v128, v10, v144
    v_and_b32 v129, v10, v145
    s_waitcnt vmcnt(4)
    s_cmp_ge_u32 s48, 24
    s_cbranch_scc1 L_bo86
    s_waitcnt vmcnt(3)
L_bo86:
    buffer_load_dwordx4 v[68:71], v1, s[40:43], s98 offen offset:1024 nt
    v_and_b32 v130, v10, v146
    v_and_b32 v131, v10, v147
    buffer_load_dwordx4 v[72:75], v1, s[40:43], s98 offen offset:2048 nt
    s_waitcnt vmcnt(5)
    buffer_load_dwordx4 v[76:79], v1, s[40:43], s98 offen offset:3072 nt
    s_barrier
    v_and_b32 v200, 3, v0
    v_bfe_u32 v201, v0, 2, 2
    v_lshrrev_b32 v202, 4, v0
    s_lshl_b32 s34, s3, 10
    s_add_u32 s34, s34, 122112
    v_mul_u32_u24 v203, 320, v201
    v_min_u32 v203, 704, v203
    v_lshl_add_u32 v203, v202, 6, v203
    v_lshl_add_u32 v203, v200, 4, v203
    v_add_u32 v203, s34, v203
    s_movk_i32 s48, 16384
    s_cmp_eq_u32 s63, 0
    s_cbranch_scc1 L_tp_wo
    s_cmp_eq_u32 s63, 1
    s_cbranch_scc1 L_tp_w1
    v_bfe_u32 v205, v0, 3, 2
    v_lshlrev_b32 v204, 3, v205
    v_lshrrev_b32 v205, 5, v0
    v_lshl_add_u32 v204, v205, 2, v204
    v_bfe_u32 v205, v0, 1, 2
    v_add_u32 v204, v204, v205
    v_and_b32 v205, 1, v0
    s_sub_u32 s49, s3, 1
    v_mul_u32_u24 v204, 1280, v204
    v_lshl_add_u32 v204, v205, 4, v204
    s_lshl_b32 s34, s62, 5
    s_mul_i32 s35, s49, 327680
    s_add_u32 s34, s34, s35
    v_add_u32 v204, s34, v204
    s_lshl_b32 s50, s49, 13
    s_add_u32 s50, s50, 40960
    v_lshl_add_u32 v205, v0, 3, s50
    s_lshl_b32 s34, s49, 8
    s_add_u32 s34, s34, s99
    s_and_b32 s35, s60, 1
    s_mul_i32 s35, s35, 917504
    s_add_u32 s34, s34, s35
    s_add_u32 s34, s34, 791552
    s_cmp_eq_u32 s49, 6
    s_cselect_b32 s35, 1, 3
    v_lshlrev_b32 v6, 6, v202
    v_lshl_add_u32 v6, v200, 4, v6
    v_add_u32 v6, s34, v6
    v_lshl_add_u32 v4, v201, 15, v6
    v_min_u32 v5, s35, v201
    v_lshl_add_u32 v5, v5, 15, v6
    v_mov_b32 v7, 99084
    s_lshl_b32 s40, s62, 1
    s_add_u32 s41, s40, 8
    s_add_u32 s42, s40, 2
    s_branch L_tp_e
L_tp_w1:
    v_and_b32 v205, 15, v0
    v_lshlrev_b32 v205, 4, v205
    s_and_b32 s49, s3, 3
    s_mul_i32 s34, s49, 1280
    s_add_u32 s34, s34, s99
    s_add_u32 s34, s34, 786432
    v_lshl_add_u32 v206, v202, 15, v205
    v_add_u32 v206, s34, v206
    s_mul_i32 s34, s49, 3840
    v_add_u32 v205, s34, v205
    s_branch L_tp_e
L_tp_wo:
    s_lshr_b32 s49, s3, 1
    s_lshl_b32 s49, s49, 15
    v_and_b32 v210, 7, v0
    s_mul_i32 s34, s60, 4096
    s_add_u32 s34, s34, s49
    s_add_u32 s34, s34, 1179904
    v_lshrrev_b32 v211, 3, v0
    v_mul_u32_u24 v205, 512, v211
    v_add_u32 v204, s34, v205
    s_lshl_b32 s35, s51, 7
    s_add_u32 s34, s34, s35
    s_sub_u32 s34, s34, 256
    v_lshl_add_u32 v205, v210, 4, v205
    v_add_u32 v205, s34, v205
    s_lshl_b32 s34, s3, 12
    s_add_u32 s34, s34, 40960
    v_lshrrev_b32 v206, 2, v0
    v_lshlrev_b32 v206, 6, v206
    v_lshl_add_u32 v206, v200, 3, v206
    v_add_u32 v206, s34, v206
    s_mul_i32 s34, s3, 1152
    s_add_u32 s34, s34, 107520
    v_mul_u32_u24 v207, 144, v211
    v_lshl_add_u32 v207, v210, 4, v207
    v_add_u32 v207, s34, v207
    v_mul_u32_u24 v208, 144, v210
    v_lshl_add_u32 v208, v202, 4, v208
    v_add_u32 v208, s34, v208
    v_mul_u32_u24 v212, 144, v211
    v_add_u32 v212, s34, v212
    v_mul_u32_u24 v213, 144, v210
    v_add_u32 v213, s34, v213
    v_and_b32 v211, 1, v211
    v_bfe_u32 v203, v0, 1, 2
    v_mul_u32_u24 v203, 144, v203
    v_and_b32 v214, 1, v0
    v_mul_u32_u24 v214, 576, v214
    v_lshl_add_u32 v214, v211, 6, v214
    v_lshl_add_u32 v214, v202, 4, v214
    s_add_u32 s34, s34, 14592
    v_add3_u32 v203, v203, v214, s34
    v_mov_b32 v210, 98816
    v_cmp_eq_u32 vcc, 0, v211
    s_nop 1
    v_cndmask_b32 v209, v208, v210, vcc
    v_cndmask_b32 v208, v210, v208, vcc
L_tp_e:
    v_mfma_f32_16x16x32_bf16 v[148:151], v[48:51], v[128:131], v[148:151]
    v_mfma_f32_16x16x32_bf16 v[152:155], v[52:55], v[128:131], v[152:155]
    v_cvt_pk_bf16_f32 v10, v29, v29
    v_and_b32 v132, v10, v144
    v_and_b32 v133, v10, v145
    v_and_b32 v134, v10, v146
    v_and_b32 v135, v10, v147
    s_waitcnt vmcnt(4)
    s_nop 0
    v_mfma_f32_16x16x32_bf16 v[148:151], v[56:59], v[132:135], v[148:151]
    v_mfma_f32_16x16x32_bf16 v[152:155], v[60:63], v[132:135], v[152:155]
    v_cvt_pk_bf16_f32 v10, v30, v30
    v_and_b32 v128, v10, v144
    v_and_b32 v129, v10, v145
    v_and_b32 v130, v10, v146
    v_and_b32 v131, v10, v147
    s_waitcnt vmcnt(2)
    s_nop 0
    v_mfma_f32_16x16x32_bf16 v[148:151], v[64:67], v[128:131], v[148:151]
    v_mfma_f32_16x16x32_bf16 v[152:155], v[68:71], v[128:131], v[152:155]
    v_cvt_pk_bf16_f32 v10, v31, v31
    v_and_b32 v132, v10, v144
    v_and_b32 v133, v10, v145
    v_and_b32 v134, v10, v146
    v_and_b32 v135, v10, v147
    s_waitcnt vmcnt(0)
    s_nop 0
    v_mfma_f32_16x16x32_bf16 v[148:151], v[72:75], v[132:135], v[148:151]
    v_mfma_f32_16x16x32_bf16 v[152:155], v[76:79], v[132:135], v[152:155]
    s_nop 7
    v_add_f32_dpp v148, v152, v148 row_ror:8 row_mask:0xf bank_mask:0xf
    v_add_f32_dpp v149, v153, v149 row_ror:8 row_mask:0xf bank_mask:0xf
    v_add_f32_dpp v150, v154, v150 row_ror:8 row_mask:0xf bank_mask:0xf
    v_add_f32_dpp v151, v155, v151 row_ror:8 row_mask:0xf bank_mask:0xf
    ds_write_b128 v2, v[148:151]
    s_waitcnt lgkmcnt(0)
    s_barrier
    s_cmp_eq_u32 s63, 0
    s_cbranch_scc1 L_t_wo
    s_cmp_eq_u32 s63, 2
    s_cbranch_scc1 L_t_w2
    s_cmp_eq_u32 s63, 3
    s_cbranch_scc1 L_fin
    s_barrier
L_r_w1:
    s_cmp_lt_u32 s3, 4
    s_cbranch_scc1 L_w1_ln
    s_and_b32 s49, s3, 3
    s_lshl_b32 s42, s49, 11
    s_add_u32 s42, s42, 40960
    s_bitcmp1_b32 s62, 0
    s_cbranch_scc1 L_rot1
    s_add_u32 m0, s42, 0
    s_add_u32 s34, s50, 0
    buffer_load_dwordx4 v15, s[52:55], s34 offen  lds
    s_add_u32 m0, s42, 1024
    s_add_u32 s34, s50, 884736
    buffer_load_dwordx4 v15, s[52:55], s34 offen  lds
    s_add_u32 m0, s42, 8192
    s_add_u32 s34, s50, 110592
    buffer_load_dwordx4 v15, s[52:55], s34 offen  lds
    s_add_u32 m0, s42, 9216
    s_add_u32 s34, s50, 995328
    buffer_load_dwordx4 v15, s[52:55], s34 offen  lds
    s_add_u32 m0, s42, 32768
    s_add_u32 s34, s51, 0
    buffer_load_dwordx4 v15, s[52:55], s34 offen  lds
    s_add_u32 m0, s42, 33792
    s_add_u32 s34, s51, 13824
    buffer_load_dwordx4 v15, s[52:55], s34 offen  lds
    s_add_u32 m0, s42, 16384
    s_add_u32 s34, s50, 221184
    buffer_load_dwordx4 v15, s[52:55], s34 offen  lds
    s_add_u32 m0, s42, 17408
    s_add_u32 s34, s50, 1105920
    buffer_load_dwordx4 v15, s[52:55], s34 offen  lds
    s_add_u32 m0, s42, 24576
    s_add_u32 s34, s50, 331776
    buffer_load_dwordx4 v15, s[52:55], s34 offen  lds
    s_add_u32 m0, s42, 25600
    s_add_u32 s34, s50, 1216512
    buffer_load_dwordx4 v15, s[52:55], s34 offen  lds
    s_branch L_rot2
L_rot1:
    s_add_u32 m0, s42, 16384
    s_add_u32 s34, s50, 221184
    buffer_load_dwordx4 v15, s[52:55], s34 offen  lds
    s_add_u32 m0, s42, 17408
    s_add_u32 s34, s50, 1105920
    buffer_load_dwordx4 v15, s[52:55], s34 offen  lds
    s_add_u32 m0, s42, 24576
    s_add_u32 s34, s50, 331776
    buffer_load_dwordx4 v15, s[52:55], s34 offen  lds
    s_add_u32 m0, s42, 25600
    s_add_u32 s34, s50, 1216512
    buffer_load_dwordx4 v15, s[52:55], s34 offen  lds
    s_add_u32 m0, s42, 32768
    s_add_u32 s34, s51, 0
    buffer_load_dwordx4 v15, s[52:55], s34 offen  lds
    s_add_u32 m0, s42, 33792
    s_add_u32 s34, s51, 13824
    buffer_load_dwordx4 v15, s[52:55], s34 offen  lds
    s_add_u32 m0, s42, 0
    s_add_u32 s34, s50, 0
    buffer_load_dwordx4 v15, s[52:55], s34 offen  lds
    s_add_u32 m0, s42, 1024
    s_add_u32 s34, s50, 884736
    buffer_load_dwordx4 v15, s[52:55], s34 offen  lds
    s_add_u32 m0, s42, 8192
    s_add_u32 s34, s50, 110592
    buffer_load_dwordx4 v15, s[52:55], s34 offen  lds
    s_add_u32 m0, s42, 9216
    s_add_u32 s34, s50, 995328
    buffer_load_dwordx4 v15, s[52:55], s34 offen  lds
L_rot2:
    v_lshrrev_b32 v3, 2, v0
    v_lshlrev_b32 v3, 6, v3
    v_lshl_add_u32 v3, v200, 3, v3
    v_add_u32 v3, s42, v3
    s_lshl_b32 s35, s49, 6
    s_add_u32 s35, s35, 116736
    v_mul_u32_u24 v4, 1344, v200
    v_lshl_add_u32 v4, v202, 4, v4
    v_add_u32 v4, s35, v4
    s_lshl_b32 s35, s49, 10
    s_sub_u32 s35, s35, 4096
    v_add_u32 v5, s35, v203
    v_and_b32 v6, 1, v201
    v_mul_u32_u24 v6, 5376, v6
    v_add_u32 v6, v6, v4
    v_subrev_u32 v6, 90112, v6
    v_subrev_u32 v7, 22784, v5
    s_waitcnt vmcnt(0)
    s_barrier
    ds_read_b64_tr_b16 v[32:33], v3 offset:0
    ds_read_b64_tr_b16 v[34:35], v3 offset:1024
    ds_read_b64_tr_b16 v[36:37], v3 offset:32
    ds_read_b64_tr_b16 v[38:39], v3 offset:1056
    ds_read_b64_tr_b16 v[40:41], v3 offset:8192
    ds_read_b64_tr_b16 v[42:43], v3 offset:9216
    ds_read_b64_tr_b16 v[44:45], v3 offset:8224
    ds_read_b64_tr_b16 v[46:47], v3 offset:9248
    ds_read_b64_tr_b16 v[48:49], v3 offset:16384
    ds_read_b64_tr_b16 v[50:51], v3 offset:17408
    ds_read_b64_tr_b16 v[52:53], v3 offset:16416
    ds_read_b64_tr_b16 v[54:55], v3 offset:17440
    s_waitcnt lgkmcnt(4)
    ds_read_b64_tr_b16 v[56:57], v3 offset:24576
    ds_read_b64_tr_b16 v[58:59], v3 offset:25600
    ds_read_b64_tr_b16 v[60:61], v3 offset:24608
    ds_read_b64_tr_b16 v[62:63], v3 offset:25632
    ds_read_b64_tr_b16 v[64:65], v3 offset:32768
    ds_read_b64_tr_b16 v[66:67], v3 offset:33792
    ds_read_b64_tr_b16 v[68:69], v3 offset:32800
    ds_read_b64_tr_b16 v[70:71], v3 offset:33824
    s_waitcnt lgkmcnt(0)
    ds_read_b128 v[140:143], v6 offset:0
    ds_read_b128 v[144:147], v6 offset:256
    ds_read_b128 v[148:151], v6 offset:512
    ds_read_b128 v[152:155], v6 offset:768
    ds_read_b128 v[156:159], v6 offset:1024
    s_waitcnt lgkmcnt(4)
    v_mfma_f32_16x16x32_bf16 v[20:23], v[32:35], v[140:143], 0
    v_mfma_f32_16x16x32_bf16 v[24:27], v[36:39], v[140:143], 0
    s_waitcnt lgkmcnt(3)
    v_mfma_f32_16x16x32_bf16 v[20:23], v[40:43], v[144:147], v[20:23]
    v_mfma_f32_16x16x32_bf16 v[24:27], v[44:47], v[144:147], v[24:27]
    s_waitcnt lgkmcnt(2)
    v_mfma_f32_16x16x32_bf16 v[20:23], v[48:51], v[148:151], v[20:23]
    v_mfma_f32_16x16x32_bf16 v[24:27], v[52:55], v[148:151], v[24:27]
    s_waitcnt lgkmcnt(1)
    v_mfma_f32_16x16x32_bf16 v[20:23], v[56:59], v[152:155], v[20:23]
    v_mfma_f32_16x16x32_bf16 v[24:27], v[60:63], v[152:155], v[24:27]
    s_waitcnt lgkmcnt(0)
    v_mfma_f32_16x16x32_bf16 v[20:23], v[64:67], v[156:159], v[20:23]
    v_mfma_f32_16x16x32_bf16 v[24:27], v[68:71], v[156:159], v[24:27]
    s_nop 6
    ds_write_b128 v7, v[20:23]
    ds_write_b128 v7, v[24:27] offset:1024
    s_waitcnt lgkmcnt(0)
    s_setprio 3
    s_barrier
    ds_read_b128 v[140:143], v4 offset:0
    ds_read_b128 v[144:147], v4 offset:256
    ds_read_b128 v[148:151], v4 offset:512
    ds_read_b128 v[152:155], v4 offset:768
    ds_read_b128 v[156:159], v4 offset:1024
    s_waitcnt lgkmcnt(4)
    v_mfma_f32_16x16x32_bf16 v[20:23], v[32:35], v[140:143], 0
    v_mfma_f32_16x16x32_bf16 v[24:27], v[36:39], v[140:143], 0
    s_waitcnt lgkmcnt(3)
    v_mfma_f32_16x16x32_bf16 v[20:23], v[40:43], v[144:147], v[20:23]
    v_mfma_f32_16x16x32_bf16 v[24:27], v[44:47], v[144:147], v[24:27]
    s_waitcnt lgkmcnt(2)
    v_mfma_f32_16x16x32_bf16 v[20:23], v[48:51], v[148:151], v[20:23]
    v_mfma_f32_16x16x32_bf16 v[24:27], v[52:55], v[148:151], v[24:27]
    s_waitcnt lgkmcnt(1)
    v_mfma_f32_16x16x32_bf16 v[20:23], v[56:59], v[152:155], v[20:23]
    v_mfma_f32_16x16x32_bf16 v[24:27], v[60:63], v[152:155], v[24:27]
    s_waitcnt lgkmcnt(0)
    v_mfma_f32_16x16x32_bf16 v[20:23], v[64:67], v[156:159], v[20:23]
    v_mfma_f32_16x16x32_bf16 v[24:27], v[68:71], v[156:159], v[24:27]
    s_nop 6
    ds_write_b128 v5, v[20:23]
    ds_write_b128 v5, v[24:27] offset:1024
    s_waitcnt lgkmcnt(0)
    s_barrier
    s_branch L_fin
L_w1_ln:
    s_setprio 1
    ds_read_b128 v[140:143], v205 offset:0
    ds_read_b128 v[144:147], v205 offset:256
    ds_read_b128 v[148:151], v205 offset:512
    ds_read_b128 v[152:155], v205 offset:768
    ds_read_b128 v[156:159], v205 offset:1024
    ds_read_b128 v[160:163], v205 offset:1280
    ds_read_b128 v[164:167], v205 offset:1536
    ds_read_b128 v[168:171], v205 offset:1792
    ds_read_b128 v[172:175], v205 offset:2048
    ds_read_b128 v[176:179], v205 offset:2304
    ds_read_b128 v[180:183], v205 offset:2560
    ds_read_b128 v[184:187], v205 offset:2816
    ds_read_b128 v[188:191], v205 offset:3072
    ds_read_b128 v[192:195], v205 offset:3328
    ds_read_b128 v[196:199], v205 offset:3584
    v_and_b32 v8, 1, v0
    v_lshlrev_b32 v8, 4, v8
    v_mov_b32 v9, 0xffff
    v_lshlrev_b32 v8, v8, v9
    v_bfe_u32 v9, v0, 1, 2
    v_cmp_eq_u32 vcc, 0, v9
    s_nop 1
    v_cndmask_b32 v16, 0, v8, vcc
    v_cmp_eq_u32 vcc, 1, v9
    s_nop 1
    v_cndmask_b32 v17, 0, v8, vcc
    v_cmp_eq_u32 vcc, 2, v9
    s_nop 1
    v_cndmask_b32 v18, 0, v8, vcc
    v_cmp_eq_u32 vcc, 3, v9
    s_nop 1
    v_cndmask_b32 v19, 0, v8, vcc
    v_bfe_u32 v8, v0, 3, 1
    v_cmp_eq_u32 vcc, 0, v8
    s_nop 1
    v_cndmask_b32 v20, 0, v16, vcc
    v_xor_b32 v24, v20, v16
    v_cndmask_b32 v21, 0, v17, vcc
    v_xor_b32 v25, v21, v17
    v_cndmask_b32 v22, 0, v18, vcc
    v_xor_b32 v26, v22, v18
    v_cndmask_b32 v23, 0, v19, vcc
    v_xor_b32 v27, v23, v19
    v_and_b32 v52, 0x3f803f80, v20
    v_and_b32 v60, 0x3e803e80, v20
    v_and_b32 v53, 0x3f803f80, v21
    v_and_b32 v61, 0x3e803e80, v21
    v_and_b32 v54, 0x3f803f80, v22
    v_and_b32 v62, 0x3e803e80, v22
    v_and_b32 v55, 0x3f803f80, v23
    v_and_b32 v63, 0x3e803e80, v23
    v_and_b32 v56, 0x3f803f80, v24
    v_and_b32 v64, 0x3e803e80, v24
    v_and_b32 v57, 0x3f803f80, v25
    v_and_b32 v65, 0x3e803e80, v25
    v_and_b32 v58, 0x3f803f80, v26
    v_and_b32 v66, 0x3e803e80, v26
    v_and_b32 v59, 0x3f803f80, v27
    v_and_b32 v67, 0x3e803e80, v27
    s_waitcnt lgkmcnt(0)
    v_mfma_f32_16x16x32_bf16 v[68:71], v[140:143], v[60:63], 0
    v_mfma_f32_16x16x32_bf16 v[68:71], v[144:147], v[64:67], v[68:71]
    v_mfma_f32_16x16x32_bf16 v[72:75], v[148:151], v[60:63], 0
    v_mfma_f32_16x16x32_bf16 v[72:75], v[152:155], v[64:67], v[72:75]
    v_mfma_f32_16x16x32_bf16 v[76:79], v[156:159], v[60:63], 0
    v_mfma_f32_16x16x32_bf16 v[116:119], v[160:163], v[60:63], 0
    v_mfma_f32_16x16x32_bf16 v[116:119], v[164:167], v[64:67], v[116:119]
    v_mfma_f32_16x16x32_bf16 v[120:123], v[168:171], v[60:63], 0
    v_mfma_f32_16x16x32_bf16 v[120:123], v[172:175], v[64:67], v[120:123]
    v_mfma_f32_16x16x32_bf16 v[124:127], v[176:179], v[60:63], 0
    v_mfma_f32_16x16x32_bf16 v[80:83], v[180:183], v[60:63], 1.0
    v_mfma_f32_16x16x32_bf16 v[80:83], v[184:187], v[64:67], v[80:83]
    v_mfma_f32_16x16x32_bf16 v[84:87], v[188:191], v[60:63], 1.0
    v_mfma_f32_16x16x32_bf16 v[84:87], v[192:195], v[64:67], v[84:87]
    v_mfma_f32_16x16x32_bf16 v[88:91], v[196:199], v[60:63], 1.0
    s_mul_i32 s34, s3, 1344
    s_add_u32 s34, s34, 116736
    v_lshl_add_u32 v7, v0, 4, s34
    v_lshlrev_b32 v8, 6, v202
    v_lshl_add_u32 v8, v200, 4, v8
    v_and_b32 v9, 1, v201
    v_lshl_add_u32 v8, v9, 3, v8
    v_add_u32 v8, s34, v8
    v_bfe_u32 v9, v0, 3, 1
    v_mul_u32_u24 v9, 6144, v9
    v_sub_u32 v8, v8, v9
    v_lshrrev_b32 v9, 5, v0
    v_lshlrev_b32 v9, 10, v9
    v_and_b32 v6, 1, v202
    v_lshl_add_u32 v9, v6, 7, v9
    v_bfe_u32 v6, v0, 1, 1
    v_lshl_add_u32 v9, v6, 6, v9
    v_lshl_add_u32 v9, v201, 4, v9
    v_and_b32 v6, 1, v0
    v_lshl_add_u32 v9, v6, 3, v9
    v_add_u32 v9, 122112, v9
    s_lshr_b32 s34, s62, 3
    s_lshl_b32 s34, s34, 8
    s_and_b32 s49, s62, 3
    s_lshl_b32 s49, s49, 15
    s_add_u32 s34, s34, s49
    s_bfe_u32 s49, s62, 0x10002
    s_lshl_b32 s49, s49, 14
    s_add_u32 s34, s34, s49
    s_add_u32 s34, s34, 791552
    v_lshl_add_u32 v5, v0, 2, s34
    v_add_u32 v4, 917504, v5
    s_bfe_u32 s49, s60, 0x10002
    s_lshl_b32 s49, s49, 13
    s_xor_b32 s53, s99, s49
    s_xor_b32 s52, s53, 8192
    v_subrev_u32 v10, 90112, v7
    v_subrev_u32 v11, 90112, v8
    v_cvt_pk_bf16_f32 v32, v116, v117
    v_cvt_pk_bf16_f32 v33, v118, v119
    v_cvt_pk_bf16_f32 v34, v120, v121
    v_cvt_pk_bf16_f32 v35, v122, v123
    v_cvt_pk_bf16_f32 v36, v124, v125
    v_cvt_pk_bf16_f32 v37, v126, v127
    s_mov_b32 exec_lo, 0x00ff00ff
    s_mov_b32 exec_hi, 0x00ff00ff
    ds_write_b64 v11, v[36:37] offset:6400
    s_mov_b64 exec, -1
    ds_write_b128 v10, v[32:35] offset:5376
    v_cvt_pk_bf16_f32 v20, v80, v81
    v_cvt_pk_bf16_f32 v21, v82, v83
    v_cvt_pk_bf16_f32 v22, v84, v85
    v_cvt_pk_bf16_f32 v23, v86, v87
    v_cvt_pk_bf16_f32 v24, v88, v89
    v_cvt_pk_bf16_f32 v25, v90, v91
    ds_write_b128 v10, v[20:23]
    ds_write_b64 v11, v[24:25] offset:1024
    v_lshlrev_b32 v80, 16, v20
    v_and_b32 v81, 0xffff0000, v20
    v_lshlrev_b32 v82, 16, v21
    v_and_b32 v83, 0xffff0000, v21
    v_lshlrev_b32 v84, 16, v22
    v_and_b32 v85, 0xffff0000, v22
    v_lshlrev_b32 v86, 16, v23
    v_and_b32 v87, 0xffff0000, v23
    v_lshlrev_b32 v88, 16, v24
    v_and_b32 v89, 0xffff0000, v24
    v_lshlrev_b32 v90, 16, v25
    v_and_b32 v91, 0xffff0000, v25
    v_subrev_u32 v11, 22784, v9
    s_lshl_b32 s34, s3, 3
    s_add_u32 s34, s34, 99136
    v_mov_b32 v12, s34
    v_lshlrev_b32 v13, 3, v201
    v_add_u32 v13, 99136, v13
    s_mov_b32 s54, 0
    s_brev_b32 s55, 1
    s_waitcnt lgkmcnt(0)
    s_barrier
    s_mov_b32 s35, 0
    s_mov_b64 s[40:41], -1
    s_mov_b64 s[42:43], -1
L_pb:
    s_mov_b64 exec, s[40:41]
    s_cbranch_execz L_pbs0
    buffer_load_dwordx4 v[140:143], v206, s[44:47], 0 offen offset:0 sc1
    buffer_load_dwordx4 v[148:151], v206, s[44:47], 0 offen offset:256 sc1
    buffer_load_dwordx4 v[156:159], v206, s[44:47], 0 offen offset:512 sc1
    buffer_load_dwordx4 v[164:167], v206, s[44:47], 0 offen offset:768 sc1
    buffer_load_dwordx4 v[172:175], v206, s[44:47], 0 offen offset:1024 sc1
L_pbs0:
    s_mov_b64 exec, s[42:43]
    s_cbranch_execz L_pbs1
    buffer_load_dwordx4 v[144:147], v206, s[44:47], s48 offen offset:0 sc1
    buffer_load_dwordx4 v[152:155], v206, s[44:47], s48 offen offset:256 sc1
    buffer_load_dwordx4 v[160:163], v206, s[44:47], s48 offen offset:512 sc1
    buffer_load_dwordx4 v[168:171], v206, s[44:47], s48 offen offset:768 sc1
    buffer_load_dwordx4 v[176:179], v206, s[44:47], s48 offen offset:1024 sc1
L_pbs1:
    s_mov_b64 exec, -1
    s_add_u32 s35, s35, 1
    s_waitcnt vmcnt(0)
    v_mfma_f32_16x16x32_bf16 v[128:131], v[140:143], v[52:55], v[68:71]
    v_max3_u32 v28, v140, v141, v142
    v_max3_u32 v29, v144, v145, v146
    v_mfma_f32_16x16x32_bf16 v[128:131], v[144:147], v[52:55], v[128:131]
    v_max3_u32 v28, v28, v143, v148
    v_max3_u32 v29, v29, v147, v152
    v_mfma_f32_16x16x32_bf16 v[128:131], v[148:151], v[56:59], v[128:131]
    v_max3_u32 v28, v28, v149, v150
    v_max3_u32 v29, v29, v153, v154
    v_mfma_f32_16x16x32_bf16 v[128:131], v[152:155], v[56:59], v[128:131]
    v_max3_u32 v28, v28, v151, v156
    v_max3_u32 v29, v29, v155, v160
    v_mfma_f32_16x16x32_bf16 v[132:135], v[156:159], v[52:55], v[72:75]
    v_max3_u32 v28, v28, v157, v158
    v_max3_u32 v29, v29, v161, v162
    v_mfma_f32_16x16x32_bf16 v[132:135], v[160:163], v[52:55], v[132:135]
    v_max3_u32 v28, v28, v159, v164
    v_max3_u32 v29, v29, v163, v168
    v_mfma_f32_16x16x32_bf16 v[132:135], v[164:167], v[56:59], v[132:135]
    v_max3_u32 v28, v28, v165, v166
    v_max3_u32 v29, v29, v169, v170
    v_mfma_f32_16x16x32_bf16 v[132:135], v[168:171], v[56:59], v[132:135]
    v_max3_u32 v28, v28, v167, v172
    v_max3_u32 v29, v29, v171, v176
    v_mfma_f32_16x16x32_bf16 v[136:139], v[172:175], v[52:55], v[76:79]
    v_max3_u32 v28, v28, v173, v174
    v_max3_u32 v29, v29, v177, v178
    v_mfma_f32_16x16x32_bf16 v[136:139], v[176:179], v[52:55], v[136:139]
    v_max_u32 v28, v28, v175
    v_max_u32 v29, v29, v179
    v_cmp_eq_u32 s[40:41], -1, v28
    v_cmp_eq_u32 s[42:43], -1, v29
    s_nop 0
    s_or_b64 vcc, s[40:41], s[42:43]
    s_cbranch_scc0 L_pbd
    s_cmp_lg_u32 s35, 64
    s_cbranch_scc1 L_tmo87
    s_mov_b64 exec, -1
    v_lshlrev_b32 v243, 4, v0
    v_add_u32 v243, 131328, v243
    ds_read_b96 v[240:242], v243
    s_waitcnt lgkmcnt(0)
    buffer_store_dword v240, v242, s[44:47], 0 offen sc1
    buffer_store_dword v241, v242, s[44:47], 0 offen offset:256 sc1
L_tmo87:
    s_cmp_lt_u32 s35, 60000
    s_cbranch_scc1 L_pb
L_pbd:
    v_pk_mul_f32 v[32:33], v[128:129], v[80:81]
    v_pk_mul_f32 v[34:35], v[130:131], v[82:83]
    v_pk_mul_f32 v[36:37], v[132:133], v[84:85]
    v_pk_mul_f32 v[38:39], v[134:135], v[86:87]
    v_cvt_pk_bf16_f32 v24, v32, v33
    v_cvt_pk_bf16_f32 v25, v34, v35
    v_cvt_pk_bf16_f32 v26, v36, v37
    v_cvt_pk_bf16_f32 v27, v38, v39
    ds_write_b128 v7, v[24:27]
    v_pk_mul_f32 v[40:41], v[136:137], v[88:89]
    v_pk_mul_f32 v[42:43], v[138:139], v[90:91]
    v_cvt_pk_bf16_f32 v28, v40, v41
    v_cvt_pk_bf16_f32 v29, v42, v43
    ds_write_b64 v8, v[28:29] offset:1024
    v_pk_add_f32 v[20:21], v[128:129], v[130:131]
    v_pk_mul_f32 v[22:23], v[128:129], v[128:129]
    v_pk_add_f32 v[20:21], v[20:21], v[132:133]
    v_pk_fma_f32 v[22:23], v[130:131], v[130:131], v[22:23]
    v_pk_add_f32 v[20:21], v[20:21], v[134:135]
    v_pk_fma_f32 v[22:23], v[132:133], v[132:133], v[22:23]
    v_pk_add_f32 v[20:21], v[20:21], v[136:137]
    v_pk_fma_f32 v[22:23], v[134:135], v[134:135], v[22:23]
    v_pk_add_f32 v[20:21], v[20:21], v[138:139]
    v_pk_fma_f32 v[22:23], v[136:137], v[136:137], v[22:23]
    v_pk_fma_f32 v[22:23], v[138:139], v[138:139], v[22:23]
    s_waitcnt lgkmcnt(0)
    s_barrier
    v_add_f32 v20, v20, v21
    v_add_f32 v21, v22, v23
    s_nop 0
    v_add_f32_dpp v20, v20, v20 row_ror:8 row_mask:0xf bank_mask:0xf
    v_add_f32_dpp v21, v21, v21 row_ror:8 row_mask:0xf bank_mask:0xf
    s_nop 0
    v_add_f32_dpp v20, v20, v20 row_ror:4 row_mask:0xf bank_mask:0xf
    v_add_f32_dpp v21, v21, v21 row_ror:4 row_mask:0xf bank_mask:0xf
    s_nop 0
    v_add_f32_dpp v20, v20, v20 row_ror:2 row_mask:0xf bank_mask:0xf
    v_add_f32_dpp v21, v21, v21 row_ror:2 row_mask:0xf bank_mask:0xf
    s_nop 0
    v_add_f32_dpp v20, v20, v20 row_ror:1 row_mask:0xf bank_mask:0xf
    v_add_f32_dpp v21, v21, v21 row_ror:1 row_mask:0xf bank_mask:0xf
    s_nop 0
    v_add_f32_dpp v20, v20, v20 row_bcast:15 row_mask:0xa bank_mask:0xf
    v_add_f32_dpp v21, v21, v21 row_bcast:15 row_mask:0xa bank_mask:0xf
    s_nop 0
    v_add_f32_dpp v20, v20, v20 row_bcast:31 row_mask:0xc bank_mask:0xf
    v_add_f32_dpp v21, v21, v21 row_bcast:31 row_mask:0xc bank_mask:0xf
    v_mul_f32 v22, 0x3acccccd, v20
    v_mul_f32 v21, 0x3acccccd, v21
    v_fma_f32 v21, -v22, v22, v21
    v_max_f32 v21, 0, v21
    v_add_f32 v21, 0x3727c5ac, v21
    v_rsq_f32 v20, v21
    s_nop 0
    v_mul_f32_e64 v21, -v22, v20
    s_mov_b64 exec, s[54:55]
    ds_write_b64 v12, v[20:21]
    s_mov_b64 exec, -1
    s_cmp_lg_u32 s3, 0
    s_cbranch_scc1 L_w1_x
    ds_read_b64 v[32:33], v11 offset:0
    ds_read_b64 v[40:41], v11 offset:320
    ds_read_b64 v[34:35], v11 offset:2048
    ds_read_b64 v[42:43], v11 offset:2368
    ds_read_b64 v[36:37], v11 offset:4096
    ds_read_b64 v[44:45], v11 offset:4416
    ds_read_b64 v[38:39], v11 offset:6144
    ds_read_b64 v[46:47], v11 offset:6464
    s_mov_b32 s34, 0xbdd2d3e8
    v_mov_b32 v10, 0xc0135761
    s_waitcnt lgkmcnt(8)
    s_barrier
    ds_read_b64 v[28:29], v13
    ds_read_b64 v[20:21], v9 offset:0
    ds_read_b64 v[22:23], v9 offset:2048
    ds_read_b64 v[24:25], v9 offset:4096
    ds_read_b64 v[26:27], v9 offset:6144
    s_waitcnt lgkmcnt(5)
    v_pk_add_f32 v[100:101], v[100:101], v[40:41]
    v_pk_add_f32 v[100:101], v[100:101], v[42:43]
    v_pk_add_f32 v[32:33], v[32:33], v[34:35]
    v_pk_add_f32 v[100:101], v[100:101], v[44:45]
    v_pk_add_f32 v[32:33], v[32:33], v[36:37]
    v_pk_add_f32 v[100:101], v[100:101], v[46:47]
    v_pk_add_f32 v[32:33], v[32:33], v[38:39]
    s_waitcnt lgkmcnt(4)
    v_pk_fma_f32 v[100:101], v[32:33], v[28:29], v[100:101] op_sel:[0,1,0] op_sel_hi:[1,1,1]
    s_waitcnt lgkmcnt(3)
    v_pk_fma_f32 v[100:101], v[20:21], v[28:29], v[100:101] op_sel_hi:[1,0,1]
    s_waitcnt lgkmcnt(2)
    v_pk_fma_f32 v[100:101], v[22:23], v[28:29], v[100:101] op_sel_hi:[1,0,1]
    s_waitcnt lgkmcnt(1)
    v_pk_fma_f32 v[100:101], v[24:25], v[28:29], v[100:101] op_sel_hi:[1,0,1]
    s_waitcnt lgkmcnt(0)
    v_pk_fma_f32 v[100:101], v[26:27], v[28:29], v[100:101] op_sel_hi:[1,0,1]
    v_pk_mul_f32 v[20:21], v[100:101], v[100:101]
    v_fma_f32 v20, v20, s34, v10
    v_fma_f32 v21, v21, s34, v10
    v_pk_mul_f32 v[20:21], v[20:21], v[100:101]
    v_exp_f32 v20, v20
    v_exp_f32 v21, v21
    v_add_f32 v20, 1.0, v20
    v_add_f32 v21, 1.0, v21
    v_rcp_f32 v20, v20
    v_rcp_f32 v21, v21
    s_nop 0
    v_pk_mul_f32 v[20:21], v[20:21], v[100:101]
    v_cvt_pk_bf16_f32 v20, v20, v21
    v_min_u32 v20, -2, v20
    buffer_store_dword v20, v5, s[44:47], s52 offen sc1
    buffer_store_dword v20, v4, s[44:47], s52 offen sc1
    buffer_store_dword v20, v5, s[44:47], s53 offen sc1
    buffer_store_dword v20, v4, s[44:47], s53 offen sc1
    s_branch L_fin
L_w1_x:
    s_waitcnt lgkmcnt(0)
    s_barrier
    s_branch L_fin
L_t_w2:
    s_barrier
L_w2_dma:
    s_and_b32 s34, s40, 7
    s_lshl_b32 s35, s34, 10
    s_add_u32 m0, s50, s35
    s_mul_i32 s34, s34, 40960
    buffer_load_dwordx4 v204, s[52:55], s34 offen  lds
    s_add_u32 s40, s40, 1
    s_cmp_lg_u32 s40, s42
    s_cbranch_scc1 L_w2_nw
L_w2_nw:
    s_cmp_lt_u32 s40, s41
    s_cbranch_scc1 L_w2_dma
    ds_read_b32 v8, v7
    s_waitcnt lgkmcnt(0)
    v_cmp_eq_u32 vcc, 0, v8
    s_cbranch_vccnz L_w2_slow
    s_mov_b32 s35, 0
    buffer_load_dwordx4 v[64:67], v4, s[44:47], 0 offen sc1
    buffer_load_dwordx4 v[68:71], v5, s[44:47], s48 offen sc1
    s_waitcnt vmcnt(2)
    ds_read_b64_tr_b16 v[32:33], v205 offset:0
    ds_read_b64_tr_b16 v[34:35], v205 offset:512
    ds_read_b64_tr_b16 v[36:37], v205 offset:1024
    ds_read_b64_tr_b16 v[38:39], v205 offset:1536
    ds_read_b64_tr_b16 v[40:41], v205 offset:2048
    ds_read_b64_tr_b16 v[42:43], v205 offset:2560
    ds_read_b64_tr_b16 v[44:45], v205 offset:3072
    ds_read_b64_tr_b16 v[46:47], v205 offset:3584
    s_waitcnt lgkmcnt(0)
    ds_read_b64_tr_b16 v[48:49], v205 offset:4096
    ds_read_b64_tr_b16 v[50:51], v205 offset:4608
    ds_read_b64_tr_b16 v[52:53], v205 offset:5120
    ds_read_b64_tr_b16 v[54:55], v205 offset:5632
    ds_read_b64_tr_b16 v[56:57], v205 offset:6144
    ds_read_b64_tr_b16 v[58:59], v205 offset:6656
    ds_read_b64_tr_b16 v[60:61], v205 offset:7168
    ds_read_b64_tr_b16 v[62:63], v205 offset:7680
    s_waitcnt lgkmcnt(0)
    s_branch L_w2_mid
L_w2_slow:
    s_waitcnt vmcnt(0)
    ds_read_b64_tr_b16 v[32:33], v205 offset:0
    ds_read_b64_tr_b16 v[34:35], v205 offset:512
    ds_read_b64_tr_b16 v[36:37], v205 offset:1024
    ds_read_b64_tr_b16 v[38:39], v205 offset:1536
    ds_read_b64_tr_b16 v[40:41], v205 offset:2048
    ds_read_b64_tr_b16 v[42:43], v205 offset:2560
    ds_read_b64_tr_b16 v[44:45], v205 offset:3072
    ds_read_b64_tr_b16 v[46:47], v205 offset:3584
    s_waitcnt lgkmcnt(0)
    ds_read_b64_tr_b16 v[48:49], v205 offset:4096
    ds_read_b64_tr_b16 v[50:51], v205 offset:4608
    ds_read_b64_tr_b16 v[52:53], v205 offset:5120
    ds_read_b64_tr_b16 v[54:55], v205 offset:5632
    ds_read_b64_tr_b16 v[56:57], v205 offset:6144
    ds_read_b64_tr_b16 v[58:59], v205 offset:6656
    ds_read_b64_tr_b16 v[60:61], v205 offset:7168
    ds_read_b64_tr_b16 v[62:63], v205 offset:7680
    s_waitcnt lgkmcnt(0)
    s_mov_b32 s35, 0
L_poll88:
    ds_read_b32 v8, v7
    s_add_u32 s35, s35, 1
    s_waitcnt lgkmcnt(0)
    v_cmp_eq_u32 vcc, 0, v8
    s_cbranch_vccz L_done89
    s_sleep 1
    s_cmp_lt_u32 s35, 60000
    s_cbranch_scc1 L_poll88
L_done89:
    s_mov_b32 s35, 0
L_poll91:
    buffer_load_dwordx4 v[64:67], v4, s[44:47], 0 offen sc1
    buffer_load_dwordx4 v[68:71], v5, s[44:47], s48 offen sc1
L_w2_mid:
    s_add_u32 s35, s35, 1
    s_waitcnt vmcnt(0)
    v_max3_u32 v28, v64, v65, v66
    v_max3_u32 v28, v28, v67, v68
    v_max3_u32 v28, v28, v69, v70
    v_max_u32 v28, v28, v71
    v_cmp_eq_u32 vcc, -1, v28
    s_cbranch_vccz L_done92
    s_cmp_lg_u32 s35, 64
    s_cbranch_scc1 L_tmo94
    s_mov_b64 exec, -1
    v_lshlrev_b32 v243, 4, v0
    v_add_u32 v243, 131328, v243
    ds_read_b96 v[240:242], v243
    s_waitcnt lgkmcnt(0)
    buffer_store_dword v240, v242, s[44:47], 0 offen sc1
    buffer_store_dword v241, v242, s[44:47], 0 offen offset:256 sc1
L_tmo94:
    s_cmp_lt_u32 s35, 60000
    s_cbranch_scc1 L_poll91
L_done92:
    v_mfma_f32_16x16x32_bf16 v[80:83], v[32:35], v[64:67], 0
    v_mfma_f32_16x16x32_bf16 v[80:83], v[48:51], v[68:71], v[80:83]
    v_mfma_f32_16x16x32_bf16 v[84:87], v[36:39], v[64:67], 0
    v_mfma_f32_16x16x32_bf16 v[84:87], v[52:55], v[68:71], v[84:87]
    v_mfma_f32_16x16x32_bf16 v[88:91], v[40:43], v[64:67], 0
    v_mfma_f32_16x16x32_bf16 v[88:91], v[56:59], v[68:71], v[88:91]
    v_mfma_f32_16x16x32_bf16 v[92:95], v[44:47], v[64:67], 0
    v_mfma_f32_16x16x32_bf16 v[92:95], v[60:63], v[68:71], v[92:95]
    s_nop 3
    v_add_f32_dpp v80, v84, v80 row_shl:4 row_mask:0xf bank_mask:0x1
    v_add_f32_dpp v81, v85, v81 row_shl:4 row_mask:0xf bank_mask:0x1
    v_add_f32_dpp v82, v86, v82 row_shl:4 row_mask:0xf bank_mask:0x1
    v_add_f32_dpp v83, v87, v83 row_shl:4 row_mask:0xf bank_mask:0x1
    v_add_f32_dpp v80, v88, v80 row_shl:8 row_mask:0xf bank_mask:0x1
    v_add_f32_dpp v81, v89, v81 row_shl:8 row_mask:0xf bank_mask:0x1
    v_add_f32_dpp v82, v90, v82 row_shl:8 row_mask:0xf bank_mask:0x1
    v_add_f32_dpp v83, v91, v83 row_shl:8 row_mask:0xf bank_mask:0x1
    v_add_f32_dpp v80, v92, v80 row_shl:12 row_mask:0xf bank_mask:0x1
    v_add_f32_dpp v81, v93, v81 row_shl:12 row_mask:0xf bank_mask:0x1
    v_add_f32_dpp v82, v94, v82 row_shl:12 row_mask:0xf bank_mask:0x1
    v_add_f32_dpp v83, v95, v83 row_shl:12 row_mask:0xf bank_mask:0x1
    ds_write_b128 v203, v[80:83]
    s_waitcnt lgkmcnt(0)
    s_barrier
    s_branch L_fin
L_w2_red:
    s_mov_b32 s35, 0
L_poll95:
    buffer_load_dwordx2 v[20:21], v204, s[44:47], 0 offen sc1
    buffer_load_dwordx2 v[22:23], v204, s[44:47], s48 offen sc1
    s_add_u32 s35, s35, 1
    s_waitcnt vmcnt(0)
    v_max3_u32 v28, v20, v21, v22
    v_max_u32 v28, v28, v23
    v_cmp_eq_u32 vcc, -1, v28
    s_cbranch_vccz L_done96
    s_cmp_lg_u32 s35, 21
    s_cbranch_scc1 L_tmo98
    s_mov_b64 exec, -1
    v_lshlrev_b32 v243, 4, v0
    v_add_u32 v243, 131328, v243
    ds_read_b96 v[240:242], v243
    s_waitcnt lgkmcnt(0)
    buffer_store_dword v240, v242, s[44:47], 0 offen sc1
    buffer_store_dword v241, v242, s[44:47], 0 offen offset:256 sc1
L_tmo98:
    s_sleep 6
    s_cmp_lt_u32 s35, 60000
    s_cbranch_scc1 L_poll95
L_done96:
    v_mov_b32 v7, 99084
    ds_write_b32 v7, v7
    v_lshlrev_b32 v44, 16, v20
    v_and_b32 v45, 0xffff0000, v20
    v_lshlrev_b32 v46, 16, v21
    v_and_b32 v47, 0xffff0000, v21
    v_lshlrev_b32 v48, 16, v22
    v_and_b32 v49, 0xffff0000, v22
    v_lshlrev_b32 v50, 16, v23
    v_and_b32 v51, 0xffff0000, v23
    v_add_f32 v108, v108, v44
    v_add_f32 v109, v109, v45
    v_add_f32 v110, v110, v46
    v_add_f32 v111, v111, v47
    v_add_f32 v108, v108, v48
    v_add_f32 v109, v109, v49
    v_add_f32 v110, v110, v50
    v_add_f32 v111, v111, v51
    s_mov_b32 s36, s28
    s_mov_b32 s37, s29
    s_movk_i32 s38, 5120
    v_add_f32_dpp v108, v108, v108 row_ror:4 row_mask:0xf bank_mask:0xf
    v_add_f32_dpp v109, v109, v109 row_ror:4 row_mask:0xf bank_mask:0xf
    v_add_f32_dpp v110, v110, v110 row_ror:4 row_mask:0xf bank_mask:0xf
    v_add_f32_dpp v111, v111, v111 row_ror:4 row_mask:0xf bank_mask:0xf
    v_add_f32_dpp v108, v108, v108 row_ror:8 row_mask:0xf bank_mask:0xf
    v_add_f32_dpp v109, v109, v109 row_ror:8 row_mask:0xf bank_mask:0xf
    v_add_f32_dpp v110, v110, v110 row_ror:8 row_mask:0xf bank_mask:0xf
    v_add_f32_dpp v111, v111, v111 row_ror:8 row_mask:0xf bank_mask:0xf
    v_mov_b32_dpp v108, v104 quad_perm:[0,1,2,3] row_mask:0xf bank_mask:0x2
    v_mov_b32_dpp v109, v105 quad_perm:[0,1,2,3] row_mask:0xf bank_mask:0x2
    v_mov_b32_dpp v110, v106 quad_perm:[0,1,2,3] row_mask:0xf bank_mask:0x2
    v_mov_b32_dpp v111, v107 quad_perm:[0,1,2,3] row_mask:0xf bank_mask:0x2
    ds_write_b128 v203, v[108:111]
    v_and_b32 v6, 31, v0
    v_lshlrev_b32 v6, 3, v6
    v_add_u32 v6, 122112, v6
    ds_read_b64 v[108:109], v6
    ds_read_b64 v[104:105], v6 offset:320
    v_bfe_u32 v112, v0, 1, 2
    v_mul_u32_u24 v112, 1280, v112
    v_bfe_u32 v7, v0, 3, 2
    v_lshl_add_u32 v112, v7, 3, v112
    v_and_b32 v7, 1, v0
    v_lshl_add_u32 v112, v7, 2, v112
    v_lshrrev_b32 v7, 5, v0
    v_lshl_add_u32 v112, v7, 28, v112
    s_lshl_b32 s34, s62, 5
    s_waitcnt lgkmcnt(0)
    s_barrier
    ds_read_b64 v[64:65], v6 offset:1024
    ds_read_b64 v[66:67], v6 offset:2048
    ds_read_b64 v[68:69], v6 offset:3072
    ds_read_b64 v[70:71], v6 offset:4096
    ds_read_b64 v[72:73], v6 offset:5120
    ds_read_b64 v[74:75], v6 offset:6144
    ds_read_b64 v[76:77], v6 offset:7168
    s_waitcnt lgkmcnt(6)
    v_pk_fma_f32 v[108:109], v[64:65], v[104:105], v[108:109]
    s_waitcnt lgkmcnt(5)
    v_pk_fma_f32 v[108:109], v[66:67], v[104:105], v[108:109]
    s_waitcnt lgkmcnt(4)
    v_pk_fma_f32 v[108:109], v[68:69], v[104:105], v[108:109]
    s_waitcnt lgkmcnt(3)
    v_pk_fma_f32 v[108:109], v[70:71], v[104:105], v[108:109]
    s_waitcnt lgkmcnt(2)
    v_pk_fma_f32 v[108:109], v[72:73], v[104:105], v[108:109]
    s_waitcnt lgkmcnt(1)
    v_pk_fma_f32 v[108:109], v[74:75], v[104:105], v[108:109]
    s_waitcnt lgkmcnt(0)
    v_pk_fma_f32 v[108:109], v[76:77], v[104:105], v[108:109]
    v_cvt_pk_bf16_f32 v20, v108, v109
    buffer_store_dword v20, v112, s[36:39], s34 offen
    s_branch L_fin
L_t_wo:
    s_barrier
L_r_wo2:
    s_mov_b32 m0, s56
    s_nop 0
    buffer_load_dwordx4 v15, s[52:55], s57 offen  lds
    s_mov_b32 m0, s58
    s_nop 0
    buffer_load_dwordx4 v15, s[52:55], s59 offen  lds
    s_xor_b32 m0, s56, 2048
    s_sub_u32 s34, 40960, s57
    buffer_load_dwordx4 v15, s[52:55], s34 offen  lds
    s_xor_b32 m0, s58, 2048
    s_sub_u32 s34, 42240, s57
    buffer_load_dwordx4 v15, s[52:55], s34 offen  lds
L_r_wo3:
    s_mov_b32 s35, 0
    s_mov_b32 s48, 0
    buffer_load_dwordx4 v[64:67], v205, s[44:47], 0 offen sc1
    buffer_load_dwordx2 v[26:27], v204, s[44:47], 0 offen sc1
    s_waitcnt vmcnt(2)
    ds_read_b64_tr_b16 v[32:33], v206 offset:0
    ds_read_b64_tr_b16 v[34:35], v206 offset:1024
    ds_read_b64_tr_b16 v[36:37], v206 offset:32
    ds_read_b64_tr_b16 v[38:39], v206 offset:1056
    ds_read_b64_tr_b16 v[40:41], v206 offset:2048
    ds_read_b64_tr_b16 v[42:43], v206 offset:3072
    ds_read_b64_tr_b16 v[44:45], v206 offset:2080
    ds_read_b64_tr_b16 v[46:47], v206 offset:3104
    s_branch L_pam
L_pa:
    buffer_load_dwordx4 v[64:67], v205, s[44:47], 0 offen sc1
    buffer_load_dwordx2 v[26:27], v204, s[44:47], 0 offen sc1
L_pam:
    s_add_u32 s35, s35, 1
    s_waitcnt vmcnt(0)
    ds_write_b128 v207, v[64:67]
    ds_write_b32 v212, v26 offset:128
    v_max3_u32 v28, v64, v65, v66
    v_max3_u32 v28, v28, v67, v26
    v_cmp_eq_u32 vcc, -1, v28
    s_cbranch_vccz L_pad
    s_cmp_lg_u32 s35, 64
    s_cbranch_scc1 L_tmo99
    s_mov_b64 exec, -1
    v_lshlrev_b32 v243, 4, v0
    v_add_u32 v243, 131328, v243
    ds_read_b96 v[240:242], v243
    s_waitcnt lgkmcnt(0)
    buffer_store_dword v240, v242, s[44:47], 0 offen sc1
    buffer_store_dword v241, v242, s[44:47], 0 offen offset:256 sc1
L_tmo99:
    s_mov_b64 exec, vcc
    s_cmp_lt_u32 s35, 60000
    s_cbranch_scc1 L_pa
L_pad:
    s_mov_b64 exec, -1
    ds_read_b32 v26, v213 offset:128
    ds_read_b128 v[68:71], v208 offset:0
    ds_read_b128 v[72:75], v209 offset:0
    ds_read_b128 v[76:79], v208 offset:64
    ds_read_b128 v[80:83], v209 offset:64
    s_waitcnt lgkmcnt(3)
    v_mfma_f32_16x16x32_bf16 v[20:23], v[32:35], v[68:71], 0
    s_waitcnt lgkmcnt(2)
    v_mfma_f32_16x16x32_bf16 v[20:23], v[36:39], v[72:75], v[20:23]
    s_waitcnt lgkmcnt(1)
    v_mfma_f32_16x16x32_bf16 v[20:23], v[40:43], v[76:79], v[20:23]
    s_waitcnt lgkmcnt(0)
    v_mfma_f32_16x16x32_bf16 v[20:23], v[44:47], v[80:83], v[20:23]
    v_sub_f32_dpp v26, v26, v26 quad_perm:[1,0,3,2] row_mask:0xf bank_mask:0xf
    v_exp_f32 v26, v26
    s_nop 0
    v_add_f32 v26, 1.0, v26
    v_rcp_f32 v26, v26
    s_nop 0
    v_sub_f32 v30, 1.0, v26
    s_nop 0
    v_pk_mul_f32 v[48:49], v[20:21], v[26:27] op_sel_hi:[1,0]
    v_pk_mul_f32 v[50:51], v[22:23], v[26:27] op_sel_hi:[1,0]
    v_fmac_f32_dpp v48, v20, v30 quad_perm:[1,0,3,2] row_mask:0xf bank_mask:0xf
    v_fmac_f32_dpp v49, v21, v30 quad_perm:[1,0,3,2] row_mask:0xf bank_mask:0xf
    v_fmac_f32_dpp v50, v22, v30 quad_perm:[1,0,3,2] row_mask:0xf bank_mask:0xf
    v_fmac_f32_dpp v51, v23, v30 quad_perm:[1,0,3,2] row_mask:0xf bank_mask:0xf
    ds_write_b128 v203, v[48:51]
    s_cmp_lg_u32 s3, 0
    s_waitcnt lgkmcnt(0)
    s_barrier
    s_cbranch_scc1 L_wo_x
    ds_read_b64 v[64:65], v113 offset:0
    ds_read_b64 v[66:67], v113 offset:1152
    ds_read_b64 v[68:69], v113 offset:2304
    ds_read_b64 v[70:71], v113 offset:3456
    ds_read_b64 v[72:73], v113 offset:4608
    ds_read_b64 v[74:75], v113 offset:5760
    ds_read_b64 v[76:77], v113 offset:6912
    ds_read_b64 v[78:79], v113 offset:8064
    s_waitcnt lgkmcnt(6)
    v_pk_add_f32 v[64:65], v[64:65], v[66:67]
    s_waitcnt lgkmcnt(5)
    v_pk_add_f32 v[64:65], v[64:65], v[68:69]
    s_waitcnt lgkmcnt(4)
    v_pk_add_f32 v[64:65], v[64:65], v[70:71]
    s_waitcnt lgkmcnt(3)
    v_pk_add_f32 v[64:65], v[64:65], v[72:73]
    s_waitcnt lgkmcnt(2)
    v_pk_add_f32 v[64:65], v[64:65], v[74:75]
    s_waitcnt lgkmcnt(1)
    v_pk_add_f32 v[64:65], v[64:65], v[76:77]
    s_waitcnt lgkmcnt(0)
    v_pk_add_f32 v[64:65], v[64:65], v[78:79]
    v_pk_mul_f32 v[64:65], v[64:65], v[100:101]
    v_cvt_pk_bf16_f32 v28, v64, v65
    v_min_u32 v28, -2, v28
    buffer_store_dword v28, v112, s[44:47], s101 offen sc1
    buffer_store_dword v28, v112, s[44:47], s93 offen sc1
L_wo_x:
    s_getreg_b32 s34, hwreg(HW_REG_XCC_ID, 0, 4)
    v_cmp_ne_u32 vcc, s34, v27
    s_cbranch_vccz L_fin
    s_mov_b64 exec, -1
    v_lshlrev_b32 v243, 4, v0
    v_add_u32 v243, 131328, v243
    ds_read_b96 v[240:242], v243
    s_waitcnt lgkmcnt(0)
    buffer_store_dword v240, v242, s[44:47], 0 offen sc1
    buffer_store_dword v241, v242, s[44:47], 0 offen offset:256 sc1
L_fin:
L_exit:
    s_endpgm
L_codeend:
.section .rodata,"a"
.p2align 6
.amdhsa_kernel adaLN_cond__sliding_block_cached__dense_activation_gelu__decode_kernel
  .amdhsa_next_free_vgpr 256
  .amdhsa_next_free_sgpr 102
  .amdhsa_accum_offset 256
  .amdhsa_group_segment_fixed_size 0
  .amdhsa_kernarg_size 120
  .amdhsa_user_sgpr_count 2
  .amdhsa_user_sgpr_kernarg_segment_ptr 1
  .amdhsa_system_sgpr_workgroup_id_x 1
  .amdhsa_float_denorm_mode_32 3
.end_amdhsa_kernel
```

```asm
; @launch grid=(256,1,1) block=(512,1,1) lds=132352
.amdgcn_target "amdgcn-amd-amdhsa--gfx950"
.text
.globl adaLN_cond__sliding_block_cached__dense_activation_gelu__decode_kernel
.p2align 8
.type adaLN_cond__sliding_block_cached__dense_activation_gelu__decode_kernel,@function
adaLN_cond__sliding_block_cached__dense_activation_gelu__decode_kernel:
    s_load_dwordx16 s[4:19], s[0:1], 0
    s_load_dwordx8 s[20:27], s[0:1], 64
    s_cmpk_ge_u32 s2, 256
    s_cbranch_scc1 L_exit
    v_lshrrev_b32 v1, 6, v0
    v_and_b32 v0, 63, v0
    v_readfirstlane_b32 s3, v1
    v_lshrrev_b32 v10, 3, v0
    v_and_b32 v11, 7, v0
    v_lshlrev_b32 v11, 4, v11
    s_lshr_b32 s50, s2, 2
    s_and_b32 s51, s2, 3
    s_lshl_b32 s34, s50, 7
    s_and_b32 s49, s2, 31
    s_lshl_b32 s49, s49, 8
    s_and_b32 s35, s2, 0x80
    s_add_u32 s49, s49, s35
    s_bfe_u32 s53, s2, 0x20005
    s_cmpk_lt_u32 s2, 240
    s_cselect_b32 s38, 4915200, 0
    s_movk_i32 s48, 7680
    s_mul_i32 m0, s3, 5120
    s_and_b32 s52, s3, 3
    s_cmp_ge_u32 s3, 4
    s_cselect_b32 s34, s49, s34
    s_cselect_b32 s35, s53, s51
    s_cmovk_i32 s48, 8192
    s_cmov_b32 s38, 5242880
    s_mul_i32 s35, s35, 160
    s_mul_i32 s52, s52, 40
    v_add_u32 v10, s35, v10
    v_add_u32 v10, s52, v10
    v_mad_u32_u24 v8, v10, s48, v11
    s_mul_i32 s48, s48, 8
    s_mov_b32 s39, 0x20000
    s_waitcnt lgkmcnt(0)
    s_cselect_b32 s36, s10, s26
    s_cselect_b32 s37, s11, s27
    buffer_load_dwordx4 v8, s[36:39], s34 offen nt lds
    s_add_u32 m0, m0, 1024
    s_add_u32 s34, s34, s48
    buffer_load_dwordx4 v8, s[36:39], s34 offen nt lds
    s_add_u32 m0, m0, 1024
    s_add_u32 s34, s34, s48
    buffer_load_dwordx4 v8, s[36:39], s34 offen nt lds
    s_add_u32 m0, m0, 1024
    s_add_u32 s34, s34, s48
    buffer_load_dwordx4 v8, s[36:39], s34 offen nt lds
    s_add_u32 m0, m0, 1024
    s_add_u32 s34, s34, s48
    buffer_load_dwordx4 v8, s[36:39], s34 offen nt lds
    s_load_dwordx4 s[28:31], s[0:1], 96
    s_load_dwordx2 s[32:33], s[0:1], 112
    s_and_b32 s60, s2, 7
    s_lshr_b32 s61, s2, 3
    s_mov_b32 s39, 0x20000
    s_mov_b32 s43, 0x20000
    s_mov_b32 s46, 1835008
    s_mov_b32 s47, 0x20000
    s_cmp_lg_u32 s3, 0
    s_cbranch_scc1 L_stream
    s_setprio 3
    v_and_b32 v12, 3, v0
    v_bfe_u32 v13, v0, 2, 2
    v_lshrrev_b32 v14, 4, v0
    v_mul_u32_u24 v16, 1280, v12
    v_lshl_add_u32 v18, v14, 4, v16
    s_mul_i32 s34, s51, 320
    v_add_u32 v19, s34, v18
    s_sub_u32 s52, s50, 10
    s_waitcnt lgkmcnt(0)
    s_add_u32 s44, s32, 0
    s_addc_u32 s45, s33, 0
    s_cmp_ge_u32 s2, 240
    s_cbranch_scc1 L_clear
    v_lshlrev_b32 v1, 2, v0
    v_add_u32 v1, 98304, v1
    v_mov_b32 v2, -1
    v_mov_b32 v3, 0
    ds_write_b32 v1, v2
    ds_write_b32 v1, v2 offset:256
    ds_write_b32 v1, v3 offset:512
    ds_write_b32 v1, v3 offset:768
    s_waitcnt lgkmcnt(0)
    s_barrier
    s_cmp_ge_u32 s52, 10
    s_cbranch_scc1 L_nox
    v_lshl_add_u32 v18, v13, 6, v18
    global_load_dwordx4 v[52:55], v18, s[4:5] offset:0
    global_load_dwordx4 v[56:59], v18, s[4:5] offset:256
    global_load_dwordx4 v[60:63], v18, s[4:5] offset:512
    global_load_dwordx4 v[64:67], v18, s[4:5] offset:768
    global_load_dwordx4 v[68:71], v18, s[4:5] offset:1024
    s_lshl_b32 s34, s52, 7
    v_lshl_add_u32 v16, v13, 5, v16
    v_lshl_add_u32 v16, v14, 3, v16
    v_add_u32 v16, s34, v16
    global_load_dwordx2 v[72:73], v16, s[4:5]
L_nox:
    global_load_dwordx4 v[32:35], v19, s[24:25] offset:0
    global_load_dwordx4 v[36:39], v19, s[24:25] offset:64
    global_load_dwordx4 v[40:43], v19, s[24:25] offset:128
    global_load_dwordx4 v[44:47], v19, s[24:25] offset:192
    global_load_dwordx4 v[48:51], v19, s[24:25] offset:256
    v_lshl_add_u32 v15, v14, 3, v13
    v_lshlrev_b32 v15, 7, v15
    v_lshl_add_u32 v15, v12, 3, v15
    s_waitcnt vmcnt(0)
    s_mov_b32 s34, 0xbfb8aa3b
    v_lshlrev_b32 v20, 16, v32
    v_and_b32 v21, 0xffff0000, v32
    v_lshlrev_b32 v22, 16, v33
    v_and_b32 v23, 0xffff0000, v33
    v_mul_f32 v24, s34, v20
    v_mul_f32 v25, s34, v21
    v_mul_f32 v26, s34, v22
    v_mul_f32 v27, s34, v23
    v_exp_f32 v24, v24
    v_exp_f32 v25, v25
    v_exp_f32 v26, v26
    v_exp_f32 v27, v27
    v_add_f32 v24, 1.0, v24
    v_add_f32 v25, 1.0, v25
    v_add_f32 v26, 1.0, v26
    v_add_f32 v27, 1.0, v27
    v_rcp_f32 v24, v24
    v_rcp_f32 v25, v25
    v_rcp_f32 v26, v26
    v_rcp_f32 v27, v27
    v_mul_f32 v24, v20, v24
    v_mul_f32 v25, v21, v25
    v_mul_f32 v26, v22, v26
    v_mul_f32 v27, v23, v27
    v_cvt_pk_bf16_f32 v32, v24, v25
    v_cvt_pk_bf16_f32 v33, v26, v27
    v_lshlrev_b32 v20, 16, v34
    v_and_b32 v21, 0xffff0000, v34
    v_lshlrev_b32 v22, 16, v35
    v_and_b32 v23, 0xffff0000, v35
    v_mul_f32 v24, s34, v20
    v_mul_f32 v25, s34, v21
    v_mul_f32 v26, s34, v22
    v_mul_f32 v27, s34, v23
    v_exp_f32 v24, v24
    v_exp_f32 v25, v25
    v_exp_f32 v26, v26
    v_exp_f32 v27, v27
    v_add_f32 v24, 1.0, v24
    v_add_f32 v25, 1.0, v25
    v_add_f32 v26, 1.0, v26
    v_add_f32 v27, 1.0, v27
    v_rcp_f32 v24, v24
    v_rcp_f32 v25, v25
    v_rcp_f32 v26, v26
    v_rcp_f32 v27, v27
    v_mul_f32 v24, v20, v24
    v_mul_f32 v25, v21, v25
    v_mul_f32 v26, v22, v26
    v_mul_f32 v27, v23, v27
    v_cvt_pk_bf16_f32 v34, v24, v25
    v_cvt_pk_bf16_f32 v35, v26, v27
    v_lshlrev_b32 v20, 16, v36
    v_and_b32 v21, 0xffff0000, v36
    v_lshlrev_b32 v22, 16, v37
    v_and_b32 v23, 0xffff0000, v37
    v_mul_f32 v24, s34, v20
    v_mul_f32 v25, s34, v21
    v_mul_f32 v26, s34, v22
    v_mul_f32 v27, s34, v23
    v_exp_f32 v24, v24
    v_exp_f32 v25, v25
    v_exp_f32 v26, v26
    v_exp_f32 v27, v27
    v_add_f32 v24, 1.0, v24
    v_add_f32 v25, 1.0, v25
    v_add_f32 v26, 1.0, v26
    v_add_f32 v27, 1.0, v27
    v_rcp_f32 v24, v24
    v_rcp_f32 v25, v25
    v_rcp_f32 v26, v26
    v_rcp_f32 v27, v27
    v_mul_f32 v24, v20, v24
    v_mul_f32 v25, v21, v25
    v_mul_f32 v26, v22, v26
    v_mul_f32 v27, v23, v27
    v_cvt_pk_bf16_f32 v36, v24, v25
    v_cvt_pk_bf16_f32 v37, v26, v27
    v_lshlrev_b32 v20, 16, v38
    v_and_b32 v21, 0xffff0000, v38
    v_lshlrev_b32 v22, 16, v39
    v_and_b32 v23, 0xffff0000, v39
    v_mul_f32 v24, s34, v20
    v_mul_f32 v25, s34, v21
    v_mul_f32 v26, s34, v22
    v_mul_f32 v27, s34, v23
    v_exp_f32 v24, v24
    v_exp_f32 v25, v25
    v_exp_f32 v26, v26
    v_exp_f32 v27, v27
    v_add_f32 v24, 1.0, v24
    v_add_f32 v25, 1.0, v25
    v_add_f32 v26, 1.0, v26
    v_add_f32 v27, 1.0, v27
    v_rcp_f32 v24, v24
    v_rcp_f32 v25, v25
    v_rcp_f32 v26, v26
    v_rcp_f32 v27, v27
    v_mul_f32 v24, v20, v24
    v_mul_f32 v25, v21, v25
    v_mul_f32 v26, v22, v26
    v_mul_f32 v27, v23, v27
    v_cvt_pk_bf16_f32 v38, v24, v25
    v_cvt_pk_bf16_f32 v39, v26, v27
    v_lshlrev_b32 v20, 16, v40
    v_and_b32 v21, 0xffff0000, v40
    v_lshlrev_b32 v22, 16, v41
    v_and_b32 v23, 0xffff0000, v41
    v_mul_f32 v24, s34, v20
    v_mul_f32 v25, s34, v21
    v_mul_f32 v26, s34, v22
    v_mul_f32 v27, s34, v23
    v_exp_f32 v24, v24
    v_exp_f32 v25, v25
    v_exp_f32 v26, v26
    v_exp_f32 v27, v27
    v_add_f32 v24, 1.0, v24
    v_add_f32 v25, 1.0, v25
    v_add_f32 v26, 1.0, v26
    v_add_f32 v27, 1.0, v27
    v_rcp_f32 v24, v24
    v_rcp_f32 v25, v25
    v_rcp_f32 v26, v26
    v_rcp_f32 v27, v27
    v_mul_f32 v24, v20, v24
    v_mul_f32 v25, v21, v25
    v_mul_f32 v26, v22, v26
    v_mul_f32 v27, v23, v27
    v_cvt_pk_bf16_f32 v40, v24, v25
    v_cvt_pk_bf16_f32 v41, v26, v27
    v_lshlrev_b32 v20, 16, v42
    v_and_b32 v21, 0xffff0000, v42
    v_lshlrev_b32 v22, 16, v43
    v_and_b32 v23, 0xffff0000, v43
    v_mul_f32 v24, s34, v20
    v_mul_f32 v25, s34, v21
    v_mul_f32 v26, s34, v22
    v_mul_f32 v27, s34, v23
    v_exp_f32 v24, v24
    v_exp_f32 v25, v25
    v_exp_f32 v26, v26
    v_exp_f32 v27, v27
    v_add_f32 v24, 1.0, v24
    v_add_f32 v25, 1.0, v25
    v_add_f32 v26, 1.0, v26
    v_add_f32 v27, 1.0, v27
    v_rcp_f32 v24, v24
    v_rcp_f32 v25, v25
    v_rcp_f32 v26, v26
    v_rcp_f32 v27, v27
    v_mul_f32 v24, v20, v24
    v_mul_f32 v25, v21, v25
    v_mul_f32 v26, v22, v26
    v_mul_f32 v27, v23, v27
    v_cvt_pk_bf16_f32 v42, v24, v25
    v_cvt_pk_bf16_f32 v43, v26, v27
    v_lshlrev_b32 v20, 16, v44
    v_and_b32 v21, 0xffff0000, v44
    v_lshlrev_b32 v22, 16, v45
    v_and_b32 v23, 0xffff0000, v45
    v_mul_f32 v24, s34, v20
    v_mul_f32 v25, s34, v21
    v_mul_f32 v26, s34, v22
    v_mul_f32 v27, s34, v23
    v_exp_f32 v24, v24
    v_exp_f32 v25, v25
    v_exp_f32 v26, v26
    v_exp_f32 v27, v27
    v_add_f32 v24, 1.0, v24
    v_add_f32 v25, 1.0, v25
    v_add_f32 v26, 1.0, v26
    v_add_f32 v27, 1.0, v27
    v_rcp_f32 v24, v24
    v_rcp_f32 v25, v25
    v_rcp_f32 v26, v26
    v_rcp_f32 v27, v27
    v_mul_f32 v24, v20, v24
    v_mul_f32 v25, v21, v25
    v_mul_f32 v26, v22, v26
    v_mul_f32 v27, v23, v27
    v_cvt_pk_bf16_f32 v44, v24, v25
    v_cvt_pk_bf16_f32 v45, v26, v27
    v_lshlrev_b32 v20, 16, v46
    v_and_b32 v21, 0xffff0000, v46
    v_lshlrev_b32 v22, 16, v47
    v_and_b32 v23, 0xffff0000, v47
    v_mul_f32 v24, s34, v20
    v_mul_f32 v25, s34, v21
    v_mul_f32 v26, s34, v22
    v_mul_f32 v27, s34, v23
    v_exp_f32 v24, v24
    v_exp_f32 v25, v25
    v_exp_f32 v26, v26
    v_exp_f32 v27, v27
    v_add_f32 v24, 1.0, v24
    v_add_f32 v25, 1.0, v25
    v_add_f32 v26, 1.0, v26
    v_add_f32 v27, 1.0, v27
    v_rcp_f32 v24, v24
    v_rcp_f32 v25, v25
    v_rcp_f32 v26, v26
    v_rcp_f32 v27, v27
    v_mul_f32 v24, v20, v24
    v_mul_f32 v25, v21, v25
    v_mul_f32 v26, v22, v26
    v_mul_f32 v27, v23, v27
    v_cvt_pk_bf16_f32 v46, v24, v25
    v_cvt_pk_bf16_f32 v47, v26, v27
    v_lshlrev_b32 v20, 16, v48
    v_and_b32 v21, 0xffff0000, v48
    v_lshlrev_b32 v22, 16, v49
    v_and_b32 v23, 0xffff0000, v49
    v_mul_f32 v24, s34, v20
    v_mul_f32 v25, s34, v21
    v_mul_f32 v26, s34, v22
    v_mul_f32 v27, s34, v23
    v_exp_f32 v24, v24
    v_exp_f32 v25, v25
    v_exp_f32 v26, v26
    v_exp_f32 v27, v27
    v_add_f32 v24, 1.0, v24
    v_add_f32 v25, 1.0, v25
    v_add_f32 v26, 1.0, v26
    v_add_f32 v27, 1.0, v27
    v_rcp_f32 v24, v24
    v_rcp_f32 v25, v25
    v_rcp_f32 v26, v26
    v_rcp_f32 v27, v27
    v_mul_f32 v24, v20, v24
    v_mul_f32 v25, v21, v25
    v_mul_f32 v26, v22, v26
    v_mul_f32 v27, v23, v27
    v_cvt_pk_bf16_f32 v48, v24, v25
    v_cvt_pk_bf16_f32 v49, v26, v27
    v_lshlrev_b32 v20, 16, v50
    v_and_b32 v21, 0xffff0000, v50
    v_lshlrev_b32 v22, 16, v51
    v_and_b32 v23, 0xffff0000, v51
    v_mul_f32 v24, s34, v20
    v_mul_f32 v25, s34, v21
    v_mul_f32 v26, s34, v22
    v_mul_f32 v27, s34, v23
    v_exp_f32 v24, v24
    v_exp_f32 v25, v25
    v_exp_f32 v26, v26
    v_exp_f32 v27, v27
    v_add_f32 v24, 1.0, v24
    v_add_f32 v25, 1.0, v25
    v_add_f32 v26, 1.0, v26
    v_add_f32 v27, 1.0, v27
    v_rcp_f32 v24, v24
    v_rcp_f32 v25, v25
    v_rcp_f32 v26, v26
    v_rcp_f32 v27, v27
    v_mul_f32 v24, v20, v24
    v_mul_f32 v25, v21, v25
    v_mul_f32 v26, v22, v26
    v_mul_f32 v27, v23, v27
    v_cvt_pk_bf16_f32 v50, v24, v25
    v_cvt_pk_bf16_f32 v51, v26, v27
    s_cmp_ge_u32 s52, 10
    s_cbranch_scc1 L_nostats
    v_mov_b32 v20, 0
    v_mov_b32 v21, 0
    v_mov_b32 v22, 0x3f803f80
    v_dot2c_f32_bf16 v20, v52, v22
    v_dot2c_f32_bf16 v21, v52, v52
    v_dot2c_f32_bf16 v20, v53, v22
    v_dot2c_f32_bf16 v21, v53, v53
    v_dot2c_f32_bf16 v20, v54, v22
    v_dot2c_f32_bf16 v21, v54, v54
    v_dot2c_f32_bf16 v20, v55, v22
    v_dot2c_f32_bf16 v21, v55, v55
    v_dot2c_f32_bf16 v20, v56, v22
    v_dot2c_f32_bf16 v21, v56, v56
    v_dot2c_f32_bf16 v20, v57, v22
    v_dot2c_f32_bf16 v21, v57, v57
    v_dot2c_f32_bf16 v20, v58, v22
    v_dot2c_f32_bf16 v21, v58, v58
    v_dot2c_f32_bf16 v20, v59, v22
    v_dot2c_f32_bf16 v21, v59, v59
    v_dot2c_f32_bf16 v20, v60, v22
    v_dot2c_f32_bf16 v21, v60, v60
    v_dot2c_f32_bf16 v20, v61, v22
    v_dot2c_f32_bf16 v21, v61, v61
    v_dot2c_f32_bf16 v20, v62, v22
    v_dot2c_f32_bf16 v21, v62, v62
    v_dot2c_f32_bf16 v20, v63, v22
    v_dot2c_f32_bf16 v21, v63, v63
    v_dot2c_f32_bf16 v20, v64, v22
    v_dot2c_f32_bf16 v21, v64, v64
    v_dot2c_f32_bf16 v20, v65, v22
    v_dot2c_f32_bf16 v21, v65, v65
    v_dot2c_f32_bf16 v20, v66, v22
    v_dot2c_f32_bf16 v21, v66, v66
    v_dot2c_f32_bf16 v20, v67, v22
    v_dot2c_f32_bf16 v21, v67, v67
    v_dot2c_f32_bf16 v20, v68, v22
    v_dot2c_f32_bf16 v21, v68, v68
    v_dot2c_f32_bf16 v20, v69, v22
    v_dot2c_f32_bf16 v21, v69, v69
    v_dot2c_f32_bf16 v20, v70, v22
    v_dot2c_f32_bf16 v21, v70, v70
    v_dot2c_f32_bf16 v20, v71, v22
    v_dot2c_f32_bf16 v21, v71, v71
    s_nop 1
    v_add_f32_dpp v20, v20, v20 row_ror:4 row_mask:0xf bank_mask:0xf
    v_add_f32_dpp v21, v21, v21 row_ror:4 row_mask:0xf bank_mask:0xf
    s_nop 0
    v_add_f32_dpp v20, v20, v20 row_ror:8 row_mask:0xf bank_mask:0xf
    v_add_f32_dpp v21, v21, v21 row_ror:8 row_mask:0xf bank_mask:0xf
    v_mov_b32 v22, v20
    v_mov_b32 v23, v21
    s_nop 0
    v_permlane16_swap_b32 v20, v22
    v_permlane16_swap_b32 v21, v23
    v_add_f32 v20, v20, v22
    v_add_f32 v21, v21, v23
    v_mov_b32 v22, v20
    v_mov_b32 v23, v21
    s_nop 0
    v_permlane32_swap_b32 v20, v22
    v_permlane32_swap_b32 v21, v23
    v_add_f32 v20, v20, v22
    v_add_f32 v21, v21, v23
    v_mul_f32 v22, 0x3acccccd, v20
    v_mul_f32 v21, 0x3acccccd, v21
    v_fma_f32 v21, -v22, v22, v21
    v_max_f32 v21, 0, v21
    v_add_f32 v21, 0x3727c5ac, v21
    v_rsq_f32 v20, v21
    s_nop 0
    v_mul_f32_e64 v21, -v22, v20
    v_lshlrev_b32 v24, 16, v72
    v_and_b32 v25, 0xffff0000, v72
    v_lshlrev_b32 v26, 16, v73
    v_and_b32 v27, 0xffff0000, v73
    v_fma_f32 v24, v24, v20, v21
    v_fma_f32 v25, v25, v20, v21
    v_fma_f32 v26, v26, v20, v21
    v_fma_f32 v27, v27, v20, v21
L_nostats:
    ds_read_b64_tr_b16 v[96:97], v15 offset:0
    ds_read_b64_tr_b16 v[98:99], v15 offset:512
    ds_read_b64_tr_b16 v[100:101], v15 offset:32
    ds_read_b64_tr_b16 v[102:103], v15 offset:544
    ds_read_b64_tr_b16 v[104:105], v15 offset:64
    ds_read_b64_tr_b16 v[106:107], v15 offset:576
    ds_read_b64_tr_b16 v[108:109], v15 offset:96
    ds_read_b64_tr_b16 v[110:111], v15 offset:608
    s_waitcnt lgkmcnt(7)
    ds_read_b64_tr_b16 v[112:113], v15 offset:4096
    ds_read_b64_tr_b16 v[114:115], v15 offset:4608
    ds_read_b64_tr_b16 v[116:117], v15 offset:4128
    ds_read_b64_tr_b16 v[118:119], v15 offset:4640
    ds_read_b64_tr_b16 v[120:121], v15 offset:4160
    ds_read_b64_tr_b16 v[122:123], v15 offset:4672
    ds_read_b64_tr_b16 v[124:125], v15 offset:4192
    ds_read_b64_tr_b16 v[126:127], v15 offset:4704
    s_waitcnt lgkmcnt(7)
    ds_read_b64_tr_b16 v[128:129], v15 offset:8192
    ds_read_b64_tr_b16 v[130:131], v15 offset:8704
    ds_read_b64_tr_b16 v[132:133], v15 offset:8224
    ds_read_b64_tr_b16 v[134:135], v15 offset:8736
    ds_read_b64_tr_b16 v[136:137], v15 offset:8256
    ds_read_b64_tr_b16 v[138:139], v15 offset:8768
    ds_read_b64_tr_b16 v[140:141], v15 offset:8288
    ds_read_b64_tr_b16 v[142:143], v15 offset:8800
    s_waitcnt lgkmcnt(7)
    ds_read_b64_tr_b16 v[144:145], v15 offset:12288
    ds_read_b64_tr_b16 v[146:147], v15 offset:12800
    ds_read_b64_tr_b16 v[148:149], v15 offset:12320
    ds_read_b64_tr_b16 v[150:151], v15 offset:12832
    ds_read_b64_tr_b16 v[152:153], v15 offset:12352
    ds_read_b64_tr_b16 v[154:155], v15 offset:12864
    ds_read_b64_tr_b16 v[156:157], v15 offset:12384
    ds_read_b64_tr_b16 v[158:159], v15 offset:12896
    s_waitcnt lgkmcnt(7)
    ds_read_b64_tr_b16 v[160:161], v15 offset:16384
    ds_read_b64_tr_b16 v[162:163], v15 offset:16896
    ds_read_b64_tr_b16 v[164:165], v15 offset:16416
    ds_read_b64_tr_b16 v[166:167], v15 offset:16928
    ds_read_b64_tr_b16 v[168:169], v15 offset:16448
    ds_read_b64_tr_b16 v[170:171], v15 offset:16960
    ds_read_b64_tr_b16 v[172:173], v15 offset:16480
    ds_read_b64_tr_b16 v[174:175], v15 offset:16992
    s_waitcnt lgkmcnt(0)
    v_mfma_f32_16x16x32_bf16 v[80:83], v[96:99], v[32:35], 0
    v_mfma_f32_16x16x32_bf16 v[84:87], v[100:103], v[32:35], 0
    v_mfma_f32_16x16x32_bf16 v[88:91], v[104:107], v[32:35], 0
    v_mfma_f32_16x16x32_bf16 v[92:95], v[108:111], v[32:35], 0
    v_mfma_f32_16x16x32_bf16 v[80:83], v[112:115], v[36:39], v[80:83]
    v_mfma_f32_16x16x32_bf16 v[84:87], v[116:119], v[36:39], v[84:87]
    v_mfma_f32_16x16x32_bf16 v[88:91], v[120:123], v[36:39], v[88:91]
    v_mfma_f32_16x16x32_bf16 v[92:95], v[124:127], v[36:39], v[92:95]
    v_mfma_f32_16x16x32_bf16 v[80:83], v[128:131], v[40:43], v[80:83]
    v_mfma_f32_16x16x32_bf16 v[84:87], v[132:135], v[40:43], v[84:87]
    v_mfma_f32_16x16x32_bf16 v[88:91], v[136:139], v[40:43], v[88:91]
    v_mfma_f32_16x16x32_bf16 v[92:95], v[140:143], v[40:43], v[92:95]
    v_mfma_f32_16x16x32_bf16 v[80:83], v[144:147], v[44:47], v[80:83]
    v_mfma_f32_16x16x32_bf16 v[84:87], v[148:151], v[44:47], v[84:87]
    v_mfma_f32_16x16x32_bf16 v[88:91], v[152:155], v[44:47], v[88:91]
    v_mfma_f32_16x16x32_bf16 v[92:95], v[156:159], v[44:47], v[92:95]
    v_mfma_f32_16x16x32_bf16 v[80:83], v[160:163], v[48:51], v[80:83]
    v_mfma_f32_16x16x32_bf16 v[84:87], v[164:167], v[48:51], v[84:87]
    v_mfma_f32_16x16x32_bf16 v[88:91], v[168:171], v[48:51], v[88:91]
    v_mfma_f32_16x16x32_bf16 v[92:95], v[172:175], v[48:51], v[92:95]
    s_cmp_ge_u32 s50, 20
    s_cbranch_scc1 L_adr_rest
    s_cmp_lt_u32 s50, 10
    s_cselect_b32 s34, 5120, 0
    s_cselect_b32 s35, s50, s52
    s_lshl_b32 s35, s35, 9
    s_add_u32 s34, s34, s35
    s_lshl_b32 s35, s51, 15
    s_add_u32 s34, s34, s35
    v_lshrrev_b32 v19, 1, v14
    v_lshl_add_u32 v19, v13, 1, v19
    v_lshlrev_b32 v19, 6, v19
    v_lshl_add_u32 v19, v12, 4, v19
    v_and_b32 v20, 1, v14
    v_lshl_add_u32 v19, v20, 3, v19
    s_branch L_adr_done
L_adr_rest:
    s_lshl_b32 s34, s51, 15
    s_lshl_b32 s35, s50, 9
    s_add_u32 s34, s34, s35
    s_add_u32 s34, s34, 0
    v_lshlrev_b32 v19, 7, v12
    v_lshl_add_u32 v19, v13, 5, v19
    v_lshl_add_u32 v19, v14, 3, v19
    s_nop 3
L_adr_done:
    v_add_u32 v19, s34, v19
    v_mov_b32_dpp v80, v84 quad_perm:[0,1,2,3] row_mask:0xf bank_mask:0x2
    v_mov_b32_dpp v81, v85 quad_perm:[0,1,2,3] row_mask:0xf bank_mask:0x2
    v_mov_b32_dpp v82, v86 quad_perm:[0,1,2,3] row_mask:0xf bank_mask:0x2
    v_mov_b32_dpp v83, v87 quad_perm:[0,1,2,3] row_mask:0xf bank_mask:0x2
    v_mov_b32_dpp v80, v88 quad_perm:[0,1,2,3] row_mask:0xf bank_mask:0x4
    v_mov_b32_dpp v81, v89 quad_perm:[0,1,2,3] row_mask:0xf bank_mask:0x4
    v_mov_b32_dpp v82, v90 quad_perm:[0,1,2,3] row_mask:0xf bank_mask:0x4
    v_mov_b32_dpp v83, v91 quad_perm:[0,1,2,3] row_mask:0xf bank_mask:0x4
    v_mov_b32_dpp v80, v92 quad_perm:[0,1,2,3] row_mask:0xf bank_mask:0x8
    v_mov_b32_dpp v81, v93 quad_perm:[0,1,2,3] row_mask:0xf bank_mask:0x8
    v_mov_b32_dpp v82, v94 quad_perm:[0,1,2,3] row_mask:0xf bank_mask:0x8
    v_mov_b32_dpp v83, v95 quad_perm:[0,1,2,3] row_mask:0xf bank_mask:0x8
    s_cmp_ge_u32 s52, 10
    s_cbranch_scc1 L_noz
    v_add_f32 v80, 0x3e800000, v80
    v_add_f32 v81, 0x3e800000, v81
    v_add_f32 v82, 0x3e800000, v82
    v_add_f32 v83, 0x3e800000, v83
    v_mul_f32 v80, v80, v24
    v_mul_f32 v81, v81, v25
    v_mul_f32 v82, v82, v26
    v_mul_f32 v83, v83, v27
L_noz:
    v_cvt_pk_bf16_f32 v20, v80, v81
    v_cvt_pk_bf16_f32 v21, v82, v83
    v_min_u32 v20, -2, v20
    v_min_u32 v21, -2, v21
    v_mov_b32 v22, 99072
    s_mov_b32 s35, 0
L_poll1:
    ds_read_b32 v23, v22
    s_add_u32 s35, s35, 1
    s_waitcnt lgkmcnt(0)
    v_cmp_gt_u32 vcc, 14, v23
    s_cbranch_vccz L_done2
    s_sleep 2
    s_cmp_lt_u32 s35, 60000
    s_cbranch_scc1 L_poll1
L_done2:
    v_and_b32 v22, 15, v0
    v_lshlrev_b32 v22, 2, v22
    s_mov_b32 s35, 0
L_poll4:
    global_load_dword v23, v22, s[30:31] offset:128 sc1
    s_add_u32 s35, s35, 1
    s_waitcnt vmcnt(0)
    v_cmp_eq_u32 vcc, 0, v23
    s_cbranch_vccz L_done5
    s_sleep 8
    s_cmp_lt_u32 s35, 60000
    s_cbranch_scc1 L_poll4
L_done5:
    s_getreg_b32 s97, hwreg(HW_REG_XCC_ID, 0, 4)
    s_sub_u32 s97, s97, s2
    s_and_b32 s97, s97, 7
    s_add_u32 s97, s97, 1
    v_cmp_ne_u32 vcc, s97, v23
    s_nop 0
    s_mov_b32 s97, vcc_lo
    buffer_store_dwordx2 v[20:21], v19, s[44:47], 0 offen sc1
    s_branch L_p2
L_clear:
    s_sub_u32 s55, s2, 240
    s_lshr_b32 s34, s55, 2
    s_lshl_b32 s35, s34, 3
    s_lshr_b32 s54, 538910750, s35
    s_and_b32 s54, s54, 0xff
    s_lshl_b32 s54, s54, 10
    s_mul_i32 s34, s34, 393216
    s_lshl_b32 s35, s51, 15
    s_add_u32 s34, s34, s35
    v_lshl_add_u32 v9, v0, 4, s34
    v_mov_b32 v4, -1
    v_mov_b32 v5, -1
    v_mov_b32 v6, -1
    v_mov_b32 v7, -1
    s_lshl_b32 s34, s3, 10
L_clrloop:
    buffer_store_dwordx4 v[4:7], v9, s[44:47], s34 offen offset:0 sc1
    s_add_u32 s34, s34, 1024
    s_cmp_lt_u32 s34, s54
    s_cbranch_scc1 L_clrloop
L_clrend:
    s_cmp_ge_u32 s55, 4
    s_cbranch_scc1 L_clrend2
    s_mov_b32 s34, 1572864
    buffer_store_dwordx4 v[4:7], v9, s[44:47], s34 offen sc1
    s_mov_b32 s34, 1573888
    buffer_store_dwordx4 v[4:7], v9, s[44:47], s34 offen sc1
    s_mov_b32 s34, 1574912
    buffer_store_dwordx4 v[4:7], v9, s[44:47], s34 offen sc1
    s_mov_b32 s34, 1575936
    buffer_store_dwordx4 v[4:7], v9, s[44:47], s34 offen sc1
    s_mov_b32 s34, 1576960
    buffer_store_dwordx4 v[4:7], v9, s[44:47], s34 offen sc1
L_clrend2:
    s_lshr_b32 s35, s55, 2
    s_mul_i32 s35, s35, -385024
    s_add_u32 s34, s35, 1709056
    buffer_store_dwordx4 v[4:7], v9, s[44:47], s34 offen sc1
    s_add_u32 s34, s35, 1710080
    buffer_store_dwordx4 v[4:7], v9, s[44:47], s34 offen sc1
    v_lshlrev_b32 v1, 2, v0
    v_add_u32 v1, 98304, v1
    v_mov_b32 v2, -1
    v_mov_b32 v3, 0
    ds_write_b32 v1, v2
    ds_write_b32 v1, v2 offset:256
    ds_write_b32 v1, v3 offset:512
    ds_write_b32 v1, v3 offset:768
    s_waitcnt lgkmcnt(0)
    s_barrier
    s_lshl_b32 s34, s55, 2
    v_mov_b32 v24, s34
    s_getreg_b32 s97, hwreg(HW_REG_XCC_ID, 0, 4)
    s_sub_u32 s97, s97, s2
    s_and_b32 s97, s97, 7
    s_add_u32 s97, s97, 1
    v_mov_b32 v25, s97
    v_readfirstlane_b32 s90, v9
    s_mov_b32 s91, 0
    s_waitcnt vmcnt(0)
    s_mov_b64 exec, 1
    global_store_dword v24, v25, s[30:31] offset:128 sc1
    s_mov_b64 exec, -1
    v_lshl_add_u32 v15, v14, 3, v13
    v_lshlrev_b32 v15, 7, v15
    v_lshl_add_u32 v15, v12, 3, v15
    s_cmp_ge_u32 s55, 10
    s_cbranch_scc1 L_novote
    s_add_u32 s34, s90, 0
    s_add_u32 s35, s90, 8192
    s_mov_b64 s[88:89], 0
    s_load_dword s88, s[44:45], s34
    s_load_dword s89, s[44:45], s35
    s_waitcnt lgkmcnt(1)
    s_cmp_lg_u32 s89, 0
    s_addc_u32 s91, s91, 0
    s_waitcnt lgkmcnt(0)
    s_add_u32 s34, s90, 1024
    s_add_u32 s35, s90, 9216
    s_mov_b64 s[88:89], 0
    s_load_dword s89, s[44:45], s35
    s_load_dword s88, s[44:45], s34
    s_waitcnt lgkmcnt(1)
    s_cmp_eq_u32 s88, 0
    s_addc_u32 s91, s91, 0
    s_waitcnt lgkmcnt(0)
    s_getreg_b32 s34, hwreg(HW_REG_XCC_ID, 2, 1)
    s_sub_u32 s35, 1, s91
    s_sub_u32 s91, s91, 1
    s_cmp_eq_u32 s34, 0
    s_cselect_b32 s91, s91, s35
    v_mov_b32 v25, s91
    s_mov_b64 exec, 1
    global_store_dword v24, v25, s[30:31] sc1
    s_mov_b64 exec, -1
L_novote:
    v_mov_b32 v22, 99072
    s_mov_b32 s35, 0
L_poll7:
    ds_read_b32 v23, v22
    s_add_u32 s35, s35, 1
    s_waitcnt lgkmcnt(0)
    v_cmp_gt_u32 vcc, 14, v23
    s_cbranch_vccz L_done8
    s_sleep 2
    s_cmp_lt_u32 s35, 60000
    s_cbranch_scc1 L_poll7
L_done8:
    v_and_b32 v22, 15, v0
    v_lshlrev_b32 v22, 2, v22
    s_mov_b32 s35, 0
L_poll10:
    global_load_dword v23, v22, s[30:31] offset:128 sc1
    s_add_u32 s35, s35, 1
    s_waitcnt vmcnt(0)
    v_cmp_eq_u32 vcc, 0, v23
    s_cbranch_vccz L_done11
    s_sleep 8
    s_cmp_lt_u32 s35, 60000
    s_cbranch_scc1 L_poll10
L_done11:
    s_getreg_b32 s97, hwreg(HW_REG_XCC_ID, 0, 4)
    s_sub_u32 s97, s97, s2
    s_and_b32 s97, s97, 7
    s_add_u32 s97, s97, 1
    v_cmp_ne_u32 vcc, s97, v23
    s_nop 0
    s_mov_b32 s97, vcc_lo
L_p2:
    v_mov_b32 v199, v19
    ds_read_b64_tr_b16 v[96:97], v15 offset:20480
    ds_read_b64_tr_b16 v[98:99], v15 offset:20992
    ds_read_b64_tr_b16 v[100:101], v15 offset:20512
    ds_read_b64_tr_b16 v[102:103], v15 offset:21024
    ds_read_b64_tr_b16 v[104:105], v15 offset:20544
    ds_read_b64_tr_b16 v[106:107], v15 offset:21056
    ds_read_b64_tr_b16 v[108:109], v15 offset:20576
    ds_read_b64_tr_b16 v[110:111], v15 offset:21088
    s_waitcnt lgkmcnt(7)
    ds_read_b64_tr_b16 v[112:113], v15 offset:24576
    ds_read_b64_tr_b16 v[114:115], v15 offset:25088
    ds_read_b64_tr_b16 v[116:117], v15 offset:24608
    ds_read_b64_tr_b16 v[118:119], v15 offset:25120
    ds_read_b64_tr_b16 v[120:121], v15 offset:24640
    ds_read_b64_tr_b16 v[122:123], v15 offset:25152
    ds_read_b64_tr_b16 v[124:125], v15 offset:24672
    ds_read_b64_tr_b16 v[126:127], v15 offset:25184
    s_waitcnt lgkmcnt(7)
    ds_read_b64_tr_b16 v[128:129], v15 offset:28672
    ds_read_b64_tr_b16 v[130:131], v15 offset:29184
    ds_read_b64_tr_b16 v[132:133], v15 offset:28704
    ds_read_b64_tr_b16 v[134:135], v15 offset:29216
    ds_read_b64_tr_b16 v[136:137], v15 offset:28736
    ds_read_b64_tr_b16 v[138:139], v15 offset:29248
    ds_read_b64_tr_b16 v[140:141], v15 offset:28768
    ds_read_b64_tr_b16 v[142:143], v15 offset:29280
    s_waitcnt lgkmcnt(7)
    ds_read_b64_tr_b16 v[144:145], v15 offset:32768
    ds_read_b64_tr_b16 v[146:147], v15 offset:33280
    ds_read_b64_tr_b16 v[148:149], v15 offset:32800
    ds_read_b64_tr_b16 v[150:151], v15 offset:33312
    ds_read_b64_tr_b16 v[152:153], v15 offset:32832
    ds_read_b64_tr_b16 v[154:155], v15 offset:33344
    ds_read_b64_tr_b16 v[156:157], v15 offset:32864
    ds_read_b64_tr_b16 v[158:159], v15 offset:33376
    s_waitcnt lgkmcnt(7)
    ds_read_b64_tr_b16 v[160:161], v15 offset:36864
    ds_read_b64_tr_b16 v[162:163], v15 offset:37376
    ds_read_b64_tr_b16 v[164:165], v15 offset:36896
    ds_read_b64_tr_b16 v[166:167], v15 offset:37408
    ds_read_b64_tr_b16 v[168:169], v15 offset:36928
    ds_read_b64_tr_b16 v[170:171], v15 offset:37440
    ds_read_b64_tr_b16 v[172:173], v15 offset:36960
    ds_read_b64_tr_b16 v[174:175], v15 offset:37472
    s_waitcnt lgkmcnt(0)
    s_mul_i32 s34, s53, 1280
    v_lshlrev_b32 v19, 15, v13
    v_lshl_add_u32 v19, v14, 6, v19
    v_lshl_add_u32 v19, v12, 4, v19
    v_add_u32 v19, s34, v19
    s_movk_i32 s48, 5120
    s_mov_b32 s56, 32768
    s_mov_b32 s57, 65536
    s_mov_b32 s58, 98304
    s_sub_u32 s34, s2, 80
    s_cmp_lt_u32 s34, 160
    s_cselect_b32 s54, 1, 0
    s_and_b32 s34, s2, 3
    s_cselect_b32 s54, 0, s54
    v_mov_b32 v180, 0
    v_mov_b32 v181, 0
    v_mov_b32 v182, 0
    v_mov_b32 v183, 0
    v_mov_b32 v184, 0
    v_mov_b32 v185, 0
    v_mov_b32 v186, 0
    v_mov_b32 v187, 0
    v_mov_b32 v22, 99072
    s_mov_b32 s35, 0
L_poll13:
    ds_read_b32 v23, v22
    s_add_u32 s35, s35, 1
    s_waitcnt lgkmcnt(0)
    v_cmp_gt_u32 vcc, 22, v23
    s_cbranch_vccz L_done14
    s_sleep 2
    s_cmp_lt_u32 s35, 60000
    s_cbranch_scc1 L_poll13
L_done14:
    s_mov_b32 s35, 0
L_poll16:
    buffer_load_dwordx4 v[32:35], v19, s[44:47], 0 offen offset:0 sc1
    buffer_load_dwordx4 v[36:39], v19, s[44:47], s48 offen offset:0 sc1
    buffer_load_dwordx4 v[40:43], v19, s[44:47], 0 offen offset:256 sc1
    buffer_load_dwordx4 v[44:47], v19, s[44:47], s48 offen offset:256 sc1
    buffer_load_dwordx4 v[48:51], v19, s[44:47], 0 offen offset:512 sc1
    buffer_load_dwordx4 v[52:55], v19, s[44:47], s48 offen offset:512 sc1
    buffer_load_dwordx4 v[56:59], v19, s[44:47], 0 offen offset:768 sc1
    buffer_load_dwordx4 v[60:63], v19, s[44:47], s48 offen offset:768 sc1
    buffer_load_dwordx4 v[64:67], v19, s[44:47], 0 offen offset:1024 sc1
    buffer_load_dwordx4 v[68:71], v19, s[44:47], s48 offen offset:1024 sc1
    s_cmp_eq_u32 s54, 0
    s_cbranch_scc1 L_hskip
    buffer_load_dwordx2 v[180:181], v199, s[44:47], 0 offen sc1
    buffer_load_dwordx2 v[182:183], v199, s[44:47], s56 offen sc1
    buffer_load_dwordx2 v[184:185], v199, s[44:47], s57 offen sc1
    buffer_load_dwordx2 v[186:187], v199, s[44:47], s58 offen sc1
L_hskip:
    s_add_u32 s35, s35, 1
    s_waitcnt vmcnt(0)
    v_max3_u32 v20, v32, v33, v34
    v_max3_u32 v20, v20, v35, v36
    v_max3_u32 v20, v20, v37, v38
    v_max3_u32 v20, v20, v39, v40
    v_max3_u32 v20, v20, v41, v42
    v_max3_u32 v20, v20, v43, v44
    v_max3_u32 v20, v20, v45, v46
    v_max3_u32 v20, v20, v47, v48
    v_max3_u32 v20, v20, v49, v50
    v_max3_u32 v20, v20, v51, v52
    v_max3_u32 v20, v20, v53, v54
    v_max3_u32 v20, v20, v55, v56
    v_max3_u32 v20, v20, v57, v58
    v_max3_u32 v20, v20, v59, v60
    v_max3_u32 v20, v20, v61, v62
    v_max3_u32 v20, v20, v63, v64
    v_max3_u32 v20, v20, v65, v66
    v_max3_u32 v20, v20, v67, v68
    v_max3_u32 v20, v20, v69, v70
    v_max3_u32 v20, v20, v71, v180
    v_max3_u32 v20, v20, v181, v182
    v_max3_u32 v20, v20, v183, v184
    v_max3_u32 v20, v20, v185, v186
    v_max_u32 v20, v20, v187
    v_cmp_eq_u32 vcc, -1, v20
    s_cbranch_vccz L_done17
    s_sleep 16
    s_cmp_lt_u32 s35, 60000
    s_cbranch_scc1 L_poll16
L_done17:
    v_mfma_f32_16x16x32_bf16 v[80:83], v[96:99], v[32:35], 0
    v_mfma_f32_16x16x32_bf16 v[84:87], v[100:103], v[32:35], 0
    v_mfma_f32_16x16x32_bf16 v[88:91], v[104:107], v[32:35], 0
    v_mfma_f32_16x16x32_bf16 v[92:95], v[108:111], v[32:35], 0
    v_mfma_f32_16x16x32_bf16 v[80:83], v[96:99], v[36:39], v[80:83]
    v_mfma_f32_16x16x32_bf16 v[84:87], v[100:103], v[36:39], v[84:87]
    v_mfma_f32_16x16x32_bf16 v[88:91], v[104:107], v[36:39], v[88:91]
    v_mfma_f32_16x16x32_bf16 v[92:95], v[108:111], v[36:39], v[92:95]
    v_mfma_f32_16x16x32_bf16 v[80:83], v[112:115], v[40:43], v[80:83]
    v_mfma_f32_16x16x32_bf16 v[84:87], v[116:119], v[40:43], v[84:87]
    v_mfma_f32_16x16x32_bf16 v[88:91], v[120:123], v[40:43], v[88:91]
    v_mfma_f32_16x16x32_bf16 v[92:95], v[124:127], v[40:43], v[92:95]
    v_mfma_f32_16x16x32_bf16 v[80:83], v[112:115], v[44:47], v[80:83]
    v_mfma_f32_16x16x32_bf16 v[84:87], v[116:119], v[44:47], v[84:87]
    v_mfma_f32_16x16x32_bf16 v[88:91], v[120:123], v[44:47], v[88:91]
    v_mfma_f32_16x16x32_bf16 v[92:95], v[124:127], v[44:47], v[92:95]
    v_mfma_f32_16x16x32_bf16 v[80:83], v[128:131], v[48:51], v[80:83]
    v_mfma_f32_16x16x32_bf16 v[84:87], v[132:135], v[48:51], v[84:87]
    v_mfma_f32_16x16x32_bf16 v[88:91], v[136:139], v[48:51], v[88:91]
    v_mfma_f32_16x16x32_bf16 v[92:95], v[140:143], v[48:51], v[92:95]
    v_mfma_f32_16x16x32_bf16 v[80:83], v[128:131], v[52:55], v[80:83]
    v_mfma_f32_16x16x32_bf16 v[84:87], v[132:135], v[52:55], v[84:87]
    v_mfma_f32_16x16x32_bf16 v[88:91], v[136:139], v[52:55], v[88:91]
    v_mfma_f32_16x16x32_bf16 v[92:95], v[140:143], v[52:55], v[92:95]
    v_mfma_f32_16x16x32_bf16 v[80:83], v[144:147], v[56:59], v[80:83]
    v_mfma_f32_16x16x32_bf16 v[84:87], v[148:151], v[56:59], v[84:87]
    v_mfma_f32_16x16x32_bf16 v[88:91], v[152:155], v[56:59], v[88:91]
    v_mfma_f32_16x16x32_bf16 v[92:95], v[156:159], v[56:59], v[92:95]
    v_mfma_f32_16x16x32_bf16 v[80:83], v[144:147], v[60:63], v[80:83]
    v_mfma_f32_16x16x32_bf16 v[84:87], v[148:151], v[60:63], v[84:87]
    v_mfma_f32_16x16x32_bf16 v[88:91], v[152:155], v[60:63], v[88:91]
    v_mfma_f32_16x16x32_bf16 v[92:95], v[156:159], v[60:63], v[92:95]
    v_mfma_f32_16x16x32_bf16 v[80:83], v[160:163], v[64:67], v[80:83]
    v_mfma_f32_16x16x32_bf16 v[84:87], v[164:167], v[64:67], v[84:87]
    v_mfma_f32_16x16x32_bf16 v[88:91], v[168:171], v[64:67], v[88:91]
    v_mfma_f32_16x16x32_bf16 v[92:95], v[172:175], v[64:67], v[92:95]
    v_mfma_f32_16x16x32_bf16 v[80:83], v[160:163], v[68:71], v[80:83]
    v_mfma_f32_16x16x32_bf16 v[84:87], v[164:167], v[68:71], v[84:87]
    v_mfma_f32_16x16x32_bf16 v[88:91], v[168:171], v[68:71], v[88:91]
    v_mfma_f32_16x16x32_bf16 v[92:95], v[172:175], v[68:71], v[92:95]
    s_lshl_b32 s34, s53, 15
    s_lshl_b32 s35, s49, 2
    s_add_u32 s34, s34, s35
    s_add_u32 s34, s34, 393216
    v_lshlrev_b32 v19, 7, v12
    v_lshl_add_u32 v19, v13, 5, v19
    v_lshl_add_u32 v19, v14, 3, v19
    v_add_u32 v19, s34, v19
    v_add_f32_dpp v20, v80, v80 row_ror:8 row_mask:0xf bank_mask:0x3
    v_add_f32_dpp v24, v84, v84 row_ror:8 row_mask:0xf bank_mask:0x3
    v_add_f32_dpp v21, v81, v81 row_ror:8 row_mask:0xf bank_mask:0x3
    v_add_f32_dpp v25, v85, v85 row_ror:8 row_mask:0xf bank_mask:0x3
    v_add_f32_dpp v22, v82, v82 row_ror:8 row_mask:0xf bank_mask:0x3
    v_add_f32_dpp v26, v86, v86 row_ror:8 row_mask:0xf bank_mask:0x3
    v_add_f32_dpp v23, v83, v83 row_ror:8 row_mask:0xf bank_mask:0x3
    v_add_f32_dpp v27, v87, v87 row_ror:8 row_mask:0xf bank_mask:0x3
    v_add_f32_dpp v20, v88, v88 row_ror:8 row_mask:0xf bank_mask:0xc
    v_add_f32_dpp v24, v92, v92 row_ror:8 row_mask:0xf bank_mask:0xc
    v_add_f32_dpp v21, v89, v89 row_ror:8 row_mask:0xf bank_mask:0xc
    v_add_f32_dpp v25, v93, v93 row_ror:8 row_mask:0xf bank_mask:0xc
    v_add_f32_dpp v22, v90, v90 row_ror:8 row_mask:0xf bank_mask:0xc
    v_add_f32_dpp v26, v94, v94 row_ror:8 row_mask:0xf bank_mask:0xc
    v_add_f32_dpp v23, v91, v91 row_ror:8 row_mask:0xf bank_mask:0xc
    v_add_f32_dpp v27, v95, v95 row_ror:8 row_mask:0xf bank_mask:0xc
    v_add_f32_dpp v28, v20, v20 row_shl:4 row_mask:0xf bank_mask:0x5
    v_add_f32_dpp v29, v21, v21 row_shl:4 row_mask:0xf bank_mask:0x5
    v_add_f32_dpp v30, v22, v22 row_shl:4 row_mask:0xf bank_mask:0x5
    v_add_f32_dpp v31, v23, v23 row_shl:4 row_mask:0xf bank_mask:0x5
    v_add_f32_dpp v28, v24, v24 row_shr:4 row_mask:0xf bank_mask:0xa
    v_add_f32_dpp v29, v25, v25 row_shr:4 row_mask:0xf bank_mask:0xa
    v_add_f32_dpp v30, v26, v26 row_shr:4 row_mask:0xf bank_mask:0xa
    v_add_f32_dpp v31, v27, v27 row_shr:4 row_mask:0xf bank_mask:0xa
    v_cvt_pk_bf16_f32 v20, v28, v29
    v_cvt_pk_bf16_f32 v21, v30, v31
    v_min_u32 v20, -2, v20
    v_min_u32 v21, -2, v21
    buffer_store_dwordx2 v[20:21], v19, s[44:47], 0 offen sc1
    s_cmp_eq_u32 s54, 0
    s_cbranch_scc1 L_nomf
    v_lshlrev_b32 v24, 16, v180
    v_and_b32 v25, 0xffff0000, v180
    v_lshlrev_b32 v26, 16, v181
    v_and_b32 v27, 0xffff0000, v181
    v_lshlrev_b32 v28, 16, v182
    v_and_b32 v29, 0xffff0000, v182
    v_lshlrev_b32 v30, 16, v183
    v_and_b32 v31, 0xffff0000, v183
    v_add_f32 v24, v24, v28
    v_add_f32 v25, v25, v29
    v_add_f32 v26, v26, v30
    v_add_f32 v27, v27, v31
    v_lshlrev_b32 v28, 16, v184
    v_and_b32 v29, 0xffff0000, v184
    v_lshlrev_b32 v30, 16, v185
    v_and_b32 v31, 0xffff0000, v185
    v_add_f32 v24, v24, v28
    v_add_f32 v25, v25, v29
    v_add_f32 v26, v26, v30
    v_add_f32 v27, v27, v31
    v_lshlrev_b32 v28, 16, v186
    v_and_b32 v29, 0xffff0000, v186
    v_lshlrev_b32 v30, 16, v187
    v_and_b32 v31, 0xffff0000, v187
    v_add_f32 v24, v24, v28
    v_add_f32 v25, v25, v29
    v_add_f32 v26, v26, v30
    v_add_f32 v27, v27, v31
    v_cvt_pk_bf16_f32 v22, v24, v25
    v_cvt_pk_bf16_f32 v23, v26, v27
    v_min_u32 v22, -2, v22
    v_min_u32 v23, -2, v23
    s_sub_u32 s34, s50, 20
    s_lshl_b32 s35, s34, 9
    v_subrev_u32 v199, s35, v199
    s_lshr_b32 s35, s34, 2
    s_lshl_b32 s35, s35, 9
    s_and_b32 s34, s34, 3
    s_lshl_b32 s34, s34, 15
    s_add_u32 s34, s34, s35
    s_add_u32 s34, s34, 1562624
    v_add_u32 v199, s34, v199
    buffer_store_dwordx2 v[22:23], v199, s[44:47], 0 offen sc1
L_nomf:
    s_and_b32 s34, s2, 127
    s_lshl_b32 s34, s34, 21
    s_lshr_b32 s35, s2, 7
    s_lshl_b32 s35, s35, 18
    s_add_u32 s34, s34, s35
    s_add_u32 s34, s34, 1572864
    s_mov_b32 s38, 0x40000
    s_mov_b32 s42, 0x40000
    s_waitcnt lgkmcnt(0)
    s_add_u32 s36, s6, s34
    s_addc_u32 s37, s7, 0
    s_add_u32 s40, s8, s34
    s_addc_u32 s41, s9, 0
    v_lshlrev_b32 v18, 4, v0
    s_mov_b32 s34, 258048
    buffer_load_dwordx4 v[128:131], v18, s[36:39], s34 offen offset:0 nt
    buffer_load_dwordx4 v[132:135], v18, s[36:39], s34 offen offset:1024 nt
    buffer_load_dwordx4 v[136:139], v18, s[36:39], s34 offen offset:2048 nt
    buffer_load_dwordx4 v[140:143], v18, s[36:39], s34 offen offset:3072 nt
    s_and_b32 s34, s2, 31
    s_lshl_b32 s34, s34, 10
    s_lshl_b32 s35, s53, 7
    s_add_u32 s34, s34, s35
    s_add_u32 s34, s34, 393216
    v_lshrrev_b32 v19, 5, v0
    v_mul_u32_u24 v19, 384, v19
    v_lshl_add_u32 v19, v0, 2, v19
    v_add_u32 v19, s34, v19
    v_mov_b32 v22, 99072
    s_and_b32 s34, s60, 3
    s_lshl_b32 s34, s34, 15
    s_lshr_b32 s35, s60, 2
    s_lshl_b32 s35, s35, 7
    s_add_u32 s34, s34, s35
    s_add_u32 s34, s34, 793344
    v_and_b32 v252, 31, v0
    v_lshl_add_u32 v252, v252, 2, s34
    v_mov_b32 v253, 0
    s_mov_b32 s35, 0
L_poll19:
    ds_read_b32 v23, v22
    s_add_u32 s35, s35, 1
    s_waitcnt lgkmcnt(0)
    v_cmp_gt_u32 vcc, 34, v23
    s_cbranch_vccz L_done20
    s_sleep 2
    s_cmp_lt_u32 s35, 60000
    s_cbranch_scc1 L_poll19
L_done20:
    buffer_load_dword v251, v252, s[44:47], 0 offen sc1
    s_lshl_b64 exec, 1, s61
    buffer_store_dword v253, v252, s[44:47], 0 offen
    s_mov_b64 exec, -1
    v_and_b32 v44, 15, v0
    v_lshlrev_b32 v44, 2, v44
    global_load_dword v44, v44, s[30:31] sc1
    s_mov_b32 s35, 0
L_poll22:
    buffer_load_dword v32, v19, s[44:47], 0 offen sc1
    buffer_load_dword v33, v19, s[44:47], s56 offen sc1
    buffer_load_dword v34, v19, s[44:47], s57 offen sc1
    buffer_load_dword v35, v19, s[44:47], s58 offen sc1
    s_add_u32 s35, s35, 1
    s_waitcnt vmcnt(0)
    v_max3_u32 v22, v32, v33, v34
    v_max_u32 v22, v22, v35
    v_cmp_eq_u32 vcc, -1, v22
    s_cbranch_vccz L_done23
    s_sleep 16
    s_cmp_lt_u32 s35, 60000
    s_cbranch_scc1 L_poll22
L_done23:
    v_cmp_ne_u32 vcc, -1, v251
    v_mov_b32 v252, 99076
    s_bcnt1_i32_b32 s34, vcc_lo
    v_mov_b32 v251, s34
    s_mov_b64 exec, 1
    ds_write_b32 v252, v251
    s_mov_b64 exec, -1
    v_add_u32_dpp v44, v44, v44 row_ror:8 row_mask:0xf bank_mask:0xf
    s_nop 1
    v_add_u32_dpp v44, v44, v44 row_ror:4 row_mask:0xf bank_mask:0xf
    s_nop 1
    v_add_u32_dpp v44, v44, v44 row_ror:2 row_mask:0xf bank_mask:0xf
    s_nop 1
    v_add_u32_dpp v44, v44, v44 row_ror:1 row_mask:0xf bank_mask:0xf
    s_nop 0
    v_readfirstlane_b32 s99, v44
    s_nop 0
    s_cmp_gt_i32 s99, 0
    s_cselect_b32 s99, 1, 0
    s_getreg_b32 s34, hwreg(HW_REG_XCC_ID, 2, 1)
    s_xor_b32 s99, s99, s34
    s_lshl_b32 s99, s99, 13
    v_mov_b32 v45, 99080
    v_mov_b32 v44, s99
    ds_write_b32 v45, v44
    v_lshlrev_b32 v36, 16, v32
    v_and_b32 v37, 0xffff0000, v32
    v_lshlrev_b32 v38, 16, v33
    v_and_b32 v39, 0xffff0000, v33
    v_lshlrev_b32 v40, 16, v34
    v_and_b32 v41, 0xffff0000, v34
    v_lshlrev_b32 v42, 16, v35
    v_and_b32 v43, 0xffff0000, v35
    v_pk_add_f32 v[36:37], v[36:37], v[38:39]
    v_pk_add_f32 v[40:41], v[40:41], v[42:43]
    v_pk_add_f32 v[36:37], v[36:37], v[40:41]
    v_cvt_pk_bf16_f32 v32, v36, v37
    v_min_u32 v32, -2, v32
    ds_write_b32 v1, v32
    s_mov_b32 s34, 258048
    buffer_load_dwordx4 v[144:147], v18, s[40:43], s34 offen offset:0 nt
    buffer_load_dwordx4 v[148:151], v18, s[40:43], s34 offen offset:1024 nt
    buffer_load_dwordx4 v[152:155], v18, s[40:43], s34 offen offset:2048 nt
    buffer_load_dwordx4 v[156:159], v18, s[40:43], s34 offen offset:3072 nt
    v_and_b32 v2, 15, v0
    v_lshlrev_b32 v2, 4, v2
    v_add_u32 v2, 98304, v2
    ds_read_b128 v[4:7], v2
    s_waitcnt lgkmcnt(0)
    v_dot2_f32_bf16 v8, v128, v4, 0
    v_dot2_f32_bf16 v9, v132, v4, 0
    v_dot2_f32_bf16 v10, v136, v4, 0
    v_dot2_f32_bf16 v11, v140, v4, 0
    v_dot2c_f32_bf16 v8, v129, v5
    v_dot2c_f32_bf16 v9, v133, v5
    v_dot2c_f32_bf16 v10, v137, v5
    v_dot2c_f32_bf16 v11, v141, v5
    v_dot2c_f32_bf16 v8, v130, v6
    v_dot2c_f32_bf16 v9, v134, v6
    v_dot2c_f32_bf16 v10, v138, v6
    v_dot2c_f32_bf16 v11, v142, v6
    v_dot2c_f32_bf16 v8, v131, v7
    v_dot2c_f32_bf16 v9, v135, v7
    v_dot2c_f32_bf16 v10, v139, v7
    v_dot2c_f32_bf16 v11, v143, v7
    v_add_f32_dpp v16, v8, v8 row_ror:8 row_mask:0xf bank_mask:0x3
    v_add_f32_dpp v16, v9, v9 row_ror:8 row_mask:0xf bank_mask:0xc
    v_add_f32_dpp v17, v10, v10 row_ror:8 row_mask:0xf bank_mask:0x3
    v_add_f32_dpp v17, v11, v11 row_ror:8 row_mask:0xf bank_mask:0xc
    v_add_f32_dpp v16, v16, v16 row_half_mirror row_mask:0xf bank_mask:0xf
    s_nop 0
    v_add_f32_dpp v17, v17, v17 row_half_mirror row_mask:0xf bank_mask:0xf
    v_add_f32_dpp v16, v16, v16 quad_perm:[1,0,3,2] row_mask:0xf bank_mask:0xf
    s_nop 0
    v_add_f32_dpp v17, v17, v17 quad_perm:[1,0,3,2] row_mask:0xf bank_mask:0xf
    v_add_f32_dpp v16, v16, v16 quad_perm:[2,3,0,1] row_mask:0xf bank_mask:0xf
    s_nop 0
    v_add_f32_dpp v17, v17, v17 quad_perm:[2,3,0,1] row_mask:0xf bank_mask:0xf
    v_max_f32 v8, v16, v17
    s_mov_b32 s34, 0x3e0293ee
    s_nop 0
    v_max_f32_dpp v8, v8, v8 row_ror:8 row_mask:0xf bank_mask:0xf
    v_mov_b32 v9, v8
    s_nop 1
    v_permlane16_swap_b32 v8, v9
    v_max_f32 v8, v8, v9
    v_mov_b32 v9, v8
    s_nop 1
    v_permlane32_swap_b32 v8, v9
    v_max_f32 v8, v8, v9
    v_mul_f32 v8, s34, v8
    v_fma_f32 v16, v16, s34, -v8
    v_fma_f32 v17, v17, s34, -v8
    v_exp_f32 v16, v16
    v_exp_f32 v17, v17
    s_nop 0
    v_add_f32 v9, v16, v17
    v_and_b32 v10, 1, v0
    v_lshlrev_b32 v10, 4, v10
    v_mov_b32 v11, 0xffff
    v_lshlrev_b32 v10, v10, v11
    v_bfe_u32 v11, v0, 1, 2
    v_cmp_eq_u32 vcc, 0, v11
    s_nop 1
    v_cndmask_b32 v20, 0, v10, vcc
    v_cmp_eq_u32 vcc, 1, v11
    s_nop 1
    v_cndmask_b32 v21, 0, v10, vcc
    v_cmp_eq_u32 vcc, 2, v11
    s_nop 1
    v_cndmask_b32 v22, 0, v10, vcc
    v_cmp_eq_u32 vcc, 3, v11
    s_nop 1
    v_cndmask_b32 v23, 0, v10, vcc
    v_add_f32_dpp v9, v9, v9 row_ror:8 row_mask:0xf bank_mask:0xf
    v_mov_b32 v10, v9
    s_nop 1
    v_permlane16_swap_b32 v9, v10
    v_add_f32 v9, v9, v10
    v_mov_b32 v10, v9
    s_nop 1
    v_permlane32_swap_b32 v9, v10
    v_add_f32 v9, v9, v10
    v_mov_b32 v10, 98616
    s_mov_b64 exec, 1
    ds_write_b64 v10, v[8:9]
    s_mov_b64 exec, -1
    s_waitcnt vmcnt(0)
    v_cvt_pk_bf16_f32 v10, v16, v16
    v_and_b32 v24, v10, v20
    v_and_b32 v25, v10, v21
    v_and_b32 v26, v10, v22
    v_and_b32 v27, v10, v23
    s_nop 1
    v_mfma_f32_16x16x32_bf16 v[116:119], v[144:147], v[24:27], 0
    v_mfma_f32_16x16x32_bf16 v[120:123], v[148:151], v[24:27], 0
    v_cvt_pk_bf16_f32 v10, v17, v17
    v_and_b32 v28, v10, v20
    v_and_b32 v29, v10, v21
    v_and_b32 v30, v10, v22
    v_and_b32 v31, v10, v23
    s_nop 1
    v_mfma_f32_16x16x32_bf16 v[116:119], v[152:155], v[28:31], v[116:119]
    v_mfma_f32_16x16x32_bf16 v[120:123], v[156:159], v[28:31], v[120:123]
    s_mov_b32 s34, 106496
    v_lshrrev_b32 v16, 4, v0
    v_and_b32 v17, 7, v0
    v_lshl_add_u32 v16, v16, 3, v17
    v_bfe_u32 v17, v0, 3, 1
    v_lshl_add_u32 v16, v17, 5, v16
    v_lshl_add_u32 v16, v16, 4, s34
    s_nop 0
    v_add_f32_dpp v116, v120, v116 row_ror:8 row_mask:0xf bank_mask:0xf
    v_add_f32_dpp v117, v121, v117 row_ror:8 row_mask:0xf bank_mask:0xf
    v_add_f32_dpp v118, v122, v118 row_ror:8 row_mask:0xf bank_mask:0xf
    v_add_f32_dpp v119, v123, v119 row_ror:8 row_mask:0xf bank_mask:0xf
    ds_write_b128 v16, v[116:119]
    v_lshl_add_u32 v16, v0, 3, s34
    ds_read_b64 v[116:117], v16
    s_waitcnt lgkmcnt(0)
    s_mov_b32 s63, 0
    s_mov_b32 s62, s61
    s_cmp_lt_u32 s61, 20
    s_cbranch_scc1 L_rd25
    s_mul_i32 s62, s60, 12
    s_add_u32 s62, s62, s61
    s_sub_u32 s62, s62, 20
    s_mov_b32 s63, 1
    s_cmp_lt_u32 s62, 54
    s_cbranch_scc1 L_rd25
    s_cmp_lt_u32 s62, 56
    s_cselect_b32 s63, 3, 2
    s_sub_u32 s62, s62, 56
L_rd25:
    v_and_b32 v8, 3, v0
    v_bfe_u32 v9, v0, 2, 2
    v_lshrrev_b32 v10, 4, v0
    s_mov_b32 s55, 0x20000
    s_lshl_b32 s35, s62, 6
    s_and_b32 s49, s62, 1
    s_cmp_eq_u32 s63, 0
    s_cbranch_scc1 L_dp27
    s_cmp_eq_u32 s63, 1
    s_cbranch_scc1 L_dp28
    s_mov_b32 s52, s20
    s_mov_b32 s53, s21
    s_mov_b32 s54, 2211840
    v_mov_b32 v15, 0
    s_branch L_dp29
L_dp28:
    s_mov_b32 s52, s16
    s_mov_b32 s53, s17
    s_mov_b32 s54, 2211840
    v_lshl_add_u32 v15, v9, 3, v10
    v_mul_u32_u24 v15, 3456, v15
    v_lshl_add_u32 v15, v8, 4, v15
    v_add_u32 v15, s35, v15
    s_bfe_u32 s50, s3, 0x10001
    s_lshl_b32 s50, s50, 7
    s_and_b32 s34, s3, 1
    s_lshl_b32 s34, s34, 2
    s_add_u32 s50, s50, s34
    s_and_b32 s51, s3, 3
    s_lshl_b32 s51, s51, 5
    s_add_u32 s51, s51, 512
    s_mul_i32 s50, s50, 3456
    s_mul_i32 s51, s51, 3456
    s_branch L_dp29
L_dp27:
    s_mov_b32 s52, s12
    s_mov_b32 s53, s13
    s_mov_b32 s54, 5242880
    s_lshr_b32 s50, s3, 1
    s_lshl_b32 s50, s50, 3
    s_add_u32 s50, s50, s60
    s_and_b32 s51, s3, 1
    s_lshl_b32 s34, s50, 1
    s_add_u32 s34, s34, s51
    s_mul_i32 s34, s34, 81920
    s_add_u32 s34, s34, s35
    v_lshl_add_u32 v15, v9, 2, v10
    v_mul_u32_u24 v15, 2560, v15
    v_lshl_add_u32 v15, v8, 4, v15
    v_add_u32 v15, s34, v15
    s_lshl_b32 s56, s3, 12
    s_lshl_b32 s34, s49, 11
    s_add_u32 s56, s56, s34
    s_add_u32 s56, s56, 40960
    s_add_u32 s58, s56, 1024
    s_mul_i32 s57, s49, 40960
    s_add_u32 s59, s57, 1280
L_dp29:
    v_and_b32 v200, 3, v0
    v_bfe_u32 v201, v0, 2, 2
    v_lshrrev_b32 v202, 4, v0
    s_lshl_b32 s34, s3, 10
    s_add_u32 s34, s34, 122112
    v_mul_u32_u24 v203, 320, v201
    v_min_u32 v203, 704, v203
    v_lshl_add_u32 v203, v202, 6, v203
    v_lshl_add_u32 v203, v200, 4, v203
    v_add_u32 v203, s34, v203
    s_movk_i32 s48, 16384
    v_mov_b32 v197, 0
    s_mov_b32 s40, 0
    s_mov_b32 s41, 0
    s_mov_b32 s42, 0
    s_cmp_eq_u32 s63, 0
    s_cbranch_scc1 L_d_wo
    s_cmp_eq_u32 s63, 2
    s_cbranch_scc1 L_d_w2
    s_cmp_eq_u32 s63, 3
    s_cbranch_scc1 L_d_none
    v_and_b32 v205, 15, v0
    v_lshlrev_b32 v205, 4, v205
    s_and_b32 s49, s3, 3
    s_mul_i32 s34, s49, 1280
    s_add_u32 s34, s34, s99
    s_add_u32 s34, s34, 786432
    v_lshl_add_u32 v206, v202, 15, v205
    v_add_u32 v206, s34, v206
    s_mul_i32 s34, s49, 3840
    v_add_u32 v205, s34, v205
    s_lshl_b32 s34, s62, 6
    v_lshlrev_b32 v5, 4, v14
    v_lshl_add_u32 v5, v12, 2, v5
    v_add_u32 v5, s34, v5
    global_load_dword v6, v5, s[18:19]
    v_and_b32 v7, 15, v0
    v_lshlrev_b32 v7, 4, v7
    v_mul_u32_u24 v8, 1280, v14
    v_add_u32 v8, v8, v7
    v_bfe_u32 v9, v0, 3, 1
    v_lshlrev_b32 v9, 15, v9
    v_lshl_add_u32 v9, v14, 7, v9
    v_and_b32 v10, 7, v0
    v_lshl_add_u32 v9, v10, 4, v9
    v_add_u32 v9, 1572864, v9
    s_mov_b32 s57, 65536
    v_mul_u32_u24 v5, 3840, v14
    v_add_u32 v5, v5, v7
    global_load_dwordx4 v[32:35], v8, s[4:5] offset:0
    global_load_dwordx4 v[36:39], v8, s[4:5] offset:256
    global_load_dwordx4 v[40:43], v8, s[4:5] offset:512
    global_load_dwordx4 v[44:47], v8, s[4:5] offset:768
    global_load_dwordx4 v[48:51], v8, s[4:5] offset:1024
    s_mov_b32 s35, 0
L_poll30:
    buffer_load_dwordx4 v[52:55], v9, s[44:47], s57 offen offset:1024 sc1
    buffer_load_dwordx4 v[56:59], v9, s[44:47], 0 offen offset:1536 sc1
    buffer_load_dwordx4 v[60:63], v9, s[44:47], s57 offen offset:1536 sc1
    buffer_load_dwordx4 v[64:67], v9, s[44:47], 0 offen offset:2048 sc1
    buffer_load_dwordx4 v[68:71], v9, s[44:47], s57 offen offset:2048 sc1
    buffer_load_dwordx4 v[72:75], v9, s[44:47], 0 offen offset:2560 sc1
    buffer_load_dwordx4 v[76:79], v9, s[44:47], s57 offen offset:2560 sc1
    buffer_load_dwordx4 v[80:83], v9, s[44:47], 0 offen offset:3072 sc1
    buffer_load_dwordx4 v[84:87], v9, s[44:47], s57 offen offset:3072 sc1
    buffer_load_dwordx4 v[88:91], v9, s[44:47], 0 offen offset:3584 sc1
    s_add_u32 s35, s35, 1
    s_waitcnt vmcnt(0)
    v_max3_u32 v28, v52, v53, v54
    v_max3_u32 v28, v28, v55, v56
    v_max3_u32 v28, v28, v57, v58
    v_max3_u32 v28, v28, v59, v60
    v_max3_u32 v28, v28, v61, v62
    v_max3_u32 v28, v28, v63, v64
    v_max3_u32 v28, v28, v65, v66
    v_max3_u32 v28, v28, v67, v68
    v_max3_u32 v28, v28, v69, v70
    v_max3_u32 v28, v28, v71, v72
    v_max3_u32 v28, v28, v73, v74
    v_max3_u32 v28, v28, v75, v76
    v_max3_u32 v28, v28, v77, v78
    v_max3_u32 v28, v28, v79, v80
    v_max3_u32 v28, v28, v81, v82
    v_max3_u32 v28, v28, v83, v84
    v_max3_u32 v28, v28, v85, v86
    v_max3_u32 v28, v28, v87, v88
    v_max3_u32 v28, v28, v89, v90
    v_max_u32 v28, v28, v91
    v_cmp_eq_u32 vcc, -1, v28
    s_cbranch_vccz L_done31
    s_sleep 16
    s_cmp_lt_u32 s35, 60000
    s_cbranch_scc1 L_poll30
L_done31:
    ds_write_b128 v5, v[32:35] offset:0
    ds_write_b128 v5, v[36:39] offset:256
    ds_write_b128 v5, v[40:43] offset:512
    ds_write_b128 v5, v[44:47] offset:768
    ds_write_b128 v5, v[48:51] offset:1024
    ds_write_b128 v5, v[52:55] offset:1280
    ds_write_b128 v5, v[56:59] offset:1536
    ds_write_b128 v5, v[60:63] offset:1792
    ds_write_b128 v5, v[64:67] offset:2048
    ds_write_b128 v5, v[68:71] offset:2304
    ds_write_b128 v5, v[72:75] offset:2560
    ds_write_b128 v5, v[76:79] offset:2816
    ds_write_b128 v5, v[80:83] offset:3072
    ds_write_b128 v5, v[84:87] offset:3328
    ds_write_b128 v5, v[88:91] offset:3584
    s_waitcnt lgkmcnt(0)
    v_lshlrev_b32 v100, 16, v6
    v_and_b32 v101, 0xffff0000, v6
    s_cmp_eq_u32 s60, 4
    s_cselect_b32 s40, 6, 12
    s_mov_b32 s41, 5462
    s_cmov_b32 s41, 10923
    s_cselect_b32 s34, 20, 20
    s_mov_b32 s49, 17280
    s_cmov_b32 s49, 34560
    v_min_u32 v196, 59, v0
    v_mul_u32_u24 v197, s41, v196
    v_lshrrev_b32 v197, 16, v197
    v_mul_u32_u24 v194, s40, v197
    v_sub_u32 v196, v196, v194
    v_mul_u32_u24 v197, 3456, v197
    v_lshl_add_u32 v197, v196, 6, v197
    s_mul_i32 s35, s60, 768
    s_add_i32 s35, s35, 0
    s_cmp_eq_u32 s60, 4
    s_cselect_b32 s35, 3072, s35
    s_sub_u32 s34, s61, s34
    s_mul_i32 s34, s34, s49
    s_mul_i32 s34, s34, 11
    s_add_u32 s34, s34, s35
    v_add_u32 v197, s34, v197
    s_mov_b32 s40, s49
    s_mov_b32 s41, s49
    s_branch L_d_none
L_d_w2:
    s_lshl_b32 s34, s62, 5
    v_lshl_add_u32 v3, v14, 3, s34
    global_load_dwordx2 v[20:21], v3, s[22:23]
    v_mul_u32_u24 v112, 1280, v12
    v_add_u32 v112, v112, v3
    global_load_dwordx2 v[22:23], v112, s[4:5]
    s_lshr_b32 s34, s62, 2
    s_add_u32 s34, s34, 30
    s_lshr_b32 s35, s34, 2
    s_lshl_b32 s35, s35, 9
    s_and_b32 s34, s34, 3
    s_lshl_b32 s34, s34, 15
    s_add_u32 s34, s34, s35
    s_and_b32 s35, s62, 3
    s_mul_i32 s35, s35, 32
    s_add_u32 s34, s34, s35
    s_add_u32 s34, s34, 1572864
    v_lshlrev_b32 v5, 7, v12
    v_lshl_add_u32 v5, v14, 3, v5
    v_add_u32 v5, s34, v5
    s_waitcnt vmcnt(0)
    v_lshlrev_b32 v32, 16, v20
    v_and_b32 v33, 0xffff0000, v20
    v_lshlrev_b32 v34, 16, v21
    v_and_b32 v35, 0xffff0000, v21
    v_lshlrev_b32 v108, 16, v22
    v_and_b32 v109, 0xffff0000, v22
    v_lshlrev_b32 v110, 16, v23
    v_and_b32 v111, 0xffff0000, v23
    s_mov_b32 s35, 0
L_poll33:
    buffer_load_dwordx2 v[24:25], v5, s[44:47], 0 offen sc1
    s_add_u32 s35, s35, 1
    s_waitcnt vmcnt(0)
    v_max_u32 v28, v24, v25
    v_cmp_eq_u32 vcc, -1, v28
    s_cbranch_vccz L_done34
    s_sleep 16
    s_cmp_lt_u32 s35, 60000
    s_cbranch_scc1 L_poll33
L_done34:
    v_lshlrev_b32 v104, 16, v24
    v_and_b32 v105, 0xffff0000, v24
    v_lshlrev_b32 v106, 16, v25
    v_and_b32 v107, 0xffff0000, v25
    v_fma_f32 v108, v104, v32, v108
    v_fma_f32 v109, v105, v33, v109
    v_fma_f32 v110, v106, v34, v110
    v_fma_f32 v111, v107, v35, v111
    v_mul_f32 v108, 0x3e800000, v108
    v_mul_f32 v109, 0x3e800000, v109
    v_mul_f32 v110, 0x3e800000, v110
    v_mul_f32 v111, 0x3e800000, v111
    v_lshl_add_u32 v204, v13, 15, v112
    s_add_u32 s34, s99, 786432
    v_add_u32 v204, s34, v204
    s_cmp_eq_u32 s60, 4
    s_cselect_b32 s40, 2, 6
    s_mov_b32 s41, 10923
    s_cmov_b32 s41, 32769
    s_cselect_b32 s34, 28, 20
    s_mov_b32 s49, 12800
    s_cmov_b32 s49, 38400
    v_min_u32 v196, 59, v0
    v_mul_u32_u24 v197, s41, v196
    v_lshrrev_b32 v197, 16, v197
    v_mul_u32_u24 v194, s40, v197
    v_sub_u32 v196, v196, v194
    v_mul_u32_u24 v197, 1280, v197
    v_lshl_add_u32 v197, v196, 6, v197
    s_mul_i32 s35, s60, 384
    s_add_i32 s35, s35, -1792
    s_cmp_eq_u32 s60, 4
    s_cselect_b32 s35, 0, s35
    s_sub_u32 s34, s61, s34
    s_mul_i32 s34, s34, s49
    s_mul_i32 s34, s34, 15
    s_add_u32 s34, s34, s35
    v_add_u32 v197, s34, v197
    s_mov_b32 s40, s49
    s_mov_b32 s41, s49
    s_branch L_d_none
L_d_wo:
    s_lshr_b32 s49, s3, 1
    s_lshl_b32 s49, s49, 15
    v_and_b32 v210, 7, v0
    s_mul_i32 s34, s60, 4096
    s_add_u32 s34, s34, s49
    s_add_u32 s34, s34, 1179904
    v_lshrrev_b32 v211, 3, v0
    v_mul_u32_u24 v205, 512, v211
    v_add_u32 v204, s34, v205
    s_lshl_b32 s35, s51, 7
    s_add_u32 s34, s34, s35
    s_sub_u32 s34, s34, 256
    v_lshl_add_u32 v205, v210, 4, v205
    v_add_u32 v205, s34, v205
    s_lshl_b32 s34, s3, 12
    s_add_u32 s34, s34, 40960
    v_lshrrev_b32 v206, 2, v0
    v_lshlrev_b32 v206, 6, v206
    v_lshl_add_u32 v206, v200, 3, v206
    v_add_u32 v206, s34, v206
    s_mul_i32 s34, s3, 1152
    s_add_u32 s34, s34, 107520
    v_mul_u32_u24 v207, 144, v211
    v_lshl_add_u32 v207, v210, 4, v207
    v_add_u32 v207, s34, v207
    v_mul_u32_u24 v208, 144, v210
    v_lshl_add_u32 v208, v202, 4, v208
    v_add_u32 v208, s34, v208
    v_mul_u32_u24 v212, 144, v211
    v_add_u32 v212, s34, v212
    v_mul_u32_u24 v213, 144, v210
    v_add_u32 v213, s34, v213
    v_and_b32 v211, 1, v211
    v_bfe_u32 v203, v0, 1, 2
    v_mul_u32_u24 v203, 144, v203
    v_and_b32 v214, 1, v0
    v_mul_u32_u24 v214, 576, v214
    v_lshl_add_u32 v214, v211, 6, v214
    v_lshl_add_u32 v214, v202, 4, v214
    s_add_u32 s34, s34, 14592
    v_add3_u32 v203, v203, v214, s34
    v_mov_b32 v210, 98816
    v_cmp_eq_u32 vcc, 0, v211
    s_nop 1
    v_cndmask_b32 v209, v208, v210, vcc
    v_cndmask_b32 v208, v210, v208, vcc
    v_and_b32 v8, 15, v0
    s_lshr_b32 s34, s62, 1
    s_add_u32 s34, s34, 0
    s_lshr_b32 s35, s34, 2
    s_lshl_b32 s35, s35, 9
    s_and_b32 s34, s34, 3
    s_lshl_b32 s34, s34, 15
    s_add_u32 s34, s34, s35
    s_and_b32 s35, s62, 1
    s_mul_i32 s35, s35, 64
    s_add_u32 s34, s34, s35
    s_add_u32 s34, s34, 1572864
    v_lshlrev_b32 v9, 2, v8
    v_lshl_add_u32 v9, v14, 7, v9
    v_add_u32 v9, s34, v9
    s_lshr_b32 s34, s60, 2
    s_lshl_b32 s34, s34, 14
    s_and_b32 s35, s60, 3
    s_lshl_b32 s35, s35, 15
    s_add_u32 s34, s34, s35
    s_lshl_b32 s35, s62, 6
    s_add_u32 s34, s34, s35
    s_add_u32 s34, s34, 786432
    v_mul_u32_u24 v112, 1280, v14
    v_lshl_add_u32 v112, v8, 2, v112
    v_add_u32 v112, s34, v112
    v_add_u32 v114, 917504, v112
    v_mul_u32_u24 v113, 144, v14
    v_lshl_add_u32 v113, v8, 3, v113
    v_add_u32 v113, 122112, v113
    s_bfe_u32 s35, s60, 0x10002
    s_lshl_b32 s35, s35, 13
    s_xor_b32 s101, s99, s35
    s_xor_b32 s93, s101, 8192
    s_mul_i32 s34, s62, 52
    s_lshr_b32 s34, s34, 8
    s_mul_i32 s35, s34, 5
    s_sub_u32 s35, s62, s35
    s_mul_i32 s34, s34, 1310720
    s_lshl_b32 s35, s35, 15
    s_add_u32 s34, s34, s35
    s_mul_i32 s35, s60, 163840
    s_add_u32 s34, s34, s35
    v_lshl_add_u32 v197, v0, 6, s34
    s_movk_i32 s40, 4096
    s_movk_i32 s41, 4096
    s_mov_b32 s35, 0
L_poll36:
    buffer_load_dword v32, v9, s[44:47], 0 offen sc1
    s_add_u32 s35, s35, 1
    s_waitcnt vmcnt(0)
    v_mov_b32 v22, v32
    v_cmp_eq_u32 vcc, -1, v22
    s_cbranch_vccz L_done37
    s_sleep 16
    s_cmp_lt_u32 s35, 60000
    s_cbranch_scc1 L_poll36
L_done37:
    v_lshlrev_b32 v100, 16, v32
    v_and_b32 v101, 0xffff0000, v32
L_d_none:
    v_mov_b32 v22, 99072
    s_and_b32 s34, s60, 3
    s_lshl_b32 s34, s34, 15
    s_lshr_b32 s35, s60, 2
    s_lshl_b32 s35, s35, 7
    s_add_u32 s34, s34, s35
    s_add_u32 s34, s34, 793600
    v_and_b32 v252, 31, v0
    v_lshl_add_u32 v252, v252, 2, s34
    v_mov_b32 v253, 0
    s_mov_b32 s35, 0
L_poll39:
    ds_read_b32 v23, v22
    s_add_u32 s35, s35, 1
    s_waitcnt lgkmcnt(0)
    v_cmp_gt_u32 vcc, 46, v23
    s_cbranch_vccz L_done40
    s_sleep 2
    s_cmp_lt_u32 s35, 60000
    s_cbranch_scc1 L_poll39
L_done40:
    buffer_load_dword v251, v252, s[44:47], 0 offen sc1
    s_lshl_b64 exec, 1, s61
    buffer_store_dword v253, v252, s[44:47], 0 offen
    s_mov_b64 exec, -1
    s_waitcnt vmcnt(1)
    v_cmp_ne_u32 vcc, -1, v251
    v_mov_b32 v252, 99076
    s_bcnt1_i32_b32 s34, vcc_lo
    v_mov_b32 v251, s34
    s_mov_b64 exec, 1
    ds_write_b32 v252, v251
    s_mov_b64 exec, -1
    v_mov_b32 v22, 99072
    s_and_b32 s34, s60, 3
    s_lshl_b32 s34, s34, 15
    s_lshr_b32 s35, s60, 2
    s_lshl_b32 s35, s35, 7
    s_add_u32 s34, s34, s35
    s_add_u32 s34, s34, 793856
    v_and_b32 v252, 31, v0
    v_lshl_add_u32 v252, v252, 2, s34
    v_mov_b32 v253, 0
    s_mov_b32 s35, 0
L_poll42:
    ds_read_b32 v23, v22
    s_add_u32 s35, s35, 1
    s_waitcnt lgkmcnt(0)
    v_cmp_gt_u32 vcc, 57, v23
    s_cbranch_vccz L_done43
    s_sleep 2
    s_cmp_lt_u32 s35, 60000
    s_cbranch_scc1 L_poll42
L_done43:
    buffer_load_dword v251, v252, s[44:47], 0 offen sc1
    s_lshl_b64 exec, 1, s61
    buffer_store_dword v253, v252, s[44:47], 0 offen
    s_mov_b64 exec, -1
    s_waitcnt vmcnt(1)
    v_cmp_ne_u32 vcc, -1, v251
    v_mov_b32 v252, 99076
    s_bcnt1_i32_b32 s34, vcc_lo
    v_mov_b32 v251, s34
    s_mov_b64 exec, 1
    ds_write_b32 v252, v251
    s_mov_b64 exec, -1
    v_and_b32 v19, 7, v0
    v_lshlrev_b32 v19, 3, v19
    v_add_u32 v19, 98560, v19
    s_mov_b32 s35, 0
L_poll45:
    ds_read_b64 v[20:21], v19
    s_add_u32 s35, s35, 1
    s_waitcnt lgkmcnt(0)
    v_max_u32 v22, v20, v21
    v_cmp_eq_u32 vcc, -1, v22
    s_cbranch_vccz L_done46
    s_sleep 2
    s_cmp_lt_u32 s35, 60000
    s_cbranch_scc1 L_poll45
L_done46:
    v_max_f32_dpp v22, v20, v20 row_half_mirror row_mask:0xf bank_mask:0xf
    s_nop 1
    v_max_f32_dpp v22, v22, v22 quad_perm:[1,0,3,2] row_mask:0xf bank_mask:0xf
    s_nop 1
    v_max_f32_dpp v22, v22, v22 quad_perm:[2,3,0,1] row_mask:0xf bank_mask:0xf
    v_sub_f32 v20, v20, v22
    v_exp_f32 v20, v20
    s_nop 0
    v_mul_f32 v21, v21, v20
    s_nop 1
    v_add_f32_dpp v21, v21, v21 row_half_mirror row_mask:0xf bank_mask:0xf
    s_nop 1
    v_add_f32_dpp v21, v21, v21 quad_perm:[1,0,3,2] row_mask:0xf bank_mask:0xf
    s_nop 1
    v_add_f32_dpp v21, v21, v21 quad_perm:[2,3,0,1] row_mask:0xf bank_mask:0xf
    v_rcp_f32 v23, v21
    v_log_f32 v21, v21
    v_mul_f32 v20, v20, v23
    v_add_f32 v21, v21, v22
    v_min_u32 v21, -2, v21
    v_readlane_b32 s88, v20, 0
    v_readlane_b32 s90, v20, 1
    v_readlane_b32 s92, v20, 2
    v_readlane_b32 s94, v20, 3
    v_readlane_b32 s96, v20, 4
    v_readlane_b32 s98, v20, 5
    v_readlane_b32 s100, v20, 6
    v_readlane_b32 s89, v20, 7
    s_and_b32 s95, s61, 3
    s_lshl_b32 s95, s95, 15
    s_bfe_u32 s35, s2, 0x20005
    s_lshl_b32 s35, s35, 1
    s_lshr_b32 s91, s2, 7
    s_add_u32 s35, s35, s91
    s_getreg_b32 s91, hwreg(HW_REG_XCC_ID, 0, 4)
    v_and_b32 v24, 1, v0
    v_cmp_eq_u32 vcc, 0, v24
    v_mov_b32 v25, s91
    s_nop 0
    v_cndmask_b32 v25, v25, v21, vcc
    v_mul_f32 v20, s89, v116
    v_mul_f32 v21, s89, v117
    s_mul_i32 s34, s60, 4096
    s_mul_i32 s35, s35, 512
    s_add_u32 s34, s34, s35
    s_add_u32 s34, s34, s95
    s_add_u32 s34, s34, 1179648
    v_lshl_add_u32 v26, v0, 2, s34
    v_lshlrev_b32 v19, 3, v0
    v_add_u32 v19, 99328, v19
    v_lshlrev_b32 v18, 4, v0
    v_add_u32 v18, 131328, v18
    s_mov_b32 s36, s12
    s_mov_b32 s37, s13
    s_mov_b32 s38, 5242880
    s_and_b32 s34, s61, 24
    s_add_u32 s34, s34, s60
    s_mul_i32 s34, s34, 163840
    s_and_b32 s35, s61, 7
    s_mul_i32 s35, s35, 20480
    s_add_u32 s34, s34, s35
    v_lshl_add_u32 v195, v0, 6, s34
    s_mov_b32 s34, 0
    s_barrier
    buffer_load_dword v250, v195, s[36:39], s34 offen
    s_add_u32 s34, s34, 4096
    buffer_load_dword v250, v195, s[36:39], s34 offen
    s_add_u32 s34, s34, 4096
    buffer_load_dword v250, v195, s[36:39], s34 offen
    s_add_u32 s34, s34, 4096
    buffer_load_dword v250, v195, s[36:39], s34 offen
    s_add_u32 s34, s34, 4096
    buffer_load_dword v250, v195, s[36:39], s34 offen
    s_add_u32 s34, s34, 4096
    s_cmp_lt_u32 s63, 1
    s_cbranch_scc1 L_nopf
    buffer_load_dword v250, v197, s[52:55], s42 offen
    s_add_u32 s42, s42, s40
    buffer_load_dword v250, v197, s[52:55], s42 offen
    s_add_u32 s42, s42, s41
L_nopf:
    s_cmp_eq_u32 s97, 0
    s_barrier
    ds_read_b64 v[32:33], v19 offset:0
    ds_read_b64 v[34:35], v19 offset:1024
    ds_read_b64 v[36:37], v19 offset:2048
    ds_read_b64 v[38:39], v19 offset:3072
    ds_read_b64 v[40:41], v19 offset:4096
    ds_read_b64 v[42:43], v19 offset:5120
    ds_read_b64 v[44:45], v19 offset:6144
    buffer_store_dword v25, v26, s[44:47], 0 offen offset:256
    s_waitcnt lgkmcnt(6)
    v_pk_fma_f32 v[20:21], v[32:33], s[88:89], v[20:21] op_sel_hi:[1,0,1]
    s_waitcnt lgkmcnt(5)
    v_pk_fma_f32 v[20:21], v[34:35], s[90:91], v[20:21] op_sel_hi:[1,0,1]
    s_waitcnt lgkmcnt(4)
    v_pk_fma_f32 v[20:21], v[36:37], s[92:93], v[20:21] op_sel_hi:[1,0,1]
    s_waitcnt lgkmcnt(3)
    v_pk_fma_f32 v[20:21], v[38:39], s[94:95], v[20:21] op_sel_hi:[1,0,1]
    s_waitcnt lgkmcnt(2)
    v_pk_fma_f32 v[20:21], v[40:41], s[96:97], v[20:21] op_sel_hi:[1,0,1]
    s_waitcnt lgkmcnt(1)
    v_pk_fma_f32 v[20:21], v[42:43], s[98:99], v[20:21] op_sel_hi:[1,0,1]
    s_waitcnt lgkmcnt(0)
    v_pk_fma_f32 v[20:21], v[44:45], s[100:101], v[20:21] op_sel_hi:[1,0,1]
    v_cvt_pk_bf16_f32 v24, v20, v21
    v_min_u32 v24, -2, v24
    buffer_store_dword v24, v26, s[44:47], 0 offen
    s_cbranch_scc1 L_ostd
    buffer_store_dword v24, v26, s[44:47], 0 offen sc1
    buffer_store_dword v25, v26, s[44:47], 0 offen offset:256 sc1
L_ostd:
    ds_write_b96 v18, v[24:26]
    s_cmp_lt_u32 s63, 1
    s_cbranch_scc1 L_nopf2
    buffer_load_dword v250, v197, s[52:55], s42 offen
    s_add_u32 s42, s42, s40
    buffer_load_dword v250, v197, s[52:55], s42 offen
    s_add_u32 s42, s42, s41
    buffer_load_dword v250, v197, s[52:55], s42 offen
    s_add_u32 s42, s42, s40
    buffer_load_dword v250, v197, s[52:55], s42 offen
    s_add_u32 s42, s42, s41
    buffer_load_dword v250, v197, s[52:55], s42 offen
    s_add_u32 s42, s42, s40
    buffer_load_dword v250, v197, s[52:55], s42 offen
    s_add_u32 s42, s42, s41
    buffer_load_dword v250, v197, s[52:55], s42 offen
    s_add_u32 s42, s42, s40
    buffer_load_dword v250, v197, s[52:55], s42 offen
    s_add_u32 s42, s42, s41
L_nopf2:
    s_waitcnt lgkmcnt(0)
    s_barrier
    s_cmp_eq_u32 s63, 0
    s_cbranch_scc1 L_r_wo2
    buffer_load_dword v250, v197, s[52:55], s42 offen
    s_add_u32 s42, s42, s40
    s_cmp_eq_u32 s63, 1
    s_cbranch_scc1 L_r_w1
    buffer_load_dword v250, v197, s[52:55], s42 offen
    s_add_u32 s42, s42, s40
    buffer_load_dword v250, v197, s[52:55], s42 offen
    s_add_u32 s42, s42, s41
    buffer_load_dword v250, v197, s[52:55], s42 offen
    s_add_u32 s42, s42, s40
    buffer_load_dword v250, v197, s[52:55], s42 offen
    s_add_u32 s42, s42, s41
    s_cmp_eq_u32 s63, 2
    s_cbranch_scc1 L_w2_red
    s_waitcnt vmcnt(0)
    s_mov_b64 exec, -1
    v_lshlrev_b32 v243, 4, v0
    v_add_u32 v243, 131328, v243
    ds_read_b96 v[240:242], v243
    s_waitcnt lgkmcnt(0)
    buffer_store_dword v240, v242, s[44:47], 0 offen sc1
    buffer_store_dword v241, v242, s[44:47], 0 offen offset:256 sc1
    s_branch L_fin
L_stream:
    s_sub_u32 s49, s3, 1
    s_mul_i32 s49, s49, 4096
    v_lshl_add_u32 v1, v0, 4, s49
    s_lshr_b32 s98, s2, 7
    s_mul_i32 s98, s98, 57344
    s_and_b32 s34, s2, 127
    s_lshl_b32 s34, s34, 21
    s_lshr_b32 s35, s2, 7
    s_lshl_b32 s35, s35, 18
    s_add_u32 s34, s34, s35
    s_add_u32 s34, s34, 1572864
    s_mov_b32 s38, 0x40000
    s_mov_b32 s42, 0x40000
    s_waitcnt lgkmcnt(0)
    s_add_u32 s36, s6, s34
    s_addc_u32 s37, s7, 0
    s_add_u32 s40, s8, s34
    s_addc_u32 s41, s9, 0
    s_waitcnt vmcnt(3)
    buffer_load_dwordx4 v[16:19], v1, s[36:39], s98 offen offset:0 nt
    s_waitcnt vmcnt(3)
    buffer_load_dwordx4 v[20:23], v1, s[36:39], s98 offen offset:1024 nt
    s_waitcnt vmcnt(3)
    buffer_load_dwordx4 v[24:27], v1, s[36:39], s98 offen offset:2048 nt
    s_waitcnt vmcnt(3)
    s_barrier
    s_waitcnt vmcnt(2)
    buffer_load_dwordx4 v[28:31], v1, s[36:39], s98 offen offset:3072 nt
    s_waitcnt vmcnt(2)
    s_addk_i32 s98, 28672
    buffer_load_dwordx4 v[32:35], v1, s[36:39], s98 offen offset:0 nt
    s_waitcnt vmcnt(2)
    buffer_load_dwordx4 v[36:39], v1, s[36:39], s98 offen offset:1024 nt
    s_waitcnt vmcnt(2)
    buffer_load_dwordx4 v[40:43], v1, s[36:39], s98 offen offset:2048 nt
    s_waitcnt vmcnt(2)
    buffer_load_dwordx4 v[44:47], v1, s[36:39], s98 offen offset:3072 nt
    s_add_u32 s44, s32, 0
    s_addc_u32 s45, s33, 0
    s_mov_b32 s63, 0
    s_mov_b32 s62, s61
    s_cmp_lt_u32 s61, 20
    s_cbranch_scc1 L_rd48
    s_mul_i32 s62, s60, 12
    s_add_u32 s62, s62, s61
    s_sub_u32 s62, s62, 20
    s_mov_b32 s63, 1
    s_cmp_lt_u32 s62, 54
    s_cbranch_scc1 L_rd48
    s_cmp_lt_u32 s62, 56
    s_cselect_b32 s63, 3, 2
    s_sub_u32 s62, s62, 56
L_rd48:
    v_and_b32 v8, 3, v0
    v_bfe_u32 v9, v0, 2, 2
    v_lshrrev_b32 v10, 4, v0
    s_mov_b32 s55, 0x20000
    s_lshl_b32 s35, s62, 6
    s_and_b32 s49, s62, 1
    s_cmp_eq_u32 s63, 0
    s_cbranch_scc1 L_dp50
    s_cmp_eq_u32 s63, 1
    s_cbranch_scc1 L_dp51
    s_mov_b32 s52, s20
    s_mov_b32 s53, s21
    s_mov_b32 s54, 2211840
    v_mov_b32 v15, 0
    s_branch L_dp52
L_dp51:
    s_mov_b32 s52, s16
    s_mov_b32 s53, s17
    s_mov_b32 s54, 2211840
    v_lshl_add_u32 v15, v9, 3, v10
    v_mul_u32_u24 v15, 3456, v15
    v_lshl_add_u32 v15, v8, 4, v15
    v_add_u32 v15, s35, v15
    s_bfe_u32 s50, s3, 0x10001
    s_lshl_b32 s50, s50, 7
    s_and_b32 s34, s3, 1
    s_lshl_b32 s34, s34, 2
    s_add_u32 s50, s50, s34
    s_and_b32 s51, s3, 3
    s_lshl_b32 s51, s51, 5
    s_add_u32 s51, s51, 512
    s_mul_i32 s50, s50, 3456
    s_mul_i32 s51, s51, 3456
    s_branch L_dp52
L_dp50:
    s_mov_b32 s52, s12
    s_mov_b32 s53, s13
    s_mov_b32 s54, 5242880
    s_lshr_b32 s50, s3, 1
    s_lshl_b32 s50, s50, 3
    s_add_u32 s50, s50, s60
    s_and_b32 s51, s3, 1
    s_lshl_b32 s34, s50, 1
    s_add_u32 s34, s34, s51
    s_mul_i32 s34, s34, 81920
    s_add_u32 s34, s34, s35
    v_lshl_add_u32 v15, v9, 2, v10
    v_mul_u32_u24 v15, 2560, v15
    v_lshl_add_u32 v15, v8, 4, v15
    v_add_u32 v15, s34, v15
    s_lshl_b32 s56, s3, 12
    s_lshl_b32 s34, s49, 11
    s_add_u32 s56, s56, s34
    s_add_u32 s56, s56, 40960
    s_add_u32 s58, s56, 1024
    s_mul_i32 s57, s49, 40960
    s_add_u32 s59, s57, 1280
L_dp52:
    v_and_b32 v2, 15, v0
    v_lshlrev_b32 v2, 4, v2
    v_add_u32 v2, 98304, v2
    s_waitcnt vmcnt(2)
    s_addk_i32 s98, 28672
    buffer_load_dwordx4 v[48:51], v1, s[36:39], s98 offen offset:0 nt
    s_waitcnt vmcnt(2)
    buffer_load_dwordx4 v[52:55], v1, s[36:39], s98 offen offset:1024 nt
    s_waitcnt vmcnt(2)
    buffer_load_dwordx4 v[56:59], v1, s[36:39], s98 offen offset:2048 nt
    s_waitcnt vmcnt(2)
    buffer_load_dwordx4 v[60:63], v1, s[36:39], s98 offen offset:3072 nt
    s_waitcnt vmcnt(2)
    s_addk_i32 s98, 28672
    buffer_load_dwordx4 v[64:67], v1, s[36:39], s98 offen offset:0 nt
    s_waitcnt vmcnt(2)
    buffer_load_dwordx4 v[68:71], v1, s[36:39], s98 offen offset:1024 nt
    v_mov_b32 v3, 14
    v_mov_b32 v14, 99072
    s_mov_b64 exec, 1
    ds_write_b32 v14, v3
    s_mov_b64 exec, -1
    s_waitcnt vmcnt(2)
    buffer_load_dwordx4 v[72:75], v1, s[36:39], s98 offen offset:2048 nt
    s_waitcnt vmcnt(2)
    buffer_load_dwordx4 v[76:79], v1, s[36:39], s98 offen offset:3072 nt
    s_waitcnt vmcnt(2)
    s_addk_i32 s98, 28672
    buffer_load_dwordx4 v[80:83], v1, s[36:39], s98 offen offset:0 nt
    s_waitcnt vmcnt(2)
    buffer_load_dwordx4 v[84:87], v1, s[36:39], s98 offen offset:1024 nt
    s_waitcnt vmcnt(2)
    buffer_load_dwordx4 v[88:91], v1, s[36:39], s98 offen offset:2048 nt
    s_waitcnt vmcnt(2)
    buffer_load_dwordx4 v[92:95], v1, s[36:39], s98 offen offset:3072 nt
    s_waitcnt vmcnt(2)
    s_addk_i32 s98, 28672
    buffer_load_dwordx4 v[96:99], v1, s[36:39], s98 offen offset:0 nt
    s_waitcnt vmcnt(2)
    buffer_load_dwordx4 v[100:103], v1, s[36:39], s98 offen offset:1024 nt
    v_mov_b32 v3, 22
    v_mov_b32 v14, 99072
    s_mov_b64 exec, 1
    ds_write_b32 v14, v3
    s_mov_b64 exec, -1
    s_waitcnt vmcnt(2)
    buffer_load_dwordx4 v[104:107], v1, s[36:39], s98 offen offset:2048 nt
    s_waitcnt vmcnt(2)
    buffer_load_dwordx4 v[108:111], v1, s[36:39], s98 offen offset:3072 nt
    s_waitcnt vmcnt(2)
    s_addk_i32 s98, 28672
    buffer_load_dwordx4 v[112:115], v1, s[36:39], s98 offen offset:0 nt
    s_waitcnt vmcnt(2)
    buffer_load_dwordx4 v[116:119], v1, s[36:39], s98 offen offset:1024 nt
    s_waitcnt vmcnt(2)
    buffer_load_dwordx4 v[120:123], v1, s[36:39], s98 offen offset:2048 nt
    s_waitcnt vmcnt(2)
    buffer_load_dwordx4 v[124:127], v1, s[36:39], s98 offen offset:3072 nt
    s_waitcnt vmcnt(2)
    s_addk_i32 s98, 28672
    s_cmp_eq_u32 s98, 258048
    s_cselect_b32 s98, 0, s98
    buffer_load_dwordx4 v[128:131], v1, s[36:39], s98 offen offset:0 nt
    s_waitcnt vmcnt(2)
    buffer_load_dwordx4 v[132:135], v1, s[36:39], s98 offen offset:1024 nt
    s_waitcnt vmcnt(2)
    buffer_load_dwordx4 v[136:139], v1, s[36:39], s98 offen offset:2048 nt
    s_waitcnt vmcnt(2)
    buffer_load_dwordx4 v[140:143], v1, s[36:39], s98 offen offset:3072 nt
    s_waitcnt vmcnt(2)
    s_addk_i32 s98, 28672
    buffer_load_dwordx4 v[144:147], v1, s[36:39], s98 offen offset:0 nt
    s_waitcnt vmcnt(2)
    buffer_load_dwordx4 v[148:151], v1, s[36:39], s98 offen offset:1024 nt
    v_mov_b32 v3, 34
    v_mov_b32 v14, 99072
    s_mov_b64 exec, 1
    ds_write_b32 v14, v3
    s_mov_b64 exec, -1
    s_waitcnt vmcnt(2)
    buffer_load_dwordx4 v[152:155], v1, s[36:39], s98 offen offset:2048 nt
    s_waitcnt vmcnt(2)
    buffer_load_dwordx4 v[156:159], v1, s[36:39], s98 offen offset:3072 nt
    s_waitcnt vmcnt(2)
    s_addk_i32 s98, 28672
    s_cmp_eq_u32 s98, 258048
    s_cselect_b32 s98, 0, s98
    buffer_load_dwordx4 v[160:163], v1, s[40:43], s98 offen offset:0 nt
    s_waitcnt vmcnt(2)
    buffer_load_dwordx4 v[164:167], v1, s[40:43], s98 offen offset:1024 nt
    v_mov_b32 v3, 99076
    ds_read_b32 v3, v3
    s_waitcnt vmcnt(2)
    s_waitcnt lgkmcnt(0)
    v_readfirstlane_b32 s48, v3
    buffer_load_dwordx4 v[168:171], v1, s[40:43], s98 offen offset:2048 nt
    s_cmp_ge_u32 s48, 20
    s_cbranch_scc1 L_bo53
    s_waitcnt vmcnt(2)
L_bo53:
    buffer_load_dwordx4 v[172:175], v1, s[40:43], s98 offen offset:3072 nt
    s_waitcnt vmcnt(3)
    s_cmp_ge_u32 s48, 21
    s_cbranch_scc1 L_bo54
    s_waitcnt vmcnt(2)
L_bo54:
    s_addk_i32 s98, 28672
    buffer_load_dwordx4 v[176:179], v1, s[40:43], s98 offen offset:0 nt
    s_waitcnt vmcnt(3)
    s_cmp_ge_u32 s48, 22
    s_cbranch_scc1 L_bo55
    s_waitcnt vmcnt(2)
L_bo55:
    buffer_load_dwordx4 v[180:183], v1, s[40:43], s98 offen offset:1024 nt
    s_waitcnt vmcnt(3)
    s_cmp_ge_u32 s48, 23
    s_cbranch_scc1 L_bo56
    s_waitcnt vmcnt(2)
L_bo56:
    buffer_load_dwordx4 v[184:187], v1, s[40:43], s98 offen offset:2048 nt
    s_waitcnt vmcnt(3)
    s_cmp_ge_u32 s48, 24
    s_cbranch_scc1 L_bo57
    s_waitcnt vmcnt(2)
L_bo57:
    buffer_load_dwordx4 v[188:191], v1, s[40:43], s98 offen offset:3072 nt
    s_waitcnt vmcnt(3)
    s_cmp_ge_u32 s48, 24
    s_cbranch_scc1 L_bo58
    s_waitcnt vmcnt(2)
L_bo58:
    s_addk_i32 s98, 28672
    buffer_load_dwordx4 v[192:195], v1, s[40:43], s98 offen offset:0 nt
    s_waitcnt vmcnt(3)
    s_cmp_ge_u32 s48, 25
    s_cbranch_scc1 L_bo59
    s_waitcnt vmcnt(2)
L_bo59:
    buffer_load_dwordx4 v[196:199], v1, s[40:43], s98 offen offset:1024 nt
    v_mov_b32 v3, 46
    v_mov_b32 v14, 99072
    s_mov_b64 exec, 1
    ds_write_b32 v14, v3
    s_mov_b64 exec, -1
    s_waitcnt vmcnt(3)
    s_cmp_ge_u32 s48, 26
    s_cbranch_scc1 L_bo60
    s_waitcnt vmcnt(2)
L_bo60:
    buffer_load_dwordx4 v[200:203], v1, s[40:43], s98 offen offset:2048 nt
    s_waitcnt vmcnt(3)
    s_cmp_ge_u32 s48, 27
    s_cbranch_scc1 L_bo61
    s_waitcnt vmcnt(2)
L_bo61:
    buffer_load_dwordx4 v[204:207], v1, s[40:43], s98 offen offset:3072 nt
    s_waitcnt vmcnt(3)
    s_cmp_ge_u32 s48, 27
    s_cbranch_scc1 L_bo62
    s_waitcnt vmcnt(2)
L_bo62:
    s_addk_i32 s98, 28672
    buffer_load_dwordx4 v[208:211], v1, s[40:43], s98 offen offset:0 nt
    s_waitcnt vmcnt(3)
    s_cmp_ge_u32 s48, 28
    s_cbranch_scc1 L_bo63
    s_waitcnt vmcnt(2)
L_bo63:
    buffer_load_dwordx4 v[212:215], v1, s[40:43], s98 offen offset:1024 nt
    v_mov_b32 v3, 99076
    ds_read_b32 v3, v3
    s_waitcnt vmcnt(3)
    s_cmp_ge_u32 s48, 28
    s_cbranch_scc1 L_bo64
    s_waitcnt vmcnt(2)
L_bo64:
    s_waitcnt lgkmcnt(0)
    v_readfirstlane_b32 s48, v3
    buffer_load_dwordx4 v[216:219], v1, s[40:43], s98 offen offset:2048 nt
    s_waitcnt vmcnt(3)
    s_cmp_ge_u32 s48, 20
    s_cbranch_scc1 L_bo65
    s_waitcnt vmcnt(2)
L_bo65:
    buffer_load_dwordx4 v[220:223], v1, s[40:43], s98 offen offset:3072 nt
    s_waitcnt vmcnt(3)
    s_cmp_ge_u32 s48, 21
    s_cbranch_scc1 L_bo66
    s_waitcnt vmcnt(2)
L_bo66:
    s_addk_i32 s98, 28672
    buffer_load_dwordx4 v[224:227], v1, s[40:43], s98 offen offset:0 nt
    s_waitcnt vmcnt(3)
    s_cmp_ge_u32 s48, 22
    s_cbranch_scc1 L_bo67
    s_waitcnt vmcnt(2)
L_bo67:
    buffer_load_dwordx4 v[228:231], v1, s[40:43], s98 offen offset:1024 nt
    s_waitcnt vmcnt(3)
    s_cmp_ge_u32 s48, 23
    s_cbranch_scc1 L_bo68
    s_waitcnt vmcnt(2)
L_bo68:
    buffer_load_dwordx4 v[232:235], v1, s[40:43], s98 offen offset:2048 nt
    s_waitcnt vmcnt(3)
    s_cmp_ge_u32 s48, 24
    s_cbranch_scc1 L_bo69
    s_waitcnt vmcnt(2)
L_bo69:
    buffer_load_dwordx4 v[236:239], v1, s[40:43], s98 offen offset:3072 nt
    s_waitcnt vmcnt(3)
    s_cmp_ge_u32 s48, 24
    s_cbranch_scc1 L_bo70
    s_waitcnt vmcnt(2)
L_bo70:
    s_addk_i32 s98, 28672
    buffer_load_dwordx4 v[240:243], v1, s[40:43], s98 offen offset:0 nt
    v_mov_b32 v3, 57
    v_mov_b32 v14, 99072
    s_mov_b64 exec, 1
    ds_write_b32 v14, v3
    s_mov_b64 exec, -1
    s_waitcnt vmcnt(3)
    s_cmp_ge_u32 s48, 25
    s_cbranch_scc1 L_bo71
    s_waitcnt vmcnt(2)
L_bo71:
    buffer_load_dwordx4 v[244:247], v1, s[40:43], s98 offen offset:1024 nt
    s_waitcnt vmcnt(3)
    s_cmp_ge_u32 s48, 26
    s_cbranch_scc1 L_bo72
    s_waitcnt vmcnt(2)
L_bo72:
    buffer_load_dwordx4 v[248:251], v1, s[40:43], s98 offen offset:2048 nt
    s_waitcnt vmcnt(3)
    s_cmp_ge_u32 s48, 27
    s_cbranch_scc1 L_bo73
    s_waitcnt vmcnt(2)
L_bo73:
    buffer_load_dwordx4 v[252:255], v1, s[40:43], s98 offen offset:3072 nt
    v_mov_b32 v14, 99080
    s_mov_b32 s35, 0
L_poll74:
    ds_read_b128 v[4:7], v2
    ds_read_b32 v8, v14
    s_add_u32 s35, s35, 1
    s_waitcnt lgkmcnt(0)
    v_max3_u32 v3, v4, v5, v6
    v_max_u32 v3, v3, v7
    v_cmp_eq_u32 vcc, -1, v3
    s_cbranch_vccz L_done75
    s_sleep 2
    s_cmp_lt_u32 s35, 60000
    s_cbranch_scc1 L_poll74
L_done75:
    v_readfirstlane_b32 s99, v8
    v_dot2_f32_bf16 v8, v16, v4, 0
    v_dot2_f32_bf16 v9, v20, v4, 0
    v_dot2_f32_bf16 v10, v24, v4, 0
    v_dot2_f32_bf16 v11, v28, v4, 0
    v_dot2c_f32_bf16 v8, v17, v5
    v_dot2c_f32_bf16 v9, v21, v5
    v_dot2c_f32_bf16 v10, v25, v5
    v_dot2c_f32_bf16 v11, v29, v5
    v_dot2c_f32_bf16 v8, v18, v6
    v_dot2c_f32_bf16 v9, v22, v6
    v_dot2c_f32_bf16 v10, v26, v6
    v_dot2c_f32_bf16 v11, v30, v6
    v_dot2c_f32_bf16 v8, v19, v7
    v_dot2c_f32_bf16 v9, v23, v7
    v_dot2c_f32_bf16 v10, v27, v7
    v_dot2c_f32_bf16 v11, v31, v7
    v_add_f32_dpp v12, v8, v8 row_ror:8 row_mask:0xf bank_mask:0x3
    v_add_f32_dpp v12, v9, v9 row_ror:8 row_mask:0xf bank_mask:0xc
    v_add_f32_dpp v13, v10, v10 row_ror:8 row_mask:0xf bank_mask:0x3
    v_add_f32_dpp v13, v11, v11 row_ror:8 row_mask:0xf bank_mask:0xc
    v_dot2_f32_bf16 v8, v32, v4, 0
    v_dot2_f32_bf16 v9, v36, v4, 0
    v_dot2_f32_bf16 v10, v40, v4, 0
    v_dot2_f32_bf16 v11, v44, v4, 0
    v_add_f32_dpp v12, v12, v12 row_half_mirror row_mask:0xf bank_mask:0xf
    v_add_f32_dpp v13, v13, v13 row_half_mirror row_mask:0xf bank_mask:0xf
    v_dot2c_f32_bf16 v8, v33, v5
    v_dot2c_f32_bf16 v9, v37, v5
    v_dot2c_f32_bf16 v10, v41, v5
    v_dot2c_f32_bf16 v11, v45, v5
    v_add_f32_dpp v12, v12, v12 quad_perm:[1,0,3,2] row_mask:0xf bank_mask:0xf
    v_add_f32_dpp v13, v13, v13 quad_perm:[1,0,3,2] row_mask:0xf bank_mask:0xf
    v_dot2c_f32_bf16 v8, v34, v6
    v_dot2c_f32_bf16 v9, v38, v6
    v_dot2c_f32_bf16 v10, v42, v6
    v_dot2c_f32_bf16 v11, v46, v6
    v_add_f32_dpp v12, v12, v12 quad_perm:[2,3,0,1] row_mask:0xf bank_mask:0xf
    v_add_f32_dpp v13, v13, v13 quad_perm:[2,3,0,1] row_mask:0xf bank_mask:0xf
    v_dot2c_f32_bf16 v8, v35, v7
    v_dot2c_f32_bf16 v9, v39, v7
    v_dot2c_f32_bf16 v10, v43, v7
    v_dot2c_f32_bf16 v11, v47, v7
    s_waitcnt vmcnt(3)
    s_cmp_ge_u32 s48, 27
    s_cbranch_scc1 L_bo77
    s_waitcnt vmcnt(2)
L_bo77:
    s_addk_i32 s98, 28672
    buffer_load_dwordx4 v[32:35], v1, s[40:43], s98 offen offset:0 nt
    v_add_f32_dpp v16, v8, v8 row_ror:8 row_mask:0xf bank_mask:0x3
    v_add_f32_dpp v16, v9, v9 row_ror:8 row_mask:0xf bank_mask:0xc
    v_add_f32_dpp v17, v10, v10 row_ror:8 row_mask:0xf bank_mask:0x3
    v_add_f32_dpp v17, v11, v11 row_ror:8 row_mask:0xf bank_mask:0xc
    v_dot2_f32_bf16 v8, v48, v4, 0
    v_dot2_f32_bf16 v9, v52, v4, 0
    v_dot2_f32_bf16 v10, v56, v4, 0
    v_dot2_f32_bf16 v11, v60, v4, 0
    v_add_f32_dpp v16, v16, v16 row_half_mirror row_mask:0xf bank_mask:0xf
    v_add_f32_dpp v17, v17, v17 row_half_mirror row_mask:0xf bank_mask:0xf
    v_dot2c_f32_bf16 v8, v49, v5
    v_dot2c_f32_bf16 v9, v53, v5
    v_dot2c_f32_bf16 v10, v57, v5
    v_dot2c_f32_bf16 v11, v61, v5
    v_add_f32_dpp v16, v16, v16 quad_perm:[1,0,3,2] row_mask:0xf bank_mask:0xf
    v_add_f32_dpp v17, v17, v17 quad_perm:[1,0,3,2] row_mask:0xf bank_mask:0xf
    v_dot2c_f32_bf16 v8, v50, v6
    v_dot2c_f32_bf16 v9, v54, v6
    v_dot2c_f32_bf16 v10, v58, v6
    v_dot2c_f32_bf16 v11, v62, v6
    v_add_f32_dpp v16, v16, v16 quad_perm:[2,3,0,1] row_mask:0xf bank_mask:0xf
    v_add_f32_dpp v17, v17, v17 quad_perm:[2,3,0,1] row_mask:0xf bank_mask:0xf
    v_dot2c_f32_bf16 v8, v51, v7
    v_dot2c_f32_bf16 v9, v55, v7
    v_dot2c_f32_bf16 v10, v59, v7
    v_dot2c_f32_bf16 v11, v63, v7
    v_add_f32_dpp v18, v8, v8 row_ror:8 row_mask:0xf bank_mask:0x3
    v_add_f32_dpp v18, v9, v9 row_ror:8 row_mask:0xf bank_mask:0xc
    v_add_f32_dpp v19, v10, v10 row_ror:8 row_mask:0xf bank_mask:0x3
    v_add_f32_dpp v19, v11, v11 row_ror:8 row_mask:0xf bank_mask:0xc
    v_dot2_f32_bf16 v8, v64, v4, 0
    v_dot2_f32_bf16 v9, v68, v4, 0
    v_dot2_f32_bf16 v10, v72, v4, 0
    v_dot2_f32_bf16 v11, v76, v4, 0
    v_add_f32_dpp v18, v18, v18 row_half_mirror row_mask:0xf bank_mask:0xf
    v_add_f32_dpp v19, v19, v19 row_half_mirror row_mask:0xf bank_mask:0xf
    v_dot2c_f32_bf16 v8, v65, v5
    v_dot2c_f32_bf16 v9, v69, v5
    v_dot2c_f32_bf16 v10, v73, v5
    v_dot2c_f32_bf16 v11, v77, v5
    v_add_f32_dpp v18, v18, v18 quad_perm:[1,0,3,2] row_mask:0xf bank_mask:0xf
    v_add_f32_dpp v19, v19, v19 quad_perm:[1,0,3,2] row_mask:0xf bank_mask:0xf
    v_dot2c_f32_bf16 v8, v66, v6
    v_dot2c_f32_bf16 v9, v70, v6
    v_mov_b32 v3, 99076
    ds_read_b32 v3, v3
    s_waitcnt vmcnt(3)
    s_cmp_ge_u32 s48, 28
    s_cbranch_scc1 L_bo78
    s_waitcnt vmcnt(2)
L_bo78:
    s_waitcnt lgkmcnt(0)
    v_readfirstlane_b32 s48, v3
    buffer_load_dwordx4 v[36:39], v1, s[40:43], s98 offen offset:1024 nt
    v_dot2c_f32_bf16 v10, v74, v6
    v_dot2c_f32_bf16 v11, v78, v6
    v_add_f32_dpp v18, v18, v18 quad_perm:[2,3,0,1] row_mask:0xf bank_mask:0xf
    v_add_f32_dpp v19, v19, v19 quad_perm:[2,3,0,1] row_mask:0xf bank_mask:0xf
    v_dot2c_f32_bf16 v8, v67, v7
    v_dot2c_f32_bf16 v9, v71, v7
    v_dot2c_f32_bf16 v10, v75, v7
    v_dot2c_f32_bf16 v11, v79, v7
    v_add_f32_dpp v20, v8, v8 row_ror:8 row_mask:0xf bank_mask:0x3
    v_add_f32_dpp v20, v9, v9 row_ror:8 row_mask:0xf bank_mask:0xc
    v_add_f32_dpp v21, v10, v10 row_ror:8 row_mask:0xf bank_mask:0x3
    v_add_f32_dpp v21, v11, v11 row_ror:8 row_mask:0xf bank_mask:0xc
    v_dot2_f32_bf16 v8, v80, v4, 0
    v_dot2_f32_bf16 v9, v84, v4, 0
    v_dot2_f32_bf16 v10, v88, v4, 0
    v_dot2_f32_bf16 v11, v92, v4, 0
    v_add_f32_dpp v20, v20, v20 row_half_mirror row_mask:0xf bank_mask:0xf
    v_add_f32_dpp v21, v21, v21 row_half_mirror row_mask:0xf bank_mask:0xf
    v_dot2c_f32_bf16 v8, v81, v5
    v_dot2c_f32_bf16 v9, v85, v5
    v_dot2c_f32_bf16 v10, v89, v5
    v_dot2c_f32_bf16 v11, v93, v5
    v_add_f32_dpp v20, v20, v20 quad_perm:[1,0,3,2] row_mask:0xf bank_mask:0xf
    v_add_f32_dpp v21, v21, v21 quad_perm:[1,0,3,2] row_mask:0xf bank_mask:0xf
    v_dot2c_f32_bf16 v8, v82, v6
    v_dot2c_f32_bf16 v9, v86, v6
    v_dot2c_f32_bf16 v10, v90, v6
    v_dot2c_f32_bf16 v11, v94, v6
    v_add_f32_dpp v20, v20, v20 quad_perm:[2,3,0,1] row_mask:0xf bank_mask:0xf
    v_add_f32_dpp v21, v21, v21 quad_perm:[2,3,0,1] row_mask:0xf bank_mask:0xf
    v_dot2c_f32_bf16 v8, v83, v7
    v_dot2c_f32_bf16 v9, v87, v7
    v_dot2c_f32_bf16 v10, v91, v7
    v_dot2c_f32_bf16 v11, v95, v7
    v_add_f32_dpp v22, v8, v8 row_ror:8 row_mask:0xf bank_mask:0x3
    v_add_f32_dpp v22, v9, v9 row_ror:8 row_mask:0xf bank_mask:0xc
    v_add_f32_dpp v23, v10, v10 row_ror:8 row_mask:0xf bank_mask:0x3
    v_add_f32_dpp v23, v11, v11 row_ror:8 row_mask:0xf bank_mask:0xc
    v_dot2_f32_bf16 v8, v96, v4, 0
    v_dot2_f32_bf16 v9, v100, v4, 0
    v_dot2_f32_bf16 v10, v104, v4, 0
    v_dot2_f32_bf16 v11, v108, v4, 0
    v_add_f32_dpp v22, v22, v22 row_half_mirror row_mask:0xf bank_mask:0xf
    v_add_f32_dpp v23, v23, v23 row_half_mirror row_mask:0xf bank_mask:0xf
    s_waitcnt vmcnt(3)
    s_cmp_ge_u32 s48, 16
    s_cbranch_scc1 L_bo79
    s_waitcnt vmcnt(2)
L_bo79:
    buffer_load_dwordx4 v[40:43], v1, s[40:43], s98 offen offset:2048 nt
    v_dot2c_f32_bf16 v8, v97, v5
    v_dot2c_f32_bf16 v9, v101, v5
    v_dot2c_f32_bf16 v10, v105, v5
    v_dot2c_f32_bf16 v11, v109, v5
    v_add_f32_dpp v22, v22, v22 quad_perm:[1,0,3,2] row_mask:0xf bank_mask:0xf
    v_add_f32_dpp v23, v23, v23 quad_perm:[1,0,3,2] row_mask:0xf bank_mask:0xf
    v_dot2c_f32_bf16 v8, v98, v6
    v_dot2c_f32_bf16 v9, v102, v6
    v_dot2c_f32_bf16 v10, v106, v6
    v_dot2c_f32_bf16 v11, v110, v6
    v_add_f32_dpp v22, v22, v22 quad_perm:[2,3,0,1] row_mask:0xf bank_mask:0xf
    v_add_f32_dpp v23, v23, v23 quad_perm:[2,3,0,1] row_mask:0xf bank_mask:0xf
    v_dot2c_f32_bf16 v8, v99, v7
    v_dot2c_f32_bf16 v9, v103, v7
    v_dot2c_f32_bf16 v10, v107, v7
    v_dot2c_f32_bf16 v11, v111, v7
    v_add_f32_dpp v24, v8, v8 row_ror:8 row_mask:0xf bank_mask:0x3
    v_add_f32_dpp v24, v9, v9 row_ror:8 row_mask:0xf bank_mask:0xc
    v_add_f32_dpp v25, v10, v10 row_ror:8 row_mask:0xf bank_mask:0x3
    v_add_f32_dpp v25, v11, v11 row_ror:8 row_mask:0xf bank_mask:0xc
    v_dot2_f32_bf16 v8, v112, v4, 0
    v_dot2_f32_bf16 v9, v116, v4, 0
    v_dot2_f32_bf16 v10, v120, v4, 0
    v_dot2_f32_bf16 v11, v124, v4, 0
    v_add_f32_dpp v24, v24, v24 row_half_mirror row_mask:0xf bank_mask:0xf
    v_add_f32_dpp v25, v25, v25 row_half_mirror row_mask:0xf bank_mask:0xf
    v_dot2c_f32_bf16 v8, v113, v5
    v_dot2c_f32_bf16 v9, v117, v5
    v_dot2c_f32_bf16 v10, v121, v5
    v_dot2c_f32_bf16 v11, v125, v5
    v_add_f32_dpp v24, v24, v24 quad_perm:[1,0,3,2] row_mask:0xf bank_mask:0xf
    v_add_f32_dpp v25, v25, v25 quad_perm:[1,0,3,2] row_mask:0xf bank_mask:0xf
    v_dot2c_f32_bf16 v8, v114, v6
    v_dot2c_f32_bf16 v9, v118, v6
    v_dot2c_f32_bf16 v10, v122, v6
    v_dot2c_f32_bf16 v11, v126, v6
    v_add_f32_dpp v24, v24, v24 quad_perm:[2,3,0,1] row_mask:0xf bank_mask:0xf
    v_add_f32_dpp v25, v25, v25 quad_perm:[2,3,0,1] row_mask:0xf bank_mask:0xf
    v_dot2c_f32_bf16 v8, v115, v7
    v_dot2c_f32_bf16 v9, v119, v7
    v_dot2c_f32_bf16 v10, v123, v7
    v_dot2c_f32_bf16 v11, v127, v7
    v_add_f32_dpp v26, v8, v8 row_ror:8 row_mask:0xf bank_mask:0x3
    v_add_f32_dpp v26, v9, v9 row_ror:8 row_mask:0xf bank_mask:0xc
    s_waitcnt vmcnt(3)
    s_cmp_ge_u32 s48, 17
    s_cbranch_scc1 L_bo80
    s_waitcnt vmcnt(2)
L_bo80:
    buffer_load_dwordx4 v[44:47], v1, s[40:43], s98 offen offset:3072 nt
    v_add_f32_dpp v27, v10, v10 row_ror:8 row_mask:0xf bank_mask:0x3
    v_add_f32_dpp v27, v11, v11 row_ror:8 row_mask:0xf bank_mask:0xc
    v_dot2_f32_bf16 v8, v128, v4, 0
    v_dot2_f32_bf16 v9, v132, v4, 0
    v_dot2_f32_bf16 v10, v136, v4, 0
    v_dot2_f32_bf16 v11, v140, v4, 0
    v_add_f32_dpp v26, v26, v26 row_half_mirror row_mask:0xf bank_mask:0xf
    v_add_f32_dpp v27, v27, v27 row_half_mirror row_mask:0xf bank_mask:0xf
    v_dot2c_f32_bf16 v8, v129, v5
    v_dot2c_f32_bf16 v9, v133, v5
    v_dot2c_f32_bf16 v10, v137, v5
    v_dot2c_f32_bf16 v11, v141, v5
    v_add_f32_dpp v26, v26, v26 quad_perm:[1,0,3,2] row_mask:0xf bank_mask:0xf
    v_add_f32_dpp v27, v27, v27 quad_perm:[1,0,3,2] row_mask:0xf bank_mask:0xf
    v_dot2c_f32_bf16 v8, v130, v6
    v_dot2c_f32_bf16 v9, v134, v6
    v_dot2c_f32_bf16 v10, v138, v6
    v_dot2c_f32_bf16 v11, v142, v6
    v_add_f32_dpp v26, v26, v26 quad_perm:[2,3,0,1] row_mask:0xf bank_mask:0xf
    v_add_f32_dpp v27, v27, v27 quad_perm:[2,3,0,1] row_mask:0xf bank_mask:0xf
    v_dot2c_f32_bf16 v8, v131, v7
    v_dot2c_f32_bf16 v9, v135, v7
    v_dot2c_f32_bf16 v10, v139, v7
    v_dot2c_f32_bf16 v11, v143, v7
    v_add_f32_dpp v28, v8, v8 row_ror:8 row_mask:0xf bank_mask:0x3
    v_add_f32_dpp v28, v9, v9 row_ror:8 row_mask:0xf bank_mask:0xc
    v_add_f32_dpp v29, v10, v10 row_ror:8 row_mask:0xf bank_mask:0x3
    v_add_f32_dpp v29, v11, v11 row_ror:8 row_mask:0xf bank_mask:0xc
    v_dot2_f32_bf16 v8, v144, v4, 0
    v_dot2_f32_bf16 v9, v148, v4, 0
    v_dot2_f32_bf16 v10, v152, v4, 0
    v_dot2_f32_bf16 v11, v156, v4, 0
    v_add_f32_dpp v28, v28, v28 row_half_mirror row_mask:0xf bank_mask:0xf
    v_add_f32_dpp v29, v29, v29 row_half_mirror row_mask:0xf bank_mask:0xf
    v_dot2c_f32_bf16 v8, v145, v5
    v_dot2c_f32_bf16 v9, v149, v5
    v_dot2c_f32_bf16 v10, v153, v5
    v_dot2c_f32_bf16 v11, v157, v5
    v_add_f32_dpp v28, v28, v28 quad_perm:[1,0,3,2] row_mask:0xf bank_mask:0xf
    v_add_f32_dpp v29, v29, v29 quad_perm:[1,0,3,2] row_mask:0xf bank_mask:0xf
    v_dot2c_f32_bf16 v8, v146, v6
    v_dot2c_f32_bf16 v9, v150, v6
    v_dot2c_f32_bf16 v10, v154, v6
    v_dot2c_f32_bf16 v11, v158, v6
    s_waitcnt vmcnt(3)
    s_cmp_ge_u32 s48, 19
    s_cbranch_scc1 L_bo81
    s_waitcnt vmcnt(2)
L_bo81:
    s_addk_i32 s98, 28672
    s_cmp_eq_u32 s98, 258048
    s_cselect_b32 s98, 0, s98
    buffer_load_dwordx4 v[48:51], v1, s[40:43], s98 offen offset:0 nt
    v_add_f32_dpp v28, v28, v28 quad_perm:[2,3,0,1] row_mask:0xf bank_mask:0xf
    v_add_f32_dpp v29, v29, v29 quad_perm:[2,3,0,1] row_mask:0xf bank_mask:0xf
    v_dot2c_f32_bf16 v8, v147, v7
    v_dot2c_f32_bf16 v9, v151, v7
    v_dot2c_f32_bf16 v10, v155, v7
    v_dot2c_f32_bf16 v11, v159, v7
    v_add_f32_dpp v30, v8, v8 row_ror:8 row_mask:0xf bank_mask:0x3
    v_add_f32_dpp v30, v9, v9 row_ror:8 row_mask:0xf bank_mask:0xc
    v_add_f32_dpp v31, v10, v10 row_ror:8 row_mask:0xf bank_mask:0x3
    v_add_f32_dpp v31, v11, v11 row_ror:8 row_mask:0xf bank_mask:0xc
    v_add_f32_dpp v30, v30, v30 row_half_mirror row_mask:0xf bank_mask:0xf
    s_nop 0
    v_add_f32_dpp v31, v31, v31 row_half_mirror row_mask:0xf bank_mask:0xf
    v_add_f32_dpp v30, v30, v30 quad_perm:[1,0,3,2] row_mask:0xf bank_mask:0xf
    s_nop 0
    v_add_f32_dpp v31, v31, v31 quad_perm:[1,0,3,2] row_mask:0xf bank_mask:0xf
    v_add_f32_dpp v30, v30, v30 quad_perm:[2,3,0,1] row_mask:0xf bank_mask:0xf
    s_nop 0
    v_add_f32_dpp v31, v31, v31 quad_perm:[2,3,0,1] row_mask:0xf bank_mask:0xf
    v_max3_f32 v8, v12, v13, v16
    v_max3_f32 v8, v8, v17, v18
    v_max3_f32 v8, v8, v19, v20
    v_max3_f32 v8, v8, v21, v22
    v_max3_f32 v8, v8, v23, v24
    v_max3_f32 v8, v8, v25, v26
    v_max3_f32 v8, v8, v27, v28
    v_max3_f32 v8, v8, v29, v30
    v_max_f32 v8, v8, v31
    s_mov_b32 s34, 0x3e0293ee
    s_nop 0
    v_max_f32_dpp v8, v8, v8 row_ror:8 row_mask:0xf bank_mask:0xf
    v_mov_b32 v9, v8
    s_nop 1
    v_permlane16_swap_b32 v8, v9
    v_max_f32 v8, v8, v9
    v_mov_b32 v9, v8
    s_nop 1
    v_permlane32_swap_b32 v8, v9
    v_max_f32 v8, v8, v9
    v_mul_f32 v8, s34, v8
    v_fma_f32 v12, v12, s34, -v8
    v_fma_f32 v13, v13, s34, -v8
    v_fma_f32 v16, v16, s34, -v8
    v_fma_f32 v17, v17, s34, -v8
    v_fma_f32 v18, v18, s34, -v8
    v_fma_f32 v19, v19, s34, -v8
    v_fma_f32 v20, v20, s34, -v8
    v_fma_f32 v21, v21, s34, -v8
    v_fma_f32 v22, v22, s34, -v8
    v_fma_f32 v23, v23, s34, -v8
    s_waitcnt vmcnt(3)
    s_cmp_ge_u32 s48, 20
    s_cbranch_scc1 L_bo82
    s_waitcnt vmcnt(2)
L_bo82:
    buffer_load_dwordx4 v[52:55], v1, s[40:43], s98 offen offset:1024 nt
    v_fma_f32 v24, v24, s34, -v8
    v_fma_f32 v25, v25, s34, -v8
    v_fma_f32 v26, v26, s34, -v8
    v_fma_f32 v27, v27, s34, -v8
    v_fma_f32 v28, v28, s34, -v8
    v_fma_f32 v29, v29, s34, -v8
    v_fma_f32 v30, v30, s34, -v8
    v_fma_f32 v31, v31, s34, -v8
    v_exp_f32 v12, v12
    v_exp_f32 v13, v13
    v_exp_f32 v16, v16
    v_exp_f32 v17, v17
    v_exp_f32 v18, v18
    v_exp_f32 v19, v19
    v_exp_f32 v20, v20
    v_exp_f32 v21, v21
    v_exp_f32 v22, v22
    v_exp_f32 v23, v23
    v_exp_f32 v24, v24
    v_exp_f32 v25, v25
    v_exp_f32 v26, v26
    v_exp_f32 v27, v27
    v_exp_f32 v28, v28
    v_exp_f32 v29, v29
    v_exp_f32 v30, v30
    v_exp_f32 v31, v31
    v_add_f32 v9, v12, v13
    v_add_f32 v9, v9, v16
    v_add_f32 v9, v9, v17
    v_add_f32 v9, v9, v18
    v_add_f32 v9, v9, v19
    v_add_f32 v9, v9, v20
    v_add_f32 v9, v9, v21
    v_add_f32 v9, v9, v22
    v_add_f32 v9, v9, v23
    v_add_f32 v9, v9, v24
    v_add_f32 v9, v9, v25
    v_add_f32 v9, v9, v26
    v_add_f32 v9, v9, v27
    v_add_f32 v9, v9, v28
    v_add_f32 v9, v9, v29
    v_add_f32 v9, v9, v30
    v_add_f32 v9, v9, v31
    v_and_b32 v10, 1, v0
    s_cmp_ge_u32 s48, 21
    s_cbranch_scc1 L_bo83
    s_waitcnt vmcnt(3)
L_bo83:
    buffer_load_dwordx4 v[56:59], v1, s[40:43], s98 offen offset:2048 nt
    v_lshlrev_b32 v10, 4, v10
    v_mov_b32 v11, 0xffff
    v_lshlrev_b32 v10, v10, v11
    v_bfe_u32 v11, v0, 1, 2
    v_cmp_eq_u32 vcc, 0, v11
    s_nop 1
    v_cndmask_b32 v144, 0, v10, vcc
    v_cmp_eq_u32 vcc, 1, v11
    s_nop 1
    v_cndmask_b32 v145, 0, v10, vcc
    v_cmp_eq_u32 vcc, 2, v11
    s_nop 1
    v_cndmask_b32 v146, 0, v10, vcc
    v_cmp_eq_u32 vcc, 3, v11
    s_nop 1
    v_cndmask_b32 v147, 0, v10, vcc
    v_add_f32_dpp v9, v9, v9 row_ror:8 row_mask:0xf bank_mask:0xf
    v_mov_b32 v10, v9
    s_nop 1
    v_permlane16_swap_b32 v9, v10
    v_add_f32 v9, v9, v10
    v_mov_b32 v10, v9
    s_nop 1
    v_permlane32_swap_b32 v9, v10
    v_add_f32 v9, v9, v10
    s_lshl_b32 s34, s3, 3
    s_add_u32 s34, s34, 98552
    v_mov_b32 v10, s34
    s_mov_b64 exec, 1
    ds_write_b64 v10, v[8:9]
    s_mov_b64 exec, -1
    s_lshl_b32 s34, s3, 10
    s_add_u32 s34, s34, 98304
    v_lshrrev_b32 v2, 4, v0
    v_and_b32 v11, 7, v0
    v_lshl_add_u32 v2, v2, 3, v11
    v_bfe_u32 v11, v0, 3, 1
    v_lshl_add_u32 v2, v11, 5, v2
    v_lshl_add_u32 v2, v2, 4, s34
    v_cvt_pk_bf16_f32 v10, v12, v12
    v_and_b32 v128, v10, v144
    v_and_b32 v129, v10, v145
    v_and_b32 v130, v10, v146
    v_and_b32 v131, v10, v147
    s_nop 1
    v_mfma_f32_16x16x32_bf16 v[148:151], v[160:163], v[128:131], 0
    v_mfma_f32_16x16x32_bf16 v[152:155], v[164:167], v[128:131], 0
    v_cvt_pk_bf16_f32 v10, v13, v13
    v_and_b32 v132, v10, v144
    v_and_b32 v133, v10, v145
    v_and_b32 v134, v10, v146
    v_and_b32 v135, v10, v147
    s_nop 1
    v_mfma_f32_16x16x32_bf16 v[148:151], v[168:171], v[132:135], v[148:151]
    s_waitcnt vmcnt(4)
    s_cmp_ge_u32 s48, 22
    s_cbranch_scc1 L_bo84
    s_waitcnt vmcnt(3)
L_bo84:
    buffer_load_dwordx4 v[60:63], v1, s[40:43], s98 offen offset:3072 nt
    v_mfma_f32_16x16x32_bf16 v[152:155], v[172:175], v[132:135], v[152:155]
    v_cvt_pk_bf16_f32 v10, v16, v16
    v_and_b32 v128, v10, v144
    v_and_b32 v129, v10, v145
    v_and_b32 v130, v10, v146
    v_and_b32 v131, v10, v147
    s_nop 1
    v_mfma_f32_16x16x32_bf16 v[148:151], v[176:179], v[128:131], v[148:151]
    v_mfma_f32_16x16x32_bf16 v[152:155], v[180:183], v[128:131], v[152:155]
    v_cvt_pk_bf16_f32 v10, v17, v17
    v_and_b32 v132, v10, v144
    v_and_b32 v133, v10, v145
    v_and_b32 v134, v10, v146
    v_and_b32 v135, v10, v147
    s_nop 1
    v_mfma_f32_16x16x32_bf16 v[148:151], v[184:187], v[132:135], v[148:151]
    v_mfma_f32_16x16x32_bf16 v[152:155], v[188:191], v[132:135], v[152:155]
    v_cvt_pk_bf16_f32 v10, v18, v18
    v_and_b32 v128, v10, v144
    v_and_b32 v129, v10, v145
    v_and_b32 v130, v10, v146
    v_and_b32 v131, v10, v147
    s_nop 1
    v_mfma_f32_16x16x32_bf16 v[148:151], v[192:195], v[128:131], v[148:151]
    v_mfma_f32_16x16x32_bf16 v[152:155], v[196:199], v[128:131], v[152:155]
    v_cvt_pk_bf16_f32 v10, v19, v19
    v_and_b32 v132, v10, v144
    v_and_b32 v133, v10, v145
    v_and_b32 v134, v10, v146
    v_and_b32 v135, v10, v147
    s_nop 1
    v_mfma_f32_16x16x32_bf16 v[148:151], v[200:203], v[132:135], v[148:151]
    v_mfma_f32_16x16x32_bf16 v[152:155], v[204:207], v[132:135], v[152:155]
    v_cvt_pk_bf16_f32 v10, v20, v20
    v_and_b32 v128, v10, v144
    v_and_b32 v129, v10, v145
    v_and_b32 v130, v10, v146
    v_and_b32 v131, v10, v147
    s_nop 1
    v_mfma_f32_16x16x32_bf16 v[148:151], v[208:211], v[128:131], v[148:151]
    v_mfma_f32_16x16x32_bf16 v[152:155], v[212:215], v[128:131], v[152:155]
    v_cvt_pk_bf16_f32 v10, v21, v21
    v_and_b32 v132, v10, v144
    v_and_b32 v133, v10, v145
    v_and_b32 v134, v10, v146
    v_and_b32 v135, v10, v147
    s_nop 1
    v_mfma_f32_16x16x32_bf16 v[148:151], v[216:219], v[132:135], v[148:151]
    v_mfma_f32_16x16x32_bf16 v[152:155], v[220:223], v[132:135], v[152:155]
    v_cvt_pk_bf16_f32 v10, v22, v22
    s_waitcnt vmcnt(4)
    s_cmp_ge_u32 s48, 23
    s_cbranch_scc1 L_bo85
    s_waitcnt vmcnt(3)
L_bo85:
    s_addk_i32 s98, 28672
    buffer_load_dwordx4 v[64:67], v1, s[40:43], s98 offen offset:0 nt
    v_and_b32 v128, v10, v144
    v_and_b32 v129, v10, v145
    v_and_b32 v130, v10, v146
    v_and_b32 v131, v10, v147
    s_nop 1
    v_mfma_f32_16x16x32_bf16 v[148:151], v[224:227], v[128:131], v[148:151]
    v_mfma_f32_16x16x32_bf16 v[152:155], v[228:231], v[128:131], v[152:155]
    v_cvt_pk_bf16_f32 v10, v23, v23
    v_and_b32 v132, v10, v144
    v_and_b32 v133, v10, v145
    v_and_b32 v134, v10, v146
    v_and_b32 v135, v10, v147
    s_nop 1
    v_mfma_f32_16x16x32_bf16 v[148:151], v[232:235], v[132:135], v[148:151]
    v_mfma_f32_16x16x32_bf16 v[152:155], v[236:239], v[132:135], v[152:155]
    v_cvt_pk_bf16_f32 v10, v24, v24
    v_and_b32 v128, v10, v144
    v_and_b32 v129, v10, v145
    v_and_b32 v130, v10, v146
    v_and_b32 v131, v10, v147
    s_nop 1
    v_mfma_f32_16x16x32_bf16 v[148:151], v[240:243], v[128:131], v[148:151]
    v_mfma_f32_16x16x32_bf16 v[152:155], v[244:247], v[128:131], v[152:155]
    v_cvt_pk_bf16_f32 v10, v25, v25
    v_and_b32 v132, v10, v144
    v_and_b32 v133, v10, v145
    v_and_b32 v134, v10, v146
    v_and_b32 v135, v10, v147
    s_nop 1
    v_mfma_f32_16x16x32_bf16 v[148:151], v[248:251], v[132:135], v[148:151]
    v_mfma_f32_16x16x32_bf16 v[152:155], v[252:255], v[132:135], v[152:155]
    v_cvt_pk_bf16_f32 v10, v26, v26
    v_and_b32 v128, v10, v144
    v_and_b32 v129, v10, v145
    v_and_b32 v130, v10, v146
    v_and_b32 v131, v10, v147
    s_nop 1
    v_mfma_f32_16x16x32_bf16 v[148:151], v[32:35], v[128:131], v[148:151]
    v_mfma_f32_16x16x32_bf16 v[152:155], v[36:39], v[128:131], v[152:155]
    v_cvt_pk_bf16_f32 v10, v27, v27
    v_and_b32 v132, v10, v144
    v_and_b32 v133, v10, v145
    v_and_b32 v134, v10, v146
    v_and_b32 v135, v10, v147
    s_nop 1
    v_mfma_f32_16x16x32_bf16 v[148:151], v[40:43], v[132:135], v[148:151]
    v_mfma_f32_16x16x32_bf16 v[152:155], v[44:47], v[132:135], v[152:155]
    v_cvt_pk_bf16_f32 v10, v28, v28
    v_and_b32 v128, v10, v144
    v_and_b32 v129, v10, v145
    s_waitcnt vmcnt(4)
    s_cmp_ge_u32 s48, 24
    s_cbranch_scc1 L_bo86
    s_waitcnt vmcnt(3)
L_bo86:
    buffer_load_dwordx4 v[68:71], v1, s[40:43], s98 offen offset:1024 nt
    v_and_b32 v130, v10, v146
    v_and_b32 v131, v10, v147
    buffer_load_dwordx4 v[72:75], v1, s[40:43], s98 offen offset:2048 nt
    s_waitcnt vmcnt(5)
    buffer_load_dwordx4 v[76:79], v1, s[40:43], s98 offen offset:3072 nt
    s_barrier
    v_and_b32 v200, 3, v0
    v_bfe_u32 v201, v0, 2, 2
    v_lshrrev_b32 v202, 4, v0
    s_lshl_b32 s34, s3, 10
    s_add_u32 s34, s34, 122112
    v_mul_u32_u24 v203, 320, v201
    v_min_u32 v203, 704, v203
    v_lshl_add_u32 v203, v202, 6, v203
    v_lshl_add_u32 v203, v200, 4, v203
    v_add_u32 v203, s34, v203
    s_movk_i32 s48, 16384
    s_cmp_eq_u32 s63, 0
    s_cbranch_scc1 L_tp_wo
    s_cmp_eq_u32 s63, 1
    s_cbranch_scc1 L_tp_w1
    v_bfe_u32 v205, v0, 3, 2
    v_lshlrev_b32 v204, 3, v205
    v_lshrrev_b32 v205, 5, v0
    v_lshl_add_u32 v204, v205, 2, v204
    v_bfe_u32 v205, v0, 1, 2
    v_add_u32 v204, v204, v205
    v_and_b32 v205, 1, v0
    s_sub_u32 s49, s3, 1
    v_mul_u32_u24 v204, 1280, v204
    v_lshl_add_u32 v204, v205, 4, v204
    s_lshl_b32 s34, s62, 5
    s_mul_i32 s35, s49, 327680
    s_add_u32 s34, s34, s35
    v_add_u32 v204, s34, v204
    s_lshl_b32 s50, s49, 13
    s_add_u32 s50, s50, 40960
    v_lshl_add_u32 v205, v0, 3, s50
    s_lshl_b32 s34, s49, 8
    s_add_u32 s34, s34, s99
    s_and_b32 s35, s60, 1
    s_mul_i32 s35, s35, 917504
    s_add_u32 s34, s34, s35
    s_add_u32 s34, s34, 791552
    s_cmp_eq_u32 s49, 6
    s_cselect_b32 s35, 1, 3
    v_lshlrev_b32 v6, 6, v202
    v_lshl_add_u32 v6, v200, 4, v6
    v_add_u32 v6, s34, v6
    v_lshl_add_u32 v4, v201, 15, v6
    v_min_u32 v5, s35, v201
    v_lshl_add_u32 v5, v5, 15, v6
    v_mov_b32 v7, 99084
    s_lshl_b32 s40, s62, 1
    s_add_u32 s41, s40, 8
    s_add_u32 s42, s40, 2
    s_branch L_tp_e
L_tp_w1:
    v_and_b32 v205, 15, v0
    v_lshlrev_b32 v205, 4, v205
    s_and_b32 s49, s3, 3
    s_mul_i32 s34, s49, 1280
    s_add_u32 s34, s34, s99
    s_add_u32 s34, s34, 786432
    v_lshl_add_u32 v206, v202, 15, v205
    v_add_u32 v206, s34, v206
    s_mul_i32 s34, s49, 3840
    v_add_u32 v205, s34, v205
    s_branch L_tp_e
L_tp_wo:
    s_lshr_b32 s49, s3, 1
    s_lshl_b32 s49, s49, 15
    v_and_b32 v210, 7, v0
    s_mul_i32 s34, s60, 4096
    s_add_u32 s34, s34, s49
    s_add_u32 s34, s34, 1179904
    v_lshrrev_b32 v211, 3, v0
    v_mul_u32_u24 v205, 512, v211
    v_add_u32 v204, s34, v205
    s_lshl_b32 s35, s51, 7
    s_add_u32 s34, s34, s35
    s_sub_u32 s34, s34, 256
    v_lshl_add_u32 v205, v210, 4, v205
    v_add_u32 v205, s34, v205
    s_lshl_b32 s34, s3, 12
    s_add_u32 s34, s34, 40960
    v_lshrrev_b32 v206, 2, v0
    v_lshlrev_b32 v206, 6, v206
    v_lshl_add_u32 v206, v200, 3, v206
    v_add_u32 v206, s34, v206
    s_mul_i32 s34, s3, 1152
    s_add_u32 s34, s34, 107520
    v_mul_u32_u24 v207, 144, v211
    v_lshl_add_u32 v207, v210, 4, v207
    v_add_u32 v207, s34, v207
    v_mul_u32_u24 v208, 144, v210
    v_lshl_add_u32 v208, v202, 4, v208
    v_add_u32 v208, s34, v208
    v_mul_u32_u24 v212, 144, v211
    v_add_u32 v212, s34, v212
    v_mul_u32_u24 v213, 144, v210
    v_add_u32 v213, s34, v213
    v_and_b32 v211, 1, v211
    v_bfe_u32 v203, v0, 1, 2
    v_mul_u32_u24 v203, 144, v203
    v_and_b32 v214, 1, v0
    v_mul_u32_u24 v214, 576, v214
    v_lshl_add_u32 v214, v211, 6, v214
    v_lshl_add_u32 v214, v202, 4, v214
    s_add_u32 s34, s34, 14592
    v_add3_u32 v203, v203, v214, s34
    v_mov_b32 v210, 98816
    v_cmp_eq_u32 vcc, 0, v211
    s_nop 1
    v_cndmask_b32 v209, v208, v210, vcc
    v_cndmask_b32 v208, v210, v208, vcc
L_tp_e:
    v_mfma_f32_16x16x32_bf16 v[148:151], v[48:51], v[128:131], v[148:151]
    v_mfma_f32_16x16x32_bf16 v[152:155], v[52:55], v[128:131], v[152:155]
    v_cvt_pk_bf16_f32 v10, v29, v29
    v_and_b32 v132, v10, v144
    v_and_b32 v133, v10, v145
    v_and_b32 v134, v10, v146
    v_and_b32 v135, v10, v147
    s_waitcnt vmcnt(4)
    s_nop 0
    v_mfma_f32_16x16x32_bf16 v[148:151], v[56:59], v[132:135], v[148:151]
    v_mfma_f32_16x16x32_bf16 v[152:155], v[60:63], v[132:135], v[152:155]
    v_cvt_pk_bf16_f32 v10, v30, v30
    v_and_b32 v128, v10, v144
    v_and_b32 v129, v10, v145
    v_and_b32 v130, v10, v146
    v_and_b32 v131, v10, v147
    s_waitcnt vmcnt(2)
    s_nop 0
    v_mfma_f32_16x16x32_bf16 v[148:151], v[64:67], v[128:131], v[148:151]
    v_mfma_f32_16x16x32_bf16 v[152:155], v[68:71], v[128:131], v[152:155]
    v_cvt_pk_bf16_f32 v10, v31, v31
    v_and_b32 v132, v10, v144
    v_and_b32 v133, v10, v145
    v_and_b32 v134, v10, v146
    v_and_b32 v135, v10, v147
    s_waitcnt vmcnt(0)
    s_nop 0
    v_mfma_f32_16x16x32_bf16 v[148:151], v[72:75], v[132:135], v[148:151]
    v_mfma_f32_16x16x32_bf16 v[152:155], v[76:79], v[132:135], v[152:155]
    s_nop 7
    v_add_f32_dpp v148, v152, v148 row_ror:8 row_mask:0xf bank_mask:0xf
    v_add_f32_dpp v149, v153, v149 row_ror:8 row_mask:0xf bank_mask:0xf
    v_add_f32_dpp v150, v154, v150 row_ror:8 row_mask:0xf bank_mask:0xf
    v_add_f32_dpp v151, v155, v151 row_ror:8 row_mask:0xf bank_mask:0xf
    ds_write_b128 v2, v[148:151]
    s_waitcnt lgkmcnt(0)
    s_barrier
    s_cmp_eq_u32 s63, 0
    s_cbranch_scc1 L_t_wo
    s_cmp_eq_u32 s63, 2
    s_cbranch_scc1 L_t_w2
    s_cmp_eq_u32 s63, 3
    s_cbranch_scc1 L_fin
    s_barrier
L_r_w1:
    s_cmp_lt_u32 s3, 4
    s_cbranch_scc1 L_w1_ln
    s_and_b32 s49, s3, 3
    s_lshl_b32 s42, s49, 11
    s_add_u32 s42, s42, 40960
    s_bitcmp1_b32 s62, 0
    s_cbranch_scc1 L_rot1
    s_add_u32 m0, s42, 0
    s_add_u32 s34, s50, 0
    buffer_load_dwordx4 v15, s[52:55], s34 offen  lds
    s_add_u32 m0, s42, 1024
    s_add_u32 s34, s50, 884736
    buffer_load_dwordx4 v15, s[52:55], s34 offen  lds
    s_add_u32 m0, s42, 8192
    s_add_u32 s34, s50, 110592
    buffer_load_dwordx4 v15, s[52:55], s34 offen  lds
    s_add_u32 m0, s42, 9216
    s_add_u32 s34, s50, 995328
    buffer_load_dwordx4 v15, s[52:55], s34 offen  lds
    s_add_u32 m0, s42, 32768
    s_add_u32 s34, s51, 0
    buffer_load_dwordx4 v15, s[52:55], s34 offen  lds
    s_add_u32 m0, s42, 33792
    s_add_u32 s34, s51, 13824
    buffer_load_dwordx4 v15, s[52:55], s34 offen  lds
    s_add_u32 m0, s42, 16384
    s_add_u32 s34, s50, 221184
    buffer_load_dwordx4 v15, s[52:55], s34 offen  lds
    s_add_u32 m0, s42, 17408
    s_add_u32 s34, s50, 1105920
    buffer_load_dwordx4 v15, s[52:55], s34 offen  lds
    s_add_u32 m0, s42, 24576
    s_add_u32 s34, s50, 331776
    buffer_load_dwordx4 v15, s[52:55], s34 offen  lds
    s_add_u32 m0, s42, 25600
    s_add_u32 s34, s50, 1216512
    buffer_load_dwordx4 v15, s[52:55], s34 offen  lds
    s_branch L_rot2
L_rot1:
    s_add_u32 m0, s42, 16384
    s_add_u32 s34, s50, 221184
    buffer_load_dwordx4 v15, s[52:55], s34 offen  lds
    s_add_u32 m0, s42, 17408
    s_add_u32 s34, s50, 1105920
    buffer_load_dwordx4 v15, s[52:55], s34 offen  lds
    s_add_u32 m0, s42, 24576
    s_add_u32 s34, s50, 331776
    buffer_load_dwordx4 v15, s[52:55], s34 offen  lds
    s_add_u32 m0, s42, 25600
    s_add_u32 s34, s50, 1216512
    buffer_load_dwordx4 v15, s[52:55], s34 offen  lds
    s_add_u32 m0, s42, 32768
    s_add_u32 s34, s51, 0
    buffer_load_dwordx4 v15, s[52:55], s34 offen  lds
    s_add_u32 m0, s42, 33792
    s_add_u32 s34, s51, 13824
    buffer_load_dwordx4 v15, s[52:55], s34 offen  lds
    s_add_u32 m0, s42, 0
    s_add_u32 s34, s50, 0
    buffer_load_dwordx4 v15, s[52:55], s34 offen  lds
    s_add_u32 m0, s42, 1024
    s_add_u32 s34, s50, 884736
    buffer_load_dwordx4 v15, s[52:55], s34 offen  lds
    s_add_u32 m0, s42, 8192
    s_add_u32 s34, s50, 110592
    buffer_load_dwordx4 v15, s[52:55], s34 offen  lds
    s_add_u32 m0, s42, 9216
    s_add_u32 s34, s50, 995328
    buffer_load_dwordx4 v15, s[52:55], s34 offen  lds
L_rot2:
    v_lshrrev_b32 v3, 2, v0
    v_lshlrev_b32 v3, 6, v3
    v_lshl_add_u32 v3, v200, 3, v3
    v_add_u32 v3, s42, v3
    s_lshl_b32 s35, s49, 6
    s_add_u32 s35, s35, 116736
    v_mul_u32_u24 v4, 1344, v200
    v_lshl_add_u32 v4, v202, 4, v4
    v_add_u32 v4, s35, v4
    s_lshl_b32 s35, s49, 10
    s_sub_u32 s35, s35, 4096
    v_add_u32 v5, s35, v203
    v_and_b32 v6, 1, v201
    v_mul_u32_u24 v6, 5376, v6
    v_add_u32 v6, v6, v4
    v_subrev_u32 v6, 90112, v6
    v_subrev_u32 v7, 22784, v5
    s_waitcnt vmcnt(0)
    s_barrier
    ds_read_b64_tr_b16 v[32:33], v3 offset:0
    ds_read_b64_tr_b16 v[34:35], v3 offset:1024
    ds_read_b64_tr_b16 v[36:37], v3 offset:32
    ds_read_b64_tr_b16 v[38:39], v3 offset:1056
    ds_read_b64_tr_b16 v[40:41], v3 offset:8192
    ds_read_b64_tr_b16 v[42:43], v3 offset:9216
    ds_read_b64_tr_b16 v[44:45], v3 offset:8224
    ds_read_b64_tr_b16 v[46:47], v3 offset:9248
    ds_read_b64_tr_b16 v[48:49], v3 offset:16384
    ds_read_b64_tr_b16 v[50:51], v3 offset:17408
    ds_read_b64_tr_b16 v[52:53], v3 offset:16416
    ds_read_b64_tr_b16 v[54:55], v3 offset:17440
    s_waitcnt lgkmcnt(4)
    ds_read_b64_tr_b16 v[56:57], v3 offset:24576
    ds_read_b64_tr_b16 v[58:59], v3 offset:25600
    ds_read_b64_tr_b16 v[60:61], v3 offset:24608
    ds_read_b64_tr_b16 v[62:63], v3 offset:25632
    ds_read_b64_tr_b16 v[64:65], v3 offset:32768
    ds_read_b64_tr_b16 v[66:67], v3 offset:33792
    ds_read_b64_tr_b16 v[68:69], v3 offset:32800
    ds_read_b64_tr_b16 v[70:71], v3 offset:33824
    s_waitcnt lgkmcnt(0)
    ds_read_b128 v[140:143], v6 offset:0
    ds_read_b128 v[144:147], v6 offset:256
    ds_read_b128 v[148:151], v6 offset:512
    ds_read_b128 v[152:155], v6 offset:768
    ds_read_b128 v[156:159], v6 offset:1024
    s_waitcnt lgkmcnt(4)
    v_mfma_f32_16x16x32_bf16 v[20:23], v[32:35], v[140:143], 0
    v_mfma_f32_16x16x32_bf16 v[24:27], v[36:39], v[140:143], 0
    s_waitcnt lgkmcnt(3)
    v_mfma_f32_16x16x32_bf16 v[20:23], v[40:43], v[144:147], v[20:23]
    v_mfma_f32_16x16x32_bf16 v[24:27], v[44:47], v[144:147], v[24:27]
    s_waitcnt lgkmcnt(2)
    v_mfma_f32_16x16x32_bf16 v[20:23], v[48:51], v[148:151], v[20:23]
    v_mfma_f32_16x16x32_bf16 v[24:27], v[52:55], v[148:151], v[24:27]
    s_waitcnt lgkmcnt(1)
    v_mfma_f32_16x16x32_bf16 v[20:23], v[56:59], v[152:155], v[20:23]
    v_mfma_f32_16x16x32_bf16 v[24:27], v[60:63], v[152:155], v[24:27]
    s_waitcnt lgkmcnt(0)
    v_mfma_f32_16x16x32_bf16 v[20:23], v[64:67], v[156:159], v[20:23]
    v_mfma_f32_16x16x32_bf16 v[24:27], v[68:71], v[156:159], v[24:27]
    s_nop 6
    ds_write_b128 v7, v[20:23]
    ds_write_b128 v7, v[24:27] offset:1024
    s_waitcnt lgkmcnt(0)
    s_setprio 3
    s_barrier
    ds_read_b128 v[140:143], v4 offset:0
    ds_read_b128 v[144:147], v4 offset:256
    ds_read_b128 v[148:151], v4 offset:512
    ds_read_b128 v[152:155], v4 offset:768
    ds_read_b128 v[156:159], v4 offset:1024
    s_waitcnt lgkmcnt(4)
    v_mfma_f32_16x16x32_bf16 v[20:23], v[32:35], v[140:143], 0
    v_mfma_f32_16x16x32_bf16 v[24:27], v[36:39], v[140:143], 0
    s_waitcnt lgkmcnt(3)
    v_mfma_f32_16x16x32_bf16 v[20:23], v[40:43], v[144:147], v[20:23]
    v_mfma_f32_16x16x32_bf16 v[24:27], v[44:47], v[144:147], v[24:27]
    s_waitcnt lgkmcnt(2)
    v_mfma_f32_16x16x32_bf16 v[20:23], v[48:51], v[148:151], v[20:23]
    v_mfma_f32_16x16x32_bf16 v[24:27], v[52:55], v[148:151], v[24:27]
    s_waitcnt lgkmcnt(1)
    v_mfma_f32_16x16x32_bf16 v[20:23], v[56:59], v[152:155], v[20:23]
    v_mfma_f32_16x16x32_bf16 v[24:27], v[60:63], v[152:155], v[24:27]
    s_waitcnt lgkmcnt(0)
    v_mfma_f32_16x16x32_bf16 v[20:23], v[64:67], v[156:159], v[20:23]
    v_mfma_f32_16x16x32_bf16 v[24:27], v[68:71], v[156:159], v[24:27]
    s_nop 6
    ds_write_b128 v5, v[20:23]
    ds_write_b128 v5, v[24:27] offset:1024
    s_waitcnt lgkmcnt(0)
    s_barrier
    s_branch L_fin
L_w1_ln:
    s_setprio 1
    ds_read_b128 v[140:143], v205 offset:0
    ds_read_b128 v[144:147], v205 offset:256
    ds_read_b128 v[148:151], v205 offset:512
    ds_read_b128 v[152:155], v205 offset:768
    ds_read_b128 v[156:159], v205 offset:1024
    ds_read_b128 v[160:163], v205 offset:1280
    ds_read_b128 v[164:167], v205 offset:1536
    ds_read_b128 v[168:171], v205 offset:1792
    ds_read_b128 v[172:175], v205 offset:2048
    ds_read_b128 v[176:179], v205 offset:2304
    ds_read_b128 v[180:183], v205 offset:2560
    ds_read_b128 v[184:187], v205 offset:2816
    ds_read_b128 v[188:191], v205 offset:3072
    ds_read_b128 v[192:195], v205 offset:3328
    ds_read_b128 v[196:199], v205 offset:3584
    v_and_b32 v8, 1, v0
    v_lshlrev_b32 v8, 4, v8
    v_mov_b32 v9, 0xffff
    v_lshlrev_b32 v8, v8, v9
    v_bfe_u32 v9, v0, 1, 2
    v_cmp_eq_u32 vcc, 0, v9
    s_nop 1
    v_cndmask_b32 v16, 0, v8, vcc
    v_cmp_eq_u32 vcc, 1, v9
    s_nop 1
    v_cndmask_b32 v17, 0, v8, vcc
    v_cmp_eq_u32 vcc, 2, v9
    s_nop 1
    v_cndmask_b32 v18, 0, v8, vcc
    v_cmp_eq_u32 vcc, 3, v9
    s_nop 1
    v_cndmask_b32 v19, 0, v8, vcc
    v_bfe_u32 v8, v0, 3, 1
    v_cmp_eq_u32 vcc, 0, v8
    s_nop 1
    v_cndmask_b32 v20, 0, v16, vcc
    v_xor_b32 v24, v20, v16
    v_cndmask_b32 v21, 0, v17, vcc
    v_xor_b32 v25, v21, v17
    v_cndmask_b32 v22, 0, v18, vcc
    v_xor_b32 v26, v22, v18
    v_cndmask_b32 v23, 0, v19, vcc
    v_xor_b32 v27, v23, v19
    v_and_b32 v52, 0x3f803f80, v20
    v_and_b32 v60, 0x3e803e80, v20
    v_and_b32 v53, 0x3f803f80, v21
    v_and_b32 v61, 0x3e803e80, v21
    v_and_b32 v54, 0x3f803f80, v22
    v_and_b32 v62, 0x3e803e80, v22
    v_and_b32 v55, 0x3f803f80, v23
    v_and_b32 v63, 0x3e803e80, v23
    v_and_b32 v56, 0x3f803f80, v24
    v_and_b32 v64, 0x3e803e80, v24
    v_and_b32 v57, 0x3f803f80, v25
    v_and_b32 v65, 0x3e803e80, v25
    v_and_b32 v58, 0x3f803f80, v26
    v_and_b32 v66, 0x3e803e80, v26
    v_and_b32 v59, 0x3f803f80, v27
    v_and_b32 v67, 0x3e803e80, v27
    s_waitcnt lgkmcnt(0)
    v_mfma_f32_16x16x32_bf16 v[68:71], v[140:143], v[60:63], 0
    v_mfma_f32_16x16x32_bf16 v[68:71], v[144:147], v[64:67], v[68:71]
    v_mfma_f32_16x16x32_bf16 v[72:75], v[148:151], v[60:63], 0
    v_mfma_f32_16x16x32_bf16 v[72:75], v[152:155], v[64:67], v[72:75]
    v_mfma_f32_16x16x32_bf16 v[76:79], v[156:159], v[60:63], 0
    v_mfma_f32_16x16x32_bf16 v[116:119], v[160:163], v[60:63], 0
    v_mfma_f32_16x16x32_bf16 v[116:119], v[164:167], v[64:67], v[116:119]
    v_mfma_f32_16x16x32_bf16 v[120:123], v[168:171], v[60:63], 0
    v_mfma_f32_16x16x32_bf16 v[120:123], v[172:175], v[64:67], v[120:123]
    v_mfma_f32_16x16x32_bf16 v[124:127], v[176:179], v[60:63], 0
    v_mfma_f32_16x16x32_bf16 v[80:83], v[180:183], v[60:63], 1.0
    v_mfma_f32_16x16x32_bf16 v[80:83], v[184:187], v[64:67], v[80:83]
    v_mfma_f32_16x16x32_bf16 v[84:87], v[188:191], v[60:63], 1.0
    v_mfma_f32_16x16x32_bf16 v[84:87], v[192:195], v[64:67], v[84:87]
    v_mfma_f32_16x16x32_bf16 v[88:91], v[196:199], v[60:63], 1.0
    s_mul_i32 s34, s3, 1344
    s_add_u32 s34, s34, 116736
    v_lshl_add_u32 v7, v0, 4, s34
    v_lshlrev_b32 v8, 6, v202
    v_lshl_add_u32 v8, v200, 4, v8
    v_and_b32 v9, 1, v201
    v_lshl_add_u32 v8, v9, 3, v8
    v_add_u32 v8, s34, v8
    v_bfe_u32 v9, v0, 3, 1
    v_mul_u32_u24 v9, 6144, v9
    v_sub_u32 v8, v8, v9
    v_lshrrev_b32 v9, 5, v0
    v_lshlrev_b32 v9, 10, v9
    v_and_b32 v6, 1, v202
    v_lshl_add_u32 v9, v6, 7, v9
    v_bfe_u32 v6, v0, 1, 1
    v_lshl_add_u32 v9, v6, 6, v9
    v_lshl_add_u32 v9, v201, 4, v9
    v_and_b32 v6, 1, v0
    v_lshl_add_u32 v9, v6, 3, v9
    v_add_u32 v9, 122112, v9
    s_lshr_b32 s34, s62, 3
    s_lshl_b32 s34, s34, 8
    s_and_b32 s49, s62, 3
    s_lshl_b32 s49, s49, 15
    s_add_u32 s34, s34, s49
    s_bfe_u32 s49, s62, 0x10002
    s_lshl_b32 s49, s49, 14
    s_add_u32 s34, s34, s49
    s_add_u32 s34, s34, 791552
    v_lshl_add_u32 v5, v0, 2, s34
    v_add_u32 v4, 917504, v5
    s_bfe_u32 s49, s60, 0x10002
    s_lshl_b32 s49, s49, 13
    s_xor_b32 s53, s99, s49
    s_xor_b32 s52, s53, 8192
    v_subrev_u32 v10, 90112, v7
    v_subrev_u32 v11, 90112, v8
    v_cvt_pk_bf16_f32 v32, v116, v117
    v_cvt_pk_bf16_f32 v33, v118, v119
    v_cvt_pk_bf16_f32 v34, v120, v121
    v_cvt_pk_bf16_f32 v35, v122, v123
    v_cvt_pk_bf16_f32 v36, v124, v125
    v_cvt_pk_bf16_f32 v37, v126, v127
    s_mov_b32 exec_lo, 0x00ff00ff
    s_mov_b32 exec_hi, 0x00ff00ff
    ds_write_b64 v11, v[36:37] offset:6400
    s_mov_b64 exec, -1
    ds_write_b128 v10, v[32:35] offset:5376
    v_cvt_pk_bf16_f32 v20, v80, v81
    v_cvt_pk_bf16_f32 v21, v82, v83
    v_cvt_pk_bf16_f32 v22, v84, v85
    v_cvt_pk_bf16_f32 v23, v86, v87
    v_cvt_pk_bf16_f32 v24, v88, v89
    v_cvt_pk_bf16_f32 v25, v90, v91
    ds_write_b128 v10, v[20:23]
    ds_write_b64 v11, v[24:25] offset:1024
    v_lshlrev_b32 v80, 16, v20
    v_and_b32 v81, 0xffff0000, v20
    v_lshlrev_b32 v82, 16, v21
    v_and_b32 v83, 0xffff0000, v21
    v_lshlrev_b32 v84, 16, v22
    v_and_b32 v85, 0xffff0000, v22
    v_lshlrev_b32 v86, 16, v23
    v_and_b32 v87, 0xffff0000, v23
    v_lshlrev_b32 v88, 16, v24
    v_and_b32 v89, 0xffff0000, v24
    v_lshlrev_b32 v90, 16, v25
    v_and_b32 v91, 0xffff0000, v25
    v_subrev_u32 v11, 22784, v9
    s_lshl_b32 s34, s3, 3
    s_add_u32 s34, s34, 99136
    v_mov_b32 v12, s34
    v_lshlrev_b32 v13, 3, v201
    v_add_u32 v13, 99136, v13
    s_mov_b32 s54, 0
    s_brev_b32 s55, 1
    s_waitcnt lgkmcnt(0)
    s_barrier
    s_mov_b32 s35, 0
    s_mov_b64 s[40:41], -1
    s_mov_b64 s[42:43], -1
L_pb:
    s_mov_b64 exec, s[40:41]
    s_cbranch_execz L_pbs0
    buffer_load_dwordx4 v[140:143], v206, s[44:47], 0 offen offset:0 sc1
    buffer_load_dwordx4 v[148:151], v206, s[44:47], 0 offen offset:256 sc1
    buffer_load_dwordx4 v[156:159], v206, s[44:47], 0 offen offset:512 sc1
    buffer_load_dwordx4 v[164:167], v206, s[44:47], 0 offen offset:768 sc1
    buffer_load_dwordx4 v[172:175], v206, s[44:47], 0 offen offset:1024 sc1
L_pbs0:
    s_mov_b64 exec, s[42:43]
    s_cbranch_execz L_pbs1
    buffer_load_dwordx4 v[144:147], v206, s[44:47], s48 offen offset:0 sc1
    buffer_load_dwordx4 v[152:155], v206, s[44:47], s48 offen offset:256 sc1
    buffer_load_dwordx4 v[160:163], v206, s[44:47], s48 offen offset:512 sc1
    buffer_load_dwordx4 v[168:171], v206, s[44:47], s48 offen offset:768 sc1
    buffer_load_dwordx4 v[176:179], v206, s[44:47], s48 offen offset:1024 sc1
L_pbs1:
    s_mov_b64 exec, -1
    s_add_u32 s35, s35, 1
    s_waitcnt vmcnt(0)
    v_mfma_f32_16x16x32_bf16 v[128:131], v[140:143], v[52:55], v[68:71]
    v_max3_u32 v28, v140, v141, v142
    v_max3_u32 v29, v144, v145, v146
    v_mfma_f32_16x16x32_bf16 v[128:131], v[144:147], v[52:55], v[128:131]
    v_max3_u32 v28, v28, v143, v148
    v_max3_u32 v29, v29, v147, v152
    v_mfma_f32_16x16x32_bf16 v[128:131], v[148:151], v[56:59], v[128:131]
    v_max3_u32 v28, v28, v149, v150
    v_max3_u32 v29, v29, v153, v154
    v_mfma_f32_16x16x32_bf16 v[128:131], v[152:155], v[56:59], v[128:131]
    v_max3_u32 v28, v28, v151, v156
    v_max3_u32 v29, v29, v155, v160
    v_mfma_f32_16x16x32_bf16 v[132:135], v[156:159], v[52:55], v[72:75]
    v_max3_u32 v28, v28, v157, v158
    v_max3_u32 v29, v29, v161, v162
    v_mfma_f32_16x16x32_bf16 v[132:135], v[160:163], v[52:55], v[132:135]
    v_max3_u32 v28, v28, v159, v164
    v_max3_u32 v29, v29, v163, v168
    v_mfma_f32_16x16x32_bf16 v[132:135], v[164:167], v[56:59], v[132:135]
    v_max3_u32 v28, v28, v165, v166
    v_max3_u32 v29, v29, v169, v170
    v_mfma_f32_16x16x32_bf16 v[132:135], v[168:171], v[56:59], v[132:135]
    v_max3_u32 v28, v28, v167, v172
    v_max3_u32 v29, v29, v171, v176
    v_mfma_f32_16x16x32_bf16 v[136:139], v[172:175], v[52:55], v[76:79]
    v_max3_u32 v28, v28, v173, v174
    v_max3_u32 v29, v29, v177, v178
    v_mfma_f32_16x16x32_bf16 v[136:139], v[176:179], v[52:55], v[136:139]
    v_max_u32 v28, v28, v175
    v_max_u32 v29, v29, v179
    v_cmp_eq_u32 s[40:41], -1, v28
    v_cmp_eq_u32 s[42:43], -1, v29
    s_nop 0
    s_or_b64 vcc, s[40:41], s[42:43]
    s_cbranch_scc0 L_pbd
    s_cmp_lg_u32 s35, 64
    s_cbranch_scc1 L_tmo87
    s_mov_b64 exec, -1
    v_lshlrev_b32 v243, 4, v0
    v_add_u32 v243, 131328, v243
    ds_read_b96 v[240:242], v243
    s_waitcnt lgkmcnt(0)
    buffer_store_dword v240, v242, s[44:47], 0 offen sc1
    buffer_store_dword v241, v242, s[44:47], 0 offen offset:256 sc1
L_tmo87:
    s_cmp_lt_u32 s35, 60000
    s_cbranch_scc1 L_pb
L_pbd:
    v_pk_mul_f32 v[32:33], v[128:129], v[80:81]
    v_pk_mul_f32 v[34:35], v[130:131], v[82:83]
    v_pk_mul_f32 v[36:37], v[132:133], v[84:85]
    v_pk_mul_f32 v[38:39], v[134:135], v[86:87]
    v_cvt_pk_bf16_f32 v24, v32, v33
    v_cvt_pk_bf16_f32 v25, v34, v35
    v_cvt_pk_bf16_f32 v26, v36, v37
    v_cvt_pk_bf16_f32 v27, v38, v39
    ds_write_b128 v7, v[24:27]
    v_pk_mul_f32 v[40:41], v[136:137], v[88:89]
    v_pk_mul_f32 v[42:43], v[138:139], v[90:91]
    v_cvt_pk_bf16_f32 v28, v40, v41
    v_cvt_pk_bf16_f32 v29, v42, v43
    ds_write_b64 v8, v[28:29] offset:1024
    v_pk_add_f32 v[20:21], v[128:129], v[130:131]
    v_pk_mul_f32 v[22:23], v[128:129], v[128:129]
    v_pk_add_f32 v[20:21], v[20:21], v[132:133]
    v_pk_fma_f32 v[22:23], v[130:131], v[130:131], v[22:23]
    v_pk_add_f32 v[20:21], v[20:21], v[134:135]
    v_pk_fma_f32 v[22:23], v[132:133], v[132:133], v[22:23]
    v_pk_add_f32 v[20:21], v[20:21], v[136:137]
    v_pk_fma_f32 v[22:23], v[134:135], v[134:135], v[22:23]
    v_pk_add_f32 v[20:21], v[20:21], v[138:139]
    v_pk_fma_f32 v[22:23], v[136:137], v[136:137], v[22:23]
    v_pk_fma_f32 v[22:23], v[138:139], v[138:139], v[22:23]
    s_waitcnt lgkmcnt(0)
    s_barrier
    v_add_f32 v20, v20, v21
    v_add_f32 v21, v22, v23
    s_nop 0
    v_add_f32_dpp v20, v20, v20 row_ror:8 row_mask:0xf bank_mask:0xf
    v_add_f32_dpp v21, v21, v21 row_ror:8 row_mask:0xf bank_mask:0xf
    s_nop 0
    v_add_f32_dpp v20, v20, v20 row_ror:4 row_mask:0xf bank_mask:0xf
    v_add_f32_dpp v21, v21, v21 row_ror:4 row_mask:0xf bank_mask:0xf
    s_nop 0
    v_add_f32_dpp v20, v20, v20 row_ror:2 row_mask:0xf bank_mask:0xf
    v_add_f32_dpp v21, v21, v21 row_ror:2 row_mask:0xf bank_mask:0xf
    s_nop 0
    v_add_f32_dpp v20, v20, v20 row_ror:1 row_mask:0xf bank_mask:0xf
    v_add_f32_dpp v21, v21, v21 row_ror:1 row_mask:0xf bank_mask:0xf
    s_nop 0
    v_add_f32_dpp v20, v20, v20 row_bcast:15 row_mask:0xa bank_mask:0xf
    v_add_f32_dpp v21, v21, v21 row_bcast:15 row_mask:0xa bank_mask:0xf
    s_nop 0
    v_add_f32_dpp v20, v20, v20 row_bcast:31 row_mask:0xc bank_mask:0xf
    v_add_f32_dpp v21, v21, v21 row_bcast:31 row_mask:0xc bank_mask:0xf
    v_mul_f32 v22, 0x3acccccd, v20
    v_mul_f32 v21, 0x3acccccd, v21
    v_fma_f32 v21, -v22, v22, v21
    v_max_f32 v21, 0, v21
    v_add_f32 v21, 0x3727c5ac, v21
    v_rsq_f32 v20, v21
    s_nop 0
    v_mul_f32_e64 v21, -v22, v20
    s_mov_b64 exec, s[54:55]
    ds_write_b64 v12, v[20:21]
    s_mov_b64 exec, -1
    s_cmp_lg_u32 s3, 0
    s_cbranch_scc1 L_w1_x
    ds_read_b64 v[32:33], v11 offset:0
    ds_read_b64 v[40:41], v11 offset:320
    ds_read_b64 v[34:35], v11 offset:2048
    ds_read_b64 v[42:43], v11 offset:2368
    ds_read_b64 v[36:37], v11 offset:4096
    ds_read_b64 v[44:45], v11 offset:4416
    ds_read_b64 v[38:39], v11 offset:6144
    ds_read_b64 v[46:47], v11 offset:6464
    s_mov_b32 s34, 0xbdd2d3e8
    v_mov_b32 v10, 0xc0135761
    s_waitcnt lgkmcnt(8)
    s_barrier
    ds_read_b64 v[28:29], v13
    ds_read_b64 v[20:21], v9 offset:0
    ds_read_b64 v[22:23], v9 offset:2048
    ds_read_b64 v[24:25], v9 offset:4096
    ds_read_b64 v[26:27], v9 offset:6144
    s_waitcnt lgkmcnt(5)
    v_pk_add_f32 v[100:101], v[100:101], v[40:41]
    v_pk_add_f32 v[100:101], v[100:101], v[42:43]
    v_pk_add_f32 v[32:33], v[32:33], v[34:35]
    v_pk_add_f32 v[100:101], v[100:101], v[44:45]
    v_pk_add_f32 v[32:33], v[32:33], v[36:37]
    v_pk_add_f32 v[100:101], v[100:101], v[46:47]
    v_pk_add_f32 v[32:33], v[32:33], v[38:39]
    s_waitcnt lgkmcnt(4)
    v_pk_fma_f32 v[100:101], v[32:33], v[28:29], v[100:101] op_sel:[0,1,0] op_sel_hi:[1,1,1]
    s_waitcnt lgkmcnt(3)
    v_pk_fma_f32 v[100:101], v[20:21], v[28:29], v[100:101] op_sel_hi:[1,0,1]
    s_waitcnt lgkmcnt(2)
    v_pk_fma_f32 v[100:101], v[22:23], v[28:29], v[100:101] op_sel_hi:[1,0,1]
    s_waitcnt lgkmcnt(1)
    v_pk_fma_f32 v[100:101], v[24:25], v[28:29], v[100:101] op_sel_hi:[1,0,1]
    s_waitcnt lgkmcnt(0)
    v_pk_fma_f32 v[100:101], v[26:27], v[28:29], v[100:101] op_sel_hi:[1,0,1]
    v_pk_mul_f32 v[20:21], v[100:101], v[100:101]
    v_fma_f32 v20, v20, s34, v10
    v_fma_f32 v21, v21, s34, v10
    v_pk_mul_f32 v[20:21], v[20:21], v[100:101]
    v_exp_f32 v20, v20
    v_exp_f32 v21, v21
    v_add_f32 v20, 1.0, v20
    v_add_f32 v21, 1.0, v21
    v_rcp_f32 v20, v20
    v_rcp_f32 v21, v21
    s_nop 0
    v_pk_mul_f32 v[20:21], v[20:21], v[100:101]
    v_cvt_pk_bf16_f32 v20, v20, v21
    v_min_u32 v20, -2, v20
    buffer_store_dword v20, v5, s[44:47], s52 offen sc1
    buffer_store_dword v20, v4, s[44:47], s52 offen sc1
    buffer_store_dword v20, v5, s[44:47], s53 offen sc1
    buffer_store_dword v20, v4, s[44:47], s53 offen sc1
    s_branch L_fin
L_w1_x:
    s_waitcnt lgkmcnt(0)
    s_barrier
    s_branch L_fin
L_t_w2:
    s_barrier
L_w2_dma:
    s_and_b32 s34, s40, 7
    s_lshl_b32 s35, s34, 10
    s_add_u32 m0, s50, s35
    s_mul_i32 s34, s34, 40960
    buffer_load_dwordx4 v204, s[52:55], s34 offen  lds
    s_add_u32 s40, s40, 1
    s_cmp_lg_u32 s40, s42
    s_cbranch_scc1 L_w2_nw
L_w2_nw:
    s_cmp_lt_u32 s40, s41
    s_cbranch_scc1 L_w2_dma
    ds_read_b32 v8, v7
    s_waitcnt lgkmcnt(0)
    v_cmp_eq_u32 vcc, 0, v8
    s_cbranch_vccnz L_w2_slow
    s_mov_b32 s35, 0
    buffer_load_dwordx4 v[64:67], v4, s[44:47], 0 offen sc1
    buffer_load_dwordx4 v[68:71], v5, s[44:47], s48 offen sc1
    s_waitcnt vmcnt(2)
    ds_read_b64_tr_b16 v[32:33], v205 offset:0
    ds_read_b64_tr_b16 v[34:35], v205 offset:512
    ds_read_b64_tr_b16 v[36:37], v205 offset:1024
    ds_read_b64_tr_b16 v[38:39], v205 offset:1536
    ds_read_b64_tr_b16 v[40:41], v205 offset:2048
    ds_read_b64_tr_b16 v[42:43], v205 offset:2560
    ds_read_b64_tr_b16 v[44:45], v205 offset:3072
    ds_read_b64_tr_b16 v[46:47], v205 offset:3584
    s_waitcnt lgkmcnt(0)
    ds_read_b64_tr_b16 v[48:49], v205 offset:4096
    ds_read_b64_tr_b16 v[50:51], v205 offset:4608
    ds_read_b64_tr_b16 v[52:53], v205 offset:5120
    ds_read_b64_tr_b16 v[54:55], v205 offset:5632
    ds_read_b64_tr_b16 v[56:57], v205 offset:6144
    ds_read_b64_tr_b16 v[58:59], v205 offset:6656
    ds_read_b64_tr_b16 v[60:61], v205 offset:7168
    ds_read_b64_tr_b16 v[62:63], v205 offset:7680
    s_waitcnt lgkmcnt(0)
    s_branch L_w2_mid
L_w2_slow:
    s_waitcnt vmcnt(0)
    ds_read_b64_tr_b16 v[32:33], v205 offset:0
    ds_read_b64_tr_b16 v[34:35], v205 offset:512
    ds_read_b64_tr_b16 v[36:37], v205 offset:1024
    ds_read_b64_tr_b16 v[38:39], v205 offset:1536
    ds_read_b64_tr_b16 v[40:41], v205 offset:2048
    ds_read_b64_tr_b16 v[42:43], v205 offset:2560
    ds_read_b64_tr_b16 v[44:45], v205 offset:3072
    ds_read_b64_tr_b16 v[46:47], v205 offset:3584
    s_waitcnt lgkmcnt(0)
    ds_read_b64_tr_b16 v[48:49], v205 offset:4096
    ds_read_b64_tr_b16 v[50:51], v205 offset:4608
    ds_read_b64_tr_b16 v[52:53], v205 offset:5120
    ds_read_b64_tr_b16 v[54:55], v205 offset:5632
    ds_read_b64_tr_b16 v[56:57], v205 offset:6144
    ds_read_b64_tr_b16 v[58:59], v205 offset:6656
    ds_read_b64_tr_b16 v[60:61], v205 offset:7168
    ds_read_b64_tr_b16 v[62:63], v205 offset:7680
    s_waitcnt lgkmcnt(0)
    s_mov_b32 s35, 0
L_poll88:
    ds_read_b32 v8, v7
    s_add_u32 s35, s35, 1
    s_waitcnt lgkmcnt(0)
    v_cmp_eq_u32 vcc, 0, v8
    s_cbranch_vccz L_done89
    s_sleep 1
    s_cmp_lt_u32 s35, 60000
    s_cbranch_scc1 L_poll88
L_done89:
    s_mov_b32 s35, 0
L_poll91:
    buffer_load_dwordx4 v[64:67], v4, s[44:47], 0 offen sc1
    buffer_load_dwordx4 v[68:71], v5, s[44:47], s48 offen sc1
L_w2_mid:
    s_add_u32 s35, s35, 1
    s_waitcnt vmcnt(0)
    v_max3_u32 v28, v64, v65, v66
    v_max3_u32 v28, v28, v67, v68
    v_max3_u32 v28, v28, v69, v70
    v_max_u32 v28, v28, v71
    v_cmp_eq_u32 vcc, -1, v28
    s_cbranch_vccz L_done92
    s_cmp_lg_u32 s35, 64
    s_cbranch_scc1 L_tmo94
    s_mov_b64 exec, -1
    v_lshlrev_b32 v243, 4, v0
    v_add_u32 v243, 131328, v243
    ds_read_b96 v[240:242], v243
    s_waitcnt lgkmcnt(0)
    buffer_store_dword v240, v242, s[44:47], 0 offen sc1
    buffer_store_dword v241, v242, s[44:47], 0 offen offset:256 sc1
L_tmo94:
    s_cmp_lt_u32 s35, 60000
    s_cbranch_scc1 L_poll91
L_done92:
    v_mfma_f32_16x16x32_bf16 v[80:83], v[32:35], v[64:67], 0
    v_mfma_f32_16x16x32_bf16 v[80:83], v[48:51], v[68:71], v[80:83]
    v_mfma_f32_16x16x32_bf16 v[84:87], v[36:39], v[64:67], 0
    v_mfma_f32_16x16x32_bf16 v[84:87], v[52:55], v[68:71], v[84:87]
    v_mfma_f32_16x16x32_bf16 v[88:91], v[40:43], v[64:67], 0
    v_mfma_f32_16x16x32_bf16 v[88:91], v[56:59], v[68:71], v[88:91]
    v_mfma_f32_16x16x32_bf16 v[92:95], v[44:47], v[64:67], 0
    v_mfma_f32_16x16x32_bf16 v[92:95], v[60:63], v[68:71], v[92:95]
    s_nop 3
    v_add_f32_dpp v80, v84, v80 row_shl:4 row_mask:0xf bank_mask:0x1
    v_add_f32_dpp v81, v85, v81 row_shl:4 row_mask:0xf bank_mask:0x1
    v_add_f32_dpp v82, v86, v82 row_shl:4 row_mask:0xf bank_mask:0x1
    v_add_f32_dpp v83, v87, v83 row_shl:4 row_mask:0xf bank_mask:0x1
    v_add_f32_dpp v80, v88, v80 row_shl:8 row_mask:0xf bank_mask:0x1
    v_add_f32_dpp v81, v89, v81 row_shl:8 row_mask:0xf bank_mask:0x1
    v_add_f32_dpp v82, v90, v82 row_shl:8 row_mask:0xf bank_mask:0x1
    v_add_f32_dpp v83, v91, v83 row_shl:8 row_mask:0xf bank_mask:0x1
    v_add_f32_dpp v80, v92, v80 row_shl:12 row_mask:0xf bank_mask:0x1
    v_add_f32_dpp v81, v93, v81 row_shl:12 row_mask:0xf bank_mask:0x1
    v_add_f32_dpp v82, v94, v82 row_shl:12 row_mask:0xf bank_mask:0x1
    v_add_f32_dpp v83, v95, v83 row_shl:12 row_mask:0xf bank_mask:0x1
    ds_write_b128 v203, v[80:83]
    s_waitcnt lgkmcnt(0)
    s_barrier
    s_branch L_fin
L_w2_red:
    s_mov_b32 s35, 0
L_poll95:
    buffer_load_dwordx2 v[20:21], v204, s[44:47], 0 offen sc1
    buffer_load_dwordx2 v[22:23], v204, s[44:47], s48 offen sc1
    s_add_u32 s35, s35, 1
    s_waitcnt vmcnt(0)
    v_max3_u32 v28, v20, v21, v22
    v_max_u32 v28, v28, v23
    v_cmp_eq_u32 vcc, -1, v28
    s_cbranch_vccz L_done96
    s_cmp_lg_u32 s35, 21
    s_cbranch_scc1 L_tmo98
    s_mov_b64 exec, -1
    v_lshlrev_b32 v243, 4, v0
    v_add_u32 v243, 131328, v243
    ds_read_b96 v[240:242], v243
    s_waitcnt lgkmcnt(0)
    buffer_store_dword v240, v242, s[44:47], 0 offen sc1
    buffer_store_dword v241, v242, s[44:47], 0 offen offset:256 sc1
L_tmo98:
    s_sleep 6
    s_cmp_lt_u32 s35, 60000
    s_cbranch_scc1 L_poll95
L_done96:
    v_mov_b32 v7, 99084
    ds_write_b32 v7, v7
    v_lshlrev_b32 v44, 16, v20
    v_and_b32 v45, 0xffff0000, v20
    v_lshlrev_b32 v46, 16, v21
    v_and_b32 v47, 0xffff0000, v21
    v_lshlrev_b32 v48, 16, v22
    v_and_b32 v49, 0xffff0000, v22
    v_lshlrev_b32 v50, 16, v23
    v_and_b32 v51, 0xffff0000, v23
    v_add_f32 v108, v108, v44
    v_add_f32 v109, v109, v45
    v_add_f32 v110, v110, v46
    v_add_f32 v111, v111, v47
    v_add_f32 v108, v108, v48
    v_add_f32 v109, v109, v49
    v_add_f32 v110, v110, v50
    v_add_f32 v111, v111, v51
    s_mov_b32 s36, s28
    s_mov_b32 s37, s29
    s_movk_i32 s38, 5120
    v_add_f32_dpp v108, v108, v108 row_ror:4 row_mask:0xf bank_mask:0xf
    v_add_f32_dpp v109, v109, v109 row_ror:4 row_mask:0xf bank_mask:0xf
    v_add_f32_dpp v110, v110, v110 row_ror:4 row_mask:0xf bank_mask:0xf
    v_add_f32_dpp v111, v111, v111 row_ror:4 row_mask:0xf bank_mask:0xf
    v_add_f32_dpp v108, v108, v108 row_ror:8 row_mask:0xf bank_mask:0xf
    v_add_f32_dpp v109, v109, v109 row_ror:8 row_mask:0xf bank_mask:0xf
    v_add_f32_dpp v110, v110, v110 row_ror:8 row_mask:0xf bank_mask:0xf
    v_add_f32_dpp v111, v111, v111 row_ror:8 row_mask:0xf bank_mask:0xf
    v_mov_b32_dpp v108, v104 quad_perm:[0,1,2,3] row_mask:0xf bank_mask:0x2
    v_mov_b32_dpp v109, v105 quad_perm:[0,1,2,3] row_mask:0xf bank_mask:0x2
    v_mov_b32_dpp v110, v106 quad_perm:[0,1,2,3] row_mask:0xf bank_mask:0x2
    v_mov_b32_dpp v111, v107 quad_perm:[0,1,2,3] row_mask:0xf bank_mask:0x2
    ds_write_b128 v203, v[108:111]
    v_and_b32 v6, 31, v0
    v_lshlrev_b32 v6, 3, v6
    v_add_u32 v6, 122112, v6
    ds_read_b64 v[108:109], v6
    ds_read_b64 v[104:105], v6 offset:320
    v_bfe_u32 v112, v0, 1, 2
    v_mul_u32_u24 v112, 1280, v112
    v_bfe_u32 v7, v0, 3, 2
    v_lshl_add_u32 v112, v7, 3, v112
    v_and_b32 v7, 1, v0
    v_lshl_add_u32 v112, v7, 2, v112
    v_lshrrev_b32 v7, 5, v0
    v_lshl_add_u32 v112, v7, 28, v112
    s_lshl_b32 s34, s62, 5
    s_waitcnt lgkmcnt(0)
    s_barrier
    ds_read_b64 v[64:65], v6 offset:1024
    ds_read_b64 v[66:67], v6 offset:2048
    ds_read_b64 v[68:69], v6 offset:3072
    ds_read_b64 v[70:71], v6 offset:4096
    ds_read_b64 v[72:73], v6 offset:5120
    ds_read_b64 v[74:75], v6 offset:6144
    ds_read_b64 v[76:77], v6 offset:7168
    s_waitcnt lgkmcnt(6)
    v_pk_fma_f32 v[108:109], v[64:65], v[104:105], v[108:109]
    s_waitcnt lgkmcnt(5)
    v_pk_fma_f32 v[108:109], v[66:67], v[104:105], v[108:109]
    s_waitcnt lgkmcnt(4)
    v_pk_fma_f32 v[108:109], v[68:69], v[104:105], v[108:109]
    s_waitcnt lgkmcnt(3)
    v_pk_fma_f32 v[108:109], v[70:71], v[104:105], v[108:109]
    s_waitcnt lgkmcnt(2)
    v_pk_fma_f32 v[108:109], v[72:73], v[104:105], v[108:109]
    s_waitcnt lgkmcnt(1)
    v_pk_fma_f32 v[108:109], v[74:75], v[104:105], v[108:109]
    s_waitcnt lgkmcnt(0)
    v_pk_fma_f32 v[108:109], v[76:77], v[104:105], v[108:109]
    v_cvt_pk_bf16_f32 v20, v108, v109
    buffer_store_dword v20, v112, s[36:39], s34 offen
    s_branch L_fin
L_t_wo:
    s_barrier
L_r_wo2:
    s_mov_b32 m0, s56
    s_nop 0
    buffer_load_dwordx4 v15, s[52:55], s57 offen  lds
    s_mov_b32 m0, s58
    s_nop 0
    buffer_load_dwordx4 v15, s[52:55], s59 offen  lds
    s_xor_b32 m0, s56, 2048
    s_sub_u32 s34, 40960, s57
    buffer_load_dwordx4 v15, s[52:55], s34 offen  lds
    s_xor_b32 m0, s58, 2048
    s_sub_u32 s34, 42240, s57
    buffer_load_dwordx4 v15, s[52:55], s34 offen  lds
L_r_wo3:
    s_mov_b32 s35, 0
    s_mov_b32 s48, 0
    buffer_load_dwordx4 v[64:67], v205, s[44:47], 0 offen sc1
    buffer_load_dwordx2 v[26:27], v204, s[44:47], 0 offen sc1
    s_waitcnt vmcnt(2)
    ds_read_b64_tr_b16 v[32:33], v206 offset:0
    ds_read_b64_tr_b16 v[34:35], v206 offset:1024
    ds_read_b64_tr_b16 v[36:37], v206 offset:32
    ds_read_b64_tr_b16 v[38:39], v206 offset:1056
    ds_read_b64_tr_b16 v[40:41], v206 offset:2048
    ds_read_b64_tr_b16 v[42:43], v206 offset:3072
    ds_read_b64_tr_b16 v[44:45], v206 offset:2080
    ds_read_b64_tr_b16 v[46:47], v206 offset:3104
    s_branch L_pam
L_pa:
    buffer_load_dwordx4 v[64:67], v205, s[44:47], 0 offen sc1
    buffer_load_dwordx2 v[26:27], v204, s[44:47], 0 offen sc1
L_pam:
    s_add_u32 s35, s35, 1
    s_waitcnt vmcnt(0)
    ds_write_b128 v207, v[64:67]
    ds_write_b32 v212, v26 offset:128
    v_max3_u32 v28, v64, v65, v66
    v_max3_u32 v28, v28, v67, v26
    v_cmp_eq_u32 vcc, -1, v28
    s_cbranch_vccz L_pad
    s_cmp_lg_u32 s35, 64
    s_cbranch_scc1 L_tmo99
    s_mov_b64 exec, -1
    v_lshlrev_b32 v243, 4, v0
    v_add_u32 v243, 131328, v243
    ds_read_b96 v[240:242], v243
    s_waitcnt lgkmcnt(0)
    buffer_store_dword v240, v242, s[44:47], 0 offen sc1
    buffer_store_dword v241, v242, s[44:47], 0 offen offset:256 sc1
L_tmo99:
    s_mov_b64 exec, vcc
    s_cmp_lt_u32 s35, 60000
    s_cbranch_scc1 L_pa
L_pad:
    s_mov_b64 exec, -1
    ds_read_b32 v26, v213 offset:128
    ds_read_b128 v[68:71], v208 offset:0
    ds_read_b128 v[72:75], v209 offset:0
    ds_read_b128 v[76:79], v208 offset:64
    ds_read_b128 v[80:83], v209 offset:64
    s_waitcnt lgkmcnt(3)
    v_mfma_f32_16x16x32_bf16 v[20:23], v[32:35], v[68:71], 0
    s_waitcnt lgkmcnt(2)
    v_mfma_f32_16x16x32_bf16 v[20:23], v[36:39], v[72:75], v[20:23]
    s_waitcnt lgkmcnt(1)
    v_mfma_f32_16x16x32_bf16 v[20:23], v[40:43], v[76:79], v[20:23]
    s_waitcnt lgkmcnt(0)
    v_mfma_f32_16x16x32_bf16 v[20:23], v[44:47], v[80:83], v[20:23]
    v_sub_f32_dpp v26, v26, v26 quad_perm:[1,0,3,2] row_mask:0xf bank_mask:0xf
    v_exp_f32 v26, v26
    s_nop 0
    v_add_f32 v26, 1.0, v26
    v_rcp_f32 v26, v26
    s_nop 0
    v_sub_f32 v30, 1.0, v26
    s_nop 0
    v_pk_mul_f32 v[48:49], v[20:21], v[26:27] op_sel_hi:[1,0]
    v_pk_mul_f32 v[50:51], v[22:23], v[26:27] op_sel_hi:[1,0]
    v_fmac_f32_dpp v48, v20, v30 quad_perm:[1,0,3,2] row_mask:0xf bank_mask:0xf
    v_fmac_f32_dpp v49, v21, v30 quad_perm:[1,0,3,2] row_mask:0xf bank_mask:0xf
    v_fmac_f32_dpp v50, v22, v30 quad_perm:[1,0,3,2] row_mask:0xf bank_mask:0xf
    v_fmac_f32_dpp v51, v23, v30 quad_perm:[1,0,3,2] row_mask:0xf bank_mask:0xf
    ds_write_b128 v203, v[48:51]
    s_cmp_lg_u32 s3, 0
    s_waitcnt lgkmcnt(0)
    s_barrier
    s_cbranch_scc1 L_wo_x
    ds_read_b64 v[64:65], v113 offset:0
    ds_read_b64 v[66:67], v113 offset:1152
    ds_read_b64 v[68:69], v113 offset:2304
    ds_read_b64 v[70:71], v113 offset:3456
    ds_read_b64 v[72:73], v113 offset:4608
    ds_read_b64 v[74:75], v113 offset:5760
    ds_read_b64 v[76:77], v113 offset:6912
    ds_read_b64 v[78:79], v113 offset:8064
    s_waitcnt lgkmcnt(6)
    v_pk_add_f32 v[64:65], v[64:65], v[66:67]
    s_waitcnt lgkmcnt(5)
    v_pk_add_f32 v[64:65], v[64:65], v[68:69]
    s_waitcnt lgkmcnt(4)
    v_pk_add_f32 v[64:65], v[64:65], v[70:71]
    s_waitcnt lgkmcnt(3)
    v_pk_add_f32 v[64:65], v[64:65], v[72:73]
    s_waitcnt lgkmcnt(2)
    v_pk_add_f32 v[64:65], v[64:65], v[74:75]
    s_waitcnt lgkmcnt(1)
    v_pk_add_f32 v[64:65], v[64:65], v[76:77]
    s_waitcnt lgkmcnt(0)
    v_pk_add_f32 v[64:65], v[64:65], v[78:79]
    v_pk_mul_f32 v[64:65], v[64:65], v[100:101]
    v_cvt_pk_bf16_f32 v28, v64, v65
    v_min_u32 v28, -2, v28
    buffer_store_dword v28, v112, s[44:47], s101 offen sc1
    buffer_store_dword v28, v112, s[44:47], s93 offen sc1
L_wo_x:
    s_getreg_b32 s34, hwreg(HW_REG_XCC_ID, 0, 4)
    v_cmp_ne_u32 vcc, s34, v27
    s_cbranch_vccz L_fin
    s_mov_b64 exec, -1
    v_lshlrev_b32 v243, 4, v0
    v_add_u32 v243, 131328, v243
    ds_read_b96 v[240:242], v243
    s_waitcnt lgkmcnt(0)
    buffer_store_dword v240, v242, s[44:47], 0 offen sc1
    buffer_store_dword v241, v242, s[44:47], 0 offen offset:256 sc1
L_fin:
L_exit:
    s_endpgm
L_codeend:
.section .rodata,"a"
.p2align 6
.amdhsa_kernel adaLN_cond__sliding_block_cached__dense_activation_gelu__decode_kernel
  .amdhsa_next_free_vgpr 256
  .amdhsa_next_free_sgpr 102
  .amdhsa_accum_offset 256
  .amdhsa_group_segment_fixed_size 0
  .amdhsa_kernarg_size 120
  .amdhsa_user_sgpr_count 2
  .amdhsa_user_sgpr_kernarg_segment_ptr 1
  .amdhsa_system_sgpr_workgroup_id_x 1
  .amdhsa_float_denorm_mode_32 3
.end_amdhsa_kernel
```

```asm
; @launch grid=(256,1,1) block=(512,1,1) lds=132352
.amdgcn_target "amdgcn-amd-amdhsa--gfx950"
.text
.globl adaLN_cond__sliding_block_cached__dense_activation_gelu__decode_kernel
.p2align 8
.type adaLN_cond__sliding_block_cached__dense_activation_gelu__decode_kernel,@function
adaLN_cond__sliding_block_cached__dense_activation_gelu__decode_kernel:
    s_load_dwordx16 s[4:19], s[0:1], 0
    s_load_dwordx8 s[20:27], s[0:1], 64
    s_cmpk_ge_u32 s2, 256
    s_cbranch_scc1 L_exit
    v_lshrrev_b32 v1, 6, v0
    v_and_b32 v0, 63, v0
    v_readfirstlane_b32 s3, v1
    v_lshrrev_b32 v10, 3, v0
    v_and_b32 v11, 7, v0
    v_lshlrev_b32 v11, 4, v11
    s_lshr_b32 s50, s2, 2
    s_and_b32 s51, s2, 3
    s_lshl_b32 s34, s50, 7
    s_and_b32 s49, s2, 31
    s_lshl_b32 s49, s49, 8
    s_and_b32 s35, s2, 0x80
    s_add_u32 s49, s49, s35
    s_bfe_u32 s53, s2, 0x20005
    s_cmpk_lt_u32 s2, 240
    s_cselect_b32 s38, 4915200, 0
    s_movk_i32 s48, 7680
    s_mul_i32 m0, s3, 5120
    s_and_b32 s52, s3, 3
    s_cmp_ge_u32 s3, 4
    s_cselect_b32 s34, s49, s34
    s_cselect_b32 s35, s53, s51
    s_cmovk_i32 s48, 8192
    s_cmov_b32 s38, 5242880
    s_mul_i32 s35, s35, 160
    s_mul_i32 s52, s52, 40
    v_add_u32 v10, s35, v10
    v_add_u32 v10, s52, v10
    v_mad_u32_u24 v8, v10, s48, v11
    s_mul_i32 s48, s48, 8
    s_mov_b32 s39, 0x20000
    s_waitcnt lgkmcnt(0)
    s_cselect_b32 s36, s10, s26
    s_cselect_b32 s37, s11, s27
    buffer_load_dwordx4 v8, s[36:39], s34 offen nt lds
    s_add_u32 m0, m0, 1024
    s_add_u32 s34, s34, s48
    buffer_load_dwordx4 v8, s[36:39], s34 offen nt lds
    s_add_u32 m0, m0, 1024
    s_add_u32 s34, s34, s48
    buffer_load_dwordx4 v8, s[36:39], s34 offen nt lds
    s_add_u32 m0, m0, 1024
    s_add_u32 s34, s34, s48
    buffer_load_dwordx4 v8, s[36:39], s34 offen nt lds
    s_add_u32 m0, m0, 1024
    s_add_u32 s34, s34, s48
    buffer_load_dwordx4 v8, s[36:39], s34 offen nt lds
    s_load_dwordx4 s[28:31], s[0:1], 96
    s_load_dwordx2 s[32:33], s[0:1], 112
    s_and_b32 s60, s2, 7
    s_lshr_b32 s61, s2, 3
    s_mov_b32 s39, 0x20000
    s_mov_b32 s43, 0x20000
    s_mov_b32 s46, 1835008
    s_mov_b32 s47, 0x20000
    s_cmp_lg_u32 s3, 0
    s_cbranch_scc1 L_stream
    s_setprio 3
    v_and_b32 v12, 3, v0
    v_bfe_u32 v13, v0, 2, 2
    v_lshrrev_b32 v14, 4, v0
    v_mul_u32_u24 v16, 1280, v12
    v_lshl_add_u32 v18, v14, 4, v16
    s_mul_i32 s34, s51, 320
    v_add_u32 v19, s34, v18
    s_sub_u32 s52, s50, 10
    s_waitcnt lgkmcnt(0)
    s_add_u32 s44, s32, 0
    s_addc_u32 s45, s33, 0
    s_cmp_ge_u32 s2, 240
    s_cbranch_scc1 L_clear
    v_lshlrev_b32 v1, 2, v0
    v_add_u32 v1, 98304, v1
    v_mov_b32 v2, -1
    v_mov_b32 v3, 0
    ds_write_b32 v1, v2
    ds_write_b32 v1, v2 offset:256
    ds_write_b32 v1, v3 offset:512
    ds_write_b32 v1, v3 offset:768
    s_waitcnt lgkmcnt(0)
    s_barrier
    s_cmp_ge_u32 s52, 10
    s_cbranch_scc1 L_nox
    v_lshl_add_u32 v18, v13, 6, v18
    global_load_dwordx4 v[52:55], v18, s[4:5] offset:0
    global_load_dwordx4 v[56:59], v18, s[4:5] offset:256
    global_load_dwordx4 v[60:63], v18, s[4:5] offset:512
    global_load_dwordx4 v[64:67], v18, s[4:5] offset:768
    global_load_dwordx4 v[68:71], v18, s[4:5] offset:1024
    s_lshl_b32 s34, s52, 7
    v_lshl_add_u32 v16, v13, 5, v16
    v_lshl_add_u32 v16, v14, 3, v16
    v_add_u32 v16, s34, v16
    global_load_dwordx2 v[72:73], v16, s[4:5]
L_nox:
    global_load_dwordx4 v[32:35], v19, s[24:25] offset:0
    global_load_dwordx4 v[36:39], v19, s[24:25] offset:64
    global_load_dwordx4 v[40:43], v19, s[24:25] offset:128
    global_load_dwordx4 v[44:47], v19, s[24:25] offset:192
    global_load_dwordx4 v[48:51], v19, s[24:25] offset:256
    v_lshl_add_u32 v15, v14, 3, v13
    v_lshlrev_b32 v15, 7, v15
    v_lshl_add_u32 v15, v12, 3, v15
    s_waitcnt vmcnt(0)
    s_mov_b32 s34, 0xbfb8aa3b
    v_lshlrev_b32 v20, 16, v32
    v_and_b32 v21, 0xffff0000, v32
    v_lshlrev_b32 v22, 16, v33
    v_and_b32 v23, 0xffff0000, v33
    v_mul_f32 v24, s34, v20
    v_mul_f32 v25, s34, v21
    v_mul_f32 v26, s34, v22
    v_mul_f32 v27, s34, v23
    v_exp_f32 v24, v24
    v_exp_f32 v25, v25
    v_exp_f32 v26, v26
    v_exp_f32 v27, v27
    v_add_f32 v24, 1.0, v24
    v_add_f32 v25, 1.0, v25
    v_add_f32 v26, 1.0, v26
    v_add_f32 v27, 1.0, v27
    v_rcp_f32 v24, v24
    v_rcp_f32 v25, v25
    v_rcp_f32 v26, v26
    v_rcp_f32 v27, v27
    v_mul_f32 v24, v20, v24
    v_mul_f32 v25, v21, v25
    v_mul_f32 v26, v22, v26
    v_mul_f32 v27, v23, v27
    v_cvt_pk_bf16_f32 v32, v24, v25
    v_cvt_pk_bf16_f32 v33, v26, v27
    v_lshlrev_b32 v20, 16, v34
    v_and_b32 v21, 0xffff0000, v34
    v_lshlrev_b32 v22, 16, v35
    v_and_b32 v23, 0xffff0000, v35
    v_mul_f32 v24, s34, v20
    v_mul_f32 v25, s34, v21
    v_mul_f32 v26, s34, v22
    v_mul_f32 v27, s34, v23
    v_exp_f32 v24, v24
    v_exp_f32 v25, v25
    v_exp_f32 v26, v26
    v_exp_f32 v27, v27
    v_add_f32 v24, 1.0, v24
    v_add_f32 v25, 1.0, v25
    v_add_f32 v26, 1.0, v26
    v_add_f32 v27, 1.0, v27
    v_rcp_f32 v24, v24
    v_rcp_f32 v25, v25
    v_rcp_f32 v26, v26
    v_rcp_f32 v27, v27
    v_mul_f32 v24, v20, v24
    v_mul_f32 v25, v21, v25
    v_mul_f32 v26, v22, v26
    v_mul_f32 v27, v23, v27
    v_cvt_pk_bf16_f32 v34, v24, v25
    v_cvt_pk_bf16_f32 v35, v26, v27
    v_lshlrev_b32 v20, 16, v36
    v_and_b32 v21, 0xffff0000, v36
    v_lshlrev_b32 v22, 16, v37
    v_and_b32 v23, 0xffff0000, v37
    v_mul_f32 v24, s34, v20
    v_mul_f32 v25, s34, v21
    v_mul_f32 v26, s34, v22
    v_mul_f32 v27, s34, v23
    v_exp_f32 v24, v24
    v_exp_f32 v25, v25
    v_exp_f32 v26, v26
    v_exp_f32 v27, v27
    v_add_f32 v24, 1.0, v24
    v_add_f32 v25, 1.0, v25
    v_add_f32 v26, 1.0, v26
    v_add_f32 v27, 1.0, v27
    v_rcp_f32 v24, v24
    v_rcp_f32 v25, v25
    v_rcp_f32 v26, v26
    v_rcp_f32 v27, v27
    v_mul_f32 v24, v20, v24
    v_mul_f32 v25, v21, v25
    v_mul_f32 v26, v22, v26
    v_mul_f32 v27, v23, v27
    v_cvt_pk_bf16_f32 v36, v24, v25
    v_cvt_pk_bf16_f32 v37, v26, v27
    v_lshlrev_b32 v20, 16, v38
    v_and_b32 v21, 0xffff0000, v38
    v_lshlrev_b32 v22, 16, v39
    v_and_b32 v23, 0xffff0000, v39
    v_mul_f32 v24, s34, v20
    v_mul_f32 v25, s34, v21
    v_mul_f32 v26, s34, v22
    v_mul_f32 v27, s34, v23
    v_exp_f32 v24, v24
    v_exp_f32 v25, v25
    v_exp_f32 v26, v26
    v_exp_f32 v27, v27
    v_add_f32 v24, 1.0, v24
    v_add_f32 v25, 1.0, v25
    v_add_f32 v26, 1.0, v26
    v_add_f32 v27, 1.0, v27
    v_rcp_f32 v24, v24
    v_rcp_f32 v25, v25
    v_rcp_f32 v26, v26
    v_rcp_f32 v27, v27
    v_mul_f32 v24, v20, v24
    v_mul_f32 v25, v21, v25
    v_mul_f32 v26, v22, v26
    v_mul_f32 v27, v23, v27
    v_cvt_pk_bf16_f32 v38, v24, v25
    v_cvt_pk_bf16_f32 v39, v26, v27
    v_lshlrev_b32 v20, 16, v40
    v_and_b32 v21, 0xffff0000, v40
    v_lshlrev_b32 v22, 16, v41
    v_and_b32 v23, 0xffff0000, v41
    v_mul_f32 v24, s34, v20
    v_mul_f32 v25, s34, v21
    v_mul_f32 v26, s34, v22
    v_mul_f32 v27, s34, v23
    v_exp_f32 v24, v24
    v_exp_f32 v25, v25
    v_exp_f32 v26, v26
    v_exp_f32 v27, v27
    v_add_f32 v24, 1.0, v24
    v_add_f32 v25, 1.0, v25
    v_add_f32 v26, 1.0, v26
    v_add_f32 v27, 1.0, v27
    v_rcp_f32 v24, v24
    v_rcp_f32 v25, v25
    v_rcp_f32 v26, v26
    v_rcp_f32 v27, v27
    v_mul_f32 v24, v20, v24
    v_mul_f32 v25, v21, v25
    v_mul_f32 v26, v22, v26
    v_mul_f32 v27, v23, v27
    v_cvt_pk_bf16_f32 v40, v24, v25
    v_cvt_pk_bf16_f32 v41, v26, v27
    v_lshlrev_b32 v20, 16, v42
    v_and_b32 v21, 0xffff0000, v42
    v_lshlrev_b32 v22, 16, v43
    v_and_b32 v23, 0xffff0000, v43
    v_mul_f32 v24, s34, v20
    v_mul_f32 v25, s34, v21
    v_mul_f32 v26, s34, v22
    v_mul_f32 v27, s34, v23
    v_exp_f32 v24, v24
    v_exp_f32 v25, v25
    v_exp_f32 v26, v26
    v_exp_f32 v27, v27
    v_add_f32 v24, 1.0, v24
    v_add_f32 v25, 1.0, v25
    v_add_f32 v26, 1.0, v26
    v_add_f32 v27, 1.0, v27
    v_rcp_f32 v24, v24
    v_rcp_f32 v25, v25
    v_rcp_f32 v26, v26
    v_rcp_f32 v27, v27
    v_mul_f32 v24, v20, v24
    v_mul_f32 v25, v21, v25
    v_mul_f32 v26, v22, v26
    v_mul_f32 v27, v23, v27
    v_cvt_pk_bf16_f32 v42, v24, v25
    v_cvt_pk_bf16_f32 v43, v26, v27
    v_lshlrev_b32 v20, 16, v44
    v_and_b32 v21, 0xffff0000, v44
    v_lshlrev_b32 v22, 16, v45
    v_and_b32 v23, 0xffff0000, v45
    v_mul_f32 v24, s34, v20
    v_mul_f32 v25, s34, v21
    v_mul_f32 v26, s34, v22
    v_mul_f32 v27, s34, v23
    v_exp_f32 v24, v24
    v_exp_f32 v25, v25
    v_exp_f32 v26, v26
    v_exp_f32 v27, v27
    v_add_f32 v24, 1.0, v24
    v_add_f32 v25, 1.0, v25
    v_add_f32 v26, 1.0, v26
    v_add_f32 v27, 1.0, v27
    v_rcp_f32 v24, v24
    v_rcp_f32 v25, v25
    v_rcp_f32 v26, v26
    v_rcp_f32 v27, v27
    v_mul_f32 v24, v20, v24
    v_mul_f32 v25, v21, v25
    v_mul_f32 v26, v22, v26
    v_mul_f32 v27, v23, v27
    v_cvt_pk_bf16_f32 v44, v24, v25
    v_cvt_pk_bf16_f32 v45, v26, v27
    v_lshlrev_b32 v20, 16, v46
    v_and_b32 v21, 0xffff0000, v46
    v_lshlrev_b32 v22, 16, v47
    v_and_b32 v23, 0xffff0000, v47
    v_mul_f32 v24, s34, v20
    v_mul_f32 v25, s34, v21
    v_mul_f32 v26, s34, v22
    v_mul_f32 v27, s34, v23
    v_exp_f32 v24, v24
    v_exp_f32 v25, v25
    v_exp_f32 v26, v26
    v_exp_f32 v27, v27
    v_add_f32 v24, 1.0, v24
    v_add_f32 v25, 1.0, v25
    v_add_f32 v26, 1.0, v26
    v_add_f32 v27, 1.0, v27
    v_rcp_f32 v24, v24
    v_rcp_f32 v25, v25
    v_rcp_f32 v26, v26
    v_rcp_f32 v27, v27
    v_mul_f32 v24, v20, v24
    v_mul_f32 v25, v21, v25
    v_mul_f32 v26, v22, v26
    v_mul_f32 v27, v23, v27
    v_cvt_pk_bf16_f32 v46, v24, v25
    v_cvt_pk_bf16_f32 v47, v26, v27
    v_lshlrev_b32 v20, 16, v48
    v_and_b32 v21, 0xffff0000, v48
    v_lshlrev_b32 v22, 16, v49
    v_and_b32 v23, 0xffff0000, v49
    v_mul_f32 v24, s34, v20
    v_mul_f32 v25, s34, v21
    v_mul_f32 v26, s34, v22
    v_mul_f32 v27, s34, v23
    v_exp_f32 v24, v24
    v_exp_f32 v25, v25
    v_exp_f32 v26, v26
    v_exp_f32 v27, v27
    v_add_f32 v24, 1.0, v24
    v_add_f32 v25, 1.0, v25
    v_add_f32 v26, 1.0, v26
    v_add_f32 v27, 1.0, v27
    v_rcp_f32 v24, v24
    v_rcp_f32 v25, v25
    v_rcp_f32 v26, v26
    v_rcp_f32 v27, v27
    v_mul_f32 v24, v20, v24
    v_mul_f32 v25, v21, v25
    v_mul_f32 v26, v22, v26
    v_mul_f32 v27, v23, v27
    v_cvt_pk_bf16_f32 v48, v24, v25
    v_cvt_pk_bf16_f32 v49, v26, v27
    v_lshlrev_b32 v20, 16, v50
    v_and_b32 v21, 0xffff0000, v50
    v_lshlrev_b32 v22, 16, v51
    v_and_b32 v23, 0xffff0000, v51
    v_mul_f32 v24, s34, v20
    v_mul_f32 v25, s34, v21
    v_mul_f32 v26, s34, v22
    v_mul_f32 v27, s34, v23
    v_exp_f32 v24, v24
    v_exp_f32 v25, v25
    v_exp_f32 v26, v26
    v_exp_f32 v27, v27
    v_add_f32 v24, 1.0, v24
    v_add_f32 v25, 1.0, v25
    v_add_f32 v26, 1.0, v26
    v_add_f32 v27, 1.0, v27
    v_rcp_f32 v24, v24
    v_rcp_f32 v25, v25
    v_rcp_f32 v26, v26
    v_rcp_f32 v27, v27
    v_mul_f32 v24, v20, v24
    v_mul_f32 v25, v21, v25
    v_mul_f32 v26, v22, v26
    v_mul_f32 v27, v23, v27
    v_cvt_pk_bf16_f32 v50, v24, v25
    v_cvt_pk_bf16_f32 v51, v26, v27
    s_cmp_ge_u32 s52, 10
    s_cbranch_scc1 L_nostats
    v_mov_b32 v20, 0
    v_mov_b32 v21, 0
    v_mov_b32 v22, 0x3f803f80
    v_dot2c_f32_bf16 v20, v52, v22
    v_dot2c_f32_bf16 v21, v52, v52
    v_dot2c_f32_bf16 v20, v53, v22
    v_dot2c_f32_bf16 v21, v53, v53
    v_dot2c_f32_bf16 v20, v54, v22
    v_dot2c_f32_bf16 v21, v54, v54
    v_dot2c_f32_bf16 v20, v55, v22
    v_dot2c_f32_bf16 v21, v55, v55
    v_dot2c_f32_bf16 v20, v56, v22
    v_dot2c_f32_bf16 v21, v56, v56
    v_dot2c_f32_bf16 v20, v57, v22
    v_dot2c_f32_bf16 v21, v57, v57
    v_dot2c_f32_bf16 v20, v58, v22
    v_dot2c_f32_bf16 v21, v58, v58
    v_dot2c_f32_bf16 v20, v59, v22
    v_dot2c_f32_bf16 v21, v59, v59
    v_dot2c_f32_bf16 v20, v60, v22
    v_dot2c_f32_bf16 v21, v60, v60
    v_dot2c_f32_bf16 v20, v61, v22
    v_dot2c_f32_bf16 v21, v61, v61
    v_dot2c_f32_bf16 v20, v62, v22
    v_dot2c_f32_bf16 v21, v62, v62
    v_dot2c_f32_bf16 v20, v63, v22
    v_dot2c_f32_bf16 v21, v63, v63
    v_dot2c_f32_bf16 v20, v64, v22
    v_dot2c_f32_bf16 v21, v64, v64
    v_dot2c_f32_bf16 v20, v65, v22
    v_dot2c_f32_bf16 v21, v65, v65
    v_dot2c_f32_bf16 v20, v66, v22
    v_dot2c_f32_bf16 v21, v66, v66
    v_dot2c_f32_bf16 v20, v67, v22
    v_dot2c_f32_bf16 v21, v67, v67
    v_dot2c_f32_bf16 v20, v68, v22
    v_dot2c_f32_bf16 v21, v68, v68
    v_dot2c_f32_bf16 v20, v69, v22
    v_dot2c_f32_bf16 v21, v69, v69
    v_dot2c_f32_bf16 v20, v70, v22
    v_dot2c_f32_bf16 v21, v70, v70
    v_dot2c_f32_bf16 v20, v71, v22
    v_dot2c_f32_bf16 v21, v71, v71
    s_nop 1
    v_add_f32_dpp v20, v20, v20 row_ror:4 row_mask:0xf bank_mask:0xf
    v_add_f32_dpp v21, v21, v21 row_ror:4 row_mask:0xf bank_mask:0xf
    s_nop 0
    v_add_f32_dpp v20, v20, v20 row_ror:8 row_mask:0xf bank_mask:0xf
    v_add_f32_dpp v21, v21, v21 row_ror:8 row_mask:0xf bank_mask:0xf
    v_mov_b32 v22, v20
    v_mov_b32 v23, v21
    s_nop 0
    v_permlane16_swap_b32 v20, v22
    v_permlane16_swap_b32 v21, v23
    v_add_f32 v20, v20, v22
    v_add_f32 v21, v21, v23
    v_mov_b32 v22, v20
    v_mov_b32 v23, v21
    s_nop 0
    v_permlane32_swap_b32 v20, v22
    v_permlane32_swap_b32 v21, v23
    v_add_f32 v20, v20, v22
    v_add_f32 v21, v21, v23
    v_mul_f32 v22, 0x3acccccd, v20
    v_mul_f32 v21, 0x3acccccd, v21
    v_fma_f32 v21, -v22, v22, v21
    v_max_f32 v21, 0, v21
    v_add_f32 v21, 0x3727c5ac, v21
    v_rsq_f32 v20, v21
    s_nop 0
    v_mul_f32_e64 v21, -v22, v20
    v_lshlrev_b32 v24, 16, v72
    v_and_b32 v25, 0xffff0000, v72
    v_lshlrev_b32 v26, 16, v73
    v_and_b32 v27, 0xffff0000, v73
    v_fma_f32 v24, v24, v20, v21
    v_fma_f32 v25, v25, v20, v21
    v_fma_f32 v26, v26, v20, v21
    v_fma_f32 v27, v27, v20, v21
L_nostats:
    ds_read_b64_tr_b16 v[96:97], v15 offset:0
    ds_read_b64_tr_b16 v[98:99], v15 offset:512
    ds_read_b64_tr_b16 v[100:101], v15 offset:32
    ds_read_b64_tr_b16 v[102:103], v15 offset:544
    ds_read_b64_tr_b16 v[104:105], v15 offset:64
    ds_read_b64_tr_b16 v[106:107], v15 offset:576
    ds_read_b64_tr_b16 v[108:109], v15 offset:96
    ds_read_b64_tr_b16 v[110:111], v15 offset:608
    s_waitcnt lgkmcnt(7)
    ds_read_b64_tr_b16 v[112:113], v15 offset:4096
    ds_read_b64_tr_b16 v[114:115], v15 offset:4608
    ds_read_b64_tr_b16 v[116:117], v15 offset:4128
    ds_read_b64_tr_b16 v[118:119], v15 offset:4640
    ds_read_b64_tr_b16 v[120:121], v15 offset:4160
    ds_read_b64_tr_b16 v[122:123], v15 offset:4672
    ds_read_b64_tr_b16 v[124:125], v15 offset:4192
    ds_read_b64_tr_b16 v[126:127], v15 offset:4704
    s_waitcnt lgkmcnt(7)
    ds_read_b64_tr_b16 v[128:129], v15 offset:8192
    ds_read_b64_tr_b16 v[130:131], v15 offset:8704
    ds_read_b64_tr_b16 v[132:133], v15 offset:8224
    ds_read_b64_tr_b16 v[134:135], v15 offset:8736
    ds_read_b64_tr_b16 v[136:137], v15 offset:8256
    ds_read_b64_tr_b16 v[138:139], v15 offset:8768
    ds_read_b64_tr_b16 v[140:141], v15 offset:8288
    ds_read_b64_tr_b16 v[142:143], v15 offset:8800
    s_waitcnt lgkmcnt(7)
    ds_read_b64_tr_b16 v[144:145], v15 offset:12288
    ds_read_b64_tr_b16 v[146:147], v15 offset:12800
    ds_read_b64_tr_b16 v[148:149], v15 offset:12320
    ds_read_b64_tr_b16 v[150:151], v15 offset:12832
    ds_read_b64_tr_b16 v[152:153], v15 offset:12352
    ds_read_b64_tr_b16 v[154:155], v15 offset:12864
    ds_read_b64_tr_b16 v[156:157], v15 offset:12384
    ds_read_b64_tr_b16 v[158:159], v15 offset:12896
    s_waitcnt lgkmcnt(7)
    ds_read_b64_tr_b16 v[160:161], v15 offset:16384
    ds_read_b64_tr_b16 v[162:163], v15 offset:16896
    ds_read_b64_tr_b16 v[164:165], v15 offset:16416
    ds_read_b64_tr_b16 v[166:167], v15 offset:16928
    ds_read_b64_tr_b16 v[168:169], v15 offset:16448
    ds_read_b64_tr_b16 v[170:171], v15 offset:16960
    ds_read_b64_tr_b16 v[172:173], v15 offset:16480
    ds_read_b64_tr_b16 v[174:175], v15 offset:16992
    s_waitcnt lgkmcnt(0)
    v_mfma_f32_16x16x32_bf16 v[80:83], v[96:99], v[32:35], 0
    v_mfma_f32_16x16x32_bf16 v[84:87], v[100:103], v[32:35], 0
    v_mfma_f32_16x16x32_bf16 v[88:91], v[104:107], v[32:35], 0
    v_mfma_f32_16x16x32_bf16 v[92:95], v[108:111], v[32:35], 0
    v_mfma_f32_16x16x32_bf16 v[80:83], v[112:115], v[36:39], v[80:83]
    v_mfma_f32_16x16x32_bf16 v[84:87], v[116:119], v[36:39], v[84:87]
    v_mfma_f32_16x16x32_bf16 v[88:91], v[120:123], v[36:39], v[88:91]
    v_mfma_f32_16x16x32_bf16 v[92:95], v[124:127], v[36:39], v[92:95]
    v_mfma_f32_16x16x32_bf16 v[80:83], v[128:131], v[40:43], v[80:83]
    v_mfma_f32_16x16x32_bf16 v[84:87], v[132:135], v[40:43], v[84:87]
    v_mfma_f32_16x16x32_bf16 v[88:91], v[136:139], v[40:43], v[88:91]
    v_mfma_f32_16x16x32_bf16 v[92:95], v[140:143], v[40:43], v[92:95]
    v_mfma_f32_16x16x32_bf16 v[80:83], v[144:147], v[44:47], v[80:83]
    v_mfma_f32_16x16x32_bf16 v[84:87], v[148:151], v[44:47], v[84:87]
    v_mfma_f32_16x16x32_bf16 v[88:91], v[152:155], v[44:47], v[88:91]
    v_mfma_f32_16x16x32_bf16 v[92:95], v[156:159], v[44:47], v[92:95]
    v_mfma_f32_16x16x32_bf16 v[80:83], v[160:163], v[48:51], v[80:83]
    v_mfma_f32_16x16x32_bf16 v[84:87], v[164:167], v[48:51], v[84:87]
    v_mfma_f32_16x16x32_bf16 v[88:91], v[168:171], v[48:51], v[88:91]
    v_mfma_f32_16x16x32_bf16 v[92:95], v[172:175], v[48:51], v[92:95]
    s_cmp_ge_u32 s50, 20
    s_cbranch_scc1 L_adr_rest
    s_cmp_lt_u32 s50, 10
    s_cselect_b32 s34, 5120, 0
    s_cselect_b32 s35, s50, s52
    s_lshl_b32 s35, s35, 9
    s_add_u32 s34, s34, s35
    s_lshl_b32 s35, s51, 15
    s_add_u32 s34, s34, s35
    v_lshrrev_b32 v19, 1, v14
    v_lshl_add_u32 v19, v13, 1, v19
    v_lshlrev_b32 v19, 6, v19
    v_lshl_add_u32 v19, v12, 4, v19
    v_and_b32 v20, 1, v14
    v_lshl_add_u32 v19, v20, 3, v19
    s_branch L_adr_done
L_adr_rest:
    s_lshl_b32 s34, s51, 15
    s_lshl_b32 s35, s50, 9
    s_add_u32 s34, s34, s35
    s_add_u32 s34, s34, 0
    v_lshlrev_b32 v19, 7, v12
    v_lshl_add_u32 v19, v13, 5, v19
    v_lshl_add_u32 v19, v14, 3, v19
    s_nop 3
L_adr_done:
    v_add_u32 v19, s34, v19
    v_mov_b32_dpp v80, v84 quad_perm:[0,1,2,3] row_mask:0xf bank_mask:0x2
    v_mov_b32_dpp v81, v85 quad_perm:[0,1,2,3] row_mask:0xf bank_mask:0x2
    v_mov_b32_dpp v82, v86 quad_perm:[0,1,2,3] row_mask:0xf bank_mask:0x2
    v_mov_b32_dpp v83, v87 quad_perm:[0,1,2,3] row_mask:0xf bank_mask:0x2
    v_mov_b32_dpp v80, v88 quad_perm:[0,1,2,3] row_mask:0xf bank_mask:0x4
    v_mov_b32_dpp v81, v89 quad_perm:[0,1,2,3] row_mask:0xf bank_mask:0x4
    v_mov_b32_dpp v82, v90 quad_perm:[0,1,2,3] row_mask:0xf bank_mask:0x4
    v_mov_b32_dpp v83, v91 quad_perm:[0,1,2,3] row_mask:0xf bank_mask:0x4
    v_mov_b32_dpp v80, v92 quad_perm:[0,1,2,3] row_mask:0xf bank_mask:0x8
    v_mov_b32_dpp v81, v93 quad_perm:[0,1,2,3] row_mask:0xf bank_mask:0x8
    v_mov_b32_dpp v82, v94 quad_perm:[0,1,2,3] row_mask:0xf bank_mask:0x8
    v_mov_b32_dpp v83, v95 quad_perm:[0,1,2,3] row_mask:0xf bank_mask:0x8
    s_cmp_ge_u32 s52, 10
    s_cbranch_scc1 L_noz
    v_add_f32 v80, 0x3e800000, v80
    v_add_f32 v81, 0x3e800000, v81
    v_add_f32 v82, 0x3e800000, v82
    v_add_f32 v83, 0x3e800000, v83
    v_mul_f32 v80, v80, v24
    v_mul_f32 v81, v81, v25
    v_mul_f32 v82, v82, v26
    v_mul_f32 v83, v83, v27
L_noz:
    v_cvt_pk_bf16_f32 v20, v80, v81
    v_cvt_pk_bf16_f32 v21, v82, v83
    v_min_u32 v20, -2, v20
    v_min_u32 v21, -2, v21
    v_mov_b32 v22, 99072
    s_mov_b32 s35, 0
L_poll1:
    ds_read_b32 v23, v22
    s_add_u32 s35, s35, 1
    s_waitcnt lgkmcnt(0)
    v_cmp_gt_u32 vcc, 14, v23
    s_cbranch_vccz L_done2
    s_sleep 2
    s_cmp_lt_u32 s35, 60000
    s_cbranch_scc1 L_poll1
L_done2:
    v_and_b32 v22, 15, v0
    v_lshlrev_b32 v22, 2, v22
    s_mov_b32 s35, 0
L_poll4:
    global_load_dword v23, v22, s[30:31] offset:128 sc1
    s_add_u32 s35, s35, 1
    s_waitcnt vmcnt(0)
    v_cmp_eq_u32 vcc, 0, v23
    s_cbranch_vccz L_done5
    s_sleep 8
    s_cmp_lt_u32 s35, 60000
    s_cbranch_scc1 L_poll4
L_done5:
    s_getreg_b32 s97, hwreg(HW_REG_XCC_ID, 0, 4)
    s_sub_u32 s97, s97, s2
    s_and_b32 s97, s97, 7
    s_add_u32 s97, s97, 1
    v_cmp_ne_u32 vcc, s97, v23
    s_nop 0
    s_mov_b32 s97, vcc_lo
    buffer_store_dwordx2 v[20:21], v19, s[44:47], 0 offen sc1
    s_branch L_p2
L_clear:
    s_sub_u32 s55, s2, 240
    s_lshr_b32 s34, s55, 2
    s_lshl_b32 s35, s34, 3
    s_lshr_b32 s54, 538910750, s35
    s_and_b32 s54, s54, 0xff
    s_lshl_b32 s54, s54, 10
    s_mul_i32 s34, s34, 393216
    s_lshl_b32 s35, s51, 15
    s_add_u32 s34, s34, s35
    v_lshl_add_u32 v9, v0, 4, s34
    v_mov_b32 v4, -1
    v_mov_b32 v5, -1
    v_mov_b32 v6, -1
    v_mov_b32 v7, -1
    s_lshl_b32 s34, s3, 10
L_clrloop:
    buffer_store_dwordx4 v[4:7], v9, s[44:47], s34 offen offset:0 sc1
    s_add_u32 s34, s34, 1024
    s_cmp_lt_u32 s34, s54
    s_cbranch_scc1 L_clrloop
L_clrend:
    s_cmp_ge_u32 s55, 4
    s_cbranch_scc1 L_clrend2
    s_mov_b32 s34, 1572864
    buffer_store_dwordx4 v[4:7], v9, s[44:47], s34 offen sc1
    s_mov_b32 s34, 1573888
    buffer_store_dwordx4 v[4:7], v9, s[44:47], s34 offen sc1
    s_mov_b32 s34, 1574912
    buffer_store_dwordx4 v[4:7], v9, s[44:47], s34 offen sc1
    s_mov_b32 s34, 1575936
    buffer_store_dwordx4 v[4:7], v9, s[44:47], s34 offen sc1
    s_mov_b32 s34, 1576960
    buffer_store_dwordx4 v[4:7], v9, s[44:47], s34 offen sc1
L_clrend2:
    s_lshr_b32 s35, s55, 2
    s_mul_i32 s35, s35, -385024
    s_add_u32 s34, s35, 1709056
    buffer_store_dwordx4 v[4:7], v9, s[44:47], s34 offen sc1
    s_add_u32 s34, s35, 1710080
    buffer_store_dwordx4 v[4:7], v9, s[44:47], s34 offen sc1
    v_lshlrev_b32 v1, 2, v0
    v_add_u32 v1, 98304, v1
    v_mov_b32 v2, -1
    v_mov_b32 v3, 0
    ds_write_b32 v1, v2
    ds_write_b32 v1, v2 offset:256
    ds_write_b32 v1, v3 offset:512
    ds_write_b32 v1, v3 offset:768
    s_waitcnt lgkmcnt(0)
    s_barrier
    s_lshl_b32 s34, s55, 2
    v_mov_b32 v24, s34
    s_getreg_b32 s97, hwreg(HW_REG_XCC_ID, 0, 4)
    s_sub_u32 s97, s97, s2
    s_and_b32 s97, s97, 7
    s_add_u32 s97, s97, 1
    v_mov_b32 v25, s97
    v_mov_b32 v19, v9
    v_readfirstlane_b32 s90, v9
    s_mov_b32 s91, 0
    s_waitcnt vmcnt(0)
    s_mov_b64 exec, 1
    global_store_dword v24, v25, s[30:31] offset:128 sc1
    s_mov_b64 exec, -1
    v_lshl_add_u32 v15, v14, 3, v13
    v_lshlrev_b32 v15, 7, v15
    v_lshl_add_u32 v15, v12, 3, v15
    s_cmp_ge_u32 s55, 10
    s_cbranch_scc1 L_novote
    s_add_u32 s34, s90, 0
    s_add_u32 s35, s90, 8192
    s_mov_b64 s[88:89], 0
    s_load_dword s88, s[44:45], s34
    s_load_dword s89, s[44:45], s35
    s_waitcnt lgkmcnt(1)
    s_cmp_lg_u32 s89, 0
    s_addc_u32 s91, s91, 0
    s_waitcnt lgkmcnt(0)
    s_add_u32 s34, s90, 1024
    s_add_u32 s35, s90, 9216
    s_mov_b64 s[88:89], 0
    s_load_dword s89, s[44:45], s35
    s_load_dword s88, s[44:45], s34
    s_waitcnt lgkmcnt(1)
    s_cmp_eq_u32 s88, 0
    s_addc_u32 s91, s91, 0
    s_waitcnt lgkmcnt(0)
    s_getreg_b32 s34, hwreg(HW_REG_XCC_ID, 2, 1)
    s_sub_u32 s35, 1, s91
    s_sub_u32 s91, s91, 1
    s_cmp_eq_u32 s34, 0
    s_cselect_b32 s91, s91, s35
    v_mov_b32 v25, s91
    s_mov_b64 exec, 1
    global_store_dword v24, v25, s[30:31] sc1
    s_mov_b64 exec, -1
L_novote:
    v_mov_b32 v22, 99072
    s_mov_b32 s35, 0
L_poll7:
    ds_read_b32 v23, v22
    s_add_u32 s35, s35, 1
    s_waitcnt lgkmcnt(0)
    v_cmp_gt_u32 vcc, 14, v23
    s_cbranch_vccz L_done8
    s_sleep 2
    s_cmp_lt_u32 s35, 60000
    s_cbranch_scc1 L_poll7
L_done8:
    v_and_b32 v22, 15, v0
    v_lshlrev_b32 v22, 2, v22
    s_mov_b32 s35, 0
L_poll10:
    global_load_dword v23, v22, s[30:31] offset:128 sc1
    s_add_u32 s35, s35, 1
    s_waitcnt vmcnt(0)
    v_cmp_eq_u32 vcc, 0, v23
    s_cbranch_vccz L_done11
    s_sleep 8
    s_cmp_lt_u32 s35, 60000
    s_cbranch_scc1 L_poll10
L_done11:
    s_getreg_b32 s97, hwreg(HW_REG_XCC_ID, 0, 4)
    s_sub_u32 s97, s97, s2
    s_and_b32 s97, s97, 7
    s_add_u32 s97, s97, 1
    v_cmp_ne_u32 vcc, s97, v23
    s_nop 0
    s_mov_b32 s97, vcc_lo
L_p2:
    v_mov_b32 v199, v19
    ds_read_b64_tr_b16 v[96:97], v15 offset:20480
    ds_read_b64_tr_b16 v[98:99], v15 offset:20992
    ds_read_b64_tr_b16 v[100:101], v15 offset:20512
    ds_read_b64_tr_b16 v[102:103], v15 offset:21024
    ds_read_b64_tr_b16 v[104:105], v15 offset:20544
    ds_read_b64_tr_b16 v[106:107], v15 offset:21056
    ds_read_b64_tr_b16 v[108:109], v15 offset:20576
    ds_read_b64_tr_b16 v[110:111], v15 offset:21088
    s_waitcnt lgkmcnt(7)
    ds_read_b64_tr_b16 v[112:113], v15 offset:24576
    ds_read_b64_tr_b16 v[114:115], v15 offset:25088
    ds_read_b64_tr_b16 v[116:117], v15 offset:24608
    ds_read_b64_tr_b16 v[118:119], v15 offset:25120
    ds_read_b64_tr_b16 v[120:121], v15 offset:24640
    ds_read_b64_tr_b16 v[122:123], v15 offset:25152
    ds_read_b64_tr_b16 v[124:125], v15 offset:24672
    ds_read_b64_tr_b16 v[126:127], v15 offset:25184
    s_waitcnt lgkmcnt(7)
    ds_read_b64_tr_b16 v[128:129], v15 offset:28672
    ds_read_b64_tr_b16 v[130:131], v15 offset:29184
    ds_read_b64_tr_b16 v[132:133], v15 offset:28704
    ds_read_b64_tr_b16 v[134:135], v15 offset:29216
    ds_read_b64_tr_b16 v[136:137], v15 offset:28736
    ds_read_b64_tr_b16 v[138:139], v15 offset:29248
    ds_read_b64_tr_b16 v[140:141], v15 offset:28768
    ds_read_b64_tr_b16 v[142:143], v15 offset:29280
    s_waitcnt lgkmcnt(7)
    ds_read_b64_tr_b16 v[144:145], v15 offset:32768
    ds_read_b64_tr_b16 v[146:147], v15 offset:33280
    ds_read_b64_tr_b16 v[148:149], v15 offset:32800
    ds_read_b64_tr_b16 v[150:151], v15 offset:33312
    ds_read_b64_tr_b16 v[152:153], v15 offset:32832
    ds_read_b64_tr_b16 v[154:155], v15 offset:33344
    ds_read_b64_tr_b16 v[156:157], v15 offset:32864
    ds_read_b64_tr_b16 v[158:159], v15 offset:33376
    s_waitcnt lgkmcnt(7)
    ds_read_b64_tr_b16 v[160:161], v15 offset:36864
    ds_read_b64_tr_b16 v[162:163], v15 offset:37376
    ds_read_b64_tr_b16 v[164:165], v15 offset:36896
    ds_read_b64_tr_b16 v[166:167], v15 offset:37408
    ds_read_b64_tr_b16 v[168:169], v15 offset:36928
    ds_read_b64_tr_b16 v[170:171], v15 offset:37440
    ds_read_b64_tr_b16 v[172:173], v15 offset:36960
    ds_read_b64_tr_b16 v[174:175], v15 offset:37472
    s_waitcnt lgkmcnt(0)
    s_mul_i32 s34, s53, 1280
    v_lshlrev_b32 v19, 15, v13
    v_lshl_add_u32 v19, v14, 6, v19
    v_lshl_add_u32 v19, v12, 4, v19
    v_add_u32 v19, s34, v19
    s_movk_i32 s48, 5120
    s_mov_b32 s56, 32768
    s_mov_b32 s57, 65536
    s_mov_b32 s58, 98304
    s_sub_u32 s34, s2, 80
    s_cmp_lt_u32 s34, 160
    s_cselect_b32 s54, 1, 0
    s_and_b32 s34, s2, 3
    s_cselect_b32 s54, 0, s54
    v_mov_b32 v180, 0
    v_mov_b32 v181, 0
    v_mov_b32 v182, 0
    v_mov_b32 v183, 0
    v_mov_b32 v184, 0
    v_mov_b32 v185, 0
    v_mov_b32 v186, 0
    v_mov_b32 v187, 0
    v_mov_b32 v22, 99072
    s_mov_b32 s35, 0
L_poll13:
    ds_read_b32 v23, v22
    s_add_u32 s35, s35, 1
    s_waitcnt lgkmcnt(0)
    v_cmp_gt_u32 vcc, 22, v23
    s_cbranch_vccz L_done14
    s_sleep 2
    s_cmp_lt_u32 s35, 60000
    s_cbranch_scc1 L_poll13
L_done14:
    s_mov_b32 s35, 0
L_poll16:
    buffer_load_dwordx4 v[32:35], v19, s[44:47], 0 offen offset:0 sc1
    buffer_load_dwordx4 v[36:39], v19, s[44:47], s48 offen offset:0 sc1
    buffer_load_dwordx4 v[40:43], v19, s[44:47], 0 offen offset:256 sc1
    buffer_load_dwordx4 v[44:47], v19, s[44:47], s48 offen offset:256 sc1
    buffer_load_dwordx4 v[48:51], v19, s[44:47], 0 offen offset:512 sc1
    buffer_load_dwordx4 v[52:55], v19, s[44:47], s48 offen offset:512 sc1
    buffer_load_dwordx4 v[56:59], v19, s[44:47], 0 offen offset:768 sc1
    buffer_load_dwordx4 v[60:63], v19, s[44:47], s48 offen offset:768 sc1
    buffer_load_dwordx4 v[64:67], v19, s[44:47], 0 offen offset:1024 sc1
    buffer_load_dwordx4 v[68:71], v19, s[44:47], s48 offen offset:1024 sc1
    s_cmp_eq_u32 s54, 0
    s_cbranch_scc1 L_hskip
    buffer_load_dwordx2 v[180:181], v199, s[44:47], 0 offen sc1
    buffer_load_dwordx2 v[182:183], v199, s[44:47], s56 offen sc1
    buffer_load_dwordx2 v[184:185], v199, s[44:47], s57 offen sc1
    buffer_load_dwordx2 v[186:187], v199, s[44:47], s58 offen sc1
L_hskip:
    s_add_u32 s35, s35, 1
    s_waitcnt vmcnt(0)
    v_max3_u32 v20, v32, v33, v34
    v_max3_u32 v20, v20, v35, v36
    v_max3_u32 v20, v20, v37, v38
    v_max3_u32 v20, v20, v39, v40
    v_max3_u32 v20, v20, v41, v42
    v_max3_u32 v20, v20, v43, v44
    v_max3_u32 v20, v20, v45, v46
    v_max3_u32 v20, v20, v47, v48
    v_max3_u32 v20, v20, v49, v50
    v_max3_u32 v20, v20, v51, v52
    v_max3_u32 v20, v20, v53, v54
    v_max3_u32 v20, v20, v55, v56
    v_max3_u32 v20, v20, v57, v58
    v_max3_u32 v20, v20, v59, v60
    v_max3_u32 v20, v20, v61, v62
    v_max3_u32 v20, v20, v63, v64
    v_max3_u32 v20, v20, v65, v66
    v_max3_u32 v20, v20, v67, v68
    v_max3_u32 v20, v20, v69, v70
    v_max3_u32 v20, v20, v71, v180
    v_max3_u32 v20, v20, v181, v182
    v_max3_u32 v20, v20, v183, v184
    v_max3_u32 v20, v20, v185, v186
    v_max_u32 v20, v20, v187
    v_cmp_eq_u32 vcc, -1, v20
    s_cbranch_vccz L_done17
    s_sleep 16
    s_cmp_lt_u32 s35, 60000
    s_cbranch_scc1 L_poll16
L_done17:
    v_mfma_f32_16x16x32_bf16 v[80:83], v[96:99], v[32:35], 0
    v_mfma_f32_16x16x32_bf16 v[84:87], v[100:103], v[32:35], 0
    v_mfma_f32_16x16x32_bf16 v[88:91], v[104:107], v[32:35], 0
    v_mfma_f32_16x16x32_bf16 v[92:95], v[108:111], v[32:35], 0
    v_mfma_f32_16x16x32_bf16 v[80:83], v[96:99], v[36:39], v[80:83]
    v_mfma_f32_16x16x32_bf16 v[84:87], v[100:103], v[36:39], v[84:87]
    v_mfma_f32_16x16x32_bf16 v[88:91], v[104:107], v[36:39], v[88:91]
    v_mfma_f32_16x16x32_bf16 v[92:95], v[108:111], v[36:39], v[92:95]
    v_mfma_f32_16x16x32_bf16 v[80:83], v[112:115], v[40:43], v[80:83]
    v_mfma_f32_16x16x32_bf16 v[84:87], v[116:119], v[40:43], v[84:87]
    v_mfma_f32_16x16x32_bf16 v[88:91], v[120:123], v[40:43], v[88:91]
    v_mfma_f32_16x16x32_bf16 v[92:95], v[124:127], v[40:43], v[92:95]
    v_mfma_f32_16x16x32_bf16 v[80:83], v[112:115], v[44:47], v[80:83]
    v_mfma_f32_16x16x32_bf16 v[84:87], v[116:119], v[44:47], v[84:87]
    v_mfma_f32_16x16x32_bf16 v[88:91], v[120:123], v[44:47], v[88:91]
    v_mfma_f32_16x16x32_bf16 v[92:95], v[124:127], v[44:47], v[92:95]
    v_mfma_f32_16x16x32_bf16 v[80:83], v[128:131], v[48:51], v[80:83]
    v_mfma_f32_16x16x32_bf16 v[84:87], v[132:135], v[48:51], v[84:87]
    v_mfma_f32_16x16x32_bf16 v[88:91], v[136:139], v[48:51], v[88:91]
    v_mfma_f32_16x16x32_bf16 v[92:95], v[140:143], v[48:51], v[92:95]
    v_mfma_f32_16x16x32_bf16 v[80:83], v[128:131], v[52:55], v[80:83]
    v_mfma_f32_16x16x32_bf16 v[84:87], v[132:135], v[52:55], v[84:87]
    v_mfma_f32_16x16x32_bf16 v[88:91], v[136:139], v[52:55], v[88:91]
    v_mfma_f32_16x16x32_bf16 v[92:95], v[140:143], v[52:55], v[92:95]
    v_mfma_f32_16x16x32_bf16 v[80:83], v[144:147], v[56:59], v[80:83]
    v_mfma_f32_16x16x32_bf16 v[84:87], v[148:151], v[56:59], v[84:87]
    v_mfma_f32_16x16x32_bf16 v[88:91], v[152:155], v[56:59], v[88:91]
    v_mfma_f32_16x16x32_bf16 v[92:95], v[156:159], v[56:59], v[92:95]
    v_mfma_f32_16x16x32_bf16 v[80:83], v[144:147], v[60:63], v[80:83]
    v_mfma_f32_16x16x32_bf16 v[84:87], v[148:151], v[60:63], v[84:87]
    v_mfma_f32_16x16x32_bf16 v[88:91], v[152:155], v[60:63], v[88:91]
    v_mfma_f32_16x16x32_bf16 v[92:95], v[156:159], v[60:63], v[92:95]
    v_mfma_f32_16x16x32_bf16 v[80:83], v[160:163], v[64:67], v[80:83]
    v_mfma_f32_16x16x32_bf16 v[84:87], v[164:167], v[64:67], v[84:87]
    v_mfma_f32_16x16x32_bf16 v[88:91], v[168:171], v[64:67], v[88:91]
    v_mfma_f32_16x16x32_bf16 v[92:95], v[172:175], v[64:67], v[92:95]
    v_mfma_f32_16x16x32_bf16 v[80:83], v[160:163], v[68:71], v[80:83]
    v_mfma_f32_16x16x32_bf16 v[84:87], v[164:167], v[68:71], v[84:87]
    v_mfma_f32_16x16x32_bf16 v[88:91], v[168:171], v[68:71], v[88:91]
    v_mfma_f32_16x16x32_bf16 v[92:95], v[172:175], v[68:71], v[92:95]
    s_lshl_b32 s34, s53, 15
    s_lshl_b32 s35, s49, 2
    s_add_u32 s34, s34, s35
    s_add_u32 s34, s34, 393216
    v_lshlrev_b32 v19, 7, v12
    v_lshl_add_u32 v19, v13, 5, v19
    v_lshl_add_u32 v19, v14, 3, v19
    v_add_u32 v19, s34, v19
    v_add_f32_dpp v20, v80, v80 row_ror:8 row_mask:0xf bank_mask:0x3
    v_add_f32_dpp v24, v84, v84 row_ror:8 row_mask:0xf bank_mask:0x3
    v_add_f32_dpp v21, v81, v81 row_ror:8 row_mask:0xf bank_mask:0x3
    v_add_f32_dpp v25, v85, v85 row_ror:8 row_mask:0xf bank_mask:0x3
    v_add_f32_dpp v22, v82, v82 row_ror:8 row_mask:0xf bank_mask:0x3
    v_add_f32_dpp v26, v86, v86 row_ror:8 row_mask:0xf bank_mask:0x3
    v_add_f32_dpp v23, v83, v83 row_ror:8 row_mask:0xf bank_mask:0x3
    v_add_f32_dpp v27, v87, v87 row_ror:8 row_mask:0xf bank_mask:0x3
    v_add_f32_dpp v20, v88, v88 row_ror:8 row_mask:0xf bank_mask:0xc
    v_add_f32_dpp v24, v92, v92 row_ror:8 row_mask:0xf bank_mask:0xc
    v_add_f32_dpp v21, v89, v89 row_ror:8 row_mask:0xf bank_mask:0xc
    v_add_f32_dpp v25, v93, v93 row_ror:8 row_mask:0xf bank_mask:0xc
    v_add_f32_dpp v22, v90, v90 row_ror:8 row_mask:0xf bank_mask:0xc
    v_add_f32_dpp v26, v94, v94 row_ror:8 row_mask:0xf bank_mask:0xc
    v_add_f32_dpp v23, v91, v91 row_ror:8 row_mask:0xf bank_mask:0xc
    v_add_f32_dpp v27, v95, v95 row_ror:8 row_mask:0xf bank_mask:0xc
    v_add_f32_dpp v28, v20, v20 row_shl:4 row_mask:0xf bank_mask:0x5
    v_add_f32_dpp v29, v21, v21 row_shl:4 row_mask:0xf bank_mask:0x5
    v_add_f32_dpp v30, v22, v22 row_shl:4 row_mask:0xf bank_mask:0x5
    v_add_f32_dpp v31, v23, v23 row_shl:4 row_mask:0xf bank_mask:0x5
    v_add_f32_dpp v28, v24, v24 row_shr:4 row_mask:0xf bank_mask:0xa
    v_add_f32_dpp v29, v25, v25 row_shr:4 row_mask:0xf bank_mask:0xa
    v_add_f32_dpp v30, v26, v26 row_shr:4 row_mask:0xf bank_mask:0xa
    v_add_f32_dpp v31, v27, v27 row_shr:4 row_mask:0xf bank_mask:0xa
    v_cvt_pk_bf16_f32 v20, v28, v29
    v_cvt_pk_bf16_f32 v21, v30, v31
    v_min_u32 v20, -2, v20
    v_min_u32 v21, -2, v21
    buffer_store_dwordx2 v[20:21], v19, s[44:47], 0 offen sc1
    s_cmp_eq_u32 s54, 0
    s_cbranch_scc1 L_nomf
    v_lshlrev_b32 v24, 16, v180
    v_and_b32 v25, 0xffff0000, v180
    v_lshlrev_b32 v26, 16, v181
    v_and_b32 v27, 0xffff0000, v181
    v_lshlrev_b32 v28, 16, v182
    v_and_b32 v29, 0xffff0000, v182
    v_lshlrev_b32 v30, 16, v183
    v_and_b32 v31, 0xffff0000, v183
    v_add_f32 v24, v24, v28
    v_add_f32 v25, v25, v29
    v_add_f32 v26, v26, v30
    v_add_f32 v27, v27, v31
    v_lshlrev_b32 v28, 16, v184
    v_and_b32 v29, 0xffff0000, v184
    v_lshlrev_b32 v30, 16, v185
    v_and_b32 v31, 0xffff0000, v185
    v_add_f32 v24, v24, v28
    v_add_f32 v25, v25, v29
    v_add_f32 v26, v26, v30
    v_add_f32 v27, v27, v31
    v_lshlrev_b32 v28, 16, v186
    v_and_b32 v29, 0xffff0000, v186
    v_lshlrev_b32 v30, 16, v187
    v_and_b32 v31, 0xffff0000, v187
    v_add_f32 v24, v24, v28
    v_add_f32 v25, v25, v29
    v_add_f32 v26, v26, v30
    v_add_f32 v27, v27, v31
    v_cvt_pk_bf16_f32 v22, v24, v25
    v_cvt_pk_bf16_f32 v23, v26, v27
    v_min_u32 v22, -2, v22
    v_min_u32 v23, -2, v23
    s_sub_u32 s34, s50, 20
    s_lshl_b32 s35, s34, 9
    v_subrev_u32 v199, s35, v199
    s_lshr_b32 s35, s34, 2
    s_lshl_b32 s35, s35, 9
    s_and_b32 s34, s34, 3
    s_lshl_b32 s34, s34, 15
    s_add_u32 s34, s34, s35
    s_add_u32 s34, s34, 1562624
    v_add_u32 v199, s34, v199
    buffer_store_dwordx2 v[22:23], v199, s[44:47], 0 offen sc1
L_nomf:
    s_and_b32 s34, s2, 127
    s_lshl_b32 s34, s34, 21
    s_lshr_b32 s35, s2, 7
    s_lshl_b32 s35, s35, 18
    s_add_u32 s34, s34, s35
    s_add_u32 s34, s34, 1572864
    s_mov_b32 s38, 0x40000
    s_mov_b32 s42, 0x40000
    s_waitcnt lgkmcnt(0)
    s_add_u32 s36, s6, s34
    s_addc_u32 s37, s7, 0
    s_add_u32 s40, s8, s34
    s_addc_u32 s41, s9, 0
    v_lshlrev_b32 v18, 4, v0
    s_mov_b32 s34, 258048
    buffer_load_dwordx4 v[128:131], v18, s[36:39], s34 offen offset:0 nt
    buffer_load_dwordx4 v[132:135], v18, s[36:39], s34 offen offset:1024 nt
    buffer_load_dwordx4 v[136:139], v18, s[36:39], s34 offen offset:2048 nt
    buffer_load_dwordx4 v[140:143], v18, s[36:39], s34 offen offset:3072 nt
    s_and_b32 s34, s2, 31
    s_lshl_b32 s34, s34, 10
    s_lshl_b32 s35, s53, 7
    s_add_u32 s34, s34, s35
    s_add_u32 s34, s34, 393216
    v_lshrrev_b32 v19, 5, v0
    v_mul_u32_u24 v19, 384, v19
    v_lshl_add_u32 v19, v0, 2, v19
    v_add_u32 v19, s34, v19
    v_mov_b32 v22, 99072
    s_and_b32 s34, s60, 3
    s_lshl_b32 s34, s34, 15
    s_lshr_b32 s35, s60, 2
    s_lshl_b32 s35, s35, 7
    s_add_u32 s34, s34, s35
    s_add_u32 s34, s34, 793344
    v_and_b32 v252, 31, v0
    v_lshl_add_u32 v252, v252, 2, s34
    v_mov_b32 v253, 0
    s_mov_b32 s35, 0
L_poll19:
    ds_read_b32 v23, v22
    s_add_u32 s35, s35, 1
    s_waitcnt lgkmcnt(0)
    v_cmp_gt_u32 vcc, 34, v23
    s_cbranch_vccz L_done20
    s_sleep 2
    s_cmp_lt_u32 s35, 60000
    s_cbranch_scc1 L_poll19
L_done20:
    buffer_load_dword v251, v252, s[44:47], 0 offen sc1
    s_lshl_b64 exec, 1, s61
    buffer_store_dword v253, v252, s[44:47], 0 offen
    s_mov_b64 exec, -1
    v_and_b32 v44, 15, v0
    v_lshlrev_b32 v44, 2, v44
    global_load_dword v44, v44, s[30:31] sc1
    s_mov_b32 s35, 0
L_poll22:
    buffer_load_dword v32, v19, s[44:47], 0 offen sc1
    buffer_load_dword v33, v19, s[44:47], s56 offen sc1
    buffer_load_dword v34, v19, s[44:47], s57 offen sc1
    buffer_load_dword v35, v19, s[44:47], s58 offen sc1
    s_add_u32 s35, s35, 1
    s_waitcnt vmcnt(0)
    v_max3_u32 v22, v32, v33, v34
    v_max_u32 v22, v22, v35
    v_cmp_eq_u32 vcc, -1, v22
    s_cbranch_vccz L_done23
    s_sleep 16
    s_cmp_lt_u32 s35, 60000
    s_cbranch_scc1 L_poll22
L_done23:
    v_cmp_ne_u32 vcc, -1, v251
    v_mov_b32 v248, v252
    v_mov_b32 v252, 99076
    s_bcnt1_i32_b32 s34, vcc_lo
    s_mov_b32 s91, s34
    v_mov_b32 v251, s34
    s_mov_b64 exec, 1
    ds_write_b32 v252, v251
    s_mov_b64 exec, -1
    v_add_u32_dpp v44, v44, v44 row_ror:8 row_mask:0xf bank_mask:0xf
    s_nop 1
    v_add_u32_dpp v44, v44, v44 row_ror:4 row_mask:0xf bank_mask:0xf
    s_nop 1
    v_add_u32_dpp v44, v44, v44 row_ror:2 row_mask:0xf bank_mask:0xf
    s_nop 1
    v_add_u32_dpp v44, v44, v44 row_ror:1 row_mask:0xf bank_mask:0xf
    s_nop 0
    v_readfirstlane_b32 s99, v44
    s_nop 0
    s_cmp_gt_i32 s99, 0
    s_cselect_b32 s99, 1, 0
    s_getreg_b32 s34, hwreg(HW_REG_XCC_ID, 2, 1)
    s_xor_b32 s99, s99, s34
    s_lshl_b32 s99, s99, 13
    v_mov_b32 v45, 99080
    v_mov_b32 v44, s99
    ds_write_b32 v45, v44
    v_lshlrev_b32 v36, 16, v32
    v_and_b32 v37, 0xffff0000, v32
    v_lshlrev_b32 v38, 16, v33
    v_and_b32 v39, 0xffff0000, v33
    v_lshlrev_b32 v40, 16, v34
    v_and_b32 v41, 0xffff0000, v34
    v_lshlrev_b32 v42, 16, v35
    v_and_b32 v43, 0xffff0000, v35
    v_pk_add_f32 v[36:37], v[36:37], v[38:39]
    v_pk_add_f32 v[40:41], v[40:41], v[42:43]
    v_pk_add_f32 v[36:37], v[36:37], v[40:41]
    v_cvt_pk_bf16_f32 v32, v36, v37
    v_min_u32 v32, -2, v32
    ds_write_b32 v1, v32
    s_mov_b32 s34, 258048
    buffer_load_dwordx4 v[144:147], v18, s[40:43], s34 offen offset:0 nt
    buffer_load_dwordx4 v[148:151], v18, s[40:43], s34 offen offset:1024 nt
    buffer_load_dwordx4 v[152:155], v18, s[40:43], s34 offen offset:2048 nt
    buffer_load_dwordx4 v[156:159], v18, s[40:43], s34 offen offset:3072 nt
    v_and_b32 v2, 15, v0
    v_lshlrev_b32 v2, 4, v2
    v_add_u32 v2, 98304, v2
    ds_read_b128 v[4:7], v2
    s_waitcnt lgkmcnt(0)
    v_dot2_f32_bf16 v8, v128, v4, 0
    v_dot2_f32_bf16 v9, v132, v4, 0
    v_dot2_f32_bf16 v10, v136, v4, 0
    v_dot2_f32_bf16 v11, v140, v4, 0
    v_dot2c_f32_bf16 v8, v129, v5
    v_dot2c_f32_bf16 v9, v133, v5
    v_dot2c_f32_bf16 v10, v137, v5
    v_dot2c_f32_bf16 v11, v141, v5
    v_dot2c_f32_bf16 v8, v130, v6
    v_dot2c_f32_bf16 v9, v134, v6
    v_dot2c_f32_bf16 v10, v138, v6
    v_dot2c_f32_bf16 v11, v142, v6
    v_dot2c_f32_bf16 v8, v131, v7
    v_dot2c_f32_bf16 v9, v135, v7
    v_dot2c_f32_bf16 v10, v139, v7
    v_dot2c_f32_bf16 v11, v143, v7
    v_add_f32_dpp v16, v8, v8 row_ror:8 row_mask:0xf bank_mask:0x3
    v_add_f32_dpp v16, v9, v9 row_ror:8 row_mask:0xf bank_mask:0xc
    v_add_f32_dpp v17, v10, v10 row_ror:8 row_mask:0xf bank_mask:0x3
    v_add_f32_dpp v17, v11, v11 row_ror:8 row_mask:0xf bank_mask:0xc
    v_add_f32_dpp v16, v16, v16 row_half_mirror row_mask:0xf bank_mask:0xf
    s_nop 0
    v_add_f32_dpp v17, v17, v17 row_half_mirror row_mask:0xf bank_mask:0xf
    v_add_f32_dpp v16, v16, v16 quad_perm:[1,0,3,2] row_mask:0xf bank_mask:0xf
    s_nop 0
    v_add_f32_dpp v17, v17, v17 quad_perm:[1,0,3,2] row_mask:0xf bank_mask:0xf
    v_add_f32_dpp v16, v16, v16 quad_perm:[2,3,0,1] row_mask:0xf bank_mask:0xf
    s_nop 0
    v_add_f32_dpp v17, v17, v17 quad_perm:[2,3,0,1] row_mask:0xf bank_mask:0xf
    v_max_f32 v8, v16, v17
    s_mov_b32 s34, 0x3e0293ee
    s_nop 0
    v_max_f32_dpp v8, v8, v8 row_ror:8 row_mask:0xf bank_mask:0xf
    v_mov_b32 v9, v8
    s_nop 1
    v_permlane16_swap_b32 v8, v9
    v_max_f32 v8, v8, v9
    v_mov_b32 v9, v8
    s_nop 1
    v_permlane32_swap_b32 v8, v9
    v_max_f32 v8, v8, v9
    v_mul_f32 v8, s34, v8
    v_fma_f32 v16, v16, s34, -v8
    v_fma_f32 v17, v17, s34, -v8
    v_exp_f32 v16, v16
    v_exp_f32 v17, v17
    s_nop 0
    v_add_f32 v9, v16, v17
    v_and_b32 v10, 1, v0
    v_lshlrev_b32 v10, 4, v10
    v_mov_b32 v11, 0xffff
    v_lshlrev_b32 v10, v10, v11
    v_bfe_u32 v11, v0, 1, 2
    v_cmp_eq_u32 vcc, 0, v11
    s_nop 1
    v_cndmask_b32 v20, 0, v10, vcc
    v_cmp_eq_u32 vcc, 1, v11
    s_nop 1
    v_cndmask_b32 v21, 0, v10, vcc
    v_cmp_eq_u32 vcc, 2, v11
    s_nop 1
    v_cndmask_b32 v22, 0, v10, vcc
    v_cmp_eq_u32 vcc, 3, v11
    s_nop 1
    v_cndmask_b32 v23, 0, v10, vcc
    v_add_f32_dpp v9, v9, v9 row_ror:8 row_mask:0xf bank_mask:0xf
    v_mov_b32 v10, v9
    s_nop 1
    v_permlane16_swap_b32 v9, v10
    v_add_f32 v9, v9, v10
    v_mov_b32 v10, v9
    s_nop 1
    v_permlane32_swap_b32 v9, v10
    v_add_f32 v9, v9, v10
    v_mov_b32 v10, 98616
    s_mov_b64 exec, 1
    ds_write_b64 v10, v[8:9]
    s_mov_b64 exec, -1
    s_waitcnt vmcnt(0)
    v_cvt_pk_bf16_f32 v10, v16, v16
    v_and_b32 v24, v10, v20
    v_and_b32 v25, v10, v21
    v_and_b32 v26, v10, v22
    v_and_b32 v27, v10, v23
    s_nop 1
    v_mfma_f32_16x16x32_bf16 v[116:119], v[144:147], v[24:27], 0
    v_mfma_f32_16x16x32_bf16 v[120:123], v[148:151], v[24:27], 0
    v_cvt_pk_bf16_f32 v10, v17, v17
    v_and_b32 v28, v10, v20
    v_and_b32 v29, v10, v21
    v_and_b32 v30, v10, v22
    v_and_b32 v31, v10, v23
    s_nop 1
    v_mfma_f32_16x16x32_bf16 v[116:119], v[152:155], v[28:31], v[116:119]
    v_mfma_f32_16x16x32_bf16 v[120:123], v[156:159], v[28:31], v[120:123]
    s_mov_b32 s34, 106496
    v_lshrrev_b32 v16, 4, v0
    v_and_b32 v17, 7, v0
    v_lshl_add_u32 v16, v16, 3, v17
    v_bfe_u32 v17, v0, 3, 1
    v_lshl_add_u32 v16, v17, 5, v16
    v_lshl_add_u32 v16, v16, 4, s34
    s_nop 0
    v_add_f32_dpp v116, v120, v116 row_ror:8 row_mask:0xf bank_mask:0xf
    v_add_f32_dpp v117, v121, v117 row_ror:8 row_mask:0xf bank_mask:0xf
    v_add_f32_dpp v118, v122, v118 row_ror:8 row_mask:0xf bank_mask:0xf
    v_add_f32_dpp v119, v123, v119 row_ror:8 row_mask:0xf bank_mask:0xf
    ds_write_b128 v16, v[116:119]
    v_lshl_add_u32 v16, v0, 3, s34
    ds_read_b64 v[116:117], v16
    s_waitcnt lgkmcnt(0)
    s_mov_b32 s63, 0
    s_mov_b32 s62, s61
    s_cmp_lt_u32 s61, 20
    s_cbranch_scc1 L_rd25
    s_mul_i32 s62, s60, 12
    s_add_u32 s62, s62, s61
    s_sub_u32 s62, s62, 20
    s_mov_b32 s63, 1
    s_cmp_lt_u32 s62, 54
    s_cbranch_scc1 L_rd25
    s_cmp_lt_u32 s62, 56
    s_cselect_b32 s63, 3, 2
    s_sub_u32 s62, s62, 56
L_rd25:
    v_and_b32 v8, 3, v0
    v_bfe_u32 v9, v0, 2, 2
    v_lshrrev_b32 v10, 4, v0
    s_mov_b32 s55, 0x20000
    s_lshl_b32 s35, s62, 6
    s_and_b32 s49, s62, 1
    s_cmp_eq_u32 s63, 0
    s_cbranch_scc1 L_dp27
    s_cmp_eq_u32 s63, 1
    s_cbranch_scc1 L_dp28
    s_mov_b32 s52, s20
    s_mov_b32 s53, s21
    s_mov_b32 s54, 2211840
    v_mov_b32 v15, 0
    s_branch L_dp29
L_dp28:
    s_mov_b32 s52, s16
    s_mov_b32 s53, s17
    s_mov_b32 s54, 2211840
    v_lshl_add_u32 v15, v9, 3, v10
    v_mul_u32_u24 v15, 3456, v15
    v_lshl_add_u32 v15, v8, 4, v15
    v_add_u32 v15, s35, v15
    s_bfe_u32 s50, s3, 0x10001
    s_lshl_b32 s50, s50, 7
    s_and_b32 s34, s3, 1
    s_lshl_b32 s34, s34, 2
    s_add_u32 s50, s50, s34
    s_and_b32 s51, s3, 3
    s_lshl_b32 s51, s51, 5
    s_add_u32 s51, s51, 512
    s_mul_i32 s50, s50, 3456
    s_mul_i32 s51, s51, 3456
    s_branch L_dp29
L_dp27:
    s_mov_b32 s52, s12
    s_mov_b32 s53, s13
    s_mov_b32 s54, 5242880
    s_lshr_b32 s50, s3, 1
    s_lshl_b32 s50, s50, 3
    s_add_u32 s50, s50, s60
    s_and_b32 s51, s3, 1
    s_lshl_b32 s34, s50, 1
    s_add_u32 s34, s34, s51
    s_mul_i32 s34, s34, 81920
    s_add_u32 s34, s34, s35
    v_lshl_add_u32 v15, v9, 2, v10
    v_mul_u32_u24 v15, 2560, v15
    v_lshl_add_u32 v15, v8, 4, v15
    v_add_u32 v15, s34, v15
    s_lshl_b32 s56, s3, 12
    s_lshl_b32 s34, s49, 11
    s_add_u32 s56, s56, s34
    s_add_u32 s56, s56, 40960
    s_add_u32 s58, s56, 1024
    s_mul_i32 s57, s49, 40960
    s_add_u32 s59, s57, 1280
L_dp29:
    v_and_b32 v200, 3, v0
    v_bfe_u32 v201, v0, 2, 2
    v_lshrrev_b32 v202, 4, v0
    s_lshl_b32 s34, s3, 10
    s_add_u32 s34, s34, 122112
    v_mul_u32_u24 v203, 320, v201
    v_min_u32 v203, 704, v203
    v_lshl_add_u32 v203, v202, 6, v203
    v_lshl_add_u32 v203, v200, 4, v203
    v_add_u32 v203, s34, v203
    s_movk_i32 s48, 16384
    v_mov_b32 v197, 0
    s_mov_b32 s40, 0
    s_mov_b32 s41, 0
    s_mov_b32 s42, 0
    s_cmp_eq_u32 s63, 0
    s_cbranch_scc1 L_d_wo
    s_cmp_eq_u32 s63, 2
    s_cbranch_scc1 L_d_w2
    s_cmp_eq_u32 s63, 3
    s_cbranch_scc1 L_d_none
    v_and_b32 v205, 15, v0
    v_lshlrev_b32 v205, 4, v205
    s_and_b32 s49, s3, 3
    s_mul_i32 s34, s49, 1280
    s_add_u32 s34, s34, s99
    s_add_u32 s34, s34, 786432
    v_lshl_add_u32 v206, v202, 15, v205
    v_add_u32 v206, s34, v206
    s_mul_i32 s34, s49, 3840
    v_add_u32 v205, s34, v205
    s_lshl_b32 s34, s62, 6
    v_lshlrev_b32 v5, 4, v14
    v_lshl_add_u32 v5, v12, 2, v5
    v_add_u32 v5, s34, v5
    global_load_dword v6, v5, s[18:19]
    v_and_b32 v7, 15, v0
    v_lshlrev_b32 v7, 4, v7
    v_mul_u32_u24 v8, 1280, v14
    v_add_u32 v8, v8, v7
    v_bfe_u32 v9, v0, 3, 1
    v_lshlrev_b32 v9, 15, v9
    v_lshl_add_u32 v9, v14, 7, v9
    v_and_b32 v10, 7, v0
    v_lshl_add_u32 v9, v10, 4, v9
    v_add_u32 v9, 1572864, v9
    s_mov_b32 s57, 65536
    v_mul_u32_u24 v5, 3840, v14
    v_add_u32 v5, v5, v7
    global_load_dwordx4 v[32:35], v8, s[4:5] offset:0
    global_load_dwordx4 v[36:39], v8, s[4:5] offset:256
    global_load_dwordx4 v[40:43], v8, s[4:5] offset:512
    global_load_dwordx4 v[44:47], v8, s[4:5] offset:768
    global_load_dwordx4 v[48:51], v8, s[4:5] offset:1024
    s_mov_b32 s35, 0
L_poll30:
    buffer_load_dwordx4 v[52:55], v9, s[44:47], s57 offen offset:1024 sc1
    buffer_load_dwordx4 v[56:59], v9, s[44:47], 0 offen offset:1536 sc1
    buffer_load_dwordx4 v[60:63], v9, s[44:47], s57 offen offset:1536 sc1
    buffer_load_dwordx4 v[64:67], v9, s[44:47], 0 offen offset:2048 sc1
    buffer_load_dwordx4 v[68:71], v9, s[44:47], s57 offen offset:2048 sc1
    buffer_load_dwordx4 v[72:75], v9, s[44:47], 0 offen offset:2560 sc1
    buffer_load_dwordx4 v[76:79], v9, s[44:47], s57 offen offset:2560 sc1
    buffer_load_dwordx4 v[80:83], v9, s[44:47], 0 offen offset:3072 sc1
    buffer_load_dwordx4 v[84:87], v9, s[44:47], s57 offen offset:3072 sc1
    buffer_load_dwordx4 v[88:91], v9, s[44:47], 0 offen offset:3584 sc1
    s_add_u32 s35, s35, 1
    s_waitcnt vmcnt(0)
    v_max3_u32 v28, v52, v53, v54
    v_max3_u32 v28, v28, v55, v56
    v_max3_u32 v28, v28, v57, v58
    v_max3_u32 v28, v28, v59, v60
    v_max3_u32 v28, v28, v61, v62
    v_max3_u32 v28, v28, v63, v64
    v_max3_u32 v28, v28, v65, v66
    v_max3_u32 v28, v28, v67, v68
    v_max3_u32 v28, v28, v69, v70
    v_max3_u32 v28, v28, v71, v72
    v_max3_u32 v28, v28, v73, v74
    v_max3_u32 v28, v28, v75, v76
    v_max3_u32 v28, v28, v77, v78
    v_max3_u32 v28, v28, v79, v80
    v_max3_u32 v28, v28, v81, v82
    v_max3_u32 v28, v28, v83, v84
    v_max3_u32 v28, v28, v85, v86
    v_max3_u32 v28, v28, v87, v88
    v_max3_u32 v28, v28, v89, v90
    v_max_u32 v28, v28, v91
    v_cmp_eq_u32 vcc, -1, v28
    s_cbranch_vccz L_done31
    s_sleep 16
    s_cmp_lt_u32 s35, 60000
    s_cbranch_scc1 L_poll30
L_done31:
    ds_write_b128 v5, v[32:35] offset:0
    ds_write_b128 v5, v[36:39] offset:256
    ds_write_b128 v5, v[40:43] offset:512
    ds_write_b128 v5, v[44:47] offset:768
    ds_write_b128 v5, v[48:51] offset:1024
    ds_write_b128 v5, v[52:55] offset:1280
    ds_write_b128 v5, v[56:59] offset:1536
    ds_write_b128 v5, v[60:63] offset:1792
    ds_write_b128 v5, v[64:67] offset:2048
    ds_write_b128 v5, v[68:71] offset:2304
    ds_write_b128 v5, v[72:75] offset:2560
    ds_write_b128 v5, v[76:79] offset:2816
    ds_write_b128 v5, v[80:83] offset:3072
    ds_write_b128 v5, v[84:87] offset:3328
    ds_write_b128 v5, v[88:91] offset:3584
    s_waitcnt lgkmcnt(0)
    v_lshlrev_b32 v100, 16, v6
    v_and_b32 v101, 0xffff0000, v6
    s_cmp_eq_u32 s60, 4
    s_cselect_b32 s40, 6, 12
    s_mov_b32 s41, 5462
    s_cmov_b32 s41, 10923
    s_cselect_b32 s34, 20, 20
    s_mov_b32 s49, 17280
    s_cmov_b32 s49, 34560
    v_min_u32 v196, 59, v0
    v_mul_u32_u24 v197, s41, v196
    v_lshrrev_b32 v197, 16, v197
    v_mul_u32_u24 v194, s40, v197
    v_sub_u32 v196, v196, v194
    v_mul_u32_u24 v197, 3456, v197
    v_lshl_add_u32 v197, v196, 6, v197
    s_mul_i32 s35, s60, 768
    s_add_i32 s35, s35, 0
    s_cmp_eq_u32 s60, 4
    s_cselect_b32 s35, 3072, s35
    s_sub_u32 s34, s61, s34
    s_mul_i32 s34, s34, s49
    s_mul_i32 s34, s34, 11
    s_add_u32 s34, s34, s35
    v_add_u32 v197, s34, v197
    s_mov_b32 s40, s49
    s_mov_b32 s41, s49
    s_branch L_d_none
L_d_w2:
    s_lshl_b32 s34, s62, 5
    v_lshl_add_u32 v3, v14, 3, s34
    global_load_dwordx2 v[20:21], v3, s[22:23]
    v_mul_u32_u24 v112, 1280, v12
    v_add_u32 v112, v112, v3
    global_load_dwordx2 v[22:23], v112, s[4:5]
    s_lshr_b32 s34, s62, 2
    s_add_u32 s34, s34, 30
    s_lshr_b32 s35, s34, 2
    s_lshl_b32 s35, s35, 9
    s_and_b32 s34, s34, 3
    s_lshl_b32 s34, s34, 15
    s_add_u32 s34, s34, s35
    s_and_b32 s35, s62, 3
    s_mul_i32 s35, s35, 32
    s_add_u32 s34, s34, s35
    s_add_u32 s34, s34, 1572864
    v_lshlrev_b32 v5, 7, v12
    v_lshl_add_u32 v5, v14, 3, v5
    v_add_u32 v5, s34, v5
    s_waitcnt vmcnt(0)
    v_lshlrev_b32 v32, 16, v20
    v_and_b32 v33, 0xffff0000, v20
    v_lshlrev_b32 v34, 16, v21
    v_and_b32 v35, 0xffff0000, v21
    v_lshlrev_b32 v108, 16, v22
    v_and_b32 v109, 0xffff0000, v22
    v_lshlrev_b32 v110, 16, v23
    v_and_b32 v111, 0xffff0000, v23
    s_mov_b32 s35, 0
L_poll33:
    buffer_load_dwordx2 v[24:25], v5, s[44:47], 0 offen sc1
    s_add_u32 s35, s35, 1
    s_waitcnt vmcnt(0)
    v_max_u32 v28, v24, v25
    v_cmp_eq_u32 vcc, -1, v28
    s_cbranch_vccz L_done34
    s_sleep 16
    s_cmp_lt_u32 s35, 60000
    s_cbranch_scc1 L_poll33
L_done34:
    v_lshlrev_b32 v104, 16, v24
    v_and_b32 v105, 0xffff0000, v24
    v_lshlrev_b32 v106, 16, v25
    v_and_b32 v107, 0xffff0000, v25
    v_fma_f32 v108, v104, v32, v108
    v_fma_f32 v109, v105, v33, v109
    v_fma_f32 v110, v106, v34, v110
    v_fma_f32 v111, v107, v35, v111
    v_mul_f32 v108, 0x3e800000, v108
    v_mul_f32 v109, 0x3e800000, v109
    v_mul_f32 v110, 0x3e800000, v110
    v_mul_f32 v111, 0x3e800000, v111
    v_lshl_add_u32 v204, v13, 15, v112
    s_add_u32 s34, s99, 786432
    v_add_u32 v204, s34, v204
    s_cmp_eq_u32 s60, 4
    s_cselect_b32 s40, 2, 6
    s_mov_b32 s41, 10923
    s_cmov_b32 s41, 32769
    s_cselect_b32 s34, 28, 20
    s_mov_b32 s49, 12800
    s_cmov_b32 s49, 38400
    v_min_u32 v196, 59, v0
    v_mul_u32_u24 v197, s41, v196
    v_lshrrev_b32 v197, 16, v197
    v_mul_u32_u24 v194, s40, v197
    v_sub_u32 v196, v196, v194
    v_mul_u32_u24 v197, 1280, v197
    v_lshl_add_u32 v197, v196, 6, v197
    s_mul_i32 s35, s60, 384
    s_add_i32 s35, s35, -1792
    s_cmp_eq_u32 s60, 4
    s_cselect_b32 s35, 0, s35
    s_sub_u32 s34, s61, s34
    s_mul_i32 s34, s34, s49
    s_mul_i32 s34, s34, 15
    s_add_u32 s34, s34, s35
    v_add_u32 v197, s34, v197
    s_mov_b32 s40, s49
    s_mov_b32 s41, s49
    s_branch L_d_none
L_d_wo:
    s_lshr_b32 s49, s3, 1
    s_lshl_b32 s49, s49, 15
    v_and_b32 v210, 7, v0
    s_mul_i32 s34, s60, 4096
    s_add_u32 s34, s34, s49
    s_add_u32 s34, s34, 1179904
    v_lshrrev_b32 v211, 3, v0
    v_mul_u32_u24 v205, 512, v211
    v_add_u32 v204, s34, v205
    s_lshl_b32 s35, s51, 7
    s_add_u32 s34, s34, s35
    s_sub_u32 s34, s34, 256
    v_lshl_add_u32 v205, v210, 4, v205
    v_add_u32 v205, s34, v205
    s_lshl_b32 s34, s3, 12
    s_add_u32 s34, s34, 40960
    v_lshrrev_b32 v206, 2, v0
    v_lshlrev_b32 v206, 6, v206
    v_lshl_add_u32 v206, v200, 3, v206
    v_add_u32 v206, s34, v206
    s_mul_i32 s34, s3, 1152
    s_add_u32 s34, s34, 107520
    v_mul_u32_u24 v207, 144, v211
    v_lshl_add_u32 v207, v210, 4, v207
    v_add_u32 v207, s34, v207
    v_mul_u32_u24 v208, 144, v210
    v_lshl_add_u32 v208, v202, 4, v208
    v_add_u32 v208, s34, v208
    v_mul_u32_u24 v212, 144, v211
    v_add_u32 v212, s34, v212
    v_mul_u32_u24 v213, 144, v210
    v_add_u32 v213, s34, v213
    v_and_b32 v211, 1, v211
    v_bfe_u32 v203, v0, 1, 2
    v_mul_u32_u24 v203, 144, v203
    v_and_b32 v214, 1, v0
    v_mul_u32_u24 v214, 576, v214
    v_lshl_add_u32 v214, v211, 6, v214
    v_lshl_add_u32 v214, v202, 4, v214
    s_add_u32 s34, s34, 14592
    v_add3_u32 v203, v203, v214, s34
    v_mov_b32 v210, 98816
    v_cmp_eq_u32 vcc, 0, v211
    s_nop 1
    v_cndmask_b32 v209, v208, v210, vcc
    v_cndmask_b32 v208, v210, v208, vcc
    v_and_b32 v8, 15, v0
    s_lshr_b32 s34, s62, 1
    s_add_u32 s34, s34, 0
    s_lshr_b32 s35, s34, 2
    s_lshl_b32 s35, s35, 9
    s_and_b32 s34, s34, 3
    s_lshl_b32 s34, s34, 15
    s_add_u32 s34, s34, s35
    s_and_b32 s35, s62, 1
    s_mul_i32 s35, s35, 64
    s_add_u32 s34, s34, s35
    s_add_u32 s34, s34, 1572864
    v_lshlrev_b32 v9, 2, v8
    v_lshl_add_u32 v9, v14, 7, v9
    v_add_u32 v9, s34, v9
    s_lshr_b32 s34, s60, 2
    s_lshl_b32 s34, s34, 14
    s_and_b32 s35, s60, 3
    s_lshl_b32 s35, s35, 15
    s_add_u32 s34, s34, s35
    s_lshl_b32 s35, s62, 6
    s_add_u32 s34, s34, s35
    s_add_u32 s34, s34, 786432
    v_mul_u32_u24 v112, 1280, v14
    v_lshl_add_u32 v112, v8, 2, v112
    v_add_u32 v112, s34, v112
    v_add_u32 v114, 917504, v112
    v_mul_u32_u24 v113, 144, v14
    v_lshl_add_u32 v113, v8, 3, v113
    v_add_u32 v113, 122112, v113
    s_bfe_u32 s35, s60, 0x10002
    s_lshl_b32 s35, s35, 13
    s_xor_b32 s101, s99, s35
    s_xor_b32 s93, s101, 8192
    s_mul_i32 s34, s62, 52
    s_lshr_b32 s34, s34, 8
    s_mul_i32 s35, s34, 5
    s_sub_u32 s35, s62, s35
    s_mul_i32 s34, s34, 1310720
    s_lshl_b32 s35, s35, 15
    s_add_u32 s34, s34, s35
    s_mul_i32 s35, s60, 163840
    s_add_u32 s34, s34, s35
    v_lshl_add_u32 v197, v0, 6, s34
    s_movk_i32 s40, 4096
    s_movk_i32 s41, 4096
    s_mov_b32 s35, 0
L_poll36:
    buffer_load_dword v32, v9, s[44:47], 0 offen sc1
    s_add_u32 s35, s35, 1
    s_waitcnt vmcnt(0)
    v_mov_b32 v22, v32
    v_cmp_eq_u32 vcc, -1, v22
    s_cbranch_vccz L_done37
    s_sleep 16
    s_cmp_lt_u32 s35, 60000
    s_cbranch_scc1 L_poll36
L_done37:
    v_lshlrev_b32 v100, 16, v32
    v_and_b32 v101, 0xffff0000, v32
L_d_none:
    v_mov_b32 v22, 99072
    s_and_b32 s34, s60, 3
    s_lshl_b32 s34, s34, 15
    s_lshr_b32 s35, s60, 2
    s_lshl_b32 s35, s35, 7
    s_add_u32 s34, s34, s35
    s_add_u32 s34, s34, 793600
    v_and_b32 v252, 31, v0
    v_lshl_add_u32 v252, v252, 2, s34
    v_mov_b32 v253, 0
    s_mov_b32 s35, 0
L_poll39:
    ds_read_b32 v23, v22
    s_add_u32 s35, s35, 1
    s_waitcnt lgkmcnt(0)
    v_cmp_gt_u32 vcc, 46, v23
    s_cbranch_vccz L_done40
    s_sleep 2
    s_cmp_lt_u32 s35, 60000
    s_cbranch_scc1 L_poll39
L_done40:
    buffer_load_dword v251, v252, s[44:47], 0 offen sc1
    s_lshl_b64 exec, 1, s61
    buffer_store_dword v253, v252, s[44:47], 0 offen
    s_mov_b64 exec, -1
    s_waitcnt vmcnt(1)
    v_cmp_ne_u32 vcc, -1, v251
    v_mov_b32 v248, v252
    v_mov_b32 v252, 99076
    s_bcnt1_i32_b32 s34, vcc_lo
    s_mov_b32 s91, s34
    v_mov_b32 v251, s34
    s_mov_b64 exec, 1
    ds_write_b32 v252, v251
    s_mov_b64 exec, -1
    v_mov_b32 v22, 99072
    s_and_b32 s34, s60, 3
    s_lshl_b32 s34, s34, 15
    s_lshr_b32 s35, s60, 2
    s_lshl_b32 s35, s35, 7
    s_add_u32 s34, s34, s35
    s_add_u32 s34, s34, 793856
    v_and_b32 v252, 31, v0
    v_lshl_add_u32 v252, v252, 2, s34
    v_mov_b32 v253, 0
    s_mov_b32 s35, 0
L_poll42:
    ds_read_b32 v23, v22
    s_add_u32 s35, s35, 1
    s_waitcnt lgkmcnt(0)
    v_cmp_gt_u32 vcc, 57, v23
    s_cbranch_vccz L_done43
    s_sleep 2
    s_cmp_lt_u32 s35, 60000
    s_cbranch_scc1 L_poll42
L_done43:
    buffer_load_dword v251, v252, s[44:47], 0 offen sc1
    s_lshl_b64 exec, 1, s61
    buffer_store_dword v253, v252, s[44:47], 0 offen
    s_mov_b64 exec, -1
    s_waitcnt vmcnt(1)
    v_cmp_ne_u32 vcc, -1, v251
    v_mov_b32 v248, v252
    v_mov_b32 v252, 99076
    s_bcnt1_i32_b32 s34, vcc_lo
    s_mov_b32 s91, s34
    v_mov_b32 v251, s34
    s_mov_b64 exec, 1
    ds_write_b32 v252, v251
    s_mov_b64 exec, -1
    v_and_b32 v19, 7, v0
    v_lshlrev_b32 v19, 3, v19
    v_add_u32 v19, 98560, v19
    s_mov_b32 s35, 0
L_poll45:
    ds_read_b64 v[20:21], v19
    s_add_u32 s35, s35, 1
    s_waitcnt lgkmcnt(0)
    v_max_u32 v22, v20, v21
    v_cmp_eq_u32 vcc, -1, v22
    s_cbranch_vccz L_done46
    s_sleep 2
    s_cmp_lt_u32 s35, 60000
    s_cbranch_scc1 L_poll45
L_done46:
    v_max_f32_dpp v22, v20, v20 row_half_mirror row_mask:0xf bank_mask:0xf
    s_nop 1
    v_max_f32_dpp v22, v22, v22 quad_perm:[1,0,3,2] row_mask:0xf bank_mask:0xf
    s_nop 1
    v_max_f32_dpp v22, v22, v22 quad_perm:[2,3,0,1] row_mask:0xf bank_mask:0xf
    v_sub_f32 v20, v20, v22
    v_exp_f32 v20, v20
    s_nop 0
    v_mul_f32 v21, v21, v20
    s_nop 1
    v_add_f32_dpp v21, v21, v21 row_half_mirror row_mask:0xf bank_mask:0xf
    s_nop 1
    v_add_f32_dpp v21, v21, v21 quad_perm:[1,0,3,2] row_mask:0xf bank_mask:0xf
    s_nop 1
    v_add_f32_dpp v21, v21, v21 quad_perm:[2,3,0,1] row_mask:0xf bank_mask:0xf
    v_rcp_f32 v23, v21
    v_log_f32 v21, v21
    v_mul_f32 v20, v20, v23
    v_add_f32 v21, v21, v22
    v_min_u32 v21, -2, v21
    v_readlane_b32 s88, v20, 0
    v_readlane_b32 s90, v20, 1
    v_readlane_b32 s92, v20, 2
    v_readlane_b32 s94, v20, 3
    v_readlane_b32 s96, v20, 4
    v_readlane_b32 s98, v20, 5
    v_readlane_b32 s100, v20, 6
    v_readlane_b32 s89, v20, 7
    s_and_b32 s95, s61, 3
    s_lshl_b32 s95, s95, 15
    s_bfe_u32 s35, s2, 0x20005
    s_lshl_b32 s35, s35, 1
    s_lshr_b32 s91, s2, 7
    s_add_u32 s35, s35, s91
    s_getreg_b32 s91, hwreg(HW_REG_XCC_ID, 0, 4)
    v_and_b32 v24, 1, v0
    v_cmp_eq_u32 vcc, 0, v24
    v_mov_b32 v25, s91
    s_nop 0
    v_cndmask_b32 v25, v25, v21, vcc
    v_mul_f32 v20, s89, v116
    v_mul_f32 v21, s89, v117
    s_mul_i32 s34, s60, 4096
    s_mul_i32 s35, s35, 512
    s_add_u32 s34, s34, s35
    s_add_u32 s34, s34, s95
    s_add_u32 s34, s34, 1179648
    v_lshl_add_u32 v26, v0, 2, s34
    v_lshlrev_b32 v19, 3, v0
    v_add_u32 v19, 99328, v19
    v_lshlrev_b32 v18, 4, v0
    v_add_u32 v18, 131328, v18
    s_mov_b32 s36, s12
    s_mov_b32 s37, s13
    s_mov_b32 s38, 5242880
    s_and_b32 s34, s61, 24
    s_add_u32 s34, s34, s60
    s_mul_i32 s34, s34, 163840
    s_and_b32 s35, s61, 7
    s_mul_i32 s35, s35, 20480
    s_add_u32 s34, s34, s35
    v_lshl_add_u32 v195, v0, 6, s34
    s_mov_b32 s34, 0
    s_barrier
    buffer_load_dword v250, v195, s[36:39], s34 offen
    s_add_u32 s34, s34, 4096
    buffer_load_dword v250, v195, s[36:39], s34 offen
    s_add_u32 s34, s34, 4096
    buffer_load_dword v250, v195, s[36:39], s34 offen
    s_add_u32 s34, s34, 4096
    buffer_load_dword v250, v195, s[36:39], s34 offen
    s_add_u32 s34, s34, 4096
    buffer_load_dword v250, v195, s[36:39], s34 offen
    s_add_u32 s34, s34, 4096
    s_cmp_lt_u32 s63, 1
    s_cbranch_scc1 L_nopf
    buffer_load_dword v250, v197, s[52:55], s42 offen
    s_add_u32 s42, s42, s40
    buffer_load_dword v250, v197, s[52:55], s42 offen
    s_add_u32 s42, s42, s41
L_nopf:
    s_cmp_eq_u32 s97, 0
    s_barrier
    ds_read_b64 v[32:33], v19 offset:0
    ds_read_b64 v[34:35], v19 offset:1024
    ds_read_b64 v[36:37], v19 offset:2048
    ds_read_b64 v[38:39], v19 offset:3072
    ds_read_b64 v[40:41], v19 offset:4096
    ds_read_b64 v[42:43], v19 offset:5120
    ds_read_b64 v[44:45], v19 offset:6144
    buffer_store_dword v25, v26, s[44:47], 0 offen offset:256
    s_waitcnt lgkmcnt(6)
    v_pk_fma_f32 v[20:21], v[32:33], s[88:89], v[20:21] op_sel_hi:[1,0,1]
    s_waitcnt lgkmcnt(5)
    v_pk_fma_f32 v[20:21], v[34:35], s[90:91], v[20:21] op_sel_hi:[1,0,1]
    s_waitcnt lgkmcnt(4)
    v_pk_fma_f32 v[20:21], v[36:37], s[92:93], v[20:21] op_sel_hi:[1,0,1]
    s_waitcnt lgkmcnt(3)
    v_pk_fma_f32 v[20:21], v[38:39], s[94:95], v[20:21] op_sel_hi:[1,0,1]
    s_waitcnt lgkmcnt(2)
    v_pk_fma_f32 v[20:21], v[40:41], s[96:97], v[20:21] op_sel_hi:[1,0,1]
    s_waitcnt lgkmcnt(1)
    v_pk_fma_f32 v[20:21], v[42:43], s[98:99], v[20:21] op_sel_hi:[1,0,1]
    s_waitcnt lgkmcnt(0)
    v_pk_fma_f32 v[20:21], v[44:45], s[100:101], v[20:21] op_sel_hi:[1,0,1]
    v_cvt_pk_bf16_f32 v24, v20, v21
    v_min_u32 v24, -2, v24
    buffer_store_dword v24, v26, s[44:47], 0 offen
    s_cbranch_scc1 L_ostd
    buffer_store_dword v24, v26, s[44:47], 0 offen sc1
    buffer_store_dword v25, v26, s[44:47], 0 offen offset:256 sc1
L_ostd:
    ds_write_b96 v18, v[24:26]
    s_cmp_lt_u32 s63, 1
    s_cbranch_scc1 L_nopf2
    buffer_load_dword v250, v197, s[52:55], s42 offen
    s_add_u32 s42, s42, s40
    buffer_load_dword v250, v197, s[52:55], s42 offen
    s_add_u32 s42, s42, s41
    buffer_load_dword v250, v197, s[52:55], s42 offen
    s_add_u32 s42, s42, s40
    buffer_load_dword v250, v197, s[52:55], s42 offen
    s_add_u32 s42, s42, s41
    buffer_load_dword v250, v197, s[52:55], s42 offen
    s_add_u32 s42, s42, s40
    buffer_load_dword v250, v197, s[52:55], s42 offen
    s_add_u32 s42, s42, s41
    buffer_load_dword v250, v197, s[52:55], s42 offen
    s_add_u32 s42, s42, s40
    buffer_load_dword v250, v197, s[52:55], s42 offen
    s_add_u32 s42, s42, s41
L_nopf2:
    s_waitcnt lgkmcnt(0)
    s_barrier
    s_cmp_eq_u32 s63, 0
    s_cbranch_scc1 L_r_wo2
    buffer_load_dword v250, v197, s[52:55], s42 offen
    s_add_u32 s42, s42, s40
    s_cmp_eq_u32 s63, 1
    s_cbranch_scc1 L_r_w1
    buffer_load_dword v250, v197, s[52:55], s42 offen
    s_add_u32 s42, s42, s40
    buffer_load_dword v250, v197, s[52:55], s42 offen
    s_add_u32 s42, s42, s41
    buffer_load_dword v250, v197, s[52:55], s42 offen
    s_add_u32 s42, s42, s40
    buffer_load_dword v250, v197, s[52:55], s42 offen
    s_add_u32 s42, s42, s41
    s_cmp_eq_u32 s63, 2
    s_cbranch_scc1 L_w2_red
    s_waitcnt vmcnt(0)
    s_mov_b64 exec, -1
    v_lshlrev_b32 v243, 4, v0
    v_add_u32 v243, 131328, v243
    ds_read_b96 v[240:242], v243
    s_waitcnt lgkmcnt(0)
    buffer_store_dword v240, v242, s[44:47], 0 offen sc1
    buffer_store_dword v241, v242, s[44:47], 0 offen offset:256 sc1
    s_endpgm
.p2align 12
.fill 112, 4, 0xbf800000
L_stream:
    s_sub_u32 s49, s3, 1
    s_mul_i32 s49, s49, 4096
    v_lshl_add_u32 v1, v0, 4, s49
    s_lshr_b32 s98, s2, 7
    s_mul_i32 s98, s98, 57344
    s_and_b32 s34, s2, 127
    s_lshl_b32 s34, s34, 21
    s_lshr_b32 s35, s2, 7
    s_lshl_b32 s35, s35, 18
    s_add_u32 s34, s34, s35
    s_add_u32 s34, s34, 1572864
    s_mov_b32 s38, 0x40000
    s_mov_b32 s42, 0x40000
    s_waitcnt lgkmcnt(0)
    s_add_u32 s36, s6, s34
    s_addc_u32 s37, s7, 0
    s_add_u32 s40, s8, s34
    s_addc_u32 s41, s9, 0
    s_waitcnt vmcnt(3)
    buffer_load_dwordx4 v[16:19], v1, s[36:39], s98 offen offset:0 nt
    s_waitcnt vmcnt(3)
    buffer_load_dwordx4 v[20:23], v1, s[36:39], s98 offen offset:1024 nt
    s_waitcnt vmcnt(3)
    buffer_load_dwordx4 v[24:27], v1, s[36:39], s98 offen offset:2048 nt
    s_waitcnt vmcnt(3)
    s_barrier
    s_waitcnt vmcnt(2)
    buffer_load_dwordx4 v[28:31], v1, s[36:39], s98 offen offset:3072 nt
    s_waitcnt vmcnt(2)
    s_addk_i32 s98, 28672
    buffer_load_dwordx4 v[32:35], v1, s[36:39], s98 offen offset:0 nt
    s_waitcnt vmcnt(2)
    buffer_load_dwordx4 v[36:39], v1, s[36:39], s98 offen offset:1024 nt
    s_waitcnt vmcnt(2)
    buffer_load_dwordx4 v[40:43], v1, s[36:39], s98 offen offset:2048 nt
    s_waitcnt vmcnt(2)
    buffer_load_dwordx4 v[44:47], v1, s[36:39], s98 offen offset:3072 nt
    s_add_u32 s44, s32, 0
    s_addc_u32 s45, s33, 0
    s_mov_b32 s63, 0
    s_mov_b32 s62, s61
    s_cmp_lt_u32 s61, 20
    s_cbranch_scc1 L_rd48
    s_mul_i32 s62, s60, 12
    s_add_u32 s62, s62, s61
    s_sub_u32 s62, s62, 20
    s_mov_b32 s63, 1
    s_cmp_lt_u32 s62, 54
    s_cbranch_scc1 L_rd48
    s_cmp_lt_u32 s62, 56
    s_cselect_b32 s63, 3, 2
    s_sub_u32 s62, s62, 56
L_rd48:
    v_and_b32 v8, 3, v0
    v_bfe_u32 v9, v0, 2, 2
    v_lshrrev_b32 v10, 4, v0
    s_mov_b32 s55, 0x20000
    s_lshl_b32 s35, s62, 6
    s_and_b32 s49, s62, 1
    s_cmp_eq_u32 s63, 0
    s_cbranch_scc1 L_dp50
    s_cmp_eq_u32 s63, 1
    s_cbranch_scc1 L_dp51
    s_mov_b32 s52, s20
    s_mov_b32 s53, s21
    s_mov_b32 s54, 2211840
    v_mov_b32 v15, 0
    s_branch L_dp52
L_dp51:
    s_mov_b32 s52, s16
    s_mov_b32 s53, s17
    s_mov_b32 s54, 2211840
    v_lshl_add_u32 v15, v9, 3, v10
    v_mul_u32_u24 v15, 3456, v15
    v_lshl_add_u32 v15, v8, 4, v15
    v_add_u32 v15, s35, v15
    s_bfe_u32 s50, s3, 0x10001
    s_lshl_b32 s50, s50, 7
    s_and_b32 s34, s3, 1
    s_lshl_b32 s34, s34, 2
    s_add_u32 s50, s50, s34
    s_and_b32 s51, s3, 3
    s_lshl_b32 s51, s51, 5
    s_add_u32 s51, s51, 512
    s_mul_i32 s50, s50, 3456
    s_mul_i32 s51, s51, 3456
    s_branch L_dp52
L_dp50:
    s_mov_b32 s52, s12
    s_mov_b32 s53, s13
    s_mov_b32 s54, 5242880
    s_lshr_b32 s50, s3, 1
    s_lshl_b32 s50, s50, 3
    s_add_u32 s50, s50, s60
    s_and_b32 s51, s3, 1
    s_lshl_b32 s34, s50, 1
    s_add_u32 s34, s34, s51
    s_mul_i32 s34, s34, 81920
    s_add_u32 s34, s34, s35
    v_lshl_add_u32 v15, v9, 2, v10
    v_mul_u32_u24 v15, 2560, v15
    v_lshl_add_u32 v15, v8, 4, v15
    v_add_u32 v15, s34, v15
    s_lshl_b32 s56, s3, 12
    s_lshl_b32 s34, s49, 11
    s_add_u32 s56, s56, s34
    s_add_u32 s56, s56, 40960
    s_add_u32 s58, s56, 1024
    s_mul_i32 s57, s49, 40960
    s_add_u32 s59, s57, 1280
L_dp52:
    v_and_b32 v2, 15, v0
    v_lshlrev_b32 v2, 4, v2
    v_add_u32 v2, 98304, v2
    s_waitcnt vmcnt(2)
    s_addk_i32 s98, 28672
    buffer_load_dwordx4 v[48:51], v1, s[36:39], s98 offen offset:0 nt
    s_waitcnt vmcnt(2)
    buffer_load_dwordx4 v[52:55], v1, s[36:39], s98 offen offset:1024 nt
    s_waitcnt vmcnt(2)
    buffer_load_dwordx4 v[56:59], v1, s[36:39], s98 offen offset:2048 nt
    s_waitcnt vmcnt(2)
    buffer_load_dwordx4 v[60:63], v1, s[36:39], s98 offen offset:3072 nt
    s_waitcnt vmcnt(2)
    s_addk_i32 s98, 28672
    buffer_load_dwordx4 v[64:67], v1, s[36:39], s98 offen offset:0 nt
    s_waitcnt vmcnt(2)
    buffer_load_dwordx4 v[68:71], v1, s[36:39], s98 offen offset:1024 nt
    v_mov_b32 v3, 14
    v_mov_b32 v14, 99072
    s_mov_b64 exec, 1
    ds_write_b32 v14, v3
    s_mov_b64 exec, -1
    s_waitcnt vmcnt(2)
    buffer_load_dwordx4 v[72:75], v1, s[36:39], s98 offen offset:2048 nt
    s_waitcnt vmcnt(2)
    buffer_load_dwordx4 v[76:79], v1, s[36:39], s98 offen offset:3072 nt
    s_waitcnt vmcnt(2)
    s_addk_i32 s98, 28672
    buffer_load_dwordx4 v[80:83], v1, s[36:39], s98 offen offset:0 nt
    s_waitcnt vmcnt(2)
    buffer_load_dwordx4 v[84:87], v1, s[36:39], s98 offen offset:1024 nt
    s_waitcnt vmcnt(2)
    buffer_load_dwordx4 v[88:91], v1, s[36:39], s98 offen offset:2048 nt
    s_waitcnt vmcnt(2)
    buffer_load_dwordx4 v[92:95], v1, s[36:39], s98 offen offset:3072 nt
    s_waitcnt vmcnt(2)
    s_addk_i32 s98, 28672
    buffer_load_dwordx4 v[96:99], v1, s[36:39], s98 offen offset:0 nt
    s_waitcnt vmcnt(2)
    buffer_load_dwordx4 v[100:103], v1, s[36:39], s98 offen offset:1024 nt
    v_mov_b32 v3, 22
    v_mov_b32 v14, 99072
    s_mov_b64 exec, 1
    ds_write_b32 v14, v3
    s_mov_b64 exec, -1
    s_waitcnt vmcnt(2)
    buffer_load_dwordx4 v[104:107], v1, s[36:39], s98 offen offset:2048 nt
    s_waitcnt vmcnt(2)
    buffer_load_dwordx4 v[108:111], v1, s[36:39], s98 offen offset:3072 nt
    s_waitcnt vmcnt(2)
    s_addk_i32 s98, 28672
    buffer_load_dwordx4 v[112:115], v1, s[36:39], s98 offen offset:0 nt
    s_waitcnt vmcnt(2)
    buffer_load_dwordx4 v[116:119], v1, s[36:39], s98 offen offset:1024 nt
    s_waitcnt vmcnt(2)
    buffer_load_dwordx4 v[120:123], v1, s[36:39], s98 offen offset:2048 nt
    s_waitcnt vmcnt(2)
    buffer_load_dwordx4 v[124:127], v1, s[36:39], s98 offen offset:3072 nt
    s_waitcnt vmcnt(2)
    s_addk_i32 s98, 28672
    s_cmp_eq_u32 s98, 258048
    s_cselect_b32 s98, 0, s98
    buffer_load_dwordx4 v[128:131], v1, s[36:39], s98 offen offset:0 nt
    s_waitcnt vmcnt(2)
    buffer_load_dwordx4 v[132:135], v1, s[36:39], s98 offen offset:1024 nt
    s_waitcnt vmcnt(2)
    buffer_load_dwordx4 v[136:139], v1, s[36:39], s98 offen offset:2048 nt
    s_waitcnt vmcnt(2)
    buffer_load_dwordx4 v[140:143], v1, s[36:39], s98 offen offset:3072 nt
    s_waitcnt vmcnt(2)
    s_addk_i32 s98, 28672
    buffer_load_dwordx4 v[144:147], v1, s[36:39], s98 offen offset:0 nt
    s_waitcnt vmcnt(2)
    buffer_load_dwordx4 v[148:151], v1, s[36:39], s98 offen offset:1024 nt
    v_mov_b32 v3, 34
    v_mov_b32 v14, 99072
    s_mov_b64 exec, 1
    ds_write_b32 v14, v3
    s_mov_b64 exec, -1
    s_waitcnt vmcnt(2)
    buffer_load_dwordx4 v[152:155], v1, s[36:39], s98 offen offset:2048 nt
    s_waitcnt vmcnt(2)
    buffer_load_dwordx4 v[156:159], v1, s[36:39], s98 offen offset:3072 nt
    s_waitcnt vmcnt(2)
    s_addk_i32 s98, 28672
    s_cmp_eq_u32 s98, 258048
    s_cselect_b32 s98, 0, s98
    buffer_load_dwordx4 v[160:163], v1, s[40:43], s98 offen offset:0 nt
    s_waitcnt vmcnt(2)
    buffer_load_dwordx4 v[164:167], v1, s[40:43], s98 offen offset:1024 nt
    v_mov_b32 v3, 99076
    ds_read_b32 v3, v3
    s_waitcnt vmcnt(2)
    s_waitcnt lgkmcnt(0)
    v_readfirstlane_b32 s48, v3
    buffer_load_dwordx4 v[168:171], v1, s[40:43], s98 offen offset:2048 nt
    s_cmp_ge_u32 s48, 20
    s_cbranch_scc1 L_bo53
    s_waitcnt vmcnt(2)
L_bo53:
    buffer_load_dwordx4 v[172:175], v1, s[40:43], s98 offen offset:3072 nt
    s_waitcnt vmcnt(3)
    s_cmp_ge_u32 s48, 21
    s_cbranch_scc1 L_bo54
    s_waitcnt vmcnt(2)
L_bo54:
    s_addk_i32 s98, 28672
    buffer_load_dwordx4 v[176:179], v1, s[40:43], s98 offen offset:0 nt
    s_waitcnt vmcnt(3)
    s_cmp_ge_u32 s48, 22
    s_cbranch_scc1 L_bo55
    s_waitcnt vmcnt(2)
L_bo55:
    buffer_load_dwordx4 v[180:183], v1, s[40:43], s98 offen offset:1024 nt
    s_waitcnt vmcnt(3)
    s_cmp_ge_u32 s48, 23
    s_cbranch_scc1 L_bo56
    s_waitcnt vmcnt(2)
L_bo56:
    buffer_load_dwordx4 v[184:187], v1, s[40:43], s98 offen offset:2048 nt
    s_waitcnt vmcnt(3)
    s_cmp_ge_u32 s48, 24
    s_cbranch_scc1 L_bo57
    s_waitcnt vmcnt(2)
L_bo57:
    buffer_load_dwordx4 v[188:191], v1, s[40:43], s98 offen offset:3072 nt
    s_waitcnt vmcnt(3)
    s_cmp_ge_u32 s48, 24
    s_cbranch_scc1 L_bo58
    s_waitcnt vmcnt(2)
L_bo58:
    s_addk_i32 s98, 28672
    buffer_load_dwordx4 v[192:195], v1, s[40:43], s98 offen offset:0 nt
    s_waitcnt vmcnt(3)
    s_cmp_ge_u32 s48, 25
    s_cbranch_scc1 L_bo59
    s_waitcnt vmcnt(2)
L_bo59:
    buffer_load_dwordx4 v[196:199], v1, s[40:43], s98 offen offset:1024 nt
    v_mov_b32 v3, 46
    v_mov_b32 v14, 99072
    s_mov_b64 exec, 1
    ds_write_b32 v14, v3
    s_mov_b64 exec, -1
    s_waitcnt vmcnt(3)
    s_cmp_ge_u32 s48, 26
    s_cbranch_scc1 L_bo60
    s_waitcnt vmcnt(2)
L_bo60:
    buffer_load_dwordx4 v[200:203], v1, s[40:43], s98 offen offset:2048 nt
    s_waitcnt vmcnt(3)
    s_cmp_ge_u32 s48, 27
    s_cbranch_scc1 L_bo61
    s_waitcnt vmcnt(2)
L_bo61:
    buffer_load_dwordx4 v[204:207], v1, s[40:43], s98 offen offset:3072 nt
    s_waitcnt vmcnt(3)
    s_cmp_ge_u32 s48, 27
    s_cbranch_scc1 L_bo62
    s_waitcnt vmcnt(2)
L_bo62:
    s_addk_i32 s98, 28672
    buffer_load_dwordx4 v[208:211], v1, s[40:43], s98 offen offset:0 nt
    s_waitcnt vmcnt(3)
    s_cmp_ge_u32 s48, 28
    s_cbranch_scc1 L_bo63
    s_waitcnt vmcnt(2)
L_bo63:
    buffer_load_dwordx4 v[212:215], v1, s[40:43], s98 offen offset:1024 nt
    v_mov_b32 v3, 99076
    ds_read_b32 v3, v3
    s_waitcnt vmcnt(3)
    s_cmp_ge_u32 s48, 28
    s_cbranch_scc1 L_bo64
    s_waitcnt vmcnt(2)
L_bo64:
    s_waitcnt lgkmcnt(0)
    v_readfirstlane_b32 s48, v3
    buffer_load_dwordx4 v[216:219], v1, s[40:43], s98 offen offset:2048 nt
    s_waitcnt vmcnt(3)
    s_cmp_ge_u32 s48, 20
    s_cbranch_scc1 L_bo65
    s_waitcnt vmcnt(2)
L_bo65:
    buffer_load_dwordx4 v[220:223], v1, s[40:43], s98 offen offset:3072 nt
    s_waitcnt vmcnt(3)
    s_cmp_ge_u32 s48, 21
    s_cbranch_scc1 L_bo66
    s_waitcnt vmcnt(2)
L_bo66:
    s_addk_i32 s98, 28672
    buffer_load_dwordx4 v[224:227], v1, s[40:43], s98 offen offset:0 nt
    s_waitcnt vmcnt(3)
    s_cmp_ge_u32 s48, 22
    s_cbranch_scc1 L_bo67
    s_waitcnt vmcnt(2)
L_bo67:
    buffer_load_dwordx4 v[228:231], v1, s[40:43], s98 offen offset:1024 nt
    s_waitcnt vmcnt(3)
    s_cmp_ge_u32 s48, 23
    s_cbranch_scc1 L_bo68
    s_waitcnt vmcnt(2)
L_bo68:
    buffer_load_dwordx4 v[232:235], v1, s[40:43], s98 offen offset:2048 nt
    s_waitcnt vmcnt(3)
    s_cmp_ge_u32 s48, 24
    s_cbranch_scc1 L_bo69
    s_waitcnt vmcnt(2)
L_bo69:
    buffer_load_dwordx4 v[236:239], v1, s[40:43], s98 offen offset:3072 nt
    s_waitcnt vmcnt(3)
    s_cmp_ge_u32 s48, 24
    s_cbranch_scc1 L_bo70
    s_waitcnt vmcnt(2)
L_bo70:
    s_addk_i32 s98, 28672
    buffer_load_dwordx4 v[240:243], v1, s[40:43], s98 offen offset:0 nt
    v_mov_b32 v3, 57
    v_mov_b32 v14, 99072
    s_mov_b64 exec, 1
    ds_write_b32 v14, v3
    s_mov_b64 exec, -1
    s_waitcnt vmcnt(3)
    s_cmp_ge_u32 s48, 25
    s_cbranch_scc1 L_bo71
    s_waitcnt vmcnt(2)
L_bo71:
    buffer_load_dwordx4 v[244:247], v1, s[40:43], s98 offen offset:1024 nt
    s_waitcnt vmcnt(3)
    s_cmp_ge_u32 s48, 26
    s_cbranch_scc1 L_bo72
    s_waitcnt vmcnt(2)
L_bo72:
    buffer_load_dwordx4 v[248:251], v1, s[40:43], s98 offen offset:2048 nt
    s_waitcnt vmcnt(3)
    s_cmp_ge_u32 s48, 27
    s_cbranch_scc1 L_bo73
    s_waitcnt vmcnt(2)
L_bo73:
    buffer_load_dwordx4 v[252:255], v1, s[40:43], s98 offen offset:3072 nt
    v_mov_b32 v14, 99080
    s_mov_b32 s35, 0
L_poll74:
    ds_read_b128 v[4:7], v2
    ds_read_b32 v8, v14
    s_add_u32 s35, s35, 1
    s_waitcnt lgkmcnt(0)
    v_max3_u32 v3, v4, v5, v6
    v_max_u32 v3, v3, v7
    v_cmp_eq_u32 vcc, -1, v3
    s_cbranch_vccz L_done75
    s_sleep 2
    s_cmp_lt_u32 s35, 60000
    s_cbranch_scc1 L_poll74
L_done75:
    v_readfirstlane_b32 s99, v8
    v_dot2_f32_bf16 v8, v16, v4, 0
    v_dot2_f32_bf16 v9, v20, v4, 0
    v_dot2_f32_bf16 v10, v24, v4, 0
    v_dot2_f32_bf16 v11, v28, v4, 0
    v_dot2c_f32_bf16 v8, v17, v5
    v_dot2c_f32_bf16 v9, v21, v5
    v_dot2c_f32_bf16 v10, v25, v5
    v_dot2c_f32_bf16 v11, v29, v5
    v_dot2c_f32_bf16 v8, v18, v6
    v_dot2c_f32_bf16 v9, v22, v6
    v_dot2c_f32_bf16 v10, v26, v6
    v_dot2c_f32_bf16 v11, v30, v6
    v_dot2c_f32_bf16 v8, v19, v7
    v_dot2c_f32_bf16 v9, v23, v7
    v_dot2c_f32_bf16 v10, v27, v7
    v_dot2c_f32_bf16 v11, v31, v7
    v_add_f32_dpp v12, v8, v8 row_ror:8 row_mask:0xf bank_mask:0x3
    v_add_f32_dpp v12, v9, v9 row_ror:8 row_mask:0xf bank_mask:0xc
    v_add_f32_dpp v13, v10, v10 row_ror:8 row_mask:0xf bank_mask:0x3
    v_add_f32_dpp v13, v11, v11 row_ror:8 row_mask:0xf bank_mask:0xc
    v_dot2_f32_bf16 v8, v32, v4, 0
    v_dot2_f32_bf16 v9, v36, v4, 0
    v_dot2_f32_bf16 v10, v40, v4, 0
    v_dot2_f32_bf16 v11, v44, v4, 0
    v_add_f32_dpp v12, v12, v12 row_half_mirror row_mask:0xf bank_mask:0xf
    v_add_f32_dpp v13, v13, v13 row_half_mirror row_mask:0xf bank_mask:0xf
    v_dot2c_f32_bf16 v8, v33, v5
    v_dot2c_f32_bf16 v9, v37, v5
    v_dot2c_f32_bf16 v10, v41, v5
    v_dot2c_f32_bf16 v11, v45, v5
    v_add_f32_dpp v12, v12, v12 quad_perm:[1,0,3,2] row_mask:0xf bank_mask:0xf
    v_add_f32_dpp v13, v13, v13 quad_perm:[1,0,3,2] row_mask:0xf bank_mask:0xf
    v_dot2c_f32_bf16 v8, v34, v6
    v_dot2c_f32_bf16 v9, v38, v6
    v_dot2c_f32_bf16 v10, v42, v6
    v_dot2c_f32_bf16 v11, v46, v6
    v_add_f32_dpp v12, v12, v12 quad_perm:[2,3,0,1] row_mask:0xf bank_mask:0xf
    v_add_f32_dpp v13, v13, v13 quad_perm:[2,3,0,1] row_mask:0xf bank_mask:0xf
    v_dot2c_f32_bf16 v8, v35, v7
    v_dot2c_f32_bf16 v9, v39, v7
    v_dot2c_f32_bf16 v10, v43, v7
    v_dot2c_f32_bf16 v11, v47, v7
    s_waitcnt vmcnt(3)
    s_cmp_ge_u32 s48, 27
    s_cbranch_scc1 L_bo77
    s_waitcnt vmcnt(2)
L_bo77:
    s_addk_i32 s98, 28672
    buffer_load_dwordx4 v[32:35], v1, s[40:43], s98 offen offset:0 nt
    v_add_f32_dpp v16, v8, v8 row_ror:8 row_mask:0xf bank_mask:0x3
    v_add_f32_dpp v16, v9, v9 row_ror:8 row_mask:0xf bank_mask:0xc
    v_add_f32_dpp v17, v10, v10 row_ror:8 row_mask:0xf bank_mask:0x3
    v_add_f32_dpp v17, v11, v11 row_ror:8 row_mask:0xf bank_mask:0xc
    v_dot2_f32_bf16 v8, v48, v4, 0
    v_dot2_f32_bf16 v9, v52, v4, 0
    v_dot2_f32_bf16 v10, v56, v4, 0
    v_dot2_f32_bf16 v11, v60, v4, 0
    v_add_f32_dpp v16, v16, v16 row_half_mirror row_mask:0xf bank_mask:0xf
    v_add_f32_dpp v17, v17, v17 row_half_mirror row_mask:0xf bank_mask:0xf
    v_dot2c_f32_bf16 v8, v49, v5
    v_dot2c_f32_bf16 v9, v53, v5
    v_dot2c_f32_bf16 v10, v57, v5
    v_dot2c_f32_bf16 v11, v61, v5
    v_add_f32_dpp v16, v16, v16 quad_perm:[1,0,3,2] row_mask:0xf bank_mask:0xf
    v_add_f32_dpp v17, v17, v17 quad_perm:[1,0,3,2] row_mask:0xf bank_mask:0xf
    v_dot2c_f32_bf16 v8, v50, v6
    v_dot2c_f32_bf16 v9, v54, v6
    v_dot2c_f32_bf16 v10, v58, v6
    v_dot2c_f32_bf16 v11, v62, v6
    v_add_f32_dpp v16, v16, v16 quad_perm:[2,3,0,1] row_mask:0xf bank_mask:0xf
    v_add_f32_dpp v17, v17, v17 quad_perm:[2,3,0,1] row_mask:0xf bank_mask:0xf
    v_dot2c_f32_bf16 v8, v51, v7
    v_dot2c_f32_bf16 v9, v55, v7
    v_dot2c_f32_bf16 v10, v59, v7
    v_dot2c_f32_bf16 v11, v63, v7
    v_add_f32_dpp v18, v8, v8 row_ror:8 row_mask:0xf bank_mask:0x3
    v_add_f32_dpp v18, v9, v9 row_ror:8 row_mask:0xf bank_mask:0xc
    v_add_f32_dpp v19, v10, v10 row_ror:8 row_mask:0xf bank_mask:0x3
    v_add_f32_dpp v19, v11, v11 row_ror:8 row_mask:0xf bank_mask:0xc
    v_dot2_f32_bf16 v8, v64, v4, 0
    v_dot2_f32_bf16 v9, v68, v4, 0
    v_dot2_f32_bf16 v10, v72, v4, 0
    v_dot2_f32_bf16 v11, v76, v4, 0
    v_add_f32_dpp v18, v18, v18 row_half_mirror row_mask:0xf bank_mask:0xf
    v_add_f32_dpp v19, v19, v19 row_half_mirror row_mask:0xf bank_mask:0xf
    v_dot2c_f32_bf16 v8, v65, v5
    v_dot2c_f32_bf16 v9, v69, v5
    v_dot2c_f32_bf16 v10, v73, v5
    v_dot2c_f32_bf16 v11, v77, v5
    v_add_f32_dpp v18, v18, v18 quad_perm:[1,0,3,2] row_mask:0xf bank_mask:0xf
    v_add_f32_dpp v19, v19, v19 quad_perm:[1,0,3,2] row_mask:0xf bank_mask:0xf
    v_dot2c_f32_bf16 v8, v66, v6
    v_dot2c_f32_bf16 v9, v70, v6
    v_mov_b32 v3, 99076
    ds_read_b32 v3, v3
    s_waitcnt vmcnt(3)
    s_cmp_ge_u32 s48, 28
    s_cbranch_scc1 L_bo78
    s_waitcnt vmcnt(2)
L_bo78:
    s_waitcnt lgkmcnt(0)
    v_readfirstlane_b32 s48, v3
    buffer_load_dwordx4 v[36:39], v1, s[40:43], s98 offen offset:1024 nt
    v_dot2c_f32_bf16 v10, v74, v6
    v_dot2c_f32_bf16 v11, v78, v6
    v_add_f32_dpp v18, v18, v18 quad_perm:[2,3,0,1] row_mask:0xf bank_mask:0xf
    v_add_f32_dpp v19, v19, v19 quad_perm:[2,3,0,1] row_mask:0xf bank_mask:0xf
    v_dot2c_f32_bf16 v8, v67, v7
    v_dot2c_f32_bf16 v9, v71, v7
    v_dot2c_f32_bf16 v10, v75, v7
    v_dot2c_f32_bf16 v11, v79, v7
    v_add_f32_dpp v20, v8, v8 row_ror:8 row_mask:0xf bank_mask:0x3
    v_add_f32_dpp v20, v9, v9 row_ror:8 row_mask:0xf bank_mask:0xc
    v_add_f32_dpp v21, v10, v10 row_ror:8 row_mask:0xf bank_mask:0x3
    v_add_f32_dpp v21, v11, v11 row_ror:8 row_mask:0xf bank_mask:0xc
    v_dot2_f32_bf16 v8, v80, v4, 0
    v_dot2_f32_bf16 v9, v84, v4, 0
    v_dot2_f32_bf16 v10, v88, v4, 0
    v_dot2_f32_bf16 v11, v92, v4, 0
    v_add_f32_dpp v20, v20, v20 row_half_mirror row_mask:0xf bank_mask:0xf
    v_add_f32_dpp v21, v21, v21 row_half_mirror row_mask:0xf bank_mask:0xf
    v_dot2c_f32_bf16 v8, v81, v5
    v_dot2c_f32_bf16 v9, v85, v5
    v_dot2c_f32_bf16 v10, v89, v5
    v_dot2c_f32_bf16 v11, v93, v5
    v_add_f32_dpp v20, v20, v20 quad_perm:[1,0,3,2] row_mask:0xf bank_mask:0xf
    v_add_f32_dpp v21, v21, v21 quad_perm:[1,0,3,2] row_mask:0xf bank_mask:0xf
    v_dot2c_f32_bf16 v8, v82, v6
    v_dot2c_f32_bf16 v9, v86, v6
    v_dot2c_f32_bf16 v10, v90, v6
    v_dot2c_f32_bf16 v11, v94, v6
    v_add_f32_dpp v20, v20, v20 quad_perm:[2,3,0,1] row_mask:0xf bank_mask:0xf
    v_add_f32_dpp v21, v21, v21 quad_perm:[2,3,0,1] row_mask:0xf bank_mask:0xf
    v_dot2c_f32_bf16 v8, v83, v7
    v_dot2c_f32_bf16 v9, v87, v7
    v_dot2c_f32_bf16 v10, v91, v7
    v_dot2c_f32_bf16 v11, v95, v7
    v_add_f32_dpp v22, v8, v8 row_ror:8 row_mask:0xf bank_mask:0x3
    v_add_f32_dpp v22, v9, v9 row_ror:8 row_mask:0xf bank_mask:0xc
    v_add_f32_dpp v23, v10, v10 row_ror:8 row_mask:0xf bank_mask:0x3
    v_add_f32_dpp v23, v11, v11 row_ror:8 row_mask:0xf bank_mask:0xc
    v_dot2_f32_bf16 v8, v96, v4, 0
    v_dot2_f32_bf16 v9, v100, v4, 0
    v_dot2_f32_bf16 v10, v104, v4, 0
    v_dot2_f32_bf16 v11, v108, v4, 0
    v_add_f32_dpp v22, v22, v22 row_half_mirror row_mask:0xf bank_mask:0xf
    v_add_f32_dpp v23, v23, v23 row_half_mirror row_mask:0xf bank_mask:0xf
    s_waitcnt vmcnt(3)
    s_cmp_ge_u32 s48, 16
    s_cbranch_scc1 L_bo79
    s_waitcnt vmcnt(2)
L_bo79:
    buffer_load_dwordx4 v[40:43], v1, s[40:43], s98 offen offset:2048 nt
    v_dot2c_f32_bf16 v8, v97, v5
    v_dot2c_f32_bf16 v9, v101, v5
    v_dot2c_f32_bf16 v10, v105, v5
    v_dot2c_f32_bf16 v11, v109, v5
    v_add_f32_dpp v22, v22, v22 quad_perm:[1,0,3,2] row_mask:0xf bank_mask:0xf
    v_add_f32_dpp v23, v23, v23 quad_perm:[1,0,3,2] row_mask:0xf bank_mask:0xf
    v_dot2c_f32_bf16 v8, v98, v6
    v_dot2c_f32_bf16 v9, v102, v6
    v_dot2c_f32_bf16 v10, v106, v6
    v_dot2c_f32_bf16 v11, v110, v6
    v_add_f32_dpp v22, v22, v22 quad_perm:[2,3,0,1] row_mask:0xf bank_mask:0xf
    v_add_f32_dpp v23, v23, v23 quad_perm:[2,3,0,1] row_mask:0xf bank_mask:0xf
    v_dot2c_f32_bf16 v8, v99, v7
    v_dot2c_f32_bf16 v9, v103, v7
    v_dot2c_f32_bf16 v10, v107, v7
    v_dot2c_f32_bf16 v11, v111, v7
    v_add_f32_dpp v24, v8, v8 row_ror:8 row_mask:0xf bank_mask:0x3
    v_add_f32_dpp v24, v9, v9 row_ror:8 row_mask:0xf bank_mask:0xc
    v_add_f32_dpp v25, v10, v10 row_ror:8 row_mask:0xf bank_mask:0x3
    v_add_f32_dpp v25, v11, v11 row_ror:8 row_mask:0xf bank_mask:0xc
    v_dot2_f32_bf16 v8, v112, v4, 0
    v_dot2_f32_bf16 v9, v116, v4, 0
    v_dot2_f32_bf16 v10, v120, v4, 0
    v_dot2_f32_bf16 v11, v124, v4, 0
    v_add_f32_dpp v24, v24, v24 row_half_mirror row_mask:0xf bank_mask:0xf
    v_add_f32_dpp v25, v25, v25 row_half_mirror row_mask:0xf bank_mask:0xf
    v_dot2c_f32_bf16 v8, v113, v5
    v_dot2c_f32_bf16 v9, v117, v5
    v_dot2c_f32_bf16 v10, v121, v5
    v_dot2c_f32_bf16 v11, v125, v5
    v_add_f32_dpp v24, v24, v24 quad_perm:[1,0,3,2] row_mask:0xf bank_mask:0xf
    v_add_f32_dpp v25, v25, v25 quad_perm:[1,0,3,2] row_mask:0xf bank_mask:0xf
    v_dot2c_f32_bf16 v8, v114, v6
    v_dot2c_f32_bf16 v9, v118, v6
    v_dot2c_f32_bf16 v10, v122, v6
    v_dot2c_f32_bf16 v11, v126, v6
    v_add_f32_dpp v24, v24, v24 quad_perm:[2,3,0,1] row_mask:0xf bank_mask:0xf
    v_add_f32_dpp v25, v25, v25 quad_perm:[2,3,0,1] row_mask:0xf bank_mask:0xf
    v_dot2c_f32_bf16 v8, v115, v7
    v_dot2c_f32_bf16 v9, v119, v7
    v_dot2c_f32_bf16 v10, v123, v7
    v_dot2c_f32_bf16 v11, v127, v7
    v_add_f32_dpp v26, v8, v8 row_ror:8 row_mask:0xf bank_mask:0x3
    v_add_f32_dpp v26, v9, v9 row_ror:8 row_mask:0xf bank_mask:0xc
    s_waitcnt vmcnt(3)
    s_cmp_ge_u32 s48, 17
    s_cbranch_scc1 L_bo80
    s_waitcnt vmcnt(2)
L_bo80:
    buffer_load_dwordx4 v[44:47], v1, s[40:43], s98 offen offset:3072 nt
    v_add_f32_dpp v27, v10, v10 row_ror:8 row_mask:0xf bank_mask:0x3
    v_add_f32_dpp v27, v11, v11 row_ror:8 row_mask:0xf bank_mask:0xc
    v_dot2_f32_bf16 v8, v128, v4, 0
    v_dot2_f32_bf16 v9, v132, v4, 0
    v_dot2_f32_bf16 v10, v136, v4, 0
    v_dot2_f32_bf16 v11, v140, v4, 0
    v_add_f32_dpp v26, v26, v26 row_half_mirror row_mask:0xf bank_mask:0xf
    v_add_f32_dpp v27, v27, v27 row_half_mirror row_mask:0xf bank_mask:0xf
    v_dot2c_f32_bf16 v8, v129, v5
    v_dot2c_f32_bf16 v9, v133, v5
    v_dot2c_f32_bf16 v10, v137, v5
    v_dot2c_f32_bf16 v11, v141, v5
    v_add_f32_dpp v26, v26, v26 quad_perm:[1,0,3,2] row_mask:0xf bank_mask:0xf
    v_add_f32_dpp v27, v27, v27 quad_perm:[1,0,3,2] row_mask:0xf bank_mask:0xf
    v_dot2c_f32_bf16 v8, v130, v6
    v_dot2c_f32_bf16 v9, v134, v6
    v_dot2c_f32_bf16 v10, v138, v6
    v_dot2c_f32_bf16 v11, v142, v6
    v_add_f32_dpp v26, v26, v26 quad_perm:[2,3,0,1] row_mask:0xf bank_mask:0xf
    v_add_f32_dpp v27, v27, v27 quad_perm:[2,3,0,1] row_mask:0xf bank_mask:0xf
    v_dot2c_f32_bf16 v8, v131, v7
    v_dot2c_f32_bf16 v9, v135, v7
    v_dot2c_f32_bf16 v10, v139, v7
    v_dot2c_f32_bf16 v11, v143, v7
    v_add_f32_dpp v28, v8, v8 row_ror:8 row_mask:0xf bank_mask:0x3
    v_add_f32_dpp v28, v9, v9 row_ror:8 row_mask:0xf bank_mask:0xc
    v_add_f32_dpp v29, v10, v10 row_ror:8 row_mask:0xf bank_mask:0x3
    v_add_f32_dpp v29, v11, v11 row_ror:8 row_mask:0xf bank_mask:0xc
    v_dot2_f32_bf16 v8, v144, v4, 0
    v_dot2_f32_bf16 v9, v148, v4, 0
    v_dot2_f32_bf16 v10, v152, v4, 0
    v_dot2_f32_bf16 v11, v156, v4, 0
    v_add_f32_dpp v28, v28, v28 row_half_mirror row_mask:0xf bank_mask:0xf
    v_add_f32_dpp v29, v29, v29 row_half_mirror row_mask:0xf bank_mask:0xf
    v_dot2c_f32_bf16 v8, v145, v5
    v_dot2c_f32_bf16 v9, v149, v5
    v_dot2c_f32_bf16 v10, v153, v5
    v_dot2c_f32_bf16 v11, v157, v5
    v_add_f32_dpp v28, v28, v28 quad_perm:[1,0,3,2] row_mask:0xf bank_mask:0xf
    v_add_f32_dpp v29, v29, v29 quad_perm:[1,0,3,2] row_mask:0xf bank_mask:0xf
    v_dot2c_f32_bf16 v8, v146, v6
    v_dot2c_f32_bf16 v9, v150, v6
    v_dot2c_f32_bf16 v10, v154, v6
    v_dot2c_f32_bf16 v11, v158, v6
    s_waitcnt vmcnt(3)
    s_cmp_ge_u32 s48, 19
    s_cbranch_scc1 L_bo81
    s_waitcnt vmcnt(2)
L_bo81:
    s_addk_i32 s98, 28672
    s_cmp_eq_u32 s98, 258048
    s_cselect_b32 s98, 0, s98
    buffer_load_dwordx4 v[48:51], v1, s[40:43], s98 offen offset:0 nt
    v_add_f32_dpp v28, v28, v28 quad_perm:[2,3,0,1] row_mask:0xf bank_mask:0xf
    v_add_f32_dpp v29, v29, v29 quad_perm:[2,3,0,1] row_mask:0xf bank_mask:0xf
    v_dot2c_f32_bf16 v8, v147, v7
    v_dot2c_f32_bf16 v9, v151, v7
    v_dot2c_f32_bf16 v10, v155, v7
    v_dot2c_f32_bf16 v11, v159, v7
    v_add_f32_dpp v30, v8, v8 row_ror:8 row_mask:0xf bank_mask:0x3
    v_add_f32_dpp v30, v9, v9 row_ror:8 row_mask:0xf bank_mask:0xc
    v_add_f32_dpp v31, v10, v10 row_ror:8 row_mask:0xf bank_mask:0x3
    v_add_f32_dpp v31, v11, v11 row_ror:8 row_mask:0xf bank_mask:0xc
    v_add_f32_dpp v30, v30, v30 row_half_mirror row_mask:0xf bank_mask:0xf
    s_nop 0
    v_add_f32_dpp v31, v31, v31 row_half_mirror row_mask:0xf bank_mask:0xf
    v_add_f32_dpp v30, v30, v30 quad_perm:[1,0,3,2] row_mask:0xf bank_mask:0xf
    s_nop 0
    v_add_f32_dpp v31, v31, v31 quad_perm:[1,0,3,2] row_mask:0xf bank_mask:0xf
    v_add_f32_dpp v30, v30, v30 quad_perm:[2,3,0,1] row_mask:0xf bank_mask:0xf
    s_nop 0
    v_add_f32_dpp v31, v31, v31 quad_perm:[2,3,0,1] row_mask:0xf bank_mask:0xf
    v_max3_f32 v8, v12, v13, v16
    v_max3_f32 v8, v8, v17, v18
    v_max3_f32 v8, v8, v19, v20
    v_max3_f32 v8, v8, v21, v22
    v_max3_f32 v8, v8, v23, v24
    v_max3_f32 v8, v8, v25, v26
    v_max3_f32 v8, v8, v27, v28
    v_max3_f32 v8, v8, v29, v30
    v_max_f32 v8, v8, v31
    s_mov_b32 s34, 0x3e0293ee
    s_nop 0
    v_max_f32_dpp v8, v8, v8 row_ror:8 row_mask:0xf bank_mask:0xf
    v_mov_b32 v9, v8
    s_nop 1
    v_permlane16_swap_b32 v8, v9
    v_max_f32 v8, v8, v9
    v_mov_b32 v9, v8
    s_nop 1
    v_permlane32_swap_b32 v8, v9
    v_max_f32 v8, v8, v9
    v_mul_f32 v8, s34, v8
    v_fma_f32 v12, v12, s34, -v8
    v_fma_f32 v13, v13, s34, -v8
    v_fma_f32 v16, v16, s34, -v8
    v_fma_f32 v17, v17, s34, -v8
    v_fma_f32 v18, v18, s34, -v8
    v_fma_f32 v19, v19, s34, -v8
    v_fma_f32 v20, v20, s34, -v8
    v_fma_f32 v21, v21, s34, -v8
    v_fma_f32 v22, v22, s34, -v8
    v_fma_f32 v23, v23, s34, -v8
    s_waitcnt vmcnt(3)
    s_cmp_ge_u32 s48, 20
    s_cbranch_scc1 L_bo82
    s_waitcnt vmcnt(2)
L_bo82:
    buffer_load_dwordx4 v[52:55], v1, s[40:43], s98 offen offset:1024 nt
    v_fma_f32 v24, v24, s34, -v8
    v_fma_f32 v25, v25, s34, -v8
    v_fma_f32 v26, v26, s34, -v8
    v_fma_f32 v27, v27, s34, -v8
    v_fma_f32 v28, v28, s34, -v8
    v_fma_f32 v29, v29, s34, -v8
    v_fma_f32 v30, v30, s34, -v8
    v_fma_f32 v31, v31, s34, -v8
    v_exp_f32 v12, v12
    v_exp_f32 v13, v13
    v_exp_f32 v16, v16
    v_exp_f32 v17, v17
    v_exp_f32 v18, v18
    v_exp_f32 v19, v19
    v_exp_f32 v20, v20
    v_exp_f32 v21, v21
    v_exp_f32 v22, v22
    v_exp_f32 v23, v23
    v_exp_f32 v24, v24
    v_exp_f32 v25, v25
    v_exp_f32 v26, v26
    v_exp_f32 v27, v27
    v_exp_f32 v28, v28
    v_exp_f32 v29, v29
    v_exp_f32 v30, v30
    v_exp_f32 v31, v31
    v_add_f32 v9, v12, v13
    v_add_f32 v9, v9, v16
    v_add_f32 v9, v9, v17
    v_add_f32 v9, v9, v18
    v_add_f32 v9, v9, v19
    v_add_f32 v9, v9, v20
    v_add_f32 v9, v9, v21
    v_add_f32 v9, v9, v22
    v_add_f32 v9, v9, v23
    v_add_f32 v9, v9, v24
    v_add_f32 v9, v9, v25
    v_add_f32 v9, v9, v26
    v_add_f32 v9, v9, v27
    v_add_f32 v9, v9, v28
    v_add_f32 v9, v9, v29
    v_add_f32 v9, v9, v30
    v_add_f32 v9, v9, v31
    v_and_b32 v10, 1, v0
    s_cmp_ge_u32 s48, 21
    s_cbranch_scc1 L_bo83
    s_waitcnt vmcnt(3)
L_bo83:
    buffer_load_dwordx4 v[56:59], v1, s[40:43], s98 offen offset:2048 nt
    v_lshlrev_b32 v10, 4, v10
    v_mov_b32 v11, 0xffff
    v_lshlrev_b32 v10, v10, v11
    v_bfe_u32 v11, v0, 1, 2
    v_cmp_eq_u32 vcc, 0, v11
    s_nop 1
    v_cndmask_b32 v144, 0, v10, vcc
    v_cmp_eq_u32 vcc, 1, v11
    s_nop 1
    v_cndmask_b32 v145, 0, v10, vcc
    v_cmp_eq_u32 vcc, 2, v11
    s_nop 1
    v_cndmask_b32 v146, 0, v10, vcc
    v_cmp_eq_u32 vcc, 3, v11
    s_nop 1
    v_cndmask_b32 v147, 0, v10, vcc
    v_add_f32_dpp v9, v9, v9 row_ror:8 row_mask:0xf bank_mask:0xf
    v_mov_b32 v10, v9
    s_nop 1
    v_permlane16_swap_b32 v9, v10
    v_add_f32 v9, v9, v10
    v_mov_b32 v10, v9
    s_nop 1
    v_permlane32_swap_b32 v9, v10
    v_add_f32 v9, v9, v10
    s_lshl_b32 s34, s3, 3
    s_add_u32 s34, s34, 98552
    v_mov_b32 v10, s34
    s_mov_b64 exec, 1
    ds_write_b64 v10, v[8:9]
    s_mov_b64 exec, -1
    s_lshl_b32 s34, s3, 10
    s_add_u32 s34, s34, 98304
    v_lshrrev_b32 v2, 4, v0
    v_and_b32 v11, 7, v0
    v_lshl_add_u32 v2, v2, 3, v11
    v_bfe_u32 v11, v0, 3, 1
    v_lshl_add_u32 v2, v11, 5, v2
    v_lshl_add_u32 v2, v2, 4, s34
    v_cvt_pk_bf16_f32 v10, v12, v12
    v_and_b32 v128, v10, v144
    v_and_b32 v129, v10, v145
    v_and_b32 v130, v10, v146
    v_and_b32 v131, v10, v147
    s_nop 1
    v_mfma_f32_16x16x32_bf16 v[148:151], v[160:163], v[128:131], 0
    v_mfma_f32_16x16x32_bf16 v[152:155], v[164:167], v[128:131], 0
    v_cvt_pk_bf16_f32 v10, v13, v13
    v_and_b32 v132, v10, v144
    v_and_b32 v133, v10, v145
    v_and_b32 v134, v10, v146
    v_and_b32 v135, v10, v147
    s_nop 1
    v_mfma_f32_16x16x32_bf16 v[148:151], v[168:171], v[132:135], v[148:151]
    s_waitcnt vmcnt(4)
    s_cmp_ge_u32 s48, 22
    s_cbranch_scc1 L_bo84
    s_waitcnt vmcnt(3)
L_bo84:
    buffer_load_dwordx4 v[60:63], v1, s[40:43], s98 offen offset:3072 nt
    v_mfma_f32_16x16x32_bf16 v[152:155], v[172:175], v[132:135], v[152:155]
    v_cvt_pk_bf16_f32 v10, v16, v16
    v_and_b32 v128, v10, v144
    v_and_b32 v129, v10, v145
    v_and_b32 v130, v10, v146
    v_and_b32 v131, v10, v147
    s_nop 1
    v_mfma_f32_16x16x32_bf16 v[148:151], v[176:179], v[128:131], v[148:151]
    v_mfma_f32_16x16x32_bf16 v[152:155], v[180:183], v[128:131], v[152:155]
    v_cvt_pk_bf16_f32 v10, v17, v17
    v_and_b32 v132, v10, v144
    v_and_b32 v133, v10, v145
    v_and_b32 v134, v10, v146
    v_and_b32 v135, v10, v147
    s_nop 1
    v_mfma_f32_16x16x32_bf16 v[148:151], v[184:187], v[132:135], v[148:151]
    v_mfma_f32_16x16x32_bf16 v[152:155], v[188:191], v[132:135], v[152:155]
    v_cvt_pk_bf16_f32 v10, v18, v18
    v_and_b32 v128, v10, v144
    v_and_b32 v129, v10, v145
    v_and_b32 v130, v10, v146
    v_and_b32 v131, v10, v147
    s_nop 1
    v_mfma_f32_16x16x32_bf16 v[148:151], v[192:195], v[128:131], v[148:151]
    v_mfma_f32_16x16x32_bf16 v[152:155], v[196:199], v[128:131], v[152:155]
    v_cvt_pk_bf16_f32 v10, v19, v19
    v_and_b32 v132, v10, v144
    v_and_b32 v133, v10, v145
    v_and_b32 v134, v10, v146
    v_and_b32 v135, v10, v147
    s_nop 1
    v_mfma_f32_16x16x32_bf16 v[148:151], v[200:203], v[132:135], v[148:151]
    v_mfma_f32_16x16x32_bf16 v[152:155], v[204:207], v[132:135], v[152:155]
    v_cvt_pk_bf16_f32 v10, v20, v20
    v_and_b32 v128, v10, v144
    v_and_b32 v129, v10, v145
    v_and_b32 v130, v10, v146
    v_and_b32 v131, v10, v147
    s_nop 1
    v_mfma_f32_16x16x32_bf16 v[148:151], v[208:211], v[128:131], v[148:151]
    v_mfma_f32_16x16x32_bf16 v[152:155], v[212:215], v[128:131], v[152:155]
    v_cvt_pk_bf16_f32 v10, v21, v21
    v_and_b32 v132, v10, v144
    v_and_b32 v133, v10, v145
    v_and_b32 v134, v10, v146
    v_and_b32 v135, v10, v147
    s_nop 1
    v_mfma_f32_16x16x32_bf16 v[148:151], v[216:219], v[132:135], v[148:151]
    v_mfma_f32_16x16x32_bf16 v[152:155], v[220:223], v[132:135], v[152:155]
    v_cvt_pk_bf16_f32 v10, v22, v22
    s_waitcnt vmcnt(4)
    s_cmp_ge_u32 s48, 23
    s_cbranch_scc1 L_bo85
    s_waitcnt vmcnt(3)
L_bo85:
    s_addk_i32 s98, 28672
    buffer_load_dwordx4 v[64:67], v1, s[40:43], s98 offen offset:0 nt
    v_and_b32 v128, v10, v144
    v_and_b32 v129, v10, v145
    v_and_b32 v130, v10, v146
    v_and_b32 v131, v10, v147
    s_nop 1
    v_mfma_f32_16x16x32_bf16 v[148:151], v[224:227], v[128:131], v[148:151]
    v_mfma_f32_16x16x32_bf16 v[152:155], v[228:231], v[128:131], v[152:155]
    v_cvt_pk_bf16_f32 v10, v23, v23
    v_and_b32 v132, v10, v144
    v_and_b32 v133, v10, v145
    v_and_b32 v134, v10, v146
    v_and_b32 v135, v10, v147
    s_nop 1
    v_mfma_f32_16x16x32_bf16 v[148:151], v[232:235], v[132:135], v[148:151]
    v_mfma_f32_16x16x32_bf16 v[152:155], v[236:239], v[132:135], v[152:155]
    v_cvt_pk_bf16_f32 v10, v24, v24
    v_and_b32 v128, v10, v144
    v_and_b32 v129, v10, v145
    v_and_b32 v130, v10, v146
    v_and_b32 v131, v10, v147
    s_nop 1
    v_mfma_f32_16x16x32_bf16 v[148:151], v[240:243], v[128:131], v[148:151]
    v_mfma_f32_16x16x32_bf16 v[152:155], v[244:247], v[128:131], v[152:155]
    v_cvt_pk_bf16_f32 v10, v25, v25
    v_and_b32 v132, v10, v144
    v_and_b32 v133, v10, v145
    v_and_b32 v134, v10, v146
    v_and_b32 v135, v10, v147
    s_nop 1
    v_mfma_f32_16x16x32_bf16 v[148:151], v[248:251], v[132:135], v[148:151]
    v_mfma_f32_16x16x32_bf16 v[152:155], v[252:255], v[132:135], v[152:155]
    v_cvt_pk_bf16_f32 v10, v26, v26
    v_and_b32 v128, v10, v144
    v_and_b32 v129, v10, v145
    v_and_b32 v130, v10, v146
    v_and_b32 v131, v10, v147
    s_nop 1
    v_mfma_f32_16x16x32_bf16 v[148:151], v[32:35], v[128:131], v[148:151]
    v_mfma_f32_16x16x32_bf16 v[152:155], v[36:39], v[128:131], v[152:155]
    v_cvt_pk_bf16_f32 v10, v27, v27
    v_and_b32 v132, v10, v144
    v_and_b32 v133, v10, v145
    v_and_b32 v134, v10, v146
    v_and_b32 v135, v10, v147
    s_nop 1
    v_mfma_f32_16x16x32_bf16 v[148:151], v[40:43], v[132:135], v[148:151]
    v_mfma_f32_16x16x32_bf16 v[152:155], v[44:47], v[132:135], v[152:155]
    v_cvt_pk_bf16_f32 v10, v28, v28
    v_and_b32 v128, v10, v144
    v_and_b32 v129, v10, v145
    s_waitcnt vmcnt(4)
    s_cmp_ge_u32 s48, 24
    s_cbranch_scc1 L_bo86
    s_waitcnt vmcnt(3)
L_bo86:
    buffer_load_dwordx4 v[68:71], v1, s[40:43], s98 offen offset:1024 nt
    v_and_b32 v130, v10, v146
    v_and_b32 v131, v10, v147
    buffer_load_dwordx4 v[72:75], v1, s[40:43], s98 offen offset:2048 nt
    s_waitcnt vmcnt(5)
    buffer_load_dwordx4 v[76:79], v1, s[40:43], s98 offen offset:3072 nt
    s_barrier
    v_and_b32 v200, 3, v0
    v_bfe_u32 v201, v0, 2, 2
    v_lshrrev_b32 v202, 4, v0
    s_lshl_b32 s34, s3, 10
    s_add_u32 s34, s34, 122112
    v_mul_u32_u24 v203, 320, v201
    v_min_u32 v203, 704, v203
    v_lshl_add_u32 v203, v202, 6, v203
    v_lshl_add_u32 v203, v200, 4, v203
    v_add_u32 v203, s34, v203
    s_movk_i32 s48, 16384
    s_cmp_eq_u32 s63, 0
    s_cbranch_scc1 L_tp_wo
    s_cmp_eq_u32 s63, 1
    s_cbranch_scc1 L_tp_w1
    v_bfe_u32 v205, v0, 3, 2
    v_lshlrev_b32 v204, 3, v205
    v_lshrrev_b32 v205, 5, v0
    v_lshl_add_u32 v204, v205, 2, v204
    v_bfe_u32 v205, v0, 1, 2
    v_add_u32 v204, v204, v205
    v_and_b32 v205, 1, v0
    s_sub_u32 s49, s3, 1
    v_mul_u32_u24 v204, 1280, v204
    v_lshl_add_u32 v204, v205, 4, v204
    s_lshl_b32 s34, s62, 5
    s_mul_i32 s35, s49, 327680
    s_add_u32 s34, s34, s35
    v_add_u32 v204, s34, v204
    s_lshl_b32 s50, s49, 13
    s_add_u32 s50, s50, 40960
    v_lshl_add_u32 v205, v0, 3, s50
    s_lshl_b32 s34, s49, 8
    s_add_u32 s34, s34, s99
    s_and_b32 s35, s60, 1
    s_mul_i32 s35, s35, 917504
    s_add_u32 s34, s34, s35
    s_add_u32 s34, s34, 791552
    s_cmp_eq_u32 s49, 6
    s_cselect_b32 s35, 1, 3
    v_lshlrev_b32 v6, 6, v202
    v_lshl_add_u32 v6, v200, 4, v6
    v_add_u32 v6, s34, v6
    v_lshl_add_u32 v4, v201, 15, v6
    v_min_u32 v5, s35, v201
    v_lshl_add_u32 v5, v5, 15, v6
    v_mov_b32 v7, 99084
    s_lshl_b32 s40, s62, 1
    s_add_u32 s41, s40, 8
    s_add_u32 s42, s40, 2
    s_branch L_tp_e
L_tp_w1:
    v_and_b32 v205, 15, v0
    v_lshlrev_b32 v205, 4, v205
    s_and_b32 s49, s3, 3
    s_mul_i32 s34, s49, 1280
    s_add_u32 s34, s34, s99
    s_add_u32 s34, s34, 786432
    v_lshl_add_u32 v206, v202, 15, v205
    v_add_u32 v206, s34, v206
    s_mul_i32 s34, s49, 3840
    v_add_u32 v205, s34, v205
    s_branch L_tp_e
L_tp_wo:
    s_lshr_b32 s49, s3, 1
    s_lshl_b32 s49, s49, 15
    v_and_b32 v210, 7, v0
    s_mul_i32 s34, s60, 4096
    s_add_u32 s34, s34, s49
    s_add_u32 s34, s34, 1179904
    v_lshrrev_b32 v211, 3, v0
    v_mul_u32_u24 v205, 512, v211
    v_add_u32 v204, s34, v205
    s_lshl_b32 s35, s51, 7
    s_add_u32 s34, s34, s35
    s_sub_u32 s34, s34, 256
    v_lshl_add_u32 v205, v210, 4, v205
    v_add_u32 v205, s34, v205
    s_lshl_b32 s34, s3, 12
    s_add_u32 s34, s34, 40960
    v_lshrrev_b32 v206, 2, v0
    v_lshlrev_b32 v206, 6, v206
    v_lshl_add_u32 v206, v200, 3, v206
    v_add_u32 v206, s34, v206
    s_mul_i32 s34, s3, 1152
    s_add_u32 s34, s34, 107520
    v_mul_u32_u24 v207, 144, v211
    v_lshl_add_u32 v207, v210, 4, v207
    v_add_u32 v207, s34, v207
    v_mul_u32_u24 v208, 144, v210
    v_lshl_add_u32 v208, v202, 4, v208
    v_add_u32 v208, s34, v208
    v_mul_u32_u24 v212, 144, v211
    v_add_u32 v212, s34, v212
    v_mul_u32_u24 v213, 144, v210
    v_add_u32 v213, s34, v213
    v_and_b32 v211, 1, v211
    v_bfe_u32 v203, v0, 1, 2
    v_mul_u32_u24 v203, 144, v203
    v_and_b32 v214, 1, v0
    v_mul_u32_u24 v214, 576, v214
    v_lshl_add_u32 v214, v211, 6, v214
    v_lshl_add_u32 v214, v202, 4, v214
    s_add_u32 s34, s34, 14592
    v_add3_u32 v203, v203, v214, s34
    v_mov_b32 v210, 98816
    v_cmp_eq_u32 vcc, 0, v211
    s_nop 1
    v_cndmask_b32 v209, v208, v210, vcc
    v_cndmask_b32 v208, v210, v208, vcc
L_tp_e:
    v_mfma_f32_16x16x32_bf16 v[148:151], v[48:51], v[128:131], v[148:151]
    v_mfma_f32_16x16x32_bf16 v[152:155], v[52:55], v[128:131], v[152:155]
    v_cvt_pk_bf16_f32 v10, v29, v29
    v_and_b32 v132, v10, v144
    v_and_b32 v133, v10, v145
    v_and_b32 v134, v10, v146
    v_and_b32 v135, v10, v147
    s_waitcnt vmcnt(4)
    s_nop 0
    v_mfma_f32_16x16x32_bf16 v[148:151], v[56:59], v[132:135], v[148:151]
    v_mfma_f32_16x16x32_bf16 v[152:155], v[60:63], v[132:135], v[152:155]
    v_cvt_pk_bf16_f32 v10, v30, v30
    v_and_b32 v128, v10, v144
    v_and_b32 v129, v10, v145
    v_and_b32 v130, v10, v146
    v_and_b32 v131, v10, v147
    s_waitcnt vmcnt(2)
    s_nop 0
    v_mfma_f32_16x16x32_bf16 v[148:151], v[64:67], v[128:131], v[148:151]
    v_mfma_f32_16x16x32_bf16 v[152:155], v[68:71], v[128:131], v[152:155]
    v_cvt_pk_bf16_f32 v10, v31, v31
    v_and_b32 v132, v10, v144
    v_and_b32 v133, v10, v145
    v_and_b32 v134, v10, v146
    v_and_b32 v135, v10, v147
    s_waitcnt vmcnt(0)
    s_nop 0
    v_mfma_f32_16x16x32_bf16 v[148:151], v[72:75], v[132:135], v[148:151]
    v_mfma_f32_16x16x32_bf16 v[152:155], v[76:79], v[132:135], v[152:155]
    s_nop 7
    v_add_f32_dpp v148, v152, v148 row_ror:8 row_mask:0xf bank_mask:0xf
    v_add_f32_dpp v149, v153, v149 row_ror:8 row_mask:0xf bank_mask:0xf
    v_add_f32_dpp v150, v154, v150 row_ror:8 row_mask:0xf bank_mask:0xf
    v_add_f32_dpp v151, v155, v151 row_ror:8 row_mask:0xf bank_mask:0xf
    ds_write_b128 v2, v[148:151]
    s_waitcnt lgkmcnt(0)
    s_barrier
    s_cmp_eq_u32 s63, 0
    s_cbranch_scc1 L_t_wo
    s_cmp_eq_u32 s63, 2
    s_cbranch_scc1 L_t_w2
    s_cmp_eq_u32 s63, 3
    s_cbranch_scc1 L_fin
    s_branch L_t_w1
L_t_w2:
    s_barrier
L_w2_dma:
    s_and_b32 s34, s40, 7
    s_lshl_b32 s35, s34, 10
    s_add_u32 m0, s50, s35
    s_mul_i32 s34, s34, 40960
    buffer_load_dwordx4 v204, s[52:55], s34 offen  lds
    s_add_u32 s40, s40, 1
    s_cmp_lg_u32 s40, s42
    s_cbranch_scc1 L_w2_nw
L_w2_nw:
    s_cmp_lt_u32 s40, s41
    s_cbranch_scc1 L_w2_dma
    ds_read_b32 v8, v7
    s_waitcnt lgkmcnt(0)
    v_cmp_eq_u32 vcc, 0, v8
    s_cbranch_vccnz L_w2_slow
    s_mov_b32 s35, 0
    buffer_load_dwordx4 v[64:67], v4, s[44:47], 0 offen sc1
    buffer_load_dwordx4 v[68:71], v5, s[44:47], s48 offen sc1
    s_waitcnt vmcnt(2)
    ds_read_b64_tr_b16 v[32:33], v205 offset:0
    ds_read_b64_tr_b16 v[34:35], v205 offset:512
    ds_read_b64_tr_b16 v[36:37], v205 offset:1024
    ds_read_b64_tr_b16 v[38:39], v205 offset:1536
    ds_read_b64_tr_b16 v[40:41], v205 offset:2048
    ds_read_b64_tr_b16 v[42:43], v205 offset:2560
    ds_read_b64_tr_b16 v[44:45], v205 offset:3072
    ds_read_b64_tr_b16 v[46:47], v205 offset:3584
    s_waitcnt lgkmcnt(0)
    ds_read_b64_tr_b16 v[48:49], v205 offset:4096
    ds_read_b64_tr_b16 v[50:51], v205 offset:4608
    ds_read_b64_tr_b16 v[52:53], v205 offset:5120
    ds_read_b64_tr_b16 v[54:55], v205 offset:5632
    ds_read_b64_tr_b16 v[56:57], v205 offset:6144
    ds_read_b64_tr_b16 v[58:59], v205 offset:6656
    ds_read_b64_tr_b16 v[60:61], v205 offset:7168
    ds_read_b64_tr_b16 v[62:63], v205 offset:7680
    s_waitcnt lgkmcnt(0)
    s_branch L_w2_mid
L_w2_slow:
    s_waitcnt vmcnt(0)
    ds_read_b64_tr_b16 v[32:33], v205 offset:0
    ds_read_b64_tr_b16 v[34:35], v205 offset:512
    ds_read_b64_tr_b16 v[36:37], v205 offset:1024
    ds_read_b64_tr_b16 v[38:39], v205 offset:1536
    ds_read_b64_tr_b16 v[40:41], v205 offset:2048
    ds_read_b64_tr_b16 v[42:43], v205 offset:2560
    ds_read_b64_tr_b16 v[44:45], v205 offset:3072
    ds_read_b64_tr_b16 v[46:47], v205 offset:3584
    s_waitcnt lgkmcnt(0)
    ds_read_b64_tr_b16 v[48:49], v205 offset:4096
    ds_read_b64_tr_b16 v[50:51], v205 offset:4608
    ds_read_b64_tr_b16 v[52:53], v205 offset:5120
    ds_read_b64_tr_b16 v[54:55], v205 offset:5632
    ds_read_b64_tr_b16 v[56:57], v205 offset:6144
    ds_read_b64_tr_b16 v[58:59], v205 offset:6656
    ds_read_b64_tr_b16 v[60:61], v205 offset:7168
    ds_read_b64_tr_b16 v[62:63], v205 offset:7680
    s_waitcnt lgkmcnt(0)
    s_mov_b32 s35, 0
L_poll87:
    ds_read_b32 v8, v7
    s_add_u32 s35, s35, 1
    s_waitcnt lgkmcnt(0)
    v_cmp_eq_u32 vcc, 0, v8
    s_cbranch_vccz L_done88
    s_sleep 1
    s_cmp_lt_u32 s35, 60000
    s_cbranch_scc1 L_poll87
L_done88:
    s_mov_b32 s35, 0
L_poll90:
    buffer_load_dwordx4 v[64:67], v4, s[44:47], 0 offen sc1
    buffer_load_dwordx4 v[68:71], v5, s[44:47], s48 offen sc1
L_w2_mid:
    s_add_u32 s35, s35, 1
    s_waitcnt vmcnt(0)
    v_max3_u32 v28, v64, v65, v66
    v_max3_u32 v28, v28, v67, v68
    v_max3_u32 v28, v28, v69, v70
    v_max_u32 v28, v28, v71
    v_cmp_eq_u32 vcc, -1, v28
    s_cbranch_vccz L_done91
    s_cmp_lg_u32 s35, 64
    s_cbranch_scc1 L_tmo93
    s_mov_b64 exec, -1
    v_lshlrev_b32 v243, 4, v0
    v_add_u32 v243, 131328, v243
    ds_read_b96 v[240:242], v243
    s_waitcnt lgkmcnt(0)
    buffer_store_dword v240, v242, s[44:47], 0 offen sc1
    buffer_store_dword v241, v242, s[44:47], 0 offen offset:256 sc1
L_tmo93:
    s_cmp_lt_u32 s35, 60000
    s_cbranch_scc1 L_poll90
L_done91:
    v_mfma_f32_16x16x32_bf16 v[80:83], v[32:35], v[64:67], 0
    v_mfma_f32_16x16x32_bf16 v[80:83], v[48:51], v[68:71], v[80:83]
    v_mfma_f32_16x16x32_bf16 v[84:87], v[36:39], v[64:67], 0
    v_mfma_f32_16x16x32_bf16 v[84:87], v[52:55], v[68:71], v[84:87]
    v_mfma_f32_16x16x32_bf16 v[88:91], v[40:43], v[64:67], 0
    v_mfma_f32_16x16x32_bf16 v[88:91], v[56:59], v[68:71], v[88:91]
    v_mfma_f32_16x16x32_bf16 v[92:95], v[44:47], v[64:67], 0
    v_mfma_f32_16x16x32_bf16 v[92:95], v[60:63], v[68:71], v[92:95]
    s_nop 3
    v_add_f32_dpp v80, v84, v80 row_shl:4 row_mask:0xf bank_mask:0x1
    v_add_f32_dpp v81, v85, v81 row_shl:4 row_mask:0xf bank_mask:0x1
    v_add_f32_dpp v82, v86, v82 row_shl:4 row_mask:0xf bank_mask:0x1
    v_add_f32_dpp v83, v87, v83 row_shl:4 row_mask:0xf bank_mask:0x1
    v_add_f32_dpp v80, v88, v80 row_shl:8 row_mask:0xf bank_mask:0x1
    v_add_f32_dpp v81, v89, v81 row_shl:8 row_mask:0xf bank_mask:0x1
    v_add_f32_dpp v82, v90, v82 row_shl:8 row_mask:0xf bank_mask:0x1
    v_add_f32_dpp v83, v91, v83 row_shl:8 row_mask:0xf bank_mask:0x1
    v_add_f32_dpp v80, v92, v80 row_shl:12 row_mask:0xf bank_mask:0x1
    v_add_f32_dpp v81, v93, v81 row_shl:12 row_mask:0xf bank_mask:0x1
    v_add_f32_dpp v82, v94, v82 row_shl:12 row_mask:0xf bank_mask:0x1
    v_add_f32_dpp v83, v95, v83 row_shl:12 row_mask:0xf bank_mask:0x1
    ds_write_b128 v203, v[80:83]
    s_waitcnt lgkmcnt(0)
    s_barrier
    s_endpgm
L_w2_red:
    s_mov_b32 s35, 0
L_poll94:
    buffer_load_dwordx2 v[20:21], v204, s[44:47], 0 offen sc1
    buffer_load_dwordx2 v[22:23], v204, s[44:47], s48 offen sc1
    s_add_u32 s35, s35, 1
    s_waitcnt vmcnt(0)
    v_max3_u32 v28, v20, v21, v22
    v_max_u32 v28, v28, v23
    v_cmp_eq_u32 vcc, -1, v28
    s_cbranch_vccz L_done95
    s_cmp_lg_u32 s35, 21
    s_cbranch_scc1 L_tmo97
    s_mov_b64 exec, -1
    v_lshlrev_b32 v243, 4, v0
    v_add_u32 v243, 131328, v243
    ds_read_b96 v[240:242], v243
    s_waitcnt lgkmcnt(0)
    buffer_store_dword v240, v242, s[44:47], 0 offen sc1
    buffer_store_dword v241, v242, s[44:47], 0 offen offset:256 sc1
L_tmo97:
    s_sleep 6
    s_cmp_lt_u32 s35, 60000
    s_cbranch_scc1 L_poll94
L_done95:
    v_mov_b32 v7, 99084
    ds_write_b32 v7, v7
    v_lshlrev_b32 v44, 16, v20
    v_and_b32 v45, 0xffff0000, v20
    v_lshlrev_b32 v46, 16, v21
    v_and_b32 v47, 0xffff0000, v21
    v_lshlrev_b32 v48, 16, v22
    v_and_b32 v49, 0xffff0000, v22
    v_lshlrev_b32 v50, 16, v23
    v_and_b32 v51, 0xffff0000, v23
    v_add_f32 v108, v108, v44
    v_add_f32 v109, v109, v45
    v_add_f32 v110, v110, v46
    v_add_f32 v111, v111, v47
    v_add_f32 v108, v108, v48
    v_add_f32 v109, v109, v49
    v_add_f32 v110, v110, v50
    v_add_f32 v111, v111, v51
    s_mov_b32 s36, s28
    s_mov_b32 s37, s29
    s_movk_i32 s38, 5120
    v_add_f32_dpp v108, v108, v108 row_ror:4 row_mask:0xf bank_mask:0xf
    v_add_f32_dpp v109, v109, v109 row_ror:4 row_mask:0xf bank_mask:0xf
    v_add_f32_dpp v110, v110, v110 row_ror:4 row_mask:0xf bank_mask:0xf
    v_add_f32_dpp v111, v111, v111 row_ror:4 row_mask:0xf bank_mask:0xf
    v_add_f32_dpp v108, v108, v108 row_ror:8 row_mask:0xf bank_mask:0xf
    v_add_f32_dpp v109, v109, v109 row_ror:8 row_mask:0xf bank_mask:0xf
    v_add_f32_dpp v110, v110, v110 row_ror:8 row_mask:0xf bank_mask:0xf
    v_add_f32_dpp v111, v111, v111 row_ror:8 row_mask:0xf bank_mask:0xf
    v_mov_b32_dpp v108, v104 quad_perm:[0,1,2,3] row_mask:0xf bank_mask:0x2
    v_mov_b32_dpp v109, v105 quad_perm:[0,1,2,3] row_mask:0xf bank_mask:0x2
    v_mov_b32_dpp v110, v106 quad_perm:[0,1,2,3] row_mask:0xf bank_mask:0x2
    v_mov_b32_dpp v111, v107 quad_perm:[0,1,2,3] row_mask:0xf bank_mask:0x2
    ds_write_b128 v203, v[108:111]
    v_and_b32 v6, 31, v0
    v_lshlrev_b32 v6, 3, v6
    v_add_u32 v6, 122112, v6
    ds_read_b64 v[108:109], v6
    ds_read_b64 v[104:105], v6 offset:320
    v_bfe_u32 v112, v0, 1, 2
    v_mul_u32_u24 v112, 1280, v112
    v_bfe_u32 v7, v0, 3, 2
    v_lshl_add_u32 v112, v7, 3, v112
    v_and_b32 v7, 1, v0
    v_lshl_add_u32 v112, v7, 2, v112
    v_lshrrev_b32 v7, 5, v0
    v_lshl_add_u32 v112, v7, 28, v112
    s_lshl_b32 s34, s62, 5
    s_waitcnt lgkmcnt(0)
    s_barrier
    ds_read_b64 v[64:65], v6 offset:1024
    ds_read_b64 v[66:67], v6 offset:2048
    ds_read_b64 v[68:69], v6 offset:3072
    ds_read_b64 v[70:71], v6 offset:4096
    ds_read_b64 v[72:73], v6 offset:5120
    ds_read_b64 v[74:75], v6 offset:6144
    ds_read_b64 v[76:77], v6 offset:7168
    s_waitcnt lgkmcnt(6)
    v_pk_fma_f32 v[108:109], v[64:65], v[104:105], v[108:109]
    s_waitcnt lgkmcnt(5)
    v_pk_fma_f32 v[108:109], v[66:67], v[104:105], v[108:109]
    s_waitcnt lgkmcnt(4)
    v_pk_fma_f32 v[108:109], v[68:69], v[104:105], v[108:109]
    s_waitcnt lgkmcnt(3)
    v_pk_fma_f32 v[108:109], v[70:71], v[104:105], v[108:109]
    s_waitcnt lgkmcnt(2)
    v_pk_fma_f32 v[108:109], v[72:73], v[104:105], v[108:109]
    s_waitcnt lgkmcnt(1)
    v_pk_fma_f32 v[108:109], v[74:75], v[104:105], v[108:109]
    s_waitcnt lgkmcnt(0)
    v_pk_fma_f32 v[108:109], v[76:77], v[104:105], v[108:109]
    v_cvt_pk_bf16_f32 v20, v108, v109
    buffer_store_dword v20, v112, s[36:39], s34 offen
    s_endpgm
L_t_wo:
    s_barrier
L_r_wo2:
    s_mov_b32 m0, s56
    s_nop 0
    buffer_load_dwordx4 v15, s[52:55], s57 offen  lds
    s_mov_b32 m0, s58
    s_nop 0
    buffer_load_dwordx4 v15, s[52:55], s59 offen  lds
    s_xor_b32 m0, s56, 2048
    s_sub_u32 s34, 40960, s57
    buffer_load_dwordx4 v15, s[52:55], s34 offen  lds
    s_xor_b32 m0, s58, 2048
    s_sub_u32 s34, 42240, s57
    buffer_load_dwordx4 v15, s[52:55], s34 offen  lds
L_r_wo3:
    s_mov_b32 s35, 0
    s_mov_b32 s48, 0
    buffer_load_dwordx4 v[64:67], v205, s[44:47], 0 offen sc1
    buffer_load_dwordx2 v[26:27], v204, s[44:47], 0 offen sc1
    s_waitcnt vmcnt(2)
    ds_read_b64_tr_b16 v[32:33], v206 offset:0
    ds_read_b64_tr_b16 v[34:35], v206 offset:1024
    ds_read_b64_tr_b16 v[36:37], v206 offset:32
    ds_read_b64_tr_b16 v[38:39], v206 offset:1056
    ds_read_b64_tr_b16 v[40:41], v206 offset:2048
    ds_read_b64_tr_b16 v[42:43], v206 offset:3072
    ds_read_b64_tr_b16 v[44:45], v206 offset:2080
    ds_read_b64_tr_b16 v[46:47], v206 offset:3104
    s_branch L_pam
L_pa:
    buffer_load_dwordx4 v[64:67], v205, s[44:47], 0 offen sc1
    buffer_load_dwordx2 v[26:27], v204, s[44:47], 0 offen sc1
L_pam:
    s_add_u32 s35, s35, 1
    s_waitcnt vmcnt(0)
    ds_write_b128 v207, v[64:67]
    ds_write_b32 v212, v26 offset:128
    v_max3_u32 v28, v64, v65, v66
    v_max3_u32 v28, v28, v67, v26
    v_cmp_eq_u32 vcc, -1, v28
    s_cbranch_vccz L_pad
    s_cmp_lg_u32 s35, 64
    s_cbranch_scc1 L_tmo98
    s_mov_b64 exec, -1
    v_lshlrev_b32 v243, 4, v0
    v_add_u32 v243, 131328, v243
    ds_read_b96 v[240:242], v243
    s_waitcnt lgkmcnt(0)
    buffer_store_dword v240, v242, s[44:47], 0 offen sc1
    buffer_store_dword v241, v242, s[44:47], 0 offen offset:256 sc1
L_tmo98:
    s_mov_b64 exec, vcc
    s_cmp_lt_u32 s35, 60000
    s_cbranch_scc1 L_pa
L_pad:
    s_mov_b64 exec, -1
    ds_read_b32 v26, v213 offset:128
    ds_read_b128 v[68:71], v208 offset:0
    ds_read_b128 v[72:75], v209 offset:0
    ds_read_b128 v[76:79], v208 offset:64
    ds_read_b128 v[80:83], v209 offset:64
    s_waitcnt lgkmcnt(3)
    v_mfma_f32_16x16x32_bf16 v[20:23], v[32:35], v[68:71], 0
    s_waitcnt lgkmcnt(2)
    v_mfma_f32_16x16x32_bf16 v[20:23], v[36:39], v[72:75], v[20:23]
    s_waitcnt lgkmcnt(1)
    v_mfma_f32_16x16x32_bf16 v[20:23], v[40:43], v[76:79], v[20:23]
    s_waitcnt lgkmcnt(0)
    v_mfma_f32_16x16x32_bf16 v[20:23], v[44:47], v[80:83], v[20:23]
    v_sub_f32_dpp v26, v26, v26 quad_perm:[1,0,3,2] row_mask:0xf bank_mask:0xf
    v_exp_f32 v26, v26
    s_nop 0
    v_add_f32 v26, 1.0, v26
    v_rcp_f32 v26, v26
    s_nop 0
    v_sub_f32 v30, 1.0, v26
    s_nop 0
    v_pk_mul_f32 v[48:49], v[20:21], v[26:27] op_sel_hi:[1,0]
    v_pk_mul_f32 v[50:51], v[22:23], v[26:27] op_sel_hi:[1,0]
    v_fmac_f32_dpp v48, v20, v30 quad_perm:[1,0,3,2] row_mask:0xf bank_mask:0xf
    v_fmac_f32_dpp v49, v21, v30 quad_perm:[1,0,3,2] row_mask:0xf bank_mask:0xf
    v_fmac_f32_dpp v50, v22, v30 quad_perm:[1,0,3,2] row_mask:0xf bank_mask:0xf
    v_fmac_f32_dpp v51, v23, v30 quad_perm:[1,0,3,2] row_mask:0xf bank_mask:0xf
    ds_write_b128 v203, v[48:51]
    s_cmp_lg_u32 s3, 0
    s_waitcnt lgkmcnt(0)
    s_barrier
    s_cbranch_scc1 L_wo_x
    ds_read_b64 v[64:65], v113 offset:0
    ds_read_b64 v[66:67], v113 offset:1152
    ds_read_b64 v[68:69], v113 offset:2304
    ds_read_b64 v[70:71], v113 offset:3456
    ds_read_b64 v[72:73], v113 offset:4608
    ds_read_b64 v[74:75], v113 offset:5760
    ds_read_b64 v[76:77], v113 offset:6912
    ds_read_b64 v[78:79], v113 offset:8064
    s_waitcnt lgkmcnt(6)
    v_pk_add_f32 v[64:65], v[64:65], v[66:67]
    s_waitcnt lgkmcnt(5)
    v_pk_add_f32 v[64:65], v[64:65], v[68:69]
    s_waitcnt lgkmcnt(4)
    v_pk_add_f32 v[64:65], v[64:65], v[70:71]
    s_waitcnt lgkmcnt(3)
    v_pk_add_f32 v[64:65], v[64:65], v[72:73]
    s_waitcnt lgkmcnt(2)
    v_pk_add_f32 v[64:65], v[64:65], v[74:75]
    s_waitcnt lgkmcnt(1)
    v_pk_add_f32 v[64:65], v[64:65], v[76:77]
    s_waitcnt lgkmcnt(0)
    v_pk_add_f32 v[64:65], v[64:65], v[78:79]
    v_pk_mul_f32 v[64:65], v[64:65], v[100:101]
    v_cvt_pk_bf16_f32 v28, v64, v65
    v_min_u32 v28, -2, v28
    buffer_store_dword v28, v112, s[44:47], s101 offen sc1
    buffer_store_dword v28, v112, s[44:47], s93 offen sc1
L_wo_x:
    s_getreg_b32 s34, hwreg(HW_REG_XCC_ID, 0, 4)
    v_cmp_ne_u32 vcc, s34, v27
    s_cbranch_vccz L_fin
    s_mov_b64 exec, -1
    v_lshlrev_b32 v243, 4, v0
    v_add_u32 v243, 131328, v243
    ds_read_b96 v[240:242], v243
    s_waitcnt lgkmcnt(0)
    buffer_store_dword v240, v242, s[44:47], 0 offen sc1
    buffer_store_dword v241, v242, s[44:47], 0 offen offset:256 sc1
    s_endpgm
L_pgend:
.p2align 12
L_t_w1:
    s_barrier
L_r_w1:
    s_cmp_lt_u32 s3, 4
    s_cbranch_scc1 L_w1_ln
    s_and_b32 s49, s3, 3
    s_lshl_b32 s42, s49, 11
    s_add_u32 s42, s42, 40960
    s_bitcmp1_b32 s62, 0
    s_cbranch_scc1 L_rot1
    s_add_u32 m0, s42, 0
    s_add_u32 s34, s50, 0
    buffer_load_dwordx4 v15, s[52:55], s34 offen  lds
    s_add_u32 m0, s42, 1024
    s_add_u32 s34, s50, 884736
    buffer_load_dwordx4 v15, s[52:55], s34 offen  lds
    s_add_u32 m0, s42, 8192
    s_add_u32 s34, s50, 110592
    buffer_load_dwordx4 v15, s[52:55], s34 offen  lds
    s_add_u32 m0, s42, 9216
    s_add_u32 s34, s50, 995328
    buffer_load_dwordx4 v15, s[52:55], s34 offen  lds
    s_add_u32 m0, s42, 32768
    s_add_u32 s34, s51, 0
    buffer_load_dwordx4 v15, s[52:55], s34 offen  lds
    s_add_u32 m0, s42, 33792
    s_add_u32 s34, s51, 13824
    buffer_load_dwordx4 v15, s[52:55], s34 offen  lds
    s_add_u32 m0, s42, 16384
    s_add_u32 s34, s50, 221184
    buffer_load_dwordx4 v15, s[52:55], s34 offen  lds
    s_add_u32 m0, s42, 17408
    s_add_u32 s34, s50, 1105920
    buffer_load_dwordx4 v15, s[52:55], s34 offen  lds
    s_add_u32 m0, s42, 24576
    s_add_u32 s34, s50, 331776
    buffer_load_dwordx4 v15, s[52:55], s34 offen  lds
    s_add_u32 m0, s42, 25600
    s_add_u32 s34, s50, 1216512
    buffer_load_dwordx4 v15, s[52:55], s34 offen  lds
    s_branch L_rot2
L_rot1:
    s_add_u32 m0, s42, 16384
    s_add_u32 s34, s50, 221184
    buffer_load_dwordx4 v15, s[52:55], s34 offen  lds
    s_add_u32 m0, s42, 17408
    s_add_u32 s34, s50, 1105920
    buffer_load_dwordx4 v15, s[52:55], s34 offen  lds
    s_add_u32 m0, s42, 24576
    s_add_u32 s34, s50, 331776
    buffer_load_dwordx4 v15, s[52:55], s34 offen  lds
    s_add_u32 m0, s42, 25600
    s_add_u32 s34, s50, 1216512
    buffer_load_dwordx4 v15, s[52:55], s34 offen  lds
    s_add_u32 m0, s42, 32768
    s_add_u32 s34, s51, 0
    buffer_load_dwordx4 v15, s[52:55], s34 offen  lds
    s_add_u32 m0, s42, 33792
    s_add_u32 s34, s51, 13824
    buffer_load_dwordx4 v15, s[52:55], s34 offen  lds
    s_add_u32 m0, s42, 0
    s_add_u32 s34, s50, 0
    buffer_load_dwordx4 v15, s[52:55], s34 offen  lds
    s_add_u32 m0, s42, 1024
    s_add_u32 s34, s50, 884736
    buffer_load_dwordx4 v15, s[52:55], s34 offen  lds
    s_add_u32 m0, s42, 8192
    s_add_u32 s34, s50, 110592
    buffer_load_dwordx4 v15, s[52:55], s34 offen  lds
    s_add_u32 m0, s42, 9216
    s_add_u32 s34, s50, 995328
    buffer_load_dwordx4 v15, s[52:55], s34 offen  lds
L_rot2:
    v_lshrrev_b32 v3, 2, v0
    v_lshlrev_b32 v3, 6, v3
    v_lshl_add_u32 v3, v200, 3, v3
    v_add_u32 v3, s42, v3
    s_lshl_b32 s35, s49, 6
    s_add_u32 s35, s35, 116736
    v_mul_u32_u24 v4, 1344, v200
    v_lshl_add_u32 v4, v202, 4, v4
    v_add_u32 v4, s35, v4
    s_lshl_b32 s35, s49, 10
    s_sub_u32 s35, s35, 4096
    v_add_u32 v5, s35, v203
    v_and_b32 v6, 1, v201
    v_mul_u32_u24 v6, 5376, v6
    v_add_u32 v6, v6, v4
    v_subrev_u32 v6, 90112, v6
    v_subrev_u32 v7, 22784, v5
    s_waitcnt vmcnt(0)
    s_barrier
    ds_read_b64_tr_b16 v[32:33], v3 offset:0
    ds_read_b64_tr_b16 v[34:35], v3 offset:1024
    ds_read_b64_tr_b16 v[36:37], v3 offset:32
    ds_read_b64_tr_b16 v[38:39], v3 offset:1056
    ds_read_b64_tr_b16 v[40:41], v3 offset:8192
    ds_read_b64_tr_b16 v[42:43], v3 offset:9216
    ds_read_b64_tr_b16 v[44:45], v3 offset:8224
    ds_read_b64_tr_b16 v[46:47], v3 offset:9248
    ds_read_b64_tr_b16 v[48:49], v3 offset:16384
    ds_read_b64_tr_b16 v[50:51], v3 offset:17408
    ds_read_b64_tr_b16 v[52:53], v3 offset:16416
    ds_read_b64_tr_b16 v[54:55], v3 offset:17440
    s_waitcnt lgkmcnt(4)
    ds_read_b64_tr_b16 v[56:57], v3 offset:24576
    ds_read_b64_tr_b16 v[58:59], v3 offset:25600
    ds_read_b64_tr_b16 v[60:61], v3 offset:24608
    ds_read_b64_tr_b16 v[62:63], v3 offset:25632
    ds_read_b64_tr_b16 v[64:65], v3 offset:32768
    ds_read_b64_tr_b16 v[66:67], v3 offset:33792
    ds_read_b64_tr_b16 v[68:69], v3 offset:32800
    ds_read_b64_tr_b16 v[70:71], v3 offset:33824
    s_waitcnt lgkmcnt(0)
    ds_read_b128 v[140:143], v6 offset:0
    ds_read_b128 v[144:147], v6 offset:256
    ds_read_b128 v[148:151], v6 offset:512
    ds_read_b128 v[152:155], v6 offset:768
    ds_read_b128 v[156:159], v6 offset:1024
    s_waitcnt lgkmcnt(4)
    v_mfma_f32_16x16x32_bf16 v[20:23], v[32:35], v[140:143], 0
    v_mfma_f32_16x16x32_bf16 v[24:27], v[36:39], v[140:143], 0
    s_waitcnt lgkmcnt(3)
    v_mfma_f32_16x16x32_bf16 v[20:23], v[40:43], v[144:147], v[20:23]
    v_mfma_f32_16x16x32_bf16 v[24:27], v[44:47], v[144:147], v[24:27]
    s_waitcnt lgkmcnt(2)
    v_mfma_f32_16x16x32_bf16 v[20:23], v[48:51], v[148:151], v[20:23]
    v_mfma_f32_16x16x32_bf16 v[24:27], v[52:55], v[148:151], v[24:27]
    s_waitcnt lgkmcnt(1)
    v_mfma_f32_16x16x32_bf16 v[20:23], v[56:59], v[152:155], v[20:23]
    v_mfma_f32_16x16x32_bf16 v[24:27], v[60:63], v[152:155], v[24:27]
    s_waitcnt lgkmcnt(0)
    v_mfma_f32_16x16x32_bf16 v[20:23], v[64:67], v[156:159], v[20:23]
    v_mfma_f32_16x16x32_bf16 v[24:27], v[68:71], v[156:159], v[24:27]
    s_nop 6
    ds_write_b128 v7, v[20:23]
    ds_write_b128 v7, v[24:27] offset:1024
    s_waitcnt lgkmcnt(0)
    s_setprio 3
    s_barrier
    ds_read_b128 v[140:143], v4 offset:0
    ds_read_b128 v[144:147], v4 offset:256
    ds_read_b128 v[148:151], v4 offset:512
    ds_read_b128 v[152:155], v4 offset:768
    ds_read_b128 v[156:159], v4 offset:1024
    s_waitcnt lgkmcnt(4)
    v_mfma_f32_16x16x32_bf16 v[20:23], v[32:35], v[140:143], 0
    v_mfma_f32_16x16x32_bf16 v[24:27], v[36:39], v[140:143], 0
    s_waitcnt lgkmcnt(3)
    v_mfma_f32_16x16x32_bf16 v[20:23], v[40:43], v[144:147], v[20:23]
    v_mfma_f32_16x16x32_bf16 v[24:27], v[44:47], v[144:147], v[24:27]
    s_waitcnt lgkmcnt(2)
    v_mfma_f32_16x16x32_bf16 v[20:23], v[48:51], v[148:151], v[20:23]
    v_mfma_f32_16x16x32_bf16 v[24:27], v[52:55], v[148:151], v[24:27]
    s_waitcnt lgkmcnt(1)
    v_mfma_f32_16x16x32_bf16 v[20:23], v[56:59], v[152:155], v[20:23]
    v_mfma_f32_16x16x32_bf16 v[24:27], v[60:63], v[152:155], v[24:27]
    s_waitcnt lgkmcnt(0)
    v_mfma_f32_16x16x32_bf16 v[20:23], v[64:67], v[156:159], v[20:23]
    v_mfma_f32_16x16x32_bf16 v[24:27], v[68:71], v[156:159], v[24:27]
    s_nop 6
    ds_write_b128 v5, v[20:23]
    ds_write_b128 v5, v[24:27] offset:1024
    s_waitcnt lgkmcnt(0)
    s_barrier
    s_endpgm
L_w1_ln:
    s_setprio 1
    ds_read_b128 v[140:143], v205 offset:0
    ds_read_b128 v[144:147], v205 offset:256
    ds_read_b128 v[148:151], v205 offset:512
    ds_read_b128 v[152:155], v205 offset:768
    ds_read_b128 v[156:159], v205 offset:1024
    ds_read_b128 v[160:163], v205 offset:1280
    ds_read_b128 v[164:167], v205 offset:1536
    ds_read_b128 v[168:171], v205 offset:1792
    ds_read_b128 v[172:175], v205 offset:2048
    ds_read_b128 v[176:179], v205 offset:2304
    ds_read_b128 v[180:183], v205 offset:2560
    ds_read_b128 v[184:187], v205 offset:2816
    ds_read_b128 v[188:191], v205 offset:3072
    ds_read_b128 v[192:195], v205 offset:3328
    ds_read_b128 v[196:199], v205 offset:3584
    v_and_b32 v8, 1, v0
    v_lshlrev_b32 v8, 4, v8
    v_mov_b32 v9, 0xffff
    v_lshlrev_b32 v8, v8, v9
    v_bfe_u32 v9, v0, 1, 2
    v_cmp_eq_u32 vcc, 0, v9
    s_nop 1
    v_cndmask_b32 v16, 0, v8, vcc
    v_cmp_eq_u32 vcc, 1, v9
    s_nop 1
    v_cndmask_b32 v17, 0, v8, vcc
    v_cmp_eq_u32 vcc, 2, v9
    s_nop 1
    v_cndmask_b32 v18, 0, v8, vcc
    v_cmp_eq_u32 vcc, 3, v9
    s_nop 1
    v_cndmask_b32 v19, 0, v8, vcc
    v_bfe_u32 v8, v0, 3, 1
    v_cmp_eq_u32 vcc, 0, v8
    s_nop 1
    v_cndmask_b32 v20, 0, v16, vcc
    v_xor_b32 v24, v20, v16
    v_cndmask_b32 v21, 0, v17, vcc
    v_xor_b32 v25, v21, v17
    v_cndmask_b32 v22, 0, v18, vcc
    v_xor_b32 v26, v22, v18
    v_cndmask_b32 v23, 0, v19, vcc
    v_xor_b32 v27, v23, v19
    v_and_b32 v52, 0x3f803f80, v20
    v_and_b32 v60, 0x3e803e80, v20
    v_and_b32 v53, 0x3f803f80, v21
    v_and_b32 v61, 0x3e803e80, v21
    v_and_b32 v54, 0x3f803f80, v22
    v_and_b32 v62, 0x3e803e80, v22
    v_and_b32 v55, 0x3f803f80, v23
    v_and_b32 v63, 0x3e803e80, v23
    v_and_b32 v56, 0x3f803f80, v24
    v_and_b32 v64, 0x3e803e80, v24
    v_and_b32 v57, 0x3f803f80, v25
    v_and_b32 v65, 0x3e803e80, v25
    v_and_b32 v58, 0x3f803f80, v26
    v_and_b32 v66, 0x3e803e80, v26
    v_and_b32 v59, 0x3f803f80, v27
    v_and_b32 v67, 0x3e803e80, v27
    s_waitcnt lgkmcnt(0)
    v_mfma_f32_16x16x32_bf16 v[68:71], v[140:143], v[60:63], 0
    v_mfma_f32_16x16x32_bf16 v[68:71], v[144:147], v[64:67], v[68:71]
    v_mfma_f32_16x16x32_bf16 v[72:75], v[148:151], v[60:63], 0
    v_mfma_f32_16x16x32_bf16 v[72:75], v[152:155], v[64:67], v[72:75]
    v_mfma_f32_16x16x32_bf16 v[76:79], v[156:159], v[60:63], 0
    v_mfma_f32_16x16x32_bf16 v[116:119], v[160:163], v[60:63], 0
    v_mfma_f32_16x16x32_bf16 v[116:119], v[164:167], v[64:67], v[116:119]
    v_mfma_f32_16x16x32_bf16 v[120:123], v[168:171], v[60:63], 0
    v_mfma_f32_16x16x32_bf16 v[120:123], v[172:175], v[64:67], v[120:123]
    v_mfma_f32_16x16x32_bf16 v[124:127], v[176:179], v[60:63], 0
    v_mfma_f32_16x16x32_bf16 v[80:83], v[180:183], v[60:63], 1.0
    v_mfma_f32_16x16x32_bf16 v[80:83], v[184:187], v[64:67], v[80:83]
    v_mfma_f32_16x16x32_bf16 v[84:87], v[188:191], v[60:63], 1.0
    v_mfma_f32_16x16x32_bf16 v[84:87], v[192:195], v[64:67], v[84:87]
    v_mfma_f32_16x16x32_bf16 v[88:91], v[196:199], v[60:63], 1.0
    s_mul_i32 s34, s3, 1344
    s_add_u32 s34, s34, 116736
    v_lshl_add_u32 v7, v0, 4, s34
    v_lshlrev_b32 v8, 6, v202
    v_lshl_add_u32 v8, v200, 4, v8
    v_and_b32 v9, 1, v201
    v_lshl_add_u32 v8, v9, 3, v8
    v_add_u32 v8, s34, v8
    v_bfe_u32 v9, v0, 3, 1
    v_mul_u32_u24 v9, 6144, v9
    v_sub_u32 v8, v8, v9
    v_lshrrev_b32 v9, 5, v0
    v_lshlrev_b32 v9, 10, v9
    v_and_b32 v6, 1, v202
    v_lshl_add_u32 v9, v6, 7, v9
    v_bfe_u32 v6, v0, 1, 1
    v_lshl_add_u32 v9, v6, 6, v9
    v_lshl_add_u32 v9, v201, 4, v9
    v_and_b32 v6, 1, v0
    v_lshl_add_u32 v9, v6, 3, v9
    v_add_u32 v9, 122112, v9
    s_lshr_b32 s34, s62, 3
    s_lshl_b32 s34, s34, 8
    s_and_b32 s49, s62, 3
    s_lshl_b32 s49, s49, 15
    s_add_u32 s34, s34, s49
    s_bfe_u32 s49, s62, 0x10002
    s_lshl_b32 s49, s49, 14
    s_add_u32 s34, s34, s49
    s_add_u32 s34, s34, 791552
    v_lshl_add_u32 v5, v0, 2, s34
    v_add_u32 v4, 917504, v5
    s_bfe_u32 s49, s60, 0x10002
    s_lshl_b32 s49, s49, 13
    s_xor_b32 s53, s99, s49
    s_xor_b32 s52, s53, 8192
    v_subrev_u32 v10, 90112, v7
    v_subrev_u32 v11, 90112, v8
    v_cvt_pk_bf16_f32 v32, v116, v117
    v_cvt_pk_bf16_f32 v33, v118, v119
    v_cvt_pk_bf16_f32 v34, v120, v121
    v_cvt_pk_bf16_f32 v35, v122, v123
    v_cvt_pk_bf16_f32 v36, v124, v125
    v_cvt_pk_bf16_f32 v37, v126, v127
    s_mov_b32 exec_lo, 0x00ff00ff
    s_mov_b32 exec_hi, 0x00ff00ff
    ds_write_b64 v11, v[36:37] offset:6400
    s_mov_b64 exec, -1
    ds_write_b128 v10, v[32:35] offset:5376
    v_cvt_pk_bf16_f32 v20, v80, v81
    v_cvt_pk_bf16_f32 v21, v82, v83
    v_cvt_pk_bf16_f32 v22, v84, v85
    v_cvt_pk_bf16_f32 v23, v86, v87
    v_cvt_pk_bf16_f32 v24, v88, v89
    v_cvt_pk_bf16_f32 v25, v90, v91
    ds_write_b128 v10, v[20:23]
    ds_write_b64 v11, v[24:25] offset:1024
    v_lshlrev_b32 v80, 16, v20
    v_and_b32 v81, 0xffff0000, v20
    v_lshlrev_b32 v82, 16, v21
    v_and_b32 v83, 0xffff0000, v21
    v_lshlrev_b32 v84, 16, v22
    v_and_b32 v85, 0xffff0000, v22
    v_lshlrev_b32 v86, 16, v23
    v_and_b32 v87, 0xffff0000, v23
    v_lshlrev_b32 v88, 16, v24
    v_and_b32 v89, 0xffff0000, v24
    v_lshlrev_b32 v90, 16, v25
    v_and_b32 v91, 0xffff0000, v25
    v_subrev_u32 v11, 22784, v9
    s_lshl_b32 s34, s3, 3
    s_add_u32 s34, s34, 99136
    v_mov_b32 v12, s34
    v_lshlrev_b32 v13, 3, v201
    v_add_u32 v13, 99136, v13
    s_mov_b32 s54, 0
    s_brev_b32 s55, 1
    s_waitcnt lgkmcnt(0)
    s_barrier
    s_mov_b32 s35, 0
    s_mov_b64 s[40:41], -1
    s_mov_b64 s[42:43], -1
L_pb:
    s_mov_b64 exec, s[40:41]
    s_cbranch_execz L_pbs0
    buffer_load_dwordx4 v[140:143], v206, s[44:47], 0 offen offset:0 sc1
    buffer_load_dwordx4 v[148:151], v206, s[44:47], 0 offen offset:256 sc1
    buffer_load_dwordx4 v[156:159], v206, s[44:47], 0 offen offset:512 sc1
    buffer_load_dwordx4 v[164:167], v206, s[44:47], 0 offen offset:768 sc1
    buffer_load_dwordx4 v[172:175], v206, s[44:47], 0 offen offset:1024 sc1
L_pbs0:
    s_mov_b64 exec, s[42:43]
    s_cbranch_execz L_pbs1
    buffer_load_dwordx4 v[144:147], v206, s[44:47], s48 offen offset:0 sc1
    buffer_load_dwordx4 v[152:155], v206, s[44:47], s48 offen offset:256 sc1
    buffer_load_dwordx4 v[160:163], v206, s[44:47], s48 offen offset:512 sc1
    buffer_load_dwordx4 v[168:171], v206, s[44:47], s48 offen offset:768 sc1
    buffer_load_dwordx4 v[176:179], v206, s[44:47], s48 offen offset:1024 sc1
L_pbs1:
    s_mov_b64 exec, -1
    s_add_u32 s35, s35, 1
    s_waitcnt vmcnt(0)
    v_mfma_f32_16x16x32_bf16 v[128:131], v[140:143], v[52:55], v[68:71]
    v_max3_u32 v28, v140, v141, v142
    v_max3_u32 v29, v144, v145, v146
    v_mfma_f32_16x16x32_bf16 v[128:131], v[144:147], v[52:55], v[128:131]
    v_max3_u32 v28, v28, v143, v148
    v_max3_u32 v29, v29, v147, v152
    v_mfma_f32_16x16x32_bf16 v[128:131], v[148:151], v[56:59], v[128:131]
    v_max3_u32 v28, v28, v149, v150
    v_max3_u32 v29, v29, v153, v154
    v_mfma_f32_16x16x32_bf16 v[128:131], v[152:155], v[56:59], v[128:131]
    v_max3_u32 v28, v28, v151, v156
    v_max3_u32 v29, v29, v155, v160
    v_mfma_f32_16x16x32_bf16 v[132:135], v[156:159], v[52:55], v[72:75]
    v_max3_u32 v28, v28, v157, v158
    v_max3_u32 v29, v29, v161, v162
    v_mfma_f32_16x16x32_bf16 v[132:135], v[160:163], v[52:55], v[132:135]
    v_max3_u32 v28, v28, v159, v164
    v_max3_u32 v29, v29, v163, v168
    v_mfma_f32_16x16x32_bf16 v[132:135], v[164:167], v[56:59], v[132:135]
    v_max3_u32 v28, v28, v165, v166
    v_max3_u32 v29, v29, v169, v170
    v_mfma_f32_16x16x32_bf16 v[132:135], v[168:171], v[56:59], v[132:135]
    v_max3_u32 v28, v28, v167, v172
    v_max3_u32 v29, v29, v171, v176
    v_mfma_f32_16x16x32_bf16 v[136:139], v[172:175], v[52:55], v[76:79]
    v_max3_u32 v28, v28, v173, v174
    v_max3_u32 v29, v29, v177, v178
    v_mfma_f32_16x16x32_bf16 v[136:139], v[176:179], v[52:55], v[136:139]
    v_max_u32 v28, v28, v175
    v_max_u32 v29, v29, v179
    v_cmp_eq_u32 s[40:41], -1, v28
    v_cmp_eq_u32 s[42:43], -1, v29
    s_nop 0
    s_or_b64 vcc, s[40:41], s[42:43]
    s_cbranch_scc0 L_pbd
    s_cmp_lg_u32 s35, 64
    s_cbranch_scc1 L_tmo99
    s_mov_b64 exec, -1
    v_lshlrev_b32 v243, 4, v0
    v_add_u32 v243, 131328, v243
    ds_read_b96 v[240:242], v243
    s_waitcnt lgkmcnt(0)
    buffer_store_dword v240, v242, s[44:47], 0 offen sc1
    buffer_store_dword v241, v242, s[44:47], 0 offen offset:256 sc1
L_tmo99:
    s_cmp_lt_u32 s35, 60000
    s_cbranch_scc1 L_pb
L_pbd:
    v_pk_mul_f32 v[32:33], v[128:129], v[80:81]
    v_pk_mul_f32 v[34:35], v[130:131], v[82:83]
    v_pk_mul_f32 v[36:37], v[132:133], v[84:85]
    v_pk_mul_f32 v[38:39], v[134:135], v[86:87]
    v_cvt_pk_bf16_f32 v24, v32, v33
    v_cvt_pk_bf16_f32 v25, v34, v35
    v_cvt_pk_bf16_f32 v26, v36, v37
    v_cvt_pk_bf16_f32 v27, v38, v39
    ds_write_b128 v7, v[24:27]
    v_pk_mul_f32 v[40:41], v[136:137], v[88:89]
    v_pk_mul_f32 v[42:43], v[138:139], v[90:91]
    v_cvt_pk_bf16_f32 v28, v40, v41
    v_cvt_pk_bf16_f32 v29, v42, v43
    ds_write_b64 v8, v[28:29] offset:1024
    v_pk_add_f32 v[20:21], v[128:129], v[130:131]
    v_pk_mul_f32 v[22:23], v[128:129], v[128:129]
    v_pk_add_f32 v[20:21], v[20:21], v[132:133]
    v_pk_fma_f32 v[22:23], v[130:131], v[130:131], v[22:23]
    v_pk_add_f32 v[20:21], v[20:21], v[134:135]
    v_pk_fma_f32 v[22:23], v[132:133], v[132:133], v[22:23]
    v_pk_add_f32 v[20:21], v[20:21], v[136:137]
    v_pk_fma_f32 v[22:23], v[134:135], v[134:135], v[22:23]
    v_pk_add_f32 v[20:21], v[20:21], v[138:139]
    v_pk_fma_f32 v[22:23], v[136:137], v[136:137], v[22:23]
    v_pk_fma_f32 v[22:23], v[138:139], v[138:139], v[22:23]
    s_waitcnt lgkmcnt(0)
    s_barrier
    v_add_f32 v20, v20, v21
    v_add_f32 v21, v22, v23
    s_nop 0
    v_add_f32_dpp v20, v20, v20 row_ror:8 row_mask:0xf bank_mask:0xf
    v_add_f32_dpp v21, v21, v21 row_ror:8 row_mask:0xf bank_mask:0xf
    s_nop 0
    v_add_f32_dpp v20, v20, v20 row_ror:4 row_mask:0xf bank_mask:0xf
    v_add_f32_dpp v21, v21, v21 row_ror:4 row_mask:0xf bank_mask:0xf
    s_nop 0
    v_add_f32_dpp v20, v20, v20 row_ror:2 row_mask:0xf bank_mask:0xf
    v_add_f32_dpp v21, v21, v21 row_ror:2 row_mask:0xf bank_mask:0xf
    s_nop 0
    v_add_f32_dpp v20, v20, v20 row_ror:1 row_mask:0xf bank_mask:0xf
    v_add_f32_dpp v21, v21, v21 row_ror:1 row_mask:0xf bank_mask:0xf
    s_nop 0
    v_add_f32_dpp v20, v20, v20 row_bcast:15 row_mask:0xa bank_mask:0xf
    v_add_f32_dpp v21, v21, v21 row_bcast:15 row_mask:0xa bank_mask:0xf
    s_nop 0
    v_add_f32_dpp v20, v20, v20 row_bcast:31 row_mask:0xc bank_mask:0xf
    v_add_f32_dpp v21, v21, v21 row_bcast:31 row_mask:0xc bank_mask:0xf
    v_mul_f32 v22, 0x3acccccd, v20
    v_mul_f32 v21, 0x3acccccd, v21
    v_fma_f32 v21, -v22, v22, v21
    v_max_f32 v21, 0, v21
    v_add_f32 v21, 0x3727c5ac, v21
    v_rsq_f32 v20, v21
    s_nop 0
    v_mul_f32_e64 v21, -v22, v20
    s_mov_b64 exec, s[54:55]
    ds_write_b64 v12, v[20:21]
    s_mov_b64 exec, -1
    s_cmp_lg_u32 s3, 0
    s_cbranch_scc1 L_w1_x
    ds_read_b64 v[32:33], v11 offset:0
    ds_read_b64 v[40:41], v11 offset:320
    ds_read_b64 v[34:35], v11 offset:2048
    ds_read_b64 v[42:43], v11 offset:2368
    ds_read_b64 v[36:37], v11 offset:4096
    ds_read_b64 v[44:45], v11 offset:4416
    ds_read_b64 v[38:39], v11 offset:6144
    ds_read_b64 v[46:47], v11 offset:6464
    s_mov_b32 s34, 0xbdd2d3e8
    v_mov_b32 v10, 0xc0135761
    s_waitcnt lgkmcnt(8)
    s_barrier
    ds_read_b64 v[28:29], v13
    ds_read_b64 v[20:21], v9 offset:0
    ds_read_b64 v[22:23], v9 offset:2048
    ds_read_b64 v[24:25], v9 offset:4096
    ds_read_b64 v[26:27], v9 offset:6144
    s_waitcnt lgkmcnt(5)
    v_pk_add_f32 v[100:101], v[100:101], v[40:41]
    v_pk_add_f32 v[100:101], v[100:101], v[42:43]
    v_pk_add_f32 v[32:33], v[32:33], v[34:35]
    v_pk_add_f32 v[100:101], v[100:101], v[44:45]
    v_pk_add_f32 v[32:33], v[32:33], v[36:37]
    v_pk_add_f32 v[100:101], v[100:101], v[46:47]
    v_pk_add_f32 v[32:33], v[32:33], v[38:39]
    s_waitcnt lgkmcnt(4)
    v_pk_fma_f32 v[100:101], v[32:33], v[28:29], v[100:101] op_sel:[0,1,0] op_sel_hi:[1,1,1]
    s_waitcnt lgkmcnt(3)
    v_pk_fma_f32 v[100:101], v[20:21], v[28:29], v[100:101] op_sel_hi:[1,0,1]
    s_waitcnt lgkmcnt(2)
    v_pk_fma_f32 v[100:101], v[22:23], v[28:29], v[100:101] op_sel_hi:[1,0,1]
    s_waitcnt lgkmcnt(1)
    v_pk_fma_f32 v[100:101], v[24:25], v[28:29], v[100:101] op_sel_hi:[1,0,1]
    s_waitcnt lgkmcnt(0)
    v_pk_fma_f32 v[100:101], v[26:27], v[28:29], v[100:101] op_sel_hi:[1,0,1]
    v_pk_mul_f32 v[20:21], v[100:101], v[100:101]
    v_fma_f32 v20, v20, s34, v10
    v_fma_f32 v21, v21, s34, v10
    v_pk_mul_f32 v[20:21], v[20:21], v[100:101]
    v_exp_f32 v20, v20
    v_exp_f32 v21, v21
    v_add_f32 v20, 1.0, v20
    v_add_f32 v21, 1.0, v21
    v_rcp_f32 v20, v20
    v_rcp_f32 v21, v21
    s_nop 0
    v_pk_mul_f32 v[20:21], v[20:21], v[100:101]
    v_cvt_pk_bf16_f32 v20, v20, v21
    v_min_u32 v20, -2, v20
    buffer_store_dword v20, v5, s[44:47], s52 offen sc1
    buffer_store_dword v20, v4, s[44:47], s52 offen sc1
    buffer_store_dword v20, v5, s[44:47], s53 offen sc1
    buffer_store_dword v20, v4, s[44:47], s53 offen sc1
    s_endpgm
L_w1_x:
    s_waitcnt lgkmcnt(0)
    s_barrier
    s_endpgm
L_fin:
L_exit:
    s_endpgm
L_codeend:
.section .rodata,"a"
.p2align 6
.amdhsa_kernel adaLN_cond__sliding_block_cached__dense_activation_gelu__decode_kernel
  .amdhsa_next_free_vgpr 256
  .amdhsa_next_free_sgpr 102
  .amdhsa_accum_offset 256
  .amdhsa_group_segment_fixed_size 0
  .amdhsa_kernarg_size 120
  .amdhsa_user_sgpr_count 2
  .amdhsa_user_sgpr_kernarg_segment_ptr 1
  .amdhsa_system_sgpr_workgroup_id_x 1
  .amdhsa_float_denorm_mode_32 3
.end_amdhsa_kernel
```
